```python
import torch

def _softmax(x, axis=-1):
    return torch.softmax(x, dim=axis)

def _gelu(x):
    return torch.nn.functional.gelu(x, approximate='tanh')

def _silu(x):
    return torch.nn.functional.silu(x)

def _sigmoid(x):
    return torch.sigmoid(x)

def _layernorm(x, axis=-1, eps=1e-05):
    m = x.mean(dim=axis, keepdim=True)
    v = x.var(dim=axis, keepdim=True, unbiased=False)
    return (x - m) / torch.sqrt(v + eps)

def _scatter_add(tgt, idx, src, axis=0):
    return tgt.clone().index_add_(axis, idx, src)

def _segment_sum(src, seg, n):
    out = torch.zeros((n,) + src.shape[1:], dtype=src.dtype)
    return out.index_add_(0, seg, src)

def _pad(x, pw):
    flat = tuple((v for pair in reversed(pw) for v in pair))
    return torch.nn.functional.pad(x, flat)
kernel_name = 'concat_heads__memory_aug_recurrent_mem_tr__ssm_conv_s4__prompt'

def setup_inputs():

    _w = lambda a: (lambda t: t.to(torch.bfloat16) if t.is_floating_point() else t)(torch.as_tensor(a))

    def _A_setup():
        B, S, Dm = (1, 2048, 1024)
        H, Dh = (32, 128)
        M, seg = (8, 32)
        seg = min(seg, S)
        S = S // seg * seg
        return {'x': _w((lambda *s: torch.randn(*s, dtype=torch.bfloat16) * 0.05)(B, S, Dm)), 'mem0': _w((lambda *s: torch.randn(*s, dtype=torch.bfloat16) * 0.4)(B, M, Dm)), 'Wq': _w((lambda *s: torch.randn(*s, dtype=torch.bfloat16) * 6.4)(Dm, H, Dh) * Dm ** (-0.5)), 'Wk': _w((lambda *s: torch.randn(*s, dtype=torch.bfloat16) * 6.4)(Dm, H, Dh) * Dm ** (-0.5)), 'Wv': _w((lambda *s: torch.randn(*s, dtype=torch.bfloat16) * 0.4)(Dm, H, Dh) * Dm ** (-0.5)), 'Wo': _w((lambda *s: torch.randn(*s, dtype=torch.bfloat16) * 0.4)(H, Dh, Dm) * (H * Dh) ** (-0.5)), 'seg_len': seg}
    _A_in = _A_setup()

    def _B_setup():
        B, L, D, N = (1, 2048, 1024, 128)
        A_re = -(lambda _x: torch.exp(torch.as_tensor(_x)))((lambda *s: torch.randn(*s, dtype=torch.bfloat16) * 6.4)(D, N))
        A_im = torch.pi * (lambda *s: torch.randn(*s, dtype=torch.bfloat16) * 0.05)(D, N)
        B_re = (lambda *s: torch.randn(*s, dtype=torch.bfloat16) * 0.1)(D, N)
        B_im = (lambda *s: torch.randn(*s, dtype=torch.bfloat16) * 0.1)(D, N)
        C_re = (lambda *s: torch.randn(*s, dtype=torch.bfloat16) * 0.1)(D, N)
        C_im = (lambda *s: torch.randn(*s, dtype=torch.bfloat16) * 0.1)(D, N)
        log_dt = (lambda *s: torch.randn(*s, dtype=torch.bfloat16) * 0.05)(D) * 0.5 - 4.0
        Dskip = (lambda *s: torch.randn(*s, dtype=torch.bfloat16) * 0.05)(D)
        return {'u': _w((lambda *s: torch.randn(*s, dtype=torch.bfloat16) * 0.05)(B, L, D)), 'A_re': _w(A_re), 'A_im': _w(A_im), 'B_re': _w(B_re), 'B_im': _w(B_im), 'C_re': _w(C_re), 'C_im': _w(C_im), 'log_dt': _w(log_dt), 'Dskip': _w(Dskip)}
    _B_in = _B_setup()
    return {'A_x': _A_in['x'], 'A_mem0': _A_in['mem0'], 'A_Wq': _A_in['Wq'], 'A_Wk': _A_in['Wk'], 'A_Wv': _A_in['Wv'], 'A_Wo': _A_in['Wo'], 'A_seg_len': _A_in['seg_len'], 'B_u': _B_in['u'], 'B_A_re': _B_in['A_re'], 'B_A_im': _B_in['A_im'], 'B_B_re': _B_in['B_re'], 'B_B_im': _B_in['B_im'], 'B_C_re': _B_in['C_re'], 'B_C_im': _B_in['C_im'], 'B_log_dt': _B_in['log_dt'], 'B_Dskip': _B_in['Dskip']}

def reference(A_x, A_mem0, A_Wq, A_Wk, A_Wv, A_Wo, A_seg_len, B_u, B_A_re, B_A_im, B_B_re, B_B_im, B_C_re, B_C_im, B_log_dt, B_Dskip):

    def _A_ref(x, mem0, Wq, Wk, Wv, Wo, seg_len):
        B, S, Dm = x.shape
        H, Dh = (Wq.shape[1], Wq.shape[2])
        M = mem0.shape[1]
        scale = Dh ** (-0.5)
        n_seg = S // seg_len
        L = M + seg_len
        idx = torch.arange(L)
        mask = (idx[:, None] < M) | (idx[:, None] >= idx[None, :])
        mem = mem0
        outs = []
        for s in range(n_seg):
            xs = x[:, s * seg_len:(s + 1) * seg_len, :].clone()
            h = torch.concatenate([mem, xs], axis=1)
            q = torch.einsum('btd,dhe->bhte', h, Wq)
            k = torch.einsum('btd,dhe->bhte', h, Wk)
            v = torch.einsum('btd,dhe->bhte', h, Wv)
            scores = torch.einsum('bhqe,bhke->bhqk', q, k) * scale
            scores = torch.where(mask[None, None], scores, -1000000000.0)
            p = _softmax(scores, axis=-1)
            o = torch.einsum('bhqk,bhke->bhqe', p, v)
            o = torch.einsum('bhte,hed->btd', o, Wo)
            mem = o[:, :M, :].clone()
            outs.append(o[:, M:, :])
        return torch.concatenate(outs, axis=1)

    def _B_ref(u, A_re, A_im, B_re, B_im, C_re, C_im, log_dt, Dskip):
        Bsz, L, D = u.shape
        dt = torch.exp(log_dt)[:, None]
        A = A_re + 1j * A_im
        Bc = B_re + 1j * B_im
        Cc = C_re + 1j * C_im
        logdA = dt * A
        dB = dt * Bc
        l = (lambda x, dt: x.to(dt))(torch.arange(L), A_re.dtype)
        P = torch.exp(logdA[:, :, None] * l[None, None, :])
        K = torch.einsum('dn,dnl,dn->dl', Cc, P, dB).real
        L2 = 2 * L
        Kp = _pad(K, ((0, 0), (0, L)))
        up = (lambda x, *d: x.permute(*d))(u, 0, 2, 1)
        up = _pad(up, ((0, 0), (0, 0), (0, L)))
        Kf = (lambda x, axes=(-2, -1): torch.fft.rfft2(x.float(), dim=axes))(Kp[:, None, :], axes=(-2, -1))
        Uf = (lambda x, axes=(-2, -1): torch.fft.rfft2(x.float(), dim=axes))(up[:, :, None, :], axes=(-2, -1))
        Yf = Uf * Kf[None, :, :, :]
        y = (lambda x, s, axes=(-2, -1): torch.fft.irfft2(x, s=s, dim=axes).to(torch.bfloat16))(Yf, (1, L2), axes=(-2, -1))[:, :, 0, :L]
        y = (lambda x, *d: x.permute(*d))(y, 0, 2, 1) + u * Dskip[None, None, :]
        return y
    a = _A_ref(A_x, A_mem0, A_Wq, A_Wk, A_Wv, A_Wo, A_seg_len)
    b = _B_ref(B_u, B_A_re, B_A_im, B_B_re, B_B_im, B_C_re, B_C_im, B_log_dt, B_Dskip)
    return torch.concatenate([a, b], axis=-1)
```

```asm
; @launch grid=(256,1,1) block=(256,1,1) lds=135168
.amdgcn_target "amdgcn-amd-amdhsa--gfx950"
.text
.globl concat_heads__memory_aug_recurrent_mem_tr__ssm_conv_s4__prompt_kernel
.p2align 8
.type concat_heads__memory_aug_recurrent_mem_tr__ssm_conv_s4__prompt_kernel,@function
concat_heads__memory_aug_recurrent_mem_tr__ssm_conv_s4__prompt_kernel:
    s_cmp_ge_u32 s2, 256
    s_cbranch_scc1 L_exit
    s_load_dwordx2 s[4:5], s[0:1], 144
    s_load_dwordx2 s[12:13], s[0:1], 136
    s_getreg_b32 s16, hwreg(HW_REG_XCC_ID, 0, 4)
    v_lshrrev_b32 v1, 6, v0
    s_mov_b32 s6, 0xf000000
    s_mov_b32 s7, 0x20000
    v_readfirstlane_b32 s18, v1
    s_mov_b32 s14, 256
    s_mov_b32 s15, 0x20000
    s_mov_b32 s19, 0
    s_mov_b32 s21, 0
    s_mov_b32 s22, 224
    s_and_b32 s24, s2, 7
    s_lshl_b32 s24, s24, 5
    s_lshr_b32 s20, s2, 3
    s_add_u32 s20, s20, s24
    s_waitcnt lgkmcnt(0)
    s_add_u32 s4, s4, 0x1fffff
    s_addc_u32 s5, s5, 0
    s_and_b32 s4, s4, 0xffe00000
    v_mov_b32 v2, 135104
    s_cmp_lg_u32 s18, 0
    s_cbranch_scc1 L_ticket
    s_and_b32 s24, s16, 3
    s_lshl_b32 s24, s24, 6
    s_and_b32 s25, s16, 12
    s_add_u32 s24, s24, s25
    v_mov_b32 v3, s24
    v_mov_b32 v4, 1
    s_mov_b64 exec, 1
    buffer_atomic_add v4, v3, s[12:15], 0 offen sc0 sc1
    s_waitcnt vmcnt(0)
    ds_write_b32 v2, v4
    s_waitcnt lgkmcnt(0)
    s_mov_b64 exec, -1
L_ticket:
    s_load_dwordx16 s[32:47], s[0:1], 64
    s_load_dwordx2 s[28:29], s[0:1], 56
    s_mul_i32 s54, s18, 21888
    s_add_u32 s54, s54, 0
    v_and_b32 v8, 63, v0
    s_lshl_b32 s52, s20, 2
    s_add_u32 s52, s52, s18
    s_lshl_b32 s53, s52, 8
    v_lshl_add_u32 v9, v8, 2, s53
    s_lshl_b32 s53, s52, 1
    v_mov_b32 v10, s53
    s_mov_b32 s30, 4194304
    s_mov_b32 s31, 0x20000
    s_mov_b32 s56, 0x05040100
    s_mov_b32 s57, 0x07060302
    s_mov_b32 s58, 0xffff0000
    v_lshlrev_b32 v14, 14, v0
    s_lshl_b32 s53, s20, 3
    s_waitcnt lgkmcnt(0)
    global_load_dword v32, v9, s[32:33]
    global_load_dword v33, v9, s[34:35]
    global_load_dword v34, v9, s[36:37]
    global_load_dword v35, v9, s[38:39]
    global_load_dword v36, v9, s[40:41]
    global_load_dword v37, v9, s[42:43]
    global_load_ushort v38, v10, s[44:45]
    s_load_dwordx2 s[48:49], s[46:47], s53
    buffer_load_dwordx2 v[16:17], v14, s[28:31], s53 offen offset:0
    buffer_load_dwordx2 v[18:19], v14, s[28:31], s53 offen offset:2048
    s_add_u32 s53, s53, 4096
    buffer_load_dwordx2 v[20:21], v14, s[28:31], s53 offen offset:0
    buffer_load_dwordx2 v[22:23], v14, s[28:31], s53 offen offset:2048
    s_add_u32 s53, s53, 4096
    buffer_load_dwordx2 v[24:25], v14, s[28:31], s53 offen offset:0
    buffer_load_dwordx2 v[26:27], v14, s[28:31], s53 offen offset:2048
    s_add_u32 s53, s53, 4096
    buffer_load_dwordx2 v[28:29], v14, s[28:31], s53 offen offset:0
    buffer_load_dwordx2 v[30:31], v14, s[28:31], s53 offen offset:2048
    v_and_b32 v11, 15, v8
    v_lshrrev_b32 v12, 4, v8
    v_cvt_f32_u32 v144, v11
    v_mul_f32 v150, 0x41800000, v144
    v_lshl_add_u32 v9, v11, 1, 0
    v_add_u32 v9, 256, v9
    v_and_b32 v10, 3, v11
    v_lshlrev_b32 v10, 2, v10
    v_lshrrev_b32 v13, 2, v11
    v_lshl_add_u32 v10, v13, 8, v10
    v_cmp_gt_u32 vcc, 8, v11
    s_nop 1
    v_cndmask_b32 v9, v10, v9, vcc
    v_cvt_f32_u32 v146, v9
    v_and_b32 v9, 1, v11
    v_lshlrev_b32 v9, 3, v9
    v_lshrrev_b32 v10, 1, v11
    v_min_u32 v10, 4, v10
    v_lshl_add_u32 v9, v10, 8, v9
    v_add_u32 v9, 1024, v9
    v_cvt_f32_u32 v148, v9
    s_waitcnt vmcnt(8)
    v_lshlrev_b32 v39, 16, v38
    v_mul_f32 v39, 0x3fb8aa3b, v39
    v_exp_f32 v39, v39
    s_nop 0
    v_cvt_pk_bf16_f32 v39, v39, v39
    v_and_b32 v39, s58, v39
    v_lshl_add_u32 v9, v8, 5, s54
    v_lshlrev_b32 v40, 16, v32
    v_lshlrev_b32 v41, 16, v33
    v_lshlrev_b32 v42, 16, v34
    v_lshlrev_b32 v43, 16, v35
    v_lshlrev_b32 v44, 16, v36
    v_lshlrev_b32 v45, 16, v37
    v_mul_f32 v40, v39, v40
    v_mul_f32 v41, v39, v41
    v_mul_f32 v42, v39, v42
    v_mul_f32 v43, v39, v43
    v_mul_f32 v48, 0x3fb8aa3b, v40
    v_mul_f32 v49, 0x3e22f983, v41
    v_mul_f32 v50, v44, v42
    v_fma_f32 v50, -v45, v43, v50
    v_mul_f32 v51, v44, v43
    v_fma_f32 v51, v45, v42, v51
    ds_write_b128 v9, v[48:51] offset:4160
    v_and_b32 v40, s58, v32
    v_and_b32 v41, s58, v33
    v_and_b32 v42, s58, v34
    v_and_b32 v43, s58, v35
    v_and_b32 v44, s58, v36
    v_and_b32 v45, s58, v37
    v_mul_f32 v40, v39, v40
    v_mul_f32 v41, v39, v41
    v_mul_f32 v42, v39, v42
    v_mul_f32 v43, v39, v43
    v_mul_f32 v52, 0x3fb8aa3b, v40
    v_mul_f32 v53, 0x3e22f983, v41
    v_mul_f32 v54, v44, v42
    v_fma_f32 v54, -v45, v43, v54
    v_mul_f32 v55, v44, v43
    v_fma_f32 v55, v45, v42, v55
    ds_write_b128 v9, v[52:55] offset:4176
    v_mov_b32 v64, 0
    v_mov_b32 v65, 0
    v_mov_b32 v66, 0
    v_mov_b32 v67, 0
    v_mov_b32 v68, 0
    v_mov_b32 v69, 0
    v_mov_b32 v70, 0
    v_mov_b32 v71, 0
    v_mov_b32 v72, 0
    v_mov_b32 v73, 0
    v_mov_b32 v74, 0
    v_mov_b32 v75, 0
    v_lshl_add_u32 v13, v12, 6, s54
    s_mov_b32 s55, 0
    s_waitcnt lgkmcnt(0)
L_pb_kg:
    ds_read_b128 v[32:35], v13 offset:4160
    ds_read_b128 v[36:39], v13 offset:4176
    ds_read_b128 v[40:43], v13 offset:4192
    ds_read_b128 v[44:47], v13 offset:4208
    v_add_u32 v13, 256, v13
    s_waitcnt lgkmcnt(3)
    v_pk_mul_f32 v[76:77], v[32:33], v[144:145] op_sel_hi:[1,0]
    v_pk_mul_f32 v[80:81], v[32:33], v[146:147] op_sel_hi:[1,0]
    v_pk_mul_f32 v[84:85], v[32:33], v[148:149] op_sel_hi:[1,0]
    v_pk_mul_f32 v[88:89], v[32:33], v[150:151] op_sel_hi:[1,0]
    v_fract_f32 v77, v77
    v_fract_f32 v81, v81
    v_fract_f32 v85, v85
    v_fract_f32 v89, v89
    v_exp_f32 v76, v76
    v_cos_f32 v78, v77
    v_sin_f32 v79, v77
    v_exp_f32 v80, v80
    v_cos_f32 v82, v81
    v_sin_f32 v83, v81
    v_exp_f32 v84, v84
    v_cos_f32 v86, v85
    v_sin_f32 v87, v85
    v_exp_f32 v88, v88
    v_cos_f32 v90, v89
    v_sin_f32 v91, v89
    v_pk_mul_f32 v[78:79], v[78:79], v[76:77] op_sel_hi:[1,0]
    v_pk_mul_f32 v[82:83], v[82:83], v[80:81] op_sel_hi:[1,0]
    v_pk_mul_f32 v[86:87], v[86:87], v[84:85] op_sel_hi:[1,0]
    v_pk_mul_f32 v[90:91], v[90:91], v[88:89] op_sel_hi:[1,0]
    v_pk_mul_f32 v[88:89], v[90:91], v[34:35] op_sel_hi:[0,1] neg_hi:[0,1]
    v_cvt_pk_bf16_f32 v48, v78, v79
    v_cvt_pk_bf16_f32 v52, v82, v83
    v_cvt_pk_bf16_f32 v56, v86, v87
    v_pk_fma_f32 v[88:89], v[90:91], v[34:35], v[88:89] op_sel:[1,1,0] op_sel_hi:[1,0,1] neg_lo:[0,1,0] neg_hi:[0,1,0]
    v_cvt_pk_bf16_f32 v60, v88, v89
    s_waitcnt lgkmcnt(2)
    v_pk_mul_f32 v[76:77], v[36:37], v[144:145] op_sel_hi:[1,0]
    v_pk_mul_f32 v[80:81], v[36:37], v[146:147] op_sel_hi:[1,0]
    v_pk_mul_f32 v[84:85], v[36:37], v[148:149] op_sel_hi:[1,0]
    v_pk_mul_f32 v[88:89], v[36:37], v[150:151] op_sel_hi:[1,0]
    v_fract_f32 v77, v77
    v_fract_f32 v81, v81
    v_fract_f32 v85, v85
    v_fract_f32 v89, v89
    v_exp_f32 v76, v76
    v_cos_f32 v78, v77
    v_sin_f32 v79, v77
    v_exp_f32 v80, v80
    v_cos_f32 v82, v81
    v_sin_f32 v83, v81
    v_exp_f32 v84, v84
    v_cos_f32 v86, v85
    v_sin_f32 v87, v85
    v_exp_f32 v88, v88
    v_cos_f32 v90, v89
    v_sin_f32 v91, v89
    v_pk_mul_f32 v[78:79], v[78:79], v[76:77] op_sel_hi:[1,0]
    v_pk_mul_f32 v[82:83], v[82:83], v[80:81] op_sel_hi:[1,0]
    v_pk_mul_f32 v[86:87], v[86:87], v[84:85] op_sel_hi:[1,0]
    v_pk_mul_f32 v[90:91], v[90:91], v[88:89] op_sel_hi:[1,0]
    v_pk_mul_f32 v[88:89], v[90:91], v[38:39] op_sel_hi:[0,1] neg_hi:[0,1]
    v_cvt_pk_bf16_f32 v49, v78, v79
    v_cvt_pk_bf16_f32 v53, v82, v83
    v_cvt_pk_bf16_f32 v57, v86, v87
    v_pk_fma_f32 v[88:89], v[90:91], v[38:39], v[88:89] op_sel:[1,1,0] op_sel_hi:[1,0,1] neg_lo:[0,1,0] neg_hi:[0,1,0]
    v_cvt_pk_bf16_f32 v61, v88, v89
    s_waitcnt lgkmcnt(1)
    v_pk_mul_f32 v[76:77], v[40:41], v[144:145] op_sel_hi:[1,0]
    v_pk_mul_f32 v[80:81], v[40:41], v[146:147] op_sel_hi:[1,0]
    v_pk_mul_f32 v[84:85], v[40:41], v[148:149] op_sel_hi:[1,0]
    v_pk_mul_f32 v[88:89], v[40:41], v[150:151] op_sel_hi:[1,0]
    v_fract_f32 v77, v77
    v_fract_f32 v81, v81
    v_fract_f32 v85, v85
    v_fract_f32 v89, v89
    v_exp_f32 v76, v76
    v_cos_f32 v78, v77
    v_sin_f32 v79, v77
    v_exp_f32 v80, v80
    v_cos_f32 v82, v81
    v_sin_f32 v83, v81
    v_exp_f32 v84, v84
    v_cos_f32 v86, v85
    v_sin_f32 v87, v85
    v_exp_f32 v88, v88
    v_cos_f32 v90, v89
    v_sin_f32 v91, v89
    v_pk_mul_f32 v[78:79], v[78:79], v[76:77] op_sel_hi:[1,0]
    v_pk_mul_f32 v[82:83], v[82:83], v[80:81] op_sel_hi:[1,0]
    v_pk_mul_f32 v[86:87], v[86:87], v[84:85] op_sel_hi:[1,0]
    v_pk_mul_f32 v[90:91], v[90:91], v[88:89] op_sel_hi:[1,0]
    v_pk_mul_f32 v[88:89], v[90:91], v[42:43] op_sel_hi:[0,1] neg_hi:[0,1]
    v_cvt_pk_bf16_f32 v50, v78, v79
    v_cvt_pk_bf16_f32 v54, v82, v83
    v_cvt_pk_bf16_f32 v58, v86, v87
    v_pk_fma_f32 v[88:89], v[90:91], v[42:43], v[88:89] op_sel:[1,1,0] op_sel_hi:[1,0,1] neg_lo:[0,1,0] neg_hi:[0,1,0]
    v_cvt_pk_bf16_f32 v62, v88, v89
    s_waitcnt lgkmcnt(0)
    v_pk_mul_f32 v[76:77], v[44:45], v[144:145] op_sel_hi:[1,0]
    v_pk_mul_f32 v[80:81], v[44:45], v[146:147] op_sel_hi:[1,0]
    v_pk_mul_f32 v[84:85], v[44:45], v[148:149] op_sel_hi:[1,0]
    v_pk_mul_f32 v[88:89], v[44:45], v[150:151] op_sel_hi:[1,0]
    v_fract_f32 v77, v77
    v_fract_f32 v81, v81
    v_fract_f32 v85, v85
    v_fract_f32 v89, v89
    v_exp_f32 v76, v76
    v_cos_f32 v78, v77
    v_sin_f32 v79, v77
    v_exp_f32 v80, v80
    v_cos_f32 v82, v81
    v_sin_f32 v83, v81
    v_exp_f32 v84, v84
    v_cos_f32 v86, v85
    v_sin_f32 v87, v85
    v_exp_f32 v88, v88
    v_cos_f32 v90, v89
    v_sin_f32 v91, v89
    v_pk_mul_f32 v[78:79], v[78:79], v[76:77] op_sel_hi:[1,0]
    v_pk_mul_f32 v[82:83], v[82:83], v[80:81] op_sel_hi:[1,0]
    v_pk_mul_f32 v[86:87], v[86:87], v[84:85] op_sel_hi:[1,0]
    v_pk_mul_f32 v[90:91], v[90:91], v[88:89] op_sel_hi:[1,0]
    v_pk_mul_f32 v[88:89], v[90:91], v[46:47] op_sel_hi:[0,1] neg_hi:[0,1]
    v_cvt_pk_bf16_f32 v51, v78, v79
    v_cvt_pk_bf16_f32 v55, v82, v83
    v_cvt_pk_bf16_f32 v59, v86, v87
    v_pk_fma_f32 v[88:89], v[90:91], v[46:47], v[88:89] op_sel:[1,1,0] op_sel_hi:[1,0,1] neg_lo:[0,1,0] neg_hi:[0,1,0]
    v_cvt_pk_bf16_f32 v63, v88, v89
    s_add_u32 s55, s55, 1
    s_cmp_lt_u32 s55, 8
    v_mfma_f32_16x16x32_bf16 v[64:67], v[48:51], v[60:63], v[64:67]
    v_mfma_f32_16x16x32_bf16 v[68:71], v[52:55], v[60:63], v[68:71]
    v_mfma_f32_16x16x32_bf16 v[72:75], v[56:59], v[60:63], v[72:75]
    s_cbranch_scc1 L_pb_kg
    v_lshlrev_b32 v9, 5, v11
    v_lshl_add_u32 v9, v12, 3, v9
    v_add_u32 v9, s54, v9
    v_lshlrev_b32 v10, 4, v11
    v_lshl_add_u32 v10, v12, 3, v10
    v_lshlrev_b32 v13, 3, v11
    v_lshl_add_u32 v13, v12, 7, v13
    v_cmp_gt_u32 vcc, 2, v12
    s_nop 1
    v_cndmask_b32 v10, v13, v10, vcc
    v_add_u32 v10, s54, v10
    v_lshlrev_b32 v13, 2, v11
    v_lshl_add_u32 v13, v12, 7, v13
    v_add_u32 v13, s54, v13
    v_cvt_pk_bf16_f32 v76, v64, v65
    v_cvt_pk_bf16_f32 v77, v66, v67
    v_cvt_pk_bf16_f32 v78, v68, v69
    v_cvt_pk_bf16_f32 v79, v70, v71
    v_cvt_pk_bf16_f32 v80, v72, v73
    v_cvt_pk_bf16_f32 v81, v74, v75
    ds_write_b64 v9, v[76:77]
    ds_write_b64 v10, v[78:79] offset:512
    ds_write_b32 v13, v80 offset:1024
    ds_write_b32 v13, v81 offset:1088
    v_lshrrev_b32 v9, 2, v0
    v_mul_u32_u24 v9, 80, v9
    v_and_b32 v10, 3, v0
    v_lshl_add_u32 v13, v10, 4, v9
    v_add_u32 v13, 16720, v13
    v_add_u32 v159, 43776, v13
    s_waitcnt vmcnt(0)
    v_perm_b32 v84, v18, v16, s56
    v_perm_b32 v85, v22, v20, s56
    v_perm_b32 v86, v26, v24, s56
    v_perm_b32 v87, v30, v28, s56
    ds_write_b128 v13, v[84:87] offset:0
    v_perm_b32 v88, v18, v16, s57
    v_perm_b32 v89, v22, v20, s57
    v_perm_b32 v90, v26, v24, s57
    v_perm_b32 v91, v30, v28, s57
    ds_write_b128 v13, v[88:91] offset:21888
    v_perm_b32 v92, v19, v17, s56
    v_perm_b32 v93, v23, v21, s56
    v_perm_b32 v94, v27, v25, s56
    v_perm_b32 v95, v31, v29, s56
    ds_write_b128 v159, v[92:95] offset:0
    v_perm_b32 v96, v19, v17, s57
    v_perm_b32 v97, v23, v21, s57
    v_perm_b32 v98, v27, v25, s57
    v_perm_b32 v99, v31, v29, s57
    ds_write_b128 v159, v[96:99] offset:21888
    v_lshlrev_b32 v9, 3, v8
    v_sub_u32 v9, 2047, v9
    v_cvt_f32_u32 v10, v9
    s_sub_u32 s52, s54, 34048
    s_waitcnt lgkmcnt(0)
    v_subrev_f32 v64, 0x0, v10
    v_subrev_f32 v65, 0x3f800000, v10
    v_cvt_pk_bf16_f32 v66, v64, v65
    v_and_b32 v64, 0xffff, v66
    v_lshrrev_b32 v65, 16, v66
    v_lshl_add_u32 v76, v64, 1, s52
    v_lshl_add_u32 v77, v65, 1, s52
    v_subrev_f32 v64, 0x40000000, v10
    v_subrev_f32 v65, 0x40400000, v10
    v_cvt_pk_bf16_f32 v66, v64, v65
    v_and_b32 v64, 0xffff, v66
    v_lshrrev_b32 v65, 16, v66
    v_lshl_add_u32 v78, v64, 1, s52
    v_lshl_add_u32 v79, v65, 1, s52
    v_subrev_f32 v64, 0x40800000, v10
    v_subrev_f32 v65, 0x40a00000, v10
    v_cvt_pk_bf16_f32 v66, v64, v65
    v_and_b32 v64, 0xffff, v66
    v_lshrrev_b32 v65, 16, v66
    v_lshl_add_u32 v80, v64, 1, s52
    v_lshl_add_u32 v81, v65, 1, s52
    v_subrev_f32 v64, 0x40c00000, v10
    v_subrev_f32 v65, 0x40e00000, v10
    v_cvt_pk_bf16_f32 v66, v64, v65
    v_and_b32 v64, 0xffff, v66
    v_lshrrev_b32 v65, 16, v66
    v_lshl_add_u32 v82, v64, 1, s52
    v_lshl_add_u32 v83, v65, 1, s52
    s_waitcnt lgkmcnt(0)
    ds_read_u16 v32, v76
    ds_read_u16 v36, v77
    ds_read_u16 v33, v78
    ds_read_u16 v37, v79
    ds_read_u16 v34, v80
    ds_read_u16 v38, v81
    ds_read_u16 v35, v82
    ds_read_u16 v39, v83
    v_subrev_f32 v64, 0x44000000, v10
    v_subrev_f32 v65, 0x44004000, v10
    v_cvt_pk_bf16_f32 v66, v64, v65
    v_and_b32 v64, 0xffff, v66
    v_lshrrev_b32 v65, 16, v66
    v_lshl_add_u32 v76, v64, 1, s52
    v_lshl_add_u32 v77, v65, 1, s52
    v_subrev_f32 v64, 0x44008000, v10
    v_subrev_f32 v65, 0x4400c000, v10
    v_cvt_pk_bf16_f32 v66, v64, v65
    v_and_b32 v64, 0xffff, v66
    v_lshrrev_b32 v65, 16, v66
    v_lshl_add_u32 v78, v64, 1, s52
    v_lshl_add_u32 v79, v65, 1, s52
    v_subrev_f32 v64, 0x44010000, v10
    v_subrev_f32 v65, 0x44014000, v10
    v_cvt_pk_bf16_f32 v66, v64, v65
    v_and_b32 v64, 0xffff, v66
    v_lshrrev_b32 v65, 16, v66
    v_lshl_add_u32 v80, v64, 1, s52
    v_lshl_add_u32 v81, v65, 1, s52
    v_subrev_f32 v64, 0x44018000, v10
    v_subrev_f32 v65, 0x4401c000, v10
    v_cvt_pk_bf16_f32 v66, v64, v65
    v_and_b32 v64, 0xffff, v66
    v_lshrrev_b32 v65, 16, v66
    v_lshl_add_u32 v82, v64, 1, s52
    v_lshl_add_u32 v83, v65, 1, s52
    s_waitcnt lgkmcnt(0)
    ds_read_u16 v40, v76
    ds_read_u16 v44, v77
    ds_read_u16 v41, v78
    ds_read_u16 v45, v79
    ds_read_u16 v42, v80
    ds_read_u16 v46, v81
    ds_read_u16 v43, v82
    ds_read_u16 v47, v83
    v_subrev_f32 v64, 0x44800000, v10
    v_subrev_f32 v65, 0x44802000, v10
    v_cvt_pk_bf16_f32 v66, v64, v65
    v_and_b32 v64, 0xffff, v66
    v_lshrrev_b32 v65, 16, v66
    v_lshl_add_u32 v76, v64, 1, s52
    v_lshl_add_u32 v77, v65, 1, s52
    v_subrev_f32 v64, 0x44804000, v10
    v_subrev_f32 v65, 0x44806000, v10
    v_cvt_pk_bf16_f32 v66, v64, v65
    v_and_b32 v64, 0xffff, v66
    v_lshrrev_b32 v65, 16, v66
    v_lshl_add_u32 v78, v64, 1, s52
    v_lshl_add_u32 v79, v65, 1, s52
    v_subrev_f32 v64, 0x44808000, v10
    v_subrev_f32 v65, 0x4480a000, v10
    v_cvt_pk_bf16_f32 v66, v64, v65
    v_and_b32 v64, 0xffff, v66
    v_lshrrev_b32 v65, 16, v66
    v_lshl_add_u32 v80, v64, 1, s52
    v_lshl_add_u32 v81, v65, 1, s52
    v_subrev_f32 v64, 0x4480c000, v10
    v_subrev_f32 v65, 0x4480e000, v10
    v_cvt_pk_bf16_f32 v66, v64, v65
    v_and_b32 v64, 0xffff, v66
    v_lshrrev_b32 v65, 16, v66
    v_lshl_add_u32 v82, v64, 1, s52
    v_lshl_add_u32 v83, v65, 1, s52
    s_waitcnt lgkmcnt(0)
    ds_read_u16 v48, v76
    ds_read_u16 v52, v77
    ds_read_u16 v49, v78
    ds_read_u16 v53, v79
    ds_read_u16 v50, v80
    ds_read_u16 v54, v81
    ds_read_u16 v51, v82
    ds_read_u16 v55, v83
    v_subrev_f32 v64, 0x44c00000, v10
    v_subrev_f32 v65, 0x44c02000, v10
    v_cvt_pk_bf16_f32 v66, v64, v65
    v_and_b32 v64, 0xffff, v66
    v_lshrrev_b32 v65, 16, v66
    v_subrev_u32 v66, 1536, v9
    v_min_u32 v66, 128, v66
    v_add_u32 v66, 17024, v66
    v_max_u32 v64, v64, v66
    v_subrev_u32 v66, 1537, v9
    v_min_u32 v66, 128, v66
    v_add_u32 v66, 17024, v66
    v_max_u32 v65, v65, v66
    v_lshl_add_u32 v76, v64, 1, s52
    v_lshl_add_u32 v77, v65, 1, s52
    v_subrev_f32 v64, 0x44c04000, v10
    v_subrev_f32 v65, 0x44c06000, v10
    v_cvt_pk_bf16_f32 v66, v64, v65
    v_and_b32 v64, 0xffff, v66
    v_lshrrev_b32 v65, 16, v66
    v_subrev_u32 v66, 1538, v9
    v_min_u32 v66, 128, v66
    v_add_u32 v66, 17024, v66
    v_max_u32 v64, v64, v66
    v_subrev_u32 v66, 1539, v9
    v_min_u32 v66, 128, v66
    v_add_u32 v66, 17024, v66
    v_max_u32 v65, v65, v66
    v_lshl_add_u32 v78, v64, 1, s52
    v_lshl_add_u32 v79, v65, 1, s52
    v_subrev_f32 v64, 0x44c08000, v10
    v_subrev_f32 v65, 0x44c0a000, v10
    v_cvt_pk_bf16_f32 v66, v64, v65
    v_and_b32 v64, 0xffff, v66
    v_lshrrev_b32 v65, 16, v66
    v_subrev_u32 v66, 1540, v9
    v_min_u32 v66, 128, v66
    v_add_u32 v66, 17024, v66
    v_max_u32 v64, v64, v66
    v_subrev_u32 v66, 1541, v9
    v_min_u32 v66, 128, v66
    v_add_u32 v66, 17024, v66
    v_max_u32 v65, v65, v66
    v_lshl_add_u32 v80, v64, 1, s52
    v_lshl_add_u32 v81, v65, 1, s52
    v_subrev_f32 v64, 0x44c0c000, v10
    v_subrev_f32 v65, 0x44c0e000, v10
    v_cvt_pk_bf16_f32 v66, v64, v65
    v_and_b32 v64, 0xffff, v66
    v_lshrrev_b32 v65, 16, v66
    v_subrev_u32 v66, 1542, v9
    v_min_u32 v66, 128, v66
    v_add_u32 v66, 17024, v66
    v_max_u32 v64, v64, v66
    v_subrev_u32 v66, 1543, v9
    v_min_u32 v66, 128, v66
    v_add_u32 v66, 17024, v66
    v_max_u32 v65, v65, v66
    v_lshl_add_u32 v82, v64, 1, s52
    v_lshl_add_u32 v83, v65, 1, s52
    s_waitcnt lgkmcnt(0)
    ds_read_u16 v56, v76
    ds_read_u16 v60, v77
    ds_read_u16 v57, v78
    ds_read_u16 v61, v79
    ds_read_u16 v58, v80
    ds_read_u16 v62, v81
    ds_read_u16 v59, v82
    ds_read_u16 v63, v83
    v_lshl_add_u32 v9, v8, 4, s54
    v_mov_b32 v64, 0
    v_mov_b32 v65, 0
    v_mov_b32 v66, 0
    v_mov_b32 v67, 0
    v_lshrrev_b32 v10, 2, v8
    v_mul_u32_u24 v10, 4096, v10
    v_add_u32 v10, 4096, v10
    v_cmp_gt_u32 vcc, 16, v8
    v_mov_b32 v11, 16384
    s_nop 0
    v_cndmask_b32 v10, v11, v10, vcc
    v_add_u32 v10, v10, v9
    s_waitcnt lgkmcnt(0)
    s_mov_b64 exec, 0x1fffff
    ds_write_b128 v10, v[64:67]
    s_mov_b64 exec, -1
    v_lshl_or_b32 v32, v36, 16, v32
    v_lshl_or_b32 v33, v37, 16, v33
    v_lshl_or_b32 v34, v38, 16, v34
    v_lshl_or_b32 v35, v39, 16, v35
    ds_write_b128 v9, v[32:35] offset:12480
    v_lshl_or_b32 v40, v44, 16, v40
    v_lshl_or_b32 v41, v45, 16, v41
    v_lshl_or_b32 v42, v46, 16, v42
    v_lshl_or_b32 v43, v47, 16, v43
    ds_write_b128 v9, v[40:43] offset:13504
    v_lshl_or_b32 v48, v52, 16, v48
    v_lshl_or_b32 v49, v53, 16, v49
    v_lshl_or_b32 v50, v54, 16, v50
    v_lshl_or_b32 v51, v55, 16, v51
    ds_write_b128 v9, v[48:51] offset:14528
    v_lshl_or_b32 v56, v60, 16, v56
    v_lshl_or_b32 v57, v61, 16, v57
    v_lshl_or_b32 v58, v62, 16, v58
    v_lshl_or_b32 v59, v63, 16, v59
    ds_write_b128 v9, v[56:59] offset:15552
    s_waitcnt lgkmcnt(0)
    ds_read_b64 v[36:37], v9 offset:12496
    ds_read_b64 v[44:45], v9 offset:13520
    ds_read_b64 v[52:53], v9 offset:14544
    ds_read_b64 v[60:61], v9 offset:15568
    s_waitcnt lgkmcnt(0)
    v_alignbit_b32 v76, v33, v32, 16
    v_mov_b32 v80, v33
    v_alignbit_b32 v84, v34, v33, 16
    v_alignbit_b32 v77, v34, v33, 16
    v_mov_b32 v81, v34
    v_alignbit_b32 v85, v35, v34, 16
    v_alignbit_b32 v78, v35, v34, 16
    v_mov_b32 v82, v35
    v_alignbit_b32 v86, v36, v35, 16
    v_alignbit_b32 v79, v36, v35, 16
    v_mov_b32 v83, v36
    v_alignbit_b32 v87, v37, v36, 16
    ds_write_b128 v9, v[76:79] offset:8320
    ds_write_b128 v9, v[80:83] offset:4160
    ds_write_b128 v9, v[84:87] offset:0
    v_alignbit_b32 v88, v41, v40, 16
    v_mov_b32 v92, v41
    v_alignbit_b32 v96, v42, v41, 16
    v_alignbit_b32 v89, v42, v41, 16
    v_mov_b32 v93, v42
    v_alignbit_b32 v97, v43, v42, 16
    v_alignbit_b32 v90, v43, v42, 16
    v_mov_b32 v94, v43
    v_alignbit_b32 v98, v44, v43, 16
    v_alignbit_b32 v91, v44, v43, 16
    v_mov_b32 v95, v44
    v_alignbit_b32 v99, v45, v44, 16
    ds_write_b128 v9, v[88:91] offset:9344
    ds_write_b128 v9, v[92:95] offset:5184
    ds_write_b128 v9, v[96:99] offset:1024
    v_alignbit_b32 v76, v49, v48, 16
    v_mov_b32 v80, v49
    v_alignbit_b32 v84, v50, v49, 16
    v_alignbit_b32 v77, v50, v49, 16
    v_mov_b32 v81, v50
    v_alignbit_b32 v85, v51, v50, 16
    v_alignbit_b32 v78, v51, v50, 16
    v_mov_b32 v82, v51
    v_alignbit_b32 v86, v52, v51, 16
    v_alignbit_b32 v79, v52, v51, 16
    v_mov_b32 v83, v52
    v_alignbit_b32 v87, v53, v52, 16
    ds_write_b128 v9, v[76:79] offset:10368
    ds_write_b128 v9, v[80:83] offset:6208
    ds_write_b128 v9, v[84:87] offset:2048
    v_alignbit_b32 v88, v57, v56, 16
    v_mov_b32 v92, v57
    v_alignbit_b32 v96, v58, v57, 16
    v_alignbit_b32 v89, v58, v57, 16
    v_mov_b32 v93, v58
    v_alignbit_b32 v97, v59, v58, 16
    v_alignbit_b32 v90, v59, v58, 16
    v_mov_b32 v94, v59
    v_alignbit_b32 v98, v60, v59, 16
    v_alignbit_b32 v91, v60, v59, 16
    v_mov_b32 v95, v60
    v_alignbit_b32 v99, v61, v60, 16
    ds_write_b128 v9, v[88:91] offset:11392
    ds_write_b128 v9, v[92:95] offset:7232
    ds_write_b128 v9, v[96:99] offset:3072
    v_and_b32 v10, 3, v8
    v_mul_u32_u24 v9, 4160, v10
    v_bfe_u32 v10, v8, 3, 1
    v_bfe_u32 v11, v8, 2, 1
    v_lshl_add_u32 v10, v11, 1, v10
    v_bfe_u32 v11, v8, 4, 1
    v_lshl_add_u32 v10, v11, 2, v10
    v_lshlrev_b32 v10, 3, v10
    v_sub_u32 v9, v9, v10
    v_lshrrev_b32 v11, 5, v8
    v_lshl_add_u32 v9, v11, 4, v9
    s_add_u32 s52, s54, 2040
    v_add_u32 v9, s52, v9
    v_and_b32 v10, 31, v8
    v_mul_u32_u24 v10, 80, v10
    v_lshl_add_u32 v11, v11, 4, v10
    s_add_u32 s52, s54, 16720
    v_add_u32 v11, s52, v11
    v_mov_b32 v158, v11
    v_mov_b32 v12, v11
    s_sub_u32 s53, s52, 80
    v_mov_b32 v32, 0
    v_mov_b32 v33, 0
    v_mov_b32 v34, 0
    v_mov_b32 v35, 0
    v_mov_b32 v36, 0
    v_mov_b32 v37, 0
    v_mov_b32 v38, 0
    v_mov_b32 v39, 0
    v_mov_b32 v40, 0
    v_mov_b32 v41, 0
    v_mov_b32 v42, 0
    v_mov_b32 v43, 0
    v_mov_b32 v44, 0
    v_mov_b32 v45, 0
    v_mov_b32 v46, 0
    v_mov_b32 v47, 0
    v_mov_b32 v48, 0
    v_mov_b32 v49, 0
    v_mov_b32 v50, 0
    v_mov_b32 v51, 0
    v_mov_b32 v52, 0
    v_mov_b32 v53, 0
    v_mov_b32 v54, 0
    v_mov_b32 v55, 0
    v_mov_b32 v56, 0
    v_mov_b32 v57, 0
    v_mov_b32 v58, 0
    v_mov_b32 v59, 0
    v_mov_b32 v60, 0
    v_mov_b32 v61, 0
    v_mov_b32 v62, 0
    v_mov_b32 v63, 0
    s_waitcnt lgkmcnt(0)
    s_barrier
    ds_read_b64 v[64:65], v9 offset:2080
    ds_read_b64 v[66:67], v9 offset:2088
    ds_read_b128 v[72:75], v11 offset:2592
    ds_read_b128 v[76:79], v12 offset:32
    ds_read_b64 v[68:69], v9 offset:32
    ds_read_b64 v[70:71], v9 offset:40
    s_mov_b32 s55, 0
L_pb_cv0:
    ds_read_b64 v[80:81], v9 offset:2048
    ds_read_b64 v[82:83], v9 offset:2056
    ds_read_b128 v[88:91], v11 offset:2560
    ds_read_b128 v[92:95], v12 offset:0
    ds_read_b64 v[84:85], v9 offset:0
    ds_read_b64 v[86:87], v9 offset:8
    s_waitcnt lgkmcnt(6)
    v_mfma_f32_32x32x16_bf16 v[48:63], v[64:67], v[72:75], v[48:63]
    v_subrev_u32 v9, 64, v9
    v_subrev_u32 v11, 80, v11
    v_max_i32 v12, s53, v11
    v_mfma_f32_32x32x16_bf16 v[32:47], v[64:67], v[76:79], v[32:47]
    v_mfma_f32_32x32x16_bf16 v[48:63], v[68:71], v[76:79], v[48:63]
    ds_read_b64 v[64:65], v9 offset:2080
    ds_read_b64 v[66:67], v9 offset:2088
    ds_read_b128 v[72:75], v11 offset:2592
    ds_read_b128 v[76:79], v12 offset:32
    ds_read_b64 v[68:69], v9 offset:32
    ds_read_b64 v[70:71], v9 offset:40
    s_waitcnt lgkmcnt(6)
    v_mfma_f32_32x32x16_bf16 v[48:63], v[80:83], v[88:91], v[48:63]
    s_add_u32 s55, s55, 1
    s_cmp_lt_u32 s55, 16
    v_mfma_f32_32x32x16_bf16 v[32:47], v[80:83], v[92:95], v[32:47]
    v_mfma_f32_32x32x16_bf16 v[48:63], v[84:87], v[92:95], v[48:63]
    s_cbranch_scc1 L_pb_cv0
    s_mov_b32 s55, 0
L_pb_cv1:
    ds_read_b64 v[80:81], v9 offset:2048
    ds_read_b64 v[82:83], v9 offset:2056
    ds_read_b128 v[88:91], v11 offset:2560
    ds_read_b128 v[92:95], v12 offset:0
    ds_read_b64 v[84:85], v9 offset:0
    ds_read_b64 v[86:87], v9 offset:8
    s_waitcnt lgkmcnt(6)
    v_mfma_f32_32x32x16_bf16 v[48:63], v[64:67], v[72:75], v[48:63]
    v_subrev_u32 v9, 64, v9
    v_subrev_u32 v11, 80, v11
    v_max_i32 v12, s53, v11
    v_mfma_f32_32x32x16_bf16 v[32:47], v[64:67], v[76:79], v[32:47]
    v_mfma_f32_32x32x16_bf16 v[48:63], v[68:71], v[76:79], v[48:63]
    ds_read_b64 v[64:65], v9 offset:2080
    ds_read_b64 v[66:67], v9 offset:2088
    ds_read_b128 v[72:75], v11 offset:2592
    ds_read_b128 v[76:79], v12 offset:32
    ds_read_b64 v[68:69], v9 offset:32
    ds_read_b64 v[70:71], v9 offset:40
    s_waitcnt lgkmcnt(6)
    v_mfma_f32_32x32x16_bf16 v[48:63], v[80:83], v[88:91], v[48:63]
    s_add_u32 s55, s55, 1
    s_cmp_lt_u32 s55, 16
    v_mfma_f32_32x32x16_bf16 v[32:47], v[80:83], v[92:95], v[32:47]
    v_mfma_f32_32x32x16_bf16 v[48:63], v[84:87], v[92:95], v[48:63]
    s_cbranch_scc1 L_pb_cv1
    s_load_dwordx2 s[28:29], s[0:1], 128
    s_mov_b32 s30, 8388608
    s_mov_b32 s31, 0x20000
    s_lshl_b32 s50, s49, 16
    s_and_b32 s51, s49, s58
    s_and_b32 s49, s48, s58
    s_lshl_b32 s48, s48, 16
    v_lshlrev_b32 v14, 1, v14
    s_lshl_b32 s53, s20, 3
    s_add_u32 s53, s53, 2048
    s_waitcnt lgkmcnt(0)
    s_nop 1
    v_cvt_pk_bf16_f32 v96, v32, v33
    v_cvt_pk_bf16_f32 v97, v34, v35
    v_cvt_pk_bf16_f32 v98, v36, v37
    v_cvt_pk_bf16_f32 v99, v38, v39
    v_cvt_pk_bf16_f32 v100, v40, v41
    v_cvt_pk_bf16_f32 v101, v42, v43
    v_cvt_pk_bf16_f32 v102, v44, v45
    v_cvt_pk_bf16_f32 v103, v46, v47
    ds_write_b128 v158, v[96:99] offset:0
    ds_write_b128 v158, v[100:103] offset:32
    v_cvt_pk_bf16_f32 v104, v48, v49
    v_cvt_pk_bf16_f32 v105, v50, v51
    v_cvt_pk_bf16_f32 v106, v52, v53
    v_cvt_pk_bf16_f32 v107, v54, v55
    v_cvt_pk_bf16_f32 v108, v56, v57
    v_cvt_pk_bf16_f32 v109, v58, v59
    v_cvt_pk_bf16_f32 v110, v60, v61
    v_cvt_pk_bf16_f32 v111, v62, v63
    ds_write_b128 v158, v[104:107] offset:2560
    ds_write_b128 v158, v[108:111] offset:2592
    s_waitcnt lgkmcnt(0)
    s_barrier
    ds_read_b128 v[32:35], v13 offset:0
    ds_read_b128 v[36:39], v13 offset:21888
    ds_read_b128 v[40:43], v159 offset:0
    ds_read_b128 v[44:47], v159 offset:21888
    v_lshlrev_b32 v48, 16, v16
    v_and_b32 v49, s58, v16
    v_pk_mul_f32 v[48:49], v[48:49], s[48:49]
    v_cvt_pk_bf16_f32 v16, v48, v49
    v_lshlrev_b32 v48, 16, v16
    v_and_b32 v49, s58, v16
    v_lshlrev_b32 v50, 16, v17
    v_and_b32 v51, s58, v17
    v_pk_mul_f32 v[50:51], v[50:51], s[50:51]
    v_cvt_pk_bf16_f32 v17, v50, v51
    v_lshlrev_b32 v50, 16, v17
    v_and_b32 v51, s58, v17
    v_lshlrev_b32 v52, 16, v18
    v_and_b32 v53, s58, v18
    v_pk_mul_f32 v[52:53], v[52:53], s[48:49]
    v_cvt_pk_bf16_f32 v18, v52, v53
    v_lshlrev_b32 v52, 16, v18
    v_and_b32 v53, s58, v18
    v_lshlrev_b32 v54, 16, v19
    v_and_b32 v55, s58, v19
    v_pk_mul_f32 v[54:55], v[54:55], s[50:51]
    v_cvt_pk_bf16_f32 v19, v54, v55
    v_lshlrev_b32 v54, 16, v19
    v_and_b32 v55, s58, v19
    v_lshlrev_b32 v56, 16, v20
    v_and_b32 v57, s58, v20
    v_pk_mul_f32 v[56:57], v[56:57], s[48:49]
    v_cvt_pk_bf16_f32 v20, v56, v57
    v_lshlrev_b32 v56, 16, v20
    v_and_b32 v57, s58, v20
    v_lshlrev_b32 v58, 16, v21
    v_and_b32 v59, s58, v21
    v_pk_mul_f32 v[58:59], v[58:59], s[50:51]
    v_cvt_pk_bf16_f32 v21, v58, v59
    v_lshlrev_b32 v58, 16, v21
    v_and_b32 v59, s58, v21
    v_lshlrev_b32 v60, 16, v22
    v_and_b32 v61, s58, v22
    v_pk_mul_f32 v[60:61], v[60:61], s[48:49]
    v_cvt_pk_bf16_f32 v22, v60, v61
    v_lshlrev_b32 v60, 16, v22
    v_and_b32 v61, s58, v22
    v_lshlrev_b32 v62, 16, v23
    v_and_b32 v63, s58, v23
    v_pk_mul_f32 v[62:63], v[62:63], s[50:51]
    v_cvt_pk_bf16_f32 v23, v62, v63
    v_lshlrev_b32 v62, 16, v23
    v_and_b32 v63, s58, v23
    v_lshlrev_b32 v64, 16, v24
    v_and_b32 v65, s58, v24
    v_pk_mul_f32 v[64:65], v[64:65], s[48:49]
    v_cvt_pk_bf16_f32 v24, v64, v65
    v_lshlrev_b32 v64, 16, v24
    v_and_b32 v65, s58, v24
    v_lshlrev_b32 v66, 16, v25
    v_and_b32 v67, s58, v25
    v_pk_mul_f32 v[66:67], v[66:67], s[50:51]
    v_cvt_pk_bf16_f32 v25, v66, v67
    v_lshlrev_b32 v66, 16, v25
    v_and_b32 v67, s58, v25
    v_lshlrev_b32 v68, 16, v26
    v_and_b32 v69, s58, v26
    v_pk_mul_f32 v[68:69], v[68:69], s[48:49]
    v_cvt_pk_bf16_f32 v26, v68, v69
    v_lshlrev_b32 v68, 16, v26
    v_and_b32 v69, s58, v26
    v_lshlrev_b32 v70, 16, v27
    v_and_b32 v71, s58, v27
    v_pk_mul_f32 v[70:71], v[70:71], s[50:51]
    v_cvt_pk_bf16_f32 v27, v70, v71
    v_lshlrev_b32 v70, 16, v27
    v_and_b32 v71, s58, v27
    v_lshlrev_b32 v72, 16, v28
    v_and_b32 v73, s58, v28
    v_pk_mul_f32 v[72:73], v[72:73], s[48:49]
    v_cvt_pk_bf16_f32 v28, v72, v73
    v_lshlrev_b32 v72, 16, v28
    v_and_b32 v73, s58, v28
    v_lshlrev_b32 v74, 16, v29
    v_and_b32 v75, s58, v29
    v_pk_mul_f32 v[74:75], v[74:75], s[50:51]
    v_cvt_pk_bf16_f32 v29, v74, v75
    v_lshlrev_b32 v74, 16, v29
    v_and_b32 v75, s58, v29
    v_lshlrev_b32 v76, 16, v30
    v_and_b32 v77, s58, v30
    v_pk_mul_f32 v[76:77], v[76:77], s[48:49]
    v_cvt_pk_bf16_f32 v30, v76, v77
    v_lshlrev_b32 v76, 16, v30
    v_and_b32 v77, s58, v30
    v_lshlrev_b32 v78, 16, v31
    v_and_b32 v79, s58, v31
    v_pk_mul_f32 v[78:79], v[78:79], s[50:51]
    v_cvt_pk_bf16_f32 v31, v78, v79
    v_lshlrev_b32 v78, 16, v31
    v_and_b32 v79, s58, v31
    s_waitcnt lgkmcnt(0)
    v_lshlrev_b32 v80, 16, v32
    v_lshlrev_b32 v81, 16, v36
    v_lshlrev_b32 v82, 16, v40
    v_lshlrev_b32 v83, 16, v44
    v_pk_add_f32 v[48:49], v[48:49], v[80:81]
    v_cvt_pk_bf16_f32 v16, v48, v49
    v_pk_add_f32 v[50:51], v[50:51], v[82:83]
    v_cvt_pk_bf16_f32 v17, v50, v51
    buffer_store_dwordx2 v[16:17], v14, s[28:31], s53 offen
    s_add_u32 s53, s53, 4096
    v_and_b32 v80, s58, v32
    v_and_b32 v81, s58, v36
    v_and_b32 v82, s58, v40
    v_and_b32 v83, s58, v44
    v_pk_add_f32 v[52:53], v[52:53], v[80:81]
    v_cvt_pk_bf16_f32 v18, v52, v53
    v_pk_add_f32 v[54:55], v[54:55], v[82:83]
    v_cvt_pk_bf16_f32 v19, v54, v55
    buffer_store_dwordx2 v[18:19], v14, s[28:31], s53 offen
    s_add_u32 s53, s53, 4096
    v_lshlrev_b32 v80, 16, v33
    v_lshlrev_b32 v81, 16, v37
    v_lshlrev_b32 v82, 16, v41
    v_lshlrev_b32 v83, 16, v45
    v_pk_add_f32 v[56:57], v[56:57], v[80:81]
    v_cvt_pk_bf16_f32 v20, v56, v57
    v_pk_add_f32 v[58:59], v[58:59], v[82:83]
    v_cvt_pk_bf16_f32 v21, v58, v59
    buffer_store_dwordx2 v[20:21], v14, s[28:31], s53 offen
    s_add_u32 s53, s53, 4096
    v_and_b32 v80, s58, v33
    v_and_b32 v81, s58, v37
    v_and_b32 v82, s58, v41
    v_and_b32 v83, s58, v45
    v_pk_add_f32 v[60:61], v[60:61], v[80:81]
    v_cvt_pk_bf16_f32 v22, v60, v61
    v_pk_add_f32 v[62:63], v[62:63], v[82:83]
    v_cvt_pk_bf16_f32 v23, v62, v63
    buffer_store_dwordx2 v[22:23], v14, s[28:31], s53 offen
    s_add_u32 s53, s53, 4096
    v_lshlrev_b32 v80, 16, v34
    v_lshlrev_b32 v81, 16, v38
    v_lshlrev_b32 v82, 16, v42
    v_lshlrev_b32 v83, 16, v46
    v_pk_add_f32 v[64:65], v[64:65], v[80:81]
    v_cvt_pk_bf16_f32 v24, v64, v65
    v_pk_add_f32 v[66:67], v[66:67], v[82:83]
    v_cvt_pk_bf16_f32 v25, v66, v67
    buffer_store_dwordx2 v[24:25], v14, s[28:31], s53 offen
    s_add_u32 s53, s53, 4096
    v_and_b32 v80, s58, v34
    v_and_b32 v81, s58, v38
    v_and_b32 v82, s58, v42
    v_and_b32 v83, s58, v46
    v_pk_add_f32 v[68:69], v[68:69], v[80:81]
    v_cvt_pk_bf16_f32 v26, v68, v69
    v_pk_add_f32 v[70:71], v[70:71], v[82:83]
    v_cvt_pk_bf16_f32 v27, v70, v71
    buffer_store_dwordx2 v[26:27], v14, s[28:31], s53 offen
    s_add_u32 s53, s53, 4096
    v_lshlrev_b32 v80, 16, v35
    v_lshlrev_b32 v81, 16, v39
    v_lshlrev_b32 v82, 16, v43
    v_lshlrev_b32 v83, 16, v47
    v_pk_add_f32 v[72:73], v[72:73], v[80:81]
    v_cvt_pk_bf16_f32 v28, v72, v73
    v_pk_add_f32 v[74:75], v[74:75], v[82:83]
    v_cvt_pk_bf16_f32 v29, v74, v75
    buffer_store_dwordx2 v[28:29], v14, s[28:31], s53 offen
    s_add_u32 s53, s53, 4096
    v_and_b32 v80, s58, v35
    v_and_b32 v81, s58, v39
    v_and_b32 v82, s58, v43
    v_and_b32 v83, s58, v47
    v_pk_add_f32 v[76:77], v[76:77], v[80:81]
    v_cvt_pk_bf16_f32 v30, v76, v77
    v_pk_add_f32 v[78:79], v[78:79], v[82:83]
    v_cvt_pk_bf16_f32 v31, v78, v79
    buffer_store_dwordx2 v[30:31], v14, s[28:31], s53 offen
    s_add_u32 s53, s53, 4096
    s_barrier
    ds_read_b32 v4, v2
    s_waitcnt lgkmcnt(0)
    v_readfirstlane_b32 s17, v4
    s_barrier
    s_cmp_ge_u32 s17, 32
    s_cbranch_scc1 L_odd
    s_cmp_lt_u32 s16, 8
    s_cbranch_scc1 L_dispatch
L_odd:
    s_cmp_lg_u32 s18, 0
    s_cbranch_scc1 L_sig_1
    v_mov_b32 v3, s22
    v_mov_b32 v4, 65537
    s_mov_b64 exec, 1
    buffer_atomic_add v4, v3, s[12:15], 0 offen sc1
    s_mov_b64 exec, -1
L_sig_1:
    s_mov_b32 s3, 0
L_rdy_2:
    buffer_load_dwordx2 v[6:7], off, s[12:15], s22 sc1
    s_add_u32 s3, s3, 1
    s_cmp_gt_u32 s3, 400000
    s_cbranch_scc1 L_exit
    s_waitcnt vmcnt(0)
    v_readfirstlane_b32 s24, v6
    v_readfirstlane_b32 s25, v7
    s_and_b32 vcc_lo, s24, 0xffff
    s_cmp_lt_u32 vcc_lo, 256
    s_cbranch_scc1 L_rdy_2
    s_lshr_b32 vcc_lo, s24, 16
    s_cbranch_scc1 L_general
L_general:
    s_waitcnt vmcnt(0) lgkmcnt(0)
    s_barrier
    s_mov_b32 s21, 1
    s_mov_b32 s22, 240
    s_mov_b32 s19, 0
    s_lshr_b32 s16, s2, 5
    s_and_b32 s17, s2, 31
    s_add_u32 s4, s4, 0x200000
    s_addc_u32 s5, s5, 0
L_dispatch:
    s_cmp_eq_u32 s16, 4
    s_cbranch_scc1 L_role_K
    s_cmp_eq_u32 s16, 5
    s_cbranch_scc1 L_role_V
    s_cmp_eq_u32 s16, 6
    s_cbranch_scc1 L_role_Q
    s_cmp_eq_u32 s16, 7
    s_cbranch_scc1 L_role_O
    s_cmp_eq_u32 s21, 1
    s_cbranch_scc1 L_role_G
    v_and_b32 v1, 63, v0
    v_lshlrev_b32 v2, 4, v1
    v_lshlrev_b32 v3, 3, v1
    v_lshlrev_b32 v4, 2, v1
    v_mov_b32 v39, 0
    v_mov_b32 v40, 0
    v_mov_b32 v41, 0
    v_mov_b32 v50, -1
    v_bfrev_b32 v54, 1
    v_mov_b32 v51, -1
    v_bfrev_b32 v55, 1
    v_mov_b32 v52, -1
    v_bfrev_b32 v56, 1
    v_mov_b32 v53, -1
    v_bfrev_b32 v57, 1
    v_bfrev_b32 v31, 1
    v_mov_b32 v37, 0
    v_mov_b32 v30, 0
    v_bfe_u32 v32, v1, 1, 1
    v_mul_u32_u24 v32, 0xaaaa, v32
    v_add_u32 v5, 0x4444, v32
    s_lshl_b32 s33, s18, 12
    v_add_u32 v6, s33, v2
    v_and_b32 v34, 15, v1
    v_lshrrev_b32 v35, 4, v1
    s_mul_i32 s33, s18, 2304
    s_add_u32 s33, s33, 4096
    v_mul_u32_u24 v32, 288, v35
    v_lshl_add_u32 v32, v34, 2, v32
    v_add_u32 v7, s33, v32
    v_add_u32 v8, 1152, v7
    v_mul_u32_u24 v32, 144, v34
    v_lshl_add_u32 v9, v35, 5, v32
    s_lshl_b32 s33, s18, 10
    v_add_u32 v10, s33, v2
    v_mov_b32 v32, 0x3e0293ee
    v_cmp_gt_u32 vcc, 8, v34
    s_nop 1
    v_cndmask_b32 v94, 1.0, v32, vcc
    s_mul_i32 s33, s17, 1280
    v_add_u32 v22, s33, v2
    v_cmp_gt_u32 vcc, 8, v34
    s_nop 1
    v_cndmask_b32 v11, v31, v22, vcc
    v_cmp_gt_u32 vcc, 16, v1
    s_nop 1
    v_cndmask_b32 v23, v31, v22, vcc
    v_lshlrev_b32 v32, 5, v34
    v_lshl_add_u32 v32, v35, 4, v32
    s_add_u32 s34, s33, 768
    v_add_u32 v32, s34, v32
    v_cmp_le_u32 vcc, 8, v34
    s_nop 1
    v_cndmask_b32 v32, v31, v32, vcc
    v_cmp_gt_u32 vcc, 2, v35
    s_nop 1
    v_cndmask_b32 v12, v31, v32, vcc
    s_xor_b32 s33, s17, 1
    s_mul_i32 s33, s33, 1280
    v_add_u32 v47, s33, v2
    s_xor_b32 s33, s17, 2
    s_mul_i32 s33, s33, 1280
    v_add_u32 v48, s33, v2
    s_xor_b32 s33, s17, 3
    s_mul_i32 s33, s33, 1280
    v_add_u32 v49, s33, v2
    s_and_b32 s33, s17, 28
    s_mul_i32 s33, s33, 1280
    s_add_u32 s33, s33, 1024
    v_add_u32 v13, s33, v4
    v_lshrrev_b32 v32, 1, v34
    v_lshlrev_b32 v32, 2, v32
    v_and_b32 v36, 1, v34
    v_add_u32 v32, v32, v36
    v_and_b32 v36, 1, v35
    v_lshl_add_u32 v32, v36, 1, v32
    v_lshrrev_b32 v36, 1, v35
    v_lshl_add_u32 v32, v36, 4, v32
    s_lshl_b32 s33, s17, 9
    v_lshl_add_u32 v32, v32, 4, s33
    v_cmp_gt_u32 vcc, 8, v34
    s_nop 1
    v_cndmask_b32 v14, v31, v32, vcc
    v_add_u32 v32, s33, v2
    v_cmp_gt_u32 vcc, 32, v1
    s_nop 1
    v_cndmask_b32 v21, v31, v32, vcc
    v_lshrrev_b32 v32, 2, v1
    v_lshlrev_b32 v32, 5, v32
    v_and_b32 v36, 3, v1
    v_lshl_add_u32 v32, v36, 2, v32
    v_add_u32 v16, s33, v32
    s_lshr_b32 s33, s17, 1
    s_lshl_b32 s33, s33, 14
    s_and_b32 s34, s17, 1
    s_lshl_b32 s34, s34, 12
    s_add_u32 s33, s33, s34
    v_mov_b32 v29, v31
    s_add_u32 s34, s16, 1
    s_and_b32 s34, s34, 3
    s_lshl_b32 s34, s34, 10
    s_add_u32 s34, s34, s33
    v_add_u32 v44, s34, v2
    s_add_u32 s34, s34, 0
    v_writelane_b32 v29, s34, 0
    s_add_u32 s34, s16, 2
    s_and_b32 s34, s34, 3
    s_lshl_b32 s34, s34, 10
    s_add_u32 s34, s34, s33
    v_add_u32 v45, s34, v2
    s_add_u32 s34, s34, 4
    v_writelane_b32 v29, s34, 1
    s_add_u32 s34, s16, 3
    s_and_b32 s34, s34, 3
    s_lshl_b32 s34, s34, 10
    s_add_u32 s34, s34, s33
    v_add_u32 v46, s34, v2
    s_add_u32 s34, s34, 8
    v_writelane_b32 v29, s34, 2
    s_lshl_b32 s34, s16, 10
    s_add_u32 s33, s33, s34
    v_add_u32 v24, s33, v2
    s_mov_b32 s47, s33
    s_and_b32 s34, s18, 1
    s_lshl_b32 s34, s34, 9
    s_add_u32 s33, s33, s34
    v_add_u32 v15, s33, v3
    v_lshrrev_b32 v32, 2, v34
    v_and_b32 v36, 3, v34
    v_lshl_add_u32 v32, v32, 3, v36
    v_lshlrev_b32 v32, 4, v32
    v_lshl_add_u32 v17, v35, 9, v32
    v_lshlrev_b32 v32, 4, v34
    v_lshl_add_u32 v18, v35, 9, v32
    v_lshl_add_u32 v20, v35, 2, v32
    v_lshlrev_b32 v32, 6, v34
    v_lshl_add_u32 v32, v35, 4, v32
    v_subrev_u32 v32, 512, v32
    v_cmp_le_u32 vcc, 8, v34
    s_nop 1
    v_cndmask_b32 v19, v31, v32, vcc
    s_lshl_b32 s33, s16, 3
    s_lshr_b32 s34, s17, 2
    s_add_u32 s33, s33, s34
    s_lshl_b32 s33, s33, 7
    s_and_b32 s34, s17, 3
    s_lshl_b32 s34, s34, 2
    s_add_u32 s33, s33, s34
    s_add_u32 s50, s33, 3735552
    s_add_u32 s51, s33, 3735568
    s_add_u32 s33, s33, 3735584
    v_mov_b32 v32, s33
    v_cmp_eq_u32 vcc, 0, v1
    s_nop 1
    v_cndmask_b32 v42, v31, v32, vcc
    s_lshl_b32 s33, s17, 2
    v_lshl_add_u32 v32, v1, 8, s33
    v_cmp_gt_u32 vcc, 4, v1
    s_nop 1
    v_cndmask_b32 v25, v31, v32, vcc
    s_and_b32 s33, s17, 3
    s_lshl_b32 s33, s33, 8
    v_and_b32 v32, 31, v1
    v_lshl_add_u32 v26, v32, 2, s33
    s_lshr_b32 s33, s17, 2
    s_lshl_b32 s33, s33, 8
    s_add_u32 s33, s33, 4096
    v_and_b32 v32, 3, v1
    v_lshl_add_u32 v28, v32, 2, s33
    s_and_b32 s34, s17, 3
    v_cmp_eq_u32 vcc, s34, v1
    s_nop 1
    v_cndmask_b32 v27, v31, v28, vcc
    s_mov_b32 s40, 0x42200000
    s_mov_b32 s43, 0x80000000
    s_mov_b32 s44, 0x80000001
    s_lshl_b32 s41, s16, 16
    s_lshl_b32 s42, s16, 18
    s_add_u32 s42, s42, 2621440
    s_add_u32 s41, s41, 2097152
    s_lshl_b32 s45, s16, 13
    s_add_u32 s45, s45, 3670016
    s_lshl_b32 s33, s18, 14
    s_add_u32 s27, s41, s33
    s_add_u32 s28, s27, 262144
    s_lshl_b32 s33, s18, 16
    s_add_u32 s29, s42, s33
    s_lshl_b32 s30, s18, 18
    s_add_u32 s30, s30, 134217728
    s_add_u32 s39, s30, 8192
    s_mov_b32 s46, 150732800
    s_mov_b32 s35, 150740992
    buffer_load_dwordx4 v[116:119], v21, s[4:7], s27 offen sc1
    buffer_load_dwordx4 v[120:123], v21, s[4:7], s28 offen sc1
    buffer_load_dwordx4 v[124:127], v22, s[4:7], s29 offen sc1
    buffer_load_dwordx4 v[128:131], v23, s[4:7], s29 offen offset:1024 sc1
    buffer_load_dword v136, v25, s[4:7], s45 offen sc1
    buffer_load_dword v137, v27, s[4:7], s45 offen sc1
    buffer_load_dword v138, v25, s[4:7], s45 offen offset:2048 sc1
    s_load_dwordx2 s[8:9], s[0:1], 8
    v_lshrrev_b32 v36, 2, v34
    v_lshlrev_b32 v36, 1, v36
    v_and_b32 v32, 1, v34
    v_add_u32 v36, v36, v32
    v_lshlrev_b32 v36, 11, v36
    v_lshl_add_u32 v36, v35, 5, v36
    v_bfe_u32 v32, v34, 1, 1
    v_lshl_add_u32 v36, v32, 4, v36
    s_lshl_b32 s33, s17, 6
    s_mov_b32 s10, 16384
    s_mov_b32 s11, 0x20000
    s_waitcnt lgkmcnt(0)
    buffer_load_dwordx4 v[132:135], v36, s[8:11], s33 offen
    s_waitcnt vmcnt(0)
    s_cmp_eq_u32 s18, 0
    s_cselect_b64 vcc, -1, 0
    v_max_i32 v132, s44, v132
    v_cndmask_b32 v132, v31, v132, vcc
    v_max_i32 v133, s44, v133
    v_cndmask_b32 v133, v31, v133, vcc
    v_max_i32 v134, s44, v134
    v_cndmask_b32 v134, v31, v134, vcc
    v_max_i32 v135, s44, v135
    v_cndmask_b32 v135, v31, v135, vcc
    buffer_store_dwordx4 v[132:135], v21, s[4:7], s27 offen
    buffer_store_dwordx4 v[50:53], v21, s[4:7], s28 offen
    buffer_store_dwordx4 v[50:53], v22, s[4:7], s29 offen
    buffer_store_dwordx4 v[50:53], v23, s[4:7], s29 offen offset:1024
    buffer_store_dwordx4 v[50:53], v24, s[4:7], s30 offen sc1
    buffer_store_dwordx4 v[50:53], v24, s[4:7], s39 offen sc1
    buffer_store_dword v37, v29, s[4:7], s35 offen sc1
    buffer_store_dword v37, v25, s[4:7], s45 offen
    buffer_store_dword v37, v27, s[4:7], s45 offen
    buffer_store_dword v37, v25, s[4:7], s45 offen offset:2048
    buffer_store_dword v37, v29, s[4:7], s46 offen sc1
    buffer_store_dword v37, v42, s[4:7], 0 offen sc1
    s_waitcnt vmcnt(0)
    s_barrier
    s_cmp_lg_u32 s18, 0
    s_cbranch_scc1 L_sig_3
    v_mov_b32 v32, s22
    v_mov_b32 v36, 1
    s_mov_b64 exec, 1
    buffer_atomic_add v36, v32, s[12:15], 0 offen sc1
    s_mov_b64 exec, -1
L_sig_3:
    s_load_dwordx2 s[8:9], s[0:1], 16
    s_mov_b32 s10, 8388608
    s_mov_b32 s11, 0x20000
    v_lshrrev_b32 v32, 2, v1
    v_lshlrev_b32 v32, 13, v32
    v_and_b32 v36, 3, v1
    v_lshl_add_u32 v32, v36, 4, v32
    s_lshl_b32 s33, s16, 5
    s_add_u32 s33, s33, s17
    s_lshl_b32 s33, s33, 6
    s_lshl_b32 s34, s18, 21
    s_add_u32 s33, s33, s34
    s_lshl_b32 s34, s18, 14
    s_add_u32 s34, s34, 0
    s_waitcnt lgkmcnt(0)
    s_mov_b32 m0, s34
    s_add_u32 s34, s34, 1024
    buffer_load_dwordx4 v32, s[8:11], s33 offen lds
    s_add_u32 s33, s33, 131072
    s_mov_b32 m0, s34
    s_add_u32 s34, s34, 1024
    buffer_load_dwordx4 v32, s[8:11], s33 offen lds
    s_add_u32 s33, s33, 131072
    s_mov_b32 m0, s34
    s_add_u32 s34, s34, 1024
    buffer_load_dwordx4 v32, s[8:11], s33 offen lds
    s_add_u32 s33, s33, 131072
    s_mov_b32 m0, s34
    s_add_u32 s34, s34, 1024
    buffer_load_dwordx4 v32, s[8:11], s33 offen lds
    s_add_u32 s33, s33, 131072
    s_mov_b32 m0, s34
    s_add_u32 s34, s34, 1024
    buffer_load_dwordx4 v32, s[8:11], s33 offen lds
    s_add_u32 s33, s33, 131072
    s_mov_b32 m0, s34
    s_add_u32 s34, s34, 1024
    buffer_load_dwordx4 v32, s[8:11], s33 offen lds
    s_add_u32 s33, s33, 131072
    s_mov_b32 m0, s34
    s_add_u32 s34, s34, 1024
    buffer_load_dwordx4 v32, s[8:11], s33 offen lds
    s_add_u32 s33, s33, 131072
    s_mov_b32 m0, s34
    s_add_u32 s34, s34, 1024
    buffer_load_dwordx4 v32, s[8:11], s33 offen lds
    s_add_u32 s33, s33, 131072
    s_mov_b32 m0, s34
    s_add_u32 s34, s34, 1024
    buffer_load_dwordx4 v32, s[8:11], s33 offen lds
    s_add_u32 s33, s33, 131072
    s_mov_b32 m0, s34
    s_add_u32 s34, s34, 1024
    buffer_load_dwordx4 v32, s[8:11], s33 offen lds
    s_add_u32 s33, s33, 131072
    s_mov_b32 m0, s34
    s_add_u32 s34, s34, 1024
    buffer_load_dwordx4 v32, s[8:11], s33 offen lds
    s_add_u32 s33, s33, 131072
    s_mov_b32 m0, s34
    s_add_u32 s34, s34, 1024
    buffer_load_dwordx4 v32, s[8:11], s33 offen lds
    s_add_u32 s33, s33, 131072
    s_mov_b32 m0, s34
    s_add_u32 s34, s34, 1024
    buffer_load_dwordx4 v32, s[8:11], s33 offen lds
    s_add_u32 s33, s33, 131072
    s_mov_b32 m0, s34
    s_add_u32 s34, s34, 1024
    buffer_load_dwordx4 v32, s[8:11], s33 offen lds
    s_add_u32 s33, s33, 131072
    s_mov_b32 m0, s34
    s_add_u32 s34, s34, 1024
    buffer_load_dwordx4 v32, s[8:11], s33 offen lds
    s_add_u32 s33, s33, 131072
    s_mov_b32 m0, s34
    s_add_u32 s34, s34, 1024
    buffer_load_dwordx4 v32, s[8:11], s33 offen lds
    s_add_u32 s33, s33, 131072
    s_load_dwordx2 s[8:9], s[0:1], 24
    s_mov_b32 s10, 8388608
    s_mov_b32 s11, 0x20000
    v_lshrrev_b32 v32, 2, v1
    v_lshlrev_b32 v32, 13, v32
    v_and_b32 v36, 3, v1
    v_lshl_add_u32 v32, v36, 4, v32
    s_lshl_b32 s33, s16, 5
    s_add_u32 s33, s33, s17
    s_lshl_b32 s33, s33, 6
    s_lshl_b32 s34, s18, 21
    s_add_u32 s33, s33, s34
    s_lshl_b32 s34, s18, 14
    s_add_u32 s34, s34, 65536
    s_waitcnt lgkmcnt(0)
    s_mov_b32 m0, s34
    s_add_u32 s34, s34, 1024
    buffer_load_dwordx4 v32, s[8:11], s33 offen lds
    s_add_u32 s33, s33, 131072
    s_mov_b32 m0, s34
    s_add_u32 s34, s34, 1024
    buffer_load_dwordx4 v32, s[8:11], s33 offen lds
    s_add_u32 s33, s33, 131072
    s_mov_b32 m0, s34
    s_add_u32 s34, s34, 1024
    buffer_load_dwordx4 v32, s[8:11], s33 offen lds
    s_add_u32 s33, s33, 131072
    s_mov_b32 m0, s34
    s_add_u32 s34, s34, 1024
    buffer_load_dwordx4 v32, s[8:11], s33 offen lds
    s_add_u32 s33, s33, 131072
    s_mov_b32 m0, s34
    s_add_u32 s34, s34, 1024
    buffer_load_dwordx4 v32, s[8:11], s33 offen lds
    s_add_u32 s33, s33, 131072
    s_mov_b32 m0, s34
    s_add_u32 s34, s34, 1024
    buffer_load_dwordx4 v32, s[8:11], s33 offen lds
    s_add_u32 s33, s33, 131072
    s_mov_b32 m0, s34
    s_add_u32 s34, s34, 1024
    buffer_load_dwordx4 v32, s[8:11], s33 offen lds
    s_add_u32 s33, s33, 131072
    s_mov_b32 m0, s34
    s_add_u32 s34, s34, 1024
    buffer_load_dwordx4 v32, s[8:11], s33 offen lds
    s_add_u32 s33, s33, 131072
    s_mov_b32 m0, s34
    s_add_u32 s34, s34, 1024
    buffer_load_dwordx4 v32, s[8:11], s33 offen lds
    s_add_u32 s33, s33, 131072
    s_mov_b32 m0, s34
    s_add_u32 s34, s34, 1024
    buffer_load_dwordx4 v32, s[8:11], s33 offen lds
    s_add_u32 s33, s33, 131072
    s_mov_b32 m0, s34
    s_add_u32 s34, s34, 1024
    buffer_load_dwordx4 v32, s[8:11], s33 offen lds
    s_add_u32 s33, s33, 131072
    s_mov_b32 m0, s34
    s_add_u32 s34, s34, 1024
    buffer_load_dwordx4 v32, s[8:11], s33 offen lds
    s_add_u32 s33, s33, 131072
    s_mov_b32 m0, s34
    s_add_u32 s34, s34, 1024
    buffer_load_dwordx4 v32, s[8:11], s33 offen lds
    s_add_u32 s33, s33, 131072
    s_mov_b32 m0, s34
    s_add_u32 s34, s34, 1024
    buffer_load_dwordx4 v32, s[8:11], s33 offen lds
    s_add_u32 s33, s33, 131072
    s_mov_b32 m0, s34
    s_add_u32 s34, s34, 1024
    buffer_load_dwordx4 v32, s[8:11], s33 offen lds
    s_add_u32 s33, s33, 131072
    s_mov_b32 m0, s34
    s_add_u32 s34, s34, 1024
    buffer_load_dwordx4 v32, s[8:11], s33 offen lds
    s_add_u32 s33, s33, 131072
    v_bfe_u32 v86, v1, 2, 1
    v_bfe_u32 v34, v1, 3, 1
    v_lshl_add_u32 v86, v34, 3, v86
    v_bfe_u32 v34, v1, 4, 1
    v_lshl_add_u32 v86, v34, 2, v86
    v_bfe_u32 v34, v1, 5, 1
    v_lshl_add_u32 v86, v34, 4, v86
    v_lshlrev_b32 v86, 6, v86
    v_and_b32 v34, 3, v1
    v_lshl_add_u32 v86, v34, 3, v86
    v_bfe_u32 v88, v1, 2, 1
    v_bfe_u32 v34, v1, 3, 1
    v_lshl_add_u32 v88, v34, 2, v88
    v_bfe_u32 v34, v1, 4, 1
    v_lshl_add_u32 v88, v34, 4, v88
    v_bfe_u32 v34, v1, 5, 1
    v_lshl_add_u32 v88, v34, 3, v88
    v_lshlrev_b32 v88, 6, v88
    v_and_b32 v34, 3, v1
    v_lshl_add_u32 v88, v34, 3, v88
    s_lshl_b32 s34, s18, 14
    v_add_u32 v86, s34, v86
    v_add_u32 v87, 0x10000, v86
    s_and_b32 s34, s18, 1
    s_lshl_b32 s34, s34, 5
    s_add_u32 s34, s34, 0x10000
    v_add_u32 v88, s34, v88
    s_lshr_b32 s33, s17, 3
    s_or_b32 s33, s33, s16
    s_xor_b32 s34, s18, 3
    s_or_b32 s33, s33, s34
    s_cbranch_scc1 L_cal_4
    s_lshl_b32 s33, s17, 21
    s_add_u32 s33, s33, 136052736
    s_add_u32 s34, s33, 8192
    s_mov_b32 s37, -1
    s_mov_b32 s38, -1
    s_mov_b32 s26, 0
L_cal_4_l:
    s_memtime s[54:55]
    s_waitcnt lgkmcnt(0)
    s_load_dword s35, s[4:5], s33 glc
    s_waitcnt lgkmcnt(0)
    s_memtime s[56:57]
    s_waitcnt lgkmcnt(0)
    s_sub_u32 s35, s56, s54
    s_min_u32 s37, s37, s35
    s_memtime s[54:55]
    s_waitcnt lgkmcnt(0)
    s_load_dword s35, s[4:5], s34 glc
    s_waitcnt lgkmcnt(0)
    s_memtime s[56:57]
    s_waitcnt lgkmcnt(0)
    s_sub_u32 s35, s56, s54
    s_min_u32 s38, s38, s35
    s_add_u32 s26, s26, 1
    s_cmp_lt_u32 s26, 5
    s_cbranch_scc1 L_cal_4_l
    s_cmp_lt_u32 s38, s37
    s_cselect_b32 s33, 1, 0
    s_lshl_b32 s33, s33, s17
    s_add_u32 s33, s33, 0x10000
    s_atomic_add s33, s[12:13], 228
    s_waitcnt lgkmcnt(0)
L_cal_4:
    s_waitcnt vmcnt(16)
    ds_read_b64_tr_b16 a[0:1], v86 offset:0
    ds_read_b64_tr_b16 a[2:3], v86 offset:128
    ds_read_b64_tr_b16 a[4:5], v86 offset:2048
    ds_read_b64_tr_b16 a[6:7], v86 offset:2176
    ds_read_b64_tr_b16 a[8:9], v86 offset:32
    ds_read_b64_tr_b16 a[10:11], v86 offset:160
    ds_read_b64_tr_b16 a[12:13], v86 offset:2080
    ds_read_b64_tr_b16 a[14:15], v86 offset:2208
    s_waitcnt lgkmcnt(0)
    ds_read_b64_tr_b16 a[48:49], v86 offset:4096
    ds_read_b64_tr_b16 a[50:51], v86 offset:4224
    ds_read_b64_tr_b16 a[52:53], v86 offset:6144
    ds_read_b64_tr_b16 a[54:55], v86 offset:6272
    ds_read_b64_tr_b16 a[56:57], v86 offset:4128
    ds_read_b64_tr_b16 a[58:59], v86 offset:4256
    ds_read_b64_tr_b16 a[60:61], v86 offset:6176
    ds_read_b64_tr_b16 a[62:63], v86 offset:6304
    s_waitcnt lgkmcnt(0)
    ds_read_b64_tr_b16 a[96:97], v86 offset:8192
    ds_read_b64_tr_b16 a[98:99], v86 offset:8320
    ds_read_b64_tr_b16 a[100:101], v86 offset:10240
    ds_read_b64_tr_b16 a[102:103], v86 offset:10368
    ds_read_b64_tr_b16 a[104:105], v86 offset:8224
    ds_read_b64_tr_b16 a[106:107], v86 offset:8352
    ds_read_b64_tr_b16 a[108:109], v86 offset:10272
    ds_read_b64_tr_b16 a[110:111], v86 offset:10400
    s_waitcnt lgkmcnt(0)
    ds_read_b64_tr_b16 a[144:145], v86 offset:12288
    ds_read_b64_tr_b16 a[146:147], v86 offset:12416
    ds_read_b64_tr_b16 a[148:149], v86 offset:14336
    ds_read_b64_tr_b16 a[150:151], v86 offset:14464
    ds_read_b64_tr_b16 a[152:153], v86 offset:12320
    ds_read_b64_tr_b16 a[154:155], v86 offset:12448
    ds_read_b64_tr_b16 a[156:157], v86 offset:14368
    ds_read_b64_tr_b16 a[158:159], v86 offset:14496
    s_waitcnt lgkmcnt(0)
    s_load_dwordx2 s[8:9], s[0:1], 32
    s_mov_b32 s10, 8388608
    s_mov_b32 s11, 0x20000
    v_lshrrev_b32 v32, 2, v1
    v_lshlrev_b32 v32, 13, v32
    v_and_b32 v36, 3, v1
    v_lshl_add_u32 v32, v36, 4, v32
    s_lshl_b32 s33, s16, 5
    s_add_u32 s33, s33, s17
    s_lshl_b32 s33, s33, 6
    s_lshl_b32 s34, s18, 21
    s_add_u32 s33, s33, s34
    s_lshl_b32 s34, s18, 14
    s_add_u32 s34, s34, 0
    s_waitcnt lgkmcnt(0)
    s_mov_b32 m0, s34
    s_add_u32 s34, s34, 1024
    buffer_load_dwordx4 v32, s[8:11], s33 offen lds
    s_add_u32 s33, s33, 131072
    s_mov_b32 m0, s34
    s_add_u32 s34, s34, 1024
    buffer_load_dwordx4 v32, s[8:11], s33 offen lds
    s_add_u32 s33, s33, 131072
    s_mov_b32 m0, s34
    s_add_u32 s34, s34, 1024
    buffer_load_dwordx4 v32, s[8:11], s33 offen lds
    s_add_u32 s33, s33, 131072
    s_mov_b32 m0, s34
    s_add_u32 s34, s34, 1024
    buffer_load_dwordx4 v32, s[8:11], s33 offen lds
    s_add_u32 s33, s33, 131072
    s_mov_b32 m0, s34
    s_add_u32 s34, s34, 1024
    buffer_load_dwordx4 v32, s[8:11], s33 offen lds
    s_add_u32 s33, s33, 131072
    s_mov_b32 m0, s34
    s_add_u32 s34, s34, 1024
    buffer_load_dwordx4 v32, s[8:11], s33 offen lds
    s_add_u32 s33, s33, 131072
    s_mov_b32 m0, s34
    s_add_u32 s34, s34, 1024
    buffer_load_dwordx4 v32, s[8:11], s33 offen lds
    s_add_u32 s33, s33, 131072
    s_mov_b32 m0, s34
    s_add_u32 s34, s34, 1024
    buffer_load_dwordx4 v32, s[8:11], s33 offen lds
    s_add_u32 s33, s33, 131072
    s_mov_b32 m0, s34
    s_add_u32 s34, s34, 1024
    buffer_load_dwordx4 v32, s[8:11], s33 offen lds
    s_add_u32 s33, s33, 131072
    s_mov_b32 m0, s34
    s_add_u32 s34, s34, 1024
    buffer_load_dwordx4 v32, s[8:11], s33 offen lds
    s_add_u32 s33, s33, 131072
    s_mov_b32 m0, s34
    s_add_u32 s34, s34, 1024
    buffer_load_dwordx4 v32, s[8:11], s33 offen lds
    s_add_u32 s33, s33, 131072
    s_mov_b32 m0, s34
    s_add_u32 s34, s34, 1024
    buffer_load_dwordx4 v32, s[8:11], s33 offen lds
    s_add_u32 s33, s33, 131072
    s_mov_b32 m0, s34
    s_add_u32 s34, s34, 1024
    buffer_load_dwordx4 v32, s[8:11], s33 offen lds
    s_add_u32 s33, s33, 131072
    s_mov_b32 m0, s34
    s_add_u32 s34, s34, 1024
    buffer_load_dwordx4 v32, s[8:11], s33 offen lds
    s_add_u32 s33, s33, 131072
    s_mov_b32 m0, s34
    s_add_u32 s34, s34, 1024
    buffer_load_dwordx4 v32, s[8:11], s33 offen lds
    s_add_u32 s33, s33, 131072
    s_mov_b32 m0, s34
    s_add_u32 s34, s34, 1024
    buffer_load_dwordx4 v32, s[8:11], s33 offen lds
    s_add_u32 s33, s33, 131072
    s_waitcnt vmcnt(16)
    ds_read_b64_tr_b16 a[16:17], v87 offset:0
    ds_read_b64_tr_b16 a[18:19], v87 offset:128
    ds_read_b64_tr_b16 a[20:21], v87 offset:2048
    ds_read_b64_tr_b16 a[22:23], v87 offset:2176
    ds_read_b64_tr_b16 a[24:25], v87 offset:32
    ds_read_b64_tr_b16 a[26:27], v87 offset:160
    ds_read_b64_tr_b16 a[28:29], v87 offset:2080
    ds_read_b64_tr_b16 a[30:31], v87 offset:2208
    s_waitcnt lgkmcnt(0)
    ds_read_b64_tr_b16 a[64:65], v87 offset:4096
    ds_read_b64_tr_b16 a[66:67], v87 offset:4224
    ds_read_b64_tr_b16 a[68:69], v87 offset:6144
    ds_read_b64_tr_b16 a[70:71], v87 offset:6272
    ds_read_b64_tr_b16 a[72:73], v87 offset:4128
    ds_read_b64_tr_b16 a[74:75], v87 offset:4256
    ds_read_b64_tr_b16 a[76:77], v87 offset:6176
    ds_read_b64_tr_b16 a[78:79], v87 offset:6304
    s_waitcnt lgkmcnt(0)
    ds_read_b64_tr_b16 a[112:113], v87 offset:8192
    ds_read_b64_tr_b16 a[114:115], v87 offset:8320
    ds_read_b64_tr_b16 a[116:117], v87 offset:10240
    ds_read_b64_tr_b16 a[118:119], v87 offset:10368
    ds_read_b64_tr_b16 a[120:121], v87 offset:8224
    ds_read_b64_tr_b16 a[122:123], v87 offset:8352
    ds_read_b64_tr_b16 a[124:125], v87 offset:10272
    ds_read_b64_tr_b16 a[126:127], v87 offset:10400
    s_waitcnt lgkmcnt(0)
    ds_read_b64_tr_b16 a[160:161], v87 offset:12288
    ds_read_b64_tr_b16 a[162:163], v87 offset:12416
    ds_read_b64_tr_b16 a[164:165], v87 offset:14336
    ds_read_b64_tr_b16 a[166:167], v87 offset:14464
    ds_read_b64_tr_b16 a[168:169], v87 offset:12320
    ds_read_b64_tr_b16 a[170:171], v87 offset:12448
    ds_read_b64_tr_b16 a[172:173], v87 offset:14368
    ds_read_b64_tr_b16 a[174:175], v87 offset:14496
    s_waitcnt lgkmcnt(0)
    s_load_dwordx2 s[8:9], s[0:1], 40
    s_mov_b32 s10, 8388608
    s_mov_b32 s11, 0x20000
    v_lshrrev_b32 v32, 2, v1
    v_lshlrev_b32 v32, 11, v32
    v_and_b32 v36, 3, v1
    v_lshl_add_u32 v32, v36, 4, v32
    s_lshl_b32 s33, s16, 21
    s_lshl_b32 s34, s17, 6
    s_add_u32 s33, s33, s34
    s_lshl_b32 s34, s18, 19
    s_add_u32 s33, s33, s34
    s_lshl_b32 s34, s18, 14
    s_add_u32 s34, s34, 65536
    s_waitcnt lgkmcnt(0)
    s_mov_b32 m0, s34
    s_add_u32 s34, s34, 1024
    buffer_load_dwordx4 v32, s[8:11], s33 offen lds
    s_add_u32 s33, s33, 32768
    s_mov_b32 m0, s34
    s_add_u32 s34, s34, 1024
    buffer_load_dwordx4 v32, s[8:11], s33 offen lds
    s_add_u32 s33, s33, 32768
    s_mov_b32 m0, s34
    s_add_u32 s34, s34, 1024
    buffer_load_dwordx4 v32, s[8:11], s33 offen lds
    s_add_u32 s33, s33, 32768
    s_mov_b32 m0, s34
    s_add_u32 s34, s34, 1024
    buffer_load_dwordx4 v32, s[8:11], s33 offen lds
    s_add_u32 s33, s33, 32768
    s_mov_b32 m0, s34
    s_add_u32 s34, s34, 1024
    buffer_load_dwordx4 v32, s[8:11], s33 offen lds
    s_add_u32 s33, s33, 32768
    s_mov_b32 m0, s34
    s_add_u32 s34, s34, 1024
    buffer_load_dwordx4 v32, s[8:11], s33 offen lds
    s_add_u32 s33, s33, 32768
    s_mov_b32 m0, s34
    s_add_u32 s34, s34, 1024
    buffer_load_dwordx4 v32, s[8:11], s33 offen lds
    s_add_u32 s33, s33, 32768
    s_mov_b32 m0, s34
    s_add_u32 s34, s34, 1024
    buffer_load_dwordx4 v32, s[8:11], s33 offen lds
    s_add_u32 s33, s33, 32768
    s_mov_b32 m0, s34
    s_add_u32 s34, s34, 1024
    buffer_load_dwordx4 v32, s[8:11], s33 offen lds
    s_add_u32 s33, s33, 32768
    s_mov_b32 m0, s34
    s_add_u32 s34, s34, 1024
    buffer_load_dwordx4 v32, s[8:11], s33 offen lds
    s_add_u32 s33, s33, 32768
    s_mov_b32 m0, s34
    s_add_u32 s34, s34, 1024
    buffer_load_dwordx4 v32, s[8:11], s33 offen lds
    s_add_u32 s33, s33, 32768
    s_mov_b32 m0, s34
    s_add_u32 s34, s34, 1024
    buffer_load_dwordx4 v32, s[8:11], s33 offen lds
    s_add_u32 s33, s33, 32768
    s_mov_b32 m0, s34
    s_add_u32 s34, s34, 1024
    buffer_load_dwordx4 v32, s[8:11], s33 offen lds
    s_add_u32 s33, s33, 32768
    s_mov_b32 m0, s34
    s_add_u32 s34, s34, 1024
    buffer_load_dwordx4 v32, s[8:11], s33 offen lds
    s_add_u32 s33, s33, 32768
    s_mov_b32 m0, s34
    s_add_u32 s34, s34, 1024
    buffer_load_dwordx4 v32, s[8:11], s33 offen lds
    s_add_u32 s33, s33, 32768
    s_mov_b32 m0, s34
    s_add_u32 s34, s34, 1024
    buffer_load_dwordx4 v32, s[8:11], s33 offen lds
    s_add_u32 s33, s33, 32768
    s_waitcnt vmcnt(16)
    ds_read_b64_tr_b16 a[32:33], v86 offset:0
    ds_read_b64_tr_b16 a[34:35], v86 offset:128
    ds_read_b64_tr_b16 a[36:37], v86 offset:2048
    ds_read_b64_tr_b16 a[38:39], v86 offset:2176
    ds_read_b64_tr_b16 a[40:41], v86 offset:32
    ds_read_b64_tr_b16 a[42:43], v86 offset:160
    ds_read_b64_tr_b16 a[44:45], v86 offset:2080
    ds_read_b64_tr_b16 a[46:47], v86 offset:2208
    s_waitcnt lgkmcnt(0)
    ds_read_b64_tr_b16 a[80:81], v86 offset:4096
    ds_read_b64_tr_b16 a[82:83], v86 offset:4224
    ds_read_b64_tr_b16 a[84:85], v86 offset:6144
    ds_read_b64_tr_b16 a[86:87], v86 offset:6272
    ds_read_b64_tr_b16 a[88:89], v86 offset:4128
    ds_read_b64_tr_b16 a[90:91], v86 offset:4256
    ds_read_b64_tr_b16 a[92:93], v86 offset:6176
    ds_read_b64_tr_b16 a[94:95], v86 offset:6304
    s_waitcnt lgkmcnt(0)
    ds_read_b64_tr_b16 a[128:129], v86 offset:8192
    ds_read_b64_tr_b16 a[130:131], v86 offset:8320
    ds_read_b64_tr_b16 a[132:133], v86 offset:10240
    ds_read_b64_tr_b16 a[134:135], v86 offset:10368
    ds_read_b64_tr_b16 a[136:137], v86 offset:8224
    ds_read_b64_tr_b16 a[138:139], v86 offset:8352
    ds_read_b64_tr_b16 a[140:141], v86 offset:10272
    ds_read_b64_tr_b16 a[142:143], v86 offset:10400
    s_waitcnt lgkmcnt(0)
    ds_read_b64_tr_b16 a[176:177], v86 offset:12288
    ds_read_b64_tr_b16 a[178:179], v86 offset:12416
    ds_read_b64_tr_b16 a[180:181], v86 offset:14336
    ds_read_b64_tr_b16 a[182:183], v86 offset:14464
    ds_read_b64_tr_b16 a[184:185], v86 offset:12320
    ds_read_b64_tr_b16 a[186:187], v86 offset:12448
    ds_read_b64_tr_b16 a[188:189], v86 offset:14368
    ds_read_b64_tr_b16 a[190:191], v86 offset:14496
    s_waitcnt lgkmcnt(0)
    s_waitcnt vmcnt(0)
    s_barrier
    ds_read_b64_tr_b16 a[192:193], v88 offset:0
    ds_read_b64_tr_b16 a[194:195], v88 offset:128
    ds_read_b64_tr_b16 a[196:197], v88 offset:2048
    ds_read_b64_tr_b16 a[198:199], v88 offset:2176
    ds_read_b64_tr_b16 a[200:201], v88 offset:4096
    ds_read_b64_tr_b16 a[202:203], v88 offset:4224
    ds_read_b64_tr_b16 a[204:205], v88 offset:6144
    ds_read_b64_tr_b16 a[206:207], v88 offset:6272
    s_waitcnt lgkmcnt(0)
    ds_read_b64_tr_b16 a[208:209], v88 offset:8192
    ds_read_b64_tr_b16 a[210:211], v88 offset:8320
    ds_read_b64_tr_b16 a[212:213], v88 offset:10240
    ds_read_b64_tr_b16 a[214:215], v88 offset:10368
    ds_read_b64_tr_b16 a[216:217], v88 offset:12288
    ds_read_b64_tr_b16 a[218:219], v88 offset:12416
    ds_read_b64_tr_b16 a[220:221], v88 offset:14336
    ds_read_b64_tr_b16 a[222:223], v88 offset:14464
    s_waitcnt lgkmcnt(0)
    ds_read_b64_tr_b16 a[224:225], v88 offset:16384
    ds_read_b64_tr_b16 a[226:227], v88 offset:16512
    ds_read_b64_tr_b16 a[228:229], v88 offset:18432
    ds_read_b64_tr_b16 a[230:231], v88 offset:18560
    ds_read_b64_tr_b16 a[232:233], v88 offset:20480
    ds_read_b64_tr_b16 a[234:235], v88 offset:20608
    ds_read_b64_tr_b16 a[236:237], v88 offset:22528
    ds_read_b64_tr_b16 a[238:239], v88 offset:22656
    s_waitcnt lgkmcnt(0)
    ds_read_b64_tr_b16 a[240:241], v88 offset:24576
    ds_read_b64_tr_b16 a[242:243], v88 offset:24704
    ds_read_b64_tr_b16 a[244:245], v88 offset:26624
    ds_read_b64_tr_b16 a[246:247], v88 offset:26752
    ds_read_b64_tr_b16 a[248:249], v88 offset:28672
    ds_read_b64_tr_b16 a[250:251], v88 offset:28800
    ds_read_b64_tr_b16 a[252:253], v88 offset:30720
    ds_read_b64_tr_b16 a[254:255], v88 offset:30848
    s_waitcnt lgkmcnt(0)
    ds_read_b64_tr_b16 v[180:181], v88 offset:32768
    ds_read_b64_tr_b16 v[182:183], v88 offset:32896
    ds_read_b64_tr_b16 v[184:185], v88 offset:34816
    ds_read_b64_tr_b16 v[186:187], v88 offset:34944
    ds_read_b64_tr_b16 v[188:189], v88 offset:36864
    ds_read_b64_tr_b16 v[190:191], v88 offset:36992
    ds_read_b64_tr_b16 v[192:193], v88 offset:38912
    ds_read_b64_tr_b16 v[194:195], v88 offset:39040
    s_waitcnt lgkmcnt(0)
    ds_read_b64_tr_b16 v[196:197], v88 offset:40960
    ds_read_b64_tr_b16 v[198:199], v88 offset:41088
    ds_read_b64_tr_b16 v[200:201], v88 offset:43008
    ds_read_b64_tr_b16 v[202:203], v88 offset:43136
    ds_read_b64_tr_b16 v[204:205], v88 offset:45056
    ds_read_b64_tr_b16 v[206:207], v88 offset:45184
    ds_read_b64_tr_b16 v[208:209], v88 offset:47104
    ds_read_b64_tr_b16 v[210:211], v88 offset:47232
    s_waitcnt lgkmcnt(0)
    ds_read_b64_tr_b16 v[212:213], v88 offset:49152
    ds_read_b64_tr_b16 v[214:215], v88 offset:49280
    ds_read_b64_tr_b16 v[216:217], v88 offset:51200
    ds_read_b64_tr_b16 v[218:219], v88 offset:51328
    ds_read_b64_tr_b16 v[220:221], v88 offset:53248
    ds_read_b64_tr_b16 v[222:223], v88 offset:53376
    ds_read_b64_tr_b16 v[224:225], v88 offset:55296
    ds_read_b64_tr_b16 v[226:227], v88 offset:55424
    s_waitcnt lgkmcnt(0)
    ds_read_b64_tr_b16 v[228:229], v88 offset:57344
    ds_read_b64_tr_b16 v[230:231], v88 offset:57472
    ds_read_b64_tr_b16 v[232:233], v88 offset:59392
    ds_read_b64_tr_b16 v[234:235], v88 offset:59520
    ds_read_b64_tr_b16 v[236:237], v88 offset:61440
    ds_read_b64_tr_b16 v[238:239], v88 offset:61568
    ds_read_b64_tr_b16 v[240:241], v88 offset:63488
    ds_read_b64_tr_b16 v[242:243], v88 offset:63616
    s_waitcnt lgkmcnt(0)
    s_barrier
    s_mov_b32 s3, 0
L_rdy_5:
    buffer_load_dwordx2 v[90:91], off, s[12:15], s22 sc1
    s_add_u32 s3, s3, 1
    s_cmp_gt_u32 s3, 400000
    s_cbranch_scc1 L_exit
    s_waitcnt vmcnt(0)
    v_readfirstlane_b32 s24, v90
    v_readfirstlane_b32 s25, v91
    s_and_b32 vcc_lo, s24, 0xffff
    s_cmp_lt_u32 vcc_lo, 256
    s_cbranch_scc1 L_rdy_5
    s_lshr_b32 vcc_lo, s24, 16
    s_cbranch_scc1 L_general
    s_lshr_b32 vcc_lo, s25, 16
    s_cmp_lt_u32 vcc_lo, 8
    s_cbranch_scc1 L_rdy_5
    s_mov_b32 s19, s25
    s_mov_b32 s33, 63
    s_lshr_b32 s34, s33, 3
    s_lshr_b32 s34, s19, s34
    s_and_b32 s34, s34, 1
    s_lshl_b32 s34, s34, 13
    s_lshl_b32 s46, s33, 18
    s_add_u32 s46, s46, s34
    s_add_u32 s46, s46, 134217728
    s_add_u32 s47, s47, s46
    s_add_u32 s48, s47, 4
    s_add_u32 s49, s47, 8
    s_mov_b32 s26, 0
    s_mov_b32 s27, s41
    s_lshl_b32 s33, s16, 5
    s_add_u32 s33, s33, s17
    s_lshl_b32 s31, s33, 11
    s_add_u32 s31, s31, 16777216
    s_lshl_b32 s32, s33, 9
    s_add_u32 s32, s32, 4194304
    s_mov_b32 s36, 0
    s_mov_b32 s64, 0
    s_mov_b32 s65, 0
    s_mov_b32 s66, 0
    s_mov_b32 s67, 0
    s_cmp_eq_u32 s18, 1
    s_cbranch_scc1 L_cf_w1
    s_cmp_eq_u32 s18, 2
    s_cbranch_scc1 L_cf_w2
    s_cmp_eq_u32 s18, 3
    s_cbranch_scc1 L_cf_w3
L_cf_w0:
    v_mov_b32 v213, 0
    v_mov_b32 v215, 0
    v_mov_b32 v217, 0
    s_mov_b32 s52, 0
    s_mov_b32 s53, 0
L_cf_w0_kv0:
    s_min_u32 s33, s52, s53
    s_cmp_gt_u32 s33, s26
    s_cbranch_scc1 L_cf_w0_kv0_ok
    s_load_dword s52, s[4:5], s50 glc
    s_load_dword s53, s[4:5], s51 glc
    s_add_u32 s36, s36, 1
    s_cmp_gt_u32 s36, 400000
    s_cbranch_scc1 L_done
    s_waitcnt lgkmcnt(0)
    s_branch L_cf_w0_kv0
L_cf_w0_kv0_ok:
    s_mov_b32 m0, 0
    s_add_u32 s33, s31, 16775168
    buffer_load_dwordx4 v2, s[4:7], s31 offen sc1 lds
    buffer_load_dwordx4 v2, s[4:7], s31 offen offset:1024 sc1 lds
    buffer_load_dwordx4 v2, s[4:7], s33 offen offset:2048 sc1 lds
    buffer_load_dwordx4 v2, s[4:7], s33 offen offset:3072 sc1 lds
    v_mov_b32 v58, 0
    v_mov_b32 v59, 0
    v_mov_b32 v60, 0
    v_mov_b32 v61, 0
    v_mov_b32 v62, 0
    v_mov_b32 v63, 0
    v_mov_b32 v64, 0
    v_mov_b32 v65, 0
    v_mov_b32 v66, 0
    v_mov_b32 v67, 0
    v_mov_b32 v68, 0
    v_mov_b32 v69, 0
    v_mov_b32 v70, 0
    v_mov_b32 v71, 0
    v_mov_b32 v72, 0
    v_mov_b32 v73, 0
    v_mov_b32 v74, 0
    v_mov_b32 v75, 0
    v_mov_b32 v76, 0
    v_mov_b32 v77, 0
    v_mov_b32 v78, 0
    v_mov_b32 v79, 0
    v_mov_b32 v80, 0
    v_mov_b32 v81, 0
    s_waitcnt vmcnt(0)
    s_barrier
    buffer_load_dwordx4 v[96:99], v6, s[4:7], s27 offen offset:0 sc1
    s_nop 3
    buffer_load_dwordx4 v[100:103], v6, s[4:7], s27 offen offset:1024 sc1
    s_nop 3
    buffer_load_dwordx4 v[104:107], v6, s[4:7], s27 offen offset:2048 sc1
    s_nop 3
    buffer_load_dwordx4 v[108:111], v6, s[4:7], s27 offen offset:3072 sc1
L_cf_w0_loop:
    s_and_b32 s33, s26, 3
    s_add_u32 s28, s27, 262144
    s_lshl_b32 s34, s33, 16
    s_add_u32 s29, s42, s34
    v_add_u32 v30, 1, v30
    ds_read_b128 v[180:183], v17 offset:0
    ds_read_b128 v[184:187], v17 offset:64
    ds_read_b128 v[188:191], v18 offset:2048
    ds_read_b128 v[192:195], v18 offset:2304
    s_waitcnt vmcnt(3)
    v_smfmac_f32_16x16x64_bf16 v[58:61], v[96:99], a[0:7], v5
    v_min3_i32 v36, v96, v97, v98
    v_smfmac_f32_16x16x64_bf16 v[62:65], v[96:99], a[8:15], v5
    v_min_i32 v36, v36, v99
    v_smfmac_f32_16x16x64_bf16 v[66:69], v[96:99], a[16:23], v5
    v_cmp_eq_u32 vcc, s43, v36
    v_smfmac_f32_16x16x64_bf16 v[70:73], v[96:99], a[24:31], v5
    s_cbranch_vccnz L_cf_w0_din0
    s_waitcnt vmcnt(2)
    v_smfmac_f32_16x16x64_bf16 v[58:61], v[100:103], a[48:55], v5
    v_min3_i32 v36, v100, v101, v102
    v_smfmac_f32_16x16x64_bf16 v[62:65], v[100:103], a[56:63], v5
    v_min_i32 v36, v36, v103
    v_smfmac_f32_16x16x64_bf16 v[66:69], v[100:103], a[64:71], v5
    v_cmp_eq_u32 vcc, s43, v36
    v_smfmac_f32_16x16x64_bf16 v[70:73], v[100:103], a[72:79], v5
    s_cbranch_vccnz L_cf_w0_din1
    s_waitcnt vmcnt(1)
    v_smfmac_f32_16x16x64_bf16 v[58:61], v[104:107], a[96:103], v5
    v_min3_i32 v36, v104, v105, v106
    v_smfmac_f32_16x16x64_bf16 v[62:65], v[104:107], a[104:111], v5
    v_min_i32 v36, v36, v107
    v_smfmac_f32_16x16x64_bf16 v[66:69], v[104:107], a[112:119], v5
    v_cmp_eq_u32 vcc, s43, v36
    v_smfmac_f32_16x16x64_bf16 v[70:73], v[104:107], a[120:127], v5
    s_cbranch_vccnz L_cf_w0_din2
    s_waitcnt vmcnt(0)
    v_smfmac_f32_16x16x64_bf16 v[58:61], v[108:111], a[144:151], v5
    v_min3_i32 v36, v108, v109, v110
    v_smfmac_f32_16x16x64_bf16 v[62:65], v[108:111], a[152:159], v5
    v_min_i32 v36, v36, v111
    v_smfmac_f32_16x16x64_bf16 v[66:69], v[108:111], a[160:167], v5
    v_cmp_eq_u32 vcc, s43, v36
    v_smfmac_f32_16x16x64_bf16 v[70:73], v[108:111], a[168:175], v5
    s_cbranch_vccnz L_cf_w0_din3
L_cf_w0_ddone:
    s_nop 0
    v_pk_add_f32 v[86:87], v[58:59], v[60:61]
    ds_write2_b32 v7, v86, v87 offset0:0 offset1:36
    v_pk_add_f32 v[88:89], v[62:63], v[64:65]
    ds_write2_b32 v7, v88, v89 offset0:16 offset1:52
    v_pk_add_f32 v[90:91], v[66:67], v[68:69]
    ds_write2_b32 v8, v90, v91 offset0:0 offset1:36
    v_pk_add_f32 v[92:93], v[70:71], v[72:73]
    ds_write2_b32 v8, v92, v93 offset0:16 offset1:52
    v_smfmac_f32_16x16x64_bf16 v[74:77], v[96:99], a[32:39], v5
    v_smfmac_f32_16x16x64_bf16 v[78:81], v[96:99], a[40:47], v5
    v_smfmac_f32_16x16x64_bf16 v[74:77], v[100:103], a[80:87], v5
    v_smfmac_f32_16x16x64_bf16 v[78:81], v[100:103], a[88:95], v5
    s_waitcnt lgkmcnt(0)
    s_barrier
    ds_read_b128 v[116:119], v9 offset:4096
    ds_read_b128 v[120:123], v9 offset:4112
    ds_read_b128 v[124:127], v9 offset:6400
    ds_read_b128 v[128:131], v9 offset:6416
    ds_read_b128 v[132:135], v9 offset:8704
    ds_read_b128 v[136:139], v9 offset:8720
    ds_read_b128 v[140:143], v9 offset:11008
    ds_read_b128 v[144:147], v9 offset:11024
    v_smfmac_f32_16x16x64_bf16 v[74:77], v[104:107], a[128:135], v5
    s_waitcnt lgkmcnt(6)
    v_pk_mul_f32 v[116:117], v[116:117], v[94:95] op_sel_hi:[1,0]
    v_pk_mul_f32 v[118:119], v[118:119], v[94:95] op_sel_hi:[1,0]
    v_pk_mul_f32 v[120:121], v[120:121], v[94:95] op_sel_hi:[1,0]
    v_pk_mul_f32 v[122:123], v[122:123], v[94:95] op_sel_hi:[1,0]
    s_waitcnt lgkmcnt(4)
    v_pk_fma_f32 v[116:117], v[124:125], v[94:95], v[116:117] op_sel_hi:[1,0,1]
    v_pk_fma_f32 v[118:119], v[126:127], v[94:95], v[118:119] op_sel_hi:[1,0,1]
    v_pk_fma_f32 v[120:121], v[128:129], v[94:95], v[120:121] op_sel_hi:[1,0,1]
    v_pk_fma_f32 v[122:123], v[130:131], v[94:95], v[122:123] op_sel_hi:[1,0,1]
    s_waitcnt lgkmcnt(2)
    v_pk_fma_f32 v[116:117], v[132:133], v[94:95], v[116:117] op_sel_hi:[1,0,1]
    v_pk_fma_f32 v[118:119], v[134:135], v[94:95], v[118:119] op_sel_hi:[1,0,1]
    v_pk_fma_f32 v[120:121], v[136:137], v[94:95], v[120:121] op_sel_hi:[1,0,1]
    v_pk_fma_f32 v[122:123], v[138:139], v[94:95], v[122:123] op_sel_hi:[1,0,1]
    s_waitcnt lgkmcnt(0)
    v_pk_fma_f32 v[116:117], v[140:141], v[94:95], v[116:117] op_sel_hi:[1,0,1]
    v_pk_fma_f32 v[118:119], v[142:143], v[94:95], v[118:119] op_sel_hi:[1,0,1]
    v_pk_fma_f32 v[120:121], v[144:145], v[94:95], v[120:121] op_sel_hi:[1,0,1]
    v_pk_fma_f32 v[122:123], v[146:147], v[94:95], v[122:123] op_sel_hi:[1,0,1]
    v_cvt_pk_bf16_f32 v196, v116, v117
    v_cvt_pk_bf16_f32 v197, v118, v119
    v_cvt_pk_bf16_f32 v198, v120, v121
    v_cvt_pk_bf16_f32 v199, v122, v123
    s_nop 1
    v_mfma_f32_16x16x32_bf16 v[200:203], v[180:183], v[196:199], 0
    v_mfma_f32_16x16x32_bf16 v[204:207], v[184:187], v[196:199], 0
    v_mfma_f32_16x16x32_bf16 v[208:211], v[196:199], v[196:199], 0
    s_nop 5
    buffer_store_dwordx4 v[200:203], v11, s[4:7], s29 offen
    buffer_store_dwordx4 v[204:207], v11, s[4:7], s29 offen offset:128
    buffer_store_dwordx4 v[208:211], v12, s[4:7], s29 offen
    v_smfmac_f32_16x16x64_bf16 v[78:81], v[104:107], a[136:143], v5
    v_smfmac_f32_16x16x64_bf16 v[74:77], v[108:111], a[176:183], v5
    v_smfmac_f32_16x16x64_bf16 v[78:81], v[108:111], a[184:191], v5
    s_barrier
    buffer_load_dwordx4 v[116:119], v47, s[4:7], s29 offen sc1
    buffer_load_dwordx4 v[120:123], v48, s[4:7], s29 offen sc1
    buffer_load_dwordx4 v[124:127], v49, s[4:7], s29 offen sc1
    buffer_load_dword v128, v13, s[4:7], s29 offen offset:0 sc1
    buffer_load_dword v129, v13, s[4:7], s29 offen offset:1280 sc1
    buffer_load_dword v130, v13, s[4:7], s29 offen offset:2560 sc1
    buffer_load_dword v131, v13, s[4:7], s29 offen offset:3840 sc1
    ds_read_b128 v[132:135], v2 offset:15360
    ds_read_b128 v[136:139], v2 offset:16384
    ds_read_b128 v[140:143], v2 offset:17408
    v_pk_add_f32 v[86:87], v[74:75], v[76:77]
    v_pk_add_f32 v[88:89], v[78:79], v[80:81]
    v_mov_b32_dpp v200, v204 row_ror:8 row_mask:0xf bank_mask:0xc
    v_mov_b32_dpp v201, v205 row_ror:8 row_mask:0xf bank_mask:0xc
    v_mov_b32_dpp v202, v206 row_ror:8 row_mask:0xf bank_mask:0xc
    v_mov_b32_dpp v203, v207 row_ror:8 row_mask:0xf bank_mask:0xc
    s_waitcnt lgkmcnt(2)
    v_pk_add_f32 v[86:87], v[86:87], v[132:133]
    v_pk_add_f32 v[88:89], v[88:89], v[134:135]
    s_waitcnt lgkmcnt(1)
    v_pk_add_f32 v[86:87], v[86:87], v[136:137]
    v_pk_add_f32 v[88:89], v[88:89], v[138:139]
    s_waitcnt lgkmcnt(0)
    v_pk_add_f32 v[86:87], v[86:87], v[140:141]
    v_pk_add_f32 v[88:89], v[88:89], v[142:143]
    v_cvt_pk_bf16_f32 v214, v86, v87
    v_cvt_pk_bf16_f32 v216, v88, v89
    s_cmp_eq_u32 s26, 63
    s_cbranch_scc1 L_cf_w0_done
L_cf_w0_atry:
    s_waitcnt vmcnt(6)
    v_pk_add_f32 v[238:239], v[200:201], v[116:117]
    v_pk_add_f32 v[240:241], v[202:203], v[118:119]
    s_waitcnt vmcnt(5)
    v_pk_add_f32 v[238:239], v[238:239], v[120:121]
    v_pk_add_f32 v[240:241], v[240:241], v[122:123]
    s_waitcnt vmcnt(4)
    v_pk_add_f32 v[238:239], v[238:239], v[124:125]
    v_pk_add_f32 v[240:241], v[240:241], v[126:127]
    v_maximum3_f32 v36, |v238|, |v239|, |v240|
    s_waitcnt vmcnt(0)
    buffer_store_dword v30, v25, s[4:7], s45 offen offset:0
    v_pk_add_f32 v[242:243], v[128:129], v[130:131]
    v_add_f32 v242, v242, v243
    v_maximum3_f32 v36, v36, |v241|, |v242|
    v_cmp_ngt_f32 vcc, s40, v36
    v_exp_f32 v222, v238
    v_exp_f32 v223, v239
    v_exp_f32 v224, v240
    v_exp_f32 v225, v241
    v_exp_f32 v144, v242
    s_cbranch_vccnz L_cf_w0_abad
L_cf_w0_agood:
    v_cvt_pk_bf16_f32 v218, v222, v223
    v_cvt_pk_bf16_f32 v219, v224, v225
    v_mov_b32_dpp v146, v144 row_ror:8 row_mask:0xf bank_mask:0xf
    v_mov_b32_dpp v220, v218 row_ror:8 row_mask:0xf bank_mask:0xf
    v_mov_b32_dpp v221, v219 row_ror:8 row_mask:0xf bank_mask:0xf
    v_cvt_pk_bf16_f32 v212, v144, v146
    v_pk_add_f32 v[222:223], v[222:223], v[224:225]
    v_mfma_f32_16x16x32_bf16 v[226:229], v[188:191], v[218:221], 0
    v_add_f32 v145, v222, v223
    v_add_f32 v145, v145, v144
    v_mfma_f32_16x16x32_bf16 v[230:233], v[192:195], v[218:221], 0
    s_nop 0
    v_add_f32_dpp v146, v145, v145 row_ror:8 row_mask:0xf bank_mask:0xf
    v_add_f32_dpp v147, v145, v145 row_ror:8 row_mask:0xf bank_mask:0xf
    v_mfma_f32_16x16x16_bf16 v[226:229], v[214:215], v[212:213], v[226:229]
    s_nop 0
    v_permlane16_swap_b32 v146, v147
    v_mfma_f32_16x16x16_bf16 v[230:233], v[216:217], v[212:213], v[230:233]
    v_add_f32 v145, v146, v147
    v_add_f32 v146, v146, v147
    s_nop 1
    v_permlane32_swap_b32 v145, v146
    s_nop 0
    v_add_f32 v145, v145, v146
    v_rcp_f32 v222, v145
    s_mov_b32 m0, 20480
    v_pk_mul_f32 v[226:227], v[226:227], v[222:223] op_sel_hi:[1,0]
    v_pk_mul_f32 v[228:229], v[228:229], v[222:223] op_sel_hi:[1,0]
    v_pk_mul_f32 v[230:231], v[230:231], v[222:223] op_sel_hi:[1,0]
    v_pk_mul_f32 v[232:233], v[232:233], v[222:223] op_sel_hi:[1,0]
    v_cvt_pk_bf16_f32 v234, v226, v227
    v_cvt_pk_bf16_f32 v235, v228, v229
    v_cvt_pk_bf16_f32 v236, v230, v231
    v_cvt_pk_bf16_f32 v237, v232, v233
    buffer_store_dwordx4 v[234:237], v14, s[4:7], s28 offen
    s_barrier
    buffer_load_dwordx4 v6, s[4:7], s28 offen offset:0 sc1 lds
    s_nop 3
    buffer_load_dwordx4 v6, s[4:7], s28 offen offset:1024 sc1 lds
    s_nop 3
    buffer_load_dwordx4 v6, s[4:7], s28 offen offset:2048 sc1 lds
    s_nop 3
    buffer_load_dwordx4 v6, s[4:7], s28 offen offset:3072 sc1 lds
    s_add_u32 s26, s26, 1
    s_and_b32 s35, s26, 3
    s_lshl_b32 s35, s35, 14
    s_add_u32 s27, s41, s35
    v_mov_b32 v58, 0
    v_mov_b32 v59, 0
    v_mov_b32 v60, 0
    v_mov_b32 v61, 0
    v_mov_b32 v62, 0
    v_mov_b32 v63, 0
    v_mov_b32 v64, 0
    v_mov_b32 v65, 0
    v_mov_b32 v66, 0
    v_mov_b32 v67, 0
    v_mov_b32 v68, 0
    v_mov_b32 v69, 0
    v_mov_b32 v70, 0
    v_mov_b32 v71, 0
    v_mov_b32 v72, 0
    v_mov_b32 v73, 0
    v_mov_b32 v74, 0
    v_mov_b32 v75, 0
    v_mov_b32 v76, 0
    v_mov_b32 v77, 0
    v_mov_b32 v78, 0
    v_mov_b32 v79, 0
    v_mov_b32 v80, 0
    v_mov_b32 v81, 0
    s_add_u32 s31, s31, 0x40000
    v_subrev_u32 v43, 1, v30
    s_min_u32 s33, s52, s53
    s_add_u32 s34, s26, 2
    s_min_u32 s34, s34, 63
    s_cmp_gt_u32 s33, s34
    s_cbranch_scc1 L_cf_w0_kvfresh
    s_load_dword s52, s[4:5], s50 glc
    s_load_dword s53, s[4:5], s51 glc
L_cf_w0_kvfresh:
    s_waitcnt vmcnt(3)
    s_barrier
    s_waitcnt vmcnt(2)
    s_barrier
    buffer_store_dword v30, v29, s[4:7], s46 offen sc1
    s_waitcnt vmcnt(2)
    s_barrier
    s_waitcnt vmcnt(1)
    s_barrier
L_cf_w0_kv:
    s_min_u32 s33, s52, s53
    s_cmp_gt_u32 s33, s26
    s_cbranch_scc1 L_cf_w0_kv_ok
    s_load_dword s52, s[4:5], s50 glc
    s_load_dword s53, s[4:5], s51 glc
    s_add_u32 s36, s36, 1
    s_cmp_gt_u32 s36, 400000
    s_cbranch_scc1 L_done
    s_waitcnt lgkmcnt(0)
    s_branch L_cf_w0_kv
L_cf_w0_kv_ok:
    s_mov_b32 m0, 0
    s_add_u32 s33, s31, 16775168
    buffer_load_dwordx4 v2, s[4:7], s31 offen sc1 lds
    buffer_load_dwordx4 v2, s[4:7], s31 offen offset:1024 sc1 lds
    buffer_load_dwordx4 v2, s[4:7], s33 offen offset:2048 sc1 lds
    buffer_load_dwordx4 v2, s[4:7], s33 offen offset:3072 sc1 lds
    s_add_u32 s33, s32, 4194304
    buffer_store_dwordx4 v[196:199], v19, s[4:7], s32 offen sc1
    buffer_store_dword v214, v20, s[4:7], s33 offen sc1
    buffer_store_dword v216, v20, s[4:7], s33 offen offset:256 sc1
    buffer_store_dword v43, v42, s[4:7], 0 offen sc1
    s_add_u32 s32, s32, 0x10000
L_cf_w0_bjoin:
    s_barrier
    ds_read_b32 v32, v37 offset:19456
    s_waitcnt lgkmcnt(0)
    v_cmp_ne_u32 vcc, 0, v32
    s_cbranch_vccnz L_cf_w0_bretry
    s_waitcnt vmcnt(0)
    s_barrier
    buffer_load_dwordx4 v[96:99], v6, s[4:7], s27 offen offset:0 sc1
    s_nop 3
    buffer_load_dwordx4 v[100:103], v6, s[4:7], s27 offen offset:1024 sc1
    s_nop 3
    buffer_load_dwordx4 v[104:107], v6, s[4:7], s27 offen offset:2048 sc1
    s_nop 3
    buffer_load_dwordx4 v[108:111], v6, s[4:7], s27 offen offset:3072 sc1
    s_branch L_cf_w0_loop
L_cf_w0_din0:
    s_mov_b64 s[56:57], -1
    s_mov_b64 s[58:59], -1
    s_mov_b64 s[60:61], -1
    s_branch L_cf_w0_dre0
L_cf_w0_din1:
    buffer_load_dword v38, v31, s[4:7], 0 offen
    s_mov_b64 s[54:55], 0
    s_mov_b64 s[58:59], -1
    s_mov_b64 s[60:61], -1
    s_branch L_cf_w0_dre1
L_cf_w0_din2:
    buffer_load_dword v38, v31, s[4:7], 0 offen
    buffer_load_dword v38, v31, s[4:7], 0 offen
    s_mov_b64 s[54:55], 0
    s_mov_b64 s[56:57], 0
    s_mov_b64 s[60:61], -1
    s_branch L_cf_w0_dre2
L_cf_w0_din3:
    buffer_load_dword v38, v31, s[4:7], 0 offen
    buffer_load_dword v38, v31, s[4:7], 0 offen
    buffer_load_dword v38, v31, s[4:7], 0 offen
    s_mov_b64 s[54:55], 0
    s_mov_b64 s[56:57], 0
    s_mov_b64 s[58:59], 0
    s_branch L_cf_w0_dre3
L_cf_w0_dloop:
    s_cmp_eq_u64 s[54:55], 0
    s_cbranch_scc1 L_cf_w0_dsk0
    s_waitcnt vmcnt(3)
    v_cndmask_b32 v112, 0, v96, s[54:55]
    v_cndmask_b32 v113, 0, v97, s[54:55]
    v_cndmask_b32 v114, 0, v98, s[54:55]
    v_cndmask_b32 v115, 0, v99, s[54:55]
    s_or_b64 s[62:63], s[56:57], s[58:59]
    s_or_b64 s[62:63], s[62:63], s[60:61]
    v_smfmac_f32_16x16x64_bf16 v[58:61], v[112:115], a[0:7], v5
    v_min3_i32 v36, v112, v113, v114
    v_smfmac_f32_16x16x64_bf16 v[62:65], v[112:115], a[8:15], v5
    v_min_i32 v36, v36, v115
    v_smfmac_f32_16x16x64_bf16 v[66:69], v[112:115], a[16:23], v5
    v_cmp_eq_u32 vcc, s43, v36
    v_smfmac_f32_16x16x64_bf16 v[70:73], v[112:115], a[24:31], v5
    s_or_b64 s[62:63], s[62:63], vcc
    s_cbranch_scc0 L_cf_w0_ddone
    s_cbranch_vccz L_cf_w0_dok0
L_cf_w0_dre0:
    s_mov_b64 exec, vcc
    buffer_load_dwordx4 v[96:99], v6, s[4:7], s27 offen offset:0 sc1
    s_mov_b64 exec, -1
    s_mov_b64 s[54:55], vcc
    s_branch L_cf_w0_dnx0
L_cf_w0_dok0:
    s_mov_b64 s[54:55], 0
L_cf_w0_dsk0:
    buffer_load_dword v38, v31, s[4:7], 0 offen
L_cf_w0_dnx0:
    s_cmp_eq_u64 s[56:57], 0
    s_cbranch_scc1 L_cf_w0_dsk1
    s_waitcnt vmcnt(3)
    v_cndmask_b32 v112, 0, v100, s[56:57]
    v_cndmask_b32 v113, 0, v101, s[56:57]
    v_cndmask_b32 v114, 0, v102, s[56:57]
    v_cndmask_b32 v115, 0, v103, s[56:57]
    s_or_b64 s[62:63], s[54:55], s[58:59]
    s_or_b64 s[62:63], s[62:63], s[60:61]
    v_smfmac_f32_16x16x64_bf16 v[58:61], v[112:115], a[48:55], v5
    v_min3_i32 v36, v112, v113, v114
    v_smfmac_f32_16x16x64_bf16 v[62:65], v[112:115], a[56:63], v5
    v_min_i32 v36, v36, v115
    v_smfmac_f32_16x16x64_bf16 v[66:69], v[112:115], a[64:71], v5
    v_cmp_eq_u32 vcc, s43, v36
    v_smfmac_f32_16x16x64_bf16 v[70:73], v[112:115], a[72:79], v5
    s_or_b64 s[62:63], s[62:63], vcc
    s_cbranch_scc0 L_cf_w0_ddone
    s_cbranch_vccz L_cf_w0_dok1
L_cf_w0_dre1:
    s_mov_b64 exec, vcc
    buffer_load_dwordx4 v[100:103], v6, s[4:7], s27 offen offset:1024 sc1
    s_mov_b64 exec, -1
    s_mov_b64 s[56:57], vcc
    s_branch L_cf_w0_dnx1
L_cf_w0_dok1:
    s_mov_b64 s[56:57], 0
L_cf_w0_dsk1:
    buffer_load_dword v38, v31, s[4:7], 0 offen
L_cf_w0_dnx1:
    s_cmp_eq_u64 s[58:59], 0
    s_cbranch_scc1 L_cf_w0_dsk2
    s_waitcnt vmcnt(3)
    v_cndmask_b32 v112, 0, v104, s[58:59]
    v_cndmask_b32 v113, 0, v105, s[58:59]
    v_cndmask_b32 v114, 0, v106, s[58:59]
    v_cndmask_b32 v115, 0, v107, s[58:59]
    s_or_b64 s[62:63], s[54:55], s[56:57]
    s_or_b64 s[62:63], s[62:63], s[60:61]
    v_smfmac_f32_16x16x64_bf16 v[58:61], v[112:115], a[96:103], v5
    v_min3_i32 v36, v112, v113, v114
    v_smfmac_f32_16x16x64_bf16 v[62:65], v[112:115], a[104:111], v5
    v_min_i32 v36, v36, v115
    v_smfmac_f32_16x16x64_bf16 v[66:69], v[112:115], a[112:119], v5
    v_cmp_eq_u32 vcc, s43, v36
    v_smfmac_f32_16x16x64_bf16 v[70:73], v[112:115], a[120:127], v5
    s_or_b64 s[62:63], s[62:63], vcc
    s_cbranch_scc0 L_cf_w0_ddone
    s_cbranch_vccz L_cf_w0_dok2
L_cf_w0_dre2:
    s_mov_b64 exec, vcc
    buffer_load_dwordx4 v[104:107], v6, s[4:7], s27 offen offset:2048 sc1
    s_mov_b64 exec, -1
    s_mov_b64 s[58:59], vcc
    s_branch L_cf_w0_dnx2
L_cf_w0_dok2:
    s_mov_b64 s[58:59], 0
L_cf_w0_dsk2:
    buffer_load_dword v38, v31, s[4:7], 0 offen
L_cf_w0_dnx2:
    s_cmp_eq_u64 s[60:61], 0
    s_cbranch_scc1 L_cf_w0_dsk3
    s_waitcnt vmcnt(3)
    v_cndmask_b32 v112, 0, v108, s[60:61]
    v_cndmask_b32 v113, 0, v109, s[60:61]
    v_cndmask_b32 v114, 0, v110, s[60:61]
    v_cndmask_b32 v115, 0, v111, s[60:61]
    s_or_b64 s[62:63], s[54:55], s[56:57]
    s_or_b64 s[62:63], s[62:63], s[58:59]
    v_smfmac_f32_16x16x64_bf16 v[58:61], v[112:115], a[144:151], v5
    v_min3_i32 v36, v112, v113, v114
    v_smfmac_f32_16x16x64_bf16 v[62:65], v[112:115], a[152:159], v5
    v_min_i32 v36, v36, v115
    v_smfmac_f32_16x16x64_bf16 v[66:69], v[112:115], a[160:167], v5
    v_cmp_eq_u32 vcc, s43, v36
    v_smfmac_f32_16x16x64_bf16 v[70:73], v[112:115], a[168:175], v5
    s_or_b64 s[62:63], s[62:63], vcc
    s_cbranch_scc0 L_cf_w0_ddone
    s_cbranch_vccz L_cf_w0_dok3
L_cf_w0_dre3:
    s_mov_b64 exec, vcc
    buffer_load_dwordx4 v[108:111], v6, s[4:7], s27 offen offset:3072 sc1
    s_mov_b64 exec, -1
    s_mov_b64 s[60:61], vcc
    s_branch L_cf_w0_dnx3
L_cf_w0_dok3:
    s_mov_b64 s[60:61], 0
L_cf_w0_dsk3:
    buffer_load_dword v38, v31, s[4:7], 0 offen
L_cf_w0_dnx3:
    s_add_u32 s36, s36, 1
    s_cmp_lt_u32 s36, 400000
    s_cbranch_scc1 L_cf_w0_dloop
    s_branch L_done
L_cf_w0_bretry:
    s_add_u32 s36, s36, 1
    s_cmp_gt_u32 s36, 400000
    s_cbranch_scc1 L_done
    s_mov_b32 m0, 20480
    s_nop 0
    buffer_load_dwordx4 v6, s[4:7], s28 offen offset:0 sc1 lds
    s_nop 3
    buffer_load_dwordx4 v6, s[4:7], s28 offen offset:1024 sc1 lds
    s_nop 3
    buffer_load_dwordx4 v6, s[4:7], s28 offen offset:2048 sc1 lds
    s_nop 3
    buffer_load_dwordx4 v6, s[4:7], s28 offen offset:3072 sc1 lds
    s_waitcnt vmcnt(3)
    s_barrier
    s_waitcnt vmcnt(2)
    s_barrier
    s_waitcnt vmcnt(1)
    s_barrier
    s_waitcnt vmcnt(0)
    s_barrier
    s_branch L_cf_w0_bjoin
L_cf_w0_abad:
    v_max3_u32 v36, v128, v129, v130
    v_max_u32 v36, v36, v131
    v_max3_u32 v36, v36, v116, v117
    v_max3_u32 v36, v36, v118, v119
    v_max3_u32 v36, v36, v120, v121
    v_max3_u32 v36, v36, v122, v123
    v_max3_u32 v36, v36, v124, v125
    v_max3_u32 v36, v36, v126, v127
    v_cmp_eq_u32 vcc, -1, v36
    buffer_load_dwordx4 v[116:119], v47, s[4:7], s29 offen sc1
    buffer_load_dwordx4 v[120:123], v48, s[4:7], s29 offen sc1
    buffer_load_dwordx4 v[124:127], v49, s[4:7], s29 offen sc1
    buffer_load_dword v128, v13, s[4:7], s29 offen offset:0 sc1
    buffer_load_dword v129, v13, s[4:7], s29 offen offset:1280 sc1
    buffer_load_dword v130, v13, s[4:7], s29 offen offset:2560 sc1
    buffer_load_dword v131, v13, s[4:7], s29 offen offset:3840 sc1
    s_add_u32 s36, s36, 1
    s_cmp_gt_u32 s36, 400000
    s_cbranch_scc1 L_done
    s_cbranch_vccnz L_cf_w0_atry
    v_max3_f32 v36, v238, v239, v240
    v_max3_f32 v36, v36, v241, v242
    s_nop 1
    v_max_f32_dpp v146, v36, v36 row_ror:8 row_mask:0xf bank_mask:0xf
    v_max_f32_dpp v147, v36, v36 row_ror:8 row_mask:0xf bank_mask:0xf
    s_nop 1
    v_permlane16_swap_b32 v146, v147
    s_nop 1
    v_max_f32 v36, v146, v147
    v_max_f32 v146, v146, v147
    s_nop 1
    v_permlane32_swap_b32 v36, v146
    s_nop 1
    v_max_f32 v36, v36, v146
    v_sub_f32 v238, v238, v36
    v_sub_f32 v239, v239, v36
    v_sub_f32 v240, v240, v36
    v_sub_f32 v241, v241, v36
    v_sub_f32 v242, v242, v36
    v_exp_f32 v222, v238
    v_exp_f32 v223, v239
    v_exp_f32 v224, v240
    v_exp_f32 v225, v241
    v_exp_f32 v144, v242
    s_branch L_cf_w0_agood
L_cf_w0_done:
    s_add_u32 s33, s32, 4194304
    buffer_store_dwordx4 v[196:199], v19, s[4:7], s32 offen sc1
    buffer_store_dword v214, v20, s[4:7], s33 offen sc1
    buffer_store_dword v216, v20, s[4:7], s33 offen offset:256 sc1
    s_waitcnt vmcnt(0)
    buffer_store_dword v30, v42, s[4:7], 0 offen sc1
    s_branch L_done
L_cf_w1:
    v_mov_b32 v58, 0
    v_mov_b32 v59, 0
    v_mov_b32 v60, 0
    v_mov_b32 v61, 0
    v_mov_b32 v62, 0
    v_mov_b32 v63, 0
    v_mov_b32 v64, 0
    v_mov_b32 v65, 0
    v_mov_b32 v66, 0
    v_mov_b32 v67, 0
    v_mov_b32 v68, 0
    v_mov_b32 v69, 0
    v_mov_b32 v70, 0
    v_mov_b32 v71, 0
    v_mov_b32 v72, 0
    v_mov_b32 v73, 0
    v_mov_b32 v74, 0
    v_mov_b32 v75, 0
    v_mov_b32 v76, 0
    v_mov_b32 v77, 0
    v_mov_b32 v78, 0
    v_mov_b32 v79, 0
    v_mov_b32 v80, 0
    v_mov_b32 v81, 0
    s_waitcnt vmcnt(0)
    s_barrier
    buffer_load_dwordx4 v[100:103], v6, s[4:7], s27 offen offset:1024 sc1
    s_nop 3
    buffer_load_dwordx4 v[96:99], v6, s[4:7], s27 offen offset:0 sc1
    s_nop 3
    buffer_load_dwordx4 v[108:111], v6, s[4:7], s27 offen offset:3072 sc1
    s_nop 3
    buffer_load_dwordx4 v[104:107], v6, s[4:7], s27 offen offset:2048 sc1
L_cf_w1_loop:
    s_and_b32 s33, s26, 3
    s_add_u32 s28, s27, 262144
    s_lshl_b32 s34, s33, 16
    s_add_u32 s29, s42, s34
    v_add_u32 v30, 1, v30
    s_waitcnt vmcnt(3)
    v_smfmac_f32_16x16x64_bf16 v[58:61], v[100:103], a[48:55], v5
    v_min3_i32 v36, v100, v101, v102
    v_smfmac_f32_16x16x64_bf16 v[62:65], v[100:103], a[56:63], v5
    v_min_i32 v36, v36, v103
    v_smfmac_f32_16x16x64_bf16 v[66:69], v[100:103], a[64:71], v5
    v_cmp_eq_u32 vcc, s43, v36
    v_smfmac_f32_16x16x64_bf16 v[70:73], v[100:103], a[72:79], v5
    s_cbranch_vccnz L_cf_w1_din0
    s_waitcnt vmcnt(2)
    v_smfmac_f32_16x16x64_bf16 v[58:61], v[96:99], a[0:7], v5
    v_min3_i32 v36, v96, v97, v98
    v_smfmac_f32_16x16x64_bf16 v[62:65], v[96:99], a[8:15], v5
    v_min_i32 v36, v36, v99
    v_smfmac_f32_16x16x64_bf16 v[66:69], v[96:99], a[16:23], v5
    v_cmp_eq_u32 vcc, s43, v36
    v_smfmac_f32_16x16x64_bf16 v[70:73], v[96:99], a[24:31], v5
    s_cbranch_vccnz L_cf_w1_din1
    s_waitcnt vmcnt(1)
    v_smfmac_f32_16x16x64_bf16 v[58:61], v[108:111], a[144:151], v5
    v_min3_i32 v36, v108, v109, v110
    v_smfmac_f32_16x16x64_bf16 v[62:65], v[108:111], a[152:159], v5
    v_min_i32 v36, v36, v111
    v_smfmac_f32_16x16x64_bf16 v[66:69], v[108:111], a[160:167], v5
    v_cmp_eq_u32 vcc, s43, v36
    v_smfmac_f32_16x16x64_bf16 v[70:73], v[108:111], a[168:175], v5
    s_cbranch_vccnz L_cf_w1_din2
    s_waitcnt vmcnt(0)
    v_smfmac_f32_16x16x64_bf16 v[58:61], v[104:107], a[96:103], v5
    v_min3_i32 v36, v104, v105, v106
    v_smfmac_f32_16x16x64_bf16 v[62:65], v[104:107], a[104:111], v5
    v_min_i32 v36, v36, v107
    v_smfmac_f32_16x16x64_bf16 v[66:69], v[104:107], a[112:119], v5
    v_cmp_eq_u32 vcc, s43, v36
    v_smfmac_f32_16x16x64_bf16 v[70:73], v[104:107], a[120:127], v5
    s_cbranch_vccnz L_cf_w1_din3
L_cf_w1_ddone:
    s_nop 0
    v_pk_add_f32 v[86:87], v[58:59], v[60:61]
    ds_write2_b32 v7, v86, v87 offset0:0 offset1:36
    v_pk_add_f32 v[88:89], v[62:63], v[64:65]
    ds_write2_b32 v7, v88, v89 offset0:16 offset1:52
    v_pk_add_f32 v[90:91], v[66:67], v[68:69]
    ds_write2_b32 v8, v90, v91 offset0:0 offset1:36
    v_pk_add_f32 v[92:93], v[70:71], v[72:73]
    ds_write2_b32 v8, v92, v93 offset0:16 offset1:52
    v_smfmac_f32_16x16x64_bf16 v[74:77], v[96:99], a[32:39], v5
    v_smfmac_f32_16x16x64_bf16 v[78:81], v[96:99], a[40:47], v5
    v_smfmac_f32_16x16x64_bf16 v[74:77], v[100:103], a[80:87], v5
    v_smfmac_f32_16x16x64_bf16 v[78:81], v[100:103], a[88:95], v5
    s_waitcnt lgkmcnt(0)
    s_barrier
    v_smfmac_f32_16x16x64_bf16 v[74:77], v[104:107], a[128:135], v5
    buffer_load_dword v39, v28, s[4:7], s45 offen sc1
    v_smfmac_f32_16x16x64_bf16 v[78:81], v[104:107], a[136:143], v5
    buffer_load_dword v39, v28, s[4:7], s45 offen sc1
    v_smfmac_f32_16x16x64_bf16 v[74:77], v[108:111], a[176:183], v5
    buffer_load_dword v39, v28, s[4:7], s45 offen sc1
    v_smfmac_f32_16x16x64_bf16 v[78:81], v[108:111], a[184:191], v5
    buffer_load_dword v39, v28, s[4:7], s45 offen sc1
    s_nop 7
    v_pk_add_f32 v[86:87], v[74:75], v[76:77]
    v_pk_add_f32 v[88:89], v[78:79], v[80:81]
    ds_write_b128 v10, v[86:89] offset:14336
L_cf_w1_apoll:
    v_cmp_gt_u32 vcc, v30, v39
    buffer_load_dword v39, v28, s[4:7], s45 offen offset:0 sc1
    s_cbranch_vccz L_cf_w1_ago
    v_cmp_gt_u32 vcc, v30, v39
    buffer_load_dword v39, v28, s[4:7], s45 offen offset:0 sc1
    s_cbranch_vccz L_cf_w1_ago
    v_cmp_gt_u32 vcc, v30, v39
    buffer_load_dword v39, v28, s[4:7], s45 offen offset:0 sc1
    s_cbranch_vccz L_cf_w1_ago
    v_cmp_gt_u32 vcc, v30, v39
    buffer_load_dword v39, v28, s[4:7], s45 offen offset:0 sc1
    s_cbranch_vccz L_cf_w1_ago
    v_cmp_gt_u32 vcc, v30, v39
    buffer_load_dword v39, v28, s[4:7], s45 offen offset:0 sc1
    s_cbranch_vccz L_cf_w1_ago
    v_cmp_gt_u32 vcc, v30, v39
    buffer_load_dword v39, v28, s[4:7], s45 offen offset:0 sc1
    s_cbranch_vccz L_cf_w1_ago
    v_cmp_gt_u32 vcc, v30, v39
    buffer_load_dword v39, v28, s[4:7], s45 offen offset:0 sc1
    s_cbranch_vccz L_cf_w1_ago
    v_cmp_gt_u32 vcc, v30, v39
    buffer_load_dword v39, v28, s[4:7], s45 offen offset:0 sc1
    s_cbranch_vccz L_cf_w1_ago
    v_cmp_gt_u32 vcc, v30, v39
    buffer_load_dword v39, v28, s[4:7], s45 offen offset:0 sc1
    s_cbranch_vccz L_cf_w1_ago
    v_cmp_gt_u32 vcc, v30, v39
    buffer_load_dword v39, v28, s[4:7], s45 offen offset:0 sc1
    s_cbranch_vccz L_cf_w1_ago
    s_waitcnt vmcnt(36)
    s_add_u32 s36, s36, 1
    s_cmp_lt_u32 s36, 400000
    s_cbranch_scc1 L_cf_w1_apoll
    s_branch L_done
L_cf_w1_ago:
    s_nop 15
    s_nop 5
    s_waitcnt lgkmcnt(0)
    s_barrier
    s_cmp_eq_u32 s26, 63
    s_cbranch_scc1 L_cf_w1_done
    s_lshr_b32 s34, s26, 3
    s_lshr_b32 s34, s19, s34
    s_and_b32 s34, s34, 1
    s_lshl_b32 s34, s34, 13
    s_lshl_b32 s30, s26, 18
    s_add_u32 s30, s30, s34
    s_add_u32 s30, s30, 134217728
    s_mov_b32 m0, 24576
    s_nop 15
    s_nop 7
L_cf_w1_bpoll:
    v_cmp_gt_u32 vcc, v30, v40
    buffer_load_dword v40, v26, s[4:7], s45 offen offset:0 sc1
    s_cbranch_vccz L_cf_w1_bgo
    v_cmp_gt_u32 vcc, v30, v40
    buffer_load_dword v40, v26, s[4:7], s45 offen offset:0 sc1
    s_cbranch_vccz L_cf_w1_bgo
    v_cmp_gt_u32 vcc, v30, v40
    buffer_load_dword v40, v26, s[4:7], s45 offen offset:0 sc1
    s_cbranch_vccz L_cf_w1_bgo
    v_cmp_gt_u32 vcc, v30, v40
    buffer_load_dword v40, v26, s[4:7], s45 offen offset:0 sc1
    s_cbranch_vccz L_cf_w1_bgo
    v_cmp_gt_u32 vcc, v30, v40
    buffer_load_dword v40, v26, s[4:7], s45 offen offset:0 sc1
    s_cbranch_vccz L_cf_w1_bgo
    v_cmp_gt_u32 vcc, v30, v40
    buffer_load_dword v40, v26, s[4:7], s45 offen offset:0 sc1
    s_cbranch_vccz L_cf_w1_bgo
    v_cmp_gt_u32 vcc, v30, v40
    buffer_load_dword v40, v26, s[4:7], s45 offen offset:0 sc1
    s_cbranch_vccz L_cf_w1_bgo
    v_cmp_gt_u32 vcc, v30, v40
    buffer_load_dword v40, v26, s[4:7], s45 offen offset:0 sc1
    s_cbranch_vccz L_cf_w1_bgo
    v_cmp_gt_u32 vcc, v30, v40
    buffer_load_dword v40, v26, s[4:7], s45 offen offset:0 sc1
    s_cbranch_vccz L_cf_w1_bgo
    v_cmp_gt_u32 vcc, v30, v40
    buffer_load_dword v40, v26, s[4:7], s45 offen offset:0 sc1
    s_cbranch_vccz L_cf_w1_bgo
    s_waitcnt vmcnt(36)
    s_add_u32 s36, s36, 1
    s_cmp_lt_u32 s36, 400000
    s_cbranch_scc1 L_cf_w1_bpoll
    s_branch L_done
L_cf_w1_bgo:
    s_barrier
    buffer_load_dwordx4 v6, s[4:7], s28 offen offset:1024 sc1 lds
    s_nop 3
    buffer_load_dwordx4 v6, s[4:7], s28 offen offset:0 sc1 lds
    s_nop 3
    buffer_load_dwordx4 v6, s[4:7], s28 offen offset:3072 sc1 lds
    s_nop 3
    buffer_load_dwordx4 v6, s[4:7], s28 offen offset:2048 sc1 lds
    s_add_u32 s26, s26, 1
    s_and_b32 s35, s26, 3
    s_lshl_b32 s35, s35, 14
    s_add_u32 s27, s41, s35
    v_mov_b32 v58, 0
    v_mov_b32 v59, 0
    v_mov_b32 v60, 0
    v_mov_b32 v61, 0
    v_mov_b32 v62, 0
    v_mov_b32 v63, 0
    v_mov_b32 v64, 0
    v_mov_b32 v65, 0
    v_mov_b32 v66, 0
    v_mov_b32 v67, 0
    v_mov_b32 v68, 0
    v_mov_b32 v69, 0
    v_mov_b32 v70, 0
    v_mov_b32 v71, 0
    v_mov_b32 v72, 0
    v_mov_b32 v73, 0
    v_mov_b32 v74, 0
    v_mov_b32 v75, 0
    v_mov_b32 v76, 0
    v_mov_b32 v77, 0
    v_mov_b32 v78, 0
    v_mov_b32 v79, 0
    v_mov_b32 v80, 0
    v_mov_b32 v81, 0
    s_waitcnt vmcnt(3)
    s_barrier
    s_waitcnt vmcnt(2)
    s_barrier
    s_waitcnt vmcnt(1)
    s_barrier
    s_load_dwordx4 s[64:67], s[4:5], s47 glc
    s_waitcnt vmcnt(0)
    s_barrier
L_cf_w1_cpoll:
    s_load_dwordx4 s[64:67], s[4:5], s47 glc
    s_min_u32 s33, s64, s65
    s_min_u32 s33, s33, s66
    s_cmp_ge_u32 s33, s26
    s_cbranch_scc1 L_cf_w1_cgo
    s_min_u32 s33, s64, s65
    s_min_u32 s33, s33, s66
    s_cmp_ge_u32 s33, s26
    s_cbranch_scc1 L_cf_w1_cgo
    s_min_u32 s33, s64, s65
    s_min_u32 s33, s33, s66
    s_cmp_ge_u32 s33, s26
    s_cbranch_scc1 L_cf_w1_cgo
    s_waitcnt lgkmcnt(8)
    s_add_u32 s36, s36, 1
    s_cmp_lt_u32 s36, 400000
    s_cbranch_scc1 L_cf_w1_cpoll
    s_branch L_done
L_cf_w1_cgo:
    buffer_load_dwordx4 v[116:119], v44, s[4:7], s30 offen sc1
    buffer_load_dwordx4 v[120:123], v45, s[4:7], s30 offen sc1
    buffer_load_dwordx4 v[124:127], v46, s[4:7], s30 offen sc1
L_cf_w1_bjoin:
    s_barrier
    ds_read_b32 v32, v37 offset:19456
    ds_read_b128 v[128:131], v2 offset:18432
    s_waitcnt lgkmcnt(0)
    v_cmp_ne_u32 vcc, 0, v32
    s_cbranch_vccnz L_cf_w1_bretry
    s_waitcnt vmcnt(2)
    v_pk_add_f32 v[132:133], v[128:129], v[116:117]
    v_pk_add_f32 v[134:135], v[130:131], v[118:119]
    s_waitcnt vmcnt(1)
    v_pk_add_f32 v[132:133], v[132:133], v[120:121]
    v_pk_add_f32 v[134:135], v[134:135], v[122:123]
    s_waitcnt vmcnt(0)
    v_pk_add_f32 v[132:133], v[132:133], v[124:125]
    v_pk_add_f32 v[134:135], v[134:135], v[126:127]
    v_pk_add_f32 v[86:87], v[132:133], v[134:135]
    v_cmp_u_f32 vcc, v86, v87
    v_cvt_pk_bf16_f32 v136, v132, v134
    v_cvt_pk_bf16_f32 v137, v133, v135
    v_max_i32 v136, s44, v136
    v_max_i32 v137, s44, v137
    s_cbranch_vccnz L_cf_w1_cslow
L_cf_w1_cgood:
    buffer_store_dword v136, v16, s[4:7], s27 offen
    buffer_store_dword v137, v16, s[4:7], s27 offen offset:16
    s_barrier
    buffer_load_dwordx4 v[100:103], v6, s[4:7], s27 offen offset:1024 sc1
    s_nop 3
    buffer_load_dwordx4 v[96:99], v6, s[4:7], s27 offen offset:0 sc1
    s_nop 3
    buffer_load_dwordx4 v[108:111], v6, s[4:7], s27 offen offset:3072 sc1
    s_nop 3
    buffer_load_dwordx4 v[104:107], v6, s[4:7], s27 offen offset:2048 sc1
    s_branch L_cf_w1_loop
L_cf_w1_din0:
    s_mov_b64 s[54:55], -1
    s_mov_b64 s[60:61], -1
    s_mov_b64 s[58:59], -1
    s_branch L_cf_w1_dre0
L_cf_w1_din1:
    buffer_load_dword v38, v31, s[4:7], 0 offen
    s_mov_b64 s[56:57], 0
    s_mov_b64 s[60:61], -1
    s_mov_b64 s[58:59], -1
    s_branch L_cf_w1_dre1
L_cf_w1_din2:
    buffer_load_dword v38, v31, s[4:7], 0 offen
    buffer_load_dword v38, v31, s[4:7], 0 offen
    s_mov_b64 s[56:57], 0
    s_mov_b64 s[54:55], 0
    s_mov_b64 s[58:59], -1
    s_branch L_cf_w1_dre2
L_cf_w1_din3:
    buffer_load_dword v38, v31, s[4:7], 0 offen
    buffer_load_dword v38, v31, s[4:7], 0 offen
    buffer_load_dword v38, v31, s[4:7], 0 offen
    s_mov_b64 s[56:57], 0
    s_mov_b64 s[54:55], 0
    s_mov_b64 s[60:61], 0
    s_branch L_cf_w1_dre3
L_cf_w1_dloop:
    s_cmp_eq_u64 s[56:57], 0
    s_cbranch_scc1 L_cf_w1_dsk0
    s_waitcnt vmcnt(3)
    v_cndmask_b32 v112, 0, v100, s[56:57]
    v_cndmask_b32 v113, 0, v101, s[56:57]
    v_cndmask_b32 v114, 0, v102, s[56:57]
    v_cndmask_b32 v115, 0, v103, s[56:57]
    s_or_b64 s[62:63], s[54:55], s[60:61]
    s_or_b64 s[62:63], s[62:63], s[58:59]
    v_smfmac_f32_16x16x64_bf16 v[58:61], v[112:115], a[48:55], v5
    v_min3_i32 v36, v112, v113, v114
    v_smfmac_f32_16x16x64_bf16 v[62:65], v[112:115], a[56:63], v5
    v_min_i32 v36, v36, v115
    v_smfmac_f32_16x16x64_bf16 v[66:69], v[112:115], a[64:71], v5
    v_cmp_eq_u32 vcc, s43, v36
    v_smfmac_f32_16x16x64_bf16 v[70:73], v[112:115], a[72:79], v5
    s_or_b64 s[62:63], s[62:63], vcc
    s_cbranch_scc0 L_cf_w1_ddone
    s_cbranch_vccz L_cf_w1_dok0
L_cf_w1_dre0:
    s_mov_b64 exec, vcc
    buffer_load_dwordx4 v[100:103], v6, s[4:7], s27 offen offset:1024 sc1
    s_mov_b64 exec, -1
    s_mov_b64 s[56:57], vcc
    s_branch L_cf_w1_dnx0
L_cf_w1_dok0:
    s_mov_b64 s[56:57], 0
L_cf_w1_dsk0:
    buffer_load_dword v38, v31, s[4:7], 0 offen
L_cf_w1_dnx0:
    s_cmp_eq_u64 s[54:55], 0
    s_cbranch_scc1 L_cf_w1_dsk1
    s_waitcnt vmcnt(3)
    v_cndmask_b32 v112, 0, v96, s[54:55]
    v_cndmask_b32 v113, 0, v97, s[54:55]
    v_cndmask_b32 v114, 0, v98, s[54:55]
    v_cndmask_b32 v115, 0, v99, s[54:55]
    s_or_b64 s[62:63], s[56:57], s[60:61]
    s_or_b64 s[62:63], s[62:63], s[58:59]
    v_smfmac_f32_16x16x64_bf16 v[58:61], v[112:115], a[0:7], v5
    v_min3_i32 v36, v112, v113, v114
    v_smfmac_f32_16x16x64_bf16 v[62:65], v[112:115], a[8:15], v5
    v_min_i32 v36, v36, v115
    v_smfmac_f32_16x16x64_bf16 v[66:69], v[112:115], a[16:23], v5
    v_cmp_eq_u32 vcc, s43, v36
    v_smfmac_f32_16x16x64_bf16 v[70:73], v[112:115], a[24:31], v5
    s_or_b64 s[62:63], s[62:63], vcc
    s_cbranch_scc0 L_cf_w1_ddone
    s_cbranch_vccz L_cf_w1_dok1
L_cf_w1_dre1:
    s_mov_b64 exec, vcc
    buffer_load_dwordx4 v[96:99], v6, s[4:7], s27 offen offset:0 sc1
    s_mov_b64 exec, -1
    s_mov_b64 s[54:55], vcc
    s_branch L_cf_w1_dnx1
L_cf_w1_dok1:
    s_mov_b64 s[54:55], 0
L_cf_w1_dsk1:
    buffer_load_dword v38, v31, s[4:7], 0 offen
L_cf_w1_dnx1:
    s_cmp_eq_u64 s[60:61], 0
    s_cbranch_scc1 L_cf_w1_dsk2
    s_waitcnt vmcnt(3)
    v_cndmask_b32 v112, 0, v108, s[60:61]
    v_cndmask_b32 v113, 0, v109, s[60:61]
    v_cndmask_b32 v114, 0, v110, s[60:61]
    v_cndmask_b32 v115, 0, v111, s[60:61]
    s_or_b64 s[62:63], s[56:57], s[54:55]
    s_or_b64 s[62:63], s[62:63], s[58:59]
    v_smfmac_f32_16x16x64_bf16 v[58:61], v[112:115], a[144:151], v5
    v_min3_i32 v36, v112, v113, v114
    v_smfmac_f32_16x16x64_bf16 v[62:65], v[112:115], a[152:159], v5
    v_min_i32 v36, v36, v115
    v_smfmac_f32_16x16x64_bf16 v[66:69], v[112:115], a[160:167], v5
    v_cmp_eq_u32 vcc, s43, v36
    v_smfmac_f32_16x16x64_bf16 v[70:73], v[112:115], a[168:175], v5
    s_or_b64 s[62:63], s[62:63], vcc
    s_cbranch_scc0 L_cf_w1_ddone
    s_cbranch_vccz L_cf_w1_dok2
L_cf_w1_dre2:
    s_mov_b64 exec, vcc
    buffer_load_dwordx4 v[108:111], v6, s[4:7], s27 offen offset:3072 sc1
    s_mov_b64 exec, -1
    s_mov_b64 s[60:61], vcc
    s_branch L_cf_w1_dnx2
L_cf_w1_dok2:
    s_mov_b64 s[60:61], 0
L_cf_w1_dsk2:
    buffer_load_dword v38, v31, s[4:7], 0 offen
L_cf_w1_dnx2:
    s_cmp_eq_u64 s[58:59], 0
    s_cbranch_scc1 L_cf_w1_dsk3
    s_waitcnt vmcnt(3)
    v_cndmask_b32 v112, 0, v104, s[58:59]
    v_cndmask_b32 v113, 0, v105, s[58:59]
    v_cndmask_b32 v114, 0, v106, s[58:59]
    v_cndmask_b32 v115, 0, v107, s[58:59]
    s_or_b64 s[62:63], s[56:57], s[54:55]
    s_or_b64 s[62:63], s[62:63], s[60:61]
    v_smfmac_f32_16x16x64_bf16 v[58:61], v[112:115], a[96:103], v5
    v_min3_i32 v36, v112, v113, v114
    v_smfmac_f32_16x16x64_bf16 v[62:65], v[112:115], a[104:111], v5
    v_min_i32 v36, v36, v115
    v_smfmac_f32_16x16x64_bf16 v[66:69], v[112:115], a[112:119], v5
    v_cmp_eq_u32 vcc, s43, v36
    v_smfmac_f32_16x16x64_bf16 v[70:73], v[112:115], a[120:127], v5
    s_or_b64 s[62:63], s[62:63], vcc
    s_cbranch_scc0 L_cf_w1_ddone
    s_cbranch_vccz L_cf_w1_dok3
L_cf_w1_dre3:
    s_mov_b64 exec, vcc
    buffer_load_dwordx4 v[104:107], v6, s[4:7], s27 offen offset:2048 sc1
    s_mov_b64 exec, -1
    s_mov_b64 s[58:59], vcc
    s_branch L_cf_w1_dnx3
L_cf_w1_dok3:
    s_mov_b64 s[58:59], 0
L_cf_w1_dsk3:
    buffer_load_dword v38, v31, s[4:7], 0 offen
L_cf_w1_dnx3:
    s_add_u32 s36, s36, 1
    s_cmp_lt_u32 s36, 400000
    s_cbranch_scc1 L_cf_w1_dloop
    s_branch L_done
L_cf_w1_bretry:
    s_add_u32 s36, s36, 1
    s_cmp_gt_u32 s36, 400000
    s_cbranch_scc1 L_done
    s_mov_b32 m0, 24576
    s_nop 0
    buffer_load_dwordx4 v6, s[4:7], s28 offen offset:1024 sc1 lds
    s_nop 3
    buffer_load_dwordx4 v6, s[4:7], s28 offen offset:0 sc1 lds
    s_nop 3
    buffer_load_dwordx4 v6, s[4:7], s28 offen offset:3072 sc1 lds
    s_nop 3
    buffer_load_dwordx4 v6, s[4:7], s28 offen offset:2048 sc1 lds
    s_waitcnt vmcnt(3)
    s_barrier
    s_waitcnt vmcnt(2)
    s_barrier
    s_waitcnt vmcnt(1)
    s_barrier
    s_waitcnt vmcnt(0)
    s_barrier
    s_branch L_cf_w1_bjoin
L_cf_w1_cslow:
    v_max_u32 v36, v116, v117
    v_max3_u32 v36, v36, v118, v119
    v_max3_u32 v36, v36, v120, v121
    v_max3_u32 v36, v36, v122, v123
    v_max3_u32 v36, v36, v124, v125
    v_max3_u32 v36, v36, v126, v127
    v_cmp_eq_u32 vcc, -1, v36
    s_cbranch_vccz L_cf_w1_cgood
    buffer_load_dwordx4 v[116:119], v44, s[4:7], s30 offen sc1
    buffer_load_dwordx4 v[120:123], v45, s[4:7], s30 offen sc1
    buffer_load_dwordx4 v[124:127], v46, s[4:7], s30 offen sc1
    s_add_u32 s36, s36, 1
    s_cmp_gt_u32 s36, 400000
    s_cbranch_scc1 L_done
    s_waitcnt vmcnt(2)
    v_pk_add_f32 v[132:133], v[128:129], v[116:117]
    v_pk_add_f32 v[134:135], v[130:131], v[118:119]
    s_waitcnt vmcnt(1)
    v_pk_add_f32 v[132:133], v[132:133], v[120:121]
    v_pk_add_f32 v[134:135], v[134:135], v[122:123]
    s_waitcnt vmcnt(0)
    v_pk_add_f32 v[132:133], v[132:133], v[124:125]
    v_pk_add_f32 v[134:135], v[134:135], v[126:127]
    v_cvt_pk_bf16_f32 v136, v132, v134
    v_cvt_pk_bf16_f32 v137, v133, v135
    v_max_i32 v136, s44, v136
    v_max_i32 v137, s44, v137
    s_branch L_cf_w1_cslow
L_cf_w1_done:
    s_branch L_done
L_cf_w2:
    v_mov_b32 v58, 0
    v_mov_b32 v59, 0
    v_mov_b32 v60, 0
    v_mov_b32 v61, 0
    v_mov_b32 v62, 0
    v_mov_b32 v63, 0
    v_mov_b32 v64, 0
    v_mov_b32 v65, 0
    v_mov_b32 v66, 0
    v_mov_b32 v67, 0
    v_mov_b32 v68, 0
    v_mov_b32 v69, 0
    v_mov_b32 v70, 0
    v_mov_b32 v71, 0
    v_mov_b32 v72, 0
    v_mov_b32 v73, 0
    v_mov_b32 v74, 0
    v_mov_b32 v75, 0
    v_mov_b32 v76, 0
    v_mov_b32 v77, 0
    v_mov_b32 v78, 0
    v_mov_b32 v79, 0
    v_mov_b32 v80, 0
    v_mov_b32 v81, 0
    s_waitcnt vmcnt(0)
    s_barrier
    buffer_load_dwordx4 v[104:107], v6, s[4:7], s27 offen offset:2048 sc1
    s_nop 3
    buffer_load_dwordx4 v[108:111], v6, s[4:7], s27 offen offset:3072 sc1
    s_nop 3
    buffer_load_dwordx4 v[96:99], v6, s[4:7], s27 offen offset:0 sc1
    s_nop 3
    buffer_load_dwordx4 v[100:103], v6, s[4:7], s27 offen offset:1024 sc1
L_cf_w2_loop:
    s_and_b32 s33, s26, 3
    s_add_u32 s28, s27, 262144
    s_lshl_b32 s34, s33, 16
    s_add_u32 s29, s42, s34
    v_add_u32 v30, 1, v30
    s_waitcnt vmcnt(3)
    v_smfmac_f32_16x16x64_bf16 v[58:61], v[104:107], a[96:103], v5
    v_min3_i32 v36, v104, v105, v106
    v_smfmac_f32_16x16x64_bf16 v[62:65], v[104:107], a[104:111], v5
    v_min_i32 v36, v36, v107
    v_smfmac_f32_16x16x64_bf16 v[66:69], v[104:107], a[112:119], v5
    v_cmp_eq_u32 vcc, s43, v36
    v_smfmac_f32_16x16x64_bf16 v[70:73], v[104:107], a[120:127], v5
    s_cbranch_vccnz L_cf_w2_din0
    s_waitcnt vmcnt(2)
    v_smfmac_f32_16x16x64_bf16 v[58:61], v[108:111], a[144:151], v5
    v_min3_i32 v36, v108, v109, v110
    v_smfmac_f32_16x16x64_bf16 v[62:65], v[108:111], a[152:159], v5
    v_min_i32 v36, v36, v111
    v_smfmac_f32_16x16x64_bf16 v[66:69], v[108:111], a[160:167], v5
    v_cmp_eq_u32 vcc, s43, v36
    v_smfmac_f32_16x16x64_bf16 v[70:73], v[108:111], a[168:175], v5
    s_cbranch_vccnz L_cf_w2_din1
    s_waitcnt vmcnt(1)
    v_smfmac_f32_16x16x64_bf16 v[58:61], v[96:99], a[0:7], v5
    v_min3_i32 v36, v96, v97, v98
    v_smfmac_f32_16x16x64_bf16 v[62:65], v[96:99], a[8:15], v5
    v_min_i32 v36, v36, v99
    v_smfmac_f32_16x16x64_bf16 v[66:69], v[96:99], a[16:23], v5
    v_cmp_eq_u32 vcc, s43, v36
    v_smfmac_f32_16x16x64_bf16 v[70:73], v[96:99], a[24:31], v5
    s_cbranch_vccnz L_cf_w2_din2
    s_waitcnt vmcnt(0)
    v_smfmac_f32_16x16x64_bf16 v[58:61], v[100:103], a[48:55], v5
    v_min3_i32 v36, v100, v101, v102
    v_smfmac_f32_16x16x64_bf16 v[62:65], v[100:103], a[56:63], v5
    v_min_i32 v36, v36, v103
    v_smfmac_f32_16x16x64_bf16 v[66:69], v[100:103], a[64:71], v5
    v_cmp_eq_u32 vcc, s43, v36
    v_smfmac_f32_16x16x64_bf16 v[70:73], v[100:103], a[72:79], v5
    s_cbranch_vccnz L_cf_w2_din3
L_cf_w2_ddone:
    s_nop 0
    v_pk_add_f32 v[86:87], v[58:59], v[60:61]
    ds_write2_b32 v7, v86, v87 offset0:0 offset1:36
    v_pk_add_f32 v[88:89], v[62:63], v[64:65]
    ds_write2_b32 v7, v88, v89 offset0:16 offset1:52
    v_pk_add_f32 v[90:91], v[66:67], v[68:69]
    ds_write2_b32 v8, v90, v91 offset0:0 offset1:36
    v_pk_add_f32 v[92:93], v[70:71], v[72:73]
    ds_write2_b32 v8, v92, v93 offset0:16 offset1:52
    v_smfmac_f32_16x16x64_bf16 v[74:77], v[96:99], a[32:39], v5
    v_smfmac_f32_16x16x64_bf16 v[78:81], v[96:99], a[40:47], v5
    v_smfmac_f32_16x16x64_bf16 v[74:77], v[100:103], a[80:87], v5
    v_smfmac_f32_16x16x64_bf16 v[78:81], v[100:103], a[88:95], v5
    s_waitcnt lgkmcnt(0)
    s_barrier
    buffer_store_dword v30, v27, s[4:7], s45 offen offset:0
    v_smfmac_f32_16x16x64_bf16 v[74:77], v[104:107], a[128:135], v5
    v_smfmac_f32_16x16x64_bf16 v[78:81], v[104:107], a[136:143], v5
    v_smfmac_f32_16x16x64_bf16 v[74:77], v[108:111], a[176:183], v5
    v_smfmac_f32_16x16x64_bf16 v[78:81], v[108:111], a[184:191], v5
    s_nop 7
    v_pk_add_f32 v[86:87], v[74:75], v[76:77]
    v_pk_add_f32 v[88:89], v[78:79], v[80:81]
    ds_write_b128 v10, v[86:89] offset:14336
    s_waitcnt lgkmcnt(0)
    s_barrier
    s_cmp_eq_u32 s26, 63
    s_cbranch_scc1 L_cf_w2_done
    s_lshr_b32 s34, s26, 3
    s_lshr_b32 s34, s19, s34
    s_and_b32 s34, s34, 1
    s_lshl_b32 s34, s34, 13
    s_lshl_b32 s30, s26, 18
    s_add_u32 s30, s30, s34
    s_add_u32 s30, s30, 134217728
    s_mov_b32 m0, 28672
    v_mov_b32 v82, 0
    v_mov_b32 v83, 0
    v_mov_b32 v84, 0
    v_mov_b32 v85, 0
    s_add_u32 s35, s26, 4
    s_lshr_b32 s34, s35, 3
    s_lshr_b32 s34, s19, s34
    s_and_b32 s34, s34, 1
    s_lshl_b32 s34, s34, 13
    s_lshl_b32 s39, s35, 18
    s_add_u32 s39, s39, s34
    s_add_u32 s39, s39, 134217728
    s_cmp_gt_u32 s35, 62
    s_cselect_b32 s39, 1073741824, s39
    s_barrier
    buffer_load_dwordx4 v6, s[4:7], s28 offen offset:2048 sc1 lds
    s_nop 3
    buffer_load_dwordx4 v6, s[4:7], s28 offen offset:3072 sc1 lds
    s_nop 3
    buffer_load_dwordx4 v6, s[4:7], s28 offen offset:0 sc1 lds
    s_nop 3
    buffer_load_dwordx4 v6, s[4:7], s28 offen offset:1024 sc1 lds
    s_add_u32 s26, s26, 1
    s_and_b32 s35, s26, 3
    s_lshl_b32 s35, s35, 14
    s_add_u32 s27, s41, s35
    v_mov_b32 v58, 0
    v_mov_b32 v59, 0
    v_mov_b32 v60, 0
    v_mov_b32 v61, 0
    v_mov_b32 v62, 0
    v_mov_b32 v63, 0
    v_mov_b32 v64, 0
    v_mov_b32 v65, 0
    v_mov_b32 v66, 0
    v_mov_b32 v67, 0
    v_mov_b32 v68, 0
    v_mov_b32 v69, 0
    v_mov_b32 v70, 0
    v_mov_b32 v71, 0
    v_mov_b32 v72, 0
    v_mov_b32 v73, 0
    v_mov_b32 v74, 0
    v_mov_b32 v75, 0
    v_mov_b32 v76, 0
    v_mov_b32 v77, 0
    v_mov_b32 v78, 0
    v_mov_b32 v79, 0
    v_mov_b32 v80, 0
    v_mov_b32 v81, 0
L_cf_w2_bwait:
    s_waitcnt vmcnt(3)
    s_barrier
    ds_read_b128 v[116:119], v2 offset:20480
    ds_read_b128 v[136:139], v2 offset:25600
    ds_read_b128 v[156:159], v2 offset:30720
    ds_read_b128 v[176:179], v2 offset:35840
    s_waitcnt lgkmcnt(3)
    v_smfmac_f32_16x16x64_bf16 v[82:85], v[116:119], a[192:199], v5
    s_waitcnt vmcnt(2)
    s_barrier
    ds_read_b128 v[120:123], v2 offset:21504
    ds_read_b128 v[132:135], v2 offset:24576
    ds_read_b128 v[160:163], v2 offset:31744
    ds_read_b128 v[172:175], v2 offset:34816
    s_waitcnt lgkmcnt(6)
    v_smfmac_f32_16x16x64_bf16 v[82:85], v[136:139], a[232:239], v5
    s_waitcnt lgkmcnt(5)
    v_smfmac_f32_16x16x64_bf16 v[82:85], v[156:159], v[196:203], v5
    s_waitcnt lgkmcnt(4)
    v_smfmac_f32_16x16x64_bf16 v[82:85], v[176:179], v[236:243], v5
    s_waitcnt lgkmcnt(3)
    v_smfmac_f32_16x16x64_bf16 v[82:85], v[120:123], a[200:207], v5
    s_waitcnt vmcnt(1)
    s_barrier
    ds_read_b128 v[124:127], v2 offset:22528
    ds_read_b128 v[144:147], v2 offset:27648
    ds_read_b128 v[148:151], v2 offset:28672
    ds_read_b128 v[168:171], v2 offset:33792
    s_waitcnt lgkmcnt(6)
    v_smfmac_f32_16x16x64_bf16 v[82:85], v[132:135], a[224:231], v5
    s_waitcnt lgkmcnt(5)
    v_smfmac_f32_16x16x64_bf16 v[82:85], v[160:163], v[204:211], v5
    s_waitcnt lgkmcnt(4)
    v_smfmac_f32_16x16x64_bf16 v[82:85], v[172:175], v[228:235], v5
    s_waitcnt lgkmcnt(3)
    v_smfmac_f32_16x16x64_bf16 v[82:85], v[124:127], a[208:215], v5
    s_waitcnt vmcnt(0)
    s_barrier
    ds_read_b128 v[128:131], v2 offset:23552
    ds_read_b128 v[140:143], v2 offset:26624
    ds_read_b128 v[152:155], v2 offset:29696
    ds_read_b128 v[164:167], v2 offset:32768
    s_waitcnt lgkmcnt(6)
    v_smfmac_f32_16x16x64_bf16 v[82:85], v[144:147], a[248:255], v5
    s_waitcnt lgkmcnt(5)
    v_smfmac_f32_16x16x64_bf16 v[82:85], v[148:151], v[180:187], v5
    s_waitcnt lgkmcnt(4)
    v_smfmac_f32_16x16x64_bf16 v[82:85], v[168:171], v[220:227], v5
    s_waitcnt lgkmcnt(3)
    v_smfmac_f32_16x16x64_bf16 v[82:85], v[128:131], a[216:223], v5
    s_waitcnt lgkmcnt(2)
    v_smfmac_f32_16x16x64_bf16 v[82:85], v[140:143], a[240:247], v5
    s_waitcnt lgkmcnt(1)
    v_smfmac_f32_16x16x64_bf16 v[82:85], v[152:155], v[188:195], v5
    s_waitcnt lgkmcnt(0)
    v_smfmac_f32_16x16x64_bf16 v[82:85], v[164:167], v[212:219], v5
    s_nop 7
    v_pk_add_f32 v[86:87], v[82:83], v[84:85]
    v_cmpx_o_f32 vcc, v86, v87
    buffer_store_dwordx2 v[86:87], v15, s[4:7], s30 offen sc1
    s_cmp_eq_u64 exec, -1
    s_cbranch_scc0 L_cf_w2_bslow
L_cf_w2_bgood:
    ds_write_b64 v3, v[86:87] offset:18432
    ds_write_b32 v37, v37 offset:19456
    buffer_store_dwordx4 v[50:53], v24, s[4:7], s39 offen sc1
    s_waitcnt lgkmcnt(0)
    s_barrier
    s_nop 15
    s_nop 15
    s_nop 15
L_cf_w2_spoll:
    v_cmp_gt_u32 vcc, v30, v41
    buffer_load_dword v41, v26, s[4:7], s45 offen offset:2048 sc1
    s_cbranch_vccz L_cf_w2_sgo
    v_cmp_gt_u32 vcc, v30, v41
    buffer_load_dword v41, v26, s[4:7], s45 offen offset:2048 sc1
    s_cbranch_vccz L_cf_w2_sgo
    v_cmp_gt_u32 vcc, v30, v41
    buffer_load_dword v41, v26, s[4:7], s45 offen offset:2048 sc1
    s_cbranch_vccz L_cf_w2_sgo
    v_cmp_gt_u32 vcc, v30, v41
    buffer_load_dword v41, v26, s[4:7], s45 offen offset:2048 sc1
    s_cbranch_vccz L_cf_w2_sgo
    v_cmp_gt_u32 vcc, v30, v41
    buffer_load_dword v41, v26, s[4:7], s45 offen offset:2048 sc1
    s_cbranch_vccz L_cf_w2_sgo
    v_cmp_gt_u32 vcc, v30, v41
    buffer_load_dword v41, v26, s[4:7], s45 offen offset:2048 sc1
    s_cbranch_vccz L_cf_w2_sgo
    v_cmp_gt_u32 vcc, v30, v41
    buffer_load_dword v41, v26, s[4:7], s45 offen offset:2048 sc1
    s_cbranch_vccz L_cf_w2_sgo
    v_cmp_gt_u32 vcc, v30, v41
    buffer_load_dword v41, v26, s[4:7], s45 offen offset:2048 sc1
    s_cbranch_vccz L_cf_w2_sgo
    v_cmp_gt_u32 vcc, v30, v41
    buffer_load_dword v41, v26, s[4:7], s45 offen offset:2048 sc1
    s_cbranch_vccz L_cf_w2_sgo
    v_cmp_gt_u32 vcc, v30, v41
    buffer_load_dword v41, v26, s[4:7], s45 offen offset:2048 sc1
    s_cbranch_vccz L_cf_w2_sgo
    s_waitcnt vmcnt(36)
    s_add_u32 s36, s36, 1
    s_cmp_lt_u32 s36, 400000
    s_cbranch_scc1 L_cf_w2_spoll
    s_branch L_done
L_cf_w2_sgo:
    s_barrier
    buffer_load_dwordx4 v[104:107], v6, s[4:7], s27 offen offset:2048 sc1
    s_nop 3
    buffer_load_dwordx4 v[108:111], v6, s[4:7], s27 offen offset:3072 sc1
    s_nop 3
    buffer_load_dwordx4 v[96:99], v6, s[4:7], s27 offen offset:0 sc1
    s_nop 3
    buffer_load_dwordx4 v[100:103], v6, s[4:7], s27 offen offset:1024 sc1
    s_branch L_cf_w2_loop
L_cf_w2_din0:
    s_mov_b64 s[60:61], -1
    s_mov_b64 s[54:55], -1
    s_mov_b64 s[56:57], -1
    s_branch L_cf_w2_dre0
L_cf_w2_din1:
    buffer_load_dword v38, v31, s[4:7], 0 offen
    s_mov_b64 s[58:59], 0
    s_mov_b64 s[54:55], -1
    s_mov_b64 s[56:57], -1
    s_branch L_cf_w2_dre1
L_cf_w2_din2:
    buffer_load_dword v38, v31, s[4:7], 0 offen
    buffer_load_dword v38, v31, s[4:7], 0 offen
    s_mov_b64 s[58:59], 0
    s_mov_b64 s[60:61], 0
    s_mov_b64 s[56:57], -1
    s_branch L_cf_w2_dre2
L_cf_w2_din3:
    buffer_load_dword v38, v31, s[4:7], 0 offen
    buffer_load_dword v38, v31, s[4:7], 0 offen
    buffer_load_dword v38, v31, s[4:7], 0 offen
    s_mov_b64 s[58:59], 0
    s_mov_b64 s[60:61], 0
    s_mov_b64 s[54:55], 0
    s_branch L_cf_w2_dre3
L_cf_w2_dloop:
    s_cmp_eq_u64 s[58:59], 0
    s_cbranch_scc1 L_cf_w2_dsk0
    s_waitcnt vmcnt(3)
    v_cndmask_b32 v112, 0, v104, s[58:59]
    v_cndmask_b32 v113, 0, v105, s[58:59]
    v_cndmask_b32 v114, 0, v106, s[58:59]
    v_cndmask_b32 v115, 0, v107, s[58:59]
    s_or_b64 s[62:63], s[60:61], s[54:55]
    s_or_b64 s[62:63], s[62:63], s[56:57]
    v_smfmac_f32_16x16x64_bf16 v[58:61], v[112:115], a[96:103], v5
    v_min3_i32 v36, v112, v113, v114
    v_smfmac_f32_16x16x64_bf16 v[62:65], v[112:115], a[104:111], v5
    v_min_i32 v36, v36, v115
    v_smfmac_f32_16x16x64_bf16 v[66:69], v[112:115], a[112:119], v5
    v_cmp_eq_u32 vcc, s43, v36
    v_smfmac_f32_16x16x64_bf16 v[70:73], v[112:115], a[120:127], v5
    s_or_b64 s[62:63], s[62:63], vcc
    s_cbranch_scc0 L_cf_w2_ddone
    s_cbranch_vccz L_cf_w2_dok0
L_cf_w2_dre0:
    s_mov_b64 exec, vcc
    buffer_load_dwordx4 v[104:107], v6, s[4:7], s27 offen offset:2048 sc1
    s_mov_b64 exec, -1
    s_mov_b64 s[58:59], vcc
    s_branch L_cf_w2_dnx0
L_cf_w2_dok0:
    s_mov_b64 s[58:59], 0
L_cf_w2_dsk0:
    buffer_load_dword v38, v31, s[4:7], 0 offen
L_cf_w2_dnx0:
    s_cmp_eq_u64 s[60:61], 0
    s_cbranch_scc1 L_cf_w2_dsk1
    s_waitcnt vmcnt(3)
    v_cndmask_b32 v112, 0, v108, s[60:61]
    v_cndmask_b32 v113, 0, v109, s[60:61]
    v_cndmask_b32 v114, 0, v110, s[60:61]
    v_cndmask_b32 v115, 0, v111, s[60:61]
    s_or_b64 s[62:63], s[58:59], s[54:55]
    s_or_b64 s[62:63], s[62:63], s[56:57]
    v_smfmac_f32_16x16x64_bf16 v[58:61], v[112:115], a[144:151], v5
    v_min3_i32 v36, v112, v113, v114
    v_smfmac_f32_16x16x64_bf16 v[62:65], v[112:115], a[152:159], v5
    v_min_i32 v36, v36, v115
    v_smfmac_f32_16x16x64_bf16 v[66:69], v[112:115], a[160:167], v5
    v_cmp_eq_u32 vcc, s43, v36
    v_smfmac_f32_16x16x64_bf16 v[70:73], v[112:115], a[168:175], v5
    s_or_b64 s[62:63], s[62:63], vcc
    s_cbranch_scc0 L_cf_w2_ddone
    s_cbranch_vccz L_cf_w2_dok1
L_cf_w2_dre1:
    s_mov_b64 exec, vcc
    buffer_load_dwordx4 v[108:111], v6, s[4:7], s27 offen offset:3072 sc1
    s_mov_b64 exec, -1
    s_mov_b64 s[60:61], vcc
    s_branch L_cf_w2_dnx1
L_cf_w2_dok1:
    s_mov_b64 s[60:61], 0
L_cf_w2_dsk1:
    buffer_load_dword v38, v31, s[4:7], 0 offen
L_cf_w2_dnx1:
    s_cmp_eq_u64 s[54:55], 0
    s_cbranch_scc1 L_cf_w2_dsk2
    s_waitcnt vmcnt(3)
    v_cndmask_b32 v112, 0, v96, s[54:55]
    v_cndmask_b32 v113, 0, v97, s[54:55]
    v_cndmask_b32 v114, 0, v98, s[54:55]
    v_cndmask_b32 v115, 0, v99, s[54:55]
    s_or_b64 s[62:63], s[58:59], s[60:61]
    s_or_b64 s[62:63], s[62:63], s[56:57]
    v_smfmac_f32_16x16x64_bf16 v[58:61], v[112:115], a[0:7], v5
    v_min3_i32 v36, v112, v113, v114
    v_smfmac_f32_16x16x64_bf16 v[62:65], v[112:115], a[8:15], v5
    v_min_i32 v36, v36, v115
    v_smfmac_f32_16x16x64_bf16 v[66:69], v[112:115], a[16:23], v5
    v_cmp_eq_u32 vcc, s43, v36
    v_smfmac_f32_16x16x64_bf16 v[70:73], v[112:115], a[24:31], v5
    s_or_b64 s[62:63], s[62:63], vcc
    s_cbranch_scc0 L_cf_w2_ddone
    s_cbranch_vccz L_cf_w2_dok2
L_cf_w2_dre2:
    s_mov_b64 exec, vcc
    buffer_load_dwordx4 v[96:99], v6, s[4:7], s27 offen offset:0 sc1
    s_mov_b64 exec, -1
    s_mov_b64 s[54:55], vcc
    s_branch L_cf_w2_dnx2
L_cf_w2_dok2:
    s_mov_b64 s[54:55], 0
L_cf_w2_dsk2:
    buffer_load_dword v38, v31, s[4:7], 0 offen
L_cf_w2_dnx2:
    s_cmp_eq_u64 s[56:57], 0
    s_cbranch_scc1 L_cf_w2_dsk3
    s_waitcnt vmcnt(3)
    v_cndmask_b32 v112, 0, v100, s[56:57]
    v_cndmask_b32 v113, 0, v101, s[56:57]
    v_cndmask_b32 v114, 0, v102, s[56:57]
    v_cndmask_b32 v115, 0, v103, s[56:57]
    s_or_b64 s[62:63], s[58:59], s[60:61]
    s_or_b64 s[62:63], s[62:63], s[54:55]
    v_smfmac_f32_16x16x64_bf16 v[58:61], v[112:115], a[48:55], v5
    v_min3_i32 v36, v112, v113, v114
    v_smfmac_f32_16x16x64_bf16 v[62:65], v[112:115], a[56:63], v5
    v_min_i32 v36, v36, v115
    v_smfmac_f32_16x16x64_bf16 v[66:69], v[112:115], a[64:71], v5
    v_cmp_eq_u32 vcc, s43, v36
    v_smfmac_f32_16x16x64_bf16 v[70:73], v[112:115], a[72:79], v5
    s_or_b64 s[62:63], s[62:63], vcc
    s_cbranch_scc0 L_cf_w2_ddone
    s_cbranch_vccz L_cf_w2_dok3
L_cf_w2_dre3:
    s_mov_b64 exec, vcc
    buffer_load_dwordx4 v[100:103], v6, s[4:7], s27 offen offset:1024 sc1
    s_mov_b64 exec, -1
    s_mov_b64 s[56:57], vcc
    s_branch L_cf_w2_dnx3
L_cf_w2_dok3:
    s_mov_b64 s[56:57], 0
L_cf_w2_dsk3:
    buffer_load_dword v38, v31, s[4:7], 0 offen
L_cf_w2_dnx3:
    s_add_u32 s36, s36, 1
    s_cmp_lt_u32 s36, 400000
    s_cbranch_scc1 L_cf_w2_dloop
    s_branch L_done
L_cf_w2_bslow:
    s_mov_b64 exec, -1
    v_max_u32 v36, v116, v117
    v_max3_u32 v36, v36, v118, v119
    v_max3_u32 v36, v36, v120, v121
    v_max3_u32 v36, v36, v122, v123
    v_max3_u32 v36, v36, v124, v125
    v_max3_u32 v36, v36, v126, v127
    v_max3_u32 v36, v36, v128, v129
    v_max3_u32 v36, v36, v130, v131
    v_max3_u32 v36, v36, v132, v133
    v_max3_u32 v36, v36, v134, v135
    v_max3_u32 v36, v36, v136, v137
    v_max3_u32 v36, v36, v138, v139
    v_max3_u32 v36, v36, v140, v141
    v_max3_u32 v36, v36, v142, v143
    v_max3_u32 v36, v36, v144, v145
    v_max3_u32 v36, v36, v146, v147
    v_max3_u32 v36, v36, v148, v149
    v_max3_u32 v36, v36, v150, v151
    v_max3_u32 v36, v36, v152, v153
    v_max3_u32 v36, v36, v154, v155
    v_max3_u32 v36, v36, v156, v157
    v_max3_u32 v36, v36, v158, v159
    v_max3_u32 v36, v36, v160, v161
    v_max3_u32 v36, v36, v162, v163
    v_max3_u32 v36, v36, v164, v165
    v_max3_u32 v36, v36, v166, v167
    v_max3_u32 v36, v36, v168, v169
    v_max3_u32 v36, v36, v170, v171
    v_max3_u32 v36, v36, v172, v173
    v_max3_u32 v36, v36, v174, v175
    v_max3_u32 v36, v36, v176, v177
    v_max3_u32 v36, v36, v178, v179
    v_cmp_eq_u32 vcc, -1, v36
    s_cbranch_vccnz L_cf_w2_bagain
    buffer_store_dwordx2 v[86:87], v15, s[4:7], s30 offen sc1
    s_branch L_cf_w2_bgood
L_cf_w2_bagain:
    ds_write_b32 v37, v50 offset:19456
    v_mov_b32 v82, 0
    v_mov_b32 v83, 0
    v_mov_b32 v84, 0
    v_mov_b32 v85, 0
    s_add_u32 s36, s36, 1
    s_cmp_gt_u32 s36, 400000
    s_cbranch_scc1 L_done
    s_waitcnt lgkmcnt(0)
    s_barrier
    buffer_load_dwordx4 v6, s[4:7], s28 offen offset:2048 sc1 lds
    s_nop 3
    buffer_load_dwordx4 v6, s[4:7], s28 offen offset:3072 sc1 lds
    s_nop 3
    buffer_load_dwordx4 v6, s[4:7], s28 offen offset:0 sc1 lds
    s_nop 3
    buffer_load_dwordx4 v6, s[4:7], s28 offen offset:1024 sc1 lds
    s_branch L_cf_w2_bwait
L_cf_w2_done:
    s_branch L_done
L_cf_w3:
    v_mov_b32 v58, 0
    v_mov_b32 v59, 0
    v_mov_b32 v60, 0
    v_mov_b32 v61, 0
    v_mov_b32 v62, 0
    v_mov_b32 v63, 0
    v_mov_b32 v64, 0
    v_mov_b32 v65, 0
    v_mov_b32 v66, 0
    v_mov_b32 v67, 0
    v_mov_b32 v68, 0
    v_mov_b32 v69, 0
    v_mov_b32 v70, 0
    v_mov_b32 v71, 0
    v_mov_b32 v72, 0
    v_mov_b32 v73, 0
    v_mov_b32 v74, 0
    v_mov_b32 v75, 0
    v_mov_b32 v76, 0
    v_mov_b32 v77, 0
    v_mov_b32 v78, 0
    v_mov_b32 v79, 0
    v_mov_b32 v80, 0
    v_mov_b32 v81, 0
    s_waitcnt vmcnt(0)
    s_barrier
    buffer_load_dwordx4 v[108:111], v6, s[4:7], s27 offen offset:3072 sc1
    s_nop 3
    buffer_load_dwordx4 v[104:107], v6, s[4:7], s27 offen offset:2048 sc1
    s_nop 3
    buffer_load_dwordx4 v[100:103], v6, s[4:7], s27 offen offset:1024 sc1
    s_nop 3
    buffer_load_dwordx4 v[96:99], v6, s[4:7], s27 offen offset:0 sc1
L_cf_w3_loop:
    s_and_b32 s33, s26, 3
    s_add_u32 s28, s27, 262144
    s_lshl_b32 s34, s33, 16
    s_add_u32 s29, s42, s34
    v_add_u32 v30, 1, v30
    s_waitcnt vmcnt(3)
    v_smfmac_f32_16x16x64_bf16 v[58:61], v[108:111], a[144:151], v5
    v_min3_i32 v36, v108, v109, v110
    v_smfmac_f32_16x16x64_bf16 v[62:65], v[108:111], a[152:159], v5
    v_min_i32 v36, v36, v111
    v_smfmac_f32_16x16x64_bf16 v[66:69], v[108:111], a[160:167], v5
    v_cmp_eq_u32 vcc, s43, v36
    v_smfmac_f32_16x16x64_bf16 v[70:73], v[108:111], a[168:175], v5
    s_cbranch_vccnz L_cf_w3_din0
    s_waitcnt vmcnt(2)
    v_smfmac_f32_16x16x64_bf16 v[58:61], v[104:107], a[96:103], v5
    v_min3_i32 v36, v104, v105, v106
    v_smfmac_f32_16x16x64_bf16 v[62:65], v[104:107], a[104:111], v5
    v_min_i32 v36, v36, v107
    v_smfmac_f32_16x16x64_bf16 v[66:69], v[104:107], a[112:119], v5
    v_cmp_eq_u32 vcc, s43, v36
    v_smfmac_f32_16x16x64_bf16 v[70:73], v[104:107], a[120:127], v5
    s_cbranch_vccnz L_cf_w3_din1
    s_waitcnt vmcnt(1)
    v_smfmac_f32_16x16x64_bf16 v[58:61], v[100:103], a[48:55], v5
    v_min3_i32 v36, v100, v101, v102
    v_smfmac_f32_16x16x64_bf16 v[62:65], v[100:103], a[56:63], v5
    v_min_i32 v36, v36, v103
    v_smfmac_f32_16x16x64_bf16 v[66:69], v[100:103], a[64:71], v5
    v_cmp_eq_u32 vcc, s43, v36
    v_smfmac_f32_16x16x64_bf16 v[70:73], v[100:103], a[72:79], v5
    s_cbranch_vccnz L_cf_w3_din2
    s_waitcnt vmcnt(0)
    v_smfmac_f32_16x16x64_bf16 v[58:61], v[96:99], a[0:7], v5
    v_min3_i32 v36, v96, v97, v98
    v_smfmac_f32_16x16x64_bf16 v[62:65], v[96:99], a[8:15], v5
    v_min_i32 v36, v36, v99
    v_smfmac_f32_16x16x64_bf16 v[66:69], v[96:99], a[16:23], v5
    v_cmp_eq_u32 vcc, s43, v36
    v_smfmac_f32_16x16x64_bf16 v[70:73], v[96:99], a[24:31], v5
    s_cbranch_vccnz L_cf_w3_din3
L_cf_w3_ddone:
    s_nop 0
    v_pk_add_f32 v[86:87], v[58:59], v[60:61]
    ds_write2_b32 v7, v86, v87 offset0:0 offset1:36
    v_pk_add_f32 v[88:89], v[62:63], v[64:65]
    ds_write2_b32 v7, v88, v89 offset0:16 offset1:52
    v_pk_add_f32 v[90:91], v[66:67], v[68:69]
    ds_write2_b32 v8, v90, v91 offset0:0 offset1:36
    v_pk_add_f32 v[92:93], v[70:71], v[72:73]
    ds_write2_b32 v8, v92, v93 offset0:16 offset1:52
    v_smfmac_f32_16x16x64_bf16 v[74:77], v[96:99], a[32:39], v5
    v_smfmac_f32_16x16x64_bf16 v[78:81], v[96:99], a[40:47], v5
    v_smfmac_f32_16x16x64_bf16 v[74:77], v[100:103], a[80:87], v5
    v_smfmac_f32_16x16x64_bf16 v[78:81], v[100:103], a[88:95], v5
    s_waitcnt lgkmcnt(0)
    s_barrier
    v_smfmac_f32_16x16x64_bf16 v[74:77], v[104:107], a[128:135], v5
    v_smfmac_f32_16x16x64_bf16 v[78:81], v[104:107], a[136:143], v5
    v_smfmac_f32_16x16x64_bf16 v[74:77], v[108:111], a[176:183], v5
    v_smfmac_f32_16x16x64_bf16 v[78:81], v[108:111], a[184:191], v5
    s_nop 7
    v_pk_add_f32 v[86:87], v[74:75], v[76:77]
    v_pk_add_f32 v[88:89], v[78:79], v[80:81]
    ds_write_b128 v10, v[86:89] offset:14336
    s_waitcnt lgkmcnt(0)
    s_barrier
    s_cmp_eq_u32 s26, 63
    s_cbranch_scc1 L_cf_w3_done
    s_lshr_b32 s34, s26, 3
    s_lshr_b32 s34, s19, s34
    s_and_b32 s34, s34, 1
    s_lshl_b32 s34, s34, 13
    s_lshl_b32 s30, s26, 18
    s_add_u32 s30, s30, s34
    s_add_u32 s30, s30, 134217728
    s_mov_b32 m0, 32768
    v_mov_b32 v82, 0
    v_mov_b32 v83, 0
    v_mov_b32 v84, 0
    v_mov_b32 v85, 0
    s_xor_b32 s37, s27, 0x8000
    s_xor_b32 s38, s29, 0x20000
    s_barrier
    buffer_load_dwordx4 v6, s[4:7], s28 offen offset:3072 sc1 lds
    s_nop 3
    buffer_load_dwordx4 v6, s[4:7], s28 offen offset:2048 sc1 lds
    s_nop 3
    buffer_load_dwordx4 v6, s[4:7], s28 offen offset:1024 sc1 lds
    s_nop 3
    buffer_load_dwordx4 v6, s[4:7], s28 offen offset:0 sc1 lds
    s_add_u32 s26, s26, 1
    s_and_b32 s35, s26, 3
    s_lshl_b32 s35, s35, 14
    s_add_u32 s27, s41, s35
    v_mov_b32 v58, 0
    v_mov_b32 v59, 0
    v_mov_b32 v60, 0
    v_mov_b32 v61, 0
    v_mov_b32 v62, 0
    v_mov_b32 v63, 0
    v_mov_b32 v64, 0
    v_mov_b32 v65, 0
    v_mov_b32 v66, 0
    v_mov_b32 v67, 0
    v_mov_b32 v68, 0
    v_mov_b32 v69, 0
    v_mov_b32 v70, 0
    v_mov_b32 v71, 0
    v_mov_b32 v72, 0
    v_mov_b32 v73, 0
    v_mov_b32 v74, 0
    v_mov_b32 v75, 0
    v_mov_b32 v76, 0
    v_mov_b32 v77, 0
    v_mov_b32 v78, 0
    v_mov_b32 v79, 0
    v_mov_b32 v80, 0
    v_mov_b32 v81, 0
L_cf_w3_bwait:
    s_waitcnt vmcnt(3)
    s_barrier
    ds_read_b128 v[116:119], v2 offset:20480
    ds_read_b128 v[136:139], v2 offset:25600
    ds_read_b128 v[156:159], v2 offset:30720
    ds_read_b128 v[176:179], v2 offset:35840
    s_waitcnt lgkmcnt(3)
    v_smfmac_f32_16x16x64_bf16 v[82:85], v[116:119], a[192:199], v5
    s_waitcnt vmcnt(2)
    s_barrier
    ds_read_b128 v[120:123], v2 offset:21504
    ds_read_b128 v[132:135], v2 offset:24576
    ds_read_b128 v[160:163], v2 offset:31744
    ds_read_b128 v[172:175], v2 offset:34816
    s_waitcnt lgkmcnt(6)
    v_smfmac_f32_16x16x64_bf16 v[82:85], v[136:139], a[232:239], v5
    s_waitcnt lgkmcnt(5)
    v_smfmac_f32_16x16x64_bf16 v[82:85], v[156:159], v[196:203], v5
    s_waitcnt lgkmcnt(4)
    v_smfmac_f32_16x16x64_bf16 v[82:85], v[176:179], v[236:243], v5
    s_waitcnt lgkmcnt(3)
    v_smfmac_f32_16x16x64_bf16 v[82:85], v[120:123], a[200:207], v5
    s_waitcnt vmcnt(1)
    s_barrier
    ds_read_b128 v[124:127], v2 offset:22528
    ds_read_b128 v[144:147], v2 offset:27648
    ds_read_b128 v[148:151], v2 offset:28672
    ds_read_b128 v[168:171], v2 offset:33792
    s_waitcnt lgkmcnt(6)
    v_smfmac_f32_16x16x64_bf16 v[82:85], v[132:135], a[224:231], v5
    s_waitcnt lgkmcnt(5)
    v_smfmac_f32_16x16x64_bf16 v[82:85], v[160:163], v[204:211], v5
    s_waitcnt lgkmcnt(4)
    v_smfmac_f32_16x16x64_bf16 v[82:85], v[172:175], v[228:235], v5
    s_waitcnt lgkmcnt(3)
    v_smfmac_f32_16x16x64_bf16 v[82:85], v[124:127], a[208:215], v5
    s_waitcnt vmcnt(0)
    s_barrier
    ds_read_b128 v[128:131], v2 offset:23552
    ds_read_b128 v[140:143], v2 offset:26624
    ds_read_b128 v[152:155], v2 offset:29696
    ds_read_b128 v[164:167], v2 offset:32768
    s_waitcnt lgkmcnt(6)
    v_smfmac_f32_16x16x64_bf16 v[82:85], v[144:147], a[248:255], v5
    s_waitcnt lgkmcnt(5)
    v_smfmac_f32_16x16x64_bf16 v[82:85], v[148:151], v[180:187], v5
    s_waitcnt lgkmcnt(4)
    v_smfmac_f32_16x16x64_bf16 v[82:85], v[168:171], v[220:227], v5
    s_waitcnt lgkmcnt(3)
    v_smfmac_f32_16x16x64_bf16 v[82:85], v[128:131], a[216:223], v5
    s_waitcnt lgkmcnt(2)
    v_smfmac_f32_16x16x64_bf16 v[82:85], v[140:143], a[240:247], v5
    s_waitcnt lgkmcnt(1)
    v_smfmac_f32_16x16x64_bf16 v[82:85], v[152:155], v[188:195], v5
    s_waitcnt lgkmcnt(0)
    v_smfmac_f32_16x16x64_bf16 v[82:85], v[164:167], v[212:219], v5
    s_nop 7
    v_pk_add_f32 v[86:87], v[82:83], v[84:85]
    v_cmpx_o_f32 vcc, v86, v87
    buffer_store_dwordx2 v[86:87], v15, s[4:7], s30 offen sc1
    s_cmp_eq_u64 exec, -1
    s_cbranch_scc0 L_cf_w3_bslow
L_cf_w3_bgood:
    ds_write_b64 v3, v[86:87] offset:18944
    s_add_u32 s34, s37, 262144
    buffer_store_dwordx4 v[54:57], v21, s[4:7], s37 offen
    buffer_store_dwordx4 v[50:53], v21, s[4:7], s34 offen
    buffer_store_dwordx4 v[50:53], v22, s[4:7], s38 offen
    buffer_store_dwordx4 v[50:53], v23, s[4:7], s38 offen offset:1024
    s_waitcnt lgkmcnt(0)
    s_barrier
    s_nop 15
    s_nop 15
    s_nop 15
    s_nop 15
    s_nop 15
    s_nop 15
    s_nop 8
    buffer_store_dword v30, v25, s[4:7], s45 offen offset:2048
    s_barrier
    buffer_load_dwordx4 v[108:111], v6, s[4:7], s27 offen offset:3072 sc1
    s_nop 3
    buffer_load_dwordx4 v[104:107], v6, s[4:7], s27 offen offset:2048 sc1
    s_nop 3
    buffer_load_dwordx4 v[100:103], v6, s[4:7], s27 offen offset:1024 sc1
    s_nop 3
    buffer_load_dwordx4 v[96:99], v6, s[4:7], s27 offen offset:0 sc1
    s_branch L_cf_w3_loop
L_cf_w3_din0:
    s_mov_b64 s[58:59], -1
    s_mov_b64 s[56:57], -1
    s_mov_b64 s[54:55], -1
    s_branch L_cf_w3_dre0
L_cf_w3_din1:
    buffer_load_dword v38, v31, s[4:7], 0 offen
    s_mov_b64 s[60:61], 0
    s_mov_b64 s[56:57], -1
    s_mov_b64 s[54:55], -1
    s_branch L_cf_w3_dre1
L_cf_w3_din2:
    buffer_load_dword v38, v31, s[4:7], 0 offen
    buffer_load_dword v38, v31, s[4:7], 0 offen
    s_mov_b64 s[60:61], 0
    s_mov_b64 s[58:59], 0
    s_mov_b64 s[54:55], -1
    s_branch L_cf_w3_dre2
L_cf_w3_din3:
    buffer_load_dword v38, v31, s[4:7], 0 offen
    buffer_load_dword v38, v31, s[4:7], 0 offen
    buffer_load_dword v38, v31, s[4:7], 0 offen
    s_mov_b64 s[60:61], 0
    s_mov_b64 s[58:59], 0
    s_mov_b64 s[56:57], 0
    s_branch L_cf_w3_dre3
L_cf_w3_dloop:
    s_cmp_eq_u64 s[60:61], 0
    s_cbranch_scc1 L_cf_w3_dsk0
    s_waitcnt vmcnt(3)
    v_cndmask_b32 v112, 0, v108, s[60:61]
    v_cndmask_b32 v113, 0, v109, s[60:61]
    v_cndmask_b32 v114, 0, v110, s[60:61]
    v_cndmask_b32 v115, 0, v111, s[60:61]
    s_or_b64 s[62:63], s[58:59], s[56:57]
    s_or_b64 s[62:63], s[62:63], s[54:55]
    v_smfmac_f32_16x16x64_bf16 v[58:61], v[112:115], a[144:151], v5
    v_min3_i32 v36, v112, v113, v114
    v_smfmac_f32_16x16x64_bf16 v[62:65], v[112:115], a[152:159], v5
    v_min_i32 v36, v36, v115
    v_smfmac_f32_16x16x64_bf16 v[66:69], v[112:115], a[160:167], v5
    v_cmp_eq_u32 vcc, s43, v36
    v_smfmac_f32_16x16x64_bf16 v[70:73], v[112:115], a[168:175], v5
    s_or_b64 s[62:63], s[62:63], vcc
    s_cbranch_scc0 L_cf_w3_ddone
    s_cbranch_vccz L_cf_w3_dok0
L_cf_w3_dre0:
    s_mov_b64 exec, vcc
    buffer_load_dwordx4 v[108:111], v6, s[4:7], s27 offen offset:3072 sc1
    s_mov_b64 exec, -1
    s_mov_b64 s[60:61], vcc
    s_branch L_cf_w3_dnx0
L_cf_w3_dok0:
    s_mov_b64 s[60:61], 0
L_cf_w3_dsk0:
    buffer_load_dword v38, v31, s[4:7], 0 offen
L_cf_w3_dnx0:
    s_cmp_eq_u64 s[58:59], 0
    s_cbranch_scc1 L_cf_w3_dsk1
    s_waitcnt vmcnt(3)
    v_cndmask_b32 v112, 0, v104, s[58:59]
    v_cndmask_b32 v113, 0, v105, s[58:59]
    v_cndmask_b32 v114, 0, v106, s[58:59]
    v_cndmask_b32 v115, 0, v107, s[58:59]
    s_or_b64 s[62:63], s[60:61], s[56:57]
    s_or_b64 s[62:63], s[62:63], s[54:55]
    v_smfmac_f32_16x16x64_bf16 v[58:61], v[112:115], a[96:103], v5
    v_min3_i32 v36, v112, v113, v114
    v_smfmac_f32_16x16x64_bf16 v[62:65], v[112:115], a[104:111], v5
    v_min_i32 v36, v36, v115
    v_smfmac_f32_16x16x64_bf16 v[66:69], v[112:115], a[112:119], v5
    v_cmp_eq_u32 vcc, s43, v36
    v_smfmac_f32_16x16x64_bf16 v[70:73], v[112:115], a[120:127], v5
    s_or_b64 s[62:63], s[62:63], vcc
    s_cbranch_scc0 L_cf_w3_ddone
    s_cbranch_vccz L_cf_w3_dok1
L_cf_w3_dre1:
    s_mov_b64 exec, vcc
    buffer_load_dwordx4 v[104:107], v6, s[4:7], s27 offen offset:2048 sc1
    s_mov_b64 exec, -1
    s_mov_b64 s[58:59], vcc
    s_branch L_cf_w3_dnx1
L_cf_w3_dok1:
    s_mov_b64 s[58:59], 0
L_cf_w3_dsk1:
    buffer_load_dword v38, v31, s[4:7], 0 offen
L_cf_w3_dnx1:
    s_cmp_eq_u64 s[56:57], 0
    s_cbranch_scc1 L_cf_w3_dsk2
    s_waitcnt vmcnt(3)
    v_cndmask_b32 v112, 0, v100, s[56:57]
    v_cndmask_b32 v113, 0, v101, s[56:57]
    v_cndmask_b32 v114, 0, v102, s[56:57]
    v_cndmask_b32 v115, 0, v103, s[56:57]
    s_or_b64 s[62:63], s[60:61], s[58:59]
    s_or_b64 s[62:63], s[62:63], s[54:55]
    v_smfmac_f32_16x16x64_bf16 v[58:61], v[112:115], a[48:55], v5
    v_min3_i32 v36, v112, v113, v114
    v_smfmac_f32_16x16x64_bf16 v[62:65], v[112:115], a[56:63], v5
    v_min_i32 v36, v36, v115
    v_smfmac_f32_16x16x64_bf16 v[66:69], v[112:115], a[64:71], v5
    v_cmp_eq_u32 vcc, s43, v36
    v_smfmac_f32_16x16x64_bf16 v[70:73], v[112:115], a[72:79], v5
    s_or_b64 s[62:63], s[62:63], vcc
    s_cbranch_scc0 L_cf_w3_ddone
    s_cbranch_vccz L_cf_w3_dok2
L_cf_w3_dre2:
    s_mov_b64 exec, vcc
    buffer_load_dwordx4 v[100:103], v6, s[4:7], s27 offen offset:1024 sc1
    s_mov_b64 exec, -1
    s_mov_b64 s[56:57], vcc
    s_branch L_cf_w3_dnx2
L_cf_w3_dok2:
    s_mov_b64 s[56:57], 0
L_cf_w3_dsk2:
    buffer_load_dword v38, v31, s[4:7], 0 offen
L_cf_w3_dnx2:
    s_cmp_eq_u64 s[54:55], 0
    s_cbranch_scc1 L_cf_w3_dsk3
    s_waitcnt vmcnt(3)
    v_cndmask_b32 v112, 0, v96, s[54:55]
    v_cndmask_b32 v113, 0, v97, s[54:55]
    v_cndmask_b32 v114, 0, v98, s[54:55]
    v_cndmask_b32 v115, 0, v99, s[54:55]
    s_or_b64 s[62:63], s[60:61], s[58:59]
    s_or_b64 s[62:63], s[62:63], s[56:57]
    v_smfmac_f32_16x16x64_bf16 v[58:61], v[112:115], a[0:7], v5
    v_min3_i32 v36, v112, v113, v114
    v_smfmac_f32_16x16x64_bf16 v[62:65], v[112:115], a[8:15], v5
    v_min_i32 v36, v36, v115
    v_smfmac_f32_16x16x64_bf16 v[66:69], v[112:115], a[16:23], v5
    v_cmp_eq_u32 vcc, s43, v36
    v_smfmac_f32_16x16x64_bf16 v[70:73], v[112:115], a[24:31], v5
    s_or_b64 s[62:63], s[62:63], vcc
    s_cbranch_scc0 L_cf_w3_ddone
    s_cbranch_vccz L_cf_w3_dok3
L_cf_w3_dre3:
    s_mov_b64 exec, vcc
    buffer_load_dwordx4 v[96:99], v6, s[4:7], s27 offen offset:0 sc1
    s_mov_b64 exec, -1
    s_mov_b64 s[54:55], vcc
    s_branch L_cf_w3_dnx3
L_cf_w3_dok3:
    s_mov_b64 s[54:55], 0
L_cf_w3_dsk3:
    buffer_load_dword v38, v31, s[4:7], 0 offen
L_cf_w3_dnx3:
    s_add_u32 s36, s36, 1
    s_cmp_lt_u32 s36, 400000
    s_cbranch_scc1 L_cf_w3_dloop
    s_branch L_done
L_cf_w3_bslow:
    s_mov_b64 exec, -1
    v_max_u32 v36, v116, v117
    v_max3_u32 v36, v36, v118, v119
    v_max3_u32 v36, v36, v120, v121
    v_max3_u32 v36, v36, v122, v123
    v_max3_u32 v36, v36, v124, v125
    v_max3_u32 v36, v36, v126, v127
    v_max3_u32 v36, v36, v128, v129
    v_max3_u32 v36, v36, v130, v131
    v_max3_u32 v36, v36, v132, v133
    v_max3_u32 v36, v36, v134, v135
    v_max3_u32 v36, v36, v136, v137
    v_max3_u32 v36, v36, v138, v139
    v_max3_u32 v36, v36, v140, v141
    v_max3_u32 v36, v36, v142, v143
    v_max3_u32 v36, v36, v144, v145
    v_max3_u32 v36, v36, v146, v147
    v_max3_u32 v36, v36, v148, v149
    v_max3_u32 v36, v36, v150, v151
    v_max3_u32 v36, v36, v152, v153
    v_max3_u32 v36, v36, v154, v155
    v_max3_u32 v36, v36, v156, v157
    v_max3_u32 v36, v36, v158, v159
    v_max3_u32 v36, v36, v160, v161
    v_max3_u32 v36, v36, v162, v163
    v_max3_u32 v36, v36, v164, v165
    v_max3_u32 v36, v36, v166, v167
    v_max3_u32 v36, v36, v168, v169
    v_max3_u32 v36, v36, v170, v171
    v_max3_u32 v36, v36, v172, v173
    v_max3_u32 v36, v36, v174, v175
    v_max3_u32 v36, v36, v176, v177
    v_max3_u32 v36, v36, v178, v179
    v_cmp_eq_u32 vcc, -1, v36
    s_cbranch_vccnz L_cf_w3_bagain
    buffer_store_dwordx2 v[86:87], v15, s[4:7], s30 offen sc1
    s_branch L_cf_w3_bgood
L_cf_w3_bagain:
    v_mov_b32 v82, 0
    v_mov_b32 v83, 0
    v_mov_b32 v84, 0
    v_mov_b32 v85, 0
    s_add_u32 s36, s36, 1
    s_cmp_gt_u32 s36, 400000
    s_cbranch_scc1 L_done
    s_waitcnt lgkmcnt(0)
    s_barrier
    buffer_load_dwordx4 v6, s[4:7], s28 offen offset:3072 sc1 lds
    s_nop 3
    buffer_load_dwordx4 v6, s[4:7], s28 offen offset:2048 sc1 lds
    s_nop 3
    buffer_load_dwordx4 v6, s[4:7], s28 offen offset:1024 sc1 lds
    s_nop 3
    buffer_load_dwordx4 v6, s[4:7], s28 offen offset:0 sc1 lds
    s_branch L_cf_w3_bwait
L_cf_w3_done:
    s_branch L_done
L_done:
L_exit:
    s_endpgm
L_role_K:
    v_and_b32 v1, 63, v0
    v_lshlrev_b32 v2, 4, v1
    v_bfrev_b32 v7, 1
    s_mov_b32 s40, 0
    v_and_b32 v5, 0x13, v1
    v_bfe_u32 v3, v1, 2, 1
    v_lshl_add_u32 v5, v3, 3, v5
    v_bfe_u32 v3, v1, 3, 1
    v_lshl_add_u32 v5, v3, 2, v5
    v_lshrrev_b32 v4, 5, v1
    v_lshlrev_b32 v3, 9, v4
    v_lshl_add_u32 v6, v5, 4, v3
    v_and_b32 v3, 31, v1
    v_mul_u32_u24 v3, 2064, v3
    v_lshl_add_u32 v10, v4, 4, v3
    v_add_u32 v11, 66048, v10
    s_lshl_b32 s33, s17, 7
    s_add_u32 s33, s33, 3735552
    s_lshl_b32 s34, s18, 2
    s_add_u32 s33, s33, s34
    v_mov_b32 v3, s33
    v_cmp_eq_u32 vcc, 0, v1
    v_mov_b32 v9, 0
    s_nop 0
    v_cndmask_b32 v8, v7, v3, vcc
    buffer_store_dword v9, v8, s[4:7], 0 offen sc1
    s_waitcnt vmcnt(0)
    s_barrier
    s_cmp_lg_u32 s18, 0
    s_cbranch_scc1 L_sig_6
    v_mov_b32 v3, s22
    v_mov_b32 v4, 1
    s_mov_b64 exec, 1
    buffer_atomic_add v4, v3, s[12:15], 0 offen sc1
    s_mov_b64 exec, -1
L_sig_6:
    s_load_dwordx2 s[8:9], s[0:1], 24
    s_mov_b32 s10, 8388608
    s_mov_b32 s11, 0x20000
    v_lshrrev_b32 v80, 2, v1
    v_lshlrev_b32 v80, 13, v80
    v_and_b32 v3, 3, v1
    v_lshl_add_u32 v80, v3, 4, v80
    s_lshl_b32 s33, s17, 8
    s_lshl_b32 s34, s18, 6
    s_add_u32 s33, s33, s34
    v_bfe_u32 v81, v1, 2, 2
    v_lshrrev_b32 v3, 5, v1
    v_lshl_add_u32 v81, v3, 3, v81
    v_lshlrev_b32 v81, 6, v81
    v_bfe_u32 v3, v1, 4, 1
    v_lshl_add_u32 v81, v3, 5, v81
    v_and_b32 v3, 1, v1
    v_lshl_add_u32 v81, v3, 4, v81
    v_bfe_u32 v3, v1, 1, 1
    v_lshl_add_u32 v81, v3, 3, v81
    s_lshl_b32 s35, s18, 15
    v_add_u32 v81, s35, v81
    s_waitcnt lgkmcnt(0)
    s_add_u32 s34, s35, 0
    s_mov_b32 m0, s34
    s_add_u32 s34, s34, 1024
    buffer_load_dwordx4 v80, s[8:11], s33 offen lds
    s_add_u32 s33, s33, 131072
    s_mov_b32 m0, s34
    s_add_u32 s34, s34, 1024
    buffer_load_dwordx4 v80, s[8:11], s33 offen lds
    s_add_u32 s33, s33, 131072
    s_mov_b32 m0, s34
    s_add_u32 s34, s34, 1024
    buffer_load_dwordx4 v80, s[8:11], s33 offen lds
    s_add_u32 s33, s33, 131072
    s_mov_b32 m0, s34
    s_add_u32 s34, s34, 1024
    buffer_load_dwordx4 v80, s[8:11], s33 offen lds
    s_add_u32 s33, s33, 131072
    s_mov_b32 m0, s34
    s_add_u32 s34, s34, 1024
    buffer_load_dwordx4 v80, s[8:11], s33 offen lds
    s_add_u32 s33, s33, 131072
    s_mov_b32 m0, s34
    s_add_u32 s34, s34, 1024
    buffer_load_dwordx4 v80, s[8:11], s33 offen lds
    s_add_u32 s33, s33, 131072
    s_mov_b32 m0, s34
    s_add_u32 s34, s34, 1024
    buffer_load_dwordx4 v80, s[8:11], s33 offen lds
    s_add_u32 s33, s33, 131072
    s_mov_b32 m0, s34
    s_add_u32 s34, s34, 1024
    buffer_load_dwordx4 v80, s[8:11], s33 offen lds
    s_add_u32 s33, s33, 131072
    s_mov_b32 m0, s34
    s_add_u32 s34, s34, 1024
    buffer_load_dwordx4 v80, s[8:11], s33 offen lds
    s_add_u32 s33, s33, 131072
    s_mov_b32 m0, s34
    s_add_u32 s34, s34, 1024
    buffer_load_dwordx4 v80, s[8:11], s33 offen lds
    s_add_u32 s33, s33, 131072
    s_mov_b32 m0, s34
    s_add_u32 s34, s34, 1024
    buffer_load_dwordx4 v80, s[8:11], s33 offen lds
    s_add_u32 s33, s33, 131072
    s_mov_b32 m0, s34
    s_add_u32 s34, s34, 1024
    buffer_load_dwordx4 v80, s[8:11], s33 offen lds
    s_add_u32 s33, s33, 131072
    s_mov_b32 m0, s34
    s_add_u32 s34, s34, 1024
    buffer_load_dwordx4 v80, s[8:11], s33 offen lds
    s_add_u32 s33, s33, 131072
    s_mov_b32 m0, s34
    s_add_u32 s34, s34, 1024
    buffer_load_dwordx4 v80, s[8:11], s33 offen lds
    s_add_u32 s33, s33, 131072
    s_mov_b32 m0, s34
    s_add_u32 s34, s34, 1024
    buffer_load_dwordx4 v80, s[8:11], s33 offen lds
    s_add_u32 s33, s33, 131072
    s_mov_b32 m0, s34
    s_add_u32 s34, s34, 1024
    buffer_load_dwordx4 v80, s[8:11], s33 offen lds
    s_add_u32 s33, s33, 131072
    s_add_u32 s34, s35, 16384
    s_mov_b32 m0, s34
    s_add_u32 s34, s34, 1024
    buffer_load_dwordx4 v80, s[8:11], s33 offen lds
    s_add_u32 s33, s33, 131072
    s_mov_b32 m0, s34
    s_add_u32 s34, s34, 1024
    buffer_load_dwordx4 v80, s[8:11], s33 offen lds
    s_add_u32 s33, s33, 131072
    s_mov_b32 m0, s34
    s_add_u32 s34, s34, 1024
    buffer_load_dwordx4 v80, s[8:11], s33 offen lds
    s_add_u32 s33, s33, 131072
    s_mov_b32 m0, s34
    s_add_u32 s34, s34, 1024
    buffer_load_dwordx4 v80, s[8:11], s33 offen lds
    s_add_u32 s33, s33, 131072
    s_mov_b32 m0, s34
    s_add_u32 s34, s34, 1024
    buffer_load_dwordx4 v80, s[8:11], s33 offen lds
    s_add_u32 s33, s33, 131072
    s_mov_b32 m0, s34
    s_add_u32 s34, s34, 1024
    buffer_load_dwordx4 v80, s[8:11], s33 offen lds
    s_add_u32 s33, s33, 131072
    s_mov_b32 m0, s34
    s_add_u32 s34, s34, 1024
    buffer_load_dwordx4 v80, s[8:11], s33 offen lds
    s_add_u32 s33, s33, 131072
    s_mov_b32 m0, s34
    s_add_u32 s34, s34, 1024
    buffer_load_dwordx4 v80, s[8:11], s33 offen lds
    s_add_u32 s33, s33, 131072
    s_mov_b32 m0, s34
    s_add_u32 s34, s34, 1024
    buffer_load_dwordx4 v80, s[8:11], s33 offen lds
    s_add_u32 s33, s33, 131072
    s_mov_b32 m0, s34
    s_add_u32 s34, s34, 1024
    buffer_load_dwordx4 v80, s[8:11], s33 offen lds
    s_add_u32 s33, s33, 131072
    s_mov_b32 m0, s34
    s_add_u32 s34, s34, 1024
    buffer_load_dwordx4 v80, s[8:11], s33 offen lds
    s_add_u32 s33, s33, 131072
    s_mov_b32 m0, s34
    s_add_u32 s34, s34, 1024
    buffer_load_dwordx4 v80, s[8:11], s33 offen lds
    s_add_u32 s33, s33, 131072
    s_mov_b32 m0, s34
    s_add_u32 s34, s34, 1024
    buffer_load_dwordx4 v80, s[8:11], s33 offen lds
    s_add_u32 s33, s33, 131072
    s_mov_b32 m0, s34
    s_add_u32 s34, s34, 1024
    buffer_load_dwordx4 v80, s[8:11], s33 offen lds
    s_add_u32 s33, s33, 131072
    s_mov_b32 m0, s34
    s_add_u32 s34, s34, 1024
    buffer_load_dwordx4 v80, s[8:11], s33 offen lds
    s_add_u32 s33, s33, 131072
    s_mov_b32 m0, s34
    s_add_u32 s34, s34, 1024
    buffer_load_dwordx4 v80, s[8:11], s33 offen lds
    s_add_u32 s33, s33, 131072
    s_waitcnt vmcnt(16)
    ds_read_b64_tr_b16 a[0:1], v81 offset:0
    ds_read_b64_tr_b16 a[2:3], v81 offset:256
    ds_read_b64_tr_b16 a[4:5], v81 offset:1024
    ds_read_b64_tr_b16 a[6:7], v81 offset:1280
    ds_read_b64_tr_b16 a[8:9], v81 offset:2048
    ds_read_b64_tr_b16 a[10:11], v81 offset:2304
    ds_read_b64_tr_b16 a[12:13], v81 offset:3072
    ds_read_b64_tr_b16 a[14:15], v81 offset:3328
    s_waitcnt lgkmcnt(0)
    ds_read_b64_tr_b16 a[16:17], v81 offset:4096
    ds_read_b64_tr_b16 a[18:19], v81 offset:4352
    ds_read_b64_tr_b16 a[20:21], v81 offset:5120
    ds_read_b64_tr_b16 a[22:23], v81 offset:5376
    ds_read_b64_tr_b16 a[24:25], v81 offset:6144
    ds_read_b64_tr_b16 a[26:27], v81 offset:6400
    ds_read_b64_tr_b16 a[28:29], v81 offset:7168
    ds_read_b64_tr_b16 a[30:31], v81 offset:7424
    s_waitcnt lgkmcnt(0)
    ds_read_b64_tr_b16 a[32:33], v81 offset:8192
    ds_read_b64_tr_b16 a[34:35], v81 offset:8448
    ds_read_b64_tr_b16 a[36:37], v81 offset:9216
    ds_read_b64_tr_b16 a[38:39], v81 offset:9472
    ds_read_b64_tr_b16 a[40:41], v81 offset:10240
    ds_read_b64_tr_b16 a[42:43], v81 offset:10496
    ds_read_b64_tr_b16 a[44:45], v81 offset:11264
    ds_read_b64_tr_b16 a[46:47], v81 offset:11520
    s_waitcnt lgkmcnt(0)
    ds_read_b64_tr_b16 a[48:49], v81 offset:12288
    ds_read_b64_tr_b16 a[50:51], v81 offset:12544
    ds_read_b64_tr_b16 a[52:53], v81 offset:13312
    ds_read_b64_tr_b16 a[54:55], v81 offset:13568
    ds_read_b64_tr_b16 a[56:57], v81 offset:14336
    ds_read_b64_tr_b16 a[58:59], v81 offset:14592
    ds_read_b64_tr_b16 a[60:61], v81 offset:15360
    ds_read_b64_tr_b16 a[62:63], v81 offset:15616
    s_waitcnt lgkmcnt(0)
    s_add_u32 s34, s35, 0
    s_mov_b32 m0, s34
    s_add_u32 s34, s34, 1024
    buffer_load_dwordx4 v80, s[8:11], s33 offen lds
    s_add_u32 s33, s33, 131072
    s_mov_b32 m0, s34
    s_add_u32 s34, s34, 1024
    buffer_load_dwordx4 v80, s[8:11], s33 offen lds
    s_add_u32 s33, s33, 131072
    s_mov_b32 m0, s34
    s_add_u32 s34, s34, 1024
    buffer_load_dwordx4 v80, s[8:11], s33 offen lds
    s_add_u32 s33, s33, 131072
    s_mov_b32 m0, s34
    s_add_u32 s34, s34, 1024
    buffer_load_dwordx4 v80, s[8:11], s33 offen lds
    s_add_u32 s33, s33, 131072
    s_mov_b32 m0, s34
    s_add_u32 s34, s34, 1024
    buffer_load_dwordx4 v80, s[8:11], s33 offen lds
    s_add_u32 s33, s33, 131072
    s_mov_b32 m0, s34
    s_add_u32 s34, s34, 1024
    buffer_load_dwordx4 v80, s[8:11], s33 offen lds
    s_add_u32 s33, s33, 131072
    s_mov_b32 m0, s34
    s_add_u32 s34, s34, 1024
    buffer_load_dwordx4 v80, s[8:11], s33 offen lds
    s_add_u32 s33, s33, 131072
    s_mov_b32 m0, s34
    s_add_u32 s34, s34, 1024
    buffer_load_dwordx4 v80, s[8:11], s33 offen lds
    s_add_u32 s33, s33, 131072
    s_mov_b32 m0, s34
    s_add_u32 s34, s34, 1024
    buffer_load_dwordx4 v80, s[8:11], s33 offen lds
    s_add_u32 s33, s33, 131072
    s_mov_b32 m0, s34
    s_add_u32 s34, s34, 1024
    buffer_load_dwordx4 v80, s[8:11], s33 offen lds
    s_add_u32 s33, s33, 131072
    s_mov_b32 m0, s34
    s_add_u32 s34, s34, 1024
    buffer_load_dwordx4 v80, s[8:11], s33 offen lds
    s_add_u32 s33, s33, 131072
    s_mov_b32 m0, s34
    s_add_u32 s34, s34, 1024
    buffer_load_dwordx4 v80, s[8:11], s33 offen lds
    s_add_u32 s33, s33, 131072
    s_mov_b32 m0, s34
    s_add_u32 s34, s34, 1024
    buffer_load_dwordx4 v80, s[8:11], s33 offen lds
    s_add_u32 s33, s33, 131072
    s_mov_b32 m0, s34
    s_add_u32 s34, s34, 1024
    buffer_load_dwordx4 v80, s[8:11], s33 offen lds
    s_add_u32 s33, s33, 131072
    s_mov_b32 m0, s34
    s_add_u32 s34, s34, 1024
    buffer_load_dwordx4 v80, s[8:11], s33 offen lds
    s_add_u32 s33, s33, 131072
    s_mov_b32 m0, s34
    s_add_u32 s34, s34, 1024
    buffer_load_dwordx4 v80, s[8:11], s33 offen lds
    s_add_u32 s33, s33, 131072
    s_waitcnt vmcnt(16)
    ds_read_b64_tr_b16 a[64:65], v81 offset:16384
    ds_read_b64_tr_b16 a[66:67], v81 offset:16640
    ds_read_b64_tr_b16 a[68:69], v81 offset:17408
    ds_read_b64_tr_b16 a[70:71], v81 offset:17664
    ds_read_b64_tr_b16 a[72:73], v81 offset:18432
    ds_read_b64_tr_b16 a[74:75], v81 offset:18688
    ds_read_b64_tr_b16 a[76:77], v81 offset:19456
    ds_read_b64_tr_b16 a[78:79], v81 offset:19712
    s_waitcnt lgkmcnt(0)
    ds_read_b64_tr_b16 a[80:81], v81 offset:20480
    ds_read_b64_tr_b16 a[82:83], v81 offset:20736
    ds_read_b64_tr_b16 a[84:85], v81 offset:21504
    ds_read_b64_tr_b16 a[86:87], v81 offset:21760
    ds_read_b64_tr_b16 a[88:89], v81 offset:22528
    ds_read_b64_tr_b16 a[90:91], v81 offset:22784
    ds_read_b64_tr_b16 a[92:93], v81 offset:23552
    ds_read_b64_tr_b16 a[94:95], v81 offset:23808
    s_waitcnt lgkmcnt(0)
    ds_read_b64_tr_b16 a[96:97], v81 offset:24576
    ds_read_b64_tr_b16 a[98:99], v81 offset:24832
    ds_read_b64_tr_b16 a[100:101], v81 offset:25600
    ds_read_b64_tr_b16 a[102:103], v81 offset:25856
    ds_read_b64_tr_b16 a[104:105], v81 offset:26624
    ds_read_b64_tr_b16 a[106:107], v81 offset:26880
    ds_read_b64_tr_b16 a[108:109], v81 offset:27648
    ds_read_b64_tr_b16 a[110:111], v81 offset:27904
    s_waitcnt lgkmcnt(0)
    ds_read_b64_tr_b16 a[112:113], v81 offset:28672
    ds_read_b64_tr_b16 a[114:115], v81 offset:28928
    ds_read_b64_tr_b16 a[116:117], v81 offset:29696
    ds_read_b64_tr_b16 a[118:119], v81 offset:29952
    ds_read_b64_tr_b16 a[120:121], v81 offset:30720
    ds_read_b64_tr_b16 a[122:123], v81 offset:30976
    ds_read_b64_tr_b16 a[124:125], v81 offset:31744
    ds_read_b64_tr_b16 a[126:127], v81 offset:32000
    s_waitcnt lgkmcnt(0)
    s_add_u32 s34, s35, 16384
    s_mov_b32 m0, s34
    s_add_u32 s34, s34, 1024
    buffer_load_dwordx4 v80, s[8:11], s33 offen lds
    s_add_u32 s33, s33, 131072
    s_mov_b32 m0, s34
    s_add_u32 s34, s34, 1024
    buffer_load_dwordx4 v80, s[8:11], s33 offen lds
    s_add_u32 s33, s33, 131072
    s_mov_b32 m0, s34
    s_add_u32 s34, s34, 1024
    buffer_load_dwordx4 v80, s[8:11], s33 offen lds
    s_add_u32 s33, s33, 131072
    s_mov_b32 m0, s34
    s_add_u32 s34, s34, 1024
    buffer_load_dwordx4 v80, s[8:11], s33 offen lds
    s_add_u32 s33, s33, 131072
    s_mov_b32 m0, s34
    s_add_u32 s34, s34, 1024
    buffer_load_dwordx4 v80, s[8:11], s33 offen lds
    s_add_u32 s33, s33, 131072
    s_mov_b32 m0, s34
    s_add_u32 s34, s34, 1024
    buffer_load_dwordx4 v80, s[8:11], s33 offen lds
    s_add_u32 s33, s33, 131072
    s_mov_b32 m0, s34
    s_add_u32 s34, s34, 1024
    buffer_load_dwordx4 v80, s[8:11], s33 offen lds
    s_add_u32 s33, s33, 131072
    s_mov_b32 m0, s34
    s_add_u32 s34, s34, 1024
    buffer_load_dwordx4 v80, s[8:11], s33 offen lds
    s_add_u32 s33, s33, 131072
    s_mov_b32 m0, s34
    s_add_u32 s34, s34, 1024
    buffer_load_dwordx4 v80, s[8:11], s33 offen lds
    s_add_u32 s33, s33, 131072
    s_mov_b32 m0, s34
    s_add_u32 s34, s34, 1024
    buffer_load_dwordx4 v80, s[8:11], s33 offen lds
    s_add_u32 s33, s33, 131072
    s_mov_b32 m0, s34
    s_add_u32 s34, s34, 1024
    buffer_load_dwordx4 v80, s[8:11], s33 offen lds
    s_add_u32 s33, s33, 131072
    s_mov_b32 m0, s34
    s_add_u32 s34, s34, 1024
    buffer_load_dwordx4 v80, s[8:11], s33 offen lds
    s_add_u32 s33, s33, 131072
    s_mov_b32 m0, s34
    s_add_u32 s34, s34, 1024
    buffer_load_dwordx4 v80, s[8:11], s33 offen lds
    s_add_u32 s33, s33, 131072
    s_mov_b32 m0, s34
    s_add_u32 s34, s34, 1024
    buffer_load_dwordx4 v80, s[8:11], s33 offen lds
    s_add_u32 s33, s33, 131072
    s_mov_b32 m0, s34
    s_add_u32 s34, s34, 1024
    buffer_load_dwordx4 v80, s[8:11], s33 offen lds
    s_add_u32 s33, s33, 131072
    s_mov_b32 m0, s34
    s_add_u32 s34, s34, 1024
    buffer_load_dwordx4 v80, s[8:11], s33 offen lds
    s_add_u32 s33, s33, 131072
    s_waitcnt vmcnt(16)
    ds_read_b64_tr_b16 a[128:129], v81 offset:0
    ds_read_b64_tr_b16 a[130:131], v81 offset:256
    ds_read_b64_tr_b16 a[132:133], v81 offset:1024
    ds_read_b64_tr_b16 a[134:135], v81 offset:1280
    ds_read_b64_tr_b16 a[136:137], v81 offset:2048
    ds_read_b64_tr_b16 a[138:139], v81 offset:2304
    ds_read_b64_tr_b16 a[140:141], v81 offset:3072
    ds_read_b64_tr_b16 a[142:143], v81 offset:3328
    s_waitcnt lgkmcnt(0)
    ds_read_b64_tr_b16 a[144:145], v81 offset:4096
    ds_read_b64_tr_b16 a[146:147], v81 offset:4352
    ds_read_b64_tr_b16 a[148:149], v81 offset:5120
    ds_read_b64_tr_b16 a[150:151], v81 offset:5376
    ds_read_b64_tr_b16 a[152:153], v81 offset:6144
    ds_read_b64_tr_b16 a[154:155], v81 offset:6400
    ds_read_b64_tr_b16 a[156:157], v81 offset:7168
    ds_read_b64_tr_b16 a[158:159], v81 offset:7424
    s_waitcnt lgkmcnt(0)
    ds_read_b64_tr_b16 a[160:161], v81 offset:8192
    ds_read_b64_tr_b16 a[162:163], v81 offset:8448
    ds_read_b64_tr_b16 a[164:165], v81 offset:9216
    ds_read_b64_tr_b16 a[166:167], v81 offset:9472
    ds_read_b64_tr_b16 a[168:169], v81 offset:10240
    ds_read_b64_tr_b16 a[170:171], v81 offset:10496
    ds_read_b64_tr_b16 a[172:173], v81 offset:11264
    ds_read_b64_tr_b16 a[174:175], v81 offset:11520
    s_waitcnt lgkmcnt(0)
    ds_read_b64_tr_b16 a[176:177], v81 offset:12288
    ds_read_b64_tr_b16 a[178:179], v81 offset:12544
    ds_read_b64_tr_b16 a[180:181], v81 offset:13312
    ds_read_b64_tr_b16 a[182:183], v81 offset:13568
    ds_read_b64_tr_b16 a[184:185], v81 offset:14336
    ds_read_b64_tr_b16 a[186:187], v81 offset:14592
    ds_read_b64_tr_b16 a[188:189], v81 offset:15360
    ds_read_b64_tr_b16 a[190:191], v81 offset:15616
    s_waitcnt lgkmcnt(0)
    s_waitcnt vmcnt(0)
    ds_read_b64_tr_b16 a[192:193], v81 offset:16384
    ds_read_b64_tr_b16 a[194:195], v81 offset:16640
    ds_read_b64_tr_b16 a[196:197], v81 offset:17408
    ds_read_b64_tr_b16 a[198:199], v81 offset:17664
    ds_read_b64_tr_b16 a[200:201], v81 offset:18432
    ds_read_b64_tr_b16 a[202:203], v81 offset:18688
    ds_read_b64_tr_b16 a[204:205], v81 offset:19456
    ds_read_b64_tr_b16 a[206:207], v81 offset:19712
    s_waitcnt lgkmcnt(0)
    ds_read_b64_tr_b16 a[208:209], v81 offset:20480
    ds_read_b64_tr_b16 a[210:211], v81 offset:20736
    ds_read_b64_tr_b16 a[212:213], v81 offset:21504
    ds_read_b64_tr_b16 a[214:215], v81 offset:21760
    ds_read_b64_tr_b16 a[216:217], v81 offset:22528
    ds_read_b64_tr_b16 a[218:219], v81 offset:22784
    ds_read_b64_tr_b16 a[220:221], v81 offset:23552
    ds_read_b64_tr_b16 a[222:223], v81 offset:23808
    s_waitcnt lgkmcnt(0)
    ds_read_b64_tr_b16 a[224:225], v81 offset:24576
    ds_read_b64_tr_b16 a[226:227], v81 offset:24832
    ds_read_b64_tr_b16 a[228:229], v81 offset:25600
    ds_read_b64_tr_b16 a[230:231], v81 offset:25856
    ds_read_b64_tr_b16 a[232:233], v81 offset:26624
    ds_read_b64_tr_b16 a[234:235], v81 offset:26880
    ds_read_b64_tr_b16 a[236:237], v81 offset:27648
    ds_read_b64_tr_b16 a[238:239], v81 offset:27904
    s_waitcnt lgkmcnt(0)
    ds_read_b64_tr_b16 a[240:241], v81 offset:28672
    ds_read_b64_tr_b16 a[242:243], v81 offset:28928
    ds_read_b64_tr_b16 a[244:245], v81 offset:29696
    ds_read_b64_tr_b16 a[246:247], v81 offset:29952
    ds_read_b64_tr_b16 a[248:249], v81 offset:30720
    ds_read_b64_tr_b16 a[250:251], v81 offset:30976
    ds_read_b64_tr_b16 a[252:253], v81 offset:31744
    ds_read_b64_tr_b16 a[254:255], v81 offset:32000
    s_waitcnt lgkmcnt(0)
    s_barrier
    s_mov_b32 s3, 0
L_rdy_7:
    buffer_load_dwordx2 v[82:83], off, s[12:15], s22 sc1
    s_add_u32 s3, s3, 1
    s_cmp_gt_u32 s3, 400000
    s_cbranch_scc1 L_exit
    s_waitcnt vmcnt(0)
    v_readfirstlane_b32 s24, v82
    v_readfirstlane_b32 s25, v83
    s_and_b32 vcc_lo, s24, 0xffff
    s_cmp_lt_u32 vcc_lo, 256
    s_cbranch_scc1 L_rdy_7
    s_lshr_b32 vcc_lo, s24, 16
    s_cbranch_scc1 L_general
    s_load_dwordx2 s[28:29], s[0:1], 0
    s_mov_b32 s30, 4194304
    s_mov_b32 s31, 0x20000
    s_lshl_b32 s36, s18, 14
    s_mul_i32 s37, s18, 16512
    s_lshl_b32 s33, s17, 2
    s_add_u32 s33, s33, s18
    s_lshl_b32 s38, s33, 11
    s_add_u32 s38, s38, 16777216
    s_waitcnt lgkmcnt(0)
    s_mov_b32 s44, 0
    s_mov_b32 s45, 0
    s_mov_b32 s46, 0
    s_mov_b32 s47, 0
    s_mov_b32 s48, 0
    s_mov_b32 s49, 0
    s_mov_b32 s50, 0
    s_mov_b32 s51, 0
    s_mov_b32 s52, 0
    s_mov_b32 s53, 0
    s_mov_b32 s54, 0
    s_mov_b32 s55, 0
    s_mov_b32 s56, 0
    s_mov_b32 s57, 0
    s_mov_b32 s58, 0
    s_mov_b32 s59, 0
    s_mov_b32 s32, 0
    s_add_u32 m0, s37, 0
    s_add_u32 s35, s36, 0
    buffer_load_dwordx4 v2, s[28:31], s35 offen offset:0 lds
    buffer_load_dwordx4 v2, s[28:31], s35 offen offset:1024 lds
    s_add_u32 m0, s37, 2064
    s_add_u32 s35, s36, 2048
    buffer_load_dwordx4 v2, s[28:31], s35 offen offset:0 lds
    buffer_load_dwordx4 v2, s[28:31], s35 offen offset:1024 lds
    s_add_u32 m0, s37, 4128
    s_add_u32 s35, s36, 4096
    buffer_load_dwordx4 v2, s[28:31], s35 offen offset:0 lds
    buffer_load_dwordx4 v2, s[28:31], s35 offen offset:1024 lds
    s_add_u32 m0, s37, 6192
    s_add_u32 s35, s36, 6144
    buffer_load_dwordx4 v2, s[28:31], s35 offen offset:0 lds
    buffer_load_dwordx4 v2, s[28:31], s35 offen offset:1024 lds
    s_add_u32 m0, s37, 8256
    s_add_u32 s35, s36, 8192
    buffer_load_dwordx4 v2, s[28:31], s35 offen offset:0 lds
    buffer_load_dwordx4 v2, s[28:31], s35 offen offset:1024 lds
    s_add_u32 m0, s37, 10320
    s_add_u32 s35, s36, 10240
    buffer_load_dwordx4 v2, s[28:31], s35 offen offset:0 lds
    buffer_load_dwordx4 v2, s[28:31], s35 offen offset:1024 lds
    s_add_u32 m0, s37, 12384
    s_add_u32 s35, s36, 12288
    buffer_load_dwordx4 v2, s[28:31], s35 offen offset:0 lds
    buffer_load_dwordx4 v2, s[28:31], s35 offen offset:1024 lds
    s_add_u32 m0, s37, 14448
    s_add_u32 s35, s36, 14336
    buffer_load_dwordx4 v2, s[28:31], s35 offen offset:0 lds
    buffer_load_dwordx4 v2, s[28:31], s35 offen offset:1024 lds
    s_waitcnt vmcnt(0)
    s_barrier
    ds_read_b128 v[16:19], v10 offset:0
    ds_read_b128 v[20:23], v10 offset:32
    ds_read_b128 v[24:27], v10 offset:64
    ds_read_b128 v[28:31], v10 offset:96
    ds_read_b128 v[32:35], v10 offset:128
    ds_read_b128 v[36:39], v10 offset:160
    s_add_u32 s38, s38, 1073479680
L_rK_loop:
    s_waitcnt lgkmcnt(5)
    v_mfma_f32_32x32x16_bf16 v[48:63], a[0:3], v[16:19], 0
    ds_read_b128 v[40:43], v10 offset:192
    s_add_u32 s36, s36, 65536
    s_add_u32 m0, s37, 66048
    s_add_u32 s35, s36, 0
    buffer_load_dwordx4 v2, s[28:31], s35 offen offset:0 lds
    s_waitcnt lgkmcnt(5)
    v_mfma_f32_32x32x16_bf16 v[48:63], a[4:7], v[20:23], v[48:63]
    ds_read_b128 v[44:47], v10 offset:224
    s_waitcnt lgkmcnt(5)
    v_mfma_f32_32x32x16_bf16 v[48:63], a[8:11], v[24:27], v[48:63]
    ds_read_b128 v[16:19], v10 offset:256
    buffer_load_dwordx4 v2, s[28:31], s35 offen offset:1024 lds
    s_waitcnt lgkmcnt(5)
    v_mfma_f32_32x32x16_bf16 v[48:63], a[12:15], v[28:31], v[48:63]
    ds_read_b128 v[20:23], v10 offset:288
    s_waitcnt lgkmcnt(5)
    v_mfma_f32_32x32x16_bf16 v[48:63], a[16:19], v[32:35], v[48:63]
    ds_read_b128 v[24:27], v10 offset:320
    s_add_u32 m0, s37, 68112
    s_add_u32 s35, s36, 2048
    buffer_load_dwordx4 v2, s[28:31], s35 offen offset:0 lds
    v_cvt_pk_bf16_f32 v80, v64, v65
    v_cvt_pk_bf16_f32 v81, v66, v67
    s_waitcnt lgkmcnt(5)
    v_mfma_f32_32x32x16_bf16 v[48:63], a[20:23], v[36:39], v[48:63]
    ds_read_b128 v[28:31], v10 offset:352
    v_cvt_pk_bf16_f32 v82, v68, v69
    v_cvt_pk_bf16_f32 v83, v70, v71
    s_waitcnt lgkmcnt(5)
    v_mfma_f32_32x32x16_bf16 v[48:63], a[24:27], v[40:43], v[48:63]
    ds_read_b128 v[32:35], v10 offset:384
    buffer_load_dwordx4 v2, s[28:31], s35 offen offset:1024 lds
    v_cvt_pk_bf16_f32 v84, v72, v73
    v_cvt_pk_bf16_f32 v85, v74, v75
    s_waitcnt lgkmcnt(5)
    v_mfma_f32_32x32x16_bf16 v[48:63], a[28:31], v[44:47], v[48:63]
    ds_read_b128 v[36:39], v10 offset:416
    v_cvt_pk_bf16_f32 v86, v76, v77
    v_cvt_pk_bf16_f32 v87, v78, v79
    s_waitcnt lgkmcnt(5)
    v_mfma_f32_32x32x16_bf16 v[48:63], a[32:35], v[16:19], v[48:63]
    ds_read_b128 v[40:43], v10 offset:448
    s_add_u32 m0, s37, 70176
    s_add_u32 s35, s36, 4096
    buffer_load_dwordx4 v2, s[28:31], s35 offen offset:0 lds
    s_waitcnt lgkmcnt(5)
    v_mfma_f32_32x32x16_bf16 v[48:63], a[36:39], v[20:23], v[48:63]
    ds_read_b128 v[44:47], v10 offset:480
    buffer_store_dwordx4 v[80:83], v2, s[4:7], s38 offen sc1
    s_waitcnt lgkmcnt(5)
    v_mfma_f32_32x32x16_bf16 v[48:63], a[40:43], v[24:27], v[48:63]
    ds_read_b128 v[16:19], v10 offset:512
    buffer_load_dwordx4 v2, s[28:31], s35 offen offset:1024 lds
    s_waitcnt lgkmcnt(5)
    v_mfma_f32_32x32x16_bf16 v[48:63], a[44:47], v[28:31], v[48:63]
    ds_read_b128 v[20:23], v10 offset:544
    buffer_store_dwordx4 v[84:87], v2, s[4:7], s38 offen offset:1024 sc1
    s_add_u32 s38, s38, 0x40000
    s_bitset0_b32 s38, 30
    s_waitcnt lgkmcnt(5)
    v_mfma_f32_32x32x16_bf16 v[48:63], a[48:51], v[32:35], v[48:63]
    ds_read_b128 v[24:27], v10 offset:576
    s_add_u32 m0, s37, 72240
    s_add_u32 s35, s36, 6144
    buffer_load_dwordx4 v2, s[28:31], s35 offen offset:0 lds
    s_waitcnt lgkmcnt(5)
    v_mfma_f32_32x32x16_bf16 v[48:63], a[52:55], v[36:39], v[48:63]
    ds_read_b128 v[28:31], v10 offset:608
    s_waitcnt lgkmcnt(5)
    v_mfma_f32_32x32x16_bf16 v[48:63], a[56:59], v[40:43], v[48:63]
    ds_read_b128 v[32:35], v10 offset:640
    buffer_load_dwordx4 v2, s[28:31], s35 offen offset:1024 lds
    s_waitcnt lgkmcnt(5)
    v_mfma_f32_32x32x16_bf16 v[48:63], a[60:63], v[44:47], v[48:63]
    ds_read_b128 v[36:39], v10 offset:672
    s_waitcnt lgkmcnt(5)
    v_mfma_f32_32x32x16_bf16 v[48:63], a[64:67], v[16:19], v[48:63]
    ds_read_b128 v[40:43], v10 offset:704
    s_add_u32 m0, s37, 74304
    s_add_u32 s35, s36, 8192
    buffer_load_dwordx4 v2, s[28:31], s35 offen offset:0 lds
    s_waitcnt lgkmcnt(5)
    v_mfma_f32_32x32x16_bf16 v[48:63], a[68:71], v[20:23], v[48:63]
    ds_read_b128 v[44:47], v10 offset:736
    s_waitcnt lgkmcnt(5)
    v_mfma_f32_32x32x16_bf16 v[48:63], a[72:75], v[24:27], v[48:63]
    ds_read_b128 v[16:19], v10 offset:768
    buffer_load_dwordx4 v2, s[28:31], s35 offen offset:1024 lds
    s_waitcnt lgkmcnt(5)
    v_mfma_f32_32x32x16_bf16 v[48:63], a[76:79], v[28:31], v[48:63]
    ds_read_b128 v[20:23], v10 offset:800
    s_waitcnt lgkmcnt(5)
    v_mfma_f32_32x32x16_bf16 v[48:63], a[80:83], v[32:35], v[48:63]
    ds_read_b128 v[24:27], v10 offset:832
    s_add_u32 m0, s37, 76368
    s_add_u32 s35, s36, 10240
    buffer_load_dwordx4 v2, s[28:31], s35 offen offset:0 lds
    s_waitcnt lgkmcnt(5)
    v_mfma_f32_32x32x16_bf16 v[48:63], a[84:87], v[36:39], v[48:63]
    ds_read_b128 v[28:31], v10 offset:864
    s_waitcnt lgkmcnt(5)
    v_mfma_f32_32x32x16_bf16 v[48:63], a[88:91], v[40:43], v[48:63]
    ds_read_b128 v[32:35], v10 offset:896
    buffer_load_dwordx4 v2, s[28:31], s35 offen offset:1024 lds
    s_waitcnt lgkmcnt(5)
    v_mfma_f32_32x32x16_bf16 v[48:63], a[92:95], v[44:47], v[48:63]
    ds_read_b128 v[36:39], v10 offset:928
    s_waitcnt lgkmcnt(5)
    v_mfma_f32_32x32x16_bf16 v[48:63], a[96:99], v[16:19], v[48:63]
    ds_read_b128 v[40:43], v10 offset:960
    s_add_u32 m0, s37, 78432
    s_add_u32 s35, s36, 12288
    buffer_load_dwordx4 v2, s[28:31], s35 offen offset:0 lds
    s_waitcnt lgkmcnt(5)
    v_mfma_f32_32x32x16_bf16 v[48:63], a[100:103], v[20:23], v[48:63]
    ds_read_b128 v[44:47], v10 offset:992
    s_waitcnt lgkmcnt(5)
    v_mfma_f32_32x32x16_bf16 v[48:63], a[104:107], v[24:27], v[48:63]
    ds_read_b128 v[16:19], v10 offset:1024
    buffer_load_dwordx4 v2, s[28:31], s35 offen offset:1024 lds
    s_waitcnt lgkmcnt(5)
    v_mfma_f32_32x32x16_bf16 v[48:63], a[108:111], v[28:31], v[48:63]
    ds_read_b128 v[20:23], v10 offset:1056
    s_waitcnt lgkmcnt(5)
    v_mfma_f32_32x32x16_bf16 v[48:63], a[112:115], v[32:35], v[48:63]
    ds_read_b128 v[24:27], v10 offset:1088
    s_add_u32 m0, s37, 80496
    s_add_u32 s35, s36, 14336
    buffer_load_dwordx4 v2, s[28:31], s35 offen offset:0 lds
    s_waitcnt lgkmcnt(5)
    v_mfma_f32_32x32x16_bf16 v[48:63], a[116:119], v[36:39], v[48:63]
    ds_read_b128 v[28:31], v10 offset:1120
    s_waitcnt lgkmcnt(5)
    v_mfma_f32_32x32x16_bf16 v[48:63], a[120:123], v[40:43], v[48:63]
    ds_read_b128 v[32:35], v10 offset:1152
    buffer_load_dwordx4 v2, s[28:31], s35 offen offset:1024 lds
    s_waitcnt lgkmcnt(5)
    v_mfma_f32_32x32x16_bf16 v[48:63], a[124:127], v[44:47], v[48:63]
    ds_read_b128 v[36:39], v10 offset:1184
    s_waitcnt lgkmcnt(5)
    v_mfma_f32_32x32x16_bf16 v[48:63], a[128:131], v[16:19], v[48:63]
    ds_read_b128 v[40:43], v10 offset:1216
    s_waitcnt lgkmcnt(5)
    v_mfma_f32_32x32x16_bf16 v[48:63], a[132:135], v[20:23], v[48:63]
    ds_read_b128 v[44:47], v10 offset:1248
    s_waitcnt lgkmcnt(5)
    v_mfma_f32_32x32x16_bf16 v[48:63], a[136:139], v[24:27], v[48:63]
    ds_read_b128 v[16:19], v10 offset:1280
    s_waitcnt lgkmcnt(5)
    v_mfma_f32_32x32x16_bf16 v[48:63], a[140:143], v[28:31], v[48:63]
    ds_read_b128 v[20:23], v10 offset:1312
    s_waitcnt lgkmcnt(5)
    v_mfma_f32_32x32x16_bf16 v[48:63], a[144:147], v[32:35], v[48:63]
    ds_read_b128 v[24:27], v10 offset:1344
    s_waitcnt lgkmcnt(5)
    v_mfma_f32_32x32x16_bf16 v[48:63], a[148:151], v[36:39], v[48:63]
    ds_read_b128 v[28:31], v10 offset:1376
    v_mov_b32 v9, s32
    s_waitcnt vmcnt(10)
    buffer_store_dword v9, v8, s[4:7], 0 offen sc1
    s_waitcnt lgkmcnt(5)
    v_mfma_f32_32x32x16_bf16 v[48:63], a[152:155], v[40:43], v[48:63]
    ds_read_b128 v[32:35], v10 offset:1408
    s_waitcnt lgkmcnt(5)
    v_mfma_f32_32x32x16_bf16 v[48:63], a[156:159], v[44:47], v[48:63]
    ds_read_b128 v[36:39], v10 offset:1440
    s_waitcnt lgkmcnt(5)
    v_mfma_f32_32x32x16_bf16 v[48:63], a[160:163], v[16:19], v[48:63]
    ds_read_b128 v[40:43], v10 offset:1472
    s_waitcnt lgkmcnt(5)
    v_mfma_f32_32x32x16_bf16 v[48:63], a[164:167], v[20:23], v[48:63]
    ds_read_b128 v[44:47], v10 offset:1504
    s_waitcnt lgkmcnt(5)
    v_mfma_f32_32x32x16_bf16 v[48:63], a[168:171], v[24:27], v[48:63]
    ds_read_b128 v[16:19], v10 offset:1536
    s_waitcnt lgkmcnt(5)
    v_mfma_f32_32x32x16_bf16 v[48:63], a[172:175], v[28:31], v[48:63]
    ds_read_b128 v[20:23], v10 offset:1568
    s_waitcnt lgkmcnt(5)
    v_mfma_f32_32x32x16_bf16 v[48:63], a[176:179], v[32:35], v[48:63]
    ds_read_b128 v[24:27], v10 offset:1600
    s_waitcnt lgkmcnt(5)
    v_mfma_f32_32x32x16_bf16 v[48:63], a[180:183], v[36:39], v[48:63]
    ds_read_b128 v[28:31], v10 offset:1632
    s_waitcnt lgkmcnt(5)
    v_mfma_f32_32x32x16_bf16 v[48:63], a[184:187], v[40:43], v[48:63]
    ds_read_b128 v[32:35], v10 offset:1664
    s_waitcnt lgkmcnt(5)
    v_mfma_f32_32x32x16_bf16 v[48:63], a[188:191], v[44:47], v[48:63]
    ds_read_b128 v[36:39], v10 offset:1696
    s_waitcnt lgkmcnt(5)
    v_mfma_f32_32x32x16_bf16 v[48:63], a[192:195], v[16:19], v[48:63]
    ds_read_b128 v[40:43], v10 offset:1728
    s_waitcnt lgkmcnt(5)
    v_mfma_f32_32x32x16_bf16 v[48:63], a[196:199], v[20:23], v[48:63]
    ds_read_b128 v[44:47], v10 offset:1760
    s_waitcnt lgkmcnt(5)
    v_mfma_f32_32x32x16_bf16 v[48:63], a[200:203], v[24:27], v[48:63]
    ds_read_b128 v[16:19], v10 offset:1792
    s_waitcnt lgkmcnt(5)
    v_mfma_f32_32x32x16_bf16 v[48:63], a[204:207], v[28:31], v[48:63]
    ds_read_b128 v[20:23], v10 offset:1824
    s_waitcnt lgkmcnt(5)
    v_mfma_f32_32x32x16_bf16 v[48:63], a[208:211], v[32:35], v[48:63]
    ds_read_b128 v[24:27], v10 offset:1856
    s_waitcnt lgkmcnt(5)
    v_mfma_f32_32x32x16_bf16 v[48:63], a[212:215], v[36:39], v[48:63]
    ds_read_b128 v[28:31], v10 offset:1888
    s_waitcnt lgkmcnt(5)
    v_mfma_f32_32x32x16_bf16 v[48:63], a[216:219], v[40:43], v[48:63]
    ds_read_b128 v[32:35], v10 offset:1920
    s_waitcnt lgkmcnt(5)
    v_mfma_f32_32x32x16_bf16 v[48:63], a[220:223], v[44:47], v[48:63]
    ds_read_b128 v[36:39], v10 offset:1952
    s_waitcnt lgkmcnt(5)
    v_mfma_f32_32x32x16_bf16 v[48:63], a[224:227], v[16:19], v[48:63]
    ds_read_b128 v[40:43], v10 offset:1984
    s_waitcnt lgkmcnt(5)
    v_mfma_f32_32x32x16_bf16 v[48:63], a[228:231], v[20:23], v[48:63]
    ds_read_b128 v[44:47], v10 offset:2016
    s_add_u32 s32, s32, 1
    s_waitcnt lgkmcnt(5)
    v_mfma_f32_32x32x16_bf16 v[48:63], a[232:235], v[24:27], v[48:63]
    s_waitcnt lgkmcnt(4)
    v_mfma_f32_32x32x16_bf16 v[48:63], a[236:239], v[28:31], v[48:63]
    s_waitcnt lgkmcnt(0)
    s_waitcnt vmcnt(1)
    s_barrier
    ds_read_b128 v[16:19], v11 offset:0
    ds_read_b128 v[20:23], v11 offset:32
    v_mfma_f32_32x32x16_bf16 v[48:63], a[240:243], v[32:35], v[48:63]
    ds_read_b128 v[24:27], v11 offset:64
    ds_read_b128 v[28:31], v11 offset:96
    v_mfma_f32_32x32x16_bf16 v[48:63], a[244:247], v[36:39], v[48:63]
    ds_read_b128 v[32:35], v11 offset:128
    ds_read_b128 v[36:39], v11 offset:160
    v_mfma_f32_32x32x16_bf16 v[48:63], a[248:251], v[40:43], v[48:63]
    v_mfma_f32_32x32x16_bf16 v[48:63], a[252:255], v[44:47], v[48:63]
    s_waitcnt lgkmcnt(5)
    v_mfma_f32_32x32x16_bf16 v[64:79], a[0:3], v[16:19], 0
    ds_read_b128 v[40:43], v11 offset:192
    s_add_u32 s36, s36, 65536
    s_add_u32 m0, s37, 0
    s_add_u32 s35, s36, 0
    buffer_load_dwordx4 v2, s[28:31], s35 offen offset:0 lds
    s_waitcnt lgkmcnt(5)
    v_mfma_f32_32x32x16_bf16 v[64:79], a[4:7], v[20:23], v[64:79]
    ds_read_b128 v[44:47], v11 offset:224
    s_waitcnt lgkmcnt(5)
    v_mfma_f32_32x32x16_bf16 v[64:79], a[8:11], v[24:27], v[64:79]
    ds_read_b128 v[16:19], v11 offset:256
    buffer_load_dwordx4 v2, s[28:31], s35 offen offset:1024 lds
    s_waitcnt lgkmcnt(5)
    v_mfma_f32_32x32x16_bf16 v[64:79], a[12:15], v[28:31], v[64:79]
    ds_read_b128 v[20:23], v11 offset:288
    s_waitcnt lgkmcnt(5)
    v_mfma_f32_32x32x16_bf16 v[64:79], a[16:19], v[32:35], v[64:79]
    ds_read_b128 v[24:27], v11 offset:320
    s_add_u32 m0, s37, 2064
    s_add_u32 s35, s36, 2048
    buffer_load_dwordx4 v2, s[28:31], s35 offen offset:0 lds
    v_cvt_pk_bf16_f32 v80, v48, v49
    v_cvt_pk_bf16_f32 v81, v50, v51
    s_waitcnt lgkmcnt(5)
    v_mfma_f32_32x32x16_bf16 v[64:79], a[20:23], v[36:39], v[64:79]
    ds_read_b128 v[28:31], v11 offset:352
    v_cvt_pk_bf16_f32 v82, v52, v53
    v_cvt_pk_bf16_f32 v83, v54, v55
    s_waitcnt lgkmcnt(5)
    v_mfma_f32_32x32x16_bf16 v[64:79], a[24:27], v[40:43], v[64:79]
    ds_read_b128 v[32:35], v11 offset:384
    buffer_load_dwordx4 v2, s[28:31], s35 offen offset:1024 lds
    v_cvt_pk_bf16_f32 v84, v56, v57
    v_cvt_pk_bf16_f32 v85, v58, v59
    s_waitcnt lgkmcnt(5)
    v_mfma_f32_32x32x16_bf16 v[64:79], a[28:31], v[44:47], v[64:79]
    ds_read_b128 v[36:39], v11 offset:416
    v_cvt_pk_bf16_f32 v86, v60, v61
    v_cvt_pk_bf16_f32 v87, v62, v63
    s_waitcnt lgkmcnt(5)
    v_mfma_f32_32x32x16_bf16 v[64:79], a[32:35], v[16:19], v[64:79]
    ds_read_b128 v[40:43], v11 offset:448
    s_add_u32 m0, s37, 4128
    s_add_u32 s35, s36, 4096
    buffer_load_dwordx4 v2, s[28:31], s35 offen offset:0 lds
    s_waitcnt lgkmcnt(5)
    v_mfma_f32_32x32x16_bf16 v[64:79], a[36:39], v[20:23], v[64:79]
    ds_read_b128 v[44:47], v11 offset:480
    buffer_store_dwordx4 v[80:83], v2, s[4:7], s38 offen sc1
    s_waitcnt lgkmcnt(5)
    v_mfma_f32_32x32x16_bf16 v[64:79], a[40:43], v[24:27], v[64:79]
    ds_read_b128 v[16:19], v11 offset:512
    buffer_load_dwordx4 v2, s[28:31], s35 offen offset:1024 lds
    s_waitcnt lgkmcnt(5)
    v_mfma_f32_32x32x16_bf16 v[64:79], a[44:47], v[28:31], v[64:79]
    ds_read_b128 v[20:23], v11 offset:544
    buffer_store_dwordx4 v[84:87], v2, s[4:7], s38 offen offset:1024 sc1
    s_add_u32 s38, s38, 0x40000
    s_bitset0_b32 s38, 30
    s_waitcnt lgkmcnt(5)
    v_mfma_f32_32x32x16_bf16 v[64:79], a[48:51], v[32:35], v[64:79]
    ds_read_b128 v[24:27], v11 offset:576
    s_add_u32 m0, s37, 6192
    s_add_u32 s35, s36, 6144
    buffer_load_dwordx4 v2, s[28:31], s35 offen offset:0 lds
    s_waitcnt lgkmcnt(5)
    v_mfma_f32_32x32x16_bf16 v[64:79], a[52:55], v[36:39], v[64:79]
    ds_read_b128 v[28:31], v11 offset:608
    s_waitcnt lgkmcnt(5)
    v_mfma_f32_32x32x16_bf16 v[64:79], a[56:59], v[40:43], v[64:79]
    ds_read_b128 v[32:35], v11 offset:640
    buffer_load_dwordx4 v2, s[28:31], s35 offen offset:1024 lds
    s_waitcnt lgkmcnt(5)
    v_mfma_f32_32x32x16_bf16 v[64:79], a[60:63], v[44:47], v[64:79]
    ds_read_b128 v[36:39], v11 offset:672
    s_waitcnt lgkmcnt(5)
    v_mfma_f32_32x32x16_bf16 v[64:79], a[64:67], v[16:19], v[64:79]
    ds_read_b128 v[40:43], v11 offset:704
    s_add_u32 m0, s37, 8256
    s_add_u32 s35, s36, 8192
    buffer_load_dwordx4 v2, s[28:31], s35 offen offset:0 lds
    s_waitcnt lgkmcnt(5)
    v_mfma_f32_32x32x16_bf16 v[64:79], a[68:71], v[20:23], v[64:79]
    ds_read_b128 v[44:47], v11 offset:736
    s_waitcnt lgkmcnt(5)
    v_mfma_f32_32x32x16_bf16 v[64:79], a[72:75], v[24:27], v[64:79]
    ds_read_b128 v[16:19], v11 offset:768
    buffer_load_dwordx4 v2, s[28:31], s35 offen offset:1024 lds
    s_waitcnt lgkmcnt(5)
    v_mfma_f32_32x32x16_bf16 v[64:79], a[76:79], v[28:31], v[64:79]
    ds_read_b128 v[20:23], v11 offset:800
    s_waitcnt lgkmcnt(5)
    v_mfma_f32_32x32x16_bf16 v[64:79], a[80:83], v[32:35], v[64:79]
    ds_read_b128 v[24:27], v11 offset:832
    s_add_u32 m0, s37, 10320
    s_add_u32 s35, s36, 10240
    buffer_load_dwordx4 v2, s[28:31], s35 offen offset:0 lds
    s_waitcnt lgkmcnt(5)
    v_mfma_f32_32x32x16_bf16 v[64:79], a[84:87], v[36:39], v[64:79]
    ds_read_b128 v[28:31], v11 offset:864
    s_waitcnt lgkmcnt(5)
    v_mfma_f32_32x32x16_bf16 v[64:79], a[88:91], v[40:43], v[64:79]
    ds_read_b128 v[32:35], v11 offset:896
    buffer_load_dwordx4 v2, s[28:31], s35 offen offset:1024 lds
    s_waitcnt lgkmcnt(5)
    v_mfma_f32_32x32x16_bf16 v[64:79], a[92:95], v[44:47], v[64:79]
    ds_read_b128 v[36:39], v11 offset:928
    s_waitcnt lgkmcnt(5)
    v_mfma_f32_32x32x16_bf16 v[64:79], a[96:99], v[16:19], v[64:79]
    ds_read_b128 v[40:43], v11 offset:960
    s_add_u32 m0, s37, 12384
    s_add_u32 s35, s36, 12288
    buffer_load_dwordx4 v2, s[28:31], s35 offen offset:0 lds
    s_waitcnt lgkmcnt(5)
    v_mfma_f32_32x32x16_bf16 v[64:79], a[100:103], v[20:23], v[64:79]
    ds_read_b128 v[44:47], v11 offset:992
    s_waitcnt lgkmcnt(5)
    v_mfma_f32_32x32x16_bf16 v[64:79], a[104:107], v[24:27], v[64:79]
    ds_read_b128 v[16:19], v11 offset:1024
    buffer_load_dwordx4 v2, s[28:31], s35 offen offset:1024 lds
    s_waitcnt lgkmcnt(5)
    v_mfma_f32_32x32x16_bf16 v[64:79], a[108:111], v[28:31], v[64:79]
    ds_read_b128 v[20:23], v11 offset:1056
    s_waitcnt lgkmcnt(5)
    v_mfma_f32_32x32x16_bf16 v[64:79], a[112:115], v[32:35], v[64:79]
    ds_read_b128 v[24:27], v11 offset:1088
    s_add_u32 m0, s37, 14448
    s_add_u32 s35, s36, 14336
    buffer_load_dwordx4 v2, s[28:31], s35 offen offset:0 lds
    s_waitcnt lgkmcnt(5)
    v_mfma_f32_32x32x16_bf16 v[64:79], a[116:119], v[36:39], v[64:79]
    ds_read_b128 v[28:31], v11 offset:1120
    s_waitcnt lgkmcnt(5)
    v_mfma_f32_32x32x16_bf16 v[64:79], a[120:123], v[40:43], v[64:79]
    ds_read_b128 v[32:35], v11 offset:1152
    buffer_load_dwordx4 v2, s[28:31], s35 offen offset:1024 lds
    s_waitcnt lgkmcnt(5)
    v_mfma_f32_32x32x16_bf16 v[64:79], a[124:127], v[44:47], v[64:79]
    ds_read_b128 v[36:39], v11 offset:1184
    s_waitcnt lgkmcnt(5)
    v_mfma_f32_32x32x16_bf16 v[64:79], a[128:131], v[16:19], v[64:79]
    ds_read_b128 v[40:43], v11 offset:1216
    s_waitcnt lgkmcnt(5)
    v_mfma_f32_32x32x16_bf16 v[64:79], a[132:135], v[20:23], v[64:79]
    ds_read_b128 v[44:47], v11 offset:1248
    s_waitcnt lgkmcnt(5)
    v_mfma_f32_32x32x16_bf16 v[64:79], a[136:139], v[24:27], v[64:79]
    ds_read_b128 v[16:19], v11 offset:1280
    s_waitcnt lgkmcnt(5)
    v_mfma_f32_32x32x16_bf16 v[64:79], a[140:143], v[28:31], v[64:79]
    ds_read_b128 v[20:23], v11 offset:1312
    s_waitcnt lgkmcnt(5)
    v_mfma_f32_32x32x16_bf16 v[64:79], a[144:147], v[32:35], v[64:79]
    ds_read_b128 v[24:27], v11 offset:1344
    s_waitcnt lgkmcnt(5)
    v_mfma_f32_32x32x16_bf16 v[64:79], a[148:151], v[36:39], v[64:79]
    ds_read_b128 v[28:31], v11 offset:1376
    v_mov_b32 v9, s32
    s_waitcnt vmcnt(10)
    buffer_store_dword v9, v8, s[4:7], 0 offen sc1
    s_waitcnt lgkmcnt(5)
    v_mfma_f32_32x32x16_bf16 v[64:79], a[152:155], v[40:43], v[64:79]
    ds_read_b128 v[32:35], v11 offset:1408
    s_waitcnt lgkmcnt(5)
    v_mfma_f32_32x32x16_bf16 v[64:79], a[156:159], v[44:47], v[64:79]
    ds_read_b128 v[36:39], v11 offset:1440
    s_waitcnt lgkmcnt(5)
    v_mfma_f32_32x32x16_bf16 v[64:79], a[160:163], v[16:19], v[64:79]
    ds_read_b128 v[40:43], v11 offset:1472
    s_waitcnt lgkmcnt(5)
    v_mfma_f32_32x32x16_bf16 v[64:79], a[164:167], v[20:23], v[64:79]
    ds_read_b128 v[44:47], v11 offset:1504
    s_waitcnt lgkmcnt(5)
    v_mfma_f32_32x32x16_bf16 v[64:79], a[168:171], v[24:27], v[64:79]
    ds_read_b128 v[16:19], v11 offset:1536
    s_waitcnt lgkmcnt(5)
    v_mfma_f32_32x32x16_bf16 v[64:79], a[172:175], v[28:31], v[64:79]
    ds_read_b128 v[20:23], v11 offset:1568
    s_waitcnt lgkmcnt(5)
    v_mfma_f32_32x32x16_bf16 v[64:79], a[176:179], v[32:35], v[64:79]
    ds_read_b128 v[24:27], v11 offset:1600
    s_waitcnt lgkmcnt(5)
    v_mfma_f32_32x32x16_bf16 v[64:79], a[180:183], v[36:39], v[64:79]
    ds_read_b128 v[28:31], v11 offset:1632
    s_waitcnt lgkmcnt(5)
    v_mfma_f32_32x32x16_bf16 v[64:79], a[184:187], v[40:43], v[64:79]
    ds_read_b128 v[32:35], v11 offset:1664
    s_waitcnt lgkmcnt(5)
    v_mfma_f32_32x32x16_bf16 v[64:79], a[188:191], v[44:47], v[64:79]
    ds_read_b128 v[36:39], v11 offset:1696
    s_waitcnt lgkmcnt(5)
    v_mfma_f32_32x32x16_bf16 v[64:79], a[192:195], v[16:19], v[64:79]
    ds_read_b128 v[40:43], v11 offset:1728
    s_waitcnt lgkmcnt(5)
    v_mfma_f32_32x32x16_bf16 v[64:79], a[196:199], v[20:23], v[64:79]
    ds_read_b128 v[44:47], v11 offset:1760
    s_waitcnt lgkmcnt(5)
    v_mfma_f32_32x32x16_bf16 v[64:79], a[200:203], v[24:27], v[64:79]
    ds_read_b128 v[16:19], v11 offset:1792
    s_waitcnt lgkmcnt(5)
    v_mfma_f32_32x32x16_bf16 v[64:79], a[204:207], v[28:31], v[64:79]
    ds_read_b128 v[20:23], v11 offset:1824
    s_waitcnt lgkmcnt(5)
    v_mfma_f32_32x32x16_bf16 v[64:79], a[208:211], v[32:35], v[64:79]
    ds_read_b128 v[24:27], v11 offset:1856
    s_waitcnt lgkmcnt(5)
    v_mfma_f32_32x32x16_bf16 v[64:79], a[212:215], v[36:39], v[64:79]
    ds_read_b128 v[28:31], v11 offset:1888
    s_waitcnt lgkmcnt(5)
    v_mfma_f32_32x32x16_bf16 v[64:79], a[216:219], v[40:43], v[64:79]
    ds_read_b128 v[32:35], v11 offset:1920
    s_waitcnt lgkmcnt(5)
    v_mfma_f32_32x32x16_bf16 v[64:79], a[220:223], v[44:47], v[64:79]
    ds_read_b128 v[36:39], v11 offset:1952
    s_waitcnt lgkmcnt(5)
    v_mfma_f32_32x32x16_bf16 v[64:79], a[224:227], v[16:19], v[64:79]
    ds_read_b128 v[40:43], v11 offset:1984
    s_waitcnt lgkmcnt(5)
    v_mfma_f32_32x32x16_bf16 v[64:79], a[228:231], v[20:23], v[64:79]
    ds_read_b128 v[44:47], v11 offset:2016
    s_add_u32 s32, s32, 1
    s_waitcnt lgkmcnt(5)
    v_mfma_f32_32x32x16_bf16 v[64:79], a[232:235], v[24:27], v[64:79]
    s_waitcnt lgkmcnt(4)
    v_mfma_f32_32x32x16_bf16 v[64:79], a[236:239], v[28:31], v[64:79]
    s_waitcnt lgkmcnt(0)
    s_waitcnt vmcnt(1)
    s_barrier
    ds_read_b128 v[16:19], v10 offset:0
    ds_read_b128 v[20:23], v10 offset:32
    v_mfma_f32_32x32x16_bf16 v[64:79], a[240:243], v[32:35], v[64:79]
    ds_read_b128 v[24:27], v10 offset:64
    ds_read_b128 v[28:31], v10 offset:96
    v_mfma_f32_32x32x16_bf16 v[64:79], a[244:247], v[36:39], v[64:79]
    ds_read_b128 v[32:35], v10 offset:128
    ds_read_b128 v[36:39], v10 offset:160
    v_mfma_f32_32x32x16_bf16 v[64:79], a[248:251], v[40:43], v[64:79]
    v_mfma_f32_32x32x16_bf16 v[64:79], a[252:255], v[44:47], v[64:79]
    s_cmp_lt_u32 s32, 64
    s_cbranch_scc1 L_rK_loop
    s_nop 11
    v_cvt_pk_bf16_f32 v80, v64, v65
    v_cvt_pk_bf16_f32 v81, v66, v67
    v_cvt_pk_bf16_f32 v82, v68, v69
    v_cvt_pk_bf16_f32 v83, v70, v71
    v_cvt_pk_bf16_f32 v84, v72, v73
    v_cvt_pk_bf16_f32 v85, v74, v75
    v_cvt_pk_bf16_f32 v86, v76, v77
    v_cvt_pk_bf16_f32 v87, v78, v79
    buffer_store_dwordx4 v[80:83], v2, s[4:7], s38 offen sc1
    buffer_store_dwordx4 v[84:87], v2, s[4:7], s38 offen offset:1024 sc1
    s_add_u32 s38, s38, 0x40000
    v_mov_b32 v9, 64
    s_waitcnt vmcnt(0)
    buffer_store_dword v9, v8, s[4:7], 0 offen sc1
    s_waitcnt vmcnt(0) lgkmcnt(0)
    s_barrier
    s_branch L_done
L_role_V:
    v_and_b32 v1, 63, v0
    v_lshlrev_b32 v2, 4, v1
    v_bfrev_b32 v7, 1
    s_mov_b32 s40, 0
    v_and_b32 v5, 0x13, v1
    v_bfe_u32 v3, v1, 2, 1
    v_lshl_add_u32 v5, v3, 3, v5
    v_bfe_u32 v3, v1, 3, 1
    v_lshl_add_u32 v5, v3, 2, v5
    v_lshrrev_b32 v4, 5, v1
    v_lshlrev_b32 v3, 9, v4
    v_lshl_add_u32 v6, v5, 4, v3
    v_mul_u32_u24 v3, 2064, v5
    v_lshl_add_u32 v10, v4, 4, v3
    v_add_u32 v11, 66048, v10
    s_lshl_b32 s33, s17, 7
    s_add_u32 s33, s33, 3735568
    s_lshl_b32 s34, s18, 2
    s_add_u32 s33, s33, s34
    v_mov_b32 v3, s33
    v_cmp_eq_u32 vcc, 0, v1
    v_mov_b32 v9, 0
    s_nop 0
    v_cndmask_b32 v8, v7, v3, vcc
    buffer_store_dword v9, v8, s[4:7], 0 offen sc1
    s_waitcnt vmcnt(0)
    s_barrier
    s_cmp_lg_u32 s18, 0
    s_cbranch_scc1 L_sig_8
    v_mov_b32 v3, s22
    v_mov_b32 v4, 1
    s_mov_b64 exec, 1
    buffer_atomic_add v4, v3, s[12:15], 0 offen sc1
    s_mov_b64 exec, -1
L_sig_8:
    s_load_dwordx2 s[8:9], s[0:1], 32
    s_mov_b32 s10, 8388608
    s_mov_b32 s11, 0x20000
    v_lshrrev_b32 v80, 2, v1
    v_lshlrev_b32 v80, 13, v80
    v_and_b32 v3, 3, v1
    v_lshl_add_u32 v80, v3, 4, v80
    s_lshl_b32 s33, s17, 8
    s_lshl_b32 s34, s18, 6
    s_add_u32 s33, s33, s34
    v_bfe_u32 v81, v1, 2, 2
    v_lshrrev_b32 v3, 5, v1
    v_lshl_add_u32 v81, v3, 3, v81
    v_lshlrev_b32 v81, 6, v81
    v_bfe_u32 v3, v1, 4, 1
    v_lshl_add_u32 v81, v3, 5, v81
    v_and_b32 v3, 1, v1
    v_lshl_add_u32 v81, v3, 3, v81
    v_bfe_u32 v3, v1, 1, 1
    v_lshl_add_u32 v81, v3, 4, v81
    s_lshl_b32 s35, s18, 15
    v_add_u32 v81, s35, v81
    s_waitcnt lgkmcnt(0)
    s_add_u32 s34, s35, 0
    s_mov_b32 m0, s34
    s_add_u32 s34, s34, 1024
    buffer_load_dwordx4 v80, s[8:11], s33 offen lds
    s_add_u32 s33, s33, 131072
    s_mov_b32 m0, s34
    s_add_u32 s34, s34, 1024
    buffer_load_dwordx4 v80, s[8:11], s33 offen lds
    s_add_u32 s33, s33, 131072
    s_mov_b32 m0, s34
    s_add_u32 s34, s34, 1024
    buffer_load_dwordx4 v80, s[8:11], s33 offen lds
    s_add_u32 s33, s33, 131072
    s_mov_b32 m0, s34
    s_add_u32 s34, s34, 1024
    buffer_load_dwordx4 v80, s[8:11], s33 offen lds
    s_add_u32 s33, s33, 131072
    s_mov_b32 m0, s34
    s_add_u32 s34, s34, 1024
    buffer_load_dwordx4 v80, s[8:11], s33 offen lds
    s_add_u32 s33, s33, 131072
    s_mov_b32 m0, s34
    s_add_u32 s34, s34, 1024
    buffer_load_dwordx4 v80, s[8:11], s33 offen lds
    s_add_u32 s33, s33, 131072
    s_mov_b32 m0, s34
    s_add_u32 s34, s34, 1024
    buffer_load_dwordx4 v80, s[8:11], s33 offen lds
    s_add_u32 s33, s33, 131072
    s_mov_b32 m0, s34
    s_add_u32 s34, s34, 1024
    buffer_load_dwordx4 v80, s[8:11], s33 offen lds
    s_add_u32 s33, s33, 131072
    s_mov_b32 m0, s34
    s_add_u32 s34, s34, 1024
    buffer_load_dwordx4 v80, s[8:11], s33 offen lds
    s_add_u32 s33, s33, 131072
    s_mov_b32 m0, s34
    s_add_u32 s34, s34, 1024
    buffer_load_dwordx4 v80, s[8:11], s33 offen lds
    s_add_u32 s33, s33, 131072
    s_mov_b32 m0, s34
    s_add_u32 s34, s34, 1024
    buffer_load_dwordx4 v80, s[8:11], s33 offen lds
    s_add_u32 s33, s33, 131072
    s_mov_b32 m0, s34
    s_add_u32 s34, s34, 1024
    buffer_load_dwordx4 v80, s[8:11], s33 offen lds
    s_add_u32 s33, s33, 131072
    s_mov_b32 m0, s34
    s_add_u32 s34, s34, 1024
    buffer_load_dwordx4 v80, s[8:11], s33 offen lds
    s_add_u32 s33, s33, 131072
    s_mov_b32 m0, s34
    s_add_u32 s34, s34, 1024
    buffer_load_dwordx4 v80, s[8:11], s33 offen lds
    s_add_u32 s33, s33, 131072
    s_mov_b32 m0, s34
    s_add_u32 s34, s34, 1024
    buffer_load_dwordx4 v80, s[8:11], s33 offen lds
    s_add_u32 s33, s33, 131072
    s_mov_b32 m0, s34
    s_add_u32 s34, s34, 1024
    buffer_load_dwordx4 v80, s[8:11], s33 offen lds
    s_add_u32 s33, s33, 131072
    s_add_u32 s34, s35, 16384
    s_mov_b32 m0, s34
    s_add_u32 s34, s34, 1024
    buffer_load_dwordx4 v80, s[8:11], s33 offen lds
    s_add_u32 s33, s33, 131072
    s_mov_b32 m0, s34
    s_add_u32 s34, s34, 1024
    buffer_load_dwordx4 v80, s[8:11], s33 offen lds
    s_add_u32 s33, s33, 131072
    s_mov_b32 m0, s34
    s_add_u32 s34, s34, 1024
    buffer_load_dwordx4 v80, s[8:11], s33 offen lds
    s_add_u32 s33, s33, 131072
    s_mov_b32 m0, s34
    s_add_u32 s34, s34, 1024
    buffer_load_dwordx4 v80, s[8:11], s33 offen lds
    s_add_u32 s33, s33, 131072
    s_mov_b32 m0, s34
    s_add_u32 s34, s34, 1024
    buffer_load_dwordx4 v80, s[8:11], s33 offen lds
    s_add_u32 s33, s33, 131072
    s_mov_b32 m0, s34
    s_add_u32 s34, s34, 1024
    buffer_load_dwordx4 v80, s[8:11], s33 offen lds
    s_add_u32 s33, s33, 131072
    s_mov_b32 m0, s34
    s_add_u32 s34, s34, 1024
    buffer_load_dwordx4 v80, s[8:11], s33 offen lds
    s_add_u32 s33, s33, 131072
    s_mov_b32 m0, s34
    s_add_u32 s34, s34, 1024
    buffer_load_dwordx4 v80, s[8:11], s33 offen lds
    s_add_u32 s33, s33, 131072
    s_mov_b32 m0, s34
    s_add_u32 s34, s34, 1024
    buffer_load_dwordx4 v80, s[8:11], s33 offen lds
    s_add_u32 s33, s33, 131072
    s_mov_b32 m0, s34
    s_add_u32 s34, s34, 1024
    buffer_load_dwordx4 v80, s[8:11], s33 offen lds
    s_add_u32 s33, s33, 131072
    s_mov_b32 m0, s34
    s_add_u32 s34, s34, 1024
    buffer_load_dwordx4 v80, s[8:11], s33 offen lds
    s_add_u32 s33, s33, 131072
    s_mov_b32 m0, s34
    s_add_u32 s34, s34, 1024
    buffer_load_dwordx4 v80, s[8:11], s33 offen lds
    s_add_u32 s33, s33, 131072
    s_mov_b32 m0, s34
    s_add_u32 s34, s34, 1024
    buffer_load_dwordx4 v80, s[8:11], s33 offen lds
    s_add_u32 s33, s33, 131072
    s_mov_b32 m0, s34
    s_add_u32 s34, s34, 1024
    buffer_load_dwordx4 v80, s[8:11], s33 offen lds
    s_add_u32 s33, s33, 131072
    s_mov_b32 m0, s34
    s_add_u32 s34, s34, 1024
    buffer_load_dwordx4 v80, s[8:11], s33 offen lds
    s_add_u32 s33, s33, 131072
    s_mov_b32 m0, s34
    s_add_u32 s34, s34, 1024
    buffer_load_dwordx4 v80, s[8:11], s33 offen lds
    s_add_u32 s33, s33, 131072
    s_waitcnt vmcnt(16)
    ds_read_b64_tr_b16 a[0:1], v81 offset:0
    ds_read_b64_tr_b16 a[2:3], v81 offset:256
    ds_read_b64_tr_b16 a[4:5], v81 offset:1024
    ds_read_b64_tr_b16 a[6:7], v81 offset:1280
    ds_read_b64_tr_b16 a[8:9], v81 offset:2048
    ds_read_b64_tr_b16 a[10:11], v81 offset:2304
    ds_read_b64_tr_b16 a[12:13], v81 offset:3072
    ds_read_b64_tr_b16 a[14:15], v81 offset:3328
    s_waitcnt lgkmcnt(0)
    ds_read_b64_tr_b16 a[16:17], v81 offset:4096
    ds_read_b64_tr_b16 a[18:19], v81 offset:4352
    ds_read_b64_tr_b16 a[20:21], v81 offset:5120
    ds_read_b64_tr_b16 a[22:23], v81 offset:5376
    ds_read_b64_tr_b16 a[24:25], v81 offset:6144
    ds_read_b64_tr_b16 a[26:27], v81 offset:6400
    ds_read_b64_tr_b16 a[28:29], v81 offset:7168
    ds_read_b64_tr_b16 a[30:31], v81 offset:7424
    s_waitcnt lgkmcnt(0)
    ds_read_b64_tr_b16 a[32:33], v81 offset:8192
    ds_read_b64_tr_b16 a[34:35], v81 offset:8448
    ds_read_b64_tr_b16 a[36:37], v81 offset:9216
    ds_read_b64_tr_b16 a[38:39], v81 offset:9472
    ds_read_b64_tr_b16 a[40:41], v81 offset:10240
    ds_read_b64_tr_b16 a[42:43], v81 offset:10496
    ds_read_b64_tr_b16 a[44:45], v81 offset:11264
    ds_read_b64_tr_b16 a[46:47], v81 offset:11520
    s_waitcnt lgkmcnt(0)
    ds_read_b64_tr_b16 a[48:49], v81 offset:12288
    ds_read_b64_tr_b16 a[50:51], v81 offset:12544
    ds_read_b64_tr_b16 a[52:53], v81 offset:13312
    ds_read_b64_tr_b16 a[54:55], v81 offset:13568
    ds_read_b64_tr_b16 a[56:57], v81 offset:14336
    ds_read_b64_tr_b16 a[58:59], v81 offset:14592
    ds_read_b64_tr_b16 a[60:61], v81 offset:15360
    ds_read_b64_tr_b16 a[62:63], v81 offset:15616
    s_waitcnt lgkmcnt(0)
    s_add_u32 s34, s35, 0
    s_mov_b32 m0, s34
    s_add_u32 s34, s34, 1024
    buffer_load_dwordx4 v80, s[8:11], s33 offen lds
    s_add_u32 s33, s33, 131072
    s_mov_b32 m0, s34
    s_add_u32 s34, s34, 1024
    buffer_load_dwordx4 v80, s[8:11], s33 offen lds
    s_add_u32 s33, s33, 131072
    s_mov_b32 m0, s34
    s_add_u32 s34, s34, 1024
    buffer_load_dwordx4 v80, s[8:11], s33 offen lds
    s_add_u32 s33, s33, 131072
    s_mov_b32 m0, s34
    s_add_u32 s34, s34, 1024
    buffer_load_dwordx4 v80, s[8:11], s33 offen lds
    s_add_u32 s33, s33, 131072
    s_mov_b32 m0, s34
    s_add_u32 s34, s34, 1024
    buffer_load_dwordx4 v80, s[8:11], s33 offen lds
    s_add_u32 s33, s33, 131072
    s_mov_b32 m0, s34
    s_add_u32 s34, s34, 1024
    buffer_load_dwordx4 v80, s[8:11], s33 offen lds
    s_add_u32 s33, s33, 131072
    s_mov_b32 m0, s34
    s_add_u32 s34, s34, 1024
    buffer_load_dwordx4 v80, s[8:11], s33 offen lds
    s_add_u32 s33, s33, 131072
    s_mov_b32 m0, s34
    s_add_u32 s34, s34, 1024
    buffer_load_dwordx4 v80, s[8:11], s33 offen lds
    s_add_u32 s33, s33, 131072
    s_mov_b32 m0, s34
    s_add_u32 s34, s34, 1024
    buffer_load_dwordx4 v80, s[8:11], s33 offen lds
    s_add_u32 s33, s33, 131072
    s_mov_b32 m0, s34
    s_add_u32 s34, s34, 1024
    buffer_load_dwordx4 v80, s[8:11], s33 offen lds
    s_add_u32 s33, s33, 131072
    s_mov_b32 m0, s34
    s_add_u32 s34, s34, 1024
    buffer_load_dwordx4 v80, s[8:11], s33 offen lds
    s_add_u32 s33, s33, 131072
    s_mov_b32 m0, s34
    s_add_u32 s34, s34, 1024
    buffer_load_dwordx4 v80, s[8:11], s33 offen lds
    s_add_u32 s33, s33, 131072
    s_mov_b32 m0, s34
    s_add_u32 s34, s34, 1024
    buffer_load_dwordx4 v80, s[8:11], s33 offen lds
    s_add_u32 s33, s33, 131072
    s_mov_b32 m0, s34
    s_add_u32 s34, s34, 1024
    buffer_load_dwordx4 v80, s[8:11], s33 offen lds
    s_add_u32 s33, s33, 131072
    s_mov_b32 m0, s34
    s_add_u32 s34, s34, 1024
    buffer_load_dwordx4 v80, s[8:11], s33 offen lds
    s_add_u32 s33, s33, 131072
    s_mov_b32 m0, s34
    s_add_u32 s34, s34, 1024
    buffer_load_dwordx4 v80, s[8:11], s33 offen lds
    s_add_u32 s33, s33, 131072
    s_waitcnt vmcnt(16)
    ds_read_b64_tr_b16 a[64:65], v81 offset:16384
    ds_read_b64_tr_b16 a[66:67], v81 offset:16640
    ds_read_b64_tr_b16 a[68:69], v81 offset:17408
    ds_read_b64_tr_b16 a[70:71], v81 offset:17664
    ds_read_b64_tr_b16 a[72:73], v81 offset:18432
    ds_read_b64_tr_b16 a[74:75], v81 offset:18688
    ds_read_b64_tr_b16 a[76:77], v81 offset:19456
    ds_read_b64_tr_b16 a[78:79], v81 offset:19712
    s_waitcnt lgkmcnt(0)
    ds_read_b64_tr_b16 a[80:81], v81 offset:20480
    ds_read_b64_tr_b16 a[82:83], v81 offset:20736
    ds_read_b64_tr_b16 a[84:85], v81 offset:21504
    ds_read_b64_tr_b16 a[86:87], v81 offset:21760
    ds_read_b64_tr_b16 a[88:89], v81 offset:22528
    ds_read_b64_tr_b16 a[90:91], v81 offset:22784
    ds_read_b64_tr_b16 a[92:93], v81 offset:23552
    ds_read_b64_tr_b16 a[94:95], v81 offset:23808
    s_waitcnt lgkmcnt(0)
    ds_read_b64_tr_b16 a[96:97], v81 offset:24576
    ds_read_b64_tr_b16 a[98:99], v81 offset:24832
    ds_read_b64_tr_b16 a[100:101], v81 offset:25600
    ds_read_b64_tr_b16 a[102:103], v81 offset:25856
    ds_read_b64_tr_b16 a[104:105], v81 offset:26624
    ds_read_b64_tr_b16 a[106:107], v81 offset:26880
    ds_read_b64_tr_b16 a[108:109], v81 offset:27648
    ds_read_b64_tr_b16 a[110:111], v81 offset:27904
    s_waitcnt lgkmcnt(0)
    ds_read_b64_tr_b16 a[112:113], v81 offset:28672
    ds_read_b64_tr_b16 a[114:115], v81 offset:28928
    ds_read_b64_tr_b16 a[116:117], v81 offset:29696
    ds_read_b64_tr_b16 a[118:119], v81 offset:29952
    ds_read_b64_tr_b16 a[120:121], v81 offset:30720
    ds_read_b64_tr_b16 a[122:123], v81 offset:30976
    ds_read_b64_tr_b16 a[124:125], v81 offset:31744
    ds_read_b64_tr_b16 a[126:127], v81 offset:32000
    s_waitcnt lgkmcnt(0)
    s_add_u32 s34, s35, 16384
    s_mov_b32 m0, s34
    s_add_u32 s34, s34, 1024
    buffer_load_dwordx4 v80, s[8:11], s33 offen lds
    s_add_u32 s33, s33, 131072
    s_mov_b32 m0, s34
    s_add_u32 s34, s34, 1024
    buffer_load_dwordx4 v80, s[8:11], s33 offen lds
    s_add_u32 s33, s33, 131072
    s_mov_b32 m0, s34
    s_add_u32 s34, s34, 1024
    buffer_load_dwordx4 v80, s[8:11], s33 offen lds
    s_add_u32 s33, s33, 131072
    s_mov_b32 m0, s34
    s_add_u32 s34, s34, 1024
    buffer_load_dwordx4 v80, s[8:11], s33 offen lds
    s_add_u32 s33, s33, 131072
    s_mov_b32 m0, s34
    s_add_u32 s34, s34, 1024
    buffer_load_dwordx4 v80, s[8:11], s33 offen lds
    s_add_u32 s33, s33, 131072
    s_mov_b32 m0, s34
    s_add_u32 s34, s34, 1024
    buffer_load_dwordx4 v80, s[8:11], s33 offen lds
    s_add_u32 s33, s33, 131072
    s_mov_b32 m0, s34
    s_add_u32 s34, s34, 1024
    buffer_load_dwordx4 v80, s[8:11], s33 offen lds
    s_add_u32 s33, s33, 131072
    s_mov_b32 m0, s34
    s_add_u32 s34, s34, 1024
    buffer_load_dwordx4 v80, s[8:11], s33 offen lds
    s_add_u32 s33, s33, 131072
    s_mov_b32 m0, s34
    s_add_u32 s34, s34, 1024
    buffer_load_dwordx4 v80, s[8:11], s33 offen lds
    s_add_u32 s33, s33, 131072
    s_mov_b32 m0, s34
    s_add_u32 s34, s34, 1024
    buffer_load_dwordx4 v80, s[8:11], s33 offen lds
    s_add_u32 s33, s33, 131072
    s_mov_b32 m0, s34
    s_add_u32 s34, s34, 1024
    buffer_load_dwordx4 v80, s[8:11], s33 offen lds
    s_add_u32 s33, s33, 131072
    s_mov_b32 m0, s34
    s_add_u32 s34, s34, 1024
    buffer_load_dwordx4 v80, s[8:11], s33 offen lds
    s_add_u32 s33, s33, 131072
    s_mov_b32 m0, s34
    s_add_u32 s34, s34, 1024
    buffer_load_dwordx4 v80, s[8:11], s33 offen lds
    s_add_u32 s33, s33, 131072
    s_mov_b32 m0, s34
    s_add_u32 s34, s34, 1024
    buffer_load_dwordx4 v80, s[8:11], s33 offen lds
    s_add_u32 s33, s33, 131072
    s_mov_b32 m0, s34
    s_add_u32 s34, s34, 1024
    buffer_load_dwordx4 v80, s[8:11], s33 offen lds
    s_add_u32 s33, s33, 131072
    s_mov_b32 m0, s34
    s_add_u32 s34, s34, 1024
    buffer_load_dwordx4 v80, s[8:11], s33 offen lds
    s_add_u32 s33, s33, 131072
    s_waitcnt vmcnt(16)
    ds_read_b64_tr_b16 a[128:129], v81 offset:0
    ds_read_b64_tr_b16 a[130:131], v81 offset:256
    ds_read_b64_tr_b16 a[132:133], v81 offset:1024
    ds_read_b64_tr_b16 a[134:135], v81 offset:1280
    ds_read_b64_tr_b16 a[136:137], v81 offset:2048
    ds_read_b64_tr_b16 a[138:139], v81 offset:2304
    ds_read_b64_tr_b16 a[140:141], v81 offset:3072
    ds_read_b64_tr_b16 a[142:143], v81 offset:3328
    s_waitcnt lgkmcnt(0)
    ds_read_b64_tr_b16 a[144:145], v81 offset:4096
    ds_read_b64_tr_b16 a[146:147], v81 offset:4352
    ds_read_b64_tr_b16 a[148:149], v81 offset:5120
    ds_read_b64_tr_b16 a[150:151], v81 offset:5376
    ds_read_b64_tr_b16 a[152:153], v81 offset:6144
    ds_read_b64_tr_b16 a[154:155], v81 offset:6400
    ds_read_b64_tr_b16 a[156:157], v81 offset:7168
    ds_read_b64_tr_b16 a[158:159], v81 offset:7424
    s_waitcnt lgkmcnt(0)
    ds_read_b64_tr_b16 a[160:161], v81 offset:8192
    ds_read_b64_tr_b16 a[162:163], v81 offset:8448
    ds_read_b64_tr_b16 a[164:165], v81 offset:9216
    ds_read_b64_tr_b16 a[166:167], v81 offset:9472
    ds_read_b64_tr_b16 a[168:169], v81 offset:10240
    ds_read_b64_tr_b16 a[170:171], v81 offset:10496
    ds_read_b64_tr_b16 a[172:173], v81 offset:11264
    ds_read_b64_tr_b16 a[174:175], v81 offset:11520
    s_waitcnt lgkmcnt(0)
    ds_read_b64_tr_b16 a[176:177], v81 offset:12288
    ds_read_b64_tr_b16 a[178:179], v81 offset:12544
    ds_read_b64_tr_b16 a[180:181], v81 offset:13312
    ds_read_b64_tr_b16 a[182:183], v81 offset:13568
    ds_read_b64_tr_b16 a[184:185], v81 offset:14336
    ds_read_b64_tr_b16 a[186:187], v81 offset:14592
    ds_read_b64_tr_b16 a[188:189], v81 offset:15360
    ds_read_b64_tr_b16 a[190:191], v81 offset:15616
    s_waitcnt lgkmcnt(0)
    s_waitcnt vmcnt(0)
    ds_read_b64_tr_b16 a[192:193], v81 offset:16384
    ds_read_b64_tr_b16 a[194:195], v81 offset:16640
    ds_read_b64_tr_b16 a[196:197], v81 offset:17408
    ds_read_b64_tr_b16 a[198:199], v81 offset:17664
    ds_read_b64_tr_b16 a[200:201], v81 offset:18432
    ds_read_b64_tr_b16 a[202:203], v81 offset:18688
    ds_read_b64_tr_b16 a[204:205], v81 offset:19456
    ds_read_b64_tr_b16 a[206:207], v81 offset:19712
    s_waitcnt lgkmcnt(0)
    ds_read_b64_tr_b16 a[208:209], v81 offset:20480
    ds_read_b64_tr_b16 a[210:211], v81 offset:20736
    ds_read_b64_tr_b16 a[212:213], v81 offset:21504
    ds_read_b64_tr_b16 a[214:215], v81 offset:21760
    ds_read_b64_tr_b16 a[216:217], v81 offset:22528
    ds_read_b64_tr_b16 a[218:219], v81 offset:22784
    ds_read_b64_tr_b16 a[220:221], v81 offset:23552
    ds_read_b64_tr_b16 a[222:223], v81 offset:23808
    s_waitcnt lgkmcnt(0)
    ds_read_b64_tr_b16 a[224:225], v81 offset:24576
    ds_read_b64_tr_b16 a[226:227], v81 offset:24832
    ds_read_b64_tr_b16 a[228:229], v81 offset:25600
    ds_read_b64_tr_b16 a[230:231], v81 offset:25856
    ds_read_b64_tr_b16 a[232:233], v81 offset:26624
    ds_read_b64_tr_b16 a[234:235], v81 offset:26880
    ds_read_b64_tr_b16 a[236:237], v81 offset:27648
    ds_read_b64_tr_b16 a[238:239], v81 offset:27904
    s_waitcnt lgkmcnt(0)
    ds_read_b64_tr_b16 a[240:241], v81 offset:28672
    ds_read_b64_tr_b16 a[242:243], v81 offset:28928
    ds_read_b64_tr_b16 a[244:245], v81 offset:29696
    ds_read_b64_tr_b16 a[246:247], v81 offset:29952
    ds_read_b64_tr_b16 a[248:249], v81 offset:30720
    ds_read_b64_tr_b16 a[250:251], v81 offset:30976
    ds_read_b64_tr_b16 a[252:253], v81 offset:31744
    ds_read_b64_tr_b16 a[254:255], v81 offset:32000
    s_waitcnt lgkmcnt(0)
    s_barrier
    s_mov_b32 s3, 0
L_rdy_9:
    buffer_load_dwordx2 v[82:83], off, s[12:15], s22 sc1
    s_add_u32 s3, s3, 1
    s_cmp_gt_u32 s3, 400000
    s_cbranch_scc1 L_exit
    s_waitcnt vmcnt(0)
    v_readfirstlane_b32 s24, v82
    v_readfirstlane_b32 s25, v83
    s_and_b32 vcc_lo, s24, 0xffff
    s_cmp_lt_u32 vcc_lo, 256
    s_cbranch_scc1 L_rdy_9
    s_lshr_b32 vcc_lo, s24, 16
    s_cbranch_scc1 L_general
    s_load_dwordx2 s[28:29], s[0:1], 0
    s_mov_b32 s30, 4194304
    s_mov_b32 s31, 0x20000
    s_lshl_b32 s36, s18, 14
    s_mul_i32 s37, s18, 16512
    s_lshl_b32 s33, s17, 2
    s_add_u32 s33, s33, s18
    s_lshl_b32 s38, s33, 11
    s_add_u32 s38, s38, 33554432
    s_waitcnt lgkmcnt(0)
    s_mov_b32 s44, 0
    s_mov_b32 s45, 0
    s_mov_b32 s46, 0
    s_mov_b32 s47, 0
    s_mov_b32 s48, 0
    s_mov_b32 s49, 0
    s_mov_b32 s50, 0
    s_mov_b32 s51, 0
    s_mov_b32 s52, 0
    s_mov_b32 s53, 0
    s_mov_b32 s54, 0
    s_mov_b32 s55, 0
    s_mov_b32 s56, 0
    s_mov_b32 s57, 0
    s_mov_b32 s58, 0
    s_mov_b32 s59, 0
    s_mov_b32 s32, 0
    s_add_u32 m0, s37, 0
    s_add_u32 s35, s36, 0
    buffer_load_dwordx4 v2, s[28:31], s35 offen offset:0 lds
    buffer_load_dwordx4 v2, s[28:31], s35 offen offset:1024 lds
    s_add_u32 m0, s37, 2064
    s_add_u32 s35, s36, 2048
    buffer_load_dwordx4 v2, s[28:31], s35 offen offset:0 lds
    buffer_load_dwordx4 v2, s[28:31], s35 offen offset:1024 lds
    s_add_u32 m0, s37, 4128
    s_add_u32 s35, s36, 4096
    buffer_load_dwordx4 v2, s[28:31], s35 offen offset:0 lds
    buffer_load_dwordx4 v2, s[28:31], s35 offen offset:1024 lds
    s_add_u32 m0, s37, 6192
    s_add_u32 s35, s36, 6144
    buffer_load_dwordx4 v2, s[28:31], s35 offen offset:0 lds
    buffer_load_dwordx4 v2, s[28:31], s35 offen offset:1024 lds
    s_add_u32 m0, s37, 8256
    s_add_u32 s35, s36, 8192
    buffer_load_dwordx4 v2, s[28:31], s35 offen offset:0 lds
    buffer_load_dwordx4 v2, s[28:31], s35 offen offset:1024 lds
    s_add_u32 m0, s37, 10320
    s_add_u32 s35, s36, 10240
    buffer_load_dwordx4 v2, s[28:31], s35 offen offset:0 lds
    buffer_load_dwordx4 v2, s[28:31], s35 offen offset:1024 lds
    s_add_u32 m0, s37, 12384
    s_add_u32 s35, s36, 12288
    buffer_load_dwordx4 v2, s[28:31], s35 offen offset:0 lds
    buffer_load_dwordx4 v2, s[28:31], s35 offen offset:1024 lds
    s_add_u32 m0, s37, 14448
    s_add_u32 s35, s36, 14336
    buffer_load_dwordx4 v2, s[28:31], s35 offen offset:0 lds
    buffer_load_dwordx4 v2, s[28:31], s35 offen offset:1024 lds
    s_waitcnt vmcnt(0)
    s_barrier
    ds_read_b128 v[16:19], v10 offset:0
    ds_read_b128 v[20:23], v10 offset:32
    ds_read_b128 v[24:27], v10 offset:64
    ds_read_b128 v[28:31], v10 offset:96
    ds_read_b128 v[32:35], v10 offset:128
    ds_read_b128 v[36:39], v10 offset:160
    s_add_u32 s38, s38, 1073479680
L_rV_loop:
    s_waitcnt lgkmcnt(5)
    v_mfma_f32_32x32x16_bf16 v[48:63], v[16:19], a[0:3], 0
    ds_read_b128 v[40:43], v10 offset:192
    s_add_u32 s36, s36, 65536
    s_add_u32 m0, s37, 66048
    s_add_u32 s35, s36, 0
    buffer_load_dwordx4 v2, s[28:31], s35 offen offset:0 lds
    s_waitcnt lgkmcnt(5)
    v_mfma_f32_32x32x16_bf16 v[48:63], v[20:23], a[4:7], v[48:63]
    ds_read_b128 v[44:47], v10 offset:224
    s_waitcnt lgkmcnt(5)
    v_mfma_f32_32x32x16_bf16 v[48:63], v[24:27], a[8:11], v[48:63]
    ds_read_b128 v[16:19], v10 offset:256
    buffer_load_dwordx4 v2, s[28:31], s35 offen offset:1024 lds
    s_waitcnt lgkmcnt(5)
    v_mfma_f32_32x32x16_bf16 v[48:63], v[28:31], a[12:15], v[48:63]
    ds_read_b128 v[20:23], v10 offset:288
    s_waitcnt lgkmcnt(5)
    v_mfma_f32_32x32x16_bf16 v[48:63], v[32:35], a[16:19], v[48:63]
    ds_read_b128 v[24:27], v10 offset:320
    s_add_u32 m0, s37, 68112
    s_add_u32 s35, s36, 2048
    buffer_load_dwordx4 v2, s[28:31], s35 offen offset:0 lds
    v_cvt_pk_bf16_f32 v80, v64, v65
    v_cvt_pk_bf16_f32 v81, v66, v67
    s_waitcnt lgkmcnt(5)
    v_mfma_f32_32x32x16_bf16 v[48:63], v[36:39], a[20:23], v[48:63]
    ds_read_b128 v[28:31], v10 offset:352
    v_cvt_pk_bf16_f32 v82, v68, v69
    v_cvt_pk_bf16_f32 v83, v70, v71
    s_waitcnt lgkmcnt(5)
    v_mfma_f32_32x32x16_bf16 v[48:63], v[40:43], a[24:27], v[48:63]
    ds_read_b128 v[32:35], v10 offset:384
    buffer_load_dwordx4 v2, s[28:31], s35 offen offset:1024 lds
    v_cvt_pk_bf16_f32 v84, v72, v73
    v_cvt_pk_bf16_f32 v85, v74, v75
    s_waitcnt lgkmcnt(5)
    v_mfma_f32_32x32x16_bf16 v[48:63], v[44:47], a[28:31], v[48:63]
    ds_read_b128 v[36:39], v10 offset:416
    v_cvt_pk_bf16_f32 v86, v76, v77
    v_cvt_pk_bf16_f32 v87, v78, v79
    s_waitcnt lgkmcnt(5)
    v_mfma_f32_32x32x16_bf16 v[48:63], v[16:19], a[32:35], v[48:63]
    ds_read_b128 v[40:43], v10 offset:448
    s_add_u32 m0, s37, 70176
    s_add_u32 s35, s36, 4096
    buffer_load_dwordx4 v2, s[28:31], s35 offen offset:0 lds
    s_waitcnt lgkmcnt(5)
    v_mfma_f32_32x32x16_bf16 v[48:63], v[20:23], a[36:39], v[48:63]
    ds_read_b128 v[44:47], v10 offset:480
    buffer_store_dwordx4 v[80:83], v2, s[4:7], s38 offen sc1
    s_waitcnt lgkmcnt(5)
    v_mfma_f32_32x32x16_bf16 v[48:63], v[24:27], a[40:43], v[48:63]
    ds_read_b128 v[16:19], v10 offset:512
    buffer_load_dwordx4 v2, s[28:31], s35 offen offset:1024 lds
    s_waitcnt lgkmcnt(5)
    v_mfma_f32_32x32x16_bf16 v[48:63], v[28:31], a[44:47], v[48:63]
    ds_read_b128 v[20:23], v10 offset:544
    buffer_store_dwordx4 v[84:87], v2, s[4:7], s38 offen offset:1024 sc1
    s_add_u32 s38, s38, 0x40000
    s_bitset0_b32 s38, 30
    s_waitcnt lgkmcnt(5)
    v_mfma_f32_32x32x16_bf16 v[48:63], v[32:35], a[48:51], v[48:63]
    ds_read_b128 v[24:27], v10 offset:576
    s_add_u32 m0, s37, 72240
    s_add_u32 s35, s36, 6144
    buffer_load_dwordx4 v2, s[28:31], s35 offen offset:0 lds
    s_waitcnt lgkmcnt(5)
    v_mfma_f32_32x32x16_bf16 v[48:63], v[36:39], a[52:55], v[48:63]
    ds_read_b128 v[28:31], v10 offset:608
    s_waitcnt lgkmcnt(5)
    v_mfma_f32_32x32x16_bf16 v[48:63], v[40:43], a[56:59], v[48:63]
    ds_read_b128 v[32:35], v10 offset:640
    buffer_load_dwordx4 v2, s[28:31], s35 offen offset:1024 lds
    s_waitcnt lgkmcnt(5)
    v_mfma_f32_32x32x16_bf16 v[48:63], v[44:47], a[60:63], v[48:63]
    ds_read_b128 v[36:39], v10 offset:672
    s_waitcnt lgkmcnt(5)
    v_mfma_f32_32x32x16_bf16 v[48:63], v[16:19], a[64:67], v[48:63]
    ds_read_b128 v[40:43], v10 offset:704
    s_add_u32 m0, s37, 74304
    s_add_u32 s35, s36, 8192
    buffer_load_dwordx4 v2, s[28:31], s35 offen offset:0 lds
    s_waitcnt lgkmcnt(5)
    v_mfma_f32_32x32x16_bf16 v[48:63], v[20:23], a[68:71], v[48:63]
    ds_read_b128 v[44:47], v10 offset:736
    s_waitcnt lgkmcnt(5)
    v_mfma_f32_32x32x16_bf16 v[48:63], v[24:27], a[72:75], v[48:63]
    ds_read_b128 v[16:19], v10 offset:768
    buffer_load_dwordx4 v2, s[28:31], s35 offen offset:1024 lds
    s_waitcnt lgkmcnt(5)
    v_mfma_f32_32x32x16_bf16 v[48:63], v[28:31], a[76:79], v[48:63]
    ds_read_b128 v[20:23], v10 offset:800
    s_waitcnt lgkmcnt(5)
    v_mfma_f32_32x32x16_bf16 v[48:63], v[32:35], a[80:83], v[48:63]
    ds_read_b128 v[24:27], v10 offset:832
    s_add_u32 m0, s37, 76368
    s_add_u32 s35, s36, 10240
    buffer_load_dwordx4 v2, s[28:31], s35 offen offset:0 lds
    s_waitcnt lgkmcnt(5)
    v_mfma_f32_32x32x16_bf16 v[48:63], v[36:39], a[84:87], v[48:63]
    ds_read_b128 v[28:31], v10 offset:864
    s_waitcnt lgkmcnt(5)
    v_mfma_f32_32x32x16_bf16 v[48:63], v[40:43], a[88:91], v[48:63]
    ds_read_b128 v[32:35], v10 offset:896
    buffer_load_dwordx4 v2, s[28:31], s35 offen offset:1024 lds
    s_waitcnt lgkmcnt(5)
    v_mfma_f32_32x32x16_bf16 v[48:63], v[44:47], a[92:95], v[48:63]
    ds_read_b128 v[36:39], v10 offset:928
    s_waitcnt lgkmcnt(5)
    v_mfma_f32_32x32x16_bf16 v[48:63], v[16:19], a[96:99], v[48:63]
    ds_read_b128 v[40:43], v10 offset:960
    s_add_u32 m0, s37, 78432
    s_add_u32 s35, s36, 12288
    buffer_load_dwordx4 v2, s[28:31], s35 offen offset:0 lds
    s_waitcnt lgkmcnt(5)
    v_mfma_f32_32x32x16_bf16 v[48:63], v[20:23], a[100:103], v[48:63]
    ds_read_b128 v[44:47], v10 offset:992
    s_waitcnt lgkmcnt(5)
    v_mfma_f32_32x32x16_bf16 v[48:63], v[24:27], a[104:107], v[48:63]
    ds_read_b128 v[16:19], v10 offset:1024
    buffer_load_dwordx4 v2, s[28:31], s35 offen offset:1024 lds
    s_waitcnt lgkmcnt(5)
    v_mfma_f32_32x32x16_bf16 v[48:63], v[28:31], a[108:111], v[48:63]
    ds_read_b128 v[20:23], v10 offset:1056
    s_waitcnt lgkmcnt(5)
    v_mfma_f32_32x32x16_bf16 v[48:63], v[32:35], a[112:115], v[48:63]
    ds_read_b128 v[24:27], v10 offset:1088
    s_add_u32 m0, s37, 80496
    s_add_u32 s35, s36, 14336
    buffer_load_dwordx4 v2, s[28:31], s35 offen offset:0 lds
    s_waitcnt lgkmcnt(5)
    v_mfma_f32_32x32x16_bf16 v[48:63], v[36:39], a[116:119], v[48:63]
    ds_read_b128 v[28:31], v10 offset:1120
    s_waitcnt lgkmcnt(5)
    v_mfma_f32_32x32x16_bf16 v[48:63], v[40:43], a[120:123], v[48:63]
    ds_read_b128 v[32:35], v10 offset:1152
    buffer_load_dwordx4 v2, s[28:31], s35 offen offset:1024 lds
    s_waitcnt lgkmcnt(5)
    v_mfma_f32_32x32x16_bf16 v[48:63], v[44:47], a[124:127], v[48:63]
    ds_read_b128 v[36:39], v10 offset:1184
    s_waitcnt lgkmcnt(5)
    v_mfma_f32_32x32x16_bf16 v[48:63], v[16:19], a[128:131], v[48:63]
    ds_read_b128 v[40:43], v10 offset:1216
    s_waitcnt lgkmcnt(5)
    v_mfma_f32_32x32x16_bf16 v[48:63], v[20:23], a[132:135], v[48:63]
    ds_read_b128 v[44:47], v10 offset:1248
    s_waitcnt lgkmcnt(5)
    v_mfma_f32_32x32x16_bf16 v[48:63], v[24:27], a[136:139], v[48:63]
    ds_read_b128 v[16:19], v10 offset:1280
    s_waitcnt lgkmcnt(5)
    v_mfma_f32_32x32x16_bf16 v[48:63], v[28:31], a[140:143], v[48:63]
    ds_read_b128 v[20:23], v10 offset:1312
    s_waitcnt lgkmcnt(5)
    v_mfma_f32_32x32x16_bf16 v[48:63], v[32:35], a[144:147], v[48:63]
    ds_read_b128 v[24:27], v10 offset:1344
    s_waitcnt lgkmcnt(5)
    v_mfma_f32_32x32x16_bf16 v[48:63], v[36:39], a[148:151], v[48:63]
    ds_read_b128 v[28:31], v10 offset:1376
    v_mov_b32 v9, s32
    s_waitcnt vmcnt(10)
    buffer_store_dword v9, v8, s[4:7], 0 offen sc1
    s_waitcnt lgkmcnt(5)
    v_mfma_f32_32x32x16_bf16 v[48:63], v[40:43], a[152:155], v[48:63]
    ds_read_b128 v[32:35], v10 offset:1408
    s_waitcnt lgkmcnt(5)
    v_mfma_f32_32x32x16_bf16 v[48:63], v[44:47], a[156:159], v[48:63]
    ds_read_b128 v[36:39], v10 offset:1440
    s_waitcnt lgkmcnt(5)
    v_mfma_f32_32x32x16_bf16 v[48:63], v[16:19], a[160:163], v[48:63]
    ds_read_b128 v[40:43], v10 offset:1472
    s_waitcnt lgkmcnt(5)
    v_mfma_f32_32x32x16_bf16 v[48:63], v[20:23], a[164:167], v[48:63]
    ds_read_b128 v[44:47], v10 offset:1504
    s_waitcnt lgkmcnt(5)
    v_mfma_f32_32x32x16_bf16 v[48:63], v[24:27], a[168:171], v[48:63]
    ds_read_b128 v[16:19], v10 offset:1536
    s_waitcnt lgkmcnt(5)
    v_mfma_f32_32x32x16_bf16 v[48:63], v[28:31], a[172:175], v[48:63]
    ds_read_b128 v[20:23], v10 offset:1568
    s_waitcnt lgkmcnt(5)
    v_mfma_f32_32x32x16_bf16 v[48:63], v[32:35], a[176:179], v[48:63]
    ds_read_b128 v[24:27], v10 offset:1600
    s_waitcnt lgkmcnt(5)
    v_mfma_f32_32x32x16_bf16 v[48:63], v[36:39], a[180:183], v[48:63]
    ds_read_b128 v[28:31], v10 offset:1632
    s_waitcnt lgkmcnt(5)
    v_mfma_f32_32x32x16_bf16 v[48:63], v[40:43], a[184:187], v[48:63]
    ds_read_b128 v[32:35], v10 offset:1664
    s_waitcnt lgkmcnt(5)
    v_mfma_f32_32x32x16_bf16 v[48:63], v[44:47], a[188:191], v[48:63]
    ds_read_b128 v[36:39], v10 offset:1696
    s_waitcnt lgkmcnt(5)
    v_mfma_f32_32x32x16_bf16 v[48:63], v[16:19], a[192:195], v[48:63]
    ds_read_b128 v[40:43], v10 offset:1728
    s_waitcnt lgkmcnt(5)
    v_mfma_f32_32x32x16_bf16 v[48:63], v[20:23], a[196:199], v[48:63]
    ds_read_b128 v[44:47], v10 offset:1760
    s_waitcnt lgkmcnt(5)
    v_mfma_f32_32x32x16_bf16 v[48:63], v[24:27], a[200:203], v[48:63]
    ds_read_b128 v[16:19], v10 offset:1792
    s_waitcnt lgkmcnt(5)
    v_mfma_f32_32x32x16_bf16 v[48:63], v[28:31], a[204:207], v[48:63]
    ds_read_b128 v[20:23], v10 offset:1824
    s_waitcnt lgkmcnt(5)
    v_mfma_f32_32x32x16_bf16 v[48:63], v[32:35], a[208:211], v[48:63]
    ds_read_b128 v[24:27], v10 offset:1856
    s_waitcnt lgkmcnt(5)
    v_mfma_f32_32x32x16_bf16 v[48:63], v[36:39], a[212:215], v[48:63]
    ds_read_b128 v[28:31], v10 offset:1888
    s_waitcnt lgkmcnt(5)
    v_mfma_f32_32x32x16_bf16 v[48:63], v[40:43], a[216:219], v[48:63]
    ds_read_b128 v[32:35], v10 offset:1920
    s_waitcnt lgkmcnt(5)
    v_mfma_f32_32x32x16_bf16 v[48:63], v[44:47], a[220:223], v[48:63]
    ds_read_b128 v[36:39], v10 offset:1952
    s_waitcnt lgkmcnt(5)
    v_mfma_f32_32x32x16_bf16 v[48:63], v[16:19], a[224:227], v[48:63]
    ds_read_b128 v[40:43], v10 offset:1984
    s_waitcnt lgkmcnt(5)
    v_mfma_f32_32x32x16_bf16 v[48:63], v[20:23], a[228:231], v[48:63]
    ds_read_b128 v[44:47], v10 offset:2016
    s_add_u32 s32, s32, 1
    s_waitcnt lgkmcnt(5)
    v_mfma_f32_32x32x16_bf16 v[48:63], v[24:27], a[232:235], v[48:63]
    s_waitcnt lgkmcnt(4)
    v_mfma_f32_32x32x16_bf16 v[48:63], v[28:31], a[236:239], v[48:63]
    s_waitcnt lgkmcnt(0)
    s_waitcnt vmcnt(1)
    s_barrier
    ds_read_b128 v[16:19], v11 offset:0
    ds_read_b128 v[20:23], v11 offset:32
    v_mfma_f32_32x32x16_bf16 v[48:63], v[32:35], a[240:243], v[48:63]
    ds_read_b128 v[24:27], v11 offset:64
    ds_read_b128 v[28:31], v11 offset:96
    v_mfma_f32_32x32x16_bf16 v[48:63], v[36:39], a[244:247], v[48:63]
    ds_read_b128 v[32:35], v11 offset:128
    ds_read_b128 v[36:39], v11 offset:160
    v_mfma_f32_32x32x16_bf16 v[48:63], v[40:43], a[248:251], v[48:63]
    v_mfma_f32_32x32x16_bf16 v[48:63], v[44:47], a[252:255], v[48:63]
    s_waitcnt lgkmcnt(5)
    v_mfma_f32_32x32x16_bf16 v[64:79], v[16:19], a[0:3], 0
    ds_read_b128 v[40:43], v11 offset:192
    s_add_u32 s36, s36, 65536
    s_add_u32 m0, s37, 0
    s_add_u32 s35, s36, 0
    buffer_load_dwordx4 v2, s[28:31], s35 offen offset:0 lds
    s_waitcnt lgkmcnt(5)
    v_mfma_f32_32x32x16_bf16 v[64:79], v[20:23], a[4:7], v[64:79]
    ds_read_b128 v[44:47], v11 offset:224
    s_waitcnt lgkmcnt(5)
    v_mfma_f32_32x32x16_bf16 v[64:79], v[24:27], a[8:11], v[64:79]
    ds_read_b128 v[16:19], v11 offset:256
    buffer_load_dwordx4 v2, s[28:31], s35 offen offset:1024 lds
    s_waitcnt lgkmcnt(5)
    v_mfma_f32_32x32x16_bf16 v[64:79], v[28:31], a[12:15], v[64:79]
    ds_read_b128 v[20:23], v11 offset:288
    s_waitcnt lgkmcnt(5)
    v_mfma_f32_32x32x16_bf16 v[64:79], v[32:35], a[16:19], v[64:79]
    ds_read_b128 v[24:27], v11 offset:320
    s_add_u32 m0, s37, 2064
    s_add_u32 s35, s36, 2048
    buffer_load_dwordx4 v2, s[28:31], s35 offen offset:0 lds
    v_cvt_pk_bf16_f32 v80, v48, v49
    v_cvt_pk_bf16_f32 v81, v50, v51
    s_waitcnt lgkmcnt(5)
    v_mfma_f32_32x32x16_bf16 v[64:79], v[36:39], a[20:23], v[64:79]
    ds_read_b128 v[28:31], v11 offset:352
    v_cvt_pk_bf16_f32 v82, v52, v53
    v_cvt_pk_bf16_f32 v83, v54, v55
    s_waitcnt lgkmcnt(5)
    v_mfma_f32_32x32x16_bf16 v[64:79], v[40:43], a[24:27], v[64:79]
    ds_read_b128 v[32:35], v11 offset:384
    buffer_load_dwordx4 v2, s[28:31], s35 offen offset:1024 lds
    v_cvt_pk_bf16_f32 v84, v56, v57
    v_cvt_pk_bf16_f32 v85, v58, v59
    s_waitcnt lgkmcnt(5)
    v_mfma_f32_32x32x16_bf16 v[64:79], v[44:47], a[28:31], v[64:79]
    ds_read_b128 v[36:39], v11 offset:416
    v_cvt_pk_bf16_f32 v86, v60, v61
    v_cvt_pk_bf16_f32 v87, v62, v63
    s_waitcnt lgkmcnt(5)
    v_mfma_f32_32x32x16_bf16 v[64:79], v[16:19], a[32:35], v[64:79]
    ds_read_b128 v[40:43], v11 offset:448
    s_add_u32 m0, s37, 4128
    s_add_u32 s35, s36, 4096
    buffer_load_dwordx4 v2, s[28:31], s35 offen offset:0 lds
    s_waitcnt lgkmcnt(5)
    v_mfma_f32_32x32x16_bf16 v[64:79], v[20:23], a[36:39], v[64:79]
    ds_read_b128 v[44:47], v11 offset:480
    buffer_store_dwordx4 v[80:83], v2, s[4:7], s38 offen sc1
    s_waitcnt lgkmcnt(5)
    v_mfma_f32_32x32x16_bf16 v[64:79], v[24:27], a[40:43], v[64:79]
    ds_read_b128 v[16:19], v11 offset:512
    buffer_load_dwordx4 v2, s[28:31], s35 offen offset:1024 lds
    s_waitcnt lgkmcnt(5)
    v_mfma_f32_32x32x16_bf16 v[64:79], v[28:31], a[44:47], v[64:79]
    ds_read_b128 v[20:23], v11 offset:544
    buffer_store_dwordx4 v[84:87], v2, s[4:7], s38 offen offset:1024 sc1
    s_add_u32 s38, s38, 0x40000
    s_bitset0_b32 s38, 30
    s_waitcnt lgkmcnt(5)
    v_mfma_f32_32x32x16_bf16 v[64:79], v[32:35], a[48:51], v[64:79]
    ds_read_b128 v[24:27], v11 offset:576
    s_add_u32 m0, s37, 6192
    s_add_u32 s35, s36, 6144
    buffer_load_dwordx4 v2, s[28:31], s35 offen offset:0 lds
    s_waitcnt lgkmcnt(5)
    v_mfma_f32_32x32x16_bf16 v[64:79], v[36:39], a[52:55], v[64:79]
    ds_read_b128 v[28:31], v11 offset:608
    s_waitcnt lgkmcnt(5)
    v_mfma_f32_32x32x16_bf16 v[64:79], v[40:43], a[56:59], v[64:79]
    ds_read_b128 v[32:35], v11 offset:640
    buffer_load_dwordx4 v2, s[28:31], s35 offen offset:1024 lds
    s_waitcnt lgkmcnt(5)
    v_mfma_f32_32x32x16_bf16 v[64:79], v[44:47], a[60:63], v[64:79]
    ds_read_b128 v[36:39], v11 offset:672
    s_waitcnt lgkmcnt(5)
    v_mfma_f32_32x32x16_bf16 v[64:79], v[16:19], a[64:67], v[64:79]
    ds_read_b128 v[40:43], v11 offset:704
    s_add_u32 m0, s37, 8256
    s_add_u32 s35, s36, 8192
    buffer_load_dwordx4 v2, s[28:31], s35 offen offset:0 lds
    s_waitcnt lgkmcnt(5)
    v_mfma_f32_32x32x16_bf16 v[64:79], v[20:23], a[68:71], v[64:79]
    ds_read_b128 v[44:47], v11 offset:736
    s_waitcnt lgkmcnt(5)
    v_mfma_f32_32x32x16_bf16 v[64:79], v[24:27], a[72:75], v[64:79]
    ds_read_b128 v[16:19], v11 offset:768
    buffer_load_dwordx4 v2, s[28:31], s35 offen offset:1024 lds
    s_waitcnt lgkmcnt(5)
    v_mfma_f32_32x32x16_bf16 v[64:79], v[28:31], a[76:79], v[64:79]
    ds_read_b128 v[20:23], v11 offset:800
    s_waitcnt lgkmcnt(5)
    v_mfma_f32_32x32x16_bf16 v[64:79], v[32:35], a[80:83], v[64:79]
    ds_read_b128 v[24:27], v11 offset:832
    s_add_u32 m0, s37, 10320
    s_add_u32 s35, s36, 10240
    buffer_load_dwordx4 v2, s[28:31], s35 offen offset:0 lds
    s_waitcnt lgkmcnt(5)
    v_mfma_f32_32x32x16_bf16 v[64:79], v[36:39], a[84:87], v[64:79]
    ds_read_b128 v[28:31], v11 offset:864
    s_waitcnt lgkmcnt(5)
    v_mfma_f32_32x32x16_bf16 v[64:79], v[40:43], a[88:91], v[64:79]
    ds_read_b128 v[32:35], v11 offset:896
    buffer_load_dwordx4 v2, s[28:31], s35 offen offset:1024 lds
    s_waitcnt lgkmcnt(5)
    v_mfma_f32_32x32x16_bf16 v[64:79], v[44:47], a[92:95], v[64:79]
    ds_read_b128 v[36:39], v11 offset:928
    s_waitcnt lgkmcnt(5)
    v_mfma_f32_32x32x16_bf16 v[64:79], v[16:19], a[96:99], v[64:79]
    ds_read_b128 v[40:43], v11 offset:960
    s_add_u32 m0, s37, 12384
    s_add_u32 s35, s36, 12288
    buffer_load_dwordx4 v2, s[28:31], s35 offen offset:0 lds
    s_waitcnt lgkmcnt(5)
    v_mfma_f32_32x32x16_bf16 v[64:79], v[20:23], a[100:103], v[64:79]
    ds_read_b128 v[44:47], v11 offset:992
    s_waitcnt lgkmcnt(5)
    v_mfma_f32_32x32x16_bf16 v[64:79], v[24:27], a[104:107], v[64:79]
    ds_read_b128 v[16:19], v11 offset:1024
    buffer_load_dwordx4 v2, s[28:31], s35 offen offset:1024 lds
    s_waitcnt lgkmcnt(5)
    v_mfma_f32_32x32x16_bf16 v[64:79], v[28:31], a[108:111], v[64:79]
    ds_read_b128 v[20:23], v11 offset:1056
    s_waitcnt lgkmcnt(5)
    v_mfma_f32_32x32x16_bf16 v[64:79], v[32:35], a[112:115], v[64:79]
    ds_read_b128 v[24:27], v11 offset:1088
    s_add_u32 m0, s37, 14448
    s_add_u32 s35, s36, 14336
    buffer_load_dwordx4 v2, s[28:31], s35 offen offset:0 lds
    s_waitcnt lgkmcnt(5)
    v_mfma_f32_32x32x16_bf16 v[64:79], v[36:39], a[116:119], v[64:79]
    ds_read_b128 v[28:31], v11 offset:1120
    s_waitcnt lgkmcnt(5)
    v_mfma_f32_32x32x16_bf16 v[64:79], v[40:43], a[120:123], v[64:79]
    ds_read_b128 v[32:35], v11 offset:1152
    buffer_load_dwordx4 v2, s[28:31], s35 offen offset:1024 lds
    s_waitcnt lgkmcnt(5)
    v_mfma_f32_32x32x16_bf16 v[64:79], v[44:47], a[124:127], v[64:79]
    ds_read_b128 v[36:39], v11 offset:1184
    s_waitcnt lgkmcnt(5)
    v_mfma_f32_32x32x16_bf16 v[64:79], v[16:19], a[128:131], v[64:79]
    ds_read_b128 v[40:43], v11 offset:1216
    s_waitcnt lgkmcnt(5)
    v_mfma_f32_32x32x16_bf16 v[64:79], v[20:23], a[132:135], v[64:79]
    ds_read_b128 v[44:47], v11 offset:1248
    s_waitcnt lgkmcnt(5)
    v_mfma_f32_32x32x16_bf16 v[64:79], v[24:27], a[136:139], v[64:79]
    ds_read_b128 v[16:19], v11 offset:1280
    s_waitcnt lgkmcnt(5)
    v_mfma_f32_32x32x16_bf16 v[64:79], v[28:31], a[140:143], v[64:79]
    ds_read_b128 v[20:23], v11 offset:1312
    s_waitcnt lgkmcnt(5)
    v_mfma_f32_32x32x16_bf16 v[64:79], v[32:35], a[144:147], v[64:79]
    ds_read_b128 v[24:27], v11 offset:1344
    s_waitcnt lgkmcnt(5)
    v_mfma_f32_32x32x16_bf16 v[64:79], v[36:39], a[148:151], v[64:79]
    ds_read_b128 v[28:31], v11 offset:1376
    v_mov_b32 v9, s32
    s_waitcnt vmcnt(10)
    buffer_store_dword v9, v8, s[4:7], 0 offen sc1
    s_waitcnt lgkmcnt(5)
    v_mfma_f32_32x32x16_bf16 v[64:79], v[40:43], a[152:155], v[64:79]
    ds_read_b128 v[32:35], v11 offset:1408
    s_waitcnt lgkmcnt(5)
    v_mfma_f32_32x32x16_bf16 v[64:79], v[44:47], a[156:159], v[64:79]
    ds_read_b128 v[36:39], v11 offset:1440
    s_waitcnt lgkmcnt(5)
    v_mfma_f32_32x32x16_bf16 v[64:79], v[16:19], a[160:163], v[64:79]
    ds_read_b128 v[40:43], v11 offset:1472
    s_waitcnt lgkmcnt(5)
    v_mfma_f32_32x32x16_bf16 v[64:79], v[20:23], a[164:167], v[64:79]
    ds_read_b128 v[44:47], v11 offset:1504
    s_waitcnt lgkmcnt(5)
    v_mfma_f32_32x32x16_bf16 v[64:79], v[24:27], a[168:171], v[64:79]
    ds_read_b128 v[16:19], v11 offset:1536
    s_waitcnt lgkmcnt(5)
    v_mfma_f32_32x32x16_bf16 v[64:79], v[28:31], a[172:175], v[64:79]
    ds_read_b128 v[20:23], v11 offset:1568
    s_waitcnt lgkmcnt(5)
    v_mfma_f32_32x32x16_bf16 v[64:79], v[32:35], a[176:179], v[64:79]
    ds_read_b128 v[24:27], v11 offset:1600
    s_waitcnt lgkmcnt(5)
    v_mfma_f32_32x32x16_bf16 v[64:79], v[36:39], a[180:183], v[64:79]
    ds_read_b128 v[28:31], v11 offset:1632
    s_waitcnt lgkmcnt(5)
    v_mfma_f32_32x32x16_bf16 v[64:79], v[40:43], a[184:187], v[64:79]
    ds_read_b128 v[32:35], v11 offset:1664
    s_waitcnt lgkmcnt(5)
    v_mfma_f32_32x32x16_bf16 v[64:79], v[44:47], a[188:191], v[64:79]
    ds_read_b128 v[36:39], v11 offset:1696
    s_waitcnt lgkmcnt(5)
    v_mfma_f32_32x32x16_bf16 v[64:79], v[16:19], a[192:195], v[64:79]
    ds_read_b128 v[40:43], v11 offset:1728
    s_waitcnt lgkmcnt(5)
    v_mfma_f32_32x32x16_bf16 v[64:79], v[20:23], a[196:199], v[64:79]
    ds_read_b128 v[44:47], v11 offset:1760
    s_waitcnt lgkmcnt(5)
    v_mfma_f32_32x32x16_bf16 v[64:79], v[24:27], a[200:203], v[64:79]
    ds_read_b128 v[16:19], v11 offset:1792
    s_waitcnt lgkmcnt(5)
    v_mfma_f32_32x32x16_bf16 v[64:79], v[28:31], a[204:207], v[64:79]
    ds_read_b128 v[20:23], v11 offset:1824
    s_waitcnt lgkmcnt(5)
    v_mfma_f32_32x32x16_bf16 v[64:79], v[32:35], a[208:211], v[64:79]
    ds_read_b128 v[24:27], v11 offset:1856
    s_waitcnt lgkmcnt(5)
    v_mfma_f32_32x32x16_bf16 v[64:79], v[36:39], a[212:215], v[64:79]
    ds_read_b128 v[28:31], v11 offset:1888
    s_waitcnt lgkmcnt(5)
    v_mfma_f32_32x32x16_bf16 v[64:79], v[40:43], a[216:219], v[64:79]
    ds_read_b128 v[32:35], v11 offset:1920
    s_waitcnt lgkmcnt(5)
    v_mfma_f32_32x32x16_bf16 v[64:79], v[44:47], a[220:223], v[64:79]
    ds_read_b128 v[36:39], v11 offset:1952
    s_waitcnt lgkmcnt(5)
    v_mfma_f32_32x32x16_bf16 v[64:79], v[16:19], a[224:227], v[64:79]
    ds_read_b128 v[40:43], v11 offset:1984
    s_waitcnt lgkmcnt(5)
    v_mfma_f32_32x32x16_bf16 v[64:79], v[20:23], a[228:231], v[64:79]
    ds_read_b128 v[44:47], v11 offset:2016
    s_add_u32 s32, s32, 1
    s_waitcnt lgkmcnt(5)
    v_mfma_f32_32x32x16_bf16 v[64:79], v[24:27], a[232:235], v[64:79]
    s_waitcnt lgkmcnt(4)
    v_mfma_f32_32x32x16_bf16 v[64:79], v[28:31], a[236:239], v[64:79]
    s_waitcnt lgkmcnt(0)
    s_waitcnt vmcnt(1)
    s_barrier
    ds_read_b128 v[16:19], v10 offset:0
    ds_read_b128 v[20:23], v10 offset:32
    v_mfma_f32_32x32x16_bf16 v[64:79], v[32:35], a[240:243], v[64:79]
    ds_read_b128 v[24:27], v10 offset:64
    ds_read_b128 v[28:31], v10 offset:96
    v_mfma_f32_32x32x16_bf16 v[64:79], v[36:39], a[244:247], v[64:79]
    ds_read_b128 v[32:35], v10 offset:128
    ds_read_b128 v[36:39], v10 offset:160
    v_mfma_f32_32x32x16_bf16 v[64:79], v[40:43], a[248:251], v[64:79]
    v_mfma_f32_32x32x16_bf16 v[64:79], v[44:47], a[252:255], v[64:79]
    s_cmp_lt_u32 s32, 64
    s_cbranch_scc1 L_rV_loop
    s_nop 11
    v_cvt_pk_bf16_f32 v80, v64, v65
    v_cvt_pk_bf16_f32 v81, v66, v67
    v_cvt_pk_bf16_f32 v82, v68, v69
    v_cvt_pk_bf16_f32 v83, v70, v71
    v_cvt_pk_bf16_f32 v84, v72, v73
    v_cvt_pk_bf16_f32 v85, v74, v75
    v_cvt_pk_bf16_f32 v86, v76, v77
    v_cvt_pk_bf16_f32 v87, v78, v79
    buffer_store_dwordx4 v[80:83], v2, s[4:7], s38 offen sc1
    buffer_store_dwordx4 v[84:87], v2, s[4:7], s38 offen offset:1024 sc1
    s_add_u32 s38, s38, 0x40000
    v_mov_b32 v9, 64
    s_waitcnt vmcnt(0)
    buffer_store_dword v9, v8, s[4:7], 0 offen sc1
    s_waitcnt vmcnt(0) lgkmcnt(0)
    s_barrier
    s_branch L_done
L_role_Q:
    v_and_b32 v1, 63, v0
    v_lshlrev_b32 v2, 4, v1
    v_bfrev_b32 v7, 1
    s_mov_b32 s40, 0
    v_and_b32 v5, 0x13, v1
    v_bfe_u32 v3, v1, 2, 1
    v_lshl_add_u32 v5, v3, 3, v5
    v_bfe_u32 v3, v1, 3, 1
    v_lshl_add_u32 v5, v3, 2, v5
    v_lshrrev_b32 v4, 5, v1
    v_lshlrev_b32 v3, 9, v4
    v_lshl_add_u32 v6, v5, 4, v3
    v_and_b32 v3, 31, v1
    v_mul_u32_u24 v3, 2064, v3
    v_lshl_add_u32 v10, v4, 4, v3
    v_add_u32 v11, 66048, v10
    s_lshl_b32 s33, s17, 4
    s_add_u32 s33, s33, 3743744
    s_lshl_b32 s34, s18, 2
    s_add_u32 s33, s33, s34
    v_mov_b32 v3, s33
    v_cmp_eq_u32 vcc, 0, v1
    v_mov_b32 v9, 0
    s_nop 0
    v_cndmask_b32 v8, v7, v3, vcc
    buffer_store_dword v9, v8, s[4:7], 0 offen sc1
    s_waitcnt vmcnt(0)
    s_barrier
    s_cmp_lg_u32 s18, 0
    s_cbranch_scc1 L_sig_10
    v_mov_b32 v3, s22
    v_mov_b32 v4, 1
    s_mov_b64 exec, 1
    buffer_atomic_add v4, v3, s[12:15], 0 offen sc1
    s_mov_b64 exec, -1
L_sig_10:
    s_load_dwordx2 s[8:9], s[0:1], 16
    s_mov_b32 s10, 8388608
    s_mov_b32 s11, 0x20000
    v_lshrrev_b32 v80, 2, v1
    v_lshlrev_b32 v80, 13, v80
    v_and_b32 v3, 3, v1
    v_lshl_add_u32 v80, v3, 4, v80
    s_lshl_b32 s33, s17, 8
    s_lshl_b32 s34, s18, 6
    s_add_u32 s33, s33, s34
    v_bfe_u32 v81, v1, 2, 2
    v_lshrrev_b32 v3, 5, v1
    v_lshl_add_u32 v81, v3, 3, v81
    v_lshlrev_b32 v81, 6, v81
    v_bfe_u32 v3, v1, 4, 1
    v_lshl_add_u32 v81, v3, 5, v81
    v_and_b32 v3, 1, v1
    v_lshl_add_u32 v81, v3, 4, v81
    v_bfe_u32 v3, v1, 1, 1
    v_lshl_add_u32 v81, v3, 3, v81
    s_lshl_b32 s35, s18, 15
    v_add_u32 v81, s35, v81
    s_waitcnt lgkmcnt(0)
    s_add_u32 s34, s35, 0
    s_mov_b32 m0, s34
    s_add_u32 s34, s34, 1024
    buffer_load_dwordx4 v80, s[8:11], s33 offen lds
    s_add_u32 s33, s33, 131072
    s_mov_b32 m0, s34
    s_add_u32 s34, s34, 1024
    buffer_load_dwordx4 v80, s[8:11], s33 offen lds
    s_add_u32 s33, s33, 131072
    s_mov_b32 m0, s34
    s_add_u32 s34, s34, 1024
    buffer_load_dwordx4 v80, s[8:11], s33 offen lds
    s_add_u32 s33, s33, 131072
    s_mov_b32 m0, s34
    s_add_u32 s34, s34, 1024
    buffer_load_dwordx4 v80, s[8:11], s33 offen lds
    s_add_u32 s33, s33, 131072
    s_mov_b32 m0, s34
    s_add_u32 s34, s34, 1024
    buffer_load_dwordx4 v80, s[8:11], s33 offen lds
    s_add_u32 s33, s33, 131072
    s_mov_b32 m0, s34
    s_add_u32 s34, s34, 1024
    buffer_load_dwordx4 v80, s[8:11], s33 offen lds
    s_add_u32 s33, s33, 131072
    s_mov_b32 m0, s34
    s_add_u32 s34, s34, 1024
    buffer_load_dwordx4 v80, s[8:11], s33 offen lds
    s_add_u32 s33, s33, 131072
    s_mov_b32 m0, s34
    s_add_u32 s34, s34, 1024
    buffer_load_dwordx4 v80, s[8:11], s33 offen lds
    s_add_u32 s33, s33, 131072
    s_mov_b32 m0, s34
    s_add_u32 s34, s34, 1024
    buffer_load_dwordx4 v80, s[8:11], s33 offen lds
    s_add_u32 s33, s33, 131072
    s_mov_b32 m0, s34
    s_add_u32 s34, s34, 1024
    buffer_load_dwordx4 v80, s[8:11], s33 offen lds
    s_add_u32 s33, s33, 131072
    s_mov_b32 m0, s34
    s_add_u32 s34, s34, 1024
    buffer_load_dwordx4 v80, s[8:11], s33 offen lds
    s_add_u32 s33, s33, 131072
    s_mov_b32 m0, s34
    s_add_u32 s34, s34, 1024
    buffer_load_dwordx4 v80, s[8:11], s33 offen lds
    s_add_u32 s33, s33, 131072
    s_mov_b32 m0, s34
    s_add_u32 s34, s34, 1024
    buffer_load_dwordx4 v80, s[8:11], s33 offen lds
    s_add_u32 s33, s33, 131072
    s_mov_b32 m0, s34
    s_add_u32 s34, s34, 1024
    buffer_load_dwordx4 v80, s[8:11], s33 offen lds
    s_add_u32 s33, s33, 131072
    s_mov_b32 m0, s34
    s_add_u32 s34, s34, 1024
    buffer_load_dwordx4 v80, s[8:11], s33 offen lds
    s_add_u32 s33, s33, 131072
    s_mov_b32 m0, s34
    s_add_u32 s34, s34, 1024
    buffer_load_dwordx4 v80, s[8:11], s33 offen lds
    s_add_u32 s33, s33, 131072
    s_add_u32 s34, s35, 16384
    s_mov_b32 m0, s34
    s_add_u32 s34, s34, 1024
    buffer_load_dwordx4 v80, s[8:11], s33 offen lds
    s_add_u32 s33, s33, 131072
    s_mov_b32 m0, s34
    s_add_u32 s34, s34, 1024
    buffer_load_dwordx4 v80, s[8:11], s33 offen lds
    s_add_u32 s33, s33, 131072
    s_mov_b32 m0, s34
    s_add_u32 s34, s34, 1024
    buffer_load_dwordx4 v80, s[8:11], s33 offen lds
    s_add_u32 s33, s33, 131072
    s_mov_b32 m0, s34
    s_add_u32 s34, s34, 1024
    buffer_load_dwordx4 v80, s[8:11], s33 offen lds
    s_add_u32 s33, s33, 131072
    s_mov_b32 m0, s34
    s_add_u32 s34, s34, 1024
    buffer_load_dwordx4 v80, s[8:11], s33 offen lds
    s_add_u32 s33, s33, 131072
    s_mov_b32 m0, s34
    s_add_u32 s34, s34, 1024
    buffer_load_dwordx4 v80, s[8:11], s33 offen lds
    s_add_u32 s33, s33, 131072
    s_mov_b32 m0, s34
    s_add_u32 s34, s34, 1024
    buffer_load_dwordx4 v80, s[8:11], s33 offen lds
    s_add_u32 s33, s33, 131072
    s_mov_b32 m0, s34
    s_add_u32 s34, s34, 1024
    buffer_load_dwordx4 v80, s[8:11], s33 offen lds
    s_add_u32 s33, s33, 131072
    s_mov_b32 m0, s34
    s_add_u32 s34, s34, 1024
    buffer_load_dwordx4 v80, s[8:11], s33 offen lds
    s_add_u32 s33, s33, 131072
    s_mov_b32 m0, s34
    s_add_u32 s34, s34, 1024
    buffer_load_dwordx4 v80, s[8:11], s33 offen lds
    s_add_u32 s33, s33, 131072
    s_mov_b32 m0, s34
    s_add_u32 s34, s34, 1024
    buffer_load_dwordx4 v80, s[8:11], s33 offen lds
    s_add_u32 s33, s33, 131072
    s_mov_b32 m0, s34
    s_add_u32 s34, s34, 1024
    buffer_load_dwordx4 v80, s[8:11], s33 offen lds
    s_add_u32 s33, s33, 131072
    s_mov_b32 m0, s34
    s_add_u32 s34, s34, 1024
    buffer_load_dwordx4 v80, s[8:11], s33 offen lds
    s_add_u32 s33, s33, 131072
    s_mov_b32 m0, s34
    s_add_u32 s34, s34, 1024
    buffer_load_dwordx4 v80, s[8:11], s33 offen lds
    s_add_u32 s33, s33, 131072
    s_mov_b32 m0, s34
    s_add_u32 s34, s34, 1024
    buffer_load_dwordx4 v80, s[8:11], s33 offen lds
    s_add_u32 s33, s33, 131072
    s_mov_b32 m0, s34
    s_add_u32 s34, s34, 1024
    buffer_load_dwordx4 v80, s[8:11], s33 offen lds
    s_add_u32 s33, s33, 131072
    s_waitcnt vmcnt(16)
    ds_read_b64_tr_b16 a[0:1], v81 offset:0
    ds_read_b64_tr_b16 a[2:3], v81 offset:256
    ds_read_b64_tr_b16 a[4:5], v81 offset:1024
    ds_read_b64_tr_b16 a[6:7], v81 offset:1280
    ds_read_b64_tr_b16 a[8:9], v81 offset:2048
    ds_read_b64_tr_b16 a[10:11], v81 offset:2304
    ds_read_b64_tr_b16 a[12:13], v81 offset:3072
    ds_read_b64_tr_b16 a[14:15], v81 offset:3328
    s_waitcnt lgkmcnt(0)
    ds_read_b64_tr_b16 a[16:17], v81 offset:4096
    ds_read_b64_tr_b16 a[18:19], v81 offset:4352
    ds_read_b64_tr_b16 a[20:21], v81 offset:5120
    ds_read_b64_tr_b16 a[22:23], v81 offset:5376
    ds_read_b64_tr_b16 a[24:25], v81 offset:6144
    ds_read_b64_tr_b16 a[26:27], v81 offset:6400
    ds_read_b64_tr_b16 a[28:29], v81 offset:7168
    ds_read_b64_tr_b16 a[30:31], v81 offset:7424
    s_waitcnt lgkmcnt(0)
    ds_read_b64_tr_b16 a[32:33], v81 offset:8192
    ds_read_b64_tr_b16 a[34:35], v81 offset:8448
    ds_read_b64_tr_b16 a[36:37], v81 offset:9216
    ds_read_b64_tr_b16 a[38:39], v81 offset:9472
    ds_read_b64_tr_b16 a[40:41], v81 offset:10240
    ds_read_b64_tr_b16 a[42:43], v81 offset:10496
    ds_read_b64_tr_b16 a[44:45], v81 offset:11264
    ds_read_b64_tr_b16 a[46:47], v81 offset:11520
    s_waitcnt lgkmcnt(0)
    ds_read_b64_tr_b16 a[48:49], v81 offset:12288
    ds_read_b64_tr_b16 a[50:51], v81 offset:12544
    ds_read_b64_tr_b16 a[52:53], v81 offset:13312
    ds_read_b64_tr_b16 a[54:55], v81 offset:13568
    ds_read_b64_tr_b16 a[56:57], v81 offset:14336
    ds_read_b64_tr_b16 a[58:59], v81 offset:14592
    ds_read_b64_tr_b16 a[60:61], v81 offset:15360
    ds_read_b64_tr_b16 a[62:63], v81 offset:15616
    s_waitcnt lgkmcnt(0)
    s_add_u32 s34, s35, 0
    s_mov_b32 m0, s34
    s_add_u32 s34, s34, 1024
    buffer_load_dwordx4 v80, s[8:11], s33 offen lds
    s_add_u32 s33, s33, 131072
    s_mov_b32 m0, s34
    s_add_u32 s34, s34, 1024
    buffer_load_dwordx4 v80, s[8:11], s33 offen lds
    s_add_u32 s33, s33, 131072
    s_mov_b32 m0, s34
    s_add_u32 s34, s34, 1024
    buffer_load_dwordx4 v80, s[8:11], s33 offen lds
    s_add_u32 s33, s33, 131072
    s_mov_b32 m0, s34
    s_add_u32 s34, s34, 1024
    buffer_load_dwordx4 v80, s[8:11], s33 offen lds
    s_add_u32 s33, s33, 131072
    s_mov_b32 m0, s34
    s_add_u32 s34, s34, 1024
    buffer_load_dwordx4 v80, s[8:11], s33 offen lds
    s_add_u32 s33, s33, 131072
    s_mov_b32 m0, s34
    s_add_u32 s34, s34, 1024
    buffer_load_dwordx4 v80, s[8:11], s33 offen lds
    s_add_u32 s33, s33, 131072
    s_mov_b32 m0, s34
    s_add_u32 s34, s34, 1024
    buffer_load_dwordx4 v80, s[8:11], s33 offen lds
    s_add_u32 s33, s33, 131072
    s_mov_b32 m0, s34
    s_add_u32 s34, s34, 1024
    buffer_load_dwordx4 v80, s[8:11], s33 offen lds
    s_add_u32 s33, s33, 131072
    s_mov_b32 m0, s34
    s_add_u32 s34, s34, 1024
    buffer_load_dwordx4 v80, s[8:11], s33 offen lds
    s_add_u32 s33, s33, 131072
    s_mov_b32 m0, s34
    s_add_u32 s34, s34, 1024
    buffer_load_dwordx4 v80, s[8:11], s33 offen lds
    s_add_u32 s33, s33, 131072
    s_mov_b32 m0, s34
    s_add_u32 s34, s34, 1024
    buffer_load_dwordx4 v80, s[8:11], s33 offen lds
    s_add_u32 s33, s33, 131072
    s_mov_b32 m0, s34
    s_add_u32 s34, s34, 1024
    buffer_load_dwordx4 v80, s[8:11], s33 offen lds
    s_add_u32 s33, s33, 131072
    s_mov_b32 m0, s34
    s_add_u32 s34, s34, 1024
    buffer_load_dwordx4 v80, s[8:11], s33 offen lds
    s_add_u32 s33, s33, 131072
    s_mov_b32 m0, s34
    s_add_u32 s34, s34, 1024
    buffer_load_dwordx4 v80, s[8:11], s33 offen lds
    s_add_u32 s33, s33, 131072
    s_mov_b32 m0, s34
    s_add_u32 s34, s34, 1024
    buffer_load_dwordx4 v80, s[8:11], s33 offen lds
    s_add_u32 s33, s33, 131072
    s_mov_b32 m0, s34
    s_add_u32 s34, s34, 1024
    buffer_load_dwordx4 v80, s[8:11], s33 offen lds
    s_add_u32 s33, s33, 131072
    s_waitcnt vmcnt(16)
    ds_read_b64_tr_b16 a[64:65], v81 offset:16384
    ds_read_b64_tr_b16 a[66:67], v81 offset:16640
    ds_read_b64_tr_b16 a[68:69], v81 offset:17408
    ds_read_b64_tr_b16 a[70:71], v81 offset:17664
    ds_read_b64_tr_b16 a[72:73], v81 offset:18432
    ds_read_b64_tr_b16 a[74:75], v81 offset:18688
    ds_read_b64_tr_b16 a[76:77], v81 offset:19456
    ds_read_b64_tr_b16 a[78:79], v81 offset:19712
    s_waitcnt lgkmcnt(0)
    ds_read_b64_tr_b16 a[80:81], v81 offset:20480
    ds_read_b64_tr_b16 a[82:83], v81 offset:20736
    ds_read_b64_tr_b16 a[84:85], v81 offset:21504
    ds_read_b64_tr_b16 a[86:87], v81 offset:21760
    ds_read_b64_tr_b16 a[88:89], v81 offset:22528
    ds_read_b64_tr_b16 a[90:91], v81 offset:22784
    ds_read_b64_tr_b16 a[92:93], v81 offset:23552
    ds_read_b64_tr_b16 a[94:95], v81 offset:23808
    s_waitcnt lgkmcnt(0)
    ds_read_b64_tr_b16 a[96:97], v81 offset:24576
    ds_read_b64_tr_b16 a[98:99], v81 offset:24832
    ds_read_b64_tr_b16 a[100:101], v81 offset:25600
    ds_read_b64_tr_b16 a[102:103], v81 offset:25856
    ds_read_b64_tr_b16 a[104:105], v81 offset:26624
    ds_read_b64_tr_b16 a[106:107], v81 offset:26880
    ds_read_b64_tr_b16 a[108:109], v81 offset:27648
    ds_read_b64_tr_b16 a[110:111], v81 offset:27904
    s_waitcnt lgkmcnt(0)
    ds_read_b64_tr_b16 a[112:113], v81 offset:28672
    ds_read_b64_tr_b16 a[114:115], v81 offset:28928
    ds_read_b64_tr_b16 a[116:117], v81 offset:29696
    ds_read_b64_tr_b16 a[118:119], v81 offset:29952
    ds_read_b64_tr_b16 a[120:121], v81 offset:30720
    ds_read_b64_tr_b16 a[122:123], v81 offset:30976
    ds_read_b64_tr_b16 a[124:125], v81 offset:31744
    ds_read_b64_tr_b16 a[126:127], v81 offset:32000
    s_waitcnt lgkmcnt(0)
    s_add_u32 s34, s35, 16384
    s_mov_b32 m0, s34
    s_add_u32 s34, s34, 1024
    buffer_load_dwordx4 v80, s[8:11], s33 offen lds
    s_add_u32 s33, s33, 131072
    s_mov_b32 m0, s34
    s_add_u32 s34, s34, 1024
    buffer_load_dwordx4 v80, s[8:11], s33 offen lds
    s_add_u32 s33, s33, 131072
    s_mov_b32 m0, s34
    s_add_u32 s34, s34, 1024
    buffer_load_dwordx4 v80, s[8:11], s33 offen lds
    s_add_u32 s33, s33, 131072
    s_mov_b32 m0, s34
    s_add_u32 s34, s34, 1024
    buffer_load_dwordx4 v80, s[8:11], s33 offen lds
    s_add_u32 s33, s33, 131072
    s_mov_b32 m0, s34
    s_add_u32 s34, s34, 1024
    buffer_load_dwordx4 v80, s[8:11], s33 offen lds
    s_add_u32 s33, s33, 131072
    s_mov_b32 m0, s34
    s_add_u32 s34, s34, 1024
    buffer_load_dwordx4 v80, s[8:11], s33 offen lds
    s_add_u32 s33, s33, 131072
    s_mov_b32 m0, s34
    s_add_u32 s34, s34, 1024
    buffer_load_dwordx4 v80, s[8:11], s33 offen lds
    s_add_u32 s33, s33, 131072
    s_mov_b32 m0, s34
    s_add_u32 s34, s34, 1024
    buffer_load_dwordx4 v80, s[8:11], s33 offen lds
    s_add_u32 s33, s33, 131072
    s_mov_b32 m0, s34
    s_add_u32 s34, s34, 1024
    buffer_load_dwordx4 v80, s[8:11], s33 offen lds
    s_add_u32 s33, s33, 131072
    s_mov_b32 m0, s34
    s_add_u32 s34, s34, 1024
    buffer_load_dwordx4 v80, s[8:11], s33 offen lds
    s_add_u32 s33, s33, 131072
    s_mov_b32 m0, s34
    s_add_u32 s34, s34, 1024
    buffer_load_dwordx4 v80, s[8:11], s33 offen lds
    s_add_u32 s33, s33, 131072
    s_mov_b32 m0, s34
    s_add_u32 s34, s34, 1024
    buffer_load_dwordx4 v80, s[8:11], s33 offen lds
    s_add_u32 s33, s33, 131072
    s_mov_b32 m0, s34
    s_add_u32 s34, s34, 1024
    buffer_load_dwordx4 v80, s[8:11], s33 offen lds
    s_add_u32 s33, s33, 131072
    s_mov_b32 m0, s34
    s_add_u32 s34, s34, 1024
    buffer_load_dwordx4 v80, s[8:11], s33 offen lds
    s_add_u32 s33, s33, 131072
    s_mov_b32 m0, s34
    s_add_u32 s34, s34, 1024
    buffer_load_dwordx4 v80, s[8:11], s33 offen lds
    s_add_u32 s33, s33, 131072
    s_mov_b32 m0, s34
    s_add_u32 s34, s34, 1024
    buffer_load_dwordx4 v80, s[8:11], s33 offen lds
    s_add_u32 s33, s33, 131072
    s_waitcnt vmcnt(16)
    ds_read_b64_tr_b16 a[128:129], v81 offset:0
    ds_read_b64_tr_b16 a[130:131], v81 offset:256
    ds_read_b64_tr_b16 a[132:133], v81 offset:1024
    ds_read_b64_tr_b16 a[134:135], v81 offset:1280
    ds_read_b64_tr_b16 a[136:137], v81 offset:2048
    ds_read_b64_tr_b16 a[138:139], v81 offset:2304
    ds_read_b64_tr_b16 a[140:141], v81 offset:3072
    ds_read_b64_tr_b16 a[142:143], v81 offset:3328
    s_waitcnt lgkmcnt(0)
    ds_read_b64_tr_b16 a[144:145], v81 offset:4096
    ds_read_b64_tr_b16 a[146:147], v81 offset:4352
    ds_read_b64_tr_b16 a[148:149], v81 offset:5120
    ds_read_b64_tr_b16 a[150:151], v81 offset:5376
    ds_read_b64_tr_b16 a[152:153], v81 offset:6144
    ds_read_b64_tr_b16 a[154:155], v81 offset:6400
    ds_read_b64_tr_b16 a[156:157], v81 offset:7168
    ds_read_b64_tr_b16 a[158:159], v81 offset:7424
    s_waitcnt lgkmcnt(0)
    ds_read_b64_tr_b16 a[160:161], v81 offset:8192
    ds_read_b64_tr_b16 a[162:163], v81 offset:8448
    ds_read_b64_tr_b16 a[164:165], v81 offset:9216
    ds_read_b64_tr_b16 a[166:167], v81 offset:9472
    ds_read_b64_tr_b16 a[168:169], v81 offset:10240
    ds_read_b64_tr_b16 a[170:171], v81 offset:10496
    ds_read_b64_tr_b16 a[172:173], v81 offset:11264
    ds_read_b64_tr_b16 a[174:175], v81 offset:11520
    s_waitcnt lgkmcnt(0)
    ds_read_b64_tr_b16 a[176:177], v81 offset:12288
    ds_read_b64_tr_b16 a[178:179], v81 offset:12544
    ds_read_b64_tr_b16 a[180:181], v81 offset:13312
    ds_read_b64_tr_b16 a[182:183], v81 offset:13568
    ds_read_b64_tr_b16 a[184:185], v81 offset:14336
    ds_read_b64_tr_b16 a[186:187], v81 offset:14592
    ds_read_b64_tr_b16 a[188:189], v81 offset:15360
    ds_read_b64_tr_b16 a[190:191], v81 offset:15616
    s_waitcnt lgkmcnt(0)
    s_waitcnt vmcnt(0)
    ds_read_b64_tr_b16 a[192:193], v81 offset:16384
    ds_read_b64_tr_b16 a[194:195], v81 offset:16640
    ds_read_b64_tr_b16 a[196:197], v81 offset:17408
    ds_read_b64_tr_b16 a[198:199], v81 offset:17664
    ds_read_b64_tr_b16 a[200:201], v81 offset:18432
    ds_read_b64_tr_b16 a[202:203], v81 offset:18688
    ds_read_b64_tr_b16 a[204:205], v81 offset:19456
    ds_read_b64_tr_b16 a[206:207], v81 offset:19712
    s_waitcnt lgkmcnt(0)
    ds_read_b64_tr_b16 a[208:209], v81 offset:20480
    ds_read_b64_tr_b16 a[210:211], v81 offset:20736
    ds_read_b64_tr_b16 a[212:213], v81 offset:21504
    ds_read_b64_tr_b16 a[214:215], v81 offset:21760
    ds_read_b64_tr_b16 a[216:217], v81 offset:22528
    ds_read_b64_tr_b16 a[218:219], v81 offset:22784
    ds_read_b64_tr_b16 a[220:221], v81 offset:23552
    ds_read_b64_tr_b16 a[222:223], v81 offset:23808
    s_waitcnt lgkmcnt(0)
    ds_read_b64_tr_b16 a[224:225], v81 offset:24576
    ds_read_b64_tr_b16 a[226:227], v81 offset:24832
    ds_read_b64_tr_b16 a[228:229], v81 offset:25600
    ds_read_b64_tr_b16 a[230:231], v81 offset:25856
    ds_read_b64_tr_b16 a[232:233], v81 offset:26624
    ds_read_b64_tr_b16 a[234:235], v81 offset:26880
    ds_read_b64_tr_b16 a[236:237], v81 offset:27648
    ds_read_b64_tr_b16 a[238:239], v81 offset:27904
    s_waitcnt lgkmcnt(0)
    ds_read_b64_tr_b16 a[240:241], v81 offset:28672
    ds_read_b64_tr_b16 a[242:243], v81 offset:28928
    ds_read_b64_tr_b16 a[244:245], v81 offset:29696
    ds_read_b64_tr_b16 a[246:247], v81 offset:29952
    ds_read_b64_tr_b16 a[248:249], v81 offset:30720
    ds_read_b64_tr_b16 a[250:251], v81 offset:30976
    ds_read_b64_tr_b16 a[252:253], v81 offset:31744
    ds_read_b64_tr_b16 a[254:255], v81 offset:32000
    s_waitcnt lgkmcnt(0)
    s_barrier
    s_mov_b32 s3, 0
L_rdy_11:
    buffer_load_dwordx2 v[82:83], off, s[12:15], s22 sc1
    s_add_u32 s3, s3, 1
    s_cmp_gt_u32 s3, 400000
    s_cbranch_scc1 L_exit
    s_waitcnt vmcnt(0)
    v_readfirstlane_b32 s24, v82
    v_readfirstlane_b32 s25, v83
    s_and_b32 vcc_lo, s24, 0xffff
    s_cmp_lt_u32 vcc_lo, 256
    s_cbranch_scc1 L_rdy_11
    s_lshr_b32 vcc_lo, s24, 16
    s_cbranch_scc1 L_general
    s_load_dwordx2 s[28:29], s[0:1], 0
    s_mov_b32 s30, 4194304
    s_mov_b32 s31, 0x20000
    s_lshl_b32 s36, s18, 14
    s_mul_i32 s37, s18, 16512
    s_lshl_b32 s33, s17, 2
    s_add_u32 s33, s33, s18
    s_lshl_b32 s38, s33, 11
    s_add_u32 s38, s38, 50331648
    s_waitcnt lgkmcnt(0)
    s_mov_b32 s44, 0
    s_mov_b32 s45, 0
    s_mov_b32 s46, 0
    s_mov_b32 s47, 0
    s_mov_b32 s48, 0
    s_mov_b32 s49, 0
    s_mov_b32 s50, 0
    s_mov_b32 s51, 0
    s_mov_b32 s52, 0
    s_mov_b32 s53, 0
    s_mov_b32 s54, 0
    s_mov_b32 s55, 0
    s_mov_b32 s56, 0
    s_mov_b32 s57, 0
    s_mov_b32 s58, 0
    s_mov_b32 s59, 0
    s_mov_b32 s32, 0
    s_add_u32 m0, s37, 0
    s_add_u32 s35, s36, 0
    buffer_load_dwordx4 v2, s[28:31], s35 offen offset:0 lds
    buffer_load_dwordx4 v2, s[28:31], s35 offen offset:1024 lds
    s_add_u32 m0, s37, 2064
    s_add_u32 s35, s36, 2048
    buffer_load_dwordx4 v2, s[28:31], s35 offen offset:0 lds
    buffer_load_dwordx4 v2, s[28:31], s35 offen offset:1024 lds
    s_add_u32 m0, s37, 4128
    s_add_u32 s35, s36, 4096
    buffer_load_dwordx4 v2, s[28:31], s35 offen offset:0 lds
    buffer_load_dwordx4 v2, s[28:31], s35 offen offset:1024 lds
    s_add_u32 m0, s37, 6192
    s_add_u32 s35, s36, 6144
    buffer_load_dwordx4 v2, s[28:31], s35 offen offset:0 lds
    buffer_load_dwordx4 v2, s[28:31], s35 offen offset:1024 lds
    s_add_u32 m0, s37, 8256
    s_add_u32 s35, s36, 8192
    buffer_load_dwordx4 v2, s[28:31], s35 offen offset:0 lds
    buffer_load_dwordx4 v2, s[28:31], s35 offen offset:1024 lds
    s_add_u32 m0, s37, 10320
    s_add_u32 s35, s36, 10240
    buffer_load_dwordx4 v2, s[28:31], s35 offen offset:0 lds
    buffer_load_dwordx4 v2, s[28:31], s35 offen offset:1024 lds
    s_add_u32 m0, s37, 12384
    s_add_u32 s35, s36, 12288
    buffer_load_dwordx4 v2, s[28:31], s35 offen offset:0 lds
    buffer_load_dwordx4 v2, s[28:31], s35 offen offset:1024 lds
    s_add_u32 m0, s37, 14448
    s_add_u32 s35, s36, 14336
    buffer_load_dwordx4 v2, s[28:31], s35 offen offset:0 lds
    buffer_load_dwordx4 v2, s[28:31], s35 offen offset:1024 lds
    s_waitcnt vmcnt(0)
    s_barrier
    ds_read_b128 v[16:19], v10 offset:0
    ds_read_b128 v[20:23], v10 offset:32
    ds_read_b128 v[24:27], v10 offset:64
    ds_read_b128 v[28:31], v10 offset:96
    ds_read_b128 v[32:35], v10 offset:128
    ds_read_b128 v[36:39], v10 offset:160
    s_add_u32 s38, s38, 1073479680
    v_and_b32 v3, 31, v1
    v_lshrrev_b32 v4, 5, v1
    v_lshlrev_b32 v12, 6, v3
    v_lshl_add_u32 v12, v4, 4, v12
    v_cmp_gt_u32 vcc, 8, v3
    v_lshlrev_b32 v13, 4, v5
    v_lshl_add_u32 v13, v4, 3, v13
    v_cndmask_b32 v12, v7, v12, vcc
    v_lshlrev_b32 v4, 3, v4
    v_sub_u32 v3, v3, v4
    v_mov_b32 v4, 0xf149f2ca
    v_cmp_gt_i32 vcc, 0, v3
    s_nop 1
    v_cndmask_b32 v232, 0, v4, vcc
    v_cmp_gt_i32 vcc, 1, v3
    s_nop 1
    v_cndmask_b32 v233, 0, v4, vcc
    v_cmp_gt_i32 vcc, 2, v3
    s_nop 1
    v_cndmask_b32 v234, 0, v4, vcc
    v_cmp_gt_i32 vcc, 3, v3
    s_nop 1
    v_cndmask_b32 v235, 0, v4, vcc
    v_cmp_gt_i32 vcc, 4, v3
    s_nop 1
    v_cndmask_b32 v236, 0, v4, vcc
    v_cmp_gt_i32 vcc, 5, v3
    s_nop 1
    v_cndmask_b32 v237, 0, v4, vcc
    v_cmp_gt_i32 vcc, 6, v3
    s_nop 1
    v_cndmask_b32 v238, 0, v4, vcc
    v_cmp_gt_i32 vcc, 7, v3
    s_nop 1
    v_cndmask_b32 v239, 0, v4, vcc
    v_cmp_gt_i32 vcc, 16, v3
    s_nop 1
    v_cndmask_b32 v240, 0, v4, vcc
    v_cmp_gt_i32 vcc, 17, v3
    s_nop 1
    v_cndmask_b32 v241, 0, v4, vcc
    v_cmp_gt_i32 vcc, 18, v3
    s_nop 1
    v_cndmask_b32 v242, 0, v4, vcc
    v_cmp_gt_i32 vcc, 19, v3
    s_nop 1
    v_cndmask_b32 v243, 0, v4, vcc
    v_cmp_gt_i32 vcc, 20, v3
    s_nop 1
    v_cndmask_b32 v244, 0, v4, vcc
    v_cmp_gt_i32 vcc, 21, v3
    s_nop 1
    v_cndmask_b32 v245, 0, v4, vcc
    v_cmp_gt_i32 vcc, 22, v3
    s_nop 1
    v_cndmask_b32 v246, 0, v4, vcc
    v_cmp_gt_i32 vcc, 23, v3
    s_nop 1
    v_cndmask_b32 v247, 0, v4, vcc
    v_mov_b32 v248, 0x3e0293ee
    s_lshl_b32 s39, s17, 7
    s_add_u32 s39, s39, 3735552
L_rQ_loop:
    s_waitcnt lgkmcnt(5)
    v_mfma_f32_32x32x16_bf16 v[48:63], a[0:3], v[16:19], 0
    ds_read_b128 v[40:43], v10 offset:192
    s_add_u32 s36, s36, 65536
    s_add_u32 m0, s37, 66048
    s_add_u32 s35, s36, 0
    buffer_load_dwordx4 v2, s[28:31], s35 offen offset:0 lds
    s_waitcnt lgkmcnt(5)
    v_mfma_f32_32x32x16_bf16 v[48:63], a[4:7], v[20:23], v[48:63]
    ds_read_b128 v[44:47], v10 offset:224
    s_waitcnt lgkmcnt(5)
    v_mfma_f32_32x32x16_bf16 v[48:63], a[8:11], v[24:27], v[48:63]
    ds_read_b128 v[16:19], v10 offset:256
    buffer_load_dwordx4 v2, s[28:31], s35 offen offset:1024 lds
    s_waitcnt lgkmcnt(5)
    v_mfma_f32_32x32x16_bf16 v[48:63], a[12:15], v[28:31], v[48:63]
    ds_read_b128 v[20:23], v10 offset:288
    s_waitcnt lgkmcnt(5)
    v_mfma_f32_32x32x16_bf16 v[48:63], a[16:19], v[32:35], v[48:63]
    ds_read_b128 v[24:27], v10 offset:320
    s_add_u32 m0, s37, 68112
    s_add_u32 s35, s36, 2048
    buffer_load_dwordx4 v2, s[28:31], s35 offen offset:0 lds
    v_cvt_pk_bf16_f32 v80, v64, v65
    v_cvt_pk_bf16_f32 v81, v66, v67
    s_waitcnt lgkmcnt(5)
    v_mfma_f32_32x32x16_bf16 v[48:63], a[20:23], v[36:39], v[48:63]
    ds_read_b128 v[28:31], v10 offset:352
    v_cvt_pk_bf16_f32 v82, v68, v69
    v_cvt_pk_bf16_f32 v83, v70, v71
    s_waitcnt lgkmcnt(5)
    v_mfma_f32_32x32x16_bf16 v[48:63], a[24:27], v[40:43], v[48:63]
    ds_read_b128 v[32:35], v10 offset:384
    buffer_load_dwordx4 v2, s[28:31], s35 offen offset:1024 lds
    v_cvt_pk_bf16_f32 v84, v72, v73
    v_cvt_pk_bf16_f32 v85, v74, v75
    s_waitcnt lgkmcnt(5)
    v_mfma_f32_32x32x16_bf16 v[48:63], a[28:31], v[44:47], v[48:63]
    ds_read_b128 v[36:39], v10 offset:416
    v_cvt_pk_bf16_f32 v86, v76, v77
    v_cvt_pk_bf16_f32 v87, v78, v79
    s_waitcnt lgkmcnt(5)
    v_mfma_f32_32x32x16_bf16 v[48:63], a[32:35], v[16:19], v[48:63]
    ds_read_b128 v[40:43], v10 offset:448
    s_add_u32 m0, s37, 70176
    s_add_u32 s35, s36, 4096
    buffer_load_dwordx4 v2, s[28:31], s35 offen offset:0 lds
    s_waitcnt lgkmcnt(5)
    v_mfma_f32_32x32x16_bf16 v[48:63], a[36:39], v[20:23], v[48:63]
    ds_read_b128 v[44:47], v10 offset:480
    buffer_store_dwordx4 v[80:83], v2, s[4:7], s38 offen
    s_waitcnt lgkmcnt(5)
    v_mfma_f32_32x32x16_bf16 v[48:63], a[40:43], v[24:27], v[48:63]
    ds_read_b128 v[16:19], v10 offset:512
    buffer_load_dwordx4 v2, s[28:31], s35 offen offset:1024 lds
    s_waitcnt lgkmcnt(5)
    v_mfma_f32_32x32x16_bf16 v[48:63], a[44:47], v[28:31], v[48:63]
    ds_read_b128 v[20:23], v10 offset:544
    buffer_store_dwordx4 v[84:87], v2, s[4:7], s38 offen offset:1024
    s_add_u32 s38, s38, 0x40000
    s_bitset0_b32 s38, 30
    s_waitcnt lgkmcnt(5)
    v_mfma_f32_32x32x16_bf16 v[48:63], a[48:51], v[32:35], v[48:63]
    ds_read_b128 v[24:27], v10 offset:576
    s_add_u32 m0, s37, 72240
    s_add_u32 s35, s36, 6144
    buffer_load_dwordx4 v2, s[28:31], s35 offen offset:0 lds
    s_waitcnt lgkmcnt(5)
    v_mfma_f32_32x32x16_bf16 v[48:63], a[52:55], v[36:39], v[48:63]
    ds_read_b128 v[28:31], v10 offset:608
    s_waitcnt lgkmcnt(5)
    v_mfma_f32_32x32x16_bf16 v[48:63], a[56:59], v[40:43], v[48:63]
    ds_read_b128 v[32:35], v10 offset:640
    buffer_load_dwordx4 v2, s[28:31], s35 offen offset:1024 lds
    s_waitcnt lgkmcnt(5)
    v_mfma_f32_32x32x16_bf16 v[48:63], a[60:63], v[44:47], v[48:63]
    ds_read_b128 v[36:39], v10 offset:672
    s_waitcnt lgkmcnt(5)
    v_mfma_f32_32x32x16_bf16 v[48:63], a[64:67], v[16:19], v[48:63]
    ds_read_b128 v[40:43], v10 offset:704
    s_add_u32 m0, s37, 74304
    s_add_u32 s35, s36, 8192
    buffer_load_dwordx4 v2, s[28:31], s35 offen offset:0 lds
    s_waitcnt lgkmcnt(5)
    v_mfma_f32_32x32x16_bf16 v[48:63], a[68:71], v[20:23], v[48:63]
    ds_read_b128 v[44:47], v10 offset:736
    s_waitcnt lgkmcnt(5)
    v_mfma_f32_32x32x16_bf16 v[48:63], a[72:75], v[24:27], v[48:63]
    ds_read_b128 v[16:19], v10 offset:768
    buffer_load_dwordx4 v2, s[28:31], s35 offen offset:1024 lds
    s_waitcnt lgkmcnt(5)
    v_mfma_f32_32x32x16_bf16 v[48:63], a[76:79], v[28:31], v[48:63]
    ds_read_b128 v[20:23], v10 offset:800
    s_waitcnt lgkmcnt(5)
    v_mfma_f32_32x32x16_bf16 v[48:63], a[80:83], v[32:35], v[48:63]
    ds_read_b128 v[24:27], v10 offset:832
    s_add_u32 m0, s37, 76368
    s_add_u32 s35, s36, 10240
    buffer_load_dwordx4 v2, s[28:31], s35 offen offset:0 lds
    s_waitcnt lgkmcnt(5)
    v_mfma_f32_32x32x16_bf16 v[48:63], a[84:87], v[36:39], v[48:63]
    ds_read_b128 v[28:31], v10 offset:864
    s_waitcnt lgkmcnt(5)
    v_mfma_f32_32x32x16_bf16 v[48:63], a[88:91], v[40:43], v[48:63]
    ds_read_b128 v[32:35], v10 offset:896
    buffer_load_dwordx4 v2, s[28:31], s35 offen offset:1024 lds
    s_waitcnt lgkmcnt(5)
    v_mfma_f32_32x32x16_bf16 v[48:63], a[92:95], v[44:47], v[48:63]
    ds_read_b128 v[36:39], v10 offset:928
    s_waitcnt lgkmcnt(5)
    v_mfma_f32_32x32x16_bf16 v[48:63], a[96:99], v[16:19], v[48:63]
    ds_read_b128 v[40:43], v10 offset:960
    s_add_u32 m0, s37, 78432
    s_add_u32 s35, s36, 12288
    buffer_load_dwordx4 v2, s[28:31], s35 offen offset:0 lds
    s_waitcnt lgkmcnt(5)
    v_mfma_f32_32x32x16_bf16 v[48:63], a[100:103], v[20:23], v[48:63]
    ds_read_b128 v[44:47], v10 offset:992
    s_waitcnt lgkmcnt(5)
    v_mfma_f32_32x32x16_bf16 v[48:63], a[104:107], v[24:27], v[48:63]
    ds_read_b128 v[16:19], v10 offset:1024
    buffer_load_dwordx4 v2, s[28:31], s35 offen offset:1024 lds
    s_waitcnt lgkmcnt(5)
    v_mfma_f32_32x32x16_bf16 v[48:63], a[108:111], v[28:31], v[48:63]
    ds_read_b128 v[20:23], v10 offset:1056
    s_waitcnt lgkmcnt(5)
    v_mfma_f32_32x32x16_bf16 v[48:63], a[112:115], v[32:35], v[48:63]
    ds_read_b128 v[24:27], v10 offset:1088
    s_add_u32 m0, s37, 80496
    s_add_u32 s35, s36, 14336
    buffer_load_dwordx4 v2, s[28:31], s35 offen offset:0 lds
    s_waitcnt lgkmcnt(5)
    v_mfma_f32_32x32x16_bf16 v[48:63], a[116:119], v[36:39], v[48:63]
    ds_read_b128 v[28:31], v10 offset:1120
    s_waitcnt lgkmcnt(5)
    v_mfma_f32_32x32x16_bf16 v[48:63], a[120:123], v[40:43], v[48:63]
    ds_read_b128 v[32:35], v10 offset:1152
    buffer_load_dwordx4 v2, s[28:31], s35 offen offset:1024 lds
    s_waitcnt lgkmcnt(5)
    v_mfma_f32_32x32x16_bf16 v[48:63], a[124:127], v[44:47], v[48:63]
    ds_read_b128 v[36:39], v10 offset:1184
    s_waitcnt lgkmcnt(5)
    v_mfma_f32_32x32x16_bf16 v[48:63], a[128:131], v[16:19], v[48:63]
    ds_read_b128 v[40:43], v10 offset:1216
    s_waitcnt lgkmcnt(5)
    v_mfma_f32_32x32x16_bf16 v[48:63], a[132:135], v[20:23], v[48:63]
    ds_read_b128 v[44:47], v10 offset:1248
    s_waitcnt lgkmcnt(5)
    v_mfma_f32_32x32x16_bf16 v[48:63], a[136:139], v[24:27], v[48:63]
    ds_read_b128 v[16:19], v10 offset:1280
    s_waitcnt lgkmcnt(5)
    v_mfma_f32_32x32x16_bf16 v[48:63], a[140:143], v[28:31], v[48:63]
    ds_read_b128 v[20:23], v10 offset:1312
    s_waitcnt lgkmcnt(5)
    v_mfma_f32_32x32x16_bf16 v[48:63], a[144:147], v[32:35], v[48:63]
    ds_read_b128 v[24:27], v10 offset:1344
    s_waitcnt lgkmcnt(5)
    v_mfma_f32_32x32x16_bf16 v[48:63], a[148:151], v[36:39], v[48:63]
    ds_read_b128 v[28:31], v10 offset:1376
    s_waitcnt vmcnt(10)
    buffer_store_dword v9, v8, s[4:7], 0 offen sc1
    s_waitcnt lgkmcnt(5)
    v_mfma_f32_32x32x16_bf16 v[48:63], a[152:155], v[40:43], v[48:63]
    ds_read_b128 v[32:35], v10 offset:1408
    s_waitcnt lgkmcnt(5)
    v_mfma_f32_32x32x16_bf16 v[48:63], a[156:159], v[44:47], v[48:63]
    ds_read_b128 v[36:39], v10 offset:1440
    s_waitcnt lgkmcnt(5)
    v_mfma_f32_32x32x16_bf16 v[48:63], a[160:163], v[16:19], v[48:63]
    ds_read_b128 v[40:43], v10 offset:1472
    s_waitcnt lgkmcnt(5)
    v_mfma_f32_32x32x16_bf16 v[48:63], a[164:167], v[20:23], v[48:63]
    ds_read_b128 v[44:47], v10 offset:1504
    s_waitcnt lgkmcnt(5)
    v_mfma_f32_32x32x16_bf16 v[48:63], a[168:171], v[24:27], v[48:63]
    ds_read_b128 v[16:19], v10 offset:1536
    s_waitcnt lgkmcnt(5)
    v_mfma_f32_32x32x16_bf16 v[48:63], a[172:175], v[28:31], v[48:63]
    ds_read_b128 v[20:23], v10 offset:1568
    s_waitcnt lgkmcnt(5)
    v_mfma_f32_32x32x16_bf16 v[48:63], a[176:179], v[32:35], v[48:63]
    ds_read_b128 v[24:27], v10 offset:1600
    s_waitcnt lgkmcnt(5)
    v_mfma_f32_32x32x16_bf16 v[48:63], a[180:183], v[36:39], v[48:63]
    ds_read_b128 v[28:31], v10 offset:1632
    s_waitcnt lgkmcnt(5)
    v_mfma_f32_32x32x16_bf16 v[48:63], a[184:187], v[40:43], v[48:63]
    ds_read_b128 v[32:35], v10 offset:1664
    s_waitcnt lgkmcnt(5)
    v_mfma_f32_32x32x16_bf16 v[48:63], a[188:191], v[44:47], v[48:63]
    ds_read_b128 v[36:39], v10 offset:1696
    s_waitcnt lgkmcnt(5)
    v_mfma_f32_32x32x16_bf16 v[48:63], a[192:195], v[16:19], v[48:63]
    ds_read_b128 v[40:43], v10 offset:1728
    s_waitcnt lgkmcnt(5)
    v_mfma_f32_32x32x16_bf16 v[48:63], a[196:199], v[20:23], v[48:63]
    ds_read_b128 v[44:47], v10 offset:1760
    s_waitcnt lgkmcnt(5)
    v_mfma_f32_32x32x16_bf16 v[48:63], a[200:203], v[24:27], v[48:63]
    ds_read_b128 v[16:19], v10 offset:1792
    s_waitcnt lgkmcnt(5)
    v_mfma_f32_32x32x16_bf16 v[48:63], a[204:207], v[28:31], v[48:63]
    ds_read_b128 v[20:23], v10 offset:1824
    s_waitcnt lgkmcnt(5)
    v_mfma_f32_32x32x16_bf16 v[48:63], a[208:211], v[32:35], v[48:63]
    ds_read_b128 v[24:27], v10 offset:1856
    s_waitcnt lgkmcnt(5)
    v_mfma_f32_32x32x16_bf16 v[48:63], a[212:215], v[36:39], v[48:63]
    ds_read_b128 v[28:31], v10 offset:1888
    s_waitcnt lgkmcnt(5)
    v_mfma_f32_32x32x16_bf16 v[48:63], a[216:219], v[40:43], v[48:63]
    ds_read_b128 v[32:35], v10 offset:1920
    s_waitcnt lgkmcnt(5)
    v_mfma_f32_32x32x16_bf16 v[48:63], a[220:223], v[44:47], v[48:63]
    ds_read_b128 v[36:39], v10 offset:1952
    s_waitcnt lgkmcnt(5)
    v_mfma_f32_32x32x16_bf16 v[48:63], a[224:227], v[16:19], v[48:63]
    ds_read_b128 v[40:43], v10 offset:1984
    s_waitcnt lgkmcnt(5)
    v_mfma_f32_32x32x16_bf16 v[48:63], a[228:231], v[20:23], v[48:63]
    ds_read_b128 v[44:47], v10 offset:2016
    s_add_u32 s32, s32, 1
    s_waitcnt lgkmcnt(5)
    v_mfma_f32_32x32x16_bf16 v[48:63], a[232:235], v[24:27], v[48:63]
    s_waitcnt lgkmcnt(4)
    v_mfma_f32_32x32x16_bf16 v[48:63], a[236:239], v[28:31], v[48:63]
    s_waitcnt lgkmcnt(0)
    s_waitcnt vmcnt(1)
    s_barrier
    ds_read_b128 v[16:19], v11 offset:0
    ds_read_b128 v[20:23], v11 offset:32
    v_mfma_f32_32x32x16_bf16 v[48:63], a[240:243], v[32:35], v[48:63]
    ds_read_b128 v[24:27], v11 offset:64
    ds_read_b128 v[28:31], v11 offset:96
    v_mfma_f32_32x32x16_bf16 v[48:63], a[244:247], v[36:39], v[48:63]
    ds_read_b128 v[32:35], v11 offset:128
    ds_read_b128 v[36:39], v11 offset:160
    v_mfma_f32_32x32x16_bf16 v[48:63], a[248:251], v[40:43], v[48:63]
    v_mfma_f32_32x32x16_bf16 v[48:63], a[252:255], v[44:47], v[48:63]
    s_waitcnt lgkmcnt(5)
    v_mfma_f32_32x32x16_bf16 v[64:79], a[0:3], v[16:19], 0
    ds_read_b128 v[40:43], v11 offset:192
    s_add_u32 s36, s36, 65536
    s_add_u32 m0, s37, 0
    s_add_u32 s35, s36, 0
    buffer_load_dwordx4 v2, s[28:31], s35 offen offset:0 lds
    s_waitcnt lgkmcnt(5)
    v_mfma_f32_32x32x16_bf16 v[64:79], a[4:7], v[20:23], v[64:79]
    ds_read_b128 v[44:47], v11 offset:224
    s_waitcnt lgkmcnt(5)
    v_mfma_f32_32x32x16_bf16 v[64:79], a[8:11], v[24:27], v[64:79]
    ds_read_b128 v[16:19], v11 offset:256
    buffer_load_dwordx4 v2, s[28:31], s35 offen offset:1024 lds
    s_waitcnt lgkmcnt(5)
    v_mfma_f32_32x32x16_bf16 v[64:79], a[12:15], v[28:31], v[64:79]
    ds_read_b128 v[20:23], v11 offset:288
    s_waitcnt lgkmcnt(5)
    v_mfma_f32_32x32x16_bf16 v[64:79], a[16:19], v[32:35], v[64:79]
    ds_read_b128 v[24:27], v11 offset:320
    s_add_u32 m0, s37, 2064
    s_add_u32 s35, s36, 2048
    buffer_load_dwordx4 v2, s[28:31], s35 offen offset:0 lds
    v_cvt_pk_bf16_f32 v80, v48, v49
    v_cvt_pk_bf16_f32 v81, v50, v51
    s_waitcnt lgkmcnt(5)
    v_mfma_f32_32x32x16_bf16 v[64:79], a[20:23], v[36:39], v[64:79]
    ds_read_b128 v[28:31], v11 offset:352
    v_cvt_pk_bf16_f32 v82, v52, v53
    v_cvt_pk_bf16_f32 v83, v54, v55
    s_waitcnt lgkmcnt(5)
    v_mfma_f32_32x32x16_bf16 v[64:79], a[24:27], v[40:43], v[64:79]
    ds_read_b128 v[32:35], v11 offset:384
    buffer_load_dwordx4 v2, s[28:31], s35 offen offset:1024 lds
    v_cvt_pk_bf16_f32 v84, v56, v57
    v_cvt_pk_bf16_f32 v85, v58, v59
    s_waitcnt lgkmcnt(5)
    v_mfma_f32_32x32x16_bf16 v[64:79], a[28:31], v[44:47], v[64:79]
    ds_read_b128 v[36:39], v11 offset:416
    v_cvt_pk_bf16_f32 v86, v60, v61
    v_cvt_pk_bf16_f32 v87, v62, v63
    s_waitcnt lgkmcnt(5)
    v_mfma_f32_32x32x16_bf16 v[64:79], a[32:35], v[16:19], v[64:79]
    ds_read_b128 v[40:43], v11 offset:448
    s_add_u32 m0, s37, 4128
    s_add_u32 s35, s36, 4096
    buffer_load_dwordx4 v2, s[28:31], s35 offen offset:0 lds
    s_waitcnt lgkmcnt(5)
    v_mfma_f32_32x32x16_bf16 v[64:79], a[36:39], v[20:23], v[64:79]
    ds_read_b128 v[44:47], v11 offset:480
    buffer_store_dwordx4 v[80:83], v2, s[4:7], s38 offen
    s_waitcnt lgkmcnt(5)
    v_mfma_f32_32x32x16_bf16 v[64:79], a[40:43], v[24:27], v[64:79]
    ds_read_b128 v[16:19], v11 offset:512
    buffer_load_dwordx4 v2, s[28:31], s35 offen offset:1024 lds
    s_waitcnt lgkmcnt(5)
    v_mfma_f32_32x32x16_bf16 v[64:79], a[44:47], v[28:31], v[64:79]
    ds_read_b128 v[20:23], v11 offset:544
    buffer_store_dwordx4 v[84:87], v2, s[4:7], s38 offen offset:1024
    s_add_u32 s38, s38, 0x40000
    s_bitset0_b32 s38, 30
    s_waitcnt lgkmcnt(5)
    v_mfma_f32_32x32x16_bf16 v[64:79], a[48:51], v[32:35], v[64:79]
    ds_read_b128 v[24:27], v11 offset:576
    s_add_u32 m0, s37, 6192
    s_add_u32 s35, s36, 6144
    buffer_load_dwordx4 v2, s[28:31], s35 offen offset:0 lds
    s_waitcnt lgkmcnt(5)
    v_mfma_f32_32x32x16_bf16 v[64:79], a[52:55], v[36:39], v[64:79]
    ds_read_b128 v[28:31], v11 offset:608
    s_waitcnt lgkmcnt(5)
    v_mfma_f32_32x32x16_bf16 v[64:79], a[56:59], v[40:43], v[64:79]
    ds_read_b128 v[32:35], v11 offset:640
    buffer_load_dwordx4 v2, s[28:31], s35 offen offset:1024 lds
    s_waitcnt lgkmcnt(5)
    v_mfma_f32_32x32x16_bf16 v[64:79], a[60:63], v[44:47], v[64:79]
    ds_read_b128 v[36:39], v11 offset:672
    s_waitcnt lgkmcnt(5)
    v_mfma_f32_32x32x16_bf16 v[64:79], a[64:67], v[16:19], v[64:79]
    ds_read_b128 v[40:43], v11 offset:704
    s_add_u32 m0, s37, 8256
    s_add_u32 s35, s36, 8192
    buffer_load_dwordx4 v2, s[28:31], s35 offen offset:0 lds
    s_waitcnt lgkmcnt(5)
    v_mfma_f32_32x32x16_bf16 v[64:79], a[68:71], v[20:23], v[64:79]
    ds_read_b128 v[44:47], v11 offset:736
    s_waitcnt lgkmcnt(5)
    v_mfma_f32_32x32x16_bf16 v[64:79], a[72:75], v[24:27], v[64:79]
    ds_read_b128 v[16:19], v11 offset:768
    buffer_load_dwordx4 v2, s[28:31], s35 offen offset:1024 lds
    s_waitcnt lgkmcnt(5)
    v_mfma_f32_32x32x16_bf16 v[64:79], a[76:79], v[28:31], v[64:79]
    ds_read_b128 v[20:23], v11 offset:800
    s_waitcnt lgkmcnt(5)
    v_mfma_f32_32x32x16_bf16 v[64:79], a[80:83], v[32:35], v[64:79]
    ds_read_b128 v[24:27], v11 offset:832
    s_add_u32 m0, s37, 10320
    s_add_u32 s35, s36, 10240
    buffer_load_dwordx4 v2, s[28:31], s35 offen offset:0 lds
    s_waitcnt lgkmcnt(5)
    v_mfma_f32_32x32x16_bf16 v[64:79], a[84:87], v[36:39], v[64:79]
    ds_read_b128 v[28:31], v11 offset:864
    s_waitcnt lgkmcnt(5)
    v_mfma_f32_32x32x16_bf16 v[64:79], a[88:91], v[40:43], v[64:79]
    ds_read_b128 v[32:35], v11 offset:896
    buffer_load_dwordx4 v2, s[28:31], s35 offen offset:1024 lds
    s_waitcnt lgkmcnt(5)
    v_mfma_f32_32x32x16_bf16 v[64:79], a[92:95], v[44:47], v[64:79]
    ds_read_b128 v[36:39], v11 offset:928
    s_waitcnt lgkmcnt(5)
    v_mfma_f32_32x32x16_bf16 v[64:79], a[96:99], v[16:19], v[64:79]
    ds_read_b128 v[40:43], v11 offset:960
    s_add_u32 m0, s37, 12384
    s_add_u32 s35, s36, 12288
    buffer_load_dwordx4 v2, s[28:31], s35 offen offset:0 lds
    s_waitcnt lgkmcnt(5)
    v_mfma_f32_32x32x16_bf16 v[64:79], a[100:103], v[20:23], v[64:79]
    ds_read_b128 v[44:47], v11 offset:992
    s_waitcnt lgkmcnt(5)
    v_mfma_f32_32x32x16_bf16 v[64:79], a[104:107], v[24:27], v[64:79]
    ds_read_b128 v[16:19], v11 offset:1024
    buffer_load_dwordx4 v2, s[28:31], s35 offen offset:1024 lds
    s_waitcnt lgkmcnt(5)
    v_mfma_f32_32x32x16_bf16 v[64:79], a[108:111], v[28:31], v[64:79]
    ds_read_b128 v[20:23], v11 offset:1056
    s_waitcnt lgkmcnt(5)
    v_mfma_f32_32x32x16_bf16 v[64:79], a[112:115], v[32:35], v[64:79]
    ds_read_b128 v[24:27], v11 offset:1088
    s_add_u32 m0, s37, 14448
    s_add_u32 s35, s36, 14336
    buffer_load_dwordx4 v2, s[28:31], s35 offen offset:0 lds
    s_waitcnt lgkmcnt(5)
    v_mfma_f32_32x32x16_bf16 v[64:79], a[116:119], v[36:39], v[64:79]
    ds_read_b128 v[28:31], v11 offset:1120
    s_waitcnt lgkmcnt(5)
    v_mfma_f32_32x32x16_bf16 v[64:79], a[120:123], v[40:43], v[64:79]
    ds_read_b128 v[32:35], v11 offset:1152
    buffer_load_dwordx4 v2, s[28:31], s35 offen offset:1024 lds
    s_waitcnt lgkmcnt(5)
    v_mfma_f32_32x32x16_bf16 v[64:79], a[124:127], v[44:47], v[64:79]
    ds_read_b128 v[36:39], v11 offset:1184
    s_waitcnt lgkmcnt(5)
    v_mfma_f32_32x32x16_bf16 v[64:79], a[128:131], v[16:19], v[64:79]
    ds_read_b128 v[40:43], v11 offset:1216
    s_waitcnt lgkmcnt(5)
    v_mfma_f32_32x32x16_bf16 v[64:79], a[132:135], v[20:23], v[64:79]
    ds_read_b128 v[44:47], v11 offset:1248
    s_waitcnt lgkmcnt(5)
    v_mfma_f32_32x32x16_bf16 v[64:79], a[136:139], v[24:27], v[64:79]
    ds_read_b128 v[16:19], v11 offset:1280
    s_waitcnt lgkmcnt(5)
    v_mfma_f32_32x32x16_bf16 v[64:79], a[140:143], v[28:31], v[64:79]
    ds_read_b128 v[20:23], v11 offset:1312
    s_waitcnt lgkmcnt(5)
    v_mfma_f32_32x32x16_bf16 v[64:79], a[144:147], v[32:35], v[64:79]
    ds_read_b128 v[24:27], v11 offset:1344
    s_waitcnt lgkmcnt(5)
    v_mfma_f32_32x32x16_bf16 v[64:79], a[148:151], v[36:39], v[64:79]
    ds_read_b128 v[28:31], v11 offset:1376
    s_waitcnt lgkmcnt(5)
    v_mfma_f32_32x32x16_bf16 v[64:79], a[152:155], v[40:43], v[64:79]
    ds_read_b128 v[32:35], v11 offset:1408
    s_waitcnt lgkmcnt(5)
    v_mfma_f32_32x32x16_bf16 v[64:79], a[156:159], v[44:47], v[64:79]
    ds_read_b128 v[36:39], v11 offset:1440
    s_waitcnt lgkmcnt(5)
    v_mfma_f32_32x32x16_bf16 v[64:79], a[160:163], v[16:19], v[64:79]
    ds_read_b128 v[40:43], v11 offset:1472
    s_waitcnt lgkmcnt(5)
    v_mfma_f32_32x32x16_bf16 v[64:79], a[164:167], v[20:23], v[64:79]
    ds_read_b128 v[44:47], v11 offset:1504
    s_waitcnt lgkmcnt(5)
    v_mfma_f32_32x32x16_bf16 v[64:79], a[168:171], v[24:27], v[64:79]
    ds_read_b128 v[16:19], v11 offset:1536
    s_waitcnt lgkmcnt(5)
    v_mfma_f32_32x32x16_bf16 v[64:79], a[172:175], v[28:31], v[64:79]
    ds_read_b128 v[20:23], v11 offset:1568
    s_waitcnt lgkmcnt(5)
    v_mfma_f32_32x32x16_bf16 v[64:79], a[176:179], v[32:35], v[64:79]
    ds_read_b128 v[24:27], v11 offset:1600
    s_waitcnt lgkmcnt(5)
    v_mfma_f32_32x32x16_bf16 v[64:79], a[180:183], v[36:39], v[64:79]
    ds_read_b128 v[28:31], v11 offset:1632
    s_waitcnt lgkmcnt(5)
    v_mfma_f32_32x32x16_bf16 v[64:79], a[184:187], v[40:43], v[64:79]
    ds_read_b128 v[32:35], v11 offset:1664
    s_waitcnt lgkmcnt(5)
    v_mfma_f32_32x32x16_bf16 v[64:79], a[188:191], v[44:47], v[64:79]
    ds_read_b128 v[36:39], v11 offset:1696
    s_waitcnt lgkmcnt(5)
    v_mfma_f32_32x32x16_bf16 v[64:79], a[192:195], v[16:19], v[64:79]
    ds_read_b128 v[40:43], v11 offset:1728
    s_waitcnt lgkmcnt(5)
    v_mfma_f32_32x32x16_bf16 v[64:79], a[196:199], v[20:23], v[64:79]
    ds_read_b128 v[44:47], v11 offset:1760
    s_waitcnt lgkmcnt(5)
    v_mfma_f32_32x32x16_bf16 v[64:79], a[200:203], v[24:27], v[64:79]
    ds_read_b128 v[16:19], v11 offset:1792
    s_waitcnt lgkmcnt(5)
    v_mfma_f32_32x32x16_bf16 v[64:79], a[204:207], v[28:31], v[64:79]
    ds_read_b128 v[20:23], v11 offset:1824
    s_waitcnt lgkmcnt(5)
    v_mfma_f32_32x32x16_bf16 v[64:79], a[208:211], v[32:35], v[64:79]
    ds_read_b128 v[24:27], v11 offset:1856
    s_waitcnt lgkmcnt(5)
    v_mfma_f32_32x32x16_bf16 v[64:79], a[212:215], v[36:39], v[64:79]
    ds_read_b128 v[28:31], v11 offset:1888
    s_waitcnt lgkmcnt(5)
    v_mfma_f32_32x32x16_bf16 v[64:79], a[216:219], v[40:43], v[64:79]
    ds_read_b128 v[32:35], v11 offset:1920
    s_waitcnt lgkmcnt(5)
    v_mfma_f32_32x32x16_bf16 v[64:79], a[220:223], v[44:47], v[64:79]
    ds_read_b128 v[36:39], v11 offset:1952
    s_waitcnt lgkmcnt(5)
    v_mfma_f32_32x32x16_bf16 v[64:79], a[224:227], v[16:19], v[64:79]
    ds_read_b128 v[40:43], v11 offset:1984
    s_waitcnt lgkmcnt(5)
    v_mfma_f32_32x32x16_bf16 v[64:79], a[228:231], v[20:23], v[64:79]
    ds_read_b128 v[44:47], v11 offset:2016
    s_add_u32 s32, s32, 1
    s_waitcnt lgkmcnt(5)
    v_mfma_f32_32x32x16_bf16 v[64:79], a[232:235], v[24:27], v[64:79]
    s_waitcnt lgkmcnt(4)
    v_mfma_f32_32x32x16_bf16 v[64:79], a[236:239], v[28:31], v[64:79]
    s_waitcnt lgkmcnt(0)
    s_waitcnt vmcnt(0)
    s_barrier
    ds_read_b128 v[16:19], v10 offset:0
    ds_read_b128 v[20:23], v10 offset:32
    v_mfma_f32_32x32x16_bf16 v[64:79], a[240:243], v[32:35], v[64:79]
    ds_read_b128 v[24:27], v10 offset:64
    ds_read_b128 v[28:31], v10 offset:96
    v_mfma_f32_32x32x16_bf16 v[64:79], a[244:247], v[36:39], v[64:79]
    ds_read_b128 v[32:35], v10 offset:128
    ds_read_b128 v[36:39], v10 offset:160
    v_mfma_f32_32x32x16_bf16 v[64:79], a[248:251], v[40:43], v[64:79]
    v_mfma_f32_32x32x16_bf16 v[64:79], a[252:255], v[44:47], v[64:79]
    s_waitcnt lgkmcnt(5)
    v_mfma_f32_32x32x16_bf16 v[48:63], a[0:3], v[16:19], 0
    ds_read_b128 v[40:43], v10 offset:192
    s_add_u32 s36, s36, 65536
    s_add_u32 m0, s37, 66048
    s_add_u32 s35, s36, 0
    buffer_load_dwordx4 v2, s[28:31], s35 offen offset:0 lds
    s_waitcnt lgkmcnt(5)
    v_mfma_f32_32x32x16_bf16 v[48:63], a[4:7], v[20:23], v[48:63]
    ds_read_b128 v[44:47], v10 offset:224
    s_waitcnt lgkmcnt(5)
    v_mfma_f32_32x32x16_bf16 v[48:63], a[8:11], v[24:27], v[48:63]
    ds_read_b128 v[16:19], v10 offset:256
    buffer_load_dwordx4 v2, s[28:31], s35 offen offset:1024 lds
    s_waitcnt lgkmcnt(5)
    v_mfma_f32_32x32x16_bf16 v[48:63], a[12:15], v[28:31], v[48:63]
    ds_read_b128 v[20:23], v10 offset:288
    s_waitcnt lgkmcnt(5)
    v_mfma_f32_32x32x16_bf16 v[48:63], a[16:19], v[32:35], v[48:63]
    ds_read_b128 v[24:27], v10 offset:320
    s_add_u32 m0, s37, 68112
    s_add_u32 s35, s36, 2048
    buffer_load_dwordx4 v2, s[28:31], s35 offen offset:0 lds
    v_cvt_pk_bf16_f32 v80, v64, v65
    v_cvt_pk_bf16_f32 v81, v66, v67
    s_waitcnt lgkmcnt(5)
    v_mfma_f32_32x32x16_bf16 v[48:63], a[20:23], v[36:39], v[48:63]
    ds_read_b128 v[28:31], v10 offset:352
    v_cvt_pk_bf16_f32 v82, v68, v69
    v_cvt_pk_bf16_f32 v83, v70, v71
    s_waitcnt lgkmcnt(5)
    v_mfma_f32_32x32x16_bf16 v[48:63], a[24:27], v[40:43], v[48:63]
    ds_read_b128 v[32:35], v10 offset:384
    buffer_load_dwordx4 v2, s[28:31], s35 offen offset:1024 lds
    v_cvt_pk_bf16_f32 v84, v72, v73
    v_cvt_pk_bf16_f32 v85, v74, v75
    s_waitcnt lgkmcnt(5)
    v_mfma_f32_32x32x16_bf16 v[48:63], a[28:31], v[44:47], v[48:63]
    ds_read_b128 v[36:39], v10 offset:416
    v_cvt_pk_bf16_f32 v86, v76, v77
    v_cvt_pk_bf16_f32 v87, v78, v79
    s_waitcnt lgkmcnt(5)
    v_mfma_f32_32x32x16_bf16 v[48:63], a[32:35], v[16:19], v[48:63]
    ds_read_b128 v[40:43], v10 offset:448
    s_add_u32 m0, s37, 70176
    s_add_u32 s35, s36, 4096
    buffer_load_dwordx4 v2, s[28:31], s35 offen offset:0 lds
    s_waitcnt lgkmcnt(5)
    v_mfma_f32_32x32x16_bf16 v[48:63], a[36:39], v[20:23], v[48:63]
    ds_read_b128 v[44:47], v10 offset:480
    buffer_store_dwordx4 v[80:83], v2, s[4:7], s38 offen
    s_waitcnt lgkmcnt(5)
    v_mfma_f32_32x32x16_bf16 v[48:63], a[40:43], v[24:27], v[48:63]
    ds_read_b128 v[16:19], v10 offset:512
    buffer_load_dwordx4 v2, s[28:31], s35 offen offset:1024 lds
    s_waitcnt lgkmcnt(5)
    v_mfma_f32_32x32x16_bf16 v[48:63], a[44:47], v[28:31], v[48:63]
    ds_read_b128 v[20:23], v10 offset:544
    buffer_store_dwordx4 v[84:87], v2, s[4:7], s38 offen offset:1024
    s_add_u32 s38, s38, 0x40000
    s_bitset0_b32 s38, 30
    s_waitcnt lgkmcnt(5)
    v_mfma_f32_32x32x16_bf16 v[48:63], a[48:51], v[32:35], v[48:63]
    ds_read_b128 v[24:27], v10 offset:576
    s_add_u32 m0, s37, 72240
    s_add_u32 s35, s36, 6144
    buffer_load_dwordx4 v2, s[28:31], s35 offen offset:0 lds
    s_waitcnt lgkmcnt(5)
    v_mfma_f32_32x32x16_bf16 v[48:63], a[52:55], v[36:39], v[48:63]
    ds_read_b128 v[28:31], v10 offset:608
    s_waitcnt lgkmcnt(5)
    v_mfma_f32_32x32x16_bf16 v[48:63], a[56:59], v[40:43], v[48:63]
    ds_read_b128 v[32:35], v10 offset:640
    buffer_load_dwordx4 v2, s[28:31], s35 offen offset:1024 lds
    s_waitcnt lgkmcnt(5)
    v_mfma_f32_32x32x16_bf16 v[48:63], a[60:63], v[44:47], v[48:63]
    ds_read_b128 v[36:39], v10 offset:672
    s_waitcnt lgkmcnt(5)
    v_mfma_f32_32x32x16_bf16 v[48:63], a[64:67], v[16:19], v[48:63]
    ds_read_b128 v[40:43], v10 offset:704
    s_add_u32 m0, s37, 74304
    s_add_u32 s35, s36, 8192
    buffer_load_dwordx4 v2, s[28:31], s35 offen offset:0 lds
    s_waitcnt lgkmcnt(5)
    v_mfma_f32_32x32x16_bf16 v[48:63], a[68:71], v[20:23], v[48:63]
    ds_read_b128 v[44:47], v10 offset:736
    s_waitcnt lgkmcnt(5)
    v_mfma_f32_32x32x16_bf16 v[48:63], a[72:75], v[24:27], v[48:63]
    ds_read_b128 v[16:19], v10 offset:768
    buffer_load_dwordx4 v2, s[28:31], s35 offen offset:1024 lds
    s_waitcnt lgkmcnt(5)
    v_mfma_f32_32x32x16_bf16 v[48:63], a[76:79], v[28:31], v[48:63]
    ds_read_b128 v[20:23], v10 offset:800
    s_waitcnt lgkmcnt(5)
    v_mfma_f32_32x32x16_bf16 v[48:63], a[80:83], v[32:35], v[48:63]
    ds_read_b128 v[24:27], v10 offset:832
    s_add_u32 m0, s37, 76368
    s_add_u32 s35, s36, 10240
    buffer_load_dwordx4 v2, s[28:31], s35 offen offset:0 lds
    s_waitcnt lgkmcnt(5)
    v_mfma_f32_32x32x16_bf16 v[48:63], a[84:87], v[36:39], v[48:63]
    ds_read_b128 v[28:31], v10 offset:864
    s_waitcnt lgkmcnt(5)
    v_mfma_f32_32x32x16_bf16 v[48:63], a[88:91], v[40:43], v[48:63]
    ds_read_b128 v[32:35], v10 offset:896
    buffer_load_dwordx4 v2, s[28:31], s35 offen offset:1024 lds
    s_waitcnt lgkmcnt(5)
    v_mfma_f32_32x32x16_bf16 v[48:63], a[92:95], v[44:47], v[48:63]
    ds_read_b128 v[36:39], v10 offset:928
    s_waitcnt lgkmcnt(5)
    v_mfma_f32_32x32x16_bf16 v[48:63], a[96:99], v[16:19], v[48:63]
    ds_read_b128 v[40:43], v10 offset:960
    s_add_u32 m0, s37, 78432
    s_add_u32 s35, s36, 12288
    buffer_load_dwordx4 v2, s[28:31], s35 offen offset:0 lds
    s_waitcnt lgkmcnt(5)
    v_mfma_f32_32x32x16_bf16 v[48:63], a[100:103], v[20:23], v[48:63]
    ds_read_b128 v[44:47], v10 offset:992
    s_waitcnt lgkmcnt(5)
    v_mfma_f32_32x32x16_bf16 v[48:63], a[104:107], v[24:27], v[48:63]
    ds_read_b128 v[16:19], v10 offset:1024
    buffer_load_dwordx4 v2, s[28:31], s35 offen offset:1024 lds
    s_waitcnt lgkmcnt(5)
    v_mfma_f32_32x32x16_bf16 v[48:63], a[108:111], v[28:31], v[48:63]
    ds_read_b128 v[20:23], v10 offset:1056
    s_waitcnt lgkmcnt(5)
    v_mfma_f32_32x32x16_bf16 v[48:63], a[112:115], v[32:35], v[48:63]
    ds_read_b128 v[24:27], v10 offset:1088
    s_add_u32 m0, s37, 80496
    s_add_u32 s35, s36, 14336
    buffer_load_dwordx4 v2, s[28:31], s35 offen offset:0 lds
    s_waitcnt lgkmcnt(5)
    v_mfma_f32_32x32x16_bf16 v[48:63], a[116:119], v[36:39], v[48:63]
    ds_read_b128 v[28:31], v10 offset:1120
    s_waitcnt lgkmcnt(5)
    v_mfma_f32_32x32x16_bf16 v[48:63], a[120:123], v[40:43], v[48:63]
    ds_read_b128 v[32:35], v10 offset:1152
    buffer_load_dwordx4 v2, s[28:31], s35 offen offset:1024 lds
    s_waitcnt lgkmcnt(5)
    v_mfma_f32_32x32x16_bf16 v[48:63], a[124:127], v[44:47], v[48:63]
    ds_read_b128 v[36:39], v10 offset:1184
    s_waitcnt lgkmcnt(5)
    v_mfma_f32_32x32x16_bf16 v[48:63], a[128:131], v[16:19], v[48:63]
    ds_read_b128 v[40:43], v10 offset:1216
    s_waitcnt lgkmcnt(5)
    v_mfma_f32_32x32x16_bf16 v[48:63], a[132:135], v[20:23], v[48:63]
    ds_read_b128 v[44:47], v10 offset:1248
    s_waitcnt lgkmcnt(5)
    v_mfma_f32_32x32x16_bf16 v[48:63], a[136:139], v[24:27], v[48:63]
    ds_read_b128 v[16:19], v10 offset:1280
    s_waitcnt lgkmcnt(5)
    v_mfma_f32_32x32x16_bf16 v[48:63], a[140:143], v[28:31], v[48:63]
    ds_read_b128 v[20:23], v10 offset:1312
    s_waitcnt lgkmcnt(5)
    v_mfma_f32_32x32x16_bf16 v[48:63], a[144:147], v[32:35], v[48:63]
    ds_read_b128 v[24:27], v10 offset:1344
    s_waitcnt lgkmcnt(5)
    v_mfma_f32_32x32x16_bf16 v[48:63], a[148:151], v[36:39], v[48:63]
    ds_read_b128 v[28:31], v10 offset:1376
    s_waitcnt lgkmcnt(5)
    v_mfma_f32_32x32x16_bf16 v[48:63], a[152:155], v[40:43], v[48:63]
    ds_read_b128 v[32:35], v10 offset:1408
    s_waitcnt lgkmcnt(5)
    v_mfma_f32_32x32x16_bf16 v[48:63], a[156:159], v[44:47], v[48:63]
    ds_read_b128 v[36:39], v10 offset:1440
    s_waitcnt lgkmcnt(5)
    v_mfma_f32_32x32x16_bf16 v[48:63], a[160:163], v[16:19], v[48:63]
    ds_read_b128 v[40:43], v10 offset:1472
    s_waitcnt lgkmcnt(5)
    v_mfma_f32_32x32x16_bf16 v[48:63], a[164:167], v[20:23], v[48:63]
    ds_read_b128 v[44:47], v10 offset:1504
    s_waitcnt lgkmcnt(5)
    v_mfma_f32_32x32x16_bf16 v[48:63], a[168:171], v[24:27], v[48:63]
    ds_read_b128 v[16:19], v10 offset:1536
    s_waitcnt lgkmcnt(5)
    v_mfma_f32_32x32x16_bf16 v[48:63], a[172:175], v[28:31], v[48:63]
    ds_read_b128 v[20:23], v10 offset:1568
    s_waitcnt lgkmcnt(5)
    v_mfma_f32_32x32x16_bf16 v[48:63], a[176:179], v[32:35], v[48:63]
    ds_read_b128 v[24:27], v10 offset:1600
    s_waitcnt lgkmcnt(5)
    v_mfma_f32_32x32x16_bf16 v[48:63], a[180:183], v[36:39], v[48:63]
    ds_read_b128 v[28:31], v10 offset:1632
    s_waitcnt lgkmcnt(5)
    v_mfma_f32_32x32x16_bf16 v[48:63], a[184:187], v[40:43], v[48:63]
    ds_read_b128 v[32:35], v10 offset:1664
    s_waitcnt lgkmcnt(5)
    v_mfma_f32_32x32x16_bf16 v[48:63], a[188:191], v[44:47], v[48:63]
    ds_read_b128 v[36:39], v10 offset:1696
    s_waitcnt lgkmcnt(5)
    v_mfma_f32_32x32x16_bf16 v[48:63], a[192:195], v[16:19], v[48:63]
    ds_read_b128 v[40:43], v10 offset:1728
    s_waitcnt lgkmcnt(5)
    v_mfma_f32_32x32x16_bf16 v[48:63], a[196:199], v[20:23], v[48:63]
    ds_read_b128 v[44:47], v10 offset:1760
    s_waitcnt lgkmcnt(5)
    v_mfma_f32_32x32x16_bf16 v[48:63], a[200:203], v[24:27], v[48:63]
    ds_read_b128 v[16:19], v10 offset:1792
    s_waitcnt lgkmcnt(5)
    v_mfma_f32_32x32x16_bf16 v[48:63], a[204:207], v[28:31], v[48:63]
    ds_read_b128 v[20:23], v10 offset:1824
    s_waitcnt lgkmcnt(5)
    v_mfma_f32_32x32x16_bf16 v[48:63], a[208:211], v[32:35], v[48:63]
    ds_read_b128 v[24:27], v10 offset:1856
    s_waitcnt lgkmcnt(5)
    v_mfma_f32_32x32x16_bf16 v[48:63], a[212:215], v[36:39], v[48:63]
    ds_read_b128 v[28:31], v10 offset:1888
    s_waitcnt lgkmcnt(5)
    v_mfma_f32_32x32x16_bf16 v[48:63], a[216:219], v[40:43], v[48:63]
    ds_read_b128 v[32:35], v10 offset:1920
    s_waitcnt lgkmcnt(5)
    v_mfma_f32_32x32x16_bf16 v[48:63], a[220:223], v[44:47], v[48:63]
    ds_read_b128 v[36:39], v10 offset:1952
    s_waitcnt lgkmcnt(5)
    v_mfma_f32_32x32x16_bf16 v[48:63], a[224:227], v[16:19], v[48:63]
    ds_read_b128 v[40:43], v10 offset:1984
    s_waitcnt lgkmcnt(5)
    v_mfma_f32_32x32x16_bf16 v[48:63], a[228:231], v[20:23], v[48:63]
    ds_read_b128 v[44:47], v10 offset:2016
    s_add_u32 s32, s32, 1
    s_waitcnt lgkmcnt(5)
    v_mfma_f32_32x32x16_bf16 v[48:63], a[232:235], v[24:27], v[48:63]
    s_waitcnt lgkmcnt(4)
    v_mfma_f32_32x32x16_bf16 v[48:63], a[236:239], v[28:31], v[48:63]
    s_waitcnt lgkmcnt(0)
    s_waitcnt vmcnt(0)
    s_barrier
    ds_read_b128 v[16:19], v11 offset:0
    ds_read_b128 v[20:23], v11 offset:32
    v_mfma_f32_32x32x16_bf16 v[48:63], a[240:243], v[32:35], v[48:63]
    ds_read_b128 v[24:27], v11 offset:64
    ds_read_b128 v[28:31], v11 offset:96
    v_mfma_f32_32x32x16_bf16 v[48:63], a[244:247], v[36:39], v[48:63]
    ds_read_b128 v[32:35], v11 offset:128
    ds_read_b128 v[36:39], v11 offset:160
    v_mfma_f32_32x32x16_bf16 v[48:63], a[248:251], v[40:43], v[48:63]
    v_mfma_f32_32x32x16_bf16 v[48:63], a[252:255], v[44:47], v[48:63]
    s_waitcnt lgkmcnt(5)
    v_mfma_f32_32x32x16_bf16 v[64:79], a[0:3], v[16:19], 0
    ds_read_b128 v[40:43], v11 offset:192
    s_add_u32 s36, s36, 65536
    s_add_u32 m0, s37, 0
    s_add_u32 s35, s36, 0
    buffer_load_dwordx4 v2, s[28:31], s35 offen offset:0 lds
    s_waitcnt lgkmcnt(5)
    v_mfma_f32_32x32x16_bf16 v[64:79], a[4:7], v[20:23], v[64:79]
    ds_read_b128 v[44:47], v11 offset:224
    s_waitcnt lgkmcnt(5)
    v_mfma_f32_32x32x16_bf16 v[64:79], a[8:11], v[24:27], v[64:79]
    ds_read_b128 v[16:19], v11 offset:256
    buffer_load_dwordx4 v2, s[28:31], s35 offen offset:1024 lds
    s_waitcnt lgkmcnt(5)
    v_mfma_f32_32x32x16_bf16 v[64:79], a[12:15], v[28:31], v[64:79]
    ds_read_b128 v[20:23], v11 offset:288
    s_waitcnt lgkmcnt(5)
    v_mfma_f32_32x32x16_bf16 v[64:79], a[16:19], v[32:35], v[64:79]
    ds_read_b128 v[24:27], v11 offset:320
    s_add_u32 m0, s37, 2064
    s_add_u32 s35, s36, 2048
    buffer_load_dwordx4 v2, s[28:31], s35 offen offset:0 lds
    v_cvt_pk_bf16_f32 v80, v48, v49
    v_cvt_pk_bf16_f32 v81, v50, v51
    s_waitcnt lgkmcnt(5)
    v_mfma_f32_32x32x16_bf16 v[64:79], a[20:23], v[36:39], v[64:79]
    ds_read_b128 v[28:31], v11 offset:352
    v_cvt_pk_bf16_f32 v82, v52, v53
    v_cvt_pk_bf16_f32 v83, v54, v55
    s_waitcnt lgkmcnt(5)
    v_mfma_f32_32x32x16_bf16 v[64:79], a[24:27], v[40:43], v[64:79]
    ds_read_b128 v[32:35], v11 offset:384
    buffer_load_dwordx4 v2, s[28:31], s35 offen offset:1024 lds
    v_cvt_pk_bf16_f32 v84, v56, v57
    v_cvt_pk_bf16_f32 v85, v58, v59
    s_waitcnt lgkmcnt(5)
    v_mfma_f32_32x32x16_bf16 v[64:79], a[28:31], v[44:47], v[64:79]
    ds_read_b128 v[36:39], v11 offset:416
    v_cvt_pk_bf16_f32 v86, v60, v61
    v_cvt_pk_bf16_f32 v87, v62, v63
    s_waitcnt lgkmcnt(5)
    v_mfma_f32_32x32x16_bf16 v[64:79], a[32:35], v[16:19], v[64:79]
    ds_read_b128 v[40:43], v11 offset:448
    s_add_u32 m0, s37, 4128
    s_add_u32 s35, s36, 4096
    buffer_load_dwordx4 v2, s[28:31], s35 offen offset:0 lds
    s_waitcnt lgkmcnt(5)
    v_mfma_f32_32x32x16_bf16 v[64:79], a[36:39], v[20:23], v[64:79]
    ds_read_b128 v[44:47], v11 offset:480
    buffer_store_dwordx4 v[80:83], v2, s[4:7], s38 offen
    s_waitcnt lgkmcnt(5)
    v_mfma_f32_32x32x16_bf16 v[64:79], a[40:43], v[24:27], v[64:79]
    ds_read_b128 v[16:19], v11 offset:512
    buffer_load_dwordx4 v2, s[28:31], s35 offen offset:1024 lds
    s_waitcnt lgkmcnt(5)
    v_mfma_f32_32x32x16_bf16 v[64:79], a[44:47], v[28:31], v[64:79]
    ds_read_b128 v[20:23], v11 offset:544
    buffer_store_dwordx4 v[84:87], v2, s[4:7], s38 offen offset:1024
    s_add_u32 s38, s38, 0x40000
    s_bitset0_b32 s38, 30
    s_waitcnt lgkmcnt(5)
    v_mfma_f32_32x32x16_bf16 v[64:79], a[48:51], v[32:35], v[64:79]
    ds_read_b128 v[24:27], v11 offset:576
    s_add_u32 m0, s37, 6192
    s_add_u32 s35, s36, 6144
    buffer_load_dwordx4 v2, s[28:31], s35 offen offset:0 lds
    s_waitcnt lgkmcnt(5)
    v_mfma_f32_32x32x16_bf16 v[64:79], a[52:55], v[36:39], v[64:79]
    ds_read_b128 v[28:31], v11 offset:608
    s_waitcnt lgkmcnt(5)
    v_mfma_f32_32x32x16_bf16 v[64:79], a[56:59], v[40:43], v[64:79]
    ds_read_b128 v[32:35], v11 offset:640
    buffer_load_dwordx4 v2, s[28:31], s35 offen offset:1024 lds
    s_waitcnt lgkmcnt(5)
    v_mfma_f32_32x32x16_bf16 v[64:79], a[60:63], v[44:47], v[64:79]
    ds_read_b128 v[36:39], v11 offset:672
    s_waitcnt lgkmcnt(5)
    v_mfma_f32_32x32x16_bf16 v[64:79], a[64:67], v[16:19], v[64:79]
    ds_read_b128 v[40:43], v11 offset:704
    s_add_u32 m0, s37, 8256
    s_add_u32 s35, s36, 8192
    buffer_load_dwordx4 v2, s[28:31], s35 offen offset:0 lds
    s_waitcnt lgkmcnt(5)
    v_mfma_f32_32x32x16_bf16 v[64:79], a[68:71], v[20:23], v[64:79]
    ds_read_b128 v[44:47], v11 offset:736
    s_waitcnt lgkmcnt(5)
    v_mfma_f32_32x32x16_bf16 v[64:79], a[72:75], v[24:27], v[64:79]
    ds_read_b128 v[16:19], v11 offset:768
    buffer_load_dwordx4 v2, s[28:31], s35 offen offset:1024 lds
    s_waitcnt lgkmcnt(5)
    v_mfma_f32_32x32x16_bf16 v[64:79], a[76:79], v[28:31], v[64:79]
    ds_read_b128 v[20:23], v11 offset:800
    s_waitcnt lgkmcnt(5)
    v_mfma_f32_32x32x16_bf16 v[64:79], a[80:83], v[32:35], v[64:79]
    ds_read_b128 v[24:27], v11 offset:832
    s_add_u32 m0, s37, 10320
    s_add_u32 s35, s36, 10240
    buffer_load_dwordx4 v2, s[28:31], s35 offen offset:0 lds
    s_waitcnt lgkmcnt(5)
    v_mfma_f32_32x32x16_bf16 v[64:79], a[84:87], v[36:39], v[64:79]
    ds_read_b128 v[28:31], v11 offset:864
    s_waitcnt lgkmcnt(5)
    v_mfma_f32_32x32x16_bf16 v[64:79], a[88:91], v[40:43], v[64:79]
    ds_read_b128 v[32:35], v11 offset:896
    buffer_load_dwordx4 v2, s[28:31], s35 offen offset:1024 lds
    s_waitcnt lgkmcnt(5)
    v_mfma_f32_32x32x16_bf16 v[64:79], a[92:95], v[44:47], v[64:79]
    ds_read_b128 v[36:39], v11 offset:928
    s_waitcnt lgkmcnt(5)
    v_mfma_f32_32x32x16_bf16 v[64:79], a[96:99], v[16:19], v[64:79]
    ds_read_b128 v[40:43], v11 offset:960
    s_add_u32 m0, s37, 12384
    s_add_u32 s35, s36, 12288
    buffer_load_dwordx4 v2, s[28:31], s35 offen offset:0 lds
    s_waitcnt lgkmcnt(5)
    v_mfma_f32_32x32x16_bf16 v[64:79], a[100:103], v[20:23], v[64:79]
    ds_read_b128 v[44:47], v11 offset:992
    s_waitcnt lgkmcnt(5)
    v_mfma_f32_32x32x16_bf16 v[64:79], a[104:107], v[24:27], v[64:79]
    ds_read_b128 v[16:19], v11 offset:1024
    buffer_load_dwordx4 v2, s[28:31], s35 offen offset:1024 lds
    s_waitcnt lgkmcnt(5)
    v_mfma_f32_32x32x16_bf16 v[64:79], a[108:111], v[28:31], v[64:79]
    ds_read_b128 v[20:23], v11 offset:1056
    s_waitcnt lgkmcnt(5)
    v_mfma_f32_32x32x16_bf16 v[64:79], a[112:115], v[32:35], v[64:79]
    ds_read_b128 v[24:27], v11 offset:1088
    s_add_u32 m0, s37, 14448
    s_add_u32 s35, s36, 14336
    buffer_load_dwordx4 v2, s[28:31], s35 offen offset:0 lds
    s_waitcnt lgkmcnt(5)
    v_mfma_f32_32x32x16_bf16 v[64:79], a[116:119], v[36:39], v[64:79]
    ds_read_b128 v[28:31], v11 offset:1120
    s_waitcnt lgkmcnt(5)
    v_mfma_f32_32x32x16_bf16 v[64:79], a[120:123], v[40:43], v[64:79]
    ds_read_b128 v[32:35], v11 offset:1152
    buffer_load_dwordx4 v2, s[28:31], s35 offen offset:1024 lds
    s_waitcnt lgkmcnt(5)
    v_mfma_f32_32x32x16_bf16 v[64:79], a[124:127], v[44:47], v[64:79]
    ds_read_b128 v[36:39], v11 offset:1184
    s_waitcnt lgkmcnt(5)
    v_mfma_f32_32x32x16_bf16 v[64:79], a[128:131], v[16:19], v[64:79]
    ds_read_b128 v[40:43], v11 offset:1216
    s_waitcnt lgkmcnt(5)
    v_mfma_f32_32x32x16_bf16 v[64:79], a[132:135], v[20:23], v[64:79]
    ds_read_b128 v[44:47], v11 offset:1248
    s_waitcnt lgkmcnt(5)
    v_mfma_f32_32x32x16_bf16 v[64:79], a[136:139], v[24:27], v[64:79]
    ds_read_b128 v[16:19], v11 offset:1280
    s_waitcnt lgkmcnt(5)
    v_mfma_f32_32x32x16_bf16 v[64:79], a[140:143], v[28:31], v[64:79]
    ds_read_b128 v[20:23], v11 offset:1312
    s_waitcnt lgkmcnt(5)
    v_mfma_f32_32x32x16_bf16 v[64:79], a[144:147], v[32:35], v[64:79]
    ds_read_b128 v[24:27], v11 offset:1344
    s_waitcnt lgkmcnt(5)
    v_mfma_f32_32x32x16_bf16 v[64:79], a[148:151], v[36:39], v[64:79]
    ds_read_b128 v[28:31], v11 offset:1376
    s_waitcnt lgkmcnt(5)
    v_mfma_f32_32x32x16_bf16 v[64:79], a[152:155], v[40:43], v[64:79]
    ds_read_b128 v[32:35], v11 offset:1408
    s_waitcnt lgkmcnt(5)
    v_mfma_f32_32x32x16_bf16 v[64:79], a[156:159], v[44:47], v[64:79]
    ds_read_b128 v[36:39], v11 offset:1440
    s_waitcnt lgkmcnt(5)
    v_mfma_f32_32x32x16_bf16 v[64:79], a[160:163], v[16:19], v[64:79]
    ds_read_b128 v[40:43], v11 offset:1472
    s_waitcnt lgkmcnt(5)
    v_mfma_f32_32x32x16_bf16 v[64:79], a[164:167], v[20:23], v[64:79]
    ds_read_b128 v[44:47], v11 offset:1504
    s_waitcnt lgkmcnt(5)
    v_mfma_f32_32x32x16_bf16 v[64:79], a[168:171], v[24:27], v[64:79]
    ds_read_b128 v[16:19], v11 offset:1536
    s_waitcnt lgkmcnt(5)
    v_mfma_f32_32x32x16_bf16 v[64:79], a[172:175], v[28:31], v[64:79]
    ds_read_b128 v[20:23], v11 offset:1568
    s_waitcnt lgkmcnt(5)
    v_mfma_f32_32x32x16_bf16 v[64:79], a[176:179], v[32:35], v[64:79]
    ds_read_b128 v[24:27], v11 offset:1600
    s_waitcnt lgkmcnt(5)
    v_mfma_f32_32x32x16_bf16 v[64:79], a[180:183], v[36:39], v[64:79]
    ds_read_b128 v[28:31], v11 offset:1632
    s_waitcnt lgkmcnt(5)
    v_mfma_f32_32x32x16_bf16 v[64:79], a[184:187], v[40:43], v[64:79]
    ds_read_b128 v[32:35], v11 offset:1664
    s_waitcnt lgkmcnt(5)
    v_mfma_f32_32x32x16_bf16 v[64:79], a[188:191], v[44:47], v[64:79]
    ds_read_b128 v[36:39], v11 offset:1696
    s_waitcnt lgkmcnt(5)
    v_mfma_f32_32x32x16_bf16 v[64:79], a[192:195], v[16:19], v[64:79]
    ds_read_b128 v[40:43], v11 offset:1728
    s_waitcnt lgkmcnt(5)
    v_mfma_f32_32x32x16_bf16 v[64:79], a[196:199], v[20:23], v[64:79]
    ds_read_b128 v[44:47], v11 offset:1760
    s_waitcnt lgkmcnt(5)
    v_mfma_f32_32x32x16_bf16 v[64:79], a[200:203], v[24:27], v[64:79]
    ds_read_b128 v[16:19], v11 offset:1792
    s_waitcnt lgkmcnt(5)
    v_mfma_f32_32x32x16_bf16 v[64:79], a[204:207], v[28:31], v[64:79]
    ds_read_b128 v[20:23], v11 offset:1824
    s_waitcnt lgkmcnt(5)
    v_mfma_f32_32x32x16_bf16 v[64:79], a[208:211], v[32:35], v[64:79]
    ds_read_b128 v[24:27], v11 offset:1856
    s_waitcnt lgkmcnt(5)
    v_mfma_f32_32x32x16_bf16 v[64:79], a[212:215], v[36:39], v[64:79]
    ds_read_b128 v[28:31], v11 offset:1888
    s_waitcnt lgkmcnt(5)
    v_mfma_f32_32x32x16_bf16 v[64:79], a[216:219], v[40:43], v[64:79]
    ds_read_b128 v[32:35], v11 offset:1920
    s_waitcnt lgkmcnt(5)
    v_mfma_f32_32x32x16_bf16 v[64:79], a[220:223], v[44:47], v[64:79]
    ds_read_b128 v[36:39], v11 offset:1952
    s_waitcnt lgkmcnt(5)
    v_mfma_f32_32x32x16_bf16 v[64:79], a[224:227], v[16:19], v[64:79]
    ds_read_b128 v[40:43], v11 offset:1984
    s_waitcnt lgkmcnt(5)
    v_mfma_f32_32x32x16_bf16 v[64:79], a[228:231], v[20:23], v[64:79]
    ds_read_b128 v[44:47], v11 offset:2016
    s_add_u32 s32, s32, 1
    s_waitcnt lgkmcnt(5)
    v_mfma_f32_32x32x16_bf16 v[64:79], a[232:235], v[24:27], v[64:79]
    s_waitcnt lgkmcnt(4)
    v_mfma_f32_32x32x16_bf16 v[64:79], a[236:239], v[28:31], v[64:79]
    s_waitcnt lgkmcnt(0)
    s_waitcnt vmcnt(0)
    s_barrier
    ds_read_b128 v[16:19], v10 offset:0
    ds_read_b128 v[20:23], v10 offset:32
    v_mfma_f32_32x32x16_bf16 v[64:79], a[240:243], v[32:35], v[64:79]
    ds_read_b128 v[24:27], v10 offset:64
    ds_read_b128 v[28:31], v10 offset:96
    v_mfma_f32_32x32x16_bf16 v[64:79], a[244:247], v[36:39], v[64:79]
    ds_read_b128 v[32:35], v10 offset:128
    ds_read_b128 v[36:39], v10 offset:160
    v_mfma_f32_32x32x16_bf16 v[64:79], a[248:251], v[40:43], v[64:79]
    v_mfma_f32_32x32x16_bf16 v[64:79], a[252:255], v[44:47], v[64:79]
    s_cmp_eq_u32 s32, 4
    s_cbranch_scc1 L_rQ_loop
    s_sub_u32 s42, s32, 8
    s_add_u32 s42, s42, s18
    s_waitcnt lgkmcnt(0)
L_rQ_akv:
    s_min_u32 s33, s44, s45
    s_min_u32 s33, s33, s46
    s_min_u32 s33, s33, s47
    s_min_u32 s33, s33, s48
    s_min_u32 s33, s33, s49
    s_min_u32 s33, s33, s50
    s_min_u32 s33, s33, s51
    s_cmp_gt_u32 s33, s42
    s_cbranch_scc1 L_rQ_akvok
    s_load_dwordx16 s[44:59], s[4:5], s39 glc
    s_add_u32 s40, s40, 1
    s_cmp_gt_u32 s40, 400000
    s_cbranch_scc1 L_done
    s_waitcnt lgkmcnt(0)
    s_branch L_rQ_akv
L_rQ_akvok:
    s_lshl_b32 s34, s42, 5
    s_add_u32 s34, s34, s17
    s_lshl_b32 s41, s34, 13
    s_add_u32 s35, s41, 16777216
    buffer_load_dwordx4 v[80:83], v6, s[4:7], s35 offen offset:0 sc1
    buffer_load_dwordx4 v[84:87], v6, s[4:7], s35 offen offset:1024 sc1
    buffer_load_dwordx4 v[88:91], v6, s[4:7], s35 offen offset:2048 sc1
    buffer_load_dwordx4 v[92:95], v6, s[4:7], s35 offen offset:3072 sc1
    s_add_u32 s35, s41, 16781312
    buffer_load_dwordx4 v[96:99], v6, s[4:7], s35 offen offset:0 sc1
    buffer_load_dwordx4 v[100:103], v6, s[4:7], s35 offen offset:1024 sc1
    buffer_load_dwordx4 v[104:107], v6, s[4:7], s35 offen offset:2048 sc1
    buffer_load_dwordx4 v[108:111], v6, s[4:7], s35 offen offset:3072 sc1
    s_add_u32 s35, s41, 50331648
    buffer_load_dwordx4 v[144:147], v2, s[4:7], s35 offen offset:0 sc1
    buffer_load_dwordx4 v[148:151], v2, s[4:7], s35 offen offset:1024 sc1
    buffer_load_dwordx4 v[152:155], v2, s[4:7], s35 offen offset:2048 sc1
    buffer_load_dwordx4 v[156:159], v2, s[4:7], s35 offen offset:3072 sc1
    s_add_u32 s35, s41, 50335744
    buffer_load_dwordx4 v[160:163], v2, s[4:7], s35 offen offset:0 sc1
    buffer_load_dwordx4 v[164:167], v2, s[4:7], s35 offen offset:1024 sc1
    buffer_load_dwordx4 v[168:171], v2, s[4:7], s35 offen offset:2048 sc1
    buffer_load_dwordx4 v[172:175], v2, s[4:7], s35 offen offset:3072 sc1
    s_add_u32 s35, s41, 33554432
    buffer_load_dwordx4 v[176:179], v6, s[4:7], s35 offen offset:0 sc1
    buffer_load_dwordx4 v[180:183], v6, s[4:7], s35 offen offset:1024 sc1
    buffer_load_dwordx4 v[184:187], v6, s[4:7], s35 offen offset:2048 sc1
    buffer_load_dwordx4 v[188:191], v6, s[4:7], s35 offen offset:3072 sc1
    s_add_u32 s35, s41, 33558528
    buffer_load_dwordx4 v[192:195], v6, s[4:7], s35 offen offset:0 sc1
    buffer_load_dwordx4 v[196:199], v6, s[4:7], s35 offen offset:1024 sc1
    buffer_load_dwordx4 v[200:203], v6, s[4:7], s35 offen offset:2048 sc1
    buffer_load_dwordx4 v[204:207], v6, s[4:7], s35 offen offset:3072 sc1
L_rQ_am:
    s_min_u32 s33, s52, s53
    s_min_u32 s33, s33, s54
    s_min_u32 s33, s33, s55
    s_cmp_gt_u32 s33, s42
    s_cbranch_scc1 L_rQ_amok
    s_load_dwordx16 s[44:59], s[4:5], s39 glc
    s_add_u32 s40, s40, 1
    s_cmp_gt_u32 s40, 400000
    s_cbranch_scc1 L_done
    s_waitcnt lgkmcnt(0)
    s_branch L_rQ_am
L_rQ_amok:
    s_lshr_b32 s34, s41, 2
    s_add_u32 s35, s34, 4194304
    buffer_load_dwordx4 v[112:115], v12, s[4:7], s35 offen offset:0 sc1
    buffer_load_dwordx4 v[116:119], v12, s[4:7], s35 offen offset:32 sc1
    buffer_load_dwordx4 v[120:123], v12, s[4:7], s35 offen offset:512 sc1
    buffer_load_dwordx4 v[124:127], v12, s[4:7], s35 offen offset:544 sc1
    buffer_load_dwordx4 v[128:131], v12, s[4:7], s35 offen offset:1024 sc1
    buffer_load_dwordx4 v[132:135], v12, s[4:7], s35 offen offset:1056 sc1
    buffer_load_dwordx4 v[136:139], v12, s[4:7], s35 offen offset:1536 sc1
    buffer_load_dwordx4 v[140:143], v12, s[4:7], s35 offen offset:1568 sc1
    s_add_u32 s35, s34, 8388608
    buffer_load_dwordx2 v[208:209], v13, s[4:7], s35 offen offset:0 sc1
    buffer_load_dwordx2 v[210:211], v13, s[4:7], s35 offen offset:512 sc1
    buffer_load_dwordx2 v[212:213], v13, s[4:7], s35 offen offset:1024 sc1
    buffer_load_dwordx2 v[214:215], v13, s[4:7], s35 offen offset:1536 sc1
    s_waitcnt vmcnt(20)
    v_mfma_f32_32x32x16_bf16 v[48:63], v[80:83], v[144:147], v[232:247]
    v_mfma_f32_32x32x16_bf16 v[48:63], v[84:87], v[148:151], v[48:63]
    v_mfma_f32_32x32x16_bf16 v[48:63], v[88:91], v[152:155], v[48:63]
    v_mfma_f32_32x32x16_bf16 v[48:63], v[92:95], v[156:159], v[48:63]
    v_mfma_f32_32x32x16_bf16 v[48:63], v[96:99], v[160:163], v[48:63]
    v_mfma_f32_32x32x16_bf16 v[48:63], v[100:103], v[164:167], v[48:63]
    v_mfma_f32_32x32x16_bf16 v[48:63], v[104:107], v[168:171], v[48:63]
    v_mfma_f32_32x32x16_bf16 v[48:63], v[108:111], v[172:175], v[48:63]
    s_waitcnt vmcnt(4)
    v_mfma_f32_32x32x16_bf16 v[216:231], v[112:115], v[144:147], 0
    v_mfma_f32_32x32x16_bf16 v[216:231], v[116:119], v[148:151], v[216:231]
    v_mfma_f32_32x32x16_bf16 v[216:231], v[120:123], v[152:155], v[216:231]
    v_mfma_f32_32x32x16_bf16 v[216:231], v[124:127], v[156:159], v[216:231]
    v_mfma_f32_32x32x16_bf16 v[216:231], v[128:131], v[160:163], v[216:231]
    v_mfma_f32_32x32x16_bf16 v[216:231], v[132:135], v[164:167], v[216:231]
    v_mfma_f32_32x32x16_bf16 v[216:231], v[136:139], v[168:171], v[216:231]
    v_mfma_f32_32x32x16_bf16 v[216:231], v[140:143], v[172:175], v[216:231]
    s_nop 3
    v_max3_f32 v3, v48, v49, v50
    v_max3_f32 v3, v3, v51, v52
    v_max3_f32 v3, v3, v53, v54
    v_max3_f32 v3, v3, v55, v56
    v_max3_f32 v3, v3, v57, v58
    v_max3_f32 v3, v3, v59, v60
    v_max3_f32 v3, v3, v61, v62
    v_max_f32 v3, v3, v63
    v_max3_f32 v3, v3, v216, v217
    v_max3_f32 v3, v3, v218, v219
    v_mov_b32 v4, v3
    s_nop 1
    v_permlane32_swap_b32 v3, v4
    s_nop 0
    v_max_f32 v3, v3, v4
    v_mul_f32 v3, v248, v3
    v_fma_f32 v48, v48, v248, -v3
    v_fma_f32 v49, v49, v248, -v3
    v_fma_f32 v50, v50, v248, -v3
    v_fma_f32 v51, v51, v248, -v3
    v_fma_f32 v52, v52, v248, -v3
    v_fma_f32 v53, v53, v248, -v3
    v_fma_f32 v54, v54, v248, -v3
    v_fma_f32 v55, v55, v248, -v3
    v_fma_f32 v56, v56, v248, -v3
    v_fma_f32 v57, v57, v248, -v3
    v_fma_f32 v58, v58, v248, -v3
    v_fma_f32 v59, v59, v248, -v3
    v_fma_f32 v60, v60, v248, -v3
    v_fma_f32 v61, v61, v248, -v3
    v_fma_f32 v62, v62, v248, -v3
    v_fma_f32 v63, v63, v248, -v3
    v_fma_f32 v216, v216, v248, -v3
    v_fma_f32 v217, v217, v248, -v3
    v_fma_f32 v218, v218, v248, -v3
    v_fma_f32 v219, v219, v248, -v3
    v_exp_f32 v48, v48
    v_exp_f32 v49, v49
    v_exp_f32 v50, v50
    v_exp_f32 v51, v51
    v_exp_f32 v52, v52
    v_exp_f32 v53, v53
    v_exp_f32 v54, v54
    v_exp_f32 v55, v55
    v_exp_f32 v56, v56
    v_exp_f32 v57, v57
    v_exp_f32 v58, v58
    v_exp_f32 v59, v59
    v_exp_f32 v60, v60
    v_exp_f32 v61, v61
    v_exp_f32 v62, v62
    v_exp_f32 v63, v63
    v_exp_f32 v216, v216
    v_exp_f32 v217, v217
    v_exp_f32 v218, v218
    v_exp_f32 v219, v219
    v_pk_add_f32 v[250:251], v[48:49], v[50:51]
    v_pk_add_f32 v[250:251], v[250:251], v[52:53]
    v_pk_add_f32 v[250:251], v[250:251], v[54:55]
    v_pk_add_f32 v[250:251], v[250:251], v[56:57]
    v_pk_add_f32 v[250:251], v[250:251], v[58:59]
    v_pk_add_f32 v[250:251], v[250:251], v[60:61]
    v_pk_add_f32 v[250:251], v[250:251], v[62:63]
    v_pk_add_f32 v[250:251], v[250:251], v[216:217]
    v_pk_add_f32 v[250:251], v[250:251], v[218:219]
    v_add_f32 v3, v250, v251
    v_add_f32 v4, v250, v251
    s_nop 1
    v_permlane32_swap_b32 v3, v4
    s_nop 0
    v_add_f32 v3, v3, v4
    v_rcp_f32 v250, v3
    s_nop 0
    v_pk_mul_f32 v[48:49], v[48:49], v[250:251] op_sel_hi:[1,0]
    v_pk_mul_f32 v[50:51], v[50:51], v[250:251] op_sel_hi:[1,0]
    v_pk_mul_f32 v[52:53], v[52:53], v[250:251] op_sel_hi:[1,0]
    v_pk_mul_f32 v[54:55], v[54:55], v[250:251] op_sel_hi:[1,0]
    v_pk_mul_f32 v[56:57], v[56:57], v[250:251] op_sel_hi:[1,0]
    v_pk_mul_f32 v[58:59], v[58:59], v[250:251] op_sel_hi:[1,0]
    v_pk_mul_f32 v[60:61], v[60:61], v[250:251] op_sel_hi:[1,0]
    v_pk_mul_f32 v[62:63], v[62:63], v[250:251] op_sel_hi:[1,0]
    v_pk_mul_f32 v[216:217], v[216:217], v[250:251] op_sel_hi:[1,0]
    v_pk_mul_f32 v[218:219], v[218:219], v[250:251] op_sel_hi:[1,0]
    v_cvt_pk_bf16_f32 v144, v48, v49
    v_cvt_pk_bf16_f32 v145, v50, v51
    v_cvt_pk_bf16_f32 v146, v52, v53
    v_cvt_pk_bf16_f32 v147, v54, v55
    v_cvt_pk_bf16_f32 v148, v56, v57
    v_cvt_pk_bf16_f32 v149, v58, v59
    v_cvt_pk_bf16_f32 v150, v60, v61
    v_cvt_pk_bf16_f32 v151, v62, v63
    v_cvt_pk_bf16_f32 v152, v216, v217
    v_cvt_pk_bf16_f32 v153, v218, v219
    s_waitcnt vmcnt(0)
    s_add_u32 s35, s41, 67108864
    s_add_u32 s34, s35, 4096
    v_mfma_f32_32x32x16_bf16 v[80:95], v[176:179], v[144:147], 0
    v_mfma_f32_32x32x16_bf16 v[80:95], v[180:183], v[148:151], v[80:95]
    v_mfma_f32_32x32x8_bf16 v[80:95], v[208:209], v[152:153], v[80:95]
    v_mfma_f32_32x32x16_bf16 v[96:111], v[184:187], v[144:147], 0
    v_mfma_f32_32x32x16_bf16 v[96:111], v[188:191], v[148:151], v[96:111]
    v_mfma_f32_32x32x8_bf16 v[96:111], v[210:211], v[152:153], v[96:111]
    v_mfma_f32_32x32x16_bf16 v[112:127], v[192:195], v[144:147], 0
    v_mfma_f32_32x32x16_bf16 v[112:127], v[196:199], v[148:151], v[112:127]
    v_mfma_f32_32x32x8_bf16 v[112:127], v[212:213], v[152:153], v[112:127]
    v_mfma_f32_32x32x16_bf16 v[128:143], v[200:203], v[144:147], 0
    v_mfma_f32_32x32x16_bf16 v[128:143], v[204:207], v[148:151], v[128:143]
    v_mfma_f32_32x32x8_bf16 v[128:143], v[214:215], v[152:153], v[128:143]
    s_nop 2
    v_cvt_pk_bf16_f32 v176, v80, v81
    v_cvt_pk_bf16_f32 v177, v82, v83
    v_cvt_pk_bf16_f32 v178, v84, v85
    v_cvt_pk_bf16_f32 v179, v86, v87
    v_cvt_pk_bf16_f32 v180, v88, v89
    v_cvt_pk_bf16_f32 v181, v90, v91
    v_cvt_pk_bf16_f32 v182, v92, v93
    v_cvt_pk_bf16_f32 v183, v94, v95
    buffer_store_dwordx4 v[176:179], v2, s[4:7], s35 offen offset:0 sc1
    buffer_store_dwordx4 v[180:183], v2, s[4:7], s35 offen offset:1024 sc1
    v_cvt_pk_bf16_f32 v184, v96, v97
    v_cvt_pk_bf16_f32 v185, v98, v99
    v_cvt_pk_bf16_f32 v186, v100, v101
    v_cvt_pk_bf16_f32 v187, v102, v103
    v_cvt_pk_bf16_f32 v188, v104, v105
    v_cvt_pk_bf16_f32 v189, v106, v107
    v_cvt_pk_bf16_f32 v190, v108, v109
    v_cvt_pk_bf16_f32 v191, v110, v111
    buffer_store_dwordx4 v[184:187], v2, s[4:7], s35 offen offset:2048 sc1
    buffer_store_dwordx4 v[188:191], v2, s[4:7], s35 offen offset:3072 sc1
    v_cvt_pk_bf16_f32 v192, v112, v113
    v_cvt_pk_bf16_f32 v193, v114, v115
    v_cvt_pk_bf16_f32 v194, v116, v117
    v_cvt_pk_bf16_f32 v195, v118, v119
    v_cvt_pk_bf16_f32 v196, v120, v121
    v_cvt_pk_bf16_f32 v197, v122, v123
    v_cvt_pk_bf16_f32 v198, v124, v125
    v_cvt_pk_bf16_f32 v199, v126, v127
    buffer_store_dwordx4 v[192:195], v2, s[4:7], s34 offen offset:0 sc1
    buffer_store_dwordx4 v[196:199], v2, s[4:7], s34 offen offset:1024 sc1
    v_cvt_pk_bf16_f32 v200, v128, v129
    v_cvt_pk_bf16_f32 v201, v130, v131
    v_cvt_pk_bf16_f32 v202, v132, v133
    v_cvt_pk_bf16_f32 v203, v134, v135
    v_cvt_pk_bf16_f32 v204, v136, v137
    v_cvt_pk_bf16_f32 v205, v138, v139
    v_cvt_pk_bf16_f32 v206, v140, v141
    v_cvt_pk_bf16_f32 v207, v142, v143
    buffer_store_dwordx4 v[200:203], v2, s[4:7], s34 offen offset:2048 sc1
    buffer_store_dwordx4 v[204:207], v2, s[4:7], s34 offen offset:3072 sc1
    v_add_u32 v9, 1, v9
    s_cmp_lt_u32 s32, 64
    s_cbranch_scc1 L_rQ_loop
    s_nop 11
    v_cvt_pk_bf16_f32 v80, v64, v65
    v_cvt_pk_bf16_f32 v81, v66, v67
    v_cvt_pk_bf16_f32 v82, v68, v69
    v_cvt_pk_bf16_f32 v83, v70, v71
    v_cvt_pk_bf16_f32 v84, v72, v73
    v_cvt_pk_bf16_f32 v85, v74, v75
    v_cvt_pk_bf16_f32 v86, v76, v77
    v_cvt_pk_bf16_f32 v87, v78, v79
    buffer_store_dwordx4 v[80:83], v2, s[4:7], s38 offen
    buffer_store_dwordx4 v[84:87], v2, s[4:7], s38 offen offset:1024
    s_add_u32 s38, s38, 0x40000
    s_waitcnt vmcnt(0)
    buffer_store_dword v9, v8, s[4:7], 0 offen sc1
    s_barrier
    s_mov_b32 s42, 60
    s_add_u32 s42, s42, s18
    s_waitcnt lgkmcnt(0)
L_rQ_bkv:
    s_min_u32 s33, s44, s45
    s_min_u32 s33, s33, s46
    s_min_u32 s33, s33, s47
    s_min_u32 s33, s33, s48
    s_min_u32 s33, s33, s49
    s_min_u32 s33, s33, s50
    s_min_u32 s33, s33, s51
    s_cmp_gt_u32 s33, s42
    s_cbranch_scc1 L_rQ_bkvok
    s_load_dwordx16 s[44:59], s[4:5], s39 glc
    s_add_u32 s40, s40, 1
    s_cmp_gt_u32 s40, 400000
    s_cbranch_scc1 L_done
    s_waitcnt lgkmcnt(0)
    s_branch L_rQ_bkv
L_rQ_bkvok:
    s_lshl_b32 s34, s42, 5
    s_add_u32 s34, s34, s17
    s_lshl_b32 s41, s34, 13
    s_add_u32 s35, s41, 16777216
    buffer_load_dwordx4 v[80:83], v6, s[4:7], s35 offen offset:0 sc1
    buffer_load_dwordx4 v[84:87], v6, s[4:7], s35 offen offset:1024 sc1
    buffer_load_dwordx4 v[88:91], v6, s[4:7], s35 offen offset:2048 sc1
    buffer_load_dwordx4 v[92:95], v6, s[4:7], s35 offen offset:3072 sc1
    s_add_u32 s35, s41, 16781312
    buffer_load_dwordx4 v[96:99], v6, s[4:7], s35 offen offset:0 sc1
    buffer_load_dwordx4 v[100:103], v6, s[4:7], s35 offen offset:1024 sc1
    buffer_load_dwordx4 v[104:107], v6, s[4:7], s35 offen offset:2048 sc1
    buffer_load_dwordx4 v[108:111], v6, s[4:7], s35 offen offset:3072 sc1
    s_add_u32 s35, s41, 50331648
    buffer_load_dwordx4 v[144:147], v2, s[4:7], s35 offen offset:0 sc1
    buffer_load_dwordx4 v[148:151], v2, s[4:7], s35 offen offset:1024 sc1
    buffer_load_dwordx4 v[152:155], v2, s[4:7], s35 offen offset:2048 sc1
    buffer_load_dwordx4 v[156:159], v2, s[4:7], s35 offen offset:3072 sc1
    s_add_u32 s35, s41, 50335744
    buffer_load_dwordx4 v[160:163], v2, s[4:7], s35 offen offset:0 sc1
    buffer_load_dwordx4 v[164:167], v2, s[4:7], s35 offen offset:1024 sc1
    buffer_load_dwordx4 v[168:171], v2, s[4:7], s35 offen offset:2048 sc1
    buffer_load_dwordx4 v[172:175], v2, s[4:7], s35 offen offset:3072 sc1
    s_add_u32 s35, s41, 33554432
    buffer_load_dwordx4 v[176:179], v6, s[4:7], s35 offen offset:0 sc1
    buffer_load_dwordx4 v[180:183], v6, s[4:7], s35 offen offset:1024 sc1
    buffer_load_dwordx4 v[184:187], v6, s[4:7], s35 offen offset:2048 sc1
    buffer_load_dwordx4 v[188:191], v6, s[4:7], s35 offen offset:3072 sc1
    s_add_u32 s35, s41, 33558528
    buffer_load_dwordx4 v[192:195], v6, s[4:7], s35 offen offset:0 sc1
    buffer_load_dwordx4 v[196:199], v6, s[4:7], s35 offen offset:1024 sc1
    buffer_load_dwordx4 v[200:203], v6, s[4:7], s35 offen offset:2048 sc1
    buffer_load_dwordx4 v[204:207], v6, s[4:7], s35 offen offset:3072 sc1
L_rQ_bm:
    s_min_u32 s33, s52, s53
    s_min_u32 s33, s33, s54
    s_min_u32 s33, s33, s55
    s_cmp_gt_u32 s33, s42
    s_cbranch_scc1 L_rQ_bmok
    s_load_dwordx16 s[44:59], s[4:5], s39 glc
    s_add_u32 s40, s40, 1
    s_cmp_gt_u32 s40, 400000
    s_cbranch_scc1 L_done
    s_waitcnt lgkmcnt(0)
    s_branch L_rQ_bm
L_rQ_bmok:
    s_lshr_b32 s34, s41, 2
    s_add_u32 s35, s34, 4194304
    buffer_load_dwordx4 v[112:115], v12, s[4:7], s35 offen offset:0 sc1
    buffer_load_dwordx4 v[116:119], v12, s[4:7], s35 offen offset:32 sc1
    buffer_load_dwordx4 v[120:123], v12, s[4:7], s35 offen offset:512 sc1
    buffer_load_dwordx4 v[124:127], v12, s[4:7], s35 offen offset:544 sc1
    buffer_load_dwordx4 v[128:131], v12, s[4:7], s35 offen offset:1024 sc1
    buffer_load_dwordx4 v[132:135], v12, s[4:7], s35 offen offset:1056 sc1
    buffer_load_dwordx4 v[136:139], v12, s[4:7], s35 offen offset:1536 sc1
    buffer_load_dwordx4 v[140:143], v12, s[4:7], s35 offen offset:1568 sc1
    s_add_u32 s35, s34, 8388608
    buffer_load_dwordx2 v[208:209], v13, s[4:7], s35 offen offset:0 sc1
    buffer_load_dwordx2 v[210:211], v13, s[4:7], s35 offen offset:512 sc1
    buffer_load_dwordx2 v[212:213], v13, s[4:7], s35 offen offset:1024 sc1
    buffer_load_dwordx2 v[214:215], v13, s[4:7], s35 offen offset:1536 sc1
    s_waitcnt vmcnt(20)
    v_mfma_f32_32x32x16_bf16 v[48:63], v[80:83], v[144:147], v[232:247]
    v_mfma_f32_32x32x16_bf16 v[48:63], v[84:87], v[148:151], v[48:63]
    v_mfma_f32_32x32x16_bf16 v[48:63], v[88:91], v[152:155], v[48:63]
    v_mfma_f32_32x32x16_bf16 v[48:63], v[92:95], v[156:159], v[48:63]
    v_mfma_f32_32x32x16_bf16 v[48:63], v[96:99], v[160:163], v[48:63]
    v_mfma_f32_32x32x16_bf16 v[48:63], v[100:103], v[164:167], v[48:63]
    v_mfma_f32_32x32x16_bf16 v[48:63], v[104:107], v[168:171], v[48:63]
    v_mfma_f32_32x32x16_bf16 v[48:63], v[108:111], v[172:175], v[48:63]
    s_waitcnt vmcnt(4)
    v_mfma_f32_32x32x16_bf16 v[216:231], v[112:115], v[144:147], 0
    v_mfma_f32_32x32x16_bf16 v[216:231], v[116:119], v[148:151], v[216:231]
    v_mfma_f32_32x32x16_bf16 v[216:231], v[120:123], v[152:155], v[216:231]
    v_mfma_f32_32x32x16_bf16 v[216:231], v[124:127], v[156:159], v[216:231]
    v_mfma_f32_32x32x16_bf16 v[216:231], v[128:131], v[160:163], v[216:231]
    v_mfma_f32_32x32x16_bf16 v[216:231], v[132:135], v[164:167], v[216:231]
    v_mfma_f32_32x32x16_bf16 v[216:231], v[136:139], v[168:171], v[216:231]
    v_mfma_f32_32x32x16_bf16 v[216:231], v[140:143], v[172:175], v[216:231]
    s_nop 3
    v_max3_f32 v3, v48, v49, v50
    v_max3_f32 v3, v3, v51, v52
    v_max3_f32 v3, v3, v53, v54
    v_max3_f32 v3, v3, v55, v56
    v_max3_f32 v3, v3, v57, v58
    v_max3_f32 v3, v3, v59, v60
    v_max3_f32 v3, v3, v61, v62
    v_max_f32 v3, v3, v63
    v_max3_f32 v3, v3, v216, v217
    v_max3_f32 v3, v3, v218, v219
    v_mov_b32 v4, v3
    s_nop 1
    v_permlane32_swap_b32 v3, v4
    s_nop 0
    v_max_f32 v3, v3, v4
    v_mul_f32 v3, v248, v3
    v_fma_f32 v48, v48, v248, -v3
    v_fma_f32 v49, v49, v248, -v3
    v_fma_f32 v50, v50, v248, -v3
    v_fma_f32 v51, v51, v248, -v3
    v_fma_f32 v52, v52, v248, -v3
    v_fma_f32 v53, v53, v248, -v3
    v_fma_f32 v54, v54, v248, -v3
    v_fma_f32 v55, v55, v248, -v3
    v_fma_f32 v56, v56, v248, -v3
    v_fma_f32 v57, v57, v248, -v3
    v_fma_f32 v58, v58, v248, -v3
    v_fma_f32 v59, v59, v248, -v3
    v_fma_f32 v60, v60, v248, -v3
    v_fma_f32 v61, v61, v248, -v3
    v_fma_f32 v62, v62, v248, -v3
    v_fma_f32 v63, v63, v248, -v3
    v_fma_f32 v216, v216, v248, -v3
    v_fma_f32 v217, v217, v248, -v3
    v_fma_f32 v218, v218, v248, -v3
    v_fma_f32 v219, v219, v248, -v3
    v_exp_f32 v48, v48
    v_exp_f32 v49, v49
    v_exp_f32 v50, v50
    v_exp_f32 v51, v51
    v_exp_f32 v52, v52
    v_exp_f32 v53, v53
    v_exp_f32 v54, v54
    v_exp_f32 v55, v55
    v_exp_f32 v56, v56
    v_exp_f32 v57, v57
    v_exp_f32 v58, v58
    v_exp_f32 v59, v59
    v_exp_f32 v60, v60
    v_exp_f32 v61, v61
    v_exp_f32 v62, v62
    v_exp_f32 v63, v63
    v_exp_f32 v216, v216
    v_exp_f32 v217, v217
    v_exp_f32 v218, v218
    v_exp_f32 v219, v219
    v_pk_add_f32 v[250:251], v[48:49], v[50:51]
    v_pk_add_f32 v[250:251], v[250:251], v[52:53]
    v_pk_add_f32 v[250:251], v[250:251], v[54:55]
    v_pk_add_f32 v[250:251], v[250:251], v[56:57]
    v_pk_add_f32 v[250:251], v[250:251], v[58:59]
    v_pk_add_f32 v[250:251], v[250:251], v[60:61]
    v_pk_add_f32 v[250:251], v[250:251], v[62:63]
    v_pk_add_f32 v[250:251], v[250:251], v[216:217]
    v_pk_add_f32 v[250:251], v[250:251], v[218:219]
    v_add_f32 v3, v250, v251
    v_add_f32 v4, v250, v251
    s_nop 1
    v_permlane32_swap_b32 v3, v4
    s_nop 0
    v_add_f32 v3, v3, v4
    v_rcp_f32 v250, v3
    s_nop 0
    v_pk_mul_f32 v[48:49], v[48:49], v[250:251] op_sel_hi:[1,0]
    v_pk_mul_f32 v[50:51], v[50:51], v[250:251] op_sel_hi:[1,0]
    v_pk_mul_f32 v[52:53], v[52:53], v[250:251] op_sel_hi:[1,0]
    v_pk_mul_f32 v[54:55], v[54:55], v[250:251] op_sel_hi:[1,0]
    v_pk_mul_f32 v[56:57], v[56:57], v[250:251] op_sel_hi:[1,0]
    v_pk_mul_f32 v[58:59], v[58:59], v[250:251] op_sel_hi:[1,0]
    v_pk_mul_f32 v[60:61], v[60:61], v[250:251] op_sel_hi:[1,0]
    v_pk_mul_f32 v[62:63], v[62:63], v[250:251] op_sel_hi:[1,0]
    v_pk_mul_f32 v[216:217], v[216:217], v[250:251] op_sel_hi:[1,0]
    v_pk_mul_f32 v[218:219], v[218:219], v[250:251] op_sel_hi:[1,0]
    v_cvt_pk_bf16_f32 v144, v48, v49
    v_cvt_pk_bf16_f32 v145, v50, v51
    v_cvt_pk_bf16_f32 v146, v52, v53
    v_cvt_pk_bf16_f32 v147, v54, v55
    v_cvt_pk_bf16_f32 v148, v56, v57
    v_cvt_pk_bf16_f32 v149, v58, v59
    v_cvt_pk_bf16_f32 v150, v60, v61
    v_cvt_pk_bf16_f32 v151, v62, v63
    v_cvt_pk_bf16_f32 v152, v216, v217
    v_cvt_pk_bf16_f32 v153, v218, v219
    s_waitcnt vmcnt(0)
    s_add_u32 s35, s41, 67108864
    s_add_u32 s34, s35, 4096
    v_mfma_f32_32x32x16_bf16 v[80:95], v[176:179], v[144:147], 0
    v_mfma_f32_32x32x16_bf16 v[80:95], v[180:183], v[148:151], v[80:95]
    v_mfma_f32_32x32x8_bf16 v[80:95], v[208:209], v[152:153], v[80:95]
    v_mfma_f32_32x32x16_bf16 v[96:111], v[184:187], v[144:147], 0
    v_mfma_f32_32x32x16_bf16 v[96:111], v[188:191], v[148:151], v[96:111]
    v_mfma_f32_32x32x8_bf16 v[96:111], v[210:211], v[152:153], v[96:111]
    v_mfma_f32_32x32x16_bf16 v[112:127], v[192:195], v[144:147], 0
    v_mfma_f32_32x32x16_bf16 v[112:127], v[196:199], v[148:151], v[112:127]
    v_mfma_f32_32x32x8_bf16 v[112:127], v[212:213], v[152:153], v[112:127]
    v_mfma_f32_32x32x16_bf16 v[128:143], v[200:203], v[144:147], 0
    v_mfma_f32_32x32x16_bf16 v[128:143], v[204:207], v[148:151], v[128:143]
    v_mfma_f32_32x32x8_bf16 v[128:143], v[214:215], v[152:153], v[128:143]
    s_nop 2
    v_cvt_pk_bf16_f32 v176, v80, v81
    v_cvt_pk_bf16_f32 v177, v82, v83
    v_cvt_pk_bf16_f32 v178, v84, v85
    v_cvt_pk_bf16_f32 v179, v86, v87
    v_cvt_pk_bf16_f32 v180, v88, v89
    v_cvt_pk_bf16_f32 v181, v90, v91
    v_cvt_pk_bf16_f32 v182, v92, v93
    v_cvt_pk_bf16_f32 v183, v94, v95
    buffer_store_dwordx4 v[176:179], v2, s[4:7], s35 offen offset:0 sc1
    buffer_store_dwordx4 v[180:183], v2, s[4:7], s35 offen offset:1024 sc1
    v_cvt_pk_bf16_f32 v184, v96, v97
    v_cvt_pk_bf16_f32 v185, v98, v99
    v_cvt_pk_bf16_f32 v186, v100, v101
    v_cvt_pk_bf16_f32 v187, v102, v103
    v_cvt_pk_bf16_f32 v188, v104, v105
    v_cvt_pk_bf16_f32 v189, v106, v107
    v_cvt_pk_bf16_f32 v190, v108, v109
    v_cvt_pk_bf16_f32 v191, v110, v111
    buffer_store_dwordx4 v[184:187], v2, s[4:7], s35 offen offset:2048 sc1
    buffer_store_dwordx4 v[188:191], v2, s[4:7], s35 offen offset:3072 sc1
    v_cvt_pk_bf16_f32 v192, v112, v113
    v_cvt_pk_bf16_f32 v193, v114, v115
    v_cvt_pk_bf16_f32 v194, v116, v117
    v_cvt_pk_bf16_f32 v195, v118, v119
    v_cvt_pk_bf16_f32 v196, v120, v121
    v_cvt_pk_bf16_f32 v197, v122, v123
    v_cvt_pk_bf16_f32 v198, v124, v125
    v_cvt_pk_bf16_f32 v199, v126, v127
    buffer_store_dwordx4 v[192:195], v2, s[4:7], s34 offen offset:0 sc1
    buffer_store_dwordx4 v[196:199], v2, s[4:7], s34 offen offset:1024 sc1
    v_cvt_pk_bf16_f32 v200, v128, v129
    v_cvt_pk_bf16_f32 v201, v130, v131
    v_cvt_pk_bf16_f32 v202, v132, v133
    v_cvt_pk_bf16_f32 v203, v134, v135
    v_cvt_pk_bf16_f32 v204, v136, v137
    v_cvt_pk_bf16_f32 v205, v138, v139
    v_cvt_pk_bf16_f32 v206, v140, v141
    v_cvt_pk_bf16_f32 v207, v142, v143
    buffer_store_dwordx4 v[200:203], v2, s[4:7], s34 offen offset:2048 sc1
    buffer_store_dwordx4 v[204:207], v2, s[4:7], s34 offen offset:3072 sc1
    v_add_u32 v9, 1, v9
    s_waitcnt vmcnt(0)
    buffer_store_dword v9, v8, s[4:7], 0 offen sc1
    s_waitcnt vmcnt(0) lgkmcnt(0)
    s_barrier
    s_branch L_done
L_role_O:
    v_and_b32 v1, 63, v0
    v_lshlrev_b32 v2, 4, v1
    v_bfrev_b32 v7, 1
    s_mov_b32 s40, 0
    v_and_b32 v5, 0x13, v1
    v_bfe_u32 v3, v1, 2, 1
    v_lshl_add_u32 v5, v3, 3, v5
    v_bfe_u32 v3, v1, 3, 1
    v_lshl_add_u32 v5, v3, 2, v5
    v_lshrrev_b32 v4, 5, v1
    v_lshlrev_b32 v3, 9, v4
    v_lshl_add_u32 v6, v5, 4, v3
    v_mov_b32 v10, v2
    v_add_u32 v11, 65536, v10
    s_and_b32 s33, s17, 7
    s_lshl_b32 s33, s33, 2
    s_add_u32 s33, s33, s18
    s_lshl_b32 s33, s33, 7
    s_add_u32 s33, s33, 3751936
    s_mov_b32 s41, s33
    s_lshr_b32 s34, s17, 3
    s_lshl_b32 s34, s34, 2
    s_add_u32 s33, s33, s34
    v_mov_b32 v3, s33
    v_cmp_eq_u32 vcc, 0, v1
    v_mov_b32 v9, 0
    s_nop 0
    v_cndmask_b32 v8, v7, v3, vcc
    buffer_store_dword v9, v8, s[4:7], 0 offen sc1
    s_waitcnt vmcnt(0)
    s_barrier
    s_cmp_lg_u32 s18, 0
    s_cbranch_scc1 L_sig_12
    v_mov_b32 v3, s22
    v_mov_b32 v4, 1
    s_mov_b64 exec, 1
    buffer_atomic_add v4, v3, s[12:15], 0 offen sc1
    s_mov_b64 exec, -1
L_sig_12:
    s_load_dwordx2 s[8:9], s[0:1], 40
    s_mov_b32 s10, 8388608
    s_mov_b32 s11, 0x20000
    v_lshrrev_b32 v80, 2, v1
    v_lshlrev_b32 v80, 11, v80
    v_and_b32 v3, 3, v1
    v_lshl_add_u32 v80, v3, 4, v80
    s_lshr_b32 s33, s17, 3
    s_lshl_b32 s33, s33, 21
    s_and_b32 s34, s17, 7
    s_lshl_b32 s34, s34, 8
    s_add_u32 s33, s33, s34
    s_lshl_b32 s34, s18, 6
    s_add_u32 s33, s33, s34
    v_bfe_u32 v81, v1, 2, 2
    v_lshrrev_b32 v3, 5, v1
    v_lshl_add_u32 v81, v3, 3, v81
    v_lshlrev_b32 v81, 6, v81
    v_bfe_u32 v3, v1, 4, 1
    v_lshl_add_u32 v81, v3, 5, v81
    v_and_b32 v3, 1, v1
    v_lshl_add_u32 v81, v3, 4, v81
    v_bfe_u32 v3, v1, 1, 1
    v_lshl_add_u32 v81, v3, 3, v81
    s_lshl_b32 s35, s18, 15
    v_add_u32 v81, s35, v81
    s_waitcnt lgkmcnt(0)
    s_add_u32 s34, s35, 0
    s_mov_b32 m0, s34
    s_add_u32 s34, s34, 1024
    buffer_load_dwordx4 v80, s[8:11], s33 offen lds
    s_add_u32 s33, s33, 32768
    s_mov_b32 m0, s34
    s_add_u32 s34, s34, 1024
    buffer_load_dwordx4 v80, s[8:11], s33 offen lds
    s_add_u32 s33, s33, 32768
    s_mov_b32 m0, s34
    s_add_u32 s34, s34, 1024
    buffer_load_dwordx4 v80, s[8:11], s33 offen lds
    s_add_u32 s33, s33, 32768
    s_mov_b32 m0, s34
    s_add_u32 s34, s34, 1024
    buffer_load_dwordx4 v80, s[8:11], s33 offen lds
    s_add_u32 s33, s33, 32768
    s_mov_b32 m0, s34
    s_add_u32 s34, s34, 1024
    buffer_load_dwordx4 v80, s[8:11], s33 offen lds
    s_add_u32 s33, s33, 32768
    s_mov_b32 m0, s34
    s_add_u32 s34, s34, 1024
    buffer_load_dwordx4 v80, s[8:11], s33 offen lds
    s_add_u32 s33, s33, 32768
    s_mov_b32 m0, s34
    s_add_u32 s34, s34, 1024
    buffer_load_dwordx4 v80, s[8:11], s33 offen lds
    s_add_u32 s33, s33, 32768
    s_mov_b32 m0, s34
    s_add_u32 s34, s34, 1024
    buffer_load_dwordx4 v80, s[8:11], s33 offen lds
    s_add_u32 s33, s33, 32768
    s_mov_b32 m0, s34
    s_add_u32 s34, s34, 1024
    buffer_load_dwordx4 v80, s[8:11], s33 offen lds
    s_add_u32 s33, s33, 32768
    s_mov_b32 m0, s34
    s_add_u32 s34, s34, 1024
    buffer_load_dwordx4 v80, s[8:11], s33 offen lds
    s_add_u32 s33, s33, 32768
    s_mov_b32 m0, s34
    s_add_u32 s34, s34, 1024
    buffer_load_dwordx4 v80, s[8:11], s33 offen lds
    s_add_u32 s33, s33, 32768
    s_mov_b32 m0, s34
    s_add_u32 s34, s34, 1024
    buffer_load_dwordx4 v80, s[8:11], s33 offen lds
    s_add_u32 s33, s33, 32768
    s_mov_b32 m0, s34
    s_add_u32 s34, s34, 1024
    buffer_load_dwordx4 v80, s[8:11], s33 offen lds
    s_add_u32 s33, s33, 32768
    s_mov_b32 m0, s34
    s_add_u32 s34, s34, 1024
    buffer_load_dwordx4 v80, s[8:11], s33 offen lds
    s_add_u32 s33, s33, 32768
    s_mov_b32 m0, s34
    s_add_u32 s34, s34, 1024
    buffer_load_dwordx4 v80, s[8:11], s33 offen lds
    s_add_u32 s33, s33, 32768
    s_mov_b32 m0, s34
    s_add_u32 s34, s34, 1024
    buffer_load_dwordx4 v80, s[8:11], s33 offen lds
    s_add_u32 s33, s33, 32768
    s_add_u32 s34, s35, 16384
    s_mov_b32 m0, s34
    s_add_u32 s34, s34, 1024
    buffer_load_dwordx4 v80, s[8:11], s33 offen lds
    s_add_u32 s33, s33, 32768
    s_mov_b32 m0, s34
    s_add_u32 s34, s34, 1024
    buffer_load_dwordx4 v80, s[8:11], s33 offen lds
    s_add_u32 s33, s33, 32768
    s_mov_b32 m0, s34
    s_add_u32 s34, s34, 1024
    buffer_load_dwordx4 v80, s[8:11], s33 offen lds
    s_add_u32 s33, s33, 32768
    s_mov_b32 m0, s34
    s_add_u32 s34, s34, 1024
    buffer_load_dwordx4 v80, s[8:11], s33 offen lds
    s_add_u32 s33, s33, 32768
    s_mov_b32 m0, s34
    s_add_u32 s34, s34, 1024
    buffer_load_dwordx4 v80, s[8:11], s33 offen lds
    s_add_u32 s33, s33, 32768
    s_mov_b32 m0, s34
    s_add_u32 s34, s34, 1024
    buffer_load_dwordx4 v80, s[8:11], s33 offen lds
    s_add_u32 s33, s33, 32768
    s_mov_b32 m0, s34
    s_add_u32 s34, s34, 1024
    buffer_load_dwordx4 v80, s[8:11], s33 offen lds
    s_add_u32 s33, s33, 32768
    s_mov_b32 m0, s34
    s_add_u32 s34, s34, 1024
    buffer_load_dwordx4 v80, s[8:11], s33 offen lds
    s_add_u32 s33, s33, 32768
    s_mov_b32 m0, s34
    s_add_u32 s34, s34, 1024
    buffer_load_dwordx4 v80, s[8:11], s33 offen lds
    s_add_u32 s33, s33, 32768
    s_mov_b32 m0, s34
    s_add_u32 s34, s34, 1024
    buffer_load_dwordx4 v80, s[8:11], s33 offen lds
    s_add_u32 s33, s33, 32768
    s_mov_b32 m0, s34
    s_add_u32 s34, s34, 1024
    buffer_load_dwordx4 v80, s[8:11], s33 offen lds
    s_add_u32 s33, s33, 32768
    s_mov_b32 m0, s34
    s_add_u32 s34, s34, 1024
    buffer_load_dwordx4 v80, s[8:11], s33 offen lds
    s_add_u32 s33, s33, 32768
    s_mov_b32 m0, s34
    s_add_u32 s34, s34, 1024
    buffer_load_dwordx4 v80, s[8:11], s33 offen lds
    s_add_u32 s33, s33, 32768
    s_mov_b32 m0, s34
    s_add_u32 s34, s34, 1024
    buffer_load_dwordx4 v80, s[8:11], s33 offen lds
    s_add_u32 s33, s33, 32768
    s_mov_b32 m0, s34
    s_add_u32 s34, s34, 1024
    buffer_load_dwordx4 v80, s[8:11], s33 offen lds
    s_add_u32 s33, s33, 32768
    s_mov_b32 m0, s34
    s_add_u32 s34, s34, 1024
    buffer_load_dwordx4 v80, s[8:11], s33 offen lds
    s_add_u32 s33, s33, 32768
    s_waitcnt vmcnt(16)
    ds_read_b64_tr_b16 a[0:1], v81 offset:0
    ds_read_b64_tr_b16 a[2:3], v81 offset:256
    ds_read_b64_tr_b16 a[4:5], v81 offset:1024
    ds_read_b64_tr_b16 a[6:7], v81 offset:1280
    ds_read_b64_tr_b16 a[8:9], v81 offset:2048
    ds_read_b64_tr_b16 a[10:11], v81 offset:2304
    ds_read_b64_tr_b16 a[12:13], v81 offset:3072
    ds_read_b64_tr_b16 a[14:15], v81 offset:3328
    s_waitcnt lgkmcnt(0)
    ds_read_b64_tr_b16 a[16:17], v81 offset:4096
    ds_read_b64_tr_b16 a[18:19], v81 offset:4352
    ds_read_b64_tr_b16 a[20:21], v81 offset:5120
    ds_read_b64_tr_b16 a[22:23], v81 offset:5376
    ds_read_b64_tr_b16 a[24:25], v81 offset:6144
    ds_read_b64_tr_b16 a[26:27], v81 offset:6400
    ds_read_b64_tr_b16 a[28:29], v81 offset:7168
    ds_read_b64_tr_b16 a[30:31], v81 offset:7424
    s_waitcnt lgkmcnt(0)
    ds_read_b64_tr_b16 a[32:33], v81 offset:8192
    ds_read_b64_tr_b16 a[34:35], v81 offset:8448
    ds_read_b64_tr_b16 a[36:37], v81 offset:9216
    ds_read_b64_tr_b16 a[38:39], v81 offset:9472
    ds_read_b64_tr_b16 a[40:41], v81 offset:10240
    ds_read_b64_tr_b16 a[42:43], v81 offset:10496
    ds_read_b64_tr_b16 a[44:45], v81 offset:11264
    ds_read_b64_tr_b16 a[46:47], v81 offset:11520
    s_waitcnt lgkmcnt(0)
    ds_read_b64_tr_b16 a[48:49], v81 offset:12288
    ds_read_b64_tr_b16 a[50:51], v81 offset:12544
    ds_read_b64_tr_b16 a[52:53], v81 offset:13312
    ds_read_b64_tr_b16 a[54:55], v81 offset:13568
    ds_read_b64_tr_b16 a[56:57], v81 offset:14336
    ds_read_b64_tr_b16 a[58:59], v81 offset:14592
    ds_read_b64_tr_b16 a[60:61], v81 offset:15360
    ds_read_b64_tr_b16 a[62:63], v81 offset:15616
    s_waitcnt lgkmcnt(0)
    s_add_u32 s34, s35, 0
    s_mov_b32 m0, s34
    s_add_u32 s34, s34, 1024
    buffer_load_dwordx4 v80, s[8:11], s33 offen lds
    s_add_u32 s33, s33, 32768
    s_mov_b32 m0, s34
    s_add_u32 s34, s34, 1024
    buffer_load_dwordx4 v80, s[8:11], s33 offen lds
    s_add_u32 s33, s33, 32768
    s_mov_b32 m0, s34
    s_add_u32 s34, s34, 1024
    buffer_load_dwordx4 v80, s[8:11], s33 offen lds
    s_add_u32 s33, s33, 32768
    s_mov_b32 m0, s34
    s_add_u32 s34, s34, 1024
    buffer_load_dwordx4 v80, s[8:11], s33 offen lds
    s_add_u32 s33, s33, 32768
    s_mov_b32 m0, s34
    s_add_u32 s34, s34, 1024
    buffer_load_dwordx4 v80, s[8:11], s33 offen lds
    s_add_u32 s33, s33, 32768
    s_mov_b32 m0, s34
    s_add_u32 s34, s34, 1024
    buffer_load_dwordx4 v80, s[8:11], s33 offen lds
    s_add_u32 s33, s33, 32768
    s_mov_b32 m0, s34
    s_add_u32 s34, s34, 1024
    buffer_load_dwordx4 v80, s[8:11], s33 offen lds
    s_add_u32 s33, s33, 32768
    s_mov_b32 m0, s34
    s_add_u32 s34, s34, 1024
    buffer_load_dwordx4 v80, s[8:11], s33 offen lds
    s_add_u32 s33, s33, 32768
    s_mov_b32 m0, s34
    s_add_u32 s34, s34, 1024
    buffer_load_dwordx4 v80, s[8:11], s33 offen lds
    s_add_u32 s33, s33, 32768
    s_mov_b32 m0, s34
    s_add_u32 s34, s34, 1024
    buffer_load_dwordx4 v80, s[8:11], s33 offen lds
    s_add_u32 s33, s33, 32768
    s_mov_b32 m0, s34
    s_add_u32 s34, s34, 1024
    buffer_load_dwordx4 v80, s[8:11], s33 offen lds
    s_add_u32 s33, s33, 32768
    s_mov_b32 m0, s34
    s_add_u32 s34, s34, 1024
    buffer_load_dwordx4 v80, s[8:11], s33 offen lds
    s_add_u32 s33, s33, 32768
    s_mov_b32 m0, s34
    s_add_u32 s34, s34, 1024
    buffer_load_dwordx4 v80, s[8:11], s33 offen lds
    s_add_u32 s33, s33, 32768
    s_mov_b32 m0, s34
    s_add_u32 s34, s34, 1024
    buffer_load_dwordx4 v80, s[8:11], s33 offen lds
    s_add_u32 s33, s33, 32768
    s_mov_b32 m0, s34
    s_add_u32 s34, s34, 1024
    buffer_load_dwordx4 v80, s[8:11], s33 offen lds
    s_add_u32 s33, s33, 32768
    s_mov_b32 m0, s34
    s_add_u32 s34, s34, 1024
    buffer_load_dwordx4 v80, s[8:11], s33 offen lds
    s_add_u32 s33, s33, 32768
    s_waitcnt vmcnt(16)
    ds_read_b64_tr_b16 a[64:65], v81 offset:16384
    ds_read_b64_tr_b16 a[66:67], v81 offset:16640
    ds_read_b64_tr_b16 a[68:69], v81 offset:17408
    ds_read_b64_tr_b16 a[70:71], v81 offset:17664
    ds_read_b64_tr_b16 a[72:73], v81 offset:18432
    ds_read_b64_tr_b16 a[74:75], v81 offset:18688
    ds_read_b64_tr_b16 a[76:77], v81 offset:19456
    ds_read_b64_tr_b16 a[78:79], v81 offset:19712
    s_waitcnt lgkmcnt(0)
    ds_read_b64_tr_b16 a[80:81], v81 offset:20480
    ds_read_b64_tr_b16 a[82:83], v81 offset:20736
    ds_read_b64_tr_b16 a[84:85], v81 offset:21504
    ds_read_b64_tr_b16 a[86:87], v81 offset:21760
    ds_read_b64_tr_b16 a[88:89], v81 offset:22528
    ds_read_b64_tr_b16 a[90:91], v81 offset:22784
    ds_read_b64_tr_b16 a[92:93], v81 offset:23552
    ds_read_b64_tr_b16 a[94:95], v81 offset:23808
    s_waitcnt lgkmcnt(0)
    ds_read_b64_tr_b16 a[96:97], v81 offset:24576
    ds_read_b64_tr_b16 a[98:99], v81 offset:24832
    ds_read_b64_tr_b16 a[100:101], v81 offset:25600
    ds_read_b64_tr_b16 a[102:103], v81 offset:25856
    ds_read_b64_tr_b16 a[104:105], v81 offset:26624
    ds_read_b64_tr_b16 a[106:107], v81 offset:26880
    ds_read_b64_tr_b16 a[108:109], v81 offset:27648
    ds_read_b64_tr_b16 a[110:111], v81 offset:27904
    s_waitcnt lgkmcnt(0)
    ds_read_b64_tr_b16 a[112:113], v81 offset:28672
    ds_read_b64_tr_b16 a[114:115], v81 offset:28928
    ds_read_b64_tr_b16 a[116:117], v81 offset:29696
    ds_read_b64_tr_b16 a[118:119], v81 offset:29952
    ds_read_b64_tr_b16 a[120:121], v81 offset:30720
    ds_read_b64_tr_b16 a[122:123], v81 offset:30976
    ds_read_b64_tr_b16 a[124:125], v81 offset:31744
    ds_read_b64_tr_b16 a[126:127], v81 offset:32000
    s_waitcnt lgkmcnt(0)
    s_add_u32 s34, s35, 16384
    s_mov_b32 m0, s34
    s_add_u32 s34, s34, 1024
    buffer_load_dwordx4 v80, s[8:11], s33 offen lds
    s_add_u32 s33, s33, 32768
    s_mov_b32 m0, s34
    s_add_u32 s34, s34, 1024
    buffer_load_dwordx4 v80, s[8:11], s33 offen lds
    s_add_u32 s33, s33, 32768
    s_mov_b32 m0, s34
    s_add_u32 s34, s34, 1024
    buffer_load_dwordx4 v80, s[8:11], s33 offen lds
    s_add_u32 s33, s33, 32768
    s_mov_b32 m0, s34
    s_add_u32 s34, s34, 1024
    buffer_load_dwordx4 v80, s[8:11], s33 offen lds
    s_add_u32 s33, s33, 32768
    s_mov_b32 m0, s34
    s_add_u32 s34, s34, 1024
    buffer_load_dwordx4 v80, s[8:11], s33 offen lds
    s_add_u32 s33, s33, 32768
    s_mov_b32 m0, s34
    s_add_u32 s34, s34, 1024
    buffer_load_dwordx4 v80, s[8:11], s33 offen lds
    s_add_u32 s33, s33, 32768
    s_mov_b32 m0, s34
    s_add_u32 s34, s34, 1024
    buffer_load_dwordx4 v80, s[8:11], s33 offen lds
    s_add_u32 s33, s33, 32768
    s_mov_b32 m0, s34
    s_add_u32 s34, s34, 1024
    buffer_load_dwordx4 v80, s[8:11], s33 offen lds
    s_add_u32 s33, s33, 32768
    s_mov_b32 m0, s34
    s_add_u32 s34, s34, 1024
    buffer_load_dwordx4 v80, s[8:11], s33 offen lds
    s_add_u32 s33, s33, 32768
    s_mov_b32 m0, s34
    s_add_u32 s34, s34, 1024
    buffer_load_dwordx4 v80, s[8:11], s33 offen lds
    s_add_u32 s33, s33, 32768
    s_mov_b32 m0, s34
    s_add_u32 s34, s34, 1024
    buffer_load_dwordx4 v80, s[8:11], s33 offen lds
    s_add_u32 s33, s33, 32768
    s_mov_b32 m0, s34
    s_add_u32 s34, s34, 1024
    buffer_load_dwordx4 v80, s[8:11], s33 offen lds
    s_add_u32 s33, s33, 32768
    s_mov_b32 m0, s34
    s_add_u32 s34, s34, 1024
    buffer_load_dwordx4 v80, s[8:11], s33 offen lds
    s_add_u32 s33, s33, 32768
    s_mov_b32 m0, s34
    s_add_u32 s34, s34, 1024
    buffer_load_dwordx4 v80, s[8:11], s33 offen lds
    s_add_u32 s33, s33, 32768
    s_mov_b32 m0, s34
    s_add_u32 s34, s34, 1024
    buffer_load_dwordx4 v80, s[8:11], s33 offen lds
    s_add_u32 s33, s33, 32768
    s_mov_b32 m0, s34
    s_add_u32 s34, s34, 1024
    buffer_load_dwordx4 v80, s[8:11], s33 offen lds
    s_add_u32 s33, s33, 32768
    s_waitcnt vmcnt(16)
    ds_read_b64_tr_b16 a[128:129], v81 offset:0
    ds_read_b64_tr_b16 a[130:131], v81 offset:256
    ds_read_b64_tr_b16 a[132:133], v81 offset:1024
    ds_read_b64_tr_b16 a[134:135], v81 offset:1280
    ds_read_b64_tr_b16 a[136:137], v81 offset:2048
    ds_read_b64_tr_b16 a[138:139], v81 offset:2304
    ds_read_b64_tr_b16 a[140:141], v81 offset:3072
    ds_read_b64_tr_b16 a[142:143], v81 offset:3328
    s_waitcnt lgkmcnt(0)
    ds_read_b64_tr_b16 a[144:145], v81 offset:4096
    ds_read_b64_tr_b16 a[146:147], v81 offset:4352
    ds_read_b64_tr_b16 a[148:149], v81 offset:5120
    ds_read_b64_tr_b16 a[150:151], v81 offset:5376
    ds_read_b64_tr_b16 a[152:153], v81 offset:6144
    ds_read_b64_tr_b16 a[154:155], v81 offset:6400
    ds_read_b64_tr_b16 a[156:157], v81 offset:7168
    ds_read_b64_tr_b16 a[158:159], v81 offset:7424
    s_waitcnt lgkmcnt(0)
    ds_read_b64_tr_b16 a[160:161], v81 offset:8192
    ds_read_b64_tr_b16 a[162:163], v81 offset:8448
    ds_read_b64_tr_b16 a[164:165], v81 offset:9216
    ds_read_b64_tr_b16 a[166:167], v81 offset:9472
    ds_read_b64_tr_b16 a[168:169], v81 offset:10240
    ds_read_b64_tr_b16 a[170:171], v81 offset:10496
    ds_read_b64_tr_b16 a[172:173], v81 offset:11264
    ds_read_b64_tr_b16 a[174:175], v81 offset:11520
    s_waitcnt lgkmcnt(0)
    ds_read_b64_tr_b16 a[176:177], v81 offset:12288
    ds_read_b64_tr_b16 a[178:179], v81 offset:12544
    ds_read_b64_tr_b16 a[180:181], v81 offset:13312
    ds_read_b64_tr_b16 a[182:183], v81 offset:13568
    ds_read_b64_tr_b16 a[184:185], v81 offset:14336
    ds_read_b64_tr_b16 a[186:187], v81 offset:14592
    ds_read_b64_tr_b16 a[188:189], v81 offset:15360
    ds_read_b64_tr_b16 a[190:191], v81 offset:15616
    s_waitcnt lgkmcnt(0)
    s_waitcnt vmcnt(0)
    ds_read_b64_tr_b16 a[192:193], v81 offset:16384
    ds_read_b64_tr_b16 a[194:195], v81 offset:16640
    ds_read_b64_tr_b16 a[196:197], v81 offset:17408
    ds_read_b64_tr_b16 a[198:199], v81 offset:17664
    ds_read_b64_tr_b16 a[200:201], v81 offset:18432
    ds_read_b64_tr_b16 a[202:203], v81 offset:18688
    ds_read_b64_tr_b16 a[204:205], v81 offset:19456
    ds_read_b64_tr_b16 a[206:207], v81 offset:19712
    s_waitcnt lgkmcnt(0)
    ds_read_b64_tr_b16 a[208:209], v81 offset:20480
    ds_read_b64_tr_b16 a[210:211], v81 offset:20736
    ds_read_b64_tr_b16 a[212:213], v81 offset:21504
    ds_read_b64_tr_b16 a[214:215], v81 offset:21760
    ds_read_b64_tr_b16 a[216:217], v81 offset:22528
    ds_read_b64_tr_b16 a[218:219], v81 offset:22784
    ds_read_b64_tr_b16 a[220:221], v81 offset:23552
    ds_read_b64_tr_b16 a[222:223], v81 offset:23808
    s_waitcnt lgkmcnt(0)
    ds_read_b64_tr_b16 a[224:225], v81 offset:24576
    ds_read_b64_tr_b16 a[226:227], v81 offset:24832
    ds_read_b64_tr_b16 a[228:229], v81 offset:25600
    ds_read_b64_tr_b16 a[230:231], v81 offset:25856
    ds_read_b64_tr_b16 a[232:233], v81 offset:26624
    ds_read_b64_tr_b16 a[234:235], v81 offset:26880
    ds_read_b64_tr_b16 a[236:237], v81 offset:27648
    ds_read_b64_tr_b16 a[238:239], v81 offset:27904
    s_waitcnt lgkmcnt(0)
    ds_read_b64_tr_b16 a[240:241], v81 offset:28672
    ds_read_b64_tr_b16 a[242:243], v81 offset:28928
    ds_read_b64_tr_b16 a[244:245], v81 offset:29696
    ds_read_b64_tr_b16 a[246:247], v81 offset:29952
    ds_read_b64_tr_b16 a[248:249], v81 offset:30720
    ds_read_b64_tr_b16 a[250:251], v81 offset:30976
    ds_read_b64_tr_b16 a[252:253], v81 offset:31744
    ds_read_b64_tr_b16 a[254:255], v81 offset:32000
    s_waitcnt lgkmcnt(0)
    s_barrier
    s_mov_b32 s3, 0
L_rdy_13:
    buffer_load_dwordx2 v[82:83], off, s[12:15], s22 sc1
    s_add_u32 s3, s3, 1
    s_cmp_gt_u32 s3, 400000
    s_cbranch_scc1 L_exit
    s_waitcnt vmcnt(0)
    v_readfirstlane_b32 s24, v82
    v_readfirstlane_b32 s25, v83
    s_and_b32 vcc_lo, s24, 0xffff
    s_cmp_lt_u32 vcc_lo, 256
    s_cbranch_scc1 L_rdy_13
    s_lshr_b32 vcc_lo, s24, 16
    s_cbranch_scc1 L_general
    s_load_dwordx2 s[8:9], s[0:1], 128
    s_mov_b32 s10, 8388608
    s_mov_b32 s11, 0x20000
    s_mov_b32 s28, s4
    s_mov_b32 s29, s5
    s_mov_b32 s30, s6
    s_mov_b32 s31, s7
    s_lshr_b32 s33, s17, 3
    s_lshl_b32 s33, s33, 2
    s_add_u32 s33, s33, s18
    s_lshl_b32 s36, s33, 14
    s_add_u32 s36, s36, 67108864
    s_lshl_b32 s39, s33, 5
    s_add_u32 s39, s39, 3743744
    s_lshl_b32 s37, s18, 14
    s_waitcnt lgkmcnt(0)
    s_mov_b32 s44, 0
    s_mov_b32 s45, 0
    s_mov_b32 s46, 0
    s_mov_b32 s47, 0
    s_mov_b32 s48, 0
    s_mov_b32 s49, 0
    s_mov_b32 s50, 0
    s_mov_b32 s51, 0
    s_mov_b32 s52, 0
    s_mov_b32 s53, 0
    s_mov_b32 s54, 0
    s_mov_b32 s55, 0
    s_mov_b32 s56, 0
    s_mov_b32 s57, 0
    s_mov_b32 s58, 0
    s_mov_b32 s59, 0
    s_mov_b32 s32, 0
    s_lshr_b32 s60, s17, 3
    s_and_b32 s33, s17, 7
    s_lshl_b32 s33, s33, 2
    s_add_u32 s33, s33, s18
    s_lshl_b32 s62, s33, 14
    s_add_u32 s62, s62, 83886080
    s_lshl_b32 s65, s33, 6
    v_and_b32 v3, 31, v1
    v_lshrrev_b32 v4, 5, v1
    v_lshlrev_b32 v14, 12, v3
    v_lshl_add_u32 v14, v4, 4, v14
    s_mov_b32 s64, 0
L_rO_first:
    s_min_u32 s33, s44, s48
    s_cmp_gt_u32 s33, s64
    s_cbranch_scc1 L_rO_firstok
    s_load_dwordx8 s[44:51], s[4:5], s39 glc
    s_add_u32 s40, s40, 1
    s_cmp_gt_u32 s40, 400000
    s_cbranch_scc1 L_done
    s_waitcnt lgkmcnt(0)
    s_branch L_rO_first
L_rO_firstok:
    s_add_u32 m0, s37, 0
    s_add_u32 s35, s36, 0
    buffer_load_dwordx4 v2, s[28:31], s35 offen offset:0 sc1 lds
    buffer_load_dwordx4 v2, s[28:31], s35 offen offset:1024 sc1 lds
    buffer_load_dwordx4 v2, s[28:31], s35 offen offset:2048 sc1 lds
    buffer_load_dwordx4 v2, s[28:31], s35 offen offset:3072 sc1 lds
    s_add_u32 m0, s37, 4096
    s_add_u32 s35, s36, 4096
    buffer_load_dwordx4 v2, s[28:31], s35 offen offset:0 sc1 lds
    buffer_load_dwordx4 v2, s[28:31], s35 offen offset:1024 sc1 lds
    buffer_load_dwordx4 v2, s[28:31], s35 offen offset:2048 sc1 lds
    buffer_load_dwordx4 v2, s[28:31], s35 offen offset:3072 sc1 lds
    s_add_u32 m0, s37, 8192
    s_add_u32 s35, s36, 8192
    buffer_load_dwordx4 v2, s[28:31], s35 offen offset:0 sc1 lds
    buffer_load_dwordx4 v2, s[28:31], s35 offen offset:1024 sc1 lds
    buffer_load_dwordx4 v2, s[28:31], s35 offen offset:2048 sc1 lds
    buffer_load_dwordx4 v2, s[28:31], s35 offen offset:3072 sc1 lds
    s_add_u32 m0, s37, 12288
    s_add_u32 s35, s36, 12288
    buffer_load_dwordx4 v2, s[28:31], s35 offen offset:0 sc1 lds
    buffer_load_dwordx4 v2, s[28:31], s35 offen offset:1024 sc1 lds
    buffer_load_dwordx4 v2, s[28:31], s35 offen offset:2048 sc1 lds
    buffer_load_dwordx4 v2, s[28:31], s35 offen offset:3072 sc1 lds
    s_waitcnt vmcnt(0)
    s_barrier
    ds_read_b128 v[16:19], v10 offset:0
    ds_read_b128 v[20:23], v10 offset:1024
    ds_read_b128 v[24:27], v10 offset:2048
    ds_read_b128 v[28:31], v10 offset:3072
    ds_read_b128 v[32:35], v10 offset:4096
    ds_read_b128 v[36:39], v10 offset:5120
L_rO_loop:
    s_waitcnt lgkmcnt(5)
    v_mfma_f32_32x32x16_bf16 v[48:63], a[0:3], v[16:19], 0
    ds_read_b128 v[40:43], v10 offset:6144
    s_add_u32 s36, s36, 0x40000
    s_add_u32 s34, s32, 1
    s_lshr_b32 s34, s34, 2
    s_min_u32 s33, s45, s49
    s_cmp_gt_u32 s33, s34
    s_cselect_b32 s42, 1, 0
    s_cselect_b32 s63, s36, 0x40000000
    s_waitcnt lgkmcnt(5)
    v_mfma_f32_32x32x16_bf16 v[48:63], a[4:7], v[20:23], v[48:63]
    ds_read_b128 v[44:47], v10 offset:7168
    s_add_u32 m0, s37, 65536
    s_add_u32 s35, s63, 0
    buffer_load_dwordx4 v2, s[28:31], s35 offen offset:0 sc1 lds
    s_waitcnt lgkmcnt(5)
    v_mfma_f32_32x32x16_bf16 v[48:63], a[8:11], v[24:27], v[48:63]
    ds_read_b128 v[16:19], v10 offset:8192
    s_sub_u32 s64, s32, 3
    s_cbranch_scc1 L_rO_no1
    s_xor_b32 s33, s64, s60
    s_and_b32 s33, s33, 3
    s_cbranch_scc1 L_rO_no1
    v_pk_add_f32 v[88:89], v[88:89], v[104:105]
    v_pk_add_f32 v[90:91], v[90:91], v[106:107]
    v_pk_add_f32 v[92:93], v[92:93], v[108:109]
    v_pk_add_f32 v[94:95], v[94:95], v[110:111]
    v_pk_add_f32 v[96:97], v[96:97], v[112:113]
    v_pk_add_f32 v[98:99], v[98:99], v[114:115]
    v_pk_add_f32 v[100:101], v[100:101], v[116:117]
    v_pk_add_f32 v[102:103], v[102:103], v[118:119]
    v_pk_add_f32 v[88:89], v[88:89], v[120:121]
    v_pk_add_f32 v[90:91], v[90:91], v[122:123]
    v_pk_add_f32 v[92:93], v[92:93], v[124:125]
    v_pk_add_f32 v[94:95], v[94:95], v[126:127]
    v_pk_add_f32 v[96:97], v[96:97], v[128:129]
    v_pk_add_f32 v[98:99], v[98:99], v[130:131]
    v_pk_add_f32 v[100:101], v[100:101], v[132:133]
    v_pk_add_f32 v[102:103], v[102:103], v[134:135]
    v_pk_add_f32 v[88:89], v[88:89], v[136:137]
    v_pk_add_f32 v[90:91], v[90:91], v[138:139]
    v_pk_add_f32 v[92:93], v[92:93], v[140:141]
    v_pk_add_f32 v[94:95], v[94:95], v[142:143]
    v_pk_add_f32 v[96:97], v[96:97], v[144:145]
    v_pk_add_f32 v[98:99], v[98:99], v[146:147]
    v_pk_add_f32 v[100:101], v[100:101], v[148:149]
    v_pk_add_f32 v[102:103], v[102:103], v[150:151]
    v_cvt_pk_bf16_f32 v80, v88, v89
    v_cvt_pk_bf16_f32 v81, v90, v91
    v_cvt_pk_bf16_f32 v82, v92, v93
    v_cvt_pk_bf16_f32 v83, v94, v95
    v_cvt_pk_bf16_f32 v84, v96, v97
    v_cvt_pk_bf16_f32 v85, v98, v99
    v_cvt_pk_bf16_f32 v86, v100, v101
    v_cvt_pk_bf16_f32 v87, v102, v103
    s_lshl_b32 s33, s64, 17
    s_add_u32 s33, s33, s65
    buffer_store_dwordx4 v[80:83], v14, s[8:11], s33 offen
    buffer_store_dwordx4 v[84:87], v14, s[8:11], s33 offen offset:32
L_rO_no1:
    s_waitcnt lgkmcnt(5)
    v_mfma_f32_32x32x16_bf16 v[48:63], a[12:15], v[28:31], v[48:63]
    ds_read_b128 v[20:23], v10 offset:9216
    buffer_load_dwordx4 v2, s[28:31], s35 offen offset:1024 sc1 lds
    s_waitcnt lgkmcnt(5)
    v_mfma_f32_32x32x16_bf16 v[48:63], a[16:19], v[32:35], v[48:63]
    ds_read_b128 v[24:27], v10 offset:10240
    s_waitcnt lgkmcnt(5)
    v_mfma_f32_32x32x16_bf16 v[48:63], a[20:23], v[36:39], v[48:63]
    ds_read_b128 v[28:31], v10 offset:11264
    buffer_load_dwordx4 v2, s[28:31], s35 offen offset:2048 sc1 lds
    s_waitcnt lgkmcnt(5)
    v_mfma_f32_32x32x16_bf16 v[48:63], a[24:27], v[40:43], v[48:63]
    ds_read_b128 v[32:35], v10 offset:12288
    s_sub_u32 s64, s32, 1
    s_cbranch_scc1 L_rO_ne2
    s_sub_u32 s61, s60, s64
    s_and_b32 s61, s61, 3
    s_cbranch_scc0 L_rO_hold3
    s_lshl_b32 s33, s64, 19
    s_lshl_b32 s34, s61, 12
    s_add_u32 s33, s33, s34
    s_add_u32 s33, s33, s62
    buffer_store_dwordx4 v[64:67], v2, s[4:7], s33 offen offset:0 sc1
    buffer_store_dwordx4 v[68:71], v2, s[4:7], s33 offen offset:1024 sc1
    buffer_store_dwordx4 v[72:75], v2, s[4:7], s33 offen offset:2048 sc1
    buffer_store_dwordx4 v[76:79], v2, s[4:7], s33 offen offset:3072 sc1
    s_branch L_rO_sent3
L_rO_hold3:
    v_mov_b32 v88, v64
    v_mov_b32 v89, v65
    v_mov_b32 v90, v66
    v_mov_b32 v91, v67
    v_mov_b32 v92, v68
    v_mov_b32 v93, v69
    v_mov_b32 v94, v70
    v_mov_b32 v95, v71
    v_mov_b32 v96, v72
    v_mov_b32 v97, v73
    v_mov_b32 v98, v74
    v_mov_b32 v99, v75
    v_mov_b32 v100, v76
    v_mov_b32 v101, v77
    v_mov_b32 v102, v78
    v_mov_b32 v103, v79
L_rO_sent3:
L_rO_ne2:
    s_waitcnt lgkmcnt(5)
    v_mfma_f32_32x32x16_bf16 v[48:63], a[28:31], v[44:47], v[48:63]
    ds_read_b128 v[36:39], v10 offset:13312
    buffer_load_dwordx4 v2, s[28:31], s35 offen offset:3072 sc1 lds
    s_waitcnt lgkmcnt(5)
    v_mfma_f32_32x32x16_bf16 v[48:63], a[32:35], v[16:19], v[48:63]
    ds_read_b128 v[40:43], v10 offset:14336
    s_waitcnt lgkmcnt(5)
    v_mfma_f32_32x32x16_bf16 v[48:63], a[36:39], v[20:23], v[48:63]
    ds_read_b128 v[44:47], v10 offset:15360
    s_add_u32 m0, s37, 69632
    s_add_u32 s35, s63, 4096
    buffer_load_dwordx4 v2, s[28:31], s35 offen offset:0 sc1 lds
    s_waitcnt lgkmcnt(5)
    v_mfma_f32_32x32x16_bf16 v[48:63], a[40:43], v[24:27], v[48:63]
    ds_read_b128 v[16:19], v10 offset:16384
    s_waitcnt lgkmcnt(5)
    v_mfma_f32_32x32x16_bf16 v[48:63], a[44:47], v[28:31], v[48:63]
    ds_read_b128 v[20:23], v10 offset:17408
    buffer_load_dwordx4 v2, s[28:31], s35 offen offset:1024 sc1 lds
    s_waitcnt lgkmcnt(5)
    v_mfma_f32_32x32x16_bf16 v[48:63], a[48:51], v[32:35], v[48:63]
    ds_read_b128 v[24:27], v10 offset:18432
    s_waitcnt lgkmcnt(5)
    v_mfma_f32_32x32x16_bf16 v[48:63], a[52:55], v[36:39], v[48:63]
    ds_read_b128 v[28:31], v10 offset:19456
    buffer_load_dwordx4 v2, s[28:31], s35 offen offset:2048 sc1 lds
    s_waitcnt lgkmcnt(5)
    v_mfma_f32_32x32x16_bf16 v[48:63], a[56:59], v[40:43], v[48:63]
    ds_read_b128 v[32:35], v10 offset:20480
    s_waitcnt lgkmcnt(5)
    v_mfma_f32_32x32x16_bf16 v[48:63], a[60:63], v[44:47], v[48:63]
    ds_read_b128 v[36:39], v10 offset:21504
    buffer_load_dwordx4 v2, s[28:31], s35 offen offset:3072 sc1 lds
    s_waitcnt lgkmcnt(5)
    v_mfma_f32_32x32x16_bf16 v[48:63], a[64:67], v[16:19], v[48:63]
    ds_read_b128 v[40:43], v10 offset:22528
    s_load_dwordx4 s[52:55], s[4:5], s41 glc
    s_waitcnt lgkmcnt(5)
    v_mfma_f32_32x32x16_bf16 v[48:63], a[68:71], v[20:23], v[48:63]
    ds_read_b128 v[44:47], v10 offset:23552
    s_add_u32 m0, s37, 73728
    s_add_u32 s35, s63, 8192
    buffer_load_dwordx4 v2, s[28:31], s35 offen offset:0 sc1 lds
    s_waitcnt lgkmcnt(5)
    v_mfma_f32_32x32x16_bf16 v[48:63], a[72:75], v[24:27], v[48:63]
    ds_read_b128 v[16:19], v10 offset:24576
    s_waitcnt lgkmcnt(5)
    v_mfma_f32_32x32x16_bf16 v[48:63], a[76:79], v[28:31], v[48:63]
    ds_read_b128 v[20:23], v10 offset:25600
    buffer_load_dwordx4 v2, s[28:31], s35 offen offset:1024 sc1 lds
    s_waitcnt lgkmcnt(5)
    v_mfma_f32_32x32x16_bf16 v[48:63], a[80:83], v[32:35], v[48:63]
    ds_read_b128 v[24:27], v10 offset:26624
    s_waitcnt lgkmcnt(5)
    v_mfma_f32_32x32x16_bf16 v[48:63], a[84:87], v[36:39], v[48:63]
    ds_read_b128 v[28:31], v10 offset:27648
    buffer_load_dwordx4 v2, s[28:31], s35 offen offset:2048 sc1 lds
    s_waitcnt lgkmcnt(5)
    v_mfma_f32_32x32x16_bf16 v[48:63], a[88:91], v[40:43], v[48:63]
    ds_read_b128 v[32:35], v10 offset:28672
    s_waitcnt lgkmcnt(5)
    v_mfma_f32_32x32x16_bf16 v[48:63], a[92:95], v[44:47], v[48:63]
    ds_read_b128 v[36:39], v10 offset:29696
    buffer_load_dwordx4 v2, s[28:31], s35 offen offset:3072 sc1 lds
    s_waitcnt lgkmcnt(5)
    v_mfma_f32_32x32x16_bf16 v[48:63], a[96:99], v[16:19], v[48:63]
    ds_read_b128 v[40:43], v10 offset:30720
    s_waitcnt lgkmcnt(5)
    v_mfma_f32_32x32x16_bf16 v[48:63], a[100:103], v[20:23], v[48:63]
    ds_read_b128 v[44:47], v10 offset:31744
    s_add_u32 m0, s37, 77824
    s_add_u32 s35, s63, 12288
    buffer_load_dwordx4 v2, s[28:31], s35 offen offset:0 sc1 lds
    s_waitcnt lgkmcnt(5)
    v_mfma_f32_32x32x16_bf16 v[48:63], a[104:107], v[24:27], v[48:63]
    ds_read_b128 v[16:19], v10 offset:32768
    s_waitcnt lgkmcnt(5)
    v_mfma_f32_32x32x16_bf16 v[48:63], a[108:111], v[28:31], v[48:63]
    ds_read_b128 v[20:23], v10 offset:33792
    buffer_load_dwordx4 v2, s[28:31], s35 offen offset:1024 sc1 lds
    s_waitcnt lgkmcnt(5)
    v_mfma_f32_32x32x16_bf16 v[48:63], a[112:115], v[32:35], v[48:63]
    ds_read_b128 v[24:27], v10 offset:34816
    s_waitcnt lgkmcnt(5)
    v_mfma_f32_32x32x16_bf16 v[48:63], a[116:119], v[36:39], v[48:63]
    ds_read_b128 v[28:31], v10 offset:35840
    buffer_load_dwordx4 v2, s[28:31], s35 offen offset:2048 sc1 lds
    s_waitcnt lgkmcnt(5)
    v_mfma_f32_32x32x16_bf16 v[48:63], a[120:123], v[40:43], v[48:63]
    ds_read_b128 v[32:35], v10 offset:36864
    s_waitcnt lgkmcnt(5)
    v_mfma_f32_32x32x16_bf16 v[48:63], a[124:127], v[44:47], v[48:63]
    ds_read_b128 v[36:39], v10 offset:37888
    buffer_load_dwordx4 v2, s[28:31], s35 offen offset:3072 sc1 lds
    s_waitcnt lgkmcnt(5)
    v_mfma_f32_32x32x16_bf16 v[48:63], a[128:131], v[16:19], v[48:63]
    ds_read_b128 v[40:43], v10 offset:38912
    s_waitcnt lgkmcnt(5)
    v_mfma_f32_32x32x16_bf16 v[48:63], a[132:135], v[20:23], v[48:63]
    ds_read_b128 v[44:47], v10 offset:39936
    s_waitcnt lgkmcnt(5)
    v_mfma_f32_32x32x16_bf16 v[48:63], a[136:139], v[24:27], v[48:63]
    ds_read_b128 v[16:19], v10 offset:40960
    s_waitcnt lgkmcnt(5)
    v_mfma_f32_32x32x16_bf16 v[48:63], a[140:143], v[28:31], v[48:63]
    ds_read_b128 v[20:23], v10 offset:41984
    s_waitcnt lgkmcnt(5)
    v_mfma_f32_32x32x16_bf16 v[48:63], a[144:147], v[32:35], v[48:63]
    ds_read_b128 v[24:27], v10 offset:43008
    v_mov_b32 v9, s32
    s_waitcnt vmcnt(13)
    buffer_store_dword v9, v8, s[4:7], 0 offen sc1
    s_waitcnt lgkmcnt(5)
    v_mfma_f32_32x32x16_bf16 v[48:63], a[148:151], v[36:39], v[48:63]
    ds_read_b128 v[28:31], v10 offset:44032
    s_waitcnt lgkmcnt(5)
    v_mfma_f32_32x32x16_bf16 v[48:63], a[152:155], v[40:43], v[48:63]
    ds_read_b128 v[32:35], v10 offset:45056
    s_sub_u32 s64, s32, 2
    s_cbranch_scc1 L_rO_no4
    s_xor_b32 s33, s64, s60
    s_and_b32 s33, s33, 3
    s_cbranch_scc1 L_rO_no4
L_rO_w4:
    s_min_u32 s33, s52, s53
    s_min_u32 s33, s33, s54
    s_min_u32 s33, s33, s55
    s_cmp_gt_u32 s33, s64
    s_cbranch_scc1 L_rO_w4ok
    s_load_dwordx4 s[52:55], s[4:5], s41 glc
    s_add_u32 s40, s40, 1
    s_cmp_gt_u32 s40, 400000
    s_cbranch_scc1 L_done
    s_waitcnt lgkmcnt(0)
    s_branch L_rO_w4
L_rO_w4ok:
    s_lshl_b32 s33, s64, 19
    s_add_u32 s33, s33, s62
    s_add_u32 s33, s33, 4096
    buffer_load_dwordx4 v[104:107], v2, s[4:7], s33 offen offset:0 sc1
    buffer_load_dwordx4 v[108:111], v2, s[4:7], s33 offen offset:1024 sc1
    buffer_load_dwordx4 v[112:115], v2, s[4:7], s33 offen offset:2048 sc1
    buffer_load_dwordx4 v[116:119], v2, s[4:7], s33 offen offset:3072 sc1
    s_add_u32 s33, s33, 4096
    buffer_load_dwordx4 v[120:123], v2, s[4:7], s33 offen offset:0 sc1
    buffer_load_dwordx4 v[124:127], v2, s[4:7], s33 offen offset:1024 sc1
    buffer_load_dwordx4 v[128:131], v2, s[4:7], s33 offen offset:2048 sc1
    buffer_load_dwordx4 v[132:135], v2, s[4:7], s33 offen offset:3072 sc1
    s_add_u32 s33, s33, 4096
    buffer_load_dwordx4 v[136:139], v2, s[4:7], s33 offen offset:0 sc1
    buffer_load_dwordx4 v[140:143], v2, s[4:7], s33 offen offset:1024 sc1
    buffer_load_dwordx4 v[144:147], v2, s[4:7], s33 offen offset:2048 sc1
    buffer_load_dwordx4 v[148:151], v2, s[4:7], s33 offen offset:3072 sc1
L_rO_no4:
    s_waitcnt lgkmcnt(5)
    v_mfma_f32_32x32x16_bf16 v[48:63], a[156:159], v[44:47], v[48:63]
    ds_read_b128 v[36:39], v10 offset:46080
    s_waitcnt lgkmcnt(5)
    v_mfma_f32_32x32x16_bf16 v[48:63], a[160:163], v[16:19], v[48:63]
    ds_read_b128 v[40:43], v10 offset:47104
    s_load_dwordx8 s[44:51], s[4:5], s39 glc
    s_waitcnt lgkmcnt(5)
    v_mfma_f32_32x32x16_bf16 v[48:63], a[164:167], v[20:23], v[48:63]
    ds_read_b128 v[44:47], v10 offset:48128
    s_waitcnt lgkmcnt(5)
    v_mfma_f32_32x32x16_bf16 v[48:63], a[168:171], v[24:27], v[48:63]
    ds_read_b128 v[16:19], v10 offset:49152
    s_waitcnt lgkmcnt(5)
    v_mfma_f32_32x32x16_bf16 v[48:63], a[172:175], v[28:31], v[48:63]
    ds_read_b128 v[20:23], v10 offset:50176
    s_waitcnt lgkmcnt(5)
    v_mfma_f32_32x32x16_bf16 v[48:63], a[176:179], v[32:35], v[48:63]
    ds_read_b128 v[24:27], v10 offset:51200
    s_waitcnt lgkmcnt(5)
    v_mfma_f32_32x32x16_bf16 v[48:63], a[180:183], v[36:39], v[48:63]
    ds_read_b128 v[28:31], v10 offset:52224
    s_waitcnt lgkmcnt(5)
    v_mfma_f32_32x32x16_bf16 v[48:63], a[184:187], v[40:43], v[48:63]
    ds_read_b128 v[32:35], v10 offset:53248
    s_waitcnt lgkmcnt(5)
    v_mfma_f32_32x32x16_bf16 v[48:63], a[188:191], v[44:47], v[48:63]
    ds_read_b128 v[36:39], v10 offset:54272
    s_waitcnt lgkmcnt(5)
    v_mfma_f32_32x32x16_bf16 v[48:63], a[192:195], v[16:19], v[48:63]
    ds_read_b128 v[40:43], v10 offset:55296
    s_waitcnt lgkmcnt(5)
    v_mfma_f32_32x32x16_bf16 v[48:63], a[196:199], v[20:23], v[48:63]
    ds_read_b128 v[44:47], v10 offset:56320
    s_waitcnt lgkmcnt(5)
    v_mfma_f32_32x32x16_bf16 v[48:63], a[200:203], v[24:27], v[48:63]
    ds_read_b128 v[16:19], v10 offset:57344
    s_waitcnt lgkmcnt(5)
    v_mfma_f32_32x32x16_bf16 v[48:63], a[204:207], v[28:31], v[48:63]
    ds_read_b128 v[20:23], v10 offset:58368
    s_waitcnt lgkmcnt(5)
    v_mfma_f32_32x32x16_bf16 v[48:63], a[208:211], v[32:35], v[48:63]
    ds_read_b128 v[24:27], v10 offset:59392
    s_waitcnt lgkmcnt(5)
    v_mfma_f32_32x32x16_bf16 v[48:63], a[212:215], v[36:39], v[48:63]
    ds_read_b128 v[28:31], v10 offset:60416
    s_waitcnt lgkmcnt(5)
    v_mfma_f32_32x32x16_bf16 v[48:63], a[216:219], v[40:43], v[48:63]
    ds_read_b128 v[32:35], v10 offset:61440
    s_waitcnt lgkmcnt(5)
    v_mfma_f32_32x32x16_bf16 v[48:63], a[220:223], v[44:47], v[48:63]
    ds_read_b128 v[36:39], v10 offset:62464
    s_waitcnt lgkmcnt(5)
    v_mfma_f32_32x32x16_bf16 v[48:63], a[224:227], v[16:19], v[48:63]
    ds_read_b128 v[40:43], v10 offset:63488
    s_waitcnt lgkmcnt(5)
    v_mfma_f32_32x32x16_bf16 v[48:63], a[228:231], v[20:23], v[48:63]
    ds_read_b128 v[44:47], v10 offset:64512
    s_waitcnt lgkmcnt(5)
    v_mfma_f32_32x32x16_bf16 v[48:63], a[232:235], v[24:27], v[48:63]
    s_waitcnt lgkmcnt(4)
    v_mfma_f32_32x32x16_bf16 v[48:63], a[236:239], v[28:31], v[48:63]
    s_waitcnt lgkmcnt(0)
    s_add_u32 s32, s32, 1
    s_cmp_eq_u32 s32, 64
    s_cselect_b32 s42, 1, s42
    s_cmp_eq_u32 s42, 1
    s_cbranch_scc1 L_rO_pre0
    s_lshr_b32 s64, s32, 2
L_rO_o0:
    s_min_u32 s33, s45, s49
    s_cmp_gt_u32 s33, s64
    s_cbranch_scc1 L_rO_o0ok
    s_load_dwordx8 s[44:51], s[4:5], s39 glc
    s_add_u32 s40, s40, 1
    s_cmp_gt_u32 s40, 400000
    s_cbranch_scc1 L_done
    s_waitcnt lgkmcnt(0)
    s_branch L_rO_o0
L_rO_o0ok:
    s_add_u32 m0, s37, 65536
    s_add_u32 s35, s36, 0
    buffer_load_dwordx4 v2, s[28:31], s35 offen offset:0 sc1 lds
    buffer_load_dwordx4 v2, s[28:31], s35 offen offset:1024 sc1 lds
    buffer_load_dwordx4 v2, s[28:31], s35 offen offset:2048 sc1 lds
    buffer_load_dwordx4 v2, s[28:31], s35 offen offset:3072 sc1 lds
    s_add_u32 m0, s37, 69632
    s_add_u32 s35, s36, 4096
    buffer_load_dwordx4 v2, s[28:31], s35 offen offset:0 sc1 lds
    buffer_load_dwordx4 v2, s[28:31], s35 offen offset:1024 sc1 lds
    buffer_load_dwordx4 v2, s[28:31], s35 offen offset:2048 sc1 lds
    buffer_load_dwordx4 v2, s[28:31], s35 offen offset:3072 sc1 lds
    s_add_u32 m0, s37, 73728
    s_add_u32 s35, s36, 8192
    buffer_load_dwordx4 v2, s[28:31], s35 offen offset:0 sc1 lds
    buffer_load_dwordx4 v2, s[28:31], s35 offen offset:1024 sc1 lds
    buffer_load_dwordx4 v2, s[28:31], s35 offen offset:2048 sc1 lds
    buffer_load_dwordx4 v2, s[28:31], s35 offen offset:3072 sc1 lds
    s_add_u32 m0, s37, 77824
    s_add_u32 s35, s36, 12288
    buffer_load_dwordx4 v2, s[28:31], s35 offen offset:0 sc1 lds
    buffer_load_dwordx4 v2, s[28:31], s35 offen offset:1024 sc1 lds
    buffer_load_dwordx4 v2, s[28:31], s35 offen offset:2048 sc1 lds
    buffer_load_dwordx4 v2, s[28:31], s35 offen offset:3072 sc1 lds
L_rO_pre0:
    s_waitcnt vmcnt(0)
    s_barrier
    ds_read_b128 v[16:19], v11 offset:0
    ds_read_b128 v[20:23], v11 offset:1024
    v_mfma_f32_32x32x16_bf16 v[48:63], a[240:243], v[32:35], v[48:63]
    ds_read_b128 v[24:27], v11 offset:2048
    ds_read_b128 v[28:31], v11 offset:3072
    v_mfma_f32_32x32x16_bf16 v[48:63], a[244:247], v[36:39], v[48:63]
    ds_read_b128 v[32:35], v11 offset:4096
    ds_read_b128 v[36:39], v11 offset:5120
    v_mfma_f32_32x32x16_bf16 v[48:63], a[248:251], v[40:43], v[48:63]
    v_mfma_f32_32x32x16_bf16 v[48:63], a[252:255], v[44:47], v[48:63]
    s_waitcnt lgkmcnt(5)
    v_mfma_f32_32x32x16_bf16 v[64:79], a[0:3], v[16:19], 0
    ds_read_b128 v[40:43], v11 offset:6144
    s_add_u32 s36, s36, 0x40000
    s_add_u32 s34, s32, 1
    s_lshr_b32 s34, s34, 2
    s_min_u32 s33, s46, s50
    s_cmp_gt_u32 s33, s34
    s_cselect_b32 s42, 1, 0
    s_cselect_b32 s63, s36, 0x40000000
    s_waitcnt lgkmcnt(5)
    v_mfma_f32_32x32x16_bf16 v[64:79], a[4:7], v[20:23], v[64:79]
    ds_read_b128 v[44:47], v11 offset:7168
    s_add_u32 m0, s37, 0
    s_add_u32 s35, s63, 0
    buffer_load_dwordx4 v2, s[28:31], s35 offen offset:0 sc1 lds
    s_waitcnt lgkmcnt(5)
    v_mfma_f32_32x32x16_bf16 v[64:79], a[8:11], v[24:27], v[64:79]
    ds_read_b128 v[16:19], v11 offset:8192
    s_sub_u32 s64, s32, 3
    s_cbranch_scc1 L_rO_no5
    s_xor_b32 s33, s64, s60
    s_and_b32 s33, s33, 3
    s_cbranch_scc1 L_rO_no5
    v_pk_add_f32 v[88:89], v[88:89], v[104:105]
    v_pk_add_f32 v[90:91], v[90:91], v[106:107]
    v_pk_add_f32 v[92:93], v[92:93], v[108:109]
    v_pk_add_f32 v[94:95], v[94:95], v[110:111]
    v_pk_add_f32 v[96:97], v[96:97], v[112:113]
    v_pk_add_f32 v[98:99], v[98:99], v[114:115]
    v_pk_add_f32 v[100:101], v[100:101], v[116:117]
    v_pk_add_f32 v[102:103], v[102:103], v[118:119]
    v_pk_add_f32 v[88:89], v[88:89], v[120:121]
    v_pk_add_f32 v[90:91], v[90:91], v[122:123]
    v_pk_add_f32 v[92:93], v[92:93], v[124:125]
    v_pk_add_f32 v[94:95], v[94:95], v[126:127]
    v_pk_add_f32 v[96:97], v[96:97], v[128:129]
    v_pk_add_f32 v[98:99], v[98:99], v[130:131]
    v_pk_add_f32 v[100:101], v[100:101], v[132:133]
    v_pk_add_f32 v[102:103], v[102:103], v[134:135]
    v_pk_add_f32 v[88:89], v[88:89], v[136:137]
    v_pk_add_f32 v[90:91], v[90:91], v[138:139]
    v_pk_add_f32 v[92:93], v[92:93], v[140:141]
    v_pk_add_f32 v[94:95], v[94:95], v[142:143]
    v_pk_add_f32 v[96:97], v[96:97], v[144:145]
    v_pk_add_f32 v[98:99], v[98:99], v[146:147]
    v_pk_add_f32 v[100:101], v[100:101], v[148:149]
    v_pk_add_f32 v[102:103], v[102:103], v[150:151]
    v_cvt_pk_bf16_f32 v80, v88, v89
    v_cvt_pk_bf16_f32 v81, v90, v91
    v_cvt_pk_bf16_f32 v82, v92, v93
    v_cvt_pk_bf16_f32 v83, v94, v95
    v_cvt_pk_bf16_f32 v84, v96, v97
    v_cvt_pk_bf16_f32 v85, v98, v99
    v_cvt_pk_bf16_f32 v86, v100, v101
    v_cvt_pk_bf16_f32 v87, v102, v103
    s_lshl_b32 s33, s64, 17
    s_add_u32 s33, s33, s65
    buffer_store_dwordx4 v[80:83], v14, s[8:11], s33 offen
    buffer_store_dwordx4 v[84:87], v14, s[8:11], s33 offen offset:32
L_rO_no5:
    s_waitcnt lgkmcnt(5)
    v_mfma_f32_32x32x16_bf16 v[64:79], a[12:15], v[28:31], v[64:79]
    ds_read_b128 v[20:23], v11 offset:9216
    buffer_load_dwordx4 v2, s[28:31], s35 offen offset:1024 sc1 lds
    s_waitcnt lgkmcnt(5)
    v_mfma_f32_32x32x16_bf16 v[64:79], a[16:19], v[32:35], v[64:79]
    ds_read_b128 v[24:27], v11 offset:10240
    s_waitcnt lgkmcnt(5)
    v_mfma_f32_32x32x16_bf16 v[64:79], a[20:23], v[36:39], v[64:79]
    ds_read_b128 v[28:31], v11 offset:11264
    buffer_load_dwordx4 v2, s[28:31], s35 offen offset:2048 sc1 lds
    s_waitcnt lgkmcnt(5)
    v_mfma_f32_32x32x16_bf16 v[64:79], a[24:27], v[40:43], v[64:79]
    ds_read_b128 v[32:35], v11 offset:12288
    s_sub_u32 s64, s32, 1
    s_cbranch_scc1 L_rO_ne6
    s_sub_u32 s61, s60, s64
    s_and_b32 s61, s61, 3
    s_cbranch_scc0 L_rO_hold7
    s_lshl_b32 s33, s64, 19
    s_lshl_b32 s34, s61, 12
    s_add_u32 s33, s33, s34
    s_add_u32 s33, s33, s62
    buffer_store_dwordx4 v[48:51], v2, s[4:7], s33 offen offset:0 sc1
    buffer_store_dwordx4 v[52:55], v2, s[4:7], s33 offen offset:1024 sc1
    buffer_store_dwordx4 v[56:59], v2, s[4:7], s33 offen offset:2048 sc1
    buffer_store_dwordx4 v[60:63], v2, s[4:7], s33 offen offset:3072 sc1
    s_branch L_rO_sent7
L_rO_hold7:
    v_mov_b32 v88, v48
    v_mov_b32 v89, v49
    v_mov_b32 v90, v50
    v_mov_b32 v91, v51
    v_mov_b32 v92, v52
    v_mov_b32 v93, v53
    v_mov_b32 v94, v54
    v_mov_b32 v95, v55
    v_mov_b32 v96, v56
    v_mov_b32 v97, v57
    v_mov_b32 v98, v58
    v_mov_b32 v99, v59
    v_mov_b32 v100, v60
    v_mov_b32 v101, v61
    v_mov_b32 v102, v62
    v_mov_b32 v103, v63
L_rO_sent7:
L_rO_ne6:
    s_waitcnt lgkmcnt(5)
    v_mfma_f32_32x32x16_bf16 v[64:79], a[28:31], v[44:47], v[64:79]
    ds_read_b128 v[36:39], v11 offset:13312
    buffer_load_dwordx4 v2, s[28:31], s35 offen offset:3072 sc1 lds
    s_waitcnt lgkmcnt(5)
    v_mfma_f32_32x32x16_bf16 v[64:79], a[32:35], v[16:19], v[64:79]
    ds_read_b128 v[40:43], v11 offset:14336
    s_waitcnt lgkmcnt(5)
    v_mfma_f32_32x32x16_bf16 v[64:79], a[36:39], v[20:23], v[64:79]
    ds_read_b128 v[44:47], v11 offset:15360
    s_add_u32 m0, s37, 4096
    s_add_u32 s35, s63, 4096
    buffer_load_dwordx4 v2, s[28:31], s35 offen offset:0 sc1 lds
    s_waitcnt lgkmcnt(5)
    v_mfma_f32_32x32x16_bf16 v[64:79], a[40:43], v[24:27], v[64:79]
    ds_read_b128 v[16:19], v11 offset:16384
    s_waitcnt lgkmcnt(5)
    v_mfma_f32_32x32x16_bf16 v[64:79], a[44:47], v[28:31], v[64:79]
    ds_read_b128 v[20:23], v11 offset:17408
    buffer_load_dwordx4 v2, s[28:31], s35 offen offset:1024 sc1 lds
    s_waitcnt lgkmcnt(5)
    v_mfma_f32_32x32x16_bf16 v[64:79], a[48:51], v[32:35], v[64:79]
    ds_read_b128 v[24:27], v11 offset:18432
    s_waitcnt lgkmcnt(5)
    v_mfma_f32_32x32x16_bf16 v[64:79], a[52:55], v[36:39], v[64:79]
    ds_read_b128 v[28:31], v11 offset:19456
    buffer_load_dwordx4 v2, s[28:31], s35 offen offset:2048 sc1 lds
    s_waitcnt lgkmcnt(5)
    v_mfma_f32_32x32x16_bf16 v[64:79], a[56:59], v[40:43], v[64:79]
    ds_read_b128 v[32:35], v11 offset:20480
    s_waitcnt lgkmcnt(5)
    v_mfma_f32_32x32x16_bf16 v[64:79], a[60:63], v[44:47], v[64:79]
    ds_read_b128 v[36:39], v11 offset:21504
    buffer_load_dwordx4 v2, s[28:31], s35 offen offset:3072 sc1 lds
    s_waitcnt lgkmcnt(5)
    v_mfma_f32_32x32x16_bf16 v[64:79], a[64:67], v[16:19], v[64:79]
    ds_read_b128 v[40:43], v11 offset:22528
    s_load_dwordx4 s[52:55], s[4:5], s41 glc
    s_waitcnt lgkmcnt(5)
    v_mfma_f32_32x32x16_bf16 v[64:79], a[68:71], v[20:23], v[64:79]
    ds_read_b128 v[44:47], v11 offset:23552
    s_add_u32 m0, s37, 8192
    s_add_u32 s35, s63, 8192
    buffer_load_dwordx4 v2, s[28:31], s35 offen offset:0 sc1 lds
    s_waitcnt lgkmcnt(5)
    v_mfma_f32_32x32x16_bf16 v[64:79], a[72:75], v[24:27], v[64:79]
    ds_read_b128 v[16:19], v11 offset:24576
    s_waitcnt lgkmcnt(5)
    v_mfma_f32_32x32x16_bf16 v[64:79], a[76:79], v[28:31], v[64:79]
    ds_read_b128 v[20:23], v11 offset:25600
    buffer_load_dwordx4 v2, s[28:31], s35 offen offset:1024 sc1 lds
    s_waitcnt lgkmcnt(5)
    v_mfma_f32_32x32x16_bf16 v[64:79], a[80:83], v[32:35], v[64:79]
    ds_read_b128 v[24:27], v11 offset:26624
    s_waitcnt lgkmcnt(5)
    v_mfma_f32_32x32x16_bf16 v[64:79], a[84:87], v[36:39], v[64:79]
    ds_read_b128 v[28:31], v11 offset:27648
    buffer_load_dwordx4 v2, s[28:31], s35 offen offset:2048 sc1 lds
    s_waitcnt lgkmcnt(5)
    v_mfma_f32_32x32x16_bf16 v[64:79], a[88:91], v[40:43], v[64:79]
    ds_read_b128 v[32:35], v11 offset:28672
    s_waitcnt lgkmcnt(5)
    v_mfma_f32_32x32x16_bf16 v[64:79], a[92:95], v[44:47], v[64:79]
    ds_read_b128 v[36:39], v11 offset:29696
    buffer_load_dwordx4 v2, s[28:31], s35 offen offset:3072 sc1 lds
    s_waitcnt lgkmcnt(5)
    v_mfma_f32_32x32x16_bf16 v[64:79], a[96:99], v[16:19], v[64:79]
    ds_read_b128 v[40:43], v11 offset:30720
    s_waitcnt lgkmcnt(5)
    v_mfma_f32_32x32x16_bf16 v[64:79], a[100:103], v[20:23], v[64:79]
    ds_read_b128 v[44:47], v11 offset:31744
    s_add_u32 m0, s37, 12288
    s_add_u32 s35, s63, 12288
    buffer_load_dwordx4 v2, s[28:31], s35 offen offset:0 sc1 lds
    s_waitcnt lgkmcnt(5)
    v_mfma_f32_32x32x16_bf16 v[64:79], a[104:107], v[24:27], v[64:79]
    ds_read_b128 v[16:19], v11 offset:32768
    s_waitcnt lgkmcnt(5)
    v_mfma_f32_32x32x16_bf16 v[64:79], a[108:111], v[28:31], v[64:79]
    ds_read_b128 v[20:23], v11 offset:33792
    buffer_load_dwordx4 v2, s[28:31], s35 offen offset:1024 sc1 lds
    s_waitcnt lgkmcnt(5)
    v_mfma_f32_32x32x16_bf16 v[64:79], a[112:115], v[32:35], v[64:79]
    ds_read_b128 v[24:27], v11 offset:34816
    s_waitcnt lgkmcnt(5)
    v_mfma_f32_32x32x16_bf16 v[64:79], a[116:119], v[36:39], v[64:79]
    ds_read_b128 v[28:31], v11 offset:35840
    buffer_load_dwordx4 v2, s[28:31], s35 offen offset:2048 sc1 lds
    s_waitcnt lgkmcnt(5)
    v_mfma_f32_32x32x16_bf16 v[64:79], a[120:123], v[40:43], v[64:79]
    ds_read_b128 v[32:35], v11 offset:36864
    s_waitcnt lgkmcnt(5)
    v_mfma_f32_32x32x16_bf16 v[64:79], a[124:127], v[44:47], v[64:79]
    ds_read_b128 v[36:39], v11 offset:37888
    buffer_load_dwordx4 v2, s[28:31], s35 offen offset:3072 sc1 lds
    s_waitcnt lgkmcnt(5)
    v_mfma_f32_32x32x16_bf16 v[64:79], a[128:131], v[16:19], v[64:79]
    ds_read_b128 v[40:43], v11 offset:38912
    s_waitcnt lgkmcnt(5)
    v_mfma_f32_32x32x16_bf16 v[64:79], a[132:135], v[20:23], v[64:79]
    ds_read_b128 v[44:47], v11 offset:39936
    s_waitcnt lgkmcnt(5)
    v_mfma_f32_32x32x16_bf16 v[64:79], a[136:139], v[24:27], v[64:79]
    ds_read_b128 v[16:19], v11 offset:40960
    s_waitcnt lgkmcnt(5)
    v_mfma_f32_32x32x16_bf16 v[64:79], a[140:143], v[28:31], v[64:79]
    ds_read_b128 v[20:23], v11 offset:41984
    s_waitcnt lgkmcnt(5)
    v_mfma_f32_32x32x16_bf16 v[64:79], a[144:147], v[32:35], v[64:79]
    ds_read_b128 v[24:27], v11 offset:43008
    v_mov_b32 v9, s32
    s_waitcnt vmcnt(13)
    buffer_store_dword v9, v8, s[4:7], 0 offen sc1
    s_waitcnt lgkmcnt(5)
    v_mfma_f32_32x32x16_bf16 v[64:79], a[148:151], v[36:39], v[64:79]
    ds_read_b128 v[28:31], v11 offset:44032
    s_waitcnt lgkmcnt(5)
    v_mfma_f32_32x32x16_bf16 v[64:79], a[152:155], v[40:43], v[64:79]
    ds_read_b128 v[32:35], v11 offset:45056
    s_sub_u32 s64, s32, 2
    s_cbranch_scc1 L_rO_no8
    s_xor_b32 s33, s64, s60
    s_and_b32 s33, s33, 3
    s_cbranch_scc1 L_rO_no8
L_rO_w8:
    s_min_u32 s33, s52, s53
    s_min_u32 s33, s33, s54
    s_min_u32 s33, s33, s55
    s_cmp_gt_u32 s33, s64
    s_cbranch_scc1 L_rO_w8ok
    s_load_dwordx4 s[52:55], s[4:5], s41 glc
    s_add_u32 s40, s40, 1
    s_cmp_gt_u32 s40, 400000
    s_cbranch_scc1 L_done
    s_waitcnt lgkmcnt(0)
    s_branch L_rO_w8
L_rO_w8ok:
    s_lshl_b32 s33, s64, 19
    s_add_u32 s33, s33, s62
    s_add_u32 s33, s33, 4096
    buffer_load_dwordx4 v[104:107], v2, s[4:7], s33 offen offset:0 sc1
    buffer_load_dwordx4 v[108:111], v2, s[4:7], s33 offen offset:1024 sc1
    buffer_load_dwordx4 v[112:115], v2, s[4:7], s33 offen offset:2048 sc1
    buffer_load_dwordx4 v[116:119], v2, s[4:7], s33 offen offset:3072 sc1
    s_add_u32 s33, s33, 4096
    buffer_load_dwordx4 v[120:123], v2, s[4:7], s33 offen offset:0 sc1
    buffer_load_dwordx4 v[124:127], v2, s[4:7], s33 offen offset:1024 sc1
    buffer_load_dwordx4 v[128:131], v2, s[4:7], s33 offen offset:2048 sc1
    buffer_load_dwordx4 v[132:135], v2, s[4:7], s33 offen offset:3072 sc1
    s_add_u32 s33, s33, 4096
    buffer_load_dwordx4 v[136:139], v2, s[4:7], s33 offen offset:0 sc1
    buffer_load_dwordx4 v[140:143], v2, s[4:7], s33 offen offset:1024 sc1
    buffer_load_dwordx4 v[144:147], v2, s[4:7], s33 offen offset:2048 sc1
    buffer_load_dwordx4 v[148:151], v2, s[4:7], s33 offen offset:3072 sc1
L_rO_no8:
    s_waitcnt lgkmcnt(5)
    v_mfma_f32_32x32x16_bf16 v[64:79], a[156:159], v[44:47], v[64:79]
    ds_read_b128 v[36:39], v11 offset:46080
    s_waitcnt lgkmcnt(5)
    v_mfma_f32_32x32x16_bf16 v[64:79], a[160:163], v[16:19], v[64:79]
    ds_read_b128 v[40:43], v11 offset:47104
    s_load_dwordx8 s[44:51], s[4:5], s39 glc
    s_waitcnt lgkmcnt(5)
    v_mfma_f32_32x32x16_bf16 v[64:79], a[164:167], v[20:23], v[64:79]
    ds_read_b128 v[44:47], v11 offset:48128
    s_waitcnt lgkmcnt(5)
    v_mfma_f32_32x32x16_bf16 v[64:79], a[168:171], v[24:27], v[64:79]
    ds_read_b128 v[16:19], v11 offset:49152
    s_waitcnt lgkmcnt(5)
    v_mfma_f32_32x32x16_bf16 v[64:79], a[172:175], v[28:31], v[64:79]
    ds_read_b128 v[20:23], v11 offset:50176
    s_waitcnt lgkmcnt(5)
    v_mfma_f32_32x32x16_bf16 v[64:79], a[176:179], v[32:35], v[64:79]
    ds_read_b128 v[24:27], v11 offset:51200
    s_waitcnt lgkmcnt(5)
    v_mfma_f32_32x32x16_bf16 v[64:79], a[180:183], v[36:39], v[64:79]
    ds_read_b128 v[28:31], v11 offset:52224
    s_waitcnt lgkmcnt(5)
    v_mfma_f32_32x32x16_bf16 v[64:79], a[184:187], v[40:43], v[64:79]
    ds_read_b128 v[32:35], v11 offset:53248
    s_waitcnt lgkmcnt(5)
    v_mfma_f32_32x32x16_bf16 v[64:79], a[188:191], v[44:47], v[64:79]
    ds_read_b128 v[36:39], v11 offset:54272
    s_waitcnt lgkmcnt(5)
    v_mfma_f32_32x32x16_bf16 v[64:79], a[192:195], v[16:19], v[64:79]
    ds_read_b128 v[40:43], v11 offset:55296
    s_waitcnt lgkmcnt(5)
    v_mfma_f32_32x32x16_bf16 v[64:79], a[196:199], v[20:23], v[64:79]
    ds_read_b128 v[44:47], v11 offset:56320
    s_waitcnt lgkmcnt(5)
    v_mfma_f32_32x32x16_bf16 v[64:79], a[200:203], v[24:27], v[64:79]
    ds_read_b128 v[16:19], v11 offset:57344
    s_waitcnt lgkmcnt(5)
    v_mfma_f32_32x32x16_bf16 v[64:79], a[204:207], v[28:31], v[64:79]
    ds_read_b128 v[20:23], v11 offset:58368
    s_waitcnt lgkmcnt(5)
    v_mfma_f32_32x32x16_bf16 v[64:79], a[208:211], v[32:35], v[64:79]
    ds_read_b128 v[24:27], v11 offset:59392
    s_waitcnt lgkmcnt(5)
    v_mfma_f32_32x32x16_bf16 v[64:79], a[212:215], v[36:39], v[64:79]
    ds_read_b128 v[28:31], v11 offset:60416
    s_waitcnt lgkmcnt(5)
    v_mfma_f32_32x32x16_bf16 v[64:79], a[216:219], v[40:43], v[64:79]
    ds_read_b128 v[32:35], v11 offset:61440
    s_waitcnt lgkmcnt(5)
    v_mfma_f32_32x32x16_bf16 v[64:79], a[220:223], v[44:47], v[64:79]
    ds_read_b128 v[36:39], v11 offset:62464
    s_waitcnt lgkmcnt(5)
    v_mfma_f32_32x32x16_bf16 v[64:79], a[224:227], v[16:19], v[64:79]
    ds_read_b128 v[40:43], v11 offset:63488
    s_waitcnt lgkmcnt(5)
    v_mfma_f32_32x32x16_bf16 v[64:79], a[228:231], v[20:23], v[64:79]
    ds_read_b128 v[44:47], v11 offset:64512
    s_waitcnt lgkmcnt(5)
    v_mfma_f32_32x32x16_bf16 v[64:79], a[232:235], v[24:27], v[64:79]
    s_waitcnt lgkmcnt(4)
    v_mfma_f32_32x32x16_bf16 v[64:79], a[236:239], v[28:31], v[64:79]
    s_waitcnt lgkmcnt(0)
    s_add_u32 s32, s32, 1
    s_cmp_eq_u32 s32, 64
    s_cselect_b32 s42, 1, s42
    s_cmp_eq_u32 s42, 1
    s_cbranch_scc1 L_rO_pre1
    s_lshr_b32 s64, s32, 2
L_rO_o1:
    s_min_u32 s33, s46, s50
    s_cmp_gt_u32 s33, s64
    s_cbranch_scc1 L_rO_o1ok
    s_load_dwordx8 s[44:51], s[4:5], s39 glc
    s_add_u32 s40, s40, 1
    s_cmp_gt_u32 s40, 400000
    s_cbranch_scc1 L_done
    s_waitcnt lgkmcnt(0)
    s_branch L_rO_o1
L_rO_o1ok:
    s_add_u32 m0, s37, 0
    s_add_u32 s35, s36, 0
    buffer_load_dwordx4 v2, s[28:31], s35 offen offset:0 sc1 lds
    buffer_load_dwordx4 v2, s[28:31], s35 offen offset:1024 sc1 lds
    buffer_load_dwordx4 v2, s[28:31], s35 offen offset:2048 sc1 lds
    buffer_load_dwordx4 v2, s[28:31], s35 offen offset:3072 sc1 lds
    s_add_u32 m0, s37, 4096
    s_add_u32 s35, s36, 4096
    buffer_load_dwordx4 v2, s[28:31], s35 offen offset:0 sc1 lds
    buffer_load_dwordx4 v2, s[28:31], s35 offen offset:1024 sc1 lds
    buffer_load_dwordx4 v2, s[28:31], s35 offen offset:2048 sc1 lds
    buffer_load_dwordx4 v2, s[28:31], s35 offen offset:3072 sc1 lds
    s_add_u32 m0, s37, 8192
    s_add_u32 s35, s36, 8192
    buffer_load_dwordx4 v2, s[28:31], s35 offen offset:0 sc1 lds
    buffer_load_dwordx4 v2, s[28:31], s35 offen offset:1024 sc1 lds
    buffer_load_dwordx4 v2, s[28:31], s35 offen offset:2048 sc1 lds
    buffer_load_dwordx4 v2, s[28:31], s35 offen offset:3072 sc1 lds
    s_add_u32 m0, s37, 12288
    s_add_u32 s35, s36, 12288
    buffer_load_dwordx4 v2, s[28:31], s35 offen offset:0 sc1 lds
    buffer_load_dwordx4 v2, s[28:31], s35 offen offset:1024 sc1 lds
    buffer_load_dwordx4 v2, s[28:31], s35 offen offset:2048 sc1 lds
    buffer_load_dwordx4 v2, s[28:31], s35 offen offset:3072 sc1 lds
L_rO_pre1:
    s_waitcnt vmcnt(0)
    s_barrier
    ds_read_b128 v[16:19], v10 offset:0
    ds_read_b128 v[20:23], v10 offset:1024
    v_mfma_f32_32x32x16_bf16 v[64:79], a[240:243], v[32:35], v[64:79]
    ds_read_b128 v[24:27], v10 offset:2048
    ds_read_b128 v[28:31], v10 offset:3072
    v_mfma_f32_32x32x16_bf16 v[64:79], a[244:247], v[36:39], v[64:79]
    ds_read_b128 v[32:35], v10 offset:4096
    ds_read_b128 v[36:39], v10 offset:5120
    v_mfma_f32_32x32x16_bf16 v[64:79], a[248:251], v[40:43], v[64:79]
    v_mfma_f32_32x32x16_bf16 v[64:79], a[252:255], v[44:47], v[64:79]
    s_waitcnt lgkmcnt(5)
    v_mfma_f32_32x32x16_bf16 v[48:63], a[0:3], v[16:19], 0
    ds_read_b128 v[40:43], v10 offset:6144
    s_add_u32 s36, s36, 0x40000
    s_add_u32 s34, s32, 1
    s_lshr_b32 s34, s34, 2
    s_min_u32 s33, s47, s51
    s_cmp_gt_u32 s33, s34
    s_cselect_b32 s42, 1, 0
    s_cselect_b32 s63, s36, 0x40000000
    s_waitcnt lgkmcnt(5)
    v_mfma_f32_32x32x16_bf16 v[48:63], a[4:7], v[20:23], v[48:63]
    ds_read_b128 v[44:47], v10 offset:7168
    s_add_u32 m0, s37, 65536
    s_add_u32 s35, s63, 0
    buffer_load_dwordx4 v2, s[28:31], s35 offen offset:0 sc1 lds
    s_waitcnt lgkmcnt(5)
    v_mfma_f32_32x32x16_bf16 v[48:63], a[8:11], v[24:27], v[48:63]
    ds_read_b128 v[16:19], v10 offset:8192
    s_sub_u32 s64, s32, 3
    s_cbranch_scc1 L_rO_no9
    s_xor_b32 s33, s64, s60
    s_and_b32 s33, s33, 3
    s_cbranch_scc1 L_rO_no9
    v_pk_add_f32 v[88:89], v[88:89], v[104:105]
    v_pk_add_f32 v[90:91], v[90:91], v[106:107]
    v_pk_add_f32 v[92:93], v[92:93], v[108:109]
    v_pk_add_f32 v[94:95], v[94:95], v[110:111]
    v_pk_add_f32 v[96:97], v[96:97], v[112:113]
    v_pk_add_f32 v[98:99], v[98:99], v[114:115]
    v_pk_add_f32 v[100:101], v[100:101], v[116:117]
    v_pk_add_f32 v[102:103], v[102:103], v[118:119]
    v_pk_add_f32 v[88:89], v[88:89], v[120:121]
    v_pk_add_f32 v[90:91], v[90:91], v[122:123]
    v_pk_add_f32 v[92:93], v[92:93], v[124:125]
    v_pk_add_f32 v[94:95], v[94:95], v[126:127]
    v_pk_add_f32 v[96:97], v[96:97], v[128:129]
    v_pk_add_f32 v[98:99], v[98:99], v[130:131]
    v_pk_add_f32 v[100:101], v[100:101], v[132:133]
    v_pk_add_f32 v[102:103], v[102:103], v[134:135]
    v_pk_add_f32 v[88:89], v[88:89], v[136:137]
    v_pk_add_f32 v[90:91], v[90:91], v[138:139]
    v_pk_add_f32 v[92:93], v[92:93], v[140:141]
    v_pk_add_f32 v[94:95], v[94:95], v[142:143]
    v_pk_add_f32 v[96:97], v[96:97], v[144:145]
    v_pk_add_f32 v[98:99], v[98:99], v[146:147]
    v_pk_add_f32 v[100:101], v[100:101], v[148:149]
    v_pk_add_f32 v[102:103], v[102:103], v[150:151]
    v_cvt_pk_bf16_f32 v80, v88, v89
    v_cvt_pk_bf16_f32 v81, v90, v91
    v_cvt_pk_bf16_f32 v82, v92, v93
    v_cvt_pk_bf16_f32 v83, v94, v95
    v_cvt_pk_bf16_f32 v84, v96, v97
    v_cvt_pk_bf16_f32 v85, v98, v99
    v_cvt_pk_bf16_f32 v86, v100, v101
    v_cvt_pk_bf16_f32 v87, v102, v103
    s_lshl_b32 s33, s64, 17
    s_add_u32 s33, s33, s65
    buffer_store_dwordx4 v[80:83], v14, s[8:11], s33 offen
    buffer_store_dwordx4 v[84:87], v14, s[8:11], s33 offen offset:32
L_rO_no9:
    s_waitcnt lgkmcnt(5)
    v_mfma_f32_32x32x16_bf16 v[48:63], a[12:15], v[28:31], v[48:63]
    ds_read_b128 v[20:23], v10 offset:9216
    buffer_load_dwordx4 v2, s[28:31], s35 offen offset:1024 sc1 lds
    s_waitcnt lgkmcnt(5)
    v_mfma_f32_32x32x16_bf16 v[48:63], a[16:19], v[32:35], v[48:63]
    ds_read_b128 v[24:27], v10 offset:10240
    s_waitcnt lgkmcnt(5)
    v_mfma_f32_32x32x16_bf16 v[48:63], a[20:23], v[36:39], v[48:63]
    ds_read_b128 v[28:31], v10 offset:11264
    buffer_load_dwordx4 v2, s[28:31], s35 offen offset:2048 sc1 lds
    s_waitcnt lgkmcnt(5)
    v_mfma_f32_32x32x16_bf16 v[48:63], a[24:27], v[40:43], v[48:63]
    ds_read_b128 v[32:35], v10 offset:12288
    s_sub_u32 s64, s32, 1
    s_cbranch_scc1 L_rO_ne10
    s_sub_u32 s61, s60, s64
    s_and_b32 s61, s61, 3
    s_cbranch_scc0 L_rO_hold11
    s_lshl_b32 s33, s64, 19
    s_lshl_b32 s34, s61, 12
    s_add_u32 s33, s33, s34
    s_add_u32 s33, s33, s62
    buffer_store_dwordx4 v[64:67], v2, s[4:7], s33 offen offset:0 sc1
    buffer_store_dwordx4 v[68:71], v2, s[4:7], s33 offen offset:1024 sc1
    buffer_store_dwordx4 v[72:75], v2, s[4:7], s33 offen offset:2048 sc1
    buffer_store_dwordx4 v[76:79], v2, s[4:7], s33 offen offset:3072 sc1
    s_branch L_rO_sent11
L_rO_hold11:
    v_mov_b32 v88, v64
    v_mov_b32 v89, v65
    v_mov_b32 v90, v66
    v_mov_b32 v91, v67
    v_mov_b32 v92, v68
    v_mov_b32 v93, v69
    v_mov_b32 v94, v70
    v_mov_b32 v95, v71
    v_mov_b32 v96, v72
    v_mov_b32 v97, v73
    v_mov_b32 v98, v74
    v_mov_b32 v99, v75
    v_mov_b32 v100, v76
    v_mov_b32 v101, v77
    v_mov_b32 v102, v78
    v_mov_b32 v103, v79
L_rO_sent11:
L_rO_ne10:
    s_waitcnt lgkmcnt(5)
    v_mfma_f32_32x32x16_bf16 v[48:63], a[28:31], v[44:47], v[48:63]
    ds_read_b128 v[36:39], v10 offset:13312
    buffer_load_dwordx4 v2, s[28:31], s35 offen offset:3072 sc1 lds
    s_waitcnt lgkmcnt(5)
    v_mfma_f32_32x32x16_bf16 v[48:63], a[32:35], v[16:19], v[48:63]
    ds_read_b128 v[40:43], v10 offset:14336
    s_waitcnt lgkmcnt(5)
    v_mfma_f32_32x32x16_bf16 v[48:63], a[36:39], v[20:23], v[48:63]
    ds_read_b128 v[44:47], v10 offset:15360
    s_add_u32 m0, s37, 69632
    s_add_u32 s35, s63, 4096
    buffer_load_dwordx4 v2, s[28:31], s35 offen offset:0 sc1 lds
    s_waitcnt lgkmcnt(5)
    v_mfma_f32_32x32x16_bf16 v[48:63], a[40:43], v[24:27], v[48:63]
    ds_read_b128 v[16:19], v10 offset:16384
    s_waitcnt lgkmcnt(5)
    v_mfma_f32_32x32x16_bf16 v[48:63], a[44:47], v[28:31], v[48:63]
    ds_read_b128 v[20:23], v10 offset:17408
    buffer_load_dwordx4 v2, s[28:31], s35 offen offset:1024 sc1 lds
    s_waitcnt lgkmcnt(5)
    v_mfma_f32_32x32x16_bf16 v[48:63], a[48:51], v[32:35], v[48:63]
    ds_read_b128 v[24:27], v10 offset:18432
    s_waitcnt lgkmcnt(5)
    v_mfma_f32_32x32x16_bf16 v[48:63], a[52:55], v[36:39], v[48:63]
    ds_read_b128 v[28:31], v10 offset:19456
    buffer_load_dwordx4 v2, s[28:31], s35 offen offset:2048 sc1 lds
    s_waitcnt lgkmcnt(5)
    v_mfma_f32_32x32x16_bf16 v[48:63], a[56:59], v[40:43], v[48:63]
    ds_read_b128 v[32:35], v10 offset:20480
    s_waitcnt lgkmcnt(5)
    v_mfma_f32_32x32x16_bf16 v[48:63], a[60:63], v[44:47], v[48:63]
    ds_read_b128 v[36:39], v10 offset:21504
    buffer_load_dwordx4 v2, s[28:31], s35 offen offset:3072 sc1 lds
    s_waitcnt lgkmcnt(5)
    v_mfma_f32_32x32x16_bf16 v[48:63], a[64:67], v[16:19], v[48:63]
    ds_read_b128 v[40:43], v10 offset:22528
    s_load_dwordx4 s[52:55], s[4:5], s41 glc
    s_waitcnt lgkmcnt(5)
    v_mfma_f32_32x32x16_bf16 v[48:63], a[68:71], v[20:23], v[48:63]
    ds_read_b128 v[44:47], v10 offset:23552
    s_add_u32 m0, s37, 73728
    s_add_u32 s35, s63, 8192
    buffer_load_dwordx4 v2, s[28:31], s35 offen offset:0 sc1 lds
    s_waitcnt lgkmcnt(5)
    v_mfma_f32_32x32x16_bf16 v[48:63], a[72:75], v[24:27], v[48:63]
    ds_read_b128 v[16:19], v10 offset:24576
    s_waitcnt lgkmcnt(5)
    v_mfma_f32_32x32x16_bf16 v[48:63], a[76:79], v[28:31], v[48:63]
    ds_read_b128 v[20:23], v10 offset:25600
    buffer_load_dwordx4 v2, s[28:31], s35 offen offset:1024 sc1 lds
    s_waitcnt lgkmcnt(5)
    v_mfma_f32_32x32x16_bf16 v[48:63], a[80:83], v[32:35], v[48:63]
    ds_read_b128 v[24:27], v10 offset:26624
    s_waitcnt lgkmcnt(5)
    v_mfma_f32_32x32x16_bf16 v[48:63], a[84:87], v[36:39], v[48:63]
    ds_read_b128 v[28:31], v10 offset:27648
    buffer_load_dwordx4 v2, s[28:31], s35 offen offset:2048 sc1 lds
    s_waitcnt lgkmcnt(5)
    v_mfma_f32_32x32x16_bf16 v[48:63], a[88:91], v[40:43], v[48:63]
    ds_read_b128 v[32:35], v10 offset:28672
    s_waitcnt lgkmcnt(5)
    v_mfma_f32_32x32x16_bf16 v[48:63], a[92:95], v[44:47], v[48:63]
    ds_read_b128 v[36:39], v10 offset:29696
    buffer_load_dwordx4 v2, s[28:31], s35 offen offset:3072 sc1 lds
    s_waitcnt lgkmcnt(5)
    v_mfma_f32_32x32x16_bf16 v[48:63], a[96:99], v[16:19], v[48:63]
    ds_read_b128 v[40:43], v10 offset:30720
    s_waitcnt lgkmcnt(5)
    v_mfma_f32_32x32x16_bf16 v[48:63], a[100:103], v[20:23], v[48:63]
    ds_read_b128 v[44:47], v10 offset:31744
    s_add_u32 m0, s37, 77824
    s_add_u32 s35, s63, 12288
    buffer_load_dwordx4 v2, s[28:31], s35 offen offset:0 sc1 lds
    s_waitcnt lgkmcnt(5)
    v_mfma_f32_32x32x16_bf16 v[48:63], a[104:107], v[24:27], v[48:63]
    ds_read_b128 v[16:19], v10 offset:32768
    s_waitcnt lgkmcnt(5)
    v_mfma_f32_32x32x16_bf16 v[48:63], a[108:111], v[28:31], v[48:63]
    ds_read_b128 v[20:23], v10 offset:33792
    buffer_load_dwordx4 v2, s[28:31], s35 offen offset:1024 sc1 lds
    s_waitcnt lgkmcnt(5)
    v_mfma_f32_32x32x16_bf16 v[48:63], a[112:115], v[32:35], v[48:63]
    ds_read_b128 v[24:27], v10 offset:34816
    s_waitcnt lgkmcnt(5)
    v_mfma_f32_32x32x16_bf16 v[48:63], a[116:119], v[36:39], v[48:63]
    ds_read_b128 v[28:31], v10 offset:35840
    buffer_load_dwordx4 v2, s[28:31], s35 offen offset:2048 sc1 lds
    s_waitcnt lgkmcnt(5)
    v_mfma_f32_32x32x16_bf16 v[48:63], a[120:123], v[40:43], v[48:63]
    ds_read_b128 v[32:35], v10 offset:36864
    s_waitcnt lgkmcnt(5)
    v_mfma_f32_32x32x16_bf16 v[48:63], a[124:127], v[44:47], v[48:63]
    ds_read_b128 v[36:39], v10 offset:37888
    buffer_load_dwordx4 v2, s[28:31], s35 offen offset:3072 sc1 lds
    s_waitcnt lgkmcnt(5)
    v_mfma_f32_32x32x16_bf16 v[48:63], a[128:131], v[16:19], v[48:63]
    ds_read_b128 v[40:43], v10 offset:38912
    s_waitcnt lgkmcnt(5)
    v_mfma_f32_32x32x16_bf16 v[48:63], a[132:135], v[20:23], v[48:63]
    ds_read_b128 v[44:47], v10 offset:39936
    s_waitcnt lgkmcnt(5)
    v_mfma_f32_32x32x16_bf16 v[48:63], a[136:139], v[24:27], v[48:63]
    ds_read_b128 v[16:19], v10 offset:40960
    s_waitcnt lgkmcnt(5)
    v_mfma_f32_32x32x16_bf16 v[48:63], a[140:143], v[28:31], v[48:63]
    ds_read_b128 v[20:23], v10 offset:41984
    s_waitcnt lgkmcnt(5)
    v_mfma_f32_32x32x16_bf16 v[48:63], a[144:147], v[32:35], v[48:63]
    ds_read_b128 v[24:27], v10 offset:43008
    v_mov_b32 v9, s32
    s_waitcnt vmcnt(13)
    buffer_store_dword v9, v8, s[4:7], 0 offen sc1
    s_waitcnt lgkmcnt(5)
    v_mfma_f32_32x32x16_bf16 v[48:63], a[148:151], v[36:39], v[48:63]
    ds_read_b128 v[28:31], v10 offset:44032
    s_waitcnt lgkmcnt(5)
    v_mfma_f32_32x32x16_bf16 v[48:63], a[152:155], v[40:43], v[48:63]
    ds_read_b128 v[32:35], v10 offset:45056
    s_sub_u32 s64, s32, 2
    s_cbranch_scc1 L_rO_no12
    s_xor_b32 s33, s64, s60
    s_and_b32 s33, s33, 3
    s_cbranch_scc1 L_rO_no12
L_rO_w12:
    s_min_u32 s33, s52, s53
    s_min_u32 s33, s33, s54
    s_min_u32 s33, s33, s55
    s_cmp_gt_u32 s33, s64
    s_cbranch_scc1 L_rO_w12ok
    s_load_dwordx4 s[52:55], s[4:5], s41 glc
    s_add_u32 s40, s40, 1
    s_cmp_gt_u32 s40, 400000
    s_cbranch_scc1 L_done
    s_waitcnt lgkmcnt(0)
    s_branch L_rO_w12
L_rO_w12ok:
    s_lshl_b32 s33, s64, 19
    s_add_u32 s33, s33, s62
    s_add_u32 s33, s33, 4096
    buffer_load_dwordx4 v[104:107], v2, s[4:7], s33 offen offset:0 sc1
    buffer_load_dwordx4 v[108:111], v2, s[4:7], s33 offen offset:1024 sc1
    buffer_load_dwordx4 v[112:115], v2, s[4:7], s33 offen offset:2048 sc1
    buffer_load_dwordx4 v[116:119], v2, s[4:7], s33 offen offset:3072 sc1
    s_add_u32 s33, s33, 4096
    buffer_load_dwordx4 v[120:123], v2, s[4:7], s33 offen offset:0 sc1
    buffer_load_dwordx4 v[124:127], v2, s[4:7], s33 offen offset:1024 sc1
    buffer_load_dwordx4 v[128:131], v2, s[4:7], s33 offen offset:2048 sc1
    buffer_load_dwordx4 v[132:135], v2, s[4:7], s33 offen offset:3072 sc1
    s_add_u32 s33, s33, 4096
    buffer_load_dwordx4 v[136:139], v2, s[4:7], s33 offen offset:0 sc1
    buffer_load_dwordx4 v[140:143], v2, s[4:7], s33 offen offset:1024 sc1
    buffer_load_dwordx4 v[144:147], v2, s[4:7], s33 offen offset:2048 sc1
    buffer_load_dwordx4 v[148:151], v2, s[4:7], s33 offen offset:3072 sc1
L_rO_no12:
    s_waitcnt lgkmcnt(5)
    v_mfma_f32_32x32x16_bf16 v[48:63], a[156:159], v[44:47], v[48:63]
    ds_read_b128 v[36:39], v10 offset:46080
    s_waitcnt lgkmcnt(5)
    v_mfma_f32_32x32x16_bf16 v[48:63], a[160:163], v[16:19], v[48:63]
    ds_read_b128 v[40:43], v10 offset:47104
    s_load_dwordx8 s[44:51], s[4:5], s39 glc
    s_waitcnt lgkmcnt(5)
    v_mfma_f32_32x32x16_bf16 v[48:63], a[164:167], v[20:23], v[48:63]
    ds_read_b128 v[44:47], v10 offset:48128
    s_waitcnt lgkmcnt(5)
    v_mfma_f32_32x32x16_bf16 v[48:63], a[168:171], v[24:27], v[48:63]
    ds_read_b128 v[16:19], v10 offset:49152
    s_waitcnt lgkmcnt(5)
    v_mfma_f32_32x32x16_bf16 v[48:63], a[172:175], v[28:31], v[48:63]
    ds_read_b128 v[20:23], v10 offset:50176
    s_waitcnt lgkmcnt(5)
    v_mfma_f32_32x32x16_bf16 v[48:63], a[176:179], v[32:35], v[48:63]
    ds_read_b128 v[24:27], v10 offset:51200
    s_waitcnt lgkmcnt(5)
    v_mfma_f32_32x32x16_bf16 v[48:63], a[180:183], v[36:39], v[48:63]
    ds_read_b128 v[28:31], v10 offset:52224
    s_waitcnt lgkmcnt(5)
    v_mfma_f32_32x32x16_bf16 v[48:63], a[184:187], v[40:43], v[48:63]
    ds_read_b128 v[32:35], v10 offset:53248
    s_waitcnt lgkmcnt(5)
    v_mfma_f32_32x32x16_bf16 v[48:63], a[188:191], v[44:47], v[48:63]
    ds_read_b128 v[36:39], v10 offset:54272
    s_waitcnt lgkmcnt(5)
    v_mfma_f32_32x32x16_bf16 v[48:63], a[192:195], v[16:19], v[48:63]
    ds_read_b128 v[40:43], v10 offset:55296
    s_waitcnt lgkmcnt(5)
    v_mfma_f32_32x32x16_bf16 v[48:63], a[196:199], v[20:23], v[48:63]
    ds_read_b128 v[44:47], v10 offset:56320
    s_waitcnt lgkmcnt(5)
    v_mfma_f32_32x32x16_bf16 v[48:63], a[200:203], v[24:27], v[48:63]
    ds_read_b128 v[16:19], v10 offset:57344
    s_waitcnt lgkmcnt(5)
    v_mfma_f32_32x32x16_bf16 v[48:63], a[204:207], v[28:31], v[48:63]
    ds_read_b128 v[20:23], v10 offset:58368
    s_waitcnt lgkmcnt(5)
    v_mfma_f32_32x32x16_bf16 v[48:63], a[208:211], v[32:35], v[48:63]
    ds_read_b128 v[24:27], v10 offset:59392
    s_waitcnt lgkmcnt(5)
    v_mfma_f32_32x32x16_bf16 v[48:63], a[212:215], v[36:39], v[48:63]
    ds_read_b128 v[28:31], v10 offset:60416
    s_waitcnt lgkmcnt(5)
    v_mfma_f32_32x32x16_bf16 v[48:63], a[216:219], v[40:43], v[48:63]
    ds_read_b128 v[32:35], v10 offset:61440
    s_waitcnt lgkmcnt(5)
    v_mfma_f32_32x32x16_bf16 v[48:63], a[220:223], v[44:47], v[48:63]
    ds_read_b128 v[36:39], v10 offset:62464
    s_waitcnt lgkmcnt(5)
    v_mfma_f32_32x32x16_bf16 v[48:63], a[224:227], v[16:19], v[48:63]
    ds_read_b128 v[40:43], v10 offset:63488
    s_waitcnt lgkmcnt(5)
    v_mfma_f32_32x32x16_bf16 v[48:63], a[228:231], v[20:23], v[48:63]
    ds_read_b128 v[44:47], v10 offset:64512
    s_waitcnt lgkmcnt(5)
    v_mfma_f32_32x32x16_bf16 v[48:63], a[232:235], v[24:27], v[48:63]
    s_waitcnt lgkmcnt(4)
    v_mfma_f32_32x32x16_bf16 v[48:63], a[236:239], v[28:31], v[48:63]
    s_waitcnt lgkmcnt(0)
    s_add_u32 s32, s32, 1
    s_cmp_eq_u32 s32, 64
    s_cselect_b32 s42, 1, s42
    s_cmp_eq_u32 s42, 1
    s_cbranch_scc1 L_rO_pre2
    s_lshr_b32 s64, s32, 2
L_rO_o2:
    s_min_u32 s33, s47, s51
    s_cmp_gt_u32 s33, s64
    s_cbranch_scc1 L_rO_o2ok
    s_load_dwordx8 s[44:51], s[4:5], s39 glc
    s_add_u32 s40, s40, 1
    s_cmp_gt_u32 s40, 400000
    s_cbranch_scc1 L_done
    s_waitcnt lgkmcnt(0)
    s_branch L_rO_o2
L_rO_o2ok:
    s_add_u32 m0, s37, 65536
    s_add_u32 s35, s36, 0
    buffer_load_dwordx4 v2, s[28:31], s35 offen offset:0 sc1 lds
    buffer_load_dwordx4 v2, s[28:31], s35 offen offset:1024 sc1 lds
    buffer_load_dwordx4 v2, s[28:31], s35 offen offset:2048 sc1 lds
    buffer_load_dwordx4 v2, s[28:31], s35 offen offset:3072 sc1 lds
    s_add_u32 m0, s37, 69632
    s_add_u32 s35, s36, 4096
    buffer_load_dwordx4 v2, s[28:31], s35 offen offset:0 sc1 lds
    buffer_load_dwordx4 v2, s[28:31], s35 offen offset:1024 sc1 lds
    buffer_load_dwordx4 v2, s[28:31], s35 offen offset:2048 sc1 lds
    buffer_load_dwordx4 v2, s[28:31], s35 offen offset:3072 sc1 lds
    s_add_u32 m0, s37, 73728
    s_add_u32 s35, s36, 8192
    buffer_load_dwordx4 v2, s[28:31], s35 offen offset:0 sc1 lds
    buffer_load_dwordx4 v2, s[28:31], s35 offen offset:1024 sc1 lds
    buffer_load_dwordx4 v2, s[28:31], s35 offen offset:2048 sc1 lds
    buffer_load_dwordx4 v2, s[28:31], s35 offen offset:3072 sc1 lds
    s_add_u32 m0, s37, 77824
    s_add_u32 s35, s36, 12288
    buffer_load_dwordx4 v2, s[28:31], s35 offen offset:0 sc1 lds
    buffer_load_dwordx4 v2, s[28:31], s35 offen offset:1024 sc1 lds
    buffer_load_dwordx4 v2, s[28:31], s35 offen offset:2048 sc1 lds
    buffer_load_dwordx4 v2, s[28:31], s35 offen offset:3072 sc1 lds
L_rO_pre2:
    s_waitcnt vmcnt(0)
    s_barrier
    ds_read_b128 v[16:19], v11 offset:0
    ds_read_b128 v[20:23], v11 offset:1024
    v_mfma_f32_32x32x16_bf16 v[48:63], a[240:243], v[32:35], v[48:63]
    ds_read_b128 v[24:27], v11 offset:2048
    ds_read_b128 v[28:31], v11 offset:3072
    v_mfma_f32_32x32x16_bf16 v[48:63], a[244:247], v[36:39], v[48:63]
    ds_read_b128 v[32:35], v11 offset:4096
    ds_read_b128 v[36:39], v11 offset:5120
    v_mfma_f32_32x32x16_bf16 v[48:63], a[248:251], v[40:43], v[48:63]
    v_mfma_f32_32x32x16_bf16 v[48:63], a[252:255], v[44:47], v[48:63]
    s_waitcnt lgkmcnt(5)
    v_mfma_f32_32x32x16_bf16 v[64:79], a[0:3], v[16:19], 0
    ds_read_b128 v[40:43], v11 offset:6144
    s_add_u32 s36, s36, 0x40000
    s_add_u32 s34, s32, 1
    s_lshr_b32 s34, s34, 2
    s_min_u32 s33, s44, s48
    s_cmp_gt_u32 s33, s34
    s_cselect_b32 s42, 1, 0
    s_cselect_b32 s63, s36, 0x40000000
    s_waitcnt lgkmcnt(5)
    v_mfma_f32_32x32x16_bf16 v[64:79], a[4:7], v[20:23], v[64:79]
    ds_read_b128 v[44:47], v11 offset:7168
    s_add_u32 m0, s37, 0
    s_add_u32 s35, s63, 0
    buffer_load_dwordx4 v2, s[28:31], s35 offen offset:0 sc1 lds
    s_waitcnt lgkmcnt(5)
    v_mfma_f32_32x32x16_bf16 v[64:79], a[8:11], v[24:27], v[64:79]
    ds_read_b128 v[16:19], v11 offset:8192
    s_sub_u32 s64, s32, 3
    s_cbranch_scc1 L_rO_no13
    s_xor_b32 s33, s64, s60
    s_and_b32 s33, s33, 3
    s_cbranch_scc1 L_rO_no13
    v_pk_add_f32 v[88:89], v[88:89], v[104:105]
    v_pk_add_f32 v[90:91], v[90:91], v[106:107]
    v_pk_add_f32 v[92:93], v[92:93], v[108:109]
    v_pk_add_f32 v[94:95], v[94:95], v[110:111]
    v_pk_add_f32 v[96:97], v[96:97], v[112:113]
    v_pk_add_f32 v[98:99], v[98:99], v[114:115]
    v_pk_add_f32 v[100:101], v[100:101], v[116:117]
    v_pk_add_f32 v[102:103], v[102:103], v[118:119]
    v_pk_add_f32 v[88:89], v[88:89], v[120:121]
    v_pk_add_f32 v[90:91], v[90:91], v[122:123]
    v_pk_add_f32 v[92:93], v[92:93], v[124:125]
    v_pk_add_f32 v[94:95], v[94:95], v[126:127]
    v_pk_add_f32 v[96:97], v[96:97], v[128:129]
    v_pk_add_f32 v[98:99], v[98:99], v[130:131]
    v_pk_add_f32 v[100:101], v[100:101], v[132:133]
    v_pk_add_f32 v[102:103], v[102:103], v[134:135]
    v_pk_add_f32 v[88:89], v[88:89], v[136:137]
    v_pk_add_f32 v[90:91], v[90:91], v[138:139]
    v_pk_add_f32 v[92:93], v[92:93], v[140:141]
    v_pk_add_f32 v[94:95], v[94:95], v[142:143]
    v_pk_add_f32 v[96:97], v[96:97], v[144:145]
    v_pk_add_f32 v[98:99], v[98:99], v[146:147]
    v_pk_add_f32 v[100:101], v[100:101], v[148:149]
    v_pk_add_f32 v[102:103], v[102:103], v[150:151]
    v_cvt_pk_bf16_f32 v80, v88, v89
    v_cvt_pk_bf16_f32 v81, v90, v91
    v_cvt_pk_bf16_f32 v82, v92, v93
    v_cvt_pk_bf16_f32 v83, v94, v95
    v_cvt_pk_bf16_f32 v84, v96, v97
    v_cvt_pk_bf16_f32 v85, v98, v99
    v_cvt_pk_bf16_f32 v86, v100, v101
    v_cvt_pk_bf16_f32 v87, v102, v103
    s_lshl_b32 s33, s64, 17
    s_add_u32 s33, s33, s65
    buffer_store_dwordx4 v[80:83], v14, s[8:11], s33 offen
    buffer_store_dwordx4 v[84:87], v14, s[8:11], s33 offen offset:32
L_rO_no13:
    s_waitcnt lgkmcnt(5)
    v_mfma_f32_32x32x16_bf16 v[64:79], a[12:15], v[28:31], v[64:79]
    ds_read_b128 v[20:23], v11 offset:9216
    buffer_load_dwordx4 v2, s[28:31], s35 offen offset:1024 sc1 lds
    s_waitcnt lgkmcnt(5)
    v_mfma_f32_32x32x16_bf16 v[64:79], a[16:19], v[32:35], v[64:79]
    ds_read_b128 v[24:27], v11 offset:10240
    s_waitcnt lgkmcnt(5)
    v_mfma_f32_32x32x16_bf16 v[64:79], a[20:23], v[36:39], v[64:79]
    ds_read_b128 v[28:31], v11 offset:11264
    buffer_load_dwordx4 v2, s[28:31], s35 offen offset:2048 sc1 lds
    s_waitcnt lgkmcnt(5)
    v_mfma_f32_32x32x16_bf16 v[64:79], a[24:27], v[40:43], v[64:79]
    ds_read_b128 v[32:35], v11 offset:12288
    s_sub_u32 s64, s32, 1
    s_cbranch_scc1 L_rO_ne14
    s_sub_u32 s61, s60, s64
    s_and_b32 s61, s61, 3
    s_cbranch_scc0 L_rO_hold15
    s_lshl_b32 s33, s64, 19
    s_lshl_b32 s34, s61, 12
    s_add_u32 s33, s33, s34
    s_add_u32 s33, s33, s62
    buffer_store_dwordx4 v[48:51], v2, s[4:7], s33 offen offset:0 sc1
    buffer_store_dwordx4 v[52:55], v2, s[4:7], s33 offen offset:1024 sc1
    buffer_store_dwordx4 v[56:59], v2, s[4:7], s33 offen offset:2048 sc1
    buffer_store_dwordx4 v[60:63], v2, s[4:7], s33 offen offset:3072 sc1
    s_branch L_rO_sent15
L_rO_hold15:
    v_mov_b32 v88, v48
    v_mov_b32 v89, v49
    v_mov_b32 v90, v50
    v_mov_b32 v91, v51
    v_mov_b32 v92, v52
    v_mov_b32 v93, v53
    v_mov_b32 v94, v54
    v_mov_b32 v95, v55
    v_mov_b32 v96, v56
    v_mov_b32 v97, v57
    v_mov_b32 v98, v58
    v_mov_b32 v99, v59
    v_mov_b32 v100, v60
    v_mov_b32 v101, v61
    v_mov_b32 v102, v62
    v_mov_b32 v103, v63
L_rO_sent15:
L_rO_ne14:
    s_waitcnt lgkmcnt(5)
    v_mfma_f32_32x32x16_bf16 v[64:79], a[28:31], v[44:47], v[64:79]
    ds_read_b128 v[36:39], v11 offset:13312
    buffer_load_dwordx4 v2, s[28:31], s35 offen offset:3072 sc1 lds
    s_waitcnt lgkmcnt(5)
    v_mfma_f32_32x32x16_bf16 v[64:79], a[32:35], v[16:19], v[64:79]
    ds_read_b128 v[40:43], v11 offset:14336
    s_waitcnt lgkmcnt(5)
    v_mfma_f32_32x32x16_bf16 v[64:79], a[36:39], v[20:23], v[64:79]
    ds_read_b128 v[44:47], v11 offset:15360
    s_add_u32 m0, s37, 4096
    s_add_u32 s35, s63, 4096
    buffer_load_dwordx4 v2, s[28:31], s35 offen offset:0 sc1 lds
    s_waitcnt lgkmcnt(5)
    v_mfma_f32_32x32x16_bf16 v[64:79], a[40:43], v[24:27], v[64:79]
    ds_read_b128 v[16:19], v11 offset:16384
    s_waitcnt lgkmcnt(5)
    v_mfma_f32_32x32x16_bf16 v[64:79], a[44:47], v[28:31], v[64:79]
    ds_read_b128 v[20:23], v11 offset:17408
    buffer_load_dwordx4 v2, s[28:31], s35 offen offset:1024 sc1 lds
    s_waitcnt lgkmcnt(5)
    v_mfma_f32_32x32x16_bf16 v[64:79], a[48:51], v[32:35], v[64:79]
    ds_read_b128 v[24:27], v11 offset:18432
    s_waitcnt lgkmcnt(5)
    v_mfma_f32_32x32x16_bf16 v[64:79], a[52:55], v[36:39], v[64:79]
    ds_read_b128 v[28:31], v11 offset:19456
    buffer_load_dwordx4 v2, s[28:31], s35 offen offset:2048 sc1 lds
    s_waitcnt lgkmcnt(5)
    v_mfma_f32_32x32x16_bf16 v[64:79], a[56:59], v[40:43], v[64:79]
    ds_read_b128 v[32:35], v11 offset:20480
    s_waitcnt lgkmcnt(5)
    v_mfma_f32_32x32x16_bf16 v[64:79], a[60:63], v[44:47], v[64:79]
    ds_read_b128 v[36:39], v11 offset:21504
    buffer_load_dwordx4 v2, s[28:31], s35 offen offset:3072 sc1 lds
    s_waitcnt lgkmcnt(5)
    v_mfma_f32_32x32x16_bf16 v[64:79], a[64:67], v[16:19], v[64:79]
    ds_read_b128 v[40:43], v11 offset:22528
    s_load_dwordx4 s[52:55], s[4:5], s41 glc
    s_waitcnt lgkmcnt(5)
    v_mfma_f32_32x32x16_bf16 v[64:79], a[68:71], v[20:23], v[64:79]
    ds_read_b128 v[44:47], v11 offset:23552
    s_add_u32 m0, s37, 8192
    s_add_u32 s35, s63, 8192
    buffer_load_dwordx4 v2, s[28:31], s35 offen offset:0 sc1 lds
    s_waitcnt lgkmcnt(5)
    v_mfma_f32_32x32x16_bf16 v[64:79], a[72:75], v[24:27], v[64:79]
    ds_read_b128 v[16:19], v11 offset:24576
    s_waitcnt lgkmcnt(5)
    v_mfma_f32_32x32x16_bf16 v[64:79], a[76:79], v[28:31], v[64:79]
    ds_read_b128 v[20:23], v11 offset:25600
    buffer_load_dwordx4 v2, s[28:31], s35 offen offset:1024 sc1 lds
    s_waitcnt lgkmcnt(5)
    v_mfma_f32_32x32x16_bf16 v[64:79], a[80:83], v[32:35], v[64:79]
    ds_read_b128 v[24:27], v11 offset:26624
    s_waitcnt lgkmcnt(5)
    v_mfma_f32_32x32x16_bf16 v[64:79], a[84:87], v[36:39], v[64:79]
    ds_read_b128 v[28:31], v11 offset:27648
    buffer_load_dwordx4 v2, s[28:31], s35 offen offset:2048 sc1 lds
    s_waitcnt lgkmcnt(5)
    v_mfma_f32_32x32x16_bf16 v[64:79], a[88:91], v[40:43], v[64:79]
    ds_read_b128 v[32:35], v11 offset:28672
    s_waitcnt lgkmcnt(5)
    v_mfma_f32_32x32x16_bf16 v[64:79], a[92:95], v[44:47], v[64:79]
    ds_read_b128 v[36:39], v11 offset:29696
    buffer_load_dwordx4 v2, s[28:31], s35 offen offset:3072 sc1 lds
    s_waitcnt lgkmcnt(5)
    v_mfma_f32_32x32x16_bf16 v[64:79], a[96:99], v[16:19], v[64:79]
    ds_read_b128 v[40:43], v11 offset:30720
    s_waitcnt lgkmcnt(5)
    v_mfma_f32_32x32x16_bf16 v[64:79], a[100:103], v[20:23], v[64:79]
    ds_read_b128 v[44:47], v11 offset:31744
    s_add_u32 m0, s37, 12288
    s_add_u32 s35, s63, 12288
    buffer_load_dwordx4 v2, s[28:31], s35 offen offset:0 sc1 lds
    s_waitcnt lgkmcnt(5)
    v_mfma_f32_32x32x16_bf16 v[64:79], a[104:107], v[24:27], v[64:79]
    ds_read_b128 v[16:19], v11 offset:32768
    s_waitcnt lgkmcnt(5)
    v_mfma_f32_32x32x16_bf16 v[64:79], a[108:111], v[28:31], v[64:79]
    ds_read_b128 v[20:23], v11 offset:33792
    buffer_load_dwordx4 v2, s[28:31], s35 offen offset:1024 sc1 lds
    s_waitcnt lgkmcnt(5)
    v_mfma_f32_32x32x16_bf16 v[64:79], a[112:115], v[32:35], v[64:79]
    ds_read_b128 v[24:27], v11 offset:34816
    s_waitcnt lgkmcnt(5)
    v_mfma_f32_32x32x16_bf16 v[64:79], a[116:119], v[36:39], v[64:79]
    ds_read_b128 v[28:31], v11 offset:35840
    buffer_load_dwordx4 v2, s[28:31], s35 offen offset:2048 sc1 lds
    s_waitcnt lgkmcnt(5)
    v_mfma_f32_32x32x16_bf16 v[64:79], a[120:123], v[40:43], v[64:79]
    ds_read_b128 v[32:35], v11 offset:36864
    s_waitcnt lgkmcnt(5)
    v_mfma_f32_32x32x16_bf16 v[64:79], a[124:127], v[44:47], v[64:79]
    ds_read_b128 v[36:39], v11 offset:37888
    buffer_load_dwordx4 v2, s[28:31], s35 offen offset:3072 sc1 lds
    s_waitcnt lgkmcnt(5)
    v_mfma_f32_32x32x16_bf16 v[64:79], a[128:131], v[16:19], v[64:79]
    ds_read_b128 v[40:43], v11 offset:38912
    s_waitcnt lgkmcnt(5)
    v_mfma_f32_32x32x16_bf16 v[64:79], a[132:135], v[20:23], v[64:79]
    ds_read_b128 v[44:47], v11 offset:39936
    s_waitcnt lgkmcnt(5)
    v_mfma_f32_32x32x16_bf16 v[64:79], a[136:139], v[24:27], v[64:79]
    ds_read_b128 v[16:19], v11 offset:40960
    s_waitcnt lgkmcnt(5)
    v_mfma_f32_32x32x16_bf16 v[64:79], a[140:143], v[28:31], v[64:79]
    ds_read_b128 v[20:23], v11 offset:41984
    s_waitcnt lgkmcnt(5)
    v_mfma_f32_32x32x16_bf16 v[64:79], a[144:147], v[32:35], v[64:79]
    ds_read_b128 v[24:27], v11 offset:43008
    v_mov_b32 v9, s32
    s_waitcnt vmcnt(13)
    buffer_store_dword v9, v8, s[4:7], 0 offen sc1
    s_waitcnt lgkmcnt(5)
    v_mfma_f32_32x32x16_bf16 v[64:79], a[148:151], v[36:39], v[64:79]
    ds_read_b128 v[28:31], v11 offset:44032
    s_waitcnt lgkmcnt(5)
    v_mfma_f32_32x32x16_bf16 v[64:79], a[152:155], v[40:43], v[64:79]
    ds_read_b128 v[32:35], v11 offset:45056
    s_sub_u32 s64, s32, 2
    s_cbranch_scc1 L_rO_no16
    s_xor_b32 s33, s64, s60
    s_and_b32 s33, s33, 3
    s_cbranch_scc1 L_rO_no16
L_rO_w16:
    s_min_u32 s33, s52, s53
    s_min_u32 s33, s33, s54
    s_min_u32 s33, s33, s55
    s_cmp_gt_u32 s33, s64
    s_cbranch_scc1 L_rO_w16ok
    s_load_dwordx4 s[52:55], s[4:5], s41 glc
    s_add_u32 s40, s40, 1
    s_cmp_gt_u32 s40, 400000
    s_cbranch_scc1 L_done
    s_waitcnt lgkmcnt(0)
    s_branch L_rO_w16
L_rO_w16ok:
    s_lshl_b32 s33, s64, 19
    s_add_u32 s33, s33, s62
    s_add_u32 s33, s33, 4096
    buffer_load_dwordx4 v[104:107], v2, s[4:7], s33 offen offset:0 sc1
    buffer_load_dwordx4 v[108:111], v2, s[4:7], s33 offen offset:1024 sc1
    buffer_load_dwordx4 v[112:115], v2, s[4:7], s33 offen offset:2048 sc1
    buffer_load_dwordx4 v[116:119], v2, s[4:7], s33 offen offset:3072 sc1
    s_add_u32 s33, s33, 4096
    buffer_load_dwordx4 v[120:123], v2, s[4:7], s33 offen offset:0 sc1
    buffer_load_dwordx4 v[124:127], v2, s[4:7], s33 offen offset:1024 sc1
    buffer_load_dwordx4 v[128:131], v2, s[4:7], s33 offen offset:2048 sc1
    buffer_load_dwordx4 v[132:135], v2, s[4:7], s33 offen offset:3072 sc1
    s_add_u32 s33, s33, 4096
    buffer_load_dwordx4 v[136:139], v2, s[4:7], s33 offen offset:0 sc1
    buffer_load_dwordx4 v[140:143], v2, s[4:7], s33 offen offset:1024 sc1
    buffer_load_dwordx4 v[144:147], v2, s[4:7], s33 offen offset:2048 sc1
    buffer_load_dwordx4 v[148:151], v2, s[4:7], s33 offen offset:3072 sc1
L_rO_no16:
    s_waitcnt lgkmcnt(5)
    v_mfma_f32_32x32x16_bf16 v[64:79], a[156:159], v[44:47], v[64:79]
    ds_read_b128 v[36:39], v11 offset:46080
    s_waitcnt lgkmcnt(5)
    v_mfma_f32_32x32x16_bf16 v[64:79], a[160:163], v[16:19], v[64:79]
    ds_read_b128 v[40:43], v11 offset:47104
    s_load_dwordx8 s[44:51], s[4:5], s39 glc
    s_waitcnt lgkmcnt(5)
    v_mfma_f32_32x32x16_bf16 v[64:79], a[164:167], v[20:23], v[64:79]
    ds_read_b128 v[44:47], v11 offset:48128
    s_waitcnt lgkmcnt(5)
    v_mfma_f32_32x32x16_bf16 v[64:79], a[168:171], v[24:27], v[64:79]
    ds_read_b128 v[16:19], v11 offset:49152
    s_waitcnt lgkmcnt(5)
    v_mfma_f32_32x32x16_bf16 v[64:79], a[172:175], v[28:31], v[64:79]
    ds_read_b128 v[20:23], v11 offset:50176
    s_waitcnt lgkmcnt(5)
    v_mfma_f32_32x32x16_bf16 v[64:79], a[176:179], v[32:35], v[64:79]
    ds_read_b128 v[24:27], v11 offset:51200
    s_waitcnt lgkmcnt(5)
    v_mfma_f32_32x32x16_bf16 v[64:79], a[180:183], v[36:39], v[64:79]
    ds_read_b128 v[28:31], v11 offset:52224
    s_waitcnt lgkmcnt(5)
    v_mfma_f32_32x32x16_bf16 v[64:79], a[184:187], v[40:43], v[64:79]
    ds_read_b128 v[32:35], v11 offset:53248
    s_waitcnt lgkmcnt(5)
    v_mfma_f32_32x32x16_bf16 v[64:79], a[188:191], v[44:47], v[64:79]
    ds_read_b128 v[36:39], v11 offset:54272
    s_waitcnt lgkmcnt(5)
    v_mfma_f32_32x32x16_bf16 v[64:79], a[192:195], v[16:19], v[64:79]
    ds_read_b128 v[40:43], v11 offset:55296
    s_waitcnt lgkmcnt(5)
    v_mfma_f32_32x32x16_bf16 v[64:79], a[196:199], v[20:23], v[64:79]
    ds_read_b128 v[44:47], v11 offset:56320
    s_waitcnt lgkmcnt(5)
    v_mfma_f32_32x32x16_bf16 v[64:79], a[200:203], v[24:27], v[64:79]
    ds_read_b128 v[16:19], v11 offset:57344
    s_waitcnt lgkmcnt(5)
    v_mfma_f32_32x32x16_bf16 v[64:79], a[204:207], v[28:31], v[64:79]
    ds_read_b128 v[20:23], v11 offset:58368
    s_waitcnt lgkmcnt(5)
    v_mfma_f32_32x32x16_bf16 v[64:79], a[208:211], v[32:35], v[64:79]
    ds_read_b128 v[24:27], v11 offset:59392
    s_waitcnt lgkmcnt(5)
    v_mfma_f32_32x32x16_bf16 v[64:79], a[212:215], v[36:39], v[64:79]
    ds_read_b128 v[28:31], v11 offset:60416
    s_waitcnt lgkmcnt(5)
    v_mfma_f32_32x32x16_bf16 v[64:79], a[216:219], v[40:43], v[64:79]
    ds_read_b128 v[32:35], v11 offset:61440
    s_waitcnt lgkmcnt(5)
    v_mfma_f32_32x32x16_bf16 v[64:79], a[220:223], v[44:47], v[64:79]
    ds_read_b128 v[36:39], v11 offset:62464
    s_waitcnt lgkmcnt(5)
    v_mfma_f32_32x32x16_bf16 v[64:79], a[224:227], v[16:19], v[64:79]
    ds_read_b128 v[40:43], v11 offset:63488
    s_waitcnt lgkmcnt(5)
    v_mfma_f32_32x32x16_bf16 v[64:79], a[228:231], v[20:23], v[64:79]
    ds_read_b128 v[44:47], v11 offset:64512
    s_waitcnt lgkmcnt(5)
    v_mfma_f32_32x32x16_bf16 v[64:79], a[232:235], v[24:27], v[64:79]
    s_waitcnt lgkmcnt(4)
    v_mfma_f32_32x32x16_bf16 v[64:79], a[236:239], v[28:31], v[64:79]
    s_waitcnt lgkmcnt(0)
    s_add_u32 s32, s32, 1
    s_cmp_eq_u32 s32, 64
    s_cselect_b32 s42, 1, s42
    s_cmp_eq_u32 s42, 1
    s_cbranch_scc1 L_rO_pre3
    s_lshr_b32 s64, s32, 2
L_rO_o3:
    s_min_u32 s33, s44, s48
    s_cmp_gt_u32 s33, s64
    s_cbranch_scc1 L_rO_o3ok
    s_load_dwordx8 s[44:51], s[4:5], s39 glc
    s_add_u32 s40, s40, 1
    s_cmp_gt_u32 s40, 400000
    s_cbranch_scc1 L_done
    s_waitcnt lgkmcnt(0)
    s_branch L_rO_o3
L_rO_o3ok:
    s_add_u32 m0, s37, 0
    s_add_u32 s35, s36, 0
    buffer_load_dwordx4 v2, s[28:31], s35 offen offset:0 sc1 lds
    buffer_load_dwordx4 v2, s[28:31], s35 offen offset:1024 sc1 lds
    buffer_load_dwordx4 v2, s[28:31], s35 offen offset:2048 sc1 lds
    buffer_load_dwordx4 v2, s[28:31], s35 offen offset:3072 sc1 lds
    s_add_u32 m0, s37, 4096
    s_add_u32 s35, s36, 4096
    buffer_load_dwordx4 v2, s[28:31], s35 offen offset:0 sc1 lds
    buffer_load_dwordx4 v2, s[28:31], s35 offen offset:1024 sc1 lds
    buffer_load_dwordx4 v2, s[28:31], s35 offen offset:2048 sc1 lds
    buffer_load_dwordx4 v2, s[28:31], s35 offen offset:3072 sc1 lds
    s_add_u32 m0, s37, 8192
    s_add_u32 s35, s36, 8192
    buffer_load_dwordx4 v2, s[28:31], s35 offen offset:0 sc1 lds
    buffer_load_dwordx4 v2, s[28:31], s35 offen offset:1024 sc1 lds
    buffer_load_dwordx4 v2, s[28:31], s35 offen offset:2048 sc1 lds
    buffer_load_dwordx4 v2, s[28:31], s35 offen offset:3072 sc1 lds
    s_add_u32 m0, s37, 12288
    s_add_u32 s35, s36, 12288
    buffer_load_dwordx4 v2, s[28:31], s35 offen offset:0 sc1 lds
    buffer_load_dwordx4 v2, s[28:31], s35 offen offset:1024 sc1 lds
    buffer_load_dwordx4 v2, s[28:31], s35 offen offset:2048 sc1 lds
    buffer_load_dwordx4 v2, s[28:31], s35 offen offset:3072 sc1 lds
L_rO_pre3:
    s_waitcnt vmcnt(0)
    s_barrier
    ds_read_b128 v[16:19], v10 offset:0
    ds_read_b128 v[20:23], v10 offset:1024
    v_mfma_f32_32x32x16_bf16 v[64:79], a[240:243], v[32:35], v[64:79]
    ds_read_b128 v[24:27], v10 offset:2048
    ds_read_b128 v[28:31], v10 offset:3072
    v_mfma_f32_32x32x16_bf16 v[64:79], a[244:247], v[36:39], v[64:79]
    ds_read_b128 v[32:35], v10 offset:4096
    ds_read_b128 v[36:39], v10 offset:5120
    v_mfma_f32_32x32x16_bf16 v[64:79], a[248:251], v[40:43], v[64:79]
    v_mfma_f32_32x32x16_bf16 v[64:79], a[252:255], v[44:47], v[64:79]
    s_cmp_lt_u32 s32, 64
    s_cbranch_scc1 L_rO_loop
    s_sub_u32 s64, s32, 3
    s_cbranch_scc1 L_rO_no17
    s_xor_b32 s33, s64, s60
    s_and_b32 s33, s33, 3
    s_cbranch_scc1 L_rO_no17
    v_pk_add_f32 v[88:89], v[88:89], v[104:105]
    v_pk_add_f32 v[90:91], v[90:91], v[106:107]
    v_pk_add_f32 v[92:93], v[92:93], v[108:109]
    v_pk_add_f32 v[94:95], v[94:95], v[110:111]
    v_pk_add_f32 v[96:97], v[96:97], v[112:113]
    v_pk_add_f32 v[98:99], v[98:99], v[114:115]
    v_pk_add_f32 v[100:101], v[100:101], v[116:117]
    v_pk_add_f32 v[102:103], v[102:103], v[118:119]
    v_pk_add_f32 v[88:89], v[88:89], v[120:121]
    v_pk_add_f32 v[90:91], v[90:91], v[122:123]
    v_pk_add_f32 v[92:93], v[92:93], v[124:125]
    v_pk_add_f32 v[94:95], v[94:95], v[126:127]
    v_pk_add_f32 v[96:97], v[96:97], v[128:129]
    v_pk_add_f32 v[98:99], v[98:99], v[130:131]
    v_pk_add_f32 v[100:101], v[100:101], v[132:133]
    v_pk_add_f32 v[102:103], v[102:103], v[134:135]
    v_pk_add_f32 v[88:89], v[88:89], v[136:137]
    v_pk_add_f32 v[90:91], v[90:91], v[138:139]
    v_pk_add_f32 v[92:93], v[92:93], v[140:141]
    v_pk_add_f32 v[94:95], v[94:95], v[142:143]
    v_pk_add_f32 v[96:97], v[96:97], v[144:145]
    v_pk_add_f32 v[98:99], v[98:99], v[146:147]
    v_pk_add_f32 v[100:101], v[100:101], v[148:149]
    v_pk_add_f32 v[102:103], v[102:103], v[150:151]
    v_cvt_pk_bf16_f32 v80, v88, v89
    v_cvt_pk_bf16_f32 v81, v90, v91
    v_cvt_pk_bf16_f32 v82, v92, v93
    v_cvt_pk_bf16_f32 v83, v94, v95
    v_cvt_pk_bf16_f32 v84, v96, v97
    v_cvt_pk_bf16_f32 v85, v98, v99
    v_cvt_pk_bf16_f32 v86, v100, v101
    v_cvt_pk_bf16_f32 v87, v102, v103
    s_lshl_b32 s33, s64, 17
    s_add_u32 s33, s33, s65
    buffer_store_dwordx4 v[80:83], v14, s[8:11], s33 offen
    buffer_store_dwordx4 v[84:87], v14, s[8:11], s33 offen offset:32
L_rO_no17:
    s_nop 11
    s_mov_b32 s64, 63
    s_sub_u32 s61, s60, s64
    s_and_b32 s61, s61, 3
    s_cbranch_scc0 L_rO_hold18
    s_lshl_b32 s33, s64, 19
    s_lshl_b32 s34, s61, 12
    s_add_u32 s33, s33, s34
    s_add_u32 s33, s33, s62
    buffer_store_dwordx4 v[64:67], v2, s[4:7], s33 offen offset:0 sc1
    buffer_store_dwordx4 v[68:71], v2, s[4:7], s33 offen offset:1024 sc1
    buffer_store_dwordx4 v[72:75], v2, s[4:7], s33 offen offset:2048 sc1
    buffer_store_dwordx4 v[76:79], v2, s[4:7], s33 offen offset:3072 sc1
    s_branch L_rO_sent18
L_rO_hold18:
    v_mov_b32 v88, v64
    v_mov_b32 v89, v65
    v_mov_b32 v90, v66
    v_mov_b32 v91, v67
    v_mov_b32 v92, v68
    v_mov_b32 v93, v69
    v_mov_b32 v94, v70
    v_mov_b32 v95, v71
    v_mov_b32 v96, v72
    v_mov_b32 v97, v73
    v_mov_b32 v98, v74
    v_mov_b32 v99, v75
    v_mov_b32 v100, v76
    v_mov_b32 v101, v77
    v_mov_b32 v102, v78
    v_mov_b32 v103, v79
L_rO_sent18:
    v_mov_b32 v9, 64
    s_waitcnt vmcnt(0) lgkmcnt(0)
    buffer_store_dword v9, v8, s[4:7], 0 offen sc1
    s_sub_u32 s64, s32, 2
    s_cbranch_scc1 L_rO_no19
    s_xor_b32 s33, s64, s60
    s_and_b32 s33, s33, 3
    s_cbranch_scc1 L_rO_no19
L_rO_w19:
    s_min_u32 s33, s52, s53
    s_min_u32 s33, s33, s54
    s_min_u32 s33, s33, s55
    s_cmp_gt_u32 s33, s64
    s_cbranch_scc1 L_rO_w19ok
    s_load_dwordx4 s[52:55], s[4:5], s41 glc
    s_add_u32 s40, s40, 1
    s_cmp_gt_u32 s40, 400000
    s_cbranch_scc1 L_done
    s_waitcnt lgkmcnt(0)
    s_branch L_rO_w19
L_rO_w19ok:
    s_lshl_b32 s33, s64, 19
    s_add_u32 s33, s33, s62
    s_add_u32 s33, s33, 4096
    buffer_load_dwordx4 v[104:107], v2, s[4:7], s33 offen offset:0 sc1
    buffer_load_dwordx4 v[108:111], v2, s[4:7], s33 offen offset:1024 sc1
    buffer_load_dwordx4 v[112:115], v2, s[4:7], s33 offen offset:2048 sc1
    buffer_load_dwordx4 v[116:119], v2, s[4:7], s33 offen offset:3072 sc1
    s_add_u32 s33, s33, 4096
    buffer_load_dwordx4 v[120:123], v2, s[4:7], s33 offen offset:0 sc1
    buffer_load_dwordx4 v[124:127], v2, s[4:7], s33 offen offset:1024 sc1
    buffer_load_dwordx4 v[128:131], v2, s[4:7], s33 offen offset:2048 sc1
    buffer_load_dwordx4 v[132:135], v2, s[4:7], s33 offen offset:3072 sc1
    s_add_u32 s33, s33, 4096
    buffer_load_dwordx4 v[136:139], v2, s[4:7], s33 offen offset:0 sc1
    buffer_load_dwordx4 v[140:143], v2, s[4:7], s33 offen offset:1024 sc1
    buffer_load_dwordx4 v[144:147], v2, s[4:7], s33 offen offset:2048 sc1
    buffer_load_dwordx4 v[148:151], v2, s[4:7], s33 offen offset:3072 sc1
    s_waitcnt vmcnt(0)
    v_pk_add_f32 v[88:89], v[88:89], v[104:105]
    v_pk_add_f32 v[90:91], v[90:91], v[106:107]
    v_pk_add_f32 v[92:93], v[92:93], v[108:109]
    v_pk_add_f32 v[94:95], v[94:95], v[110:111]
    v_pk_add_f32 v[96:97], v[96:97], v[112:113]
    v_pk_add_f32 v[98:99], v[98:99], v[114:115]
    v_pk_add_f32 v[100:101], v[100:101], v[116:117]
    v_pk_add_f32 v[102:103], v[102:103], v[118:119]
    v_pk_add_f32 v[88:89], v[88:89], v[120:121]
    v_pk_add_f32 v[90:91], v[90:91], v[122:123]
    v_pk_add_f32 v[92:93], v[92:93], v[124:125]
    v_pk_add_f32 v[94:95], v[94:95], v[126:127]
    v_pk_add_f32 v[96:97], v[96:97], v[128:129]
    v_pk_add_f32 v[98:99], v[98:99], v[130:131]
    v_pk_add_f32 v[100:101], v[100:101], v[132:133]
    v_pk_add_f32 v[102:103], v[102:103], v[134:135]
    v_pk_add_f32 v[88:89], v[88:89], v[136:137]
    v_pk_add_f32 v[90:91], v[90:91], v[138:139]
    v_pk_add_f32 v[92:93], v[92:93], v[140:141]
    v_pk_add_f32 v[94:95], v[94:95], v[142:143]
    v_pk_add_f32 v[96:97], v[96:97], v[144:145]
    v_pk_add_f32 v[98:99], v[98:99], v[146:147]
    v_pk_add_f32 v[100:101], v[100:101], v[148:149]
    v_pk_add_f32 v[102:103], v[102:103], v[150:151]
    v_cvt_pk_bf16_f32 v80, v88, v89
    v_cvt_pk_bf16_f32 v81, v90, v91
    v_cvt_pk_bf16_f32 v82, v92, v93
    v_cvt_pk_bf16_f32 v83, v94, v95
    v_cvt_pk_bf16_f32 v84, v96, v97
    v_cvt_pk_bf16_f32 v85, v98, v99
    v_cvt_pk_bf16_f32 v86, v100, v101
    v_cvt_pk_bf16_f32 v87, v102, v103
    s_lshl_b32 s33, s64, 17
    s_add_u32 s33, s33, s65
    buffer_store_dwordx4 v[80:83], v14, s[8:11], s33 offen
    buffer_store_dwordx4 v[84:87], v14, s[8:11], s33 offen offset:32
L_rO_no19:
    s_sub_u32 s64, s32, 1
    s_cbranch_scc1 L_rO_no20
    s_xor_b32 s33, s64, s60
    s_and_b32 s33, s33, 3
    s_cbranch_scc1 L_rO_no20
L_rO_w20:
    s_min_u32 s33, s52, s53
    s_min_u32 s33, s33, s54
    s_min_u32 s33, s33, s55
    s_cmp_gt_u32 s33, s64
    s_cbranch_scc1 L_rO_w20ok
    s_load_dwordx4 s[52:55], s[4:5], s41 glc
    s_add_u32 s40, s40, 1
    s_cmp_gt_u32 s40, 400000
    s_cbranch_scc1 L_done
    s_waitcnt lgkmcnt(0)
    s_branch L_rO_w20
L_rO_w20ok:
    s_lshl_b32 s33, s64, 19
    s_add_u32 s33, s33, s62
    s_add_u32 s33, s33, 4096
    buffer_load_dwordx4 v[104:107], v2, s[4:7], s33 offen offset:0 sc1
    buffer_load_dwordx4 v[108:111], v2, s[4:7], s33 offen offset:1024 sc1
    buffer_load_dwordx4 v[112:115], v2, s[4:7], s33 offen offset:2048 sc1
    buffer_load_dwordx4 v[116:119], v2, s[4:7], s33 offen offset:3072 sc1
    s_add_u32 s33, s33, 4096
    buffer_load_dwordx4 v[120:123], v2, s[4:7], s33 offen offset:0 sc1
    buffer_load_dwordx4 v[124:127], v2, s[4:7], s33 offen offset:1024 sc1
    buffer_load_dwordx4 v[128:131], v2, s[4:7], s33 offen offset:2048 sc1
    buffer_load_dwordx4 v[132:135], v2, s[4:7], s33 offen offset:3072 sc1
    s_add_u32 s33, s33, 4096
    buffer_load_dwordx4 v[136:139], v2, s[4:7], s33 offen offset:0 sc1
    buffer_load_dwordx4 v[140:143], v2, s[4:7], s33 offen offset:1024 sc1
    buffer_load_dwordx4 v[144:147], v2, s[4:7], s33 offen offset:2048 sc1
    buffer_load_dwordx4 v[148:151], v2, s[4:7], s33 offen offset:3072 sc1
    s_waitcnt vmcnt(0)
    v_pk_add_f32 v[88:89], v[88:89], v[104:105]
    v_pk_add_f32 v[90:91], v[90:91], v[106:107]
    v_pk_add_f32 v[92:93], v[92:93], v[108:109]
    v_pk_add_f32 v[94:95], v[94:95], v[110:111]
    v_pk_add_f32 v[96:97], v[96:97], v[112:113]
    v_pk_add_f32 v[98:99], v[98:99], v[114:115]
    v_pk_add_f32 v[100:101], v[100:101], v[116:117]
    v_pk_add_f32 v[102:103], v[102:103], v[118:119]
    v_pk_add_f32 v[88:89], v[88:89], v[120:121]
    v_pk_add_f32 v[90:91], v[90:91], v[122:123]
    v_pk_add_f32 v[92:93], v[92:93], v[124:125]
    v_pk_add_f32 v[94:95], v[94:95], v[126:127]
    v_pk_add_f32 v[96:97], v[96:97], v[128:129]
    v_pk_add_f32 v[98:99], v[98:99], v[130:131]
    v_pk_add_f32 v[100:101], v[100:101], v[132:133]
    v_pk_add_f32 v[102:103], v[102:103], v[134:135]
    v_pk_add_f32 v[88:89], v[88:89], v[136:137]
    v_pk_add_f32 v[90:91], v[90:91], v[138:139]
    v_pk_add_f32 v[92:93], v[92:93], v[140:141]
    v_pk_add_f32 v[94:95], v[94:95], v[142:143]
    v_pk_add_f32 v[96:97], v[96:97], v[144:145]
    v_pk_add_f32 v[98:99], v[98:99], v[146:147]
    v_pk_add_f32 v[100:101], v[100:101], v[148:149]
    v_pk_add_f32 v[102:103], v[102:103], v[150:151]
    v_cvt_pk_bf16_f32 v80, v88, v89
    v_cvt_pk_bf16_f32 v81, v90, v91
    v_cvt_pk_bf16_f32 v82, v92, v93
    v_cvt_pk_bf16_f32 v83, v94, v95
    v_cvt_pk_bf16_f32 v84, v96, v97
    v_cvt_pk_bf16_f32 v85, v98, v99
    v_cvt_pk_bf16_f32 v86, v100, v101
    v_cvt_pk_bf16_f32 v87, v102, v103
    s_lshl_b32 s33, s64, 17
    s_add_u32 s33, s33, s65
    buffer_store_dwordx4 v[80:83], v14, s[8:11], s33 offen
    buffer_store_dwordx4 v[84:87], v14, s[8:11], s33 offen offset:32
L_rO_no20:
    s_waitcnt vmcnt(0) lgkmcnt(0)
    s_barrier
    s_branch L_done
L_role_G:
    v_and_b32 v1, 63, v0
    v_lshlrev_b32 v2, 4, v1
    v_lshlrev_b32 v3, 3, v1
    v_lshlrev_b32 v4, 2, v1
    v_mov_b32 v39, 0
    v_mov_b32 v40, 0
    v_mov_b32 v41, 0
    v_mov_b32 v50, -1
    v_bfrev_b32 v54, 1
    v_mov_b32 v51, -1
    v_bfrev_b32 v55, 1
    v_mov_b32 v52, -1
    v_bfrev_b32 v56, 1
    v_mov_b32 v53, -1
    v_bfrev_b32 v57, 1
    v_bfrev_b32 v31, 1
    v_mov_b32 v37, 0
    v_mov_b32 v30, 0
    v_bfe_u32 v32, v1, 1, 1
    v_mul_u32_u24 v32, 0xaaaa, v32
    v_add_u32 v5, 0x4444, v32
    s_lshl_b32 s33, s18, 12
    v_add_u32 v6, s33, v2
    v_and_b32 v34, 15, v1
    v_lshrrev_b32 v35, 4, v1
    s_mul_i32 s33, s18, 2304
    s_add_u32 s33, s33, 4096
    v_mul_u32_u24 v32, 288, v35
    v_lshl_add_u32 v32, v34, 2, v32
    v_add_u32 v7, s33, v32
    v_add_u32 v8, 1152, v7
    v_mul_u32_u24 v32, 144, v34
    v_lshl_add_u32 v9, v35, 5, v32
    s_lshl_b32 s33, s18, 10
    v_add_u32 v10, s33, v2
    v_mov_b32 v32, 0x3e0293ee
    v_cmp_gt_u32 vcc, 8, v34
    s_nop 1
    v_cndmask_b32 v94, 1.0, v32, vcc
    s_mul_i32 s33, s17, 1280
    v_add_u32 v22, s33, v2
    v_cmp_gt_u32 vcc, 8, v34
    s_nop 1
    v_cndmask_b32 v11, v31, v22, vcc
    v_cmp_gt_u32 vcc, 16, v1
    s_nop 1
    v_cndmask_b32 v23, v31, v22, vcc
    v_lshlrev_b32 v32, 5, v34
    v_lshl_add_u32 v32, v35, 4, v32
    s_add_u32 s34, s33, 768
    v_add_u32 v32, s34, v32
    v_cmp_le_u32 vcc, 8, v34
    s_nop 1
    v_cndmask_b32 v32, v31, v32, vcc
    v_cmp_gt_u32 vcc, 2, v35
    s_nop 1
    v_cndmask_b32 v12, v31, v32, vcc
    s_xor_b32 s33, s17, 1
    s_mul_i32 s33, s33, 1280
    v_add_u32 v47, s33, v2
    s_xor_b32 s33, s17, 2
    s_mul_i32 s33, s33, 1280
    v_add_u32 v48, s33, v2
    s_xor_b32 s33, s17, 3
    s_mul_i32 s33, s33, 1280
    v_add_u32 v49, s33, v2
    s_and_b32 s33, s17, 28
    s_mul_i32 s33, s33, 1280
    s_add_u32 s33, s33, 1024
    v_add_u32 v13, s33, v4
    v_lshrrev_b32 v32, 1, v34
    v_lshlrev_b32 v32, 2, v32
    v_and_b32 v36, 1, v34
    v_add_u32 v32, v32, v36
    v_and_b32 v36, 1, v35
    v_lshl_add_u32 v32, v36, 1, v32
    v_lshrrev_b32 v36, 1, v35
    v_lshl_add_u32 v32, v36, 4, v32
    s_lshl_b32 s33, s17, 9
    v_lshl_add_u32 v32, v32, 4, s33
    v_cmp_gt_u32 vcc, 8, v34
    s_nop 1
    v_cndmask_b32 v14, v31, v32, vcc
    v_add_u32 v32, s33, v2
    v_cmp_gt_u32 vcc, 32, v1
    s_nop 1
    v_cndmask_b32 v21, v31, v32, vcc
    v_lshrrev_b32 v32, 2, v1
    v_lshlrev_b32 v32, 5, v32
    v_and_b32 v36, 3, v1
    v_lshl_add_u32 v32, v36, 2, v32
    v_add_u32 v16, s33, v32
    s_lshr_b32 s33, s17, 1
    s_lshl_b32 s33, s33, 14
    s_and_b32 s34, s17, 1
    s_lshl_b32 s34, s34, 12
    s_add_u32 s33, s33, s34
    v_mov_b32 v29, v31
    s_add_u32 s34, s16, 1
    s_and_b32 s34, s34, 3
    s_lshl_b32 s34, s34, 10
    s_add_u32 s34, s34, s33
    v_add_u32 v44, s34, v2
    s_add_u32 s34, s34, 0
    v_writelane_b32 v29, s34, 0
    s_add_u32 s34, s16, 2
    s_and_b32 s34, s34, 3
    s_lshl_b32 s34, s34, 10
    s_add_u32 s34, s34, s33
    v_add_u32 v45, s34, v2
    s_add_u32 s34, s34, 4
    v_writelane_b32 v29, s34, 1
    s_add_u32 s34, s16, 3
    s_and_b32 s34, s34, 3
    s_lshl_b32 s34, s34, 10
    s_add_u32 s34, s34, s33
    v_add_u32 v46, s34, v2
    s_add_u32 s34, s34, 8
    v_writelane_b32 v29, s34, 2
    s_lshl_b32 s34, s16, 10
    s_add_u32 s33, s33, s34
    v_add_u32 v24, s33, v2
    s_mov_b32 s47, s33
    s_and_b32 s34, s18, 1
    s_lshl_b32 s34, s34, 9
    s_add_u32 s33, s33, s34
    v_add_u32 v15, s33, v3
    v_lshrrev_b32 v32, 2, v34
    v_and_b32 v36, 3, v34
    v_lshl_add_u32 v32, v32, 3, v36
    v_lshlrev_b32 v32, 4, v32
    v_lshl_add_u32 v17, v35, 9, v32
    v_lshlrev_b32 v32, 4, v34
    v_lshl_add_u32 v18, v35, 9, v32
    v_lshl_add_u32 v20, v35, 2, v32
    v_lshlrev_b32 v32, 6, v34
    v_lshl_add_u32 v32, v35, 4, v32
    v_subrev_u32 v32, 512, v32
    v_cmp_le_u32 vcc, 8, v34
    s_nop 1
    v_cndmask_b32 v19, v31, v32, vcc
    s_lshl_b32 s33, s16, 3
    s_lshr_b32 s34, s17, 2
    s_add_u32 s33, s33, s34
    s_lshl_b32 s33, s33, 7
    s_and_b32 s34, s17, 3
    s_lshl_b32 s34, s34, 2
    s_add_u32 s33, s33, s34
    s_add_u32 s50, s33, 3735552
    s_add_u32 s51, s33, 3735568
    s_add_u32 s33, s33, 3735584
    v_mov_b32 v32, s33
    v_cmp_eq_u32 vcc, 0, v1
    s_nop 1
    v_cndmask_b32 v42, v31, v32, vcc
    s_lshl_b32 s33, s17, 2
    v_lshl_add_u32 v32, v1, 8, s33
    v_cmp_gt_u32 vcc, 4, v1
    s_nop 1
    v_cndmask_b32 v25, v31, v32, vcc
    s_and_b32 s33, s17, 3
    s_lshl_b32 s33, s33, 8
    v_and_b32 v32, 31, v1
    v_lshl_add_u32 v26, v32, 2, s33
    s_lshr_b32 s33, s17, 2
    s_lshl_b32 s33, s33, 8
    s_add_u32 s33, s33, 4096
    v_and_b32 v32, 3, v1
    v_lshl_add_u32 v28, v32, 2, s33
    s_and_b32 s34, s17, 3
    v_cmp_eq_u32 vcc, s34, v1
    s_nop 1
    v_cndmask_b32 v27, v31, v28, vcc
    s_mov_b32 s40, 0x42200000
    s_mov_b32 s43, 0x80000000
    s_mov_b32 s44, 0x80000001
    s_lshl_b32 s41, s16, 16
    s_lshl_b32 s42, s16, 18
    s_add_u32 s42, s42, 2621440
    s_add_u32 s41, s41, 2097152
    s_lshl_b32 s45, s16, 13
    s_add_u32 s45, s45, 3670016
    s_lshl_b32 s33, s18, 14
    s_add_u32 s27, s41, s33
    s_add_u32 s28, s27, 262144
    s_lshl_b32 s33, s18, 16
    s_add_u32 s29, s42, s33
    s_lshl_b32 s30, s18, 18
    s_add_u32 s30, s30, 134217728
    s_add_u32 s39, s30, 8192
    s_mov_b32 s46, 150732800
    s_mov_b32 s35, 150740992
    buffer_load_dwordx4 v[116:119], v21, s[4:7], s27 offen sc1
    buffer_load_dwordx4 v[120:123], v21, s[4:7], s28 offen sc1
    buffer_load_dwordx4 v[124:127], v22, s[4:7], s29 offen sc1
    buffer_load_dwordx4 v[128:131], v23, s[4:7], s29 offen offset:1024 sc1
    buffer_load_dword v136, v25, s[4:7], s45 offen sc1
    buffer_load_dword v137, v27, s[4:7], s45 offen sc1
    buffer_load_dword v138, v25, s[4:7], s45 offen offset:2048 sc1
    s_load_dwordx2 s[8:9], s[0:1], 8
    v_lshrrev_b32 v36, 2, v34
    v_lshlrev_b32 v36, 1, v36
    v_and_b32 v32, 1, v34
    v_add_u32 v36, v36, v32
    v_lshlrev_b32 v36, 11, v36
    v_lshl_add_u32 v36, v35, 5, v36
    v_bfe_u32 v32, v34, 1, 1
    v_lshl_add_u32 v36, v32, 4, v36
    s_lshl_b32 s33, s17, 6
    s_mov_b32 s10, 16384
    s_mov_b32 s11, 0x20000
    s_waitcnt lgkmcnt(0)
    buffer_load_dwordx4 v[132:135], v36, s[8:11], s33 offen
    s_waitcnt vmcnt(0)
    s_cmp_eq_u32 s18, 0
    s_cselect_b64 vcc, -1, 0
    v_max_i32 v132, s44, v132
    v_cndmask_b32 v132, v31, v132, vcc
    v_max_i32 v133, s44, v133
    v_cndmask_b32 v133, v31, v133, vcc
    v_max_i32 v134, s44, v134
    v_cndmask_b32 v134, v31, v134, vcc
    v_max_i32 v135, s44, v135
    v_cndmask_b32 v135, v31, v135, vcc
    buffer_store_dwordx4 v[132:135], v21, s[4:7], s27 offen sc1
    buffer_store_dwordx4 v[50:53], v21, s[4:7], s28 offen sc1
    buffer_store_dwordx4 v[50:53], v22, s[4:7], s29 offen sc1
    buffer_store_dwordx4 v[50:53], v23, s[4:7], s29 offen offset:1024 sc1
    buffer_store_dwordx4 v[50:53], v24, s[4:7], s30 offen sc1
    buffer_store_dwordx4 v[50:53], v24, s[4:7], s39 offen sc1
    buffer_store_dword v37, v29, s[4:7], s35 offen sc1
    buffer_store_dword v37, v25, s[4:7], s45 offen sc1
    buffer_store_dword v37, v27, s[4:7], s45 offen sc1
    buffer_store_dword v37, v25, s[4:7], s45 offen offset:2048 sc1
    buffer_store_dword v37, v29, s[4:7], s46 offen sc1
    buffer_store_dword v37, v42, s[4:7], 0 offen sc1
    s_waitcnt vmcnt(0)
    s_barrier
    s_cmp_lg_u32 s18, 0
    s_cbranch_scc1 L_sig_14
    v_mov_b32 v32, s22
    v_mov_b32 v36, 1
    s_mov_b64 exec, 1
    buffer_atomic_add v36, v32, s[12:15], 0 offen sc1
    s_mov_b64 exec, -1
L_sig_14:
    s_load_dwordx2 s[8:9], s[0:1], 16
    s_mov_b32 s10, 8388608
    s_mov_b32 s11, 0x20000
    v_lshrrev_b32 v32, 2, v1
    v_lshlrev_b32 v32, 13, v32
    v_and_b32 v36, 3, v1
    v_lshl_add_u32 v32, v36, 4, v32
    s_lshl_b32 s33, s16, 5
    s_add_u32 s33, s33, s17
    s_lshl_b32 s33, s33, 6
    s_lshl_b32 s34, s18, 21
    s_add_u32 s33, s33, s34
    s_lshl_b32 s34, s18, 14
    s_add_u32 s34, s34, 0
    s_waitcnt lgkmcnt(0)
    s_mov_b32 m0, s34
    s_add_u32 s34, s34, 1024
    buffer_load_dwordx4 v32, s[8:11], s33 offen lds
    s_add_u32 s33, s33, 131072
    s_mov_b32 m0, s34
    s_add_u32 s34, s34, 1024
    buffer_load_dwordx4 v32, s[8:11], s33 offen lds
    s_add_u32 s33, s33, 131072
    s_mov_b32 m0, s34
    s_add_u32 s34, s34, 1024
    buffer_load_dwordx4 v32, s[8:11], s33 offen lds
    s_add_u32 s33, s33, 131072
    s_mov_b32 m0, s34
    s_add_u32 s34, s34, 1024
    buffer_load_dwordx4 v32, s[8:11], s33 offen lds
    s_add_u32 s33, s33, 131072
    s_mov_b32 m0, s34
    s_add_u32 s34, s34, 1024
    buffer_load_dwordx4 v32, s[8:11], s33 offen lds
    s_add_u32 s33, s33, 131072
    s_mov_b32 m0, s34
    s_add_u32 s34, s34, 1024
    buffer_load_dwordx4 v32, s[8:11], s33 offen lds
    s_add_u32 s33, s33, 131072
    s_mov_b32 m0, s34
    s_add_u32 s34, s34, 1024
    buffer_load_dwordx4 v32, s[8:11], s33 offen lds
    s_add_u32 s33, s33, 131072
    s_mov_b32 m0, s34
    s_add_u32 s34, s34, 1024
    buffer_load_dwordx4 v32, s[8:11], s33 offen lds
    s_add_u32 s33, s33, 131072
    s_mov_b32 m0, s34
    s_add_u32 s34, s34, 1024
    buffer_load_dwordx4 v32, s[8:11], s33 offen lds
    s_add_u32 s33, s33, 131072
    s_mov_b32 m0, s34
    s_add_u32 s34, s34, 1024
    buffer_load_dwordx4 v32, s[8:11], s33 offen lds
    s_add_u32 s33, s33, 131072
    s_mov_b32 m0, s34
    s_add_u32 s34, s34, 1024
    buffer_load_dwordx4 v32, s[8:11], s33 offen lds
    s_add_u32 s33, s33, 131072
    s_mov_b32 m0, s34
    s_add_u32 s34, s34, 1024
    buffer_load_dwordx4 v32, s[8:11], s33 offen lds
    s_add_u32 s33, s33, 131072
    s_mov_b32 m0, s34
    s_add_u32 s34, s34, 1024
    buffer_load_dwordx4 v32, s[8:11], s33 offen lds
    s_add_u32 s33, s33, 131072
    s_mov_b32 m0, s34
    s_add_u32 s34, s34, 1024
    buffer_load_dwordx4 v32, s[8:11], s33 offen lds
    s_add_u32 s33, s33, 131072
    s_mov_b32 m0, s34
    s_add_u32 s34, s34, 1024
    buffer_load_dwordx4 v32, s[8:11], s33 offen lds
    s_add_u32 s33, s33, 131072
    s_mov_b32 m0, s34
    s_add_u32 s34, s34, 1024
    buffer_load_dwordx4 v32, s[8:11], s33 offen lds
    s_add_u32 s33, s33, 131072
    s_load_dwordx2 s[8:9], s[0:1], 24
    s_mov_b32 s10, 8388608
    s_mov_b32 s11, 0x20000
    v_lshrrev_b32 v32, 2, v1
    v_lshlrev_b32 v32, 13, v32
    v_and_b32 v36, 3, v1
    v_lshl_add_u32 v32, v36, 4, v32
    s_lshl_b32 s33, s16, 5
    s_add_u32 s33, s33, s17
    s_lshl_b32 s33, s33, 6
    s_lshl_b32 s34, s18, 21
    s_add_u32 s33, s33, s34
    s_lshl_b32 s34, s18, 14
    s_add_u32 s34, s34, 65536
    s_waitcnt lgkmcnt(0)
    s_mov_b32 m0, s34
    s_add_u32 s34, s34, 1024
    buffer_load_dwordx4 v32, s[8:11], s33 offen lds
    s_add_u32 s33, s33, 131072
    s_mov_b32 m0, s34
    s_add_u32 s34, s34, 1024
    buffer_load_dwordx4 v32, s[8:11], s33 offen lds
    s_add_u32 s33, s33, 131072
    s_mov_b32 m0, s34
    s_add_u32 s34, s34, 1024
    buffer_load_dwordx4 v32, s[8:11], s33 offen lds
    s_add_u32 s33, s33, 131072
    s_mov_b32 m0, s34
    s_add_u32 s34, s34, 1024
    buffer_load_dwordx4 v32, s[8:11], s33 offen lds
    s_add_u32 s33, s33, 131072
    s_mov_b32 m0, s34
    s_add_u32 s34, s34, 1024
    buffer_load_dwordx4 v32, s[8:11], s33 offen lds
    s_add_u32 s33, s33, 131072
    s_mov_b32 m0, s34
    s_add_u32 s34, s34, 1024
    buffer_load_dwordx4 v32, s[8:11], s33 offen lds
    s_add_u32 s33, s33, 131072
    s_mov_b32 m0, s34
    s_add_u32 s34, s34, 1024
    buffer_load_dwordx4 v32, s[8:11], s33 offen lds
    s_add_u32 s33, s33, 131072
    s_mov_b32 m0, s34
    s_add_u32 s34, s34, 1024
    buffer_load_dwordx4 v32, s[8:11], s33 offen lds
    s_add_u32 s33, s33, 131072
    s_mov_b32 m0, s34
    s_add_u32 s34, s34, 1024
    buffer_load_dwordx4 v32, s[8:11], s33 offen lds
    s_add_u32 s33, s33, 131072
    s_mov_b32 m0, s34
    s_add_u32 s34, s34, 1024
    buffer_load_dwordx4 v32, s[8:11], s33 offen lds
    s_add_u32 s33, s33, 131072
    s_mov_b32 m0, s34
    s_add_u32 s34, s34, 1024
    buffer_load_dwordx4 v32, s[8:11], s33 offen lds
    s_add_u32 s33, s33, 131072
    s_mov_b32 m0, s34
    s_add_u32 s34, s34, 1024
    buffer_load_dwordx4 v32, s[8:11], s33 offen lds
    s_add_u32 s33, s33, 131072
    s_mov_b32 m0, s34
    s_add_u32 s34, s34, 1024
    buffer_load_dwordx4 v32, s[8:11], s33 offen lds
    s_add_u32 s33, s33, 131072
    s_mov_b32 m0, s34
    s_add_u32 s34, s34, 1024
    buffer_load_dwordx4 v32, s[8:11], s33 offen lds
    s_add_u32 s33, s33, 131072
    s_mov_b32 m0, s34
    s_add_u32 s34, s34, 1024
    buffer_load_dwordx4 v32, s[8:11], s33 offen lds
    s_add_u32 s33, s33, 131072
    s_mov_b32 m0, s34
    s_add_u32 s34, s34, 1024
    buffer_load_dwordx4 v32, s[8:11], s33 offen lds
    s_add_u32 s33, s33, 131072
    v_bfe_u32 v86, v1, 2, 1
    v_bfe_u32 v34, v1, 3, 1
    v_lshl_add_u32 v86, v34, 3, v86
    v_bfe_u32 v34, v1, 4, 1
    v_lshl_add_u32 v86, v34, 2, v86
    v_bfe_u32 v34, v1, 5, 1
    v_lshl_add_u32 v86, v34, 4, v86
    v_lshlrev_b32 v86, 6, v86
    v_and_b32 v34, 3, v1
    v_lshl_add_u32 v86, v34, 3, v86
    v_bfe_u32 v88, v1, 2, 1
    v_bfe_u32 v34, v1, 3, 1
    v_lshl_add_u32 v88, v34, 2, v88
    v_bfe_u32 v34, v1, 4, 1
    v_lshl_add_u32 v88, v34, 4, v88
    v_bfe_u32 v34, v1, 5, 1
    v_lshl_add_u32 v88, v34, 3, v88
    v_lshlrev_b32 v88, 6, v88
    v_and_b32 v34, 3, v1
    v_lshl_add_u32 v88, v34, 3, v88
    s_lshl_b32 s34, s18, 14
    v_add_u32 v86, s34, v86
    v_add_u32 v87, 0x10000, v86
    s_and_b32 s34, s18, 1
    s_lshl_b32 s34, s34, 5
    s_add_u32 s34, s34, 0x10000
    v_add_u32 v88, s34, v88
    s_waitcnt vmcnt(16)
    ds_read_b64_tr_b16 a[0:1], v86 offset:0
    ds_read_b64_tr_b16 a[2:3], v86 offset:128
    ds_read_b64_tr_b16 a[4:5], v86 offset:2048
    ds_read_b64_tr_b16 a[6:7], v86 offset:2176
    ds_read_b64_tr_b16 a[8:9], v86 offset:32
    ds_read_b64_tr_b16 a[10:11], v86 offset:160
    ds_read_b64_tr_b16 a[12:13], v86 offset:2080
    ds_read_b64_tr_b16 a[14:15], v86 offset:2208
    s_waitcnt lgkmcnt(0)
    ds_read_b64_tr_b16 a[48:49], v86 offset:4096
    ds_read_b64_tr_b16 a[50:51], v86 offset:4224
    ds_read_b64_tr_b16 a[52:53], v86 offset:6144
    ds_read_b64_tr_b16 a[54:55], v86 offset:6272
    ds_read_b64_tr_b16 a[56:57], v86 offset:4128
    ds_read_b64_tr_b16 a[58:59], v86 offset:4256
    ds_read_b64_tr_b16 a[60:61], v86 offset:6176
    ds_read_b64_tr_b16 a[62:63], v86 offset:6304
    s_waitcnt lgkmcnt(0)
    ds_read_b64_tr_b16 a[96:97], v86 offset:8192
    ds_read_b64_tr_b16 a[98:99], v86 offset:8320
    ds_read_b64_tr_b16 a[100:101], v86 offset:10240
    ds_read_b64_tr_b16 a[102:103], v86 offset:10368
    ds_read_b64_tr_b16 a[104:105], v86 offset:8224
    ds_read_b64_tr_b16 a[106:107], v86 offset:8352
    ds_read_b64_tr_b16 a[108:109], v86 offset:10272
    ds_read_b64_tr_b16 a[110:111], v86 offset:10400
    s_waitcnt lgkmcnt(0)
    ds_read_b64_tr_b16 a[144:145], v86 offset:12288
    ds_read_b64_tr_b16 a[146:147], v86 offset:12416
    ds_read_b64_tr_b16 a[148:149], v86 offset:14336
    ds_read_b64_tr_b16 a[150:151], v86 offset:14464
    ds_read_b64_tr_b16 a[152:153], v86 offset:12320
    ds_read_b64_tr_b16 a[154:155], v86 offset:12448
    ds_read_b64_tr_b16 a[156:157], v86 offset:14368
    ds_read_b64_tr_b16 a[158:159], v86 offset:14496
    s_waitcnt lgkmcnt(0)
    s_load_dwordx2 s[8:9], s[0:1], 32
    s_mov_b32 s10, 8388608
    s_mov_b32 s11, 0x20000
    v_lshrrev_b32 v32, 2, v1
    v_lshlrev_b32 v32, 13, v32
    v_and_b32 v36, 3, v1
    v_lshl_add_u32 v32, v36, 4, v32
    s_lshl_b32 s33, s16, 5
    s_add_u32 s33, s33, s17
    s_lshl_b32 s33, s33, 6
    s_lshl_b32 s34, s18, 21
    s_add_u32 s33, s33, s34
    s_lshl_b32 s34, s18, 14
    s_add_u32 s34, s34, 0
    s_waitcnt lgkmcnt(0)
    s_mov_b32 m0, s34
    s_add_u32 s34, s34, 1024
    buffer_load_dwordx4 v32, s[8:11], s33 offen lds
    s_add_u32 s33, s33, 131072
    s_mov_b32 m0, s34
    s_add_u32 s34, s34, 1024
    buffer_load_dwordx4 v32, s[8:11], s33 offen lds
    s_add_u32 s33, s33, 131072
    s_mov_b32 m0, s34
    s_add_u32 s34, s34, 1024
    buffer_load_dwordx4 v32, s[8:11], s33 offen lds
    s_add_u32 s33, s33, 131072
    s_mov_b32 m0, s34
    s_add_u32 s34, s34, 1024
    buffer_load_dwordx4 v32, s[8:11], s33 offen lds
    s_add_u32 s33, s33, 131072
    s_mov_b32 m0, s34
    s_add_u32 s34, s34, 1024
    buffer_load_dwordx4 v32, s[8:11], s33 offen lds
    s_add_u32 s33, s33, 131072
    s_mov_b32 m0, s34
    s_add_u32 s34, s34, 1024
    buffer_load_dwordx4 v32, s[8:11], s33 offen lds
    s_add_u32 s33, s33, 131072
    s_mov_b32 m0, s34
    s_add_u32 s34, s34, 1024
    buffer_load_dwordx4 v32, s[8:11], s33 offen lds
    s_add_u32 s33, s33, 131072
    s_mov_b32 m0, s34
    s_add_u32 s34, s34, 1024
    buffer_load_dwordx4 v32, s[8:11], s33 offen lds
    s_add_u32 s33, s33, 131072
    s_mov_b32 m0, s34
    s_add_u32 s34, s34, 1024
    buffer_load_dwordx4 v32, s[8:11], s33 offen lds
    s_add_u32 s33, s33, 131072
    s_mov_b32 m0, s34
    s_add_u32 s34, s34, 1024
    buffer_load_dwordx4 v32, s[8:11], s33 offen lds
    s_add_u32 s33, s33, 131072
    s_mov_b32 m0, s34
    s_add_u32 s34, s34, 1024
    buffer_load_dwordx4 v32, s[8:11], s33 offen lds
    s_add_u32 s33, s33, 131072
    s_mov_b32 m0, s34
    s_add_u32 s34, s34, 1024
    buffer_load_dwordx4 v32, s[8:11], s33 offen lds
    s_add_u32 s33, s33, 131072
    s_mov_b32 m0, s34
    s_add_u32 s34, s34, 1024
    buffer_load_dwordx4 v32, s[8:11], s33 offen lds
    s_add_u32 s33, s33, 131072
    s_mov_b32 m0, s34
    s_add_u32 s34, s34, 1024
    buffer_load_dwordx4 v32, s[8:11], s33 offen lds
    s_add_u32 s33, s33, 131072
    s_mov_b32 m0, s34
    s_add_u32 s34, s34, 1024
    buffer_load_dwordx4 v32, s[8:11], s33 offen lds
    s_add_u32 s33, s33, 131072
    s_mov_b32 m0, s34
    s_add_u32 s34, s34, 1024
    buffer_load_dwordx4 v32, s[8:11], s33 offen lds
    s_add_u32 s33, s33, 131072
    s_waitcnt vmcnt(16)
    ds_read_b64_tr_b16 a[16:17], v87 offset:0
    ds_read_b64_tr_b16 a[18:19], v87 offset:128
    ds_read_b64_tr_b16 a[20:21], v87 offset:2048
    ds_read_b64_tr_b16 a[22:23], v87 offset:2176
    ds_read_b64_tr_b16 a[24:25], v87 offset:32
    ds_read_b64_tr_b16 a[26:27], v87 offset:160
    ds_read_b64_tr_b16 a[28:29], v87 offset:2080
    ds_read_b64_tr_b16 a[30:31], v87 offset:2208
    s_waitcnt lgkmcnt(0)
    ds_read_b64_tr_b16 a[64:65], v87 offset:4096
    ds_read_b64_tr_b16 a[66:67], v87 offset:4224
    ds_read_b64_tr_b16 a[68:69], v87 offset:6144
    ds_read_b64_tr_b16 a[70:71], v87 offset:6272
    ds_read_b64_tr_b16 a[72:73], v87 offset:4128
    ds_read_b64_tr_b16 a[74:75], v87 offset:4256
    ds_read_b64_tr_b16 a[76:77], v87 offset:6176
    ds_read_b64_tr_b16 a[78:79], v87 offset:6304
    s_waitcnt lgkmcnt(0)
    ds_read_b64_tr_b16 a[112:113], v87 offset:8192
    ds_read_b64_tr_b16 a[114:115], v87 offset:8320
    ds_read_b64_tr_b16 a[116:117], v87 offset:10240
    ds_read_b64_tr_b16 a[118:119], v87 offset:10368
    ds_read_b64_tr_b16 a[120:121], v87 offset:8224
    ds_read_b64_tr_b16 a[122:123], v87 offset:8352
    ds_read_b64_tr_b16 a[124:125], v87 offset:10272
    ds_read_b64_tr_b16 a[126:127], v87 offset:10400
    s_waitcnt lgkmcnt(0)
    ds_read_b64_tr_b16 a[160:161], v87 offset:12288
    ds_read_b64_tr_b16 a[162:163], v87 offset:12416
    ds_read_b64_tr_b16 a[164:165], v87 offset:14336
    ds_read_b64_tr_b16 a[166:167], v87 offset:14464
    ds_read_b64_tr_b16 a[168:169], v87 offset:12320
    ds_read_b64_tr_b16 a[170:171], v87 offset:12448
    ds_read_b64_tr_b16 a[172:173], v87 offset:14368
    ds_read_b64_tr_b16 a[174:175], v87 offset:14496
    s_waitcnt lgkmcnt(0)
    s_load_dwordx2 s[8:9], s[0:1], 40
    s_mov_b32 s10, 8388608
    s_mov_b32 s11, 0x20000
    v_lshrrev_b32 v32, 2, v1
    v_lshlrev_b32 v32, 11, v32
    v_and_b32 v36, 3, v1
    v_lshl_add_u32 v32, v36, 4, v32
    s_lshl_b32 s33, s16, 21
    s_lshl_b32 s34, s17, 6
    s_add_u32 s33, s33, s34
    s_lshl_b32 s34, s18, 19
    s_add_u32 s33, s33, s34
    s_lshl_b32 s34, s18, 14
    s_add_u32 s34, s34, 65536
    s_waitcnt lgkmcnt(0)
    s_mov_b32 m0, s34
    s_add_u32 s34, s34, 1024
    buffer_load_dwordx4 v32, s[8:11], s33 offen lds
    s_add_u32 s33, s33, 32768
    s_mov_b32 m0, s34
    s_add_u32 s34, s34, 1024
    buffer_load_dwordx4 v32, s[8:11], s33 offen lds
    s_add_u32 s33, s33, 32768
    s_mov_b32 m0, s34
    s_add_u32 s34, s34, 1024
    buffer_load_dwordx4 v32, s[8:11], s33 offen lds
    s_add_u32 s33, s33, 32768
    s_mov_b32 m0, s34
    s_add_u32 s34, s34, 1024
    buffer_load_dwordx4 v32, s[8:11], s33 offen lds
    s_add_u32 s33, s33, 32768
    s_mov_b32 m0, s34
    s_add_u32 s34, s34, 1024
    buffer_load_dwordx4 v32, s[8:11], s33 offen lds
    s_add_u32 s33, s33, 32768
    s_mov_b32 m0, s34
    s_add_u32 s34, s34, 1024
    buffer_load_dwordx4 v32, s[8:11], s33 offen lds
    s_add_u32 s33, s33, 32768
    s_mov_b32 m0, s34
    s_add_u32 s34, s34, 1024
    buffer_load_dwordx4 v32, s[8:11], s33 offen lds
    s_add_u32 s33, s33, 32768
    s_mov_b32 m0, s34
    s_add_u32 s34, s34, 1024
    buffer_load_dwordx4 v32, s[8:11], s33 offen lds
    s_add_u32 s33, s33, 32768
    s_mov_b32 m0, s34
    s_add_u32 s34, s34, 1024
    buffer_load_dwordx4 v32, s[8:11], s33 offen lds
    s_add_u32 s33, s33, 32768
    s_mov_b32 m0, s34
    s_add_u32 s34, s34, 1024
    buffer_load_dwordx4 v32, s[8:11], s33 offen lds
    s_add_u32 s33, s33, 32768
    s_mov_b32 m0, s34
    s_add_u32 s34, s34, 1024
    buffer_load_dwordx4 v32, s[8:11], s33 offen lds
    s_add_u32 s33, s33, 32768
    s_mov_b32 m0, s34
    s_add_u32 s34, s34, 1024
    buffer_load_dwordx4 v32, s[8:11], s33 offen lds
    s_add_u32 s33, s33, 32768
    s_mov_b32 m0, s34
    s_add_u32 s34, s34, 1024
    buffer_load_dwordx4 v32, s[8:11], s33 offen lds
    s_add_u32 s33, s33, 32768
    s_mov_b32 m0, s34
    s_add_u32 s34, s34, 1024
    buffer_load_dwordx4 v32, s[8:11], s33 offen lds
    s_add_u32 s33, s33, 32768
    s_mov_b32 m0, s34
    s_add_u32 s34, s34, 1024
    buffer_load_dwordx4 v32, s[8:11], s33 offen lds
    s_add_u32 s33, s33, 32768
    s_mov_b32 m0, s34
    s_add_u32 s34, s34, 1024
    buffer_load_dwordx4 v32, s[8:11], s33 offen lds
    s_add_u32 s33, s33, 32768
    s_waitcnt vmcnt(16)
    ds_read_b64_tr_b16 a[32:33], v86 offset:0
    ds_read_b64_tr_b16 a[34:35], v86 offset:128
    ds_read_b64_tr_b16 a[36:37], v86 offset:2048
    ds_read_b64_tr_b16 a[38:39], v86 offset:2176
    ds_read_b64_tr_b16 a[40:41], v86 offset:32
    ds_read_b64_tr_b16 a[42:43], v86 offset:160
    ds_read_b64_tr_b16 a[44:45], v86 offset:2080
    ds_read_b64_tr_b16 a[46:47], v86 offset:2208
    s_waitcnt lgkmcnt(0)
    ds_read_b64_tr_b16 a[80:81], v86 offset:4096
    ds_read_b64_tr_b16 a[82:83], v86 offset:4224
    ds_read_b64_tr_b16 a[84:85], v86 offset:6144
    ds_read_b64_tr_b16 a[86:87], v86 offset:6272
    ds_read_b64_tr_b16 a[88:89], v86 offset:4128
    ds_read_b64_tr_b16 a[90:91], v86 offset:4256
    ds_read_b64_tr_b16 a[92:93], v86 offset:6176
    ds_read_b64_tr_b16 a[94:95], v86 offset:6304
    s_waitcnt lgkmcnt(0)
    ds_read_b64_tr_b16 a[128:129], v86 offset:8192
    ds_read_b64_tr_b16 a[130:131], v86 offset:8320
    ds_read_b64_tr_b16 a[132:133], v86 offset:10240
    ds_read_b64_tr_b16 a[134:135], v86 offset:10368
    ds_read_b64_tr_b16 a[136:137], v86 offset:8224
    ds_read_b64_tr_b16 a[138:139], v86 offset:8352
    ds_read_b64_tr_b16 a[140:141], v86 offset:10272
    ds_read_b64_tr_b16 a[142:143], v86 offset:10400
    s_waitcnt lgkmcnt(0)
    ds_read_b64_tr_b16 a[176:177], v86 offset:12288
    ds_read_b64_tr_b16 a[178:179], v86 offset:12416
    ds_read_b64_tr_b16 a[180:181], v86 offset:14336
    ds_read_b64_tr_b16 a[182:183], v86 offset:14464
    ds_read_b64_tr_b16 a[184:185], v86 offset:12320
    ds_read_b64_tr_b16 a[186:187], v86 offset:12448
    ds_read_b64_tr_b16 a[188:189], v86 offset:14368
    ds_read_b64_tr_b16 a[190:191], v86 offset:14496
    s_waitcnt lgkmcnt(0)
    s_waitcnt vmcnt(0)
    s_barrier
    ds_read_b64_tr_b16 a[192:193], v88 offset:0
    ds_read_b64_tr_b16 a[194:195], v88 offset:128
    ds_read_b64_tr_b16 a[196:197], v88 offset:2048
    ds_read_b64_tr_b16 a[198:199], v88 offset:2176
    ds_read_b64_tr_b16 a[200:201], v88 offset:4096
    ds_read_b64_tr_b16 a[202:203], v88 offset:4224
    ds_read_b64_tr_b16 a[204:205], v88 offset:6144
    ds_read_b64_tr_b16 a[206:207], v88 offset:6272
    s_waitcnt lgkmcnt(0)
    ds_read_b64_tr_b16 a[208:209], v88 offset:8192
    ds_read_b64_tr_b16 a[210:211], v88 offset:8320
    ds_read_b64_tr_b16 a[212:213], v88 offset:10240
    ds_read_b64_tr_b16 a[214:215], v88 offset:10368
    ds_read_b64_tr_b16 a[216:217], v88 offset:12288
    ds_read_b64_tr_b16 a[218:219], v88 offset:12416
    ds_read_b64_tr_b16 a[220:221], v88 offset:14336
    ds_read_b64_tr_b16 a[222:223], v88 offset:14464
    s_waitcnt lgkmcnt(0)
    ds_read_b64_tr_b16 a[224:225], v88 offset:16384
    ds_read_b64_tr_b16 a[226:227], v88 offset:16512
    ds_read_b64_tr_b16 a[228:229], v88 offset:18432
    ds_read_b64_tr_b16 a[230:231], v88 offset:18560
    ds_read_b64_tr_b16 a[232:233], v88 offset:20480
    ds_read_b64_tr_b16 a[234:235], v88 offset:20608
    ds_read_b64_tr_b16 a[236:237], v88 offset:22528
    ds_read_b64_tr_b16 a[238:239], v88 offset:22656
    s_waitcnt lgkmcnt(0)
    ds_read_b64_tr_b16 a[240:241], v88 offset:24576
    ds_read_b64_tr_b16 a[242:243], v88 offset:24704
    ds_read_b64_tr_b16 a[244:245], v88 offset:26624
    ds_read_b64_tr_b16 a[246:247], v88 offset:26752
    ds_read_b64_tr_b16 a[248:249], v88 offset:28672
    ds_read_b64_tr_b16 a[250:251], v88 offset:28800
    ds_read_b64_tr_b16 a[252:253], v88 offset:30720
    ds_read_b64_tr_b16 a[254:255], v88 offset:30848
    s_waitcnt lgkmcnt(0)
    ds_read_b64_tr_b16 v[180:181], v88 offset:32768
    ds_read_b64_tr_b16 v[182:183], v88 offset:32896
    ds_read_b64_tr_b16 v[184:185], v88 offset:34816
    ds_read_b64_tr_b16 v[186:187], v88 offset:34944
    ds_read_b64_tr_b16 v[188:189], v88 offset:36864
    ds_read_b64_tr_b16 v[190:191], v88 offset:36992
    ds_read_b64_tr_b16 v[192:193], v88 offset:38912
    ds_read_b64_tr_b16 v[194:195], v88 offset:39040
    s_waitcnt lgkmcnt(0)
    ds_read_b64_tr_b16 v[196:197], v88 offset:40960
    ds_read_b64_tr_b16 v[198:199], v88 offset:41088
    ds_read_b64_tr_b16 v[200:201], v88 offset:43008
    ds_read_b64_tr_b16 v[202:203], v88 offset:43136
    ds_read_b64_tr_b16 v[204:205], v88 offset:45056
    ds_read_b64_tr_b16 v[206:207], v88 offset:45184
    ds_read_b64_tr_b16 v[208:209], v88 offset:47104
    ds_read_b64_tr_b16 v[210:211], v88 offset:47232
    s_waitcnt lgkmcnt(0)
    ds_read_b64_tr_b16 v[212:213], v88 offset:49152
    ds_read_b64_tr_b16 v[214:215], v88 offset:49280
    ds_read_b64_tr_b16 v[216:217], v88 offset:51200
    ds_read_b64_tr_b16 v[218:219], v88 offset:51328
    ds_read_b64_tr_b16 v[220:221], v88 offset:53248
    ds_read_b64_tr_b16 v[222:223], v88 offset:53376
    ds_read_b64_tr_b16 v[224:225], v88 offset:55296
    ds_read_b64_tr_b16 v[226:227], v88 offset:55424
    s_waitcnt lgkmcnt(0)
    ds_read_b64_tr_b16 v[228:229], v88 offset:57344
    ds_read_b64_tr_b16 v[230:231], v88 offset:57472
    ds_read_b64_tr_b16 v[232:233], v88 offset:59392
    ds_read_b64_tr_b16 v[234:235], v88 offset:59520
    ds_read_b64_tr_b16 v[236:237], v88 offset:61440
    ds_read_b64_tr_b16 v[238:239], v88 offset:61568
    ds_read_b64_tr_b16 v[240:241], v88 offset:63488
    ds_read_b64_tr_b16 v[242:243], v88 offset:63616
    s_waitcnt lgkmcnt(0)
    s_barrier
    s_mov_b32 s3, 0
L_rdy_15:
    buffer_load_dwordx2 v[90:91], off, s[12:15], s22 sc1
    s_add_u32 s3, s3, 1
    s_cmp_gt_u32 s3, 400000
    s_cbranch_scc1 L_exit
    s_waitcnt vmcnt(0)
    v_readfirstlane_b32 s24, v90
    v_readfirstlane_b32 s25, v91
    s_and_b32 vcc_lo, s24, 0xffff
    s_cmp_lt_u32 vcc_lo, 256
    s_cbranch_scc1 L_rdy_15
    s_lshr_b32 vcc_lo, s24, 16
    s_cbranch_scc1 L_general
    s_mov_b32 s33, 63
    s_lshr_b32 s34, s33, 3
    s_lshr_b32 s34, s19, s34
    s_and_b32 s34, s34, 1
    s_lshl_b32 s34, s34, 13
    s_lshl_b32 s46, s33, 18
    s_add_u32 s46, s46, s34
    s_add_u32 s46, s46, 134217728
    s_add_u32 s47, s47, s46
    s_add_u32 s48, s47, 4
    s_add_u32 s49, s47, 8
    s_mov_b32 s26, 0
    s_mov_b32 s27, s41
    s_lshl_b32 s33, s16, 5
    s_add_u32 s33, s33, s17
    s_lshl_b32 s31, s33, 11
    s_add_u32 s31, s31, 16777216
    s_lshl_b32 s32, s33, 9
    s_add_u32 s32, s32, 4194304
    s_mov_b32 s36, 0
    s_mov_b32 s64, 0
    s_mov_b32 s65, 0
    s_mov_b32 s66, 0
    s_mov_b32 s67, 0
    s_cmp_eq_u32 s18, 1
    s_cbranch_scc1 L_cg_w1
    s_cmp_eq_u32 s18, 2
    s_cbranch_scc1 L_cg_w2
    s_cmp_eq_u32 s18, 3
    s_cbranch_scc1 L_cg_w3
L_cg_w0:
    v_mov_b32 v213, 0
    v_mov_b32 v215, 0
    v_mov_b32 v217, 0
    s_mov_b32 s52, 0
    s_mov_b32 s53, 0
L_cg_w0_kv0:
    s_min_u32 s33, s52, s53
    s_cmp_gt_u32 s33, s26
    s_cbranch_scc1 L_cg_w0_kv0_ok
    s_load_dword s52, s[4:5], s50 glc
    s_load_dword s53, s[4:5], s51 glc
    s_add_u32 s36, s36, 1
    s_cmp_gt_u32 s36, 400000
    s_cbranch_scc1 L_done
    s_waitcnt lgkmcnt(0)
    s_branch L_cg_w0_kv0
L_cg_w0_kv0_ok:
    s_mov_b32 m0, 0
    s_add_u32 s33, s31, 16775168
    buffer_load_dwordx4 v2, s[4:7], s31 offen sc1 lds
    buffer_load_dwordx4 v2, s[4:7], s31 offen offset:1024 sc1 lds
    buffer_load_dwordx4 v2, s[4:7], s33 offen offset:2048 sc1 lds
    buffer_load_dwordx4 v2, s[4:7], s33 offen offset:3072 sc1 lds
    v_mov_b32 v58, 0
    v_mov_b32 v59, 0
    v_mov_b32 v60, 0
    v_mov_b32 v61, 0
    v_mov_b32 v62, 0
    v_mov_b32 v63, 0
    v_mov_b32 v64, 0
    v_mov_b32 v65, 0
    v_mov_b32 v66, 0
    v_mov_b32 v67, 0
    v_mov_b32 v68, 0
    v_mov_b32 v69, 0
    v_mov_b32 v70, 0
    v_mov_b32 v71, 0
    v_mov_b32 v72, 0
    v_mov_b32 v73, 0
    v_mov_b32 v74, 0
    v_mov_b32 v75, 0
    v_mov_b32 v76, 0
    v_mov_b32 v77, 0
    v_mov_b32 v78, 0
    v_mov_b32 v79, 0
    v_mov_b32 v80, 0
    v_mov_b32 v81, 0
    s_waitcnt vmcnt(0)
    s_barrier
    buffer_load_dwordx4 v[96:99], v6, s[4:7], s27 offen offset:0 sc1
    s_nop 3
    buffer_load_dwordx4 v[100:103], v6, s[4:7], s27 offen offset:1024 sc1
    s_nop 3
    buffer_load_dwordx4 v[104:107], v6, s[4:7], s27 offen offset:2048 sc1
    s_nop 3
    buffer_load_dwordx4 v[108:111], v6, s[4:7], s27 offen offset:3072 sc1
L_cg_w0_loop:
    s_and_b32 s33, s26, 3
    s_add_u32 s28, s27, 262144
    s_lshl_b32 s34, s33, 16
    s_add_u32 s29, s42, s34
    v_add_u32 v30, 1, v30
    ds_read_b128 v[180:183], v17 offset:0
    ds_read_b128 v[184:187], v17 offset:64
    ds_read_b128 v[188:191], v18 offset:2048
    ds_read_b128 v[192:195], v18 offset:2304
    s_waitcnt vmcnt(3)
    v_smfmac_f32_16x16x64_bf16 v[58:61], v[96:99], a[0:7], v5
    v_min3_i32 v36, v96, v97, v98
    v_smfmac_f32_16x16x64_bf16 v[62:65], v[96:99], a[8:15], v5
    v_min_i32 v36, v36, v99
    v_smfmac_f32_16x16x64_bf16 v[66:69], v[96:99], a[16:23], v5
    v_cmp_eq_u32 vcc, s43, v36
    v_smfmac_f32_16x16x64_bf16 v[70:73], v[96:99], a[24:31], v5
    s_cbranch_vccnz L_cg_w0_din0
    s_waitcnt vmcnt(2)
    v_smfmac_f32_16x16x64_bf16 v[58:61], v[100:103], a[48:55], v5
    v_min3_i32 v36, v100, v101, v102
    v_smfmac_f32_16x16x64_bf16 v[62:65], v[100:103], a[56:63], v5
    v_min_i32 v36, v36, v103
    v_smfmac_f32_16x16x64_bf16 v[66:69], v[100:103], a[64:71], v5
    v_cmp_eq_u32 vcc, s43, v36
    v_smfmac_f32_16x16x64_bf16 v[70:73], v[100:103], a[72:79], v5
    s_cbranch_vccnz L_cg_w0_din1
    s_waitcnt vmcnt(1)
    v_smfmac_f32_16x16x64_bf16 v[58:61], v[104:107], a[96:103], v5
    v_min3_i32 v36, v104, v105, v106
    v_smfmac_f32_16x16x64_bf16 v[62:65], v[104:107], a[104:111], v5
    v_min_i32 v36, v36, v107
    v_smfmac_f32_16x16x64_bf16 v[66:69], v[104:107], a[112:119], v5
    v_cmp_eq_u32 vcc, s43, v36
    v_smfmac_f32_16x16x64_bf16 v[70:73], v[104:107], a[120:127], v5
    s_cbranch_vccnz L_cg_w0_din2
    s_waitcnt vmcnt(0)
    v_smfmac_f32_16x16x64_bf16 v[58:61], v[108:111], a[144:151], v5
    v_min3_i32 v36, v108, v109, v110
    v_smfmac_f32_16x16x64_bf16 v[62:65], v[108:111], a[152:159], v5
    v_min_i32 v36, v36, v111
    v_smfmac_f32_16x16x64_bf16 v[66:69], v[108:111], a[160:167], v5
    v_cmp_eq_u32 vcc, s43, v36
    v_smfmac_f32_16x16x64_bf16 v[70:73], v[108:111], a[168:175], v5
    s_cbranch_vccnz L_cg_w0_din3
L_cg_w0_ddone:
    s_nop 0
    v_pk_add_f32 v[86:87], v[58:59], v[60:61]
    ds_write2_b32 v7, v86, v87 offset0:0 offset1:36
    v_pk_add_f32 v[88:89], v[62:63], v[64:65]
    ds_write2_b32 v7, v88, v89 offset0:16 offset1:52
    v_pk_add_f32 v[90:91], v[66:67], v[68:69]
    ds_write2_b32 v8, v90, v91 offset0:0 offset1:36
    v_pk_add_f32 v[92:93], v[70:71], v[72:73]
    ds_write2_b32 v8, v92, v93 offset0:16 offset1:52
    v_smfmac_f32_16x16x64_bf16 v[74:77], v[96:99], a[32:39], v5
    v_smfmac_f32_16x16x64_bf16 v[78:81], v[96:99], a[40:47], v5
    v_smfmac_f32_16x16x64_bf16 v[74:77], v[100:103], a[80:87], v5
    v_smfmac_f32_16x16x64_bf16 v[78:81], v[100:103], a[88:95], v5
    s_waitcnt lgkmcnt(0)
    s_barrier
    ds_read_b128 v[116:119], v9 offset:4096
    ds_read_b128 v[120:123], v9 offset:4112
    ds_read_b128 v[124:127], v9 offset:6400
    ds_read_b128 v[128:131], v9 offset:6416
    ds_read_b128 v[132:135], v9 offset:8704
    ds_read_b128 v[136:139], v9 offset:8720
    ds_read_b128 v[140:143], v9 offset:11008
    ds_read_b128 v[144:147], v9 offset:11024
    v_smfmac_f32_16x16x64_bf16 v[74:77], v[104:107], a[128:135], v5
    s_waitcnt lgkmcnt(6)
    v_pk_mul_f32 v[116:117], v[116:117], v[94:95] op_sel_hi:[1,0]
    v_pk_mul_f32 v[118:119], v[118:119], v[94:95] op_sel_hi:[1,0]
    v_pk_mul_f32 v[120:121], v[120:121], v[94:95] op_sel_hi:[1,0]
    v_pk_mul_f32 v[122:123], v[122:123], v[94:95] op_sel_hi:[1,0]
    s_waitcnt lgkmcnt(4)
    v_pk_fma_f32 v[116:117], v[124:125], v[94:95], v[116:117] op_sel_hi:[1,0,1]
    v_pk_fma_f32 v[118:119], v[126:127], v[94:95], v[118:119] op_sel_hi:[1,0,1]
    v_pk_fma_f32 v[120:121], v[128:129], v[94:95], v[120:121] op_sel_hi:[1,0,1]
    v_pk_fma_f32 v[122:123], v[130:131], v[94:95], v[122:123] op_sel_hi:[1,0,1]
    s_waitcnt lgkmcnt(2)
    v_pk_fma_f32 v[116:117], v[132:133], v[94:95], v[116:117] op_sel_hi:[1,0,1]
    v_pk_fma_f32 v[118:119], v[134:135], v[94:95], v[118:119] op_sel_hi:[1,0,1]
    v_pk_fma_f32 v[120:121], v[136:137], v[94:95], v[120:121] op_sel_hi:[1,0,1]
    v_pk_fma_f32 v[122:123], v[138:139], v[94:95], v[122:123] op_sel_hi:[1,0,1]
    s_waitcnt lgkmcnt(0)
    v_pk_fma_f32 v[116:117], v[140:141], v[94:95], v[116:117] op_sel_hi:[1,0,1]
    v_pk_fma_f32 v[118:119], v[142:143], v[94:95], v[118:119] op_sel_hi:[1,0,1]
    v_pk_fma_f32 v[120:121], v[144:145], v[94:95], v[120:121] op_sel_hi:[1,0,1]
    v_pk_fma_f32 v[122:123], v[146:147], v[94:95], v[122:123] op_sel_hi:[1,0,1]
    v_cvt_pk_bf16_f32 v196, v116, v117
    v_cvt_pk_bf16_f32 v197, v118, v119
    v_cvt_pk_bf16_f32 v198, v120, v121
    v_cvt_pk_bf16_f32 v199, v122, v123
    s_nop 1
    v_mfma_f32_16x16x32_bf16 v[200:203], v[180:183], v[196:199], 0
    v_mfma_f32_16x16x32_bf16 v[204:207], v[184:187], v[196:199], 0
    v_mfma_f32_16x16x32_bf16 v[208:211], v[196:199], v[196:199], 0
    s_nop 5
    buffer_store_dwordx4 v[200:203], v11, s[4:7], s29 offen sc1
    buffer_store_dwordx4 v[204:207], v11, s[4:7], s29 offen offset:128 sc1
    buffer_store_dwordx4 v[208:211], v12, s[4:7], s29 offen sc1
    v_smfmac_f32_16x16x64_bf16 v[78:81], v[104:107], a[136:143], v5
    v_smfmac_f32_16x16x64_bf16 v[74:77], v[108:111], a[176:183], v5
    v_smfmac_f32_16x16x64_bf16 v[78:81], v[108:111], a[184:191], v5
    s_barrier
    buffer_load_dwordx4 v[116:119], v47, s[4:7], s29 offen sc1
    buffer_load_dwordx4 v[120:123], v48, s[4:7], s29 offen sc1
    buffer_load_dwordx4 v[124:127], v49, s[4:7], s29 offen sc1
    buffer_load_dword v128, v13, s[4:7], s29 offen offset:0 sc1
    buffer_load_dword v129, v13, s[4:7], s29 offen offset:1280 sc1
    buffer_load_dword v130, v13, s[4:7], s29 offen offset:2560 sc1
    buffer_load_dword v131, v13, s[4:7], s29 offen offset:3840 sc1
    ds_read_b128 v[132:135], v2 offset:15360
    ds_read_b128 v[136:139], v2 offset:16384
    ds_read_b128 v[140:143], v2 offset:17408
    v_pk_add_f32 v[86:87], v[74:75], v[76:77]
    v_pk_add_f32 v[88:89], v[78:79], v[80:81]
    v_mov_b32_dpp v200, v204 row_ror:8 row_mask:0xf bank_mask:0xc
    v_mov_b32_dpp v201, v205 row_ror:8 row_mask:0xf bank_mask:0xc
    v_mov_b32_dpp v202, v206 row_ror:8 row_mask:0xf bank_mask:0xc
    v_mov_b32_dpp v203, v207 row_ror:8 row_mask:0xf bank_mask:0xc
    s_waitcnt lgkmcnt(2)
    v_pk_add_f32 v[86:87], v[86:87], v[132:133]
    v_pk_add_f32 v[88:89], v[88:89], v[134:135]
    s_waitcnt lgkmcnt(1)
    v_pk_add_f32 v[86:87], v[86:87], v[136:137]
    v_pk_add_f32 v[88:89], v[88:89], v[138:139]
    s_waitcnt lgkmcnt(0)
    v_pk_add_f32 v[86:87], v[86:87], v[140:141]
    v_pk_add_f32 v[88:89], v[88:89], v[142:143]
    v_cvt_pk_bf16_f32 v214, v86, v87
    v_cvt_pk_bf16_f32 v216, v88, v89
    s_cmp_eq_u32 s26, 63
    s_cbranch_scc1 L_cg_w0_done
L_cg_w0_atry:
    s_waitcnt vmcnt(6)
    v_pk_add_f32 v[238:239], v[200:201], v[116:117]
    v_pk_add_f32 v[240:241], v[202:203], v[118:119]
    s_waitcnt vmcnt(5)
    v_pk_add_f32 v[238:239], v[238:239], v[120:121]
    v_pk_add_f32 v[240:241], v[240:241], v[122:123]
    s_waitcnt vmcnt(4)
    v_pk_add_f32 v[238:239], v[238:239], v[124:125]
    v_pk_add_f32 v[240:241], v[240:241], v[126:127]
    v_maximum3_f32 v36, |v238|, |v239|, |v240|
    s_waitcnt vmcnt(0)
    buffer_store_dword v30, v25, s[4:7], s45 offen offset:0 sc1
    v_pk_add_f32 v[242:243], v[128:129], v[130:131]
    v_add_f32 v242, v242, v243
    v_maximum3_f32 v36, v36, |v241|, |v242|
    v_cmp_ngt_f32 vcc, s40, v36
    v_exp_f32 v222, v238
    v_exp_f32 v223, v239
    v_exp_f32 v224, v240
    v_exp_f32 v225, v241
    v_exp_f32 v144, v242
    s_cbranch_vccnz L_cg_w0_abad
L_cg_w0_agood:
    v_cvt_pk_bf16_f32 v218, v222, v223
    v_cvt_pk_bf16_f32 v219, v224, v225
    v_mov_b32_dpp v146, v144 row_ror:8 row_mask:0xf bank_mask:0xf
    v_mov_b32_dpp v220, v218 row_ror:8 row_mask:0xf bank_mask:0xf
    v_mov_b32_dpp v221, v219 row_ror:8 row_mask:0xf bank_mask:0xf
    v_cvt_pk_bf16_f32 v212, v144, v146
    v_pk_add_f32 v[222:223], v[222:223], v[224:225]
    v_mfma_f32_16x16x32_bf16 v[226:229], v[188:191], v[218:221], 0
    v_add_f32 v145, v222, v223
    v_add_f32 v145, v145, v144
    v_mfma_f32_16x16x32_bf16 v[230:233], v[192:195], v[218:221], 0
    s_nop 0
    v_add_f32_dpp v146, v145, v145 row_ror:8 row_mask:0xf bank_mask:0xf
    v_add_f32_dpp v147, v145, v145 row_ror:8 row_mask:0xf bank_mask:0xf
    v_mfma_f32_16x16x16_bf16 v[226:229], v[214:215], v[212:213], v[226:229]
    s_nop 0
    v_permlane16_swap_b32 v146, v147
    v_mfma_f32_16x16x16_bf16 v[230:233], v[216:217], v[212:213], v[230:233]
    v_add_f32 v145, v146, v147
    v_add_f32 v146, v146, v147
    s_nop 1
    v_permlane32_swap_b32 v145, v146
    s_nop 0
    v_add_f32 v145, v145, v146
    v_rcp_f32 v222, v145
    s_mov_b32 m0, 20480
    v_pk_mul_f32 v[226:227], v[226:227], v[222:223] op_sel_hi:[1,0]
    v_pk_mul_f32 v[228:229], v[228:229], v[222:223] op_sel_hi:[1,0]
    v_pk_mul_f32 v[230:231], v[230:231], v[222:223] op_sel_hi:[1,0]
    v_pk_mul_f32 v[232:233], v[232:233], v[222:223] op_sel_hi:[1,0]
    v_cvt_pk_bf16_f32 v234, v226, v227
    v_cvt_pk_bf16_f32 v235, v228, v229
    v_cvt_pk_bf16_f32 v236, v230, v231
    v_cvt_pk_bf16_f32 v237, v232, v233
    buffer_store_dwordx4 v[234:237], v14, s[4:7], s28 offen sc1
    s_barrier
    buffer_load_dwordx4 v6, s[4:7], s28 offen offset:0 sc1 lds
    s_nop 3
    buffer_load_dwordx4 v6, s[4:7], s28 offen offset:1024 sc1 lds
    s_nop 3
    buffer_load_dwordx4 v6, s[4:7], s28 offen offset:2048 sc1 lds
    s_nop 3
    buffer_load_dwordx4 v6, s[4:7], s28 offen offset:3072 sc1 lds
    s_add_u32 s26, s26, 1
    s_and_b32 s35, s26, 3
    s_lshl_b32 s35, s35, 14
    s_add_u32 s27, s41, s35
    v_mov_b32 v58, 0
    v_mov_b32 v59, 0
    v_mov_b32 v60, 0
    v_mov_b32 v61, 0
    v_mov_b32 v62, 0
    v_mov_b32 v63, 0
    v_mov_b32 v64, 0
    v_mov_b32 v65, 0
    v_mov_b32 v66, 0
    v_mov_b32 v67, 0
    v_mov_b32 v68, 0
    v_mov_b32 v69, 0
    v_mov_b32 v70, 0
    v_mov_b32 v71, 0
    v_mov_b32 v72, 0
    v_mov_b32 v73, 0
    v_mov_b32 v74, 0
    v_mov_b32 v75, 0
    v_mov_b32 v76, 0
    v_mov_b32 v77, 0
    v_mov_b32 v78, 0
    v_mov_b32 v79, 0
    v_mov_b32 v80, 0
    v_mov_b32 v81, 0
    s_add_u32 s31, s31, 0x40000
    v_subrev_u32 v43, 1, v30
    s_min_u32 s33, s52, s53
    s_add_u32 s34, s26, 2
    s_min_u32 s34, s34, 63
    s_cmp_gt_u32 s33, s34
    s_cbranch_scc1 L_cg_w0_kvfresh
    s_load_dword s52, s[4:5], s50 glc
    s_load_dword s53, s[4:5], s51 glc
L_cg_w0_kvfresh:
    s_waitcnt vmcnt(3)
    s_barrier
    s_waitcnt vmcnt(2)
    s_barrier
    buffer_store_dword v30, v29, s[4:7], s46 offen sc1
    s_waitcnt vmcnt(2)
    s_barrier
    s_waitcnt vmcnt(1)
    s_barrier
L_cg_w0_kv:
    s_min_u32 s33, s52, s53
    s_cmp_gt_u32 s33, s26
    s_cbranch_scc1 L_cg_w0_kv_ok
    s_load_dword s52, s[4:5], s50 glc
    s_load_dword s53, s[4:5], s51 glc
    s_add_u32 s36, s36, 1
    s_cmp_gt_u32 s36, 400000
    s_cbranch_scc1 L_done
    s_waitcnt lgkmcnt(0)
    s_branch L_cg_w0_kv
L_cg_w0_kv_ok:
    s_mov_b32 m0, 0
    s_add_u32 s33, s31, 16775168
    buffer_load_dwordx4 v2, s[4:7], s31 offen sc1 lds
    buffer_load_dwordx4 v2, s[4:7], s31 offen offset:1024 sc1 lds
    buffer_load_dwordx4 v2, s[4:7], s33 offen offset:2048 sc1 lds
    buffer_load_dwordx4 v2, s[4:7], s33 offen offset:3072 sc1 lds
    s_add_u32 s33, s32, 4194304
    buffer_store_dwordx4 v[196:199], v19, s[4:7], s32 offen sc1
    buffer_store_dword v214, v20, s[4:7], s33 offen sc1
    buffer_store_dword v216, v20, s[4:7], s33 offen offset:256 sc1
    buffer_store_dword v43, v42, s[4:7], 0 offen sc1
    s_add_u32 s32, s32, 0x10000
L_cg_w0_bjoin:
    s_barrier
    ds_read_b32 v32, v37 offset:19456
    s_waitcnt lgkmcnt(0)
    v_cmp_ne_u32 vcc, 0, v32
    s_cbranch_vccnz L_cg_w0_bretry
    s_waitcnt vmcnt(0)
    s_barrier
    buffer_load_dwordx4 v[96:99], v6, s[4:7], s27 offen offset:0 sc1
    s_nop 3
    buffer_load_dwordx4 v[100:103], v6, s[4:7], s27 offen offset:1024 sc1
    s_nop 3
    buffer_load_dwordx4 v[104:107], v6, s[4:7], s27 offen offset:2048 sc1
    s_nop 3
    buffer_load_dwordx4 v[108:111], v6, s[4:7], s27 offen offset:3072 sc1
    s_branch L_cg_w0_loop
L_cg_w0_din0:
    s_mov_b64 s[56:57], -1
    s_mov_b64 s[58:59], -1
    s_mov_b64 s[60:61], -1
    s_branch L_cg_w0_dre0
L_cg_w0_din1:
    buffer_load_dword v38, v31, s[4:7], 0 offen
    s_mov_b64 s[54:55], 0
    s_mov_b64 s[58:59], -1
    s_mov_b64 s[60:61], -1
    s_branch L_cg_w0_dre1
L_cg_w0_din2:
    buffer_load_dword v38, v31, s[4:7], 0 offen
    buffer_load_dword v38, v31, s[4:7], 0 offen
    s_mov_b64 s[54:55], 0
    s_mov_b64 s[56:57], 0
    s_mov_b64 s[60:61], -1
    s_branch L_cg_w0_dre2
L_cg_w0_din3:
    buffer_load_dword v38, v31, s[4:7], 0 offen
    buffer_load_dword v38, v31, s[4:7], 0 offen
    buffer_load_dword v38, v31, s[4:7], 0 offen
    s_mov_b64 s[54:55], 0
    s_mov_b64 s[56:57], 0
    s_mov_b64 s[58:59], 0
    s_branch L_cg_w0_dre3
L_cg_w0_dloop:
    s_cmp_eq_u64 s[54:55], 0
    s_cbranch_scc1 L_cg_w0_dsk0
    s_waitcnt vmcnt(3)
    v_cndmask_b32 v112, 0, v96, s[54:55]
    v_cndmask_b32 v113, 0, v97, s[54:55]
    v_cndmask_b32 v114, 0, v98, s[54:55]
    v_cndmask_b32 v115, 0, v99, s[54:55]
    s_or_b64 s[62:63], s[56:57], s[58:59]
    s_or_b64 s[62:63], s[62:63], s[60:61]
    v_smfmac_f32_16x16x64_bf16 v[58:61], v[112:115], a[0:7], v5
    v_min3_i32 v36, v112, v113, v114
    v_smfmac_f32_16x16x64_bf16 v[62:65], v[112:115], a[8:15], v5
    v_min_i32 v36, v36, v115
    v_smfmac_f32_16x16x64_bf16 v[66:69], v[112:115], a[16:23], v5
    v_cmp_eq_u32 vcc, s43, v36
    v_smfmac_f32_16x16x64_bf16 v[70:73], v[112:115], a[24:31], v5
    s_or_b64 s[62:63], s[62:63], vcc
    s_cbranch_scc0 L_cg_w0_ddone
    s_cbranch_vccz L_cg_w0_dok0
L_cg_w0_dre0:
    s_mov_b64 exec, vcc
    buffer_load_dwordx4 v[96:99], v6, s[4:7], s27 offen offset:0 sc1
    s_mov_b64 exec, -1
    s_mov_b64 s[54:55], vcc
    s_branch L_cg_w0_dnx0
L_cg_w0_dok0:
    s_mov_b64 s[54:55], 0
L_cg_w0_dsk0:
    buffer_load_dword v38, v31, s[4:7], 0 offen
L_cg_w0_dnx0:
    s_cmp_eq_u64 s[56:57], 0
    s_cbranch_scc1 L_cg_w0_dsk1
    s_waitcnt vmcnt(3)
    v_cndmask_b32 v112, 0, v100, s[56:57]
    v_cndmask_b32 v113, 0, v101, s[56:57]
    v_cndmask_b32 v114, 0, v102, s[56:57]
    v_cndmask_b32 v115, 0, v103, s[56:57]
    s_or_b64 s[62:63], s[54:55], s[58:59]
    s_or_b64 s[62:63], s[62:63], s[60:61]
    v_smfmac_f32_16x16x64_bf16 v[58:61], v[112:115], a[48:55], v5
    v_min3_i32 v36, v112, v113, v114
    v_smfmac_f32_16x16x64_bf16 v[62:65], v[112:115], a[56:63], v5
    v_min_i32 v36, v36, v115
    v_smfmac_f32_16x16x64_bf16 v[66:69], v[112:115], a[64:71], v5
    v_cmp_eq_u32 vcc, s43, v36
    v_smfmac_f32_16x16x64_bf16 v[70:73], v[112:115], a[72:79], v5
    s_or_b64 s[62:63], s[62:63], vcc
    s_cbranch_scc0 L_cg_w0_ddone
    s_cbranch_vccz L_cg_w0_dok1
L_cg_w0_dre1:
    s_mov_b64 exec, vcc
    buffer_load_dwordx4 v[100:103], v6, s[4:7], s27 offen offset:1024 sc1
    s_mov_b64 exec, -1
    s_mov_b64 s[56:57], vcc
    s_branch L_cg_w0_dnx1
L_cg_w0_dok1:
    s_mov_b64 s[56:57], 0
L_cg_w0_dsk1:
    buffer_load_dword v38, v31, s[4:7], 0 offen
L_cg_w0_dnx1:
    s_cmp_eq_u64 s[58:59], 0
    s_cbranch_scc1 L_cg_w0_dsk2
    s_waitcnt vmcnt(3)
    v_cndmask_b32 v112, 0, v104, s[58:59]
    v_cndmask_b32 v113, 0, v105, s[58:59]
    v_cndmask_b32 v114, 0, v106, s[58:59]
    v_cndmask_b32 v115, 0, v107, s[58:59]
    s_or_b64 s[62:63], s[54:55], s[56:57]
    s_or_b64 s[62:63], s[62:63], s[60:61]
    v_smfmac_f32_16x16x64_bf16 v[58:61], v[112:115], a[96:103], v5
    v_min3_i32 v36, v112, v113, v114
    v_smfmac_f32_16x16x64_bf16 v[62:65], v[112:115], a[104:111], v5
    v_min_i32 v36, v36, v115
    v_smfmac_f32_16x16x64_bf16 v[66:69], v[112:115], a[112:119], v5
    v_cmp_eq_u32 vcc, s43, v36
    v_smfmac_f32_16x16x64_bf16 v[70:73], v[112:115], a[120:127], v5
    s_or_b64 s[62:63], s[62:63], vcc
    s_cbranch_scc0 L_cg_w0_ddone
    s_cbranch_vccz L_cg_w0_dok2
L_cg_w0_dre2:
    s_mov_b64 exec, vcc
    buffer_load_dwordx4 v[104:107], v6, s[4:7], s27 offen offset:2048 sc1
    s_mov_b64 exec, -1
    s_mov_b64 s[58:59], vcc
    s_branch L_cg_w0_dnx2
L_cg_w0_dok2:
    s_mov_b64 s[58:59], 0
L_cg_w0_dsk2:
    buffer_load_dword v38, v31, s[4:7], 0 offen
L_cg_w0_dnx2:
    s_cmp_eq_u64 s[60:61], 0
    s_cbranch_scc1 L_cg_w0_dsk3
    s_waitcnt vmcnt(3)
    v_cndmask_b32 v112, 0, v108, s[60:61]
    v_cndmask_b32 v113, 0, v109, s[60:61]
    v_cndmask_b32 v114, 0, v110, s[60:61]
    v_cndmask_b32 v115, 0, v111, s[60:61]
    s_or_b64 s[62:63], s[54:55], s[56:57]
    s_or_b64 s[62:63], s[62:63], s[58:59]
    v_smfmac_f32_16x16x64_bf16 v[58:61], v[112:115], a[144:151], v5
    v_min3_i32 v36, v112, v113, v114
    v_smfmac_f32_16x16x64_bf16 v[62:65], v[112:115], a[152:159], v5
    v_min_i32 v36, v36, v115
    v_smfmac_f32_16x16x64_bf16 v[66:69], v[112:115], a[160:167], v5
    v_cmp_eq_u32 vcc, s43, v36
    v_smfmac_f32_16x16x64_bf16 v[70:73], v[112:115], a[168:175], v5
    s_or_b64 s[62:63], s[62:63], vcc
    s_cbranch_scc0 L_cg_w0_ddone
    s_cbranch_vccz L_cg_w0_dok3
L_cg_w0_dre3:
    s_mov_b64 exec, vcc
    buffer_load_dwordx4 v[108:111], v6, s[4:7], s27 offen offset:3072 sc1
    s_mov_b64 exec, -1
    s_mov_b64 s[60:61], vcc
    s_branch L_cg_w0_dnx3
L_cg_w0_dok3:
    s_mov_b64 s[60:61], 0
L_cg_w0_dsk3:
    buffer_load_dword v38, v31, s[4:7], 0 offen
L_cg_w0_dnx3:
    s_add_u32 s36, s36, 1
    s_cmp_lt_u32 s36, 400000
    s_cbranch_scc1 L_cg_w0_dloop
    s_branch L_done
L_cg_w0_bretry:
    s_add_u32 s36, s36, 1
    s_cmp_gt_u32 s36, 400000
    s_cbranch_scc1 L_done
    s_mov_b32 m0, 20480
    s_nop 0
    buffer_load_dwordx4 v6, s[4:7], s28 offen offset:0 sc1 lds
    s_nop 3
    buffer_load_dwordx4 v6, s[4:7], s28 offen offset:1024 sc1 lds
    s_nop 3
    buffer_load_dwordx4 v6, s[4:7], s28 offen offset:2048 sc1 lds
    s_nop 3
    buffer_load_dwordx4 v6, s[4:7], s28 offen offset:3072 sc1 lds
    s_waitcnt vmcnt(3)
    s_barrier
    s_waitcnt vmcnt(2)
    s_barrier
    s_waitcnt vmcnt(1)
    s_barrier
    s_waitcnt vmcnt(0)
    s_barrier
    s_branch L_cg_w0_bjoin
L_cg_w0_abad:
    v_max3_u32 v36, v128, v129, v130
    v_max_u32 v36, v36, v131
    v_max3_u32 v36, v36, v116, v117
    v_max3_u32 v36, v36, v118, v119
    v_max3_u32 v36, v36, v120, v121
    v_max3_u32 v36, v36, v122, v123
    v_max3_u32 v36, v36, v124, v125
    v_max3_u32 v36, v36, v126, v127
    v_cmp_eq_u32 vcc, -1, v36
    buffer_load_dwordx4 v[116:119], v47, s[4:7], s29 offen sc1
    buffer_load_dwordx4 v[120:123], v48, s[4:7], s29 offen sc1
    buffer_load_dwordx4 v[124:127], v49, s[4:7], s29 offen sc1
    buffer_load_dword v128, v13, s[4:7], s29 offen offset:0 sc1
    buffer_load_dword v129, v13, s[4:7], s29 offen offset:1280 sc1
    buffer_load_dword v130, v13, s[4:7], s29 offen offset:2560 sc1
    buffer_load_dword v131, v13, s[4:7], s29 offen offset:3840 sc1
    s_add_u32 s36, s36, 1
    s_cmp_gt_u32 s36, 400000
    s_cbranch_scc1 L_done
    s_cbranch_vccnz L_cg_w0_atry
    v_max3_f32 v36, v238, v239, v240
    v_max3_f32 v36, v36, v241, v242
    s_nop 1
    v_max_f32_dpp v146, v36, v36 row_ror:8 row_mask:0xf bank_mask:0xf
    v_max_f32_dpp v147, v36, v36 row_ror:8 row_mask:0xf bank_mask:0xf
    s_nop 1
    v_permlane16_swap_b32 v146, v147
    s_nop 1
    v_max_f32 v36, v146, v147
    v_max_f32 v146, v146, v147
    s_nop 1
    v_permlane32_swap_b32 v36, v146
    s_nop 1
    v_max_f32 v36, v36, v146
    v_sub_f32 v238, v238, v36
    v_sub_f32 v239, v239, v36
    v_sub_f32 v240, v240, v36
    v_sub_f32 v241, v241, v36
    v_sub_f32 v242, v242, v36
    v_exp_f32 v222, v238
    v_exp_f32 v223, v239
    v_exp_f32 v224, v240
    v_exp_f32 v225, v241
    v_exp_f32 v144, v242
    s_branch L_cg_w0_agood
L_cg_w0_done:
    s_add_u32 s33, s32, 4194304
    buffer_store_dwordx4 v[196:199], v19, s[4:7], s32 offen sc1
    buffer_store_dword v214, v20, s[4:7], s33 offen sc1
    buffer_store_dword v216, v20, s[4:7], s33 offen offset:256 sc1
    s_waitcnt vmcnt(0)
    buffer_store_dword v30, v42, s[4:7], 0 offen sc1
    s_branch L_done
L_cg_w1:
    v_mov_b32 v58, 0
    v_mov_b32 v59, 0
    v_mov_b32 v60, 0
    v_mov_b32 v61, 0
    v_mov_b32 v62, 0
    v_mov_b32 v63, 0
    v_mov_b32 v64, 0
    v_mov_b32 v65, 0
    v_mov_b32 v66, 0
    v_mov_b32 v67, 0
    v_mov_b32 v68, 0
    v_mov_b32 v69, 0
    v_mov_b32 v70, 0
    v_mov_b32 v71, 0
    v_mov_b32 v72, 0
    v_mov_b32 v73, 0
    v_mov_b32 v74, 0
    v_mov_b32 v75, 0
    v_mov_b32 v76, 0
    v_mov_b32 v77, 0
    v_mov_b32 v78, 0
    v_mov_b32 v79, 0
    v_mov_b32 v80, 0
    v_mov_b32 v81, 0
    s_waitcnt vmcnt(0)
    s_barrier
    buffer_load_dwordx4 v[100:103], v6, s[4:7], s27 offen offset:1024 sc1
    s_nop 3
    buffer_load_dwordx4 v[96:99], v6, s[4:7], s27 offen offset:0 sc1
    s_nop 3
    buffer_load_dwordx4 v[108:111], v6, s[4:7], s27 offen offset:3072 sc1
    s_nop 3
    buffer_load_dwordx4 v[104:107], v6, s[4:7], s27 offen offset:2048 sc1
L_cg_w1_loop:
    s_and_b32 s33, s26, 3
    s_add_u32 s28, s27, 262144
    s_lshl_b32 s34, s33, 16
    s_add_u32 s29, s42, s34
    v_add_u32 v30, 1, v30
    s_waitcnt vmcnt(3)
    v_smfmac_f32_16x16x64_bf16 v[58:61], v[100:103], a[48:55], v5
    v_min3_i32 v36, v100, v101, v102
    v_smfmac_f32_16x16x64_bf16 v[62:65], v[100:103], a[56:63], v5
    v_min_i32 v36, v36, v103
    v_smfmac_f32_16x16x64_bf16 v[66:69], v[100:103], a[64:71], v5
    v_cmp_eq_u32 vcc, s43, v36
    v_smfmac_f32_16x16x64_bf16 v[70:73], v[100:103], a[72:79], v5
    s_cbranch_vccnz L_cg_w1_din0
    s_waitcnt vmcnt(2)
    v_smfmac_f32_16x16x64_bf16 v[58:61], v[96:99], a[0:7], v5
    v_min3_i32 v36, v96, v97, v98
    v_smfmac_f32_16x16x64_bf16 v[62:65], v[96:99], a[8:15], v5
    v_min_i32 v36, v36, v99
    v_smfmac_f32_16x16x64_bf16 v[66:69], v[96:99], a[16:23], v5
    v_cmp_eq_u32 vcc, s43, v36
    v_smfmac_f32_16x16x64_bf16 v[70:73], v[96:99], a[24:31], v5
    s_cbranch_vccnz L_cg_w1_din1
    s_waitcnt vmcnt(1)
    v_smfmac_f32_16x16x64_bf16 v[58:61], v[108:111], a[144:151], v5
    v_min3_i32 v36, v108, v109, v110
    v_smfmac_f32_16x16x64_bf16 v[62:65], v[108:111], a[152:159], v5
    v_min_i32 v36, v36, v111
    v_smfmac_f32_16x16x64_bf16 v[66:69], v[108:111], a[160:167], v5
    v_cmp_eq_u32 vcc, s43, v36
    v_smfmac_f32_16x16x64_bf16 v[70:73], v[108:111], a[168:175], v5
    s_cbranch_vccnz L_cg_w1_din2
    s_waitcnt vmcnt(0)
    v_smfmac_f32_16x16x64_bf16 v[58:61], v[104:107], a[96:103], v5
    v_min3_i32 v36, v104, v105, v106
    v_smfmac_f32_16x16x64_bf16 v[62:65], v[104:107], a[104:111], v5
    v_min_i32 v36, v36, v107
    v_smfmac_f32_16x16x64_bf16 v[66:69], v[104:107], a[112:119], v5
    v_cmp_eq_u32 vcc, s43, v36
    v_smfmac_f32_16x16x64_bf16 v[70:73], v[104:107], a[120:127], v5
    s_cbranch_vccnz L_cg_w1_din3
L_cg_w1_ddone:
    s_nop 0
    v_pk_add_f32 v[86:87], v[58:59], v[60:61]
    ds_write2_b32 v7, v86, v87 offset0:0 offset1:36
    v_pk_add_f32 v[88:89], v[62:63], v[64:65]
    ds_write2_b32 v7, v88, v89 offset0:16 offset1:52
    v_pk_add_f32 v[90:91], v[66:67], v[68:69]
    ds_write2_b32 v8, v90, v91 offset0:0 offset1:36
    v_pk_add_f32 v[92:93], v[70:71], v[72:73]
    ds_write2_b32 v8, v92, v93 offset0:16 offset1:52
    v_smfmac_f32_16x16x64_bf16 v[74:77], v[96:99], a[32:39], v5
    v_smfmac_f32_16x16x64_bf16 v[78:81], v[96:99], a[40:47], v5
    v_smfmac_f32_16x16x64_bf16 v[74:77], v[100:103], a[80:87], v5
    v_smfmac_f32_16x16x64_bf16 v[78:81], v[100:103], a[88:95], v5
    s_waitcnt lgkmcnt(0)
    s_barrier
    v_smfmac_f32_16x16x64_bf16 v[74:77], v[104:107], a[128:135], v5
    buffer_load_dword v39, v28, s[4:7], s45 offen sc1
    v_smfmac_f32_16x16x64_bf16 v[78:81], v[104:107], a[136:143], v5
    buffer_load_dword v39, v28, s[4:7], s45 offen sc1
    v_smfmac_f32_16x16x64_bf16 v[74:77], v[108:111], a[176:183], v5
    buffer_load_dword v39, v28, s[4:7], s45 offen sc1
    v_smfmac_f32_16x16x64_bf16 v[78:81], v[108:111], a[184:191], v5
    buffer_load_dword v39, v28, s[4:7], s45 offen sc1
    s_nop 7
    v_pk_add_f32 v[86:87], v[74:75], v[76:77]
    v_pk_add_f32 v[88:89], v[78:79], v[80:81]
    ds_write_b128 v10, v[86:89] offset:14336
L_cg_w1_apoll:
    v_cmp_gt_u32 vcc, v30, v39
    buffer_load_dword v39, v28, s[4:7], s45 offen offset:0 sc1
    s_cbranch_vccz L_cg_w1_ago
    v_cmp_gt_u32 vcc, v30, v39
    buffer_load_dword v39, v28, s[4:7], s45 offen offset:0 sc1
    s_cbranch_vccz L_cg_w1_ago
    v_cmp_gt_u32 vcc, v30, v39
    buffer_load_dword v39, v28, s[4:7], s45 offen offset:0 sc1
    s_cbranch_vccz L_cg_w1_ago
    v_cmp_gt_u32 vcc, v30, v39
    buffer_load_dword v39, v28, s[4:7], s45 offen offset:0 sc1
    s_cbranch_vccz L_cg_w1_ago
    v_cmp_gt_u32 vcc, v30, v39
    buffer_load_dword v39, v28, s[4:7], s45 offen offset:0 sc1
    s_cbranch_vccz L_cg_w1_ago
    v_cmp_gt_u32 vcc, v30, v39
    buffer_load_dword v39, v28, s[4:7], s45 offen offset:0 sc1
    s_cbranch_vccz L_cg_w1_ago
    v_cmp_gt_u32 vcc, v30, v39
    buffer_load_dword v39, v28, s[4:7], s45 offen offset:0 sc1
    s_cbranch_vccz L_cg_w1_ago
    v_cmp_gt_u32 vcc, v30, v39
    buffer_load_dword v39, v28, s[4:7], s45 offen offset:0 sc1
    s_cbranch_vccz L_cg_w1_ago
    v_cmp_gt_u32 vcc, v30, v39
    buffer_load_dword v39, v28, s[4:7], s45 offen offset:0 sc1
    s_cbranch_vccz L_cg_w1_ago
    v_cmp_gt_u32 vcc, v30, v39
    buffer_load_dword v39, v28, s[4:7], s45 offen offset:0 sc1
    s_cbranch_vccz L_cg_w1_ago
    s_waitcnt vmcnt(36)
    s_add_u32 s36, s36, 1
    s_cmp_lt_u32 s36, 400000
    s_cbranch_scc1 L_cg_w1_apoll
    s_branch L_done
L_cg_w1_ago:
    s_nop 15
    s_nop 5
    s_waitcnt lgkmcnt(0)
    s_barrier
    s_cmp_eq_u32 s26, 63
    s_cbranch_scc1 L_cg_w1_done
    s_lshr_b32 s34, s26, 3
    s_lshr_b32 s34, s19, s34
    s_and_b32 s34, s34, 1
    s_lshl_b32 s34, s34, 13
    s_lshl_b32 s30, s26, 18
    s_add_u32 s30, s30, s34
    s_add_u32 s30, s30, 134217728
    s_mov_b32 m0, 24576
    s_nop 15
    s_nop 7
L_cg_w1_bpoll:
    v_cmp_gt_u32 vcc, v30, v40
    buffer_load_dword v40, v26, s[4:7], s45 offen offset:0 sc1
    s_cbranch_vccz L_cg_w1_bgo
    v_cmp_gt_u32 vcc, v30, v40
    buffer_load_dword v40, v26, s[4:7], s45 offen offset:0 sc1
    s_cbranch_vccz L_cg_w1_bgo
    v_cmp_gt_u32 vcc, v30, v40
    buffer_load_dword v40, v26, s[4:7], s45 offen offset:0 sc1
    s_cbranch_vccz L_cg_w1_bgo
    v_cmp_gt_u32 vcc, v30, v40
    buffer_load_dword v40, v26, s[4:7], s45 offen offset:0 sc1
    s_cbranch_vccz L_cg_w1_bgo
    v_cmp_gt_u32 vcc, v30, v40
    buffer_load_dword v40, v26, s[4:7], s45 offen offset:0 sc1
    s_cbranch_vccz L_cg_w1_bgo
    v_cmp_gt_u32 vcc, v30, v40
    buffer_load_dword v40, v26, s[4:7], s45 offen offset:0 sc1
    s_cbranch_vccz L_cg_w1_bgo
    v_cmp_gt_u32 vcc, v30, v40
    buffer_load_dword v40, v26, s[4:7], s45 offen offset:0 sc1
    s_cbranch_vccz L_cg_w1_bgo
    v_cmp_gt_u32 vcc, v30, v40
    buffer_load_dword v40, v26, s[4:7], s45 offen offset:0 sc1
    s_cbranch_vccz L_cg_w1_bgo
    v_cmp_gt_u32 vcc, v30, v40
    buffer_load_dword v40, v26, s[4:7], s45 offen offset:0 sc1
    s_cbranch_vccz L_cg_w1_bgo
    v_cmp_gt_u32 vcc, v30, v40
    buffer_load_dword v40, v26, s[4:7], s45 offen offset:0 sc1
    s_cbranch_vccz L_cg_w1_bgo
    s_waitcnt vmcnt(36)
    s_add_u32 s36, s36, 1
    s_cmp_lt_u32 s36, 400000
    s_cbranch_scc1 L_cg_w1_bpoll
    s_branch L_done
L_cg_w1_bgo:
    s_barrier
    buffer_load_dwordx4 v6, s[4:7], s28 offen offset:1024 sc1 lds
    s_nop 3
    buffer_load_dwordx4 v6, s[4:7], s28 offen offset:0 sc1 lds
    s_nop 3
    buffer_load_dwordx4 v6, s[4:7], s28 offen offset:3072 sc1 lds
    s_nop 3
    buffer_load_dwordx4 v6, s[4:7], s28 offen offset:2048 sc1 lds
    s_add_u32 s26, s26, 1
    s_and_b32 s35, s26, 3
    s_lshl_b32 s35, s35, 14
    s_add_u32 s27, s41, s35
    v_mov_b32 v58, 0
    v_mov_b32 v59, 0
    v_mov_b32 v60, 0
    v_mov_b32 v61, 0
    v_mov_b32 v62, 0
    v_mov_b32 v63, 0
    v_mov_b32 v64, 0
    v_mov_b32 v65, 0
    v_mov_b32 v66, 0
    v_mov_b32 v67, 0
    v_mov_b32 v68, 0
    v_mov_b32 v69, 0
    v_mov_b32 v70, 0
    v_mov_b32 v71, 0
    v_mov_b32 v72, 0
    v_mov_b32 v73, 0
    v_mov_b32 v74, 0
    v_mov_b32 v75, 0
    v_mov_b32 v76, 0
    v_mov_b32 v77, 0
    v_mov_b32 v78, 0
    v_mov_b32 v79, 0
    v_mov_b32 v80, 0
    v_mov_b32 v81, 0
    s_waitcnt vmcnt(3)
    s_barrier
    s_waitcnt vmcnt(2)
    s_barrier
    s_waitcnt vmcnt(1)
    s_barrier
    s_load_dwordx4 s[64:67], s[4:5], s47 glc
    s_waitcnt vmcnt(0)
    s_barrier
L_cg_w1_cpoll:
    s_load_dwordx4 s[64:67], s[4:5], s47 glc
    s_min_u32 s33, s64, s65
    s_min_u32 s33, s33, s66
    s_cmp_ge_u32 s33, s26
    s_cbranch_scc1 L_cg_w1_cgo
    s_min_u32 s33, s64, s65
    s_min_u32 s33, s33, s66
    s_cmp_ge_u32 s33, s26
    s_cbranch_scc1 L_cg_w1_cgo
    s_min_u32 s33, s64, s65
    s_min_u32 s33, s33, s66
    s_cmp_ge_u32 s33, s26
    s_cbranch_scc1 L_cg_w1_cgo
    s_waitcnt lgkmcnt(8)
    s_add_u32 s36, s36, 1
    s_cmp_lt_u32 s36, 400000
    s_cbranch_scc1 L_cg_w1_cpoll
    s_branch L_done
L_cg_w1_cgo:
    buffer_load_dwordx4 v[116:119], v44, s[4:7], s30 offen sc1
    buffer_load_dwordx4 v[120:123], v45, s[4:7], s30 offen sc1
    buffer_load_dwordx4 v[124:127], v46, s[4:7], s30 offen sc1
L_cg_w1_bjoin:
    s_barrier
    ds_read_b32 v32, v37 offset:19456
    ds_read_b128 v[128:131], v2 offset:18432
    s_waitcnt lgkmcnt(0)
    v_cmp_ne_u32 vcc, 0, v32
    s_cbranch_vccnz L_cg_w1_bretry
    s_waitcnt vmcnt(2)
    v_pk_add_f32 v[132:133], v[128:129], v[116:117]
    v_pk_add_f32 v[134:135], v[130:131], v[118:119]
    s_waitcnt vmcnt(1)
    v_pk_add_f32 v[132:133], v[132:133], v[120:121]
    v_pk_add_f32 v[134:135], v[134:135], v[122:123]
    s_waitcnt vmcnt(0)
    v_pk_add_f32 v[132:133], v[132:133], v[124:125]
    v_pk_add_f32 v[134:135], v[134:135], v[126:127]
    v_pk_add_f32 v[86:87], v[132:133], v[134:135]
    v_cmp_u_f32 vcc, v86, v87
    v_cvt_pk_bf16_f32 v136, v132, v134
    v_cvt_pk_bf16_f32 v137, v133, v135
    v_max_i32 v136, s44, v136
    v_max_i32 v137, s44, v137
    s_cbranch_vccnz L_cg_w1_cslow
L_cg_w1_cgood:
    buffer_store_dword v136, v16, s[4:7], s27 offen sc1
    buffer_store_dword v137, v16, s[4:7], s27 offen offset:16 sc1
    s_barrier
    buffer_load_dwordx4 v[100:103], v6, s[4:7], s27 offen offset:1024 sc1
    s_nop 3
    buffer_load_dwordx4 v[96:99], v6, s[4:7], s27 offen offset:0 sc1
    s_nop 3
    buffer_load_dwordx4 v[108:111], v6, s[4:7], s27 offen offset:3072 sc1
    s_nop 3
    buffer_load_dwordx4 v[104:107], v6, s[4:7], s27 offen offset:2048 sc1
    s_branch L_cg_w1_loop
L_cg_w1_din0:
    s_mov_b64 s[54:55], -1
    s_mov_b64 s[60:61], -1
    s_mov_b64 s[58:59], -1
    s_branch L_cg_w1_dre0
L_cg_w1_din1:
    buffer_load_dword v38, v31, s[4:7], 0 offen
    s_mov_b64 s[56:57], 0
    s_mov_b64 s[60:61], -1
    s_mov_b64 s[58:59], -1
    s_branch L_cg_w1_dre1
L_cg_w1_din2:
    buffer_load_dword v38, v31, s[4:7], 0 offen
    buffer_load_dword v38, v31, s[4:7], 0 offen
    s_mov_b64 s[56:57], 0
    s_mov_b64 s[54:55], 0
    s_mov_b64 s[58:59], -1
    s_branch L_cg_w1_dre2
L_cg_w1_din3:
    buffer_load_dword v38, v31, s[4:7], 0 offen
    buffer_load_dword v38, v31, s[4:7], 0 offen
    buffer_load_dword v38, v31, s[4:7], 0 offen
    s_mov_b64 s[56:57], 0
    s_mov_b64 s[54:55], 0
    s_mov_b64 s[60:61], 0
    s_branch L_cg_w1_dre3
L_cg_w1_dloop:
    s_cmp_eq_u64 s[56:57], 0
    s_cbranch_scc1 L_cg_w1_dsk0
    s_waitcnt vmcnt(3)
    v_cndmask_b32 v112, 0, v100, s[56:57]
    v_cndmask_b32 v113, 0, v101, s[56:57]
    v_cndmask_b32 v114, 0, v102, s[56:57]
    v_cndmask_b32 v115, 0, v103, s[56:57]
    s_or_b64 s[62:63], s[54:55], s[60:61]
    s_or_b64 s[62:63], s[62:63], s[58:59]
    v_smfmac_f32_16x16x64_bf16 v[58:61], v[112:115], a[48:55], v5
    v_min3_i32 v36, v112, v113, v114
    v_smfmac_f32_16x16x64_bf16 v[62:65], v[112:115], a[56:63], v5
    v_min_i32 v36, v36, v115
    v_smfmac_f32_16x16x64_bf16 v[66:69], v[112:115], a[64:71], v5
    v_cmp_eq_u32 vcc, s43, v36
    v_smfmac_f32_16x16x64_bf16 v[70:73], v[112:115], a[72:79], v5
    s_or_b64 s[62:63], s[62:63], vcc
    s_cbranch_scc0 L_cg_w1_ddone
    s_cbranch_vccz L_cg_w1_dok0
L_cg_w1_dre0:
    s_mov_b64 exec, vcc
    buffer_load_dwordx4 v[100:103], v6, s[4:7], s27 offen offset:1024 sc1
    s_mov_b64 exec, -1
    s_mov_b64 s[56:57], vcc
    s_branch L_cg_w1_dnx0
L_cg_w1_dok0:
    s_mov_b64 s[56:57], 0
L_cg_w1_dsk0:
    buffer_load_dword v38, v31, s[4:7], 0 offen
L_cg_w1_dnx0:
    s_cmp_eq_u64 s[54:55], 0
    s_cbranch_scc1 L_cg_w1_dsk1
    s_waitcnt vmcnt(3)
    v_cndmask_b32 v112, 0, v96, s[54:55]
    v_cndmask_b32 v113, 0, v97, s[54:55]
    v_cndmask_b32 v114, 0, v98, s[54:55]
    v_cndmask_b32 v115, 0, v99, s[54:55]
    s_or_b64 s[62:63], s[56:57], s[60:61]
    s_or_b64 s[62:63], s[62:63], s[58:59]
    v_smfmac_f32_16x16x64_bf16 v[58:61], v[112:115], a[0:7], v5
    v_min3_i32 v36, v112, v113, v114
    v_smfmac_f32_16x16x64_bf16 v[62:65], v[112:115], a[8:15], v5
    v_min_i32 v36, v36, v115
    v_smfmac_f32_16x16x64_bf16 v[66:69], v[112:115], a[16:23], v5
    v_cmp_eq_u32 vcc, s43, v36
    v_smfmac_f32_16x16x64_bf16 v[70:73], v[112:115], a[24:31], v5
    s_or_b64 s[62:63], s[62:63], vcc
    s_cbranch_scc0 L_cg_w1_ddone
    s_cbranch_vccz L_cg_w1_dok1
L_cg_w1_dre1:
    s_mov_b64 exec, vcc
    buffer_load_dwordx4 v[96:99], v6, s[4:7], s27 offen offset:0 sc1
    s_mov_b64 exec, -1
    s_mov_b64 s[54:55], vcc
    s_branch L_cg_w1_dnx1
L_cg_w1_dok1:
    s_mov_b64 s[54:55], 0
L_cg_w1_dsk1:
    buffer_load_dword v38, v31, s[4:7], 0 offen
L_cg_w1_dnx1:
    s_cmp_eq_u64 s[60:61], 0
    s_cbranch_scc1 L_cg_w1_dsk2
    s_waitcnt vmcnt(3)
    v_cndmask_b32 v112, 0, v108, s[60:61]
    v_cndmask_b32 v113, 0, v109, s[60:61]
    v_cndmask_b32 v114, 0, v110, s[60:61]
    v_cndmask_b32 v115, 0, v111, s[60:61]
    s_or_b64 s[62:63], s[56:57], s[54:55]
    s_or_b64 s[62:63], s[62:63], s[58:59]
    v_smfmac_f32_16x16x64_bf16 v[58:61], v[112:115], a[144:151], v5
    v_min3_i32 v36, v112, v113, v114
    v_smfmac_f32_16x16x64_bf16 v[62:65], v[112:115], a[152:159], v5
    v_min_i32 v36, v36, v115
    v_smfmac_f32_16x16x64_bf16 v[66:69], v[112:115], a[160:167], v5
    v_cmp_eq_u32 vcc, s43, v36
    v_smfmac_f32_16x16x64_bf16 v[70:73], v[112:115], a[168:175], v5
    s_or_b64 s[62:63], s[62:63], vcc
    s_cbranch_scc0 L_cg_w1_ddone
    s_cbranch_vccz L_cg_w1_dok2
L_cg_w1_dre2:
    s_mov_b64 exec, vcc
    buffer_load_dwordx4 v[108:111], v6, s[4:7], s27 offen offset:3072 sc1
    s_mov_b64 exec, -1
    s_mov_b64 s[60:61], vcc
    s_branch L_cg_w1_dnx2
L_cg_w1_dok2:
    s_mov_b64 s[60:61], 0
L_cg_w1_dsk2:
    buffer_load_dword v38, v31, s[4:7], 0 offen
L_cg_w1_dnx2:
    s_cmp_eq_u64 s[58:59], 0
    s_cbranch_scc1 L_cg_w1_dsk3
    s_waitcnt vmcnt(3)
    v_cndmask_b32 v112, 0, v104, s[58:59]
    v_cndmask_b32 v113, 0, v105, s[58:59]
    v_cndmask_b32 v114, 0, v106, s[58:59]
    v_cndmask_b32 v115, 0, v107, s[58:59]
    s_or_b64 s[62:63], s[56:57], s[54:55]
    s_or_b64 s[62:63], s[62:63], s[60:61]
    v_smfmac_f32_16x16x64_bf16 v[58:61], v[112:115], a[96:103], v5
    v_min3_i32 v36, v112, v113, v114
    v_smfmac_f32_16x16x64_bf16 v[62:65], v[112:115], a[104:111], v5
    v_min_i32 v36, v36, v115
    v_smfmac_f32_16x16x64_bf16 v[66:69], v[112:115], a[112:119], v5
    v_cmp_eq_u32 vcc, s43, v36
    v_smfmac_f32_16x16x64_bf16 v[70:73], v[112:115], a[120:127], v5
    s_or_b64 s[62:63], s[62:63], vcc
    s_cbranch_scc0 L_cg_w1_ddone
    s_cbranch_vccz L_cg_w1_dok3
L_cg_w1_dre3:
    s_mov_b64 exec, vcc
    buffer_load_dwordx4 v[104:107], v6, s[4:7], s27 offen offset:2048 sc1
    s_mov_b64 exec, -1
    s_mov_b64 s[58:59], vcc
    s_branch L_cg_w1_dnx3
L_cg_w1_dok3:
    s_mov_b64 s[58:59], 0
L_cg_w1_dsk3:
    buffer_load_dword v38, v31, s[4:7], 0 offen
L_cg_w1_dnx3:
    s_add_u32 s36, s36, 1
    s_cmp_lt_u32 s36, 400000
    s_cbranch_scc1 L_cg_w1_dloop
    s_branch L_done
L_cg_w1_bretry:
    s_add_u32 s36, s36, 1
    s_cmp_gt_u32 s36, 400000
    s_cbranch_scc1 L_done
    s_mov_b32 m0, 24576
    s_nop 0
    buffer_load_dwordx4 v6, s[4:7], s28 offen offset:1024 sc1 lds
    s_nop 3
    buffer_load_dwordx4 v6, s[4:7], s28 offen offset:0 sc1 lds
    s_nop 3
    buffer_load_dwordx4 v6, s[4:7], s28 offen offset:3072 sc1 lds
    s_nop 3
    buffer_load_dwordx4 v6, s[4:7], s28 offen offset:2048 sc1 lds
    s_waitcnt vmcnt(3)
    s_barrier
    s_waitcnt vmcnt(2)
    s_barrier
    s_waitcnt vmcnt(1)
    s_barrier
    s_waitcnt vmcnt(0)
    s_barrier
    s_branch L_cg_w1_bjoin
L_cg_w1_cslow:
    v_max_u32 v36, v116, v117
    v_max3_u32 v36, v36, v118, v119
    v_max3_u32 v36, v36, v120, v121
    v_max3_u32 v36, v36, v122, v123
    v_max3_u32 v36, v36, v124, v125
    v_max3_u32 v36, v36, v126, v127
    v_cmp_eq_u32 vcc, -1, v36
    s_cbranch_vccz L_cg_w1_cgood
    buffer_load_dwordx4 v[116:119], v44, s[4:7], s30 offen sc1
    buffer_load_dwordx4 v[120:123], v45, s[4:7], s30 offen sc1
    buffer_load_dwordx4 v[124:127], v46, s[4:7], s30 offen sc1
    s_add_u32 s36, s36, 1
    s_cmp_gt_u32 s36, 400000
    s_cbranch_scc1 L_done
    s_waitcnt vmcnt(2)
    v_pk_add_f32 v[132:133], v[128:129], v[116:117]
    v_pk_add_f32 v[134:135], v[130:131], v[118:119]
    s_waitcnt vmcnt(1)
    v_pk_add_f32 v[132:133], v[132:133], v[120:121]
    v_pk_add_f32 v[134:135], v[134:135], v[122:123]
    s_waitcnt vmcnt(0)
    v_pk_add_f32 v[132:133], v[132:133], v[124:125]
    v_pk_add_f32 v[134:135], v[134:135], v[126:127]
    v_cvt_pk_bf16_f32 v136, v132, v134
    v_cvt_pk_bf16_f32 v137, v133, v135
    v_max_i32 v136, s44, v136
    v_max_i32 v137, s44, v137
    s_branch L_cg_w1_cslow
L_cg_w1_done:
    s_branch L_done
L_cg_w2:
    v_mov_b32 v58, 0
    v_mov_b32 v59, 0
    v_mov_b32 v60, 0
    v_mov_b32 v61, 0
    v_mov_b32 v62, 0
    v_mov_b32 v63, 0
    v_mov_b32 v64, 0
    v_mov_b32 v65, 0
    v_mov_b32 v66, 0
    v_mov_b32 v67, 0
    v_mov_b32 v68, 0
    v_mov_b32 v69, 0
    v_mov_b32 v70, 0
    v_mov_b32 v71, 0
    v_mov_b32 v72, 0
    v_mov_b32 v73, 0
    v_mov_b32 v74, 0
    v_mov_b32 v75, 0
    v_mov_b32 v76, 0
    v_mov_b32 v77, 0
    v_mov_b32 v78, 0
    v_mov_b32 v79, 0
    v_mov_b32 v80, 0
    v_mov_b32 v81, 0
    s_waitcnt vmcnt(0)
    s_barrier
    buffer_load_dwordx4 v[104:107], v6, s[4:7], s27 offen offset:2048 sc1
    s_nop 3
    buffer_load_dwordx4 v[108:111], v6, s[4:7], s27 offen offset:3072 sc1
    s_nop 3
    buffer_load_dwordx4 v[96:99], v6, s[4:7], s27 offen offset:0 sc1
    s_nop 3
    buffer_load_dwordx4 v[100:103], v6, s[4:7], s27 offen offset:1024 sc1
L_cg_w2_loop:
    s_and_b32 s33, s26, 3
    s_add_u32 s28, s27, 262144
    s_lshl_b32 s34, s33, 16
    s_add_u32 s29, s42, s34
    v_add_u32 v30, 1, v30
    s_waitcnt vmcnt(3)
    v_smfmac_f32_16x16x64_bf16 v[58:61], v[104:107], a[96:103], v5
    v_min3_i32 v36, v104, v105, v106
    v_smfmac_f32_16x16x64_bf16 v[62:65], v[104:107], a[104:111], v5
    v_min_i32 v36, v36, v107
    v_smfmac_f32_16x16x64_bf16 v[66:69], v[104:107], a[112:119], v5
    v_cmp_eq_u32 vcc, s43, v36
    v_smfmac_f32_16x16x64_bf16 v[70:73], v[104:107], a[120:127], v5
    s_cbranch_vccnz L_cg_w2_din0
    s_waitcnt vmcnt(2)
    v_smfmac_f32_16x16x64_bf16 v[58:61], v[108:111], a[144:151], v5
    v_min3_i32 v36, v108, v109, v110
    v_smfmac_f32_16x16x64_bf16 v[62:65], v[108:111], a[152:159], v5
    v_min_i32 v36, v36, v111
    v_smfmac_f32_16x16x64_bf16 v[66:69], v[108:111], a[160:167], v5
    v_cmp_eq_u32 vcc, s43, v36
    v_smfmac_f32_16x16x64_bf16 v[70:73], v[108:111], a[168:175], v5
    s_cbranch_vccnz L_cg_w2_din1
    s_waitcnt vmcnt(1)
    v_smfmac_f32_16x16x64_bf16 v[58:61], v[96:99], a[0:7], v5
    v_min3_i32 v36, v96, v97, v98
    v_smfmac_f32_16x16x64_bf16 v[62:65], v[96:99], a[8:15], v5
    v_min_i32 v36, v36, v99
    v_smfmac_f32_16x16x64_bf16 v[66:69], v[96:99], a[16:23], v5
    v_cmp_eq_u32 vcc, s43, v36
    v_smfmac_f32_16x16x64_bf16 v[70:73], v[96:99], a[24:31], v5
    s_cbranch_vccnz L_cg_w2_din2
    s_waitcnt vmcnt(0)
    v_smfmac_f32_16x16x64_bf16 v[58:61], v[100:103], a[48:55], v5
    v_min3_i32 v36, v100, v101, v102
    v_smfmac_f32_16x16x64_bf16 v[62:65], v[100:103], a[56:63], v5
    v_min_i32 v36, v36, v103
    v_smfmac_f32_16x16x64_bf16 v[66:69], v[100:103], a[64:71], v5
    v_cmp_eq_u32 vcc, s43, v36
    v_smfmac_f32_16x16x64_bf16 v[70:73], v[100:103], a[72:79], v5
    s_cbranch_vccnz L_cg_w2_din3
L_cg_w2_ddone:
    s_nop 0
    v_pk_add_f32 v[86:87], v[58:59], v[60:61]
    ds_write2_b32 v7, v86, v87 offset0:0 offset1:36
    v_pk_add_f32 v[88:89], v[62:63], v[64:65]
    ds_write2_b32 v7, v88, v89 offset0:16 offset1:52
    v_pk_add_f32 v[90:91], v[66:67], v[68:69]
    ds_write2_b32 v8, v90, v91 offset0:0 offset1:36
    v_pk_add_f32 v[92:93], v[70:71], v[72:73]
    ds_write2_b32 v8, v92, v93 offset0:16 offset1:52
    v_smfmac_f32_16x16x64_bf16 v[74:77], v[96:99], a[32:39], v5
    v_smfmac_f32_16x16x64_bf16 v[78:81], v[96:99], a[40:47], v5
    v_smfmac_f32_16x16x64_bf16 v[74:77], v[100:103], a[80:87], v5
    v_smfmac_f32_16x16x64_bf16 v[78:81], v[100:103], a[88:95], v5
    s_waitcnt lgkmcnt(0)
    s_barrier
    buffer_store_dword v30, v27, s[4:7], s45 offen offset:0 sc1
    v_smfmac_f32_16x16x64_bf16 v[74:77], v[104:107], a[128:135], v5
    v_smfmac_f32_16x16x64_bf16 v[78:81], v[104:107], a[136:143], v5
    v_smfmac_f32_16x16x64_bf16 v[74:77], v[108:111], a[176:183], v5
    v_smfmac_f32_16x16x64_bf16 v[78:81], v[108:111], a[184:191], v5
    s_nop 7
    v_pk_add_f32 v[86:87], v[74:75], v[76:77]
    v_pk_add_f32 v[88:89], v[78:79], v[80:81]
    ds_write_b128 v10, v[86:89] offset:14336
    s_waitcnt lgkmcnt(0)
    s_barrier
    s_cmp_eq_u32 s26, 63
    s_cbranch_scc1 L_cg_w2_done
    s_lshr_b32 s34, s26, 3
    s_lshr_b32 s34, s19, s34
    s_and_b32 s34, s34, 1
    s_lshl_b32 s34, s34, 13
    s_lshl_b32 s30, s26, 18
    s_add_u32 s30, s30, s34
    s_add_u32 s30, s30, 134217728
    s_mov_b32 m0, 28672
    v_mov_b32 v82, 0
    v_mov_b32 v83, 0
    v_mov_b32 v84, 0
    v_mov_b32 v85, 0
    s_add_u32 s35, s26, 4
    s_lshr_b32 s34, s35, 3
    s_lshr_b32 s34, s19, s34
    s_and_b32 s34, s34, 1
    s_lshl_b32 s34, s34, 13
    s_lshl_b32 s39, s35, 18
    s_add_u32 s39, s39, s34
    s_add_u32 s39, s39, 134217728
    s_cmp_gt_u32 s35, 62
    s_cselect_b32 s39, 1073741824, s39
    s_barrier
    buffer_load_dwordx4 v6, s[4:7], s28 offen offset:2048 sc1 lds
    s_nop 3
    buffer_load_dwordx4 v6, s[4:7], s28 offen offset:3072 sc1 lds
    s_nop 3
    buffer_load_dwordx4 v6, s[4:7], s28 offen offset:0 sc1 lds
    s_nop 3
    buffer_load_dwordx4 v6, s[4:7], s28 offen offset:1024 sc1 lds
    s_add_u32 s26, s26, 1
    s_and_b32 s35, s26, 3
    s_lshl_b32 s35, s35, 14
    s_add_u32 s27, s41, s35
    v_mov_b32 v58, 0
    v_mov_b32 v59, 0
    v_mov_b32 v60, 0
    v_mov_b32 v61, 0
    v_mov_b32 v62, 0
    v_mov_b32 v63, 0
    v_mov_b32 v64, 0
    v_mov_b32 v65, 0
    v_mov_b32 v66, 0
    v_mov_b32 v67, 0
    v_mov_b32 v68, 0
    v_mov_b32 v69, 0
    v_mov_b32 v70, 0
    v_mov_b32 v71, 0
    v_mov_b32 v72, 0
    v_mov_b32 v73, 0
    v_mov_b32 v74, 0
    v_mov_b32 v75, 0
    v_mov_b32 v76, 0
    v_mov_b32 v77, 0
    v_mov_b32 v78, 0
    v_mov_b32 v79, 0
    v_mov_b32 v80, 0
    v_mov_b32 v81, 0
L_cg_w2_bwait:
    s_waitcnt vmcnt(3)
    s_barrier
    ds_read_b128 v[116:119], v2 offset:20480
    ds_read_b128 v[136:139], v2 offset:25600
    ds_read_b128 v[156:159], v2 offset:30720
    ds_read_b128 v[176:179], v2 offset:35840
    s_waitcnt lgkmcnt(3)
    v_smfmac_f32_16x16x64_bf16 v[82:85], v[116:119], a[192:199], v5
    s_waitcnt vmcnt(2)
    s_barrier
    ds_read_b128 v[120:123], v2 offset:21504
    ds_read_b128 v[132:135], v2 offset:24576
    ds_read_b128 v[160:163], v2 offset:31744
    ds_read_b128 v[172:175], v2 offset:34816
    s_waitcnt lgkmcnt(6)
    v_smfmac_f32_16x16x64_bf16 v[82:85], v[136:139], a[232:239], v5
    s_waitcnt lgkmcnt(5)
    v_smfmac_f32_16x16x64_bf16 v[82:85], v[156:159], v[196:203], v5
    s_waitcnt lgkmcnt(4)
    v_smfmac_f32_16x16x64_bf16 v[82:85], v[176:179], v[236:243], v5
    s_waitcnt lgkmcnt(3)
    v_smfmac_f32_16x16x64_bf16 v[82:85], v[120:123], a[200:207], v5
    s_waitcnt vmcnt(1)
    s_barrier
    ds_read_b128 v[124:127], v2 offset:22528
    ds_read_b128 v[144:147], v2 offset:27648
    ds_read_b128 v[148:151], v2 offset:28672
    ds_read_b128 v[168:171], v2 offset:33792
    s_waitcnt lgkmcnt(6)
    v_smfmac_f32_16x16x64_bf16 v[82:85], v[132:135], a[224:231], v5
    s_waitcnt lgkmcnt(5)
    v_smfmac_f32_16x16x64_bf16 v[82:85], v[160:163], v[204:211], v5
    s_waitcnt lgkmcnt(4)
    v_smfmac_f32_16x16x64_bf16 v[82:85], v[172:175], v[228:235], v5
    s_waitcnt lgkmcnt(3)
    v_smfmac_f32_16x16x64_bf16 v[82:85], v[124:127], a[208:215], v5
    s_waitcnt vmcnt(0)
    s_barrier
    ds_read_b128 v[128:131], v2 offset:23552
    ds_read_b128 v[140:143], v2 offset:26624
    ds_read_b128 v[152:155], v2 offset:29696
    ds_read_b128 v[164:167], v2 offset:32768
    s_waitcnt lgkmcnt(6)
    v_smfmac_f32_16x16x64_bf16 v[82:85], v[144:147], a[248:255], v5
    s_waitcnt lgkmcnt(5)
    v_smfmac_f32_16x16x64_bf16 v[82:85], v[148:151], v[180:187], v5
    s_waitcnt lgkmcnt(4)
    v_smfmac_f32_16x16x64_bf16 v[82:85], v[168:171], v[220:227], v5
    s_waitcnt lgkmcnt(3)
    v_smfmac_f32_16x16x64_bf16 v[82:85], v[128:131], a[216:223], v5
    s_waitcnt lgkmcnt(2)
    v_smfmac_f32_16x16x64_bf16 v[82:85], v[140:143], a[240:247], v5
    s_waitcnt lgkmcnt(1)
    v_smfmac_f32_16x16x64_bf16 v[82:85], v[152:155], v[188:195], v5
    s_waitcnt lgkmcnt(0)
    v_smfmac_f32_16x16x64_bf16 v[82:85], v[164:167], v[212:219], v5
    s_nop 7
    v_pk_add_f32 v[86:87], v[82:83], v[84:85]
    v_cmpx_o_f32 vcc, v86, v87
    buffer_store_dwordx2 v[86:87], v15, s[4:7], s30 offen sc1
    s_cmp_eq_u64 exec, -1
    s_cbranch_scc0 L_cg_w2_bslow
L_cg_w2_bgood:
    ds_write_b64 v3, v[86:87] offset:18432
    ds_write_b32 v37, v37 offset:19456
    buffer_store_dwordx4 v[50:53], v24, s[4:7], s39 offen sc1
    s_waitcnt lgkmcnt(0)
    s_barrier
    s_nop 15
    s_nop 15
    s_nop 15
L_cg_w2_spoll:
    v_cmp_gt_u32 vcc, v30, v41
    buffer_load_dword v41, v26, s[4:7], s45 offen offset:2048 sc1
    s_cbranch_vccz L_cg_w2_sgo
    v_cmp_gt_u32 vcc, v30, v41
    buffer_load_dword v41, v26, s[4:7], s45 offen offset:2048 sc1
    s_cbranch_vccz L_cg_w2_sgo
    v_cmp_gt_u32 vcc, v30, v41
    buffer_load_dword v41, v26, s[4:7], s45 offen offset:2048 sc1
    s_cbranch_vccz L_cg_w2_sgo
    v_cmp_gt_u32 vcc, v30, v41
    buffer_load_dword v41, v26, s[4:7], s45 offen offset:2048 sc1
    s_cbranch_vccz L_cg_w2_sgo
    v_cmp_gt_u32 vcc, v30, v41
    buffer_load_dword v41, v26, s[4:7], s45 offen offset:2048 sc1
    s_cbranch_vccz L_cg_w2_sgo
    v_cmp_gt_u32 vcc, v30, v41
    buffer_load_dword v41, v26, s[4:7], s45 offen offset:2048 sc1
    s_cbranch_vccz L_cg_w2_sgo
    v_cmp_gt_u32 vcc, v30, v41
    buffer_load_dword v41, v26, s[4:7], s45 offen offset:2048 sc1
    s_cbranch_vccz L_cg_w2_sgo
    v_cmp_gt_u32 vcc, v30, v41
    buffer_load_dword v41, v26, s[4:7], s45 offen offset:2048 sc1
    s_cbranch_vccz L_cg_w2_sgo
    v_cmp_gt_u32 vcc, v30, v41
    buffer_load_dword v41, v26, s[4:7], s45 offen offset:2048 sc1
    s_cbranch_vccz L_cg_w2_sgo
    v_cmp_gt_u32 vcc, v30, v41
    buffer_load_dword v41, v26, s[4:7], s45 offen offset:2048 sc1
    s_cbranch_vccz L_cg_w2_sgo
    s_waitcnt vmcnt(36)
    s_add_u32 s36, s36, 1
    s_cmp_lt_u32 s36, 400000
    s_cbranch_scc1 L_cg_w2_spoll
    s_branch L_done
L_cg_w2_sgo:
    s_barrier
    buffer_load_dwordx4 v[104:107], v6, s[4:7], s27 offen offset:2048 sc1
    s_nop 3
    buffer_load_dwordx4 v[108:111], v6, s[4:7], s27 offen offset:3072 sc1
    s_nop 3
    buffer_load_dwordx4 v[96:99], v6, s[4:7], s27 offen offset:0 sc1
    s_nop 3
    buffer_load_dwordx4 v[100:103], v6, s[4:7], s27 offen offset:1024 sc1
    s_branch L_cg_w2_loop
L_cg_w2_din0:
    s_mov_b64 s[60:61], -1
    s_mov_b64 s[54:55], -1
    s_mov_b64 s[56:57], -1
    s_branch L_cg_w2_dre0
L_cg_w2_din1:
    buffer_load_dword v38, v31, s[4:7], 0 offen
    s_mov_b64 s[58:59], 0
    s_mov_b64 s[54:55], -1
    s_mov_b64 s[56:57], -1
    s_branch L_cg_w2_dre1
L_cg_w2_din2:
    buffer_load_dword v38, v31, s[4:7], 0 offen
    buffer_load_dword v38, v31, s[4:7], 0 offen
    s_mov_b64 s[58:59], 0
    s_mov_b64 s[60:61], 0
    s_mov_b64 s[56:57], -1
    s_branch L_cg_w2_dre2
L_cg_w2_din3:
    buffer_load_dword v38, v31, s[4:7], 0 offen
    buffer_load_dword v38, v31, s[4:7], 0 offen
    buffer_load_dword v38, v31, s[4:7], 0 offen
    s_mov_b64 s[58:59], 0
    s_mov_b64 s[60:61], 0
    s_mov_b64 s[54:55], 0
    s_branch L_cg_w2_dre3
L_cg_w2_dloop:
    s_cmp_eq_u64 s[58:59], 0
    s_cbranch_scc1 L_cg_w2_dsk0
    s_waitcnt vmcnt(3)
    v_cndmask_b32 v112, 0, v104, s[58:59]
    v_cndmask_b32 v113, 0, v105, s[58:59]
    v_cndmask_b32 v114, 0, v106, s[58:59]
    v_cndmask_b32 v115, 0, v107, s[58:59]
    s_or_b64 s[62:63], s[60:61], s[54:55]
    s_or_b64 s[62:63], s[62:63], s[56:57]
    v_smfmac_f32_16x16x64_bf16 v[58:61], v[112:115], a[96:103], v5
    v_min3_i32 v36, v112, v113, v114
    v_smfmac_f32_16x16x64_bf16 v[62:65], v[112:115], a[104:111], v5
    v_min_i32 v36, v36, v115
    v_smfmac_f32_16x16x64_bf16 v[66:69], v[112:115], a[112:119], v5
    v_cmp_eq_u32 vcc, s43, v36
    v_smfmac_f32_16x16x64_bf16 v[70:73], v[112:115], a[120:127], v5
    s_or_b64 s[62:63], s[62:63], vcc
    s_cbranch_scc0 L_cg_w2_ddone
    s_cbranch_vccz L_cg_w2_dok0
L_cg_w2_dre0:
    s_mov_b64 exec, vcc
    buffer_load_dwordx4 v[104:107], v6, s[4:7], s27 offen offset:2048 sc1
    s_mov_b64 exec, -1
    s_mov_b64 s[58:59], vcc
    s_branch L_cg_w2_dnx0
L_cg_w2_dok0:
    s_mov_b64 s[58:59], 0
L_cg_w2_dsk0:
    buffer_load_dword v38, v31, s[4:7], 0 offen
L_cg_w2_dnx0:
    s_cmp_eq_u64 s[60:61], 0
    s_cbranch_scc1 L_cg_w2_dsk1
    s_waitcnt vmcnt(3)
    v_cndmask_b32 v112, 0, v108, s[60:61]
    v_cndmask_b32 v113, 0, v109, s[60:61]
    v_cndmask_b32 v114, 0, v110, s[60:61]
    v_cndmask_b32 v115, 0, v111, s[60:61]
    s_or_b64 s[62:63], s[58:59], s[54:55]
    s_or_b64 s[62:63], s[62:63], s[56:57]
    v_smfmac_f32_16x16x64_bf16 v[58:61], v[112:115], a[144:151], v5
    v_min3_i32 v36, v112, v113, v114
    v_smfmac_f32_16x16x64_bf16 v[62:65], v[112:115], a[152:159], v5
    v_min_i32 v36, v36, v115
    v_smfmac_f32_16x16x64_bf16 v[66:69], v[112:115], a[160:167], v5
    v_cmp_eq_u32 vcc, s43, v36
    v_smfmac_f32_16x16x64_bf16 v[70:73], v[112:115], a[168:175], v5
    s_or_b64 s[62:63], s[62:63], vcc
    s_cbranch_scc0 L_cg_w2_ddone
    s_cbranch_vccz L_cg_w2_dok1
L_cg_w2_dre1:
    s_mov_b64 exec, vcc
    buffer_load_dwordx4 v[108:111], v6, s[4:7], s27 offen offset:3072 sc1
    s_mov_b64 exec, -1
    s_mov_b64 s[60:61], vcc
    s_branch L_cg_w2_dnx1
L_cg_w2_dok1:
    s_mov_b64 s[60:61], 0
L_cg_w2_dsk1:
    buffer_load_dword v38, v31, s[4:7], 0 offen
L_cg_w2_dnx1:
    s_cmp_eq_u64 s[54:55], 0
    s_cbranch_scc1 L_cg_w2_dsk2
    s_waitcnt vmcnt(3)
    v_cndmask_b32 v112, 0, v96, s[54:55]
    v_cndmask_b32 v113, 0, v97, s[54:55]
    v_cndmask_b32 v114, 0, v98, s[54:55]
    v_cndmask_b32 v115, 0, v99, s[54:55]
    s_or_b64 s[62:63], s[58:59], s[60:61]
    s_or_b64 s[62:63], s[62:63], s[56:57]
    v_smfmac_f32_16x16x64_bf16 v[58:61], v[112:115], a[0:7], v5
    v_min3_i32 v36, v112, v113, v114
    v_smfmac_f32_16x16x64_bf16 v[62:65], v[112:115], a[8:15], v5
    v_min_i32 v36, v36, v115
    v_smfmac_f32_16x16x64_bf16 v[66:69], v[112:115], a[16:23], v5
    v_cmp_eq_u32 vcc, s43, v36
    v_smfmac_f32_16x16x64_bf16 v[70:73], v[112:115], a[24:31], v5
    s_or_b64 s[62:63], s[62:63], vcc
    s_cbranch_scc0 L_cg_w2_ddone
    s_cbranch_vccz L_cg_w2_dok2
L_cg_w2_dre2:
    s_mov_b64 exec, vcc
    buffer_load_dwordx4 v[96:99], v6, s[4:7], s27 offen offset:0 sc1
    s_mov_b64 exec, -1
    s_mov_b64 s[54:55], vcc
    s_branch L_cg_w2_dnx2
L_cg_w2_dok2:
    s_mov_b64 s[54:55], 0
L_cg_w2_dsk2:
    buffer_load_dword v38, v31, s[4:7], 0 offen
L_cg_w2_dnx2:
    s_cmp_eq_u64 s[56:57], 0
    s_cbranch_scc1 L_cg_w2_dsk3
    s_waitcnt vmcnt(3)
    v_cndmask_b32 v112, 0, v100, s[56:57]
    v_cndmask_b32 v113, 0, v101, s[56:57]
    v_cndmask_b32 v114, 0, v102, s[56:57]
    v_cndmask_b32 v115, 0, v103, s[56:57]
    s_or_b64 s[62:63], s[58:59], s[60:61]
    s_or_b64 s[62:63], s[62:63], s[54:55]
    v_smfmac_f32_16x16x64_bf16 v[58:61], v[112:115], a[48:55], v5
    v_min3_i32 v36, v112, v113, v114
    v_smfmac_f32_16x16x64_bf16 v[62:65], v[112:115], a[56:63], v5
    v_min_i32 v36, v36, v115
    v_smfmac_f32_16x16x64_bf16 v[66:69], v[112:115], a[64:71], v5
    v_cmp_eq_u32 vcc, s43, v36
    v_smfmac_f32_16x16x64_bf16 v[70:73], v[112:115], a[72:79], v5
    s_or_b64 s[62:63], s[62:63], vcc
    s_cbranch_scc0 L_cg_w2_ddone
    s_cbranch_vccz L_cg_w2_dok3
L_cg_w2_dre3:
    s_mov_b64 exec, vcc
    buffer_load_dwordx4 v[100:103], v6, s[4:7], s27 offen offset:1024 sc1
    s_mov_b64 exec, -1
    s_mov_b64 s[56:57], vcc
    s_branch L_cg_w2_dnx3
L_cg_w2_dok3:
    s_mov_b64 s[56:57], 0
L_cg_w2_dsk3:
    buffer_load_dword v38, v31, s[4:7], 0 offen
L_cg_w2_dnx3:
    s_add_u32 s36, s36, 1
    s_cmp_lt_u32 s36, 400000
    s_cbranch_scc1 L_cg_w2_dloop
    s_branch L_done
L_cg_w2_bslow:
    s_mov_b64 exec, -1
    v_max_u32 v36, v116, v117
    v_max3_u32 v36, v36, v118, v119
    v_max3_u32 v36, v36, v120, v121
    v_max3_u32 v36, v36, v122, v123
    v_max3_u32 v36, v36, v124, v125
    v_max3_u32 v36, v36, v126, v127
    v_max3_u32 v36, v36, v128, v129
    v_max3_u32 v36, v36, v130, v131
    v_max3_u32 v36, v36, v132, v133
    v_max3_u32 v36, v36, v134, v135
    v_max3_u32 v36, v36, v136, v137
    v_max3_u32 v36, v36, v138, v139
    v_max3_u32 v36, v36, v140, v141
    v_max3_u32 v36, v36, v142, v143
    v_max3_u32 v36, v36, v144, v145
    v_max3_u32 v36, v36, v146, v147
    v_max3_u32 v36, v36, v148, v149
    v_max3_u32 v36, v36, v150, v151
    v_max3_u32 v36, v36, v152, v153
    v_max3_u32 v36, v36, v154, v155
    v_max3_u32 v36, v36, v156, v157
    v_max3_u32 v36, v36, v158, v159
    v_max3_u32 v36, v36, v160, v161
    v_max3_u32 v36, v36, v162, v163
    v_max3_u32 v36, v36, v164, v165
    v_max3_u32 v36, v36, v166, v167
    v_max3_u32 v36, v36, v168, v169
    v_max3_u32 v36, v36, v170, v171
    v_max3_u32 v36, v36, v172, v173
    v_max3_u32 v36, v36, v174, v175
    v_max3_u32 v36, v36, v176, v177
    v_max3_u32 v36, v36, v178, v179
    v_cmp_eq_u32 vcc, -1, v36
    s_cbranch_vccnz L_cg_w2_bagain
    buffer_store_dwordx2 v[86:87], v15, s[4:7], s30 offen sc1
    s_branch L_cg_w2_bgood
L_cg_w2_bagain:
    ds_write_b32 v37, v50 offset:19456
    v_mov_b32 v82, 0
    v_mov_b32 v83, 0
    v_mov_b32 v84, 0
    v_mov_b32 v85, 0
    s_add_u32 s36, s36, 1
    s_cmp_gt_u32 s36, 400000
    s_cbranch_scc1 L_done
    s_waitcnt lgkmcnt(0)
    s_barrier
    buffer_load_dwordx4 v6, s[4:7], s28 offen offset:2048 sc1 lds
    s_nop 3
    buffer_load_dwordx4 v6, s[4:7], s28 offen offset:3072 sc1 lds
    s_nop 3
    buffer_load_dwordx4 v6, s[4:7], s28 offen offset:0 sc1 lds
    s_nop 3
    buffer_load_dwordx4 v6, s[4:7], s28 offen offset:1024 sc1 lds
    s_branch L_cg_w2_bwait
L_cg_w2_done:
    s_branch L_done
L_cg_w3:
    v_mov_b32 v58, 0
    v_mov_b32 v59, 0
    v_mov_b32 v60, 0
    v_mov_b32 v61, 0
    v_mov_b32 v62, 0
    v_mov_b32 v63, 0
    v_mov_b32 v64, 0
    v_mov_b32 v65, 0
    v_mov_b32 v66, 0
    v_mov_b32 v67, 0
    v_mov_b32 v68, 0
    v_mov_b32 v69, 0
    v_mov_b32 v70, 0
    v_mov_b32 v71, 0
    v_mov_b32 v72, 0
    v_mov_b32 v73, 0
    v_mov_b32 v74, 0
    v_mov_b32 v75, 0
    v_mov_b32 v76, 0
    v_mov_b32 v77, 0
    v_mov_b32 v78, 0
    v_mov_b32 v79, 0
    v_mov_b32 v80, 0
    v_mov_b32 v81, 0
    s_waitcnt vmcnt(0)
    s_barrier
    buffer_load_dwordx4 v[108:111], v6, s[4:7], s27 offen offset:3072 sc1
    s_nop 3
    buffer_load_dwordx4 v[104:107], v6, s[4:7], s27 offen offset:2048 sc1
    s_nop 3
    buffer_load_dwordx4 v[100:103], v6, s[4:7], s27 offen offset:1024 sc1
    s_nop 3
    buffer_load_dwordx4 v[96:99], v6, s[4:7], s27 offen offset:0 sc1
L_cg_w3_loop:
    s_and_b32 s33, s26, 3
    s_add_u32 s28, s27, 262144
    s_lshl_b32 s34, s33, 16
    s_add_u32 s29, s42, s34
    v_add_u32 v30, 1, v30
    s_waitcnt vmcnt(3)
    v_smfmac_f32_16x16x64_bf16 v[58:61], v[108:111], a[144:151], v5
    v_min3_i32 v36, v108, v109, v110
    v_smfmac_f32_16x16x64_bf16 v[62:65], v[108:111], a[152:159], v5
    v_min_i32 v36, v36, v111
    v_smfmac_f32_16x16x64_bf16 v[66:69], v[108:111], a[160:167], v5
    v_cmp_eq_u32 vcc, s43, v36
    v_smfmac_f32_16x16x64_bf16 v[70:73], v[108:111], a[168:175], v5
    s_cbranch_vccnz L_cg_w3_din0
    s_waitcnt vmcnt(2)
    v_smfmac_f32_16x16x64_bf16 v[58:61], v[104:107], a[96:103], v5
    v_min3_i32 v36, v104, v105, v106
    v_smfmac_f32_16x16x64_bf16 v[62:65], v[104:107], a[104:111], v5
    v_min_i32 v36, v36, v107
    v_smfmac_f32_16x16x64_bf16 v[66:69], v[104:107], a[112:119], v5
    v_cmp_eq_u32 vcc, s43, v36
    v_smfmac_f32_16x16x64_bf16 v[70:73], v[104:107], a[120:127], v5
    s_cbranch_vccnz L_cg_w3_din1
    s_waitcnt vmcnt(1)
    v_smfmac_f32_16x16x64_bf16 v[58:61], v[100:103], a[48:55], v5
    v_min3_i32 v36, v100, v101, v102
    v_smfmac_f32_16x16x64_bf16 v[62:65], v[100:103], a[56:63], v5
    v_min_i32 v36, v36, v103
    v_smfmac_f32_16x16x64_bf16 v[66:69], v[100:103], a[64:71], v5
    v_cmp_eq_u32 vcc, s43, v36
    v_smfmac_f32_16x16x64_bf16 v[70:73], v[100:103], a[72:79], v5
    s_cbranch_vccnz L_cg_w3_din2
    s_waitcnt vmcnt(0)
    v_smfmac_f32_16x16x64_bf16 v[58:61], v[96:99], a[0:7], v5
    v_min3_i32 v36, v96, v97, v98
    v_smfmac_f32_16x16x64_bf16 v[62:65], v[96:99], a[8:15], v5
    v_min_i32 v36, v36, v99
    v_smfmac_f32_16x16x64_bf16 v[66:69], v[96:99], a[16:23], v5
    v_cmp_eq_u32 vcc, s43, v36
    v_smfmac_f32_16x16x64_bf16 v[70:73], v[96:99], a[24:31], v5
    s_cbranch_vccnz L_cg_w3_din3
L_cg_w3_ddone:
    s_nop 0
    v_pk_add_f32 v[86:87], v[58:59], v[60:61]
    ds_write2_b32 v7, v86, v87 offset0:0 offset1:36
    v_pk_add_f32 v[88:89], v[62:63], v[64:65]
    ds_write2_b32 v7, v88, v89 offset0:16 offset1:52
    v_pk_add_f32 v[90:91], v[66:67], v[68:69]
    ds_write2_b32 v8, v90, v91 offset0:0 offset1:36
    v_pk_add_f32 v[92:93], v[70:71], v[72:73]
    ds_write2_b32 v8, v92, v93 offset0:16 offset1:52
    v_smfmac_f32_16x16x64_bf16 v[74:77], v[96:99], a[32:39], v5
    v_smfmac_f32_16x16x64_bf16 v[78:81], v[96:99], a[40:47], v5
    v_smfmac_f32_16x16x64_bf16 v[74:77], v[100:103], a[80:87], v5
    v_smfmac_f32_16x16x64_bf16 v[78:81], v[100:103], a[88:95], v5
    s_waitcnt lgkmcnt(0)
    s_barrier
    v_smfmac_f32_16x16x64_bf16 v[74:77], v[104:107], a[128:135], v5
    v_smfmac_f32_16x16x64_bf16 v[78:81], v[104:107], a[136:143], v5
    v_smfmac_f32_16x16x64_bf16 v[74:77], v[108:111], a[176:183], v5
    v_smfmac_f32_16x16x64_bf16 v[78:81], v[108:111], a[184:191], v5
    s_nop 7
    v_pk_add_f32 v[86:87], v[74:75], v[76:77]
    v_pk_add_f32 v[88:89], v[78:79], v[80:81]
    ds_write_b128 v10, v[86:89] offset:14336
    s_waitcnt lgkmcnt(0)
    s_barrier
    s_cmp_eq_u32 s26, 63
    s_cbranch_scc1 L_cg_w3_done
    s_lshr_b32 s34, s26, 3
    s_lshr_b32 s34, s19, s34
    s_and_b32 s34, s34, 1
    s_lshl_b32 s34, s34, 13
    s_lshl_b32 s30, s26, 18
    s_add_u32 s30, s30, s34
    s_add_u32 s30, s30, 134217728
    s_mov_b32 m0, 32768
    v_mov_b32 v82, 0
    v_mov_b32 v83, 0
    v_mov_b32 v84, 0
    v_mov_b32 v85, 0
    s_xor_b32 s37, s27, 0x8000
    s_xor_b32 s38, s29, 0x20000
    s_barrier
    buffer_load_dwordx4 v6, s[4:7], s28 offen offset:3072 sc1 lds
    s_nop 3
    buffer_load_dwordx4 v6, s[4:7], s28 offen offset:2048 sc1 lds
    s_nop 3
    buffer_load_dwordx4 v6, s[4:7], s28 offen offset:1024 sc1 lds
    s_nop 3
    buffer_load_dwordx4 v6, s[4:7], s28 offen offset:0 sc1 lds
    s_add_u32 s26, s26, 1
    s_and_b32 s35, s26, 3
    s_lshl_b32 s35, s35, 14
    s_add_u32 s27, s41, s35
    v_mov_b32 v58, 0
    v_mov_b32 v59, 0
    v_mov_b32 v60, 0
    v_mov_b32 v61, 0
    v_mov_b32 v62, 0
    v_mov_b32 v63, 0
    v_mov_b32 v64, 0
    v_mov_b32 v65, 0
    v_mov_b32 v66, 0
    v_mov_b32 v67, 0
    v_mov_b32 v68, 0
    v_mov_b32 v69, 0
    v_mov_b32 v70, 0
    v_mov_b32 v71, 0
    v_mov_b32 v72, 0
    v_mov_b32 v73, 0
    v_mov_b32 v74, 0
    v_mov_b32 v75, 0
    v_mov_b32 v76, 0
    v_mov_b32 v77, 0
    v_mov_b32 v78, 0
    v_mov_b32 v79, 0
    v_mov_b32 v80, 0
    v_mov_b32 v81, 0
L_cg_w3_bwait:
    s_waitcnt vmcnt(3)
    s_barrier
    ds_read_b128 v[116:119], v2 offset:20480
    ds_read_b128 v[136:139], v2 offset:25600
    ds_read_b128 v[156:159], v2 offset:30720
    ds_read_b128 v[176:179], v2 offset:35840
    s_waitcnt lgkmcnt(3)
    v_smfmac_f32_16x16x64_bf16 v[82:85], v[116:119], a[192:199], v5
    s_waitcnt vmcnt(2)
    s_barrier
    ds_read_b128 v[120:123], v2 offset:21504
    ds_read_b128 v[132:135], v2 offset:24576
    ds_read_b128 v[160:163], v2 offset:31744
    ds_read_b128 v[172:175], v2 offset:34816
    s_waitcnt lgkmcnt(6)
    v_smfmac_f32_16x16x64_bf16 v[82:85], v[136:139], a[232:239], v5
    s_waitcnt lgkmcnt(5)
    v_smfmac_f32_16x16x64_bf16 v[82:85], v[156:159], v[196:203], v5
    s_waitcnt lgkmcnt(4)
    v_smfmac_f32_16x16x64_bf16 v[82:85], v[176:179], v[236:243], v5
    s_waitcnt lgkmcnt(3)
    v_smfmac_f32_16x16x64_bf16 v[82:85], v[120:123], a[200:207], v5
    s_waitcnt vmcnt(1)
    s_barrier
    ds_read_b128 v[124:127], v2 offset:22528
    ds_read_b128 v[144:147], v2 offset:27648
    ds_read_b128 v[148:151], v2 offset:28672
    ds_read_b128 v[168:171], v2 offset:33792
    s_waitcnt lgkmcnt(6)
    v_smfmac_f32_16x16x64_bf16 v[82:85], v[132:135], a[224:231], v5
    s_waitcnt lgkmcnt(5)
    v_smfmac_f32_16x16x64_bf16 v[82:85], v[160:163], v[204:211], v5
    s_waitcnt lgkmcnt(4)
    v_smfmac_f32_16x16x64_bf16 v[82:85], v[172:175], v[228:235], v5
    s_waitcnt lgkmcnt(3)
    v_smfmac_f32_16x16x64_bf16 v[82:85], v[124:127], a[208:215], v5
    s_waitcnt vmcnt(0)
    s_barrier
    ds_read_b128 v[128:131], v2 offset:23552
    ds_read_b128 v[140:143], v2 offset:26624
    ds_read_b128 v[152:155], v2 offset:29696
    ds_read_b128 v[164:167], v2 offset:32768
    s_waitcnt lgkmcnt(6)
    v_smfmac_f32_16x16x64_bf16 v[82:85], v[144:147], a[248:255], v5
    s_waitcnt lgkmcnt(5)
    v_smfmac_f32_16x16x64_bf16 v[82:85], v[148:151], v[180:187], v5
    s_waitcnt lgkmcnt(4)
    v_smfmac_f32_16x16x64_bf16 v[82:85], v[168:171], v[220:227], v5
    s_waitcnt lgkmcnt(3)
    v_smfmac_f32_16x16x64_bf16 v[82:85], v[128:131], a[216:223], v5
    s_waitcnt lgkmcnt(2)
    v_smfmac_f32_16x16x64_bf16 v[82:85], v[140:143], a[240:247], v5
    s_waitcnt lgkmcnt(1)
    v_smfmac_f32_16x16x64_bf16 v[82:85], v[152:155], v[188:195], v5
    s_waitcnt lgkmcnt(0)
    v_smfmac_f32_16x16x64_bf16 v[82:85], v[164:167], v[212:219], v5
    s_nop 7
    v_pk_add_f32 v[86:87], v[82:83], v[84:85]
    v_cmpx_o_f32 vcc, v86, v87
    buffer_store_dwordx2 v[86:87], v15, s[4:7], s30 offen sc1
    s_cmp_eq_u64 exec, -1
    s_cbranch_scc0 L_cg_w3_bslow
L_cg_w3_bgood:
    ds_write_b64 v3, v[86:87] offset:18944
    s_add_u32 s34, s37, 262144
    buffer_store_dwordx4 v[54:57], v21, s[4:7], s37 offen sc1
    buffer_store_dwordx4 v[50:53], v21, s[4:7], s34 offen sc1
    buffer_store_dwordx4 v[50:53], v22, s[4:7], s38 offen sc1
    buffer_store_dwordx4 v[50:53], v23, s[4:7], s38 offen offset:1024 sc1
    s_waitcnt lgkmcnt(0)
    s_barrier
    s_nop 15
    s_nop 15
    s_nop 15
    s_nop 15
    s_nop 15
    s_nop 15
    s_nop 8
    buffer_store_dword v30, v25, s[4:7], s45 offen offset:2048 sc1
    s_barrier
    buffer_load_dwordx4 v[108:111], v6, s[4:7], s27 offen offset:3072 sc1
    s_nop 3
    buffer_load_dwordx4 v[104:107], v6, s[4:7], s27 offen offset:2048 sc1
    s_nop 3
    buffer_load_dwordx4 v[100:103], v6, s[4:7], s27 offen offset:1024 sc1
    s_nop 3
    buffer_load_dwordx4 v[96:99], v6, s[4:7], s27 offen offset:0 sc1
    s_branch L_cg_w3_loop
L_cg_w3_din0:
    s_mov_b64 s[58:59], -1
    s_mov_b64 s[56:57], -1
    s_mov_b64 s[54:55], -1
    s_branch L_cg_w3_dre0
L_cg_w3_din1:
    buffer_load_dword v38, v31, s[4:7], 0 offen
    s_mov_b64 s[60:61], 0
    s_mov_b64 s[56:57], -1
    s_mov_b64 s[54:55], -1
    s_branch L_cg_w3_dre1
L_cg_w3_din2:
    buffer_load_dword v38, v31, s[4:7], 0 offen
    buffer_load_dword v38, v31, s[4:7], 0 offen
    s_mov_b64 s[60:61], 0
    s_mov_b64 s[58:59], 0
    s_mov_b64 s[54:55], -1
    s_branch L_cg_w3_dre2
L_cg_w3_din3:
    buffer_load_dword v38, v31, s[4:7], 0 offen
    buffer_load_dword v38, v31, s[4:7], 0 offen
    buffer_load_dword v38, v31, s[4:7], 0 offen
    s_mov_b64 s[60:61], 0
    s_mov_b64 s[58:59], 0
    s_mov_b64 s[56:57], 0
    s_branch L_cg_w3_dre3
L_cg_w3_dloop:
    s_cmp_eq_u64 s[60:61], 0
    s_cbranch_scc1 L_cg_w3_dsk0
    s_waitcnt vmcnt(3)
    v_cndmask_b32 v112, 0, v108, s[60:61]
    v_cndmask_b32 v113, 0, v109, s[60:61]
    v_cndmask_b32 v114, 0, v110, s[60:61]
    v_cndmask_b32 v115, 0, v111, s[60:61]
    s_or_b64 s[62:63], s[58:59], s[56:57]
    s_or_b64 s[62:63], s[62:63], s[54:55]
    v_smfmac_f32_16x16x64_bf16 v[58:61], v[112:115], a[144:151], v5
    v_min3_i32 v36, v112, v113, v114
    v_smfmac_f32_16x16x64_bf16 v[62:65], v[112:115], a[152:159], v5
    v_min_i32 v36, v36, v115
    v_smfmac_f32_16x16x64_bf16 v[66:69], v[112:115], a[160:167], v5
    v_cmp_eq_u32 vcc, s43, v36
    v_smfmac_f32_16x16x64_bf16 v[70:73], v[112:115], a[168:175], v5
    s_or_b64 s[62:63], s[62:63], vcc
    s_cbranch_scc0 L_cg_w3_ddone
    s_cbranch_vccz L_cg_w3_dok0
L_cg_w3_dre0:
    s_mov_b64 exec, vcc
    buffer_load_dwordx4 v[108:111], v6, s[4:7], s27 offen offset:3072 sc1
    s_mov_b64 exec, -1
    s_mov_b64 s[60:61], vcc
    s_branch L_cg_w3_dnx0
L_cg_w3_dok0:
    s_mov_b64 s[60:61], 0
L_cg_w3_dsk0:
    buffer_load_dword v38, v31, s[4:7], 0 offen
L_cg_w3_dnx0:
    s_cmp_eq_u64 s[58:59], 0
    s_cbranch_scc1 L_cg_w3_dsk1
    s_waitcnt vmcnt(3)
    v_cndmask_b32 v112, 0, v104, s[58:59]
    v_cndmask_b32 v113, 0, v105, s[58:59]
    v_cndmask_b32 v114, 0, v106, s[58:59]
    v_cndmask_b32 v115, 0, v107, s[58:59]
    s_or_b64 s[62:63], s[60:61], s[56:57]
    s_or_b64 s[62:63], s[62:63], s[54:55]
    v_smfmac_f32_16x16x64_bf16 v[58:61], v[112:115], a[96:103], v5
    v_min3_i32 v36, v112, v113, v114
    v_smfmac_f32_16x16x64_bf16 v[62:65], v[112:115], a[104:111], v5
    v_min_i32 v36, v36, v115
    v_smfmac_f32_16x16x64_bf16 v[66:69], v[112:115], a[112:119], v5
    v_cmp_eq_u32 vcc, s43, v36
    v_smfmac_f32_16x16x64_bf16 v[70:73], v[112:115], a[120:127], v5
    s_or_b64 s[62:63], s[62:63], vcc
    s_cbranch_scc0 L_cg_w3_ddone
    s_cbranch_vccz L_cg_w3_dok1
L_cg_w3_dre1:
    s_mov_b64 exec, vcc
    buffer_load_dwordx4 v[104:107], v6, s[4:7], s27 offen offset:2048 sc1
    s_mov_b64 exec, -1
    s_mov_b64 s[58:59], vcc
    s_branch L_cg_w3_dnx1
L_cg_w3_dok1:
    s_mov_b64 s[58:59], 0
L_cg_w3_dsk1:
    buffer_load_dword v38, v31, s[4:7], 0 offen
L_cg_w3_dnx1:
    s_cmp_eq_u64 s[56:57], 0
    s_cbranch_scc1 L_cg_w3_dsk2
    s_waitcnt vmcnt(3)
    v_cndmask_b32 v112, 0, v100, s[56:57]
    v_cndmask_b32 v113, 0, v101, s[56:57]
    v_cndmask_b32 v114, 0, v102, s[56:57]
    v_cndmask_b32 v115, 0, v103, s[56:57]
    s_or_b64 s[62:63], s[60:61], s[58:59]
    s_or_b64 s[62:63], s[62:63], s[54:55]
    v_smfmac_f32_16x16x64_bf16 v[58:61], v[112:115], a[48:55], v5
    v_min3_i32 v36, v112, v113, v114
    v_smfmac_f32_16x16x64_bf16 v[62:65], v[112:115], a[56:63], v5
    v_min_i32 v36, v36, v115
    v_smfmac_f32_16x16x64_bf16 v[66:69], v[112:115], a[64:71], v5
    v_cmp_eq_u32 vcc, s43, v36
    v_smfmac_f32_16x16x64_bf16 v[70:73], v[112:115], a[72:79], v5
    s_or_b64 s[62:63], s[62:63], vcc
    s_cbranch_scc0 L_cg_w3_ddone
    s_cbranch_vccz L_cg_w3_dok2
L_cg_w3_dre2:
    s_mov_b64 exec, vcc
    buffer_load_dwordx4 v[100:103], v6, s[4:7], s27 offen offset:1024 sc1
    s_mov_b64 exec, -1
    s_mov_b64 s[56:57], vcc
    s_branch L_cg_w3_dnx2
L_cg_w3_dok2:
    s_mov_b64 s[56:57], 0
L_cg_w3_dsk2:
    buffer_load_dword v38, v31, s[4:7], 0 offen
L_cg_w3_dnx2:
    s_cmp_eq_u64 s[54:55], 0
    s_cbranch_scc1 L_cg_w3_dsk3
    s_waitcnt vmcnt(3)
    v_cndmask_b32 v112, 0, v96, s[54:55]
    v_cndmask_b32 v113, 0, v97, s[54:55]
    v_cndmask_b32 v114, 0, v98, s[54:55]
    v_cndmask_b32 v115, 0, v99, s[54:55]
    s_or_b64 s[62:63], s[60:61], s[58:59]
    s_or_b64 s[62:63], s[62:63], s[56:57]
    v_smfmac_f32_16x16x64_bf16 v[58:61], v[112:115], a[0:7], v5
    v_min3_i32 v36, v112, v113, v114
    v_smfmac_f32_16x16x64_bf16 v[62:65], v[112:115], a[8:15], v5
    v_min_i32 v36, v36, v115
    v_smfmac_f32_16x16x64_bf16 v[66:69], v[112:115], a[16:23], v5
    v_cmp_eq_u32 vcc, s43, v36
    v_smfmac_f32_16x16x64_bf16 v[70:73], v[112:115], a[24:31], v5
    s_or_b64 s[62:63], s[62:63], vcc
    s_cbranch_scc0 L_cg_w3_ddone
    s_cbranch_vccz L_cg_w3_dok3
L_cg_w3_dre3:
    s_mov_b64 exec, vcc
    buffer_load_dwordx4 v[96:99], v6, s[4:7], s27 offen offset:0 sc1
    s_mov_b64 exec, -1
    s_mov_b64 s[54:55], vcc
    s_branch L_cg_w3_dnx3
L_cg_w3_dok3:
    s_mov_b64 s[54:55], 0
L_cg_w3_dsk3:
    buffer_load_dword v38, v31, s[4:7], 0 offen
L_cg_w3_dnx3:
    s_add_u32 s36, s36, 1
    s_cmp_lt_u32 s36, 400000
    s_cbranch_scc1 L_cg_w3_dloop
    s_branch L_done
L_cg_w3_bslow:
    s_mov_b64 exec, -1
    v_max_u32 v36, v116, v117
    v_max3_u32 v36, v36, v118, v119
    v_max3_u32 v36, v36, v120, v121
    v_max3_u32 v36, v36, v122, v123
    v_max3_u32 v36, v36, v124, v125
    v_max3_u32 v36, v36, v126, v127
    v_max3_u32 v36, v36, v128, v129
    v_max3_u32 v36, v36, v130, v131
    v_max3_u32 v36, v36, v132, v133
    v_max3_u32 v36, v36, v134, v135
    v_max3_u32 v36, v36, v136, v137
    v_max3_u32 v36, v36, v138, v139
    v_max3_u32 v36, v36, v140, v141
    v_max3_u32 v36, v36, v142, v143
    v_max3_u32 v36, v36, v144, v145
    v_max3_u32 v36, v36, v146, v147
    v_max3_u32 v36, v36, v148, v149
    v_max3_u32 v36, v36, v150, v151
    v_max3_u32 v36, v36, v152, v153
    v_max3_u32 v36, v36, v154, v155
    v_max3_u32 v36, v36, v156, v157
    v_max3_u32 v36, v36, v158, v159
    v_max3_u32 v36, v36, v160, v161
    v_max3_u32 v36, v36, v162, v163
    v_max3_u32 v36, v36, v164, v165
    v_max3_u32 v36, v36, v166, v167
    v_max3_u32 v36, v36, v168, v169
    v_max3_u32 v36, v36, v170, v171
    v_max3_u32 v36, v36, v172, v173
    v_max3_u32 v36, v36, v174, v175
    v_max3_u32 v36, v36, v176, v177
    v_max3_u32 v36, v36, v178, v179
    v_cmp_eq_u32 vcc, -1, v36
    s_cbranch_vccnz L_cg_w3_bagain
    buffer_store_dwordx2 v[86:87], v15, s[4:7], s30 offen sc1
    s_branch L_cg_w3_bgood
L_cg_w3_bagain:
    v_mov_b32 v82, 0
    v_mov_b32 v83, 0
    v_mov_b32 v84, 0
    v_mov_b32 v85, 0
    s_add_u32 s36, s36, 1
    s_cmp_gt_u32 s36, 400000
    s_cbranch_scc1 L_done
    s_waitcnt lgkmcnt(0)
    s_barrier
    buffer_load_dwordx4 v6, s[4:7], s28 offen offset:3072 sc1 lds
    s_nop 3
    buffer_load_dwordx4 v6, s[4:7], s28 offen offset:2048 sc1 lds
    s_nop 3
    buffer_load_dwordx4 v6, s[4:7], s28 offen offset:1024 sc1 lds
    s_nop 3
    buffer_load_dwordx4 v6, s[4:7], s28 offen offset:0 sc1 lds
    s_branch L_cg_w3_bwait
L_cg_w3_done:
    s_branch L_done
.section .rodata,"a"
.p2align 6
.amdhsa_kernel concat_heads__memory_aug_recurrent_mem_tr__ssm_conv_s4__prompt_kernel
  .amdhsa_next_free_vgpr 512
  .amdhsa_next_free_sgpr 102
  .amdhsa_accum_offset 256
  .amdhsa_group_segment_fixed_size 0
  .amdhsa_kernarg_size 152
  .amdhsa_user_sgpr_count 2
  .amdhsa_user_sgpr_kernarg_segment_ptr 1
  .amdhsa_system_sgpr_workgroup_id_x 1
  .amdhsa_float_denorm_mode_32 3
.end_amdhsa_kernel
```

```asm
; @launch grid=(256,1,1) block=(256,1,1) lds=153600
.amdgcn_target "amdgcn-amd-amdhsa--gfx950"
.text
.globl concat_heads__memory_aug_recurrent_mem_tr__ssm_conv_s4__prompt_kernel
.p2align 8
.type concat_heads__memory_aug_recurrent_mem_tr__ssm_conv_s4__prompt_kernel,@function
concat_heads__memory_aug_recurrent_mem_tr__ssm_conv_s4__prompt_kernel:
 s_cmp_ge_u32 s2, 256
 s_cbranch_scc1 L_exit
 s_load_dwordx2 s[4:5], s[0:1], 144
 s_load_dwordx2 s[12:13], s[0:1], 136
 s_load_dwordx8 s[16:23], s[0:1], 16
 s_load_dwordx16 s[68:83], s[0:1], 64
 s_load_dwordx2 s[84:85], s[0:1], 56
 s_getreg_b32 s24, hwreg(HW_REG_XCC_ID, 0, 4)
 v_lshrrev_b32 v1, 6, v0
 s_mov_b32 s6, 0xf000000
 s_mov_b32 s7, 0x20000
 v_readfirstlane_b32 s26, v1
 s_mov_b32 s14, 256
 s_mov_b32 s15, 0x20000
 s_mov_b32 s27, 0
 s_mov_b32 s29, 0
 s_mov_b32 s30, 224
 s_and_b32 s32, s2, 7
 s_lshl_b32 s32, s32, 5
 s_lshr_b32 s28, s2, 3
 s_add_u32 s28, s28, s32
 s_waitcnt lgkmcnt(0)
 s_add_u32 s4, s4, 0x1fffff
 s_addc_u32 s5, s5, 0
 s_and_b32 s4, s4, 0xffe00000
 v_mov_b32 v2, 153536
 s_mov_b64 s[34:35], 1
 s_cmp_lg_u32 s26, 0
 s_cbranch_scc1 L_start
 s_and_b32 s32, s24, 3
 s_lshl_b32 s32, s32, 6
 s_and_b32 s33, s24, 12
 s_add_u32 s32, s32, s33
 v_mov_b32 v3, s32
 v_mov_b32 v4, 1
 s_mov_b64 exec, 1
 buffer_atomic_add v4, v3, s[12:15], 0 offen sc0 sc1
 s_mov_b64 exec, -1
L_start:
 s_mul_i32 s94, s26, 21888
 s_add_u32 s94, s94, 65536
 v_and_b32 v64, 63, v0
 s_lshl_b32 s92, s28, 2
 s_add_u32 s92, s92, s26
 s_lshl_b32 s93, s92, 8
 v_lshl_add_u32 v65, v64, 2, s93
 s_lshl_b32 s93, s92, 1
 v_mov_b32 v66, s93
 s_mov_b32 s86, 4194304
 s_mov_b32 s87, 0x20000
 s_mov_b32 s96, 0x05040100
 s_mov_b32 s97, 0x07060302
 s_mov_b32 s98, 0xffff0000
 v_lshlrev_b32 v70, 14, v0
 s_lshl_b32 s93, s28, 3
 global_load_dword v88, v65, s[68:69]
 global_load_dword v89, v65, s[70:71]
 global_load_dword v90, v65, s[72:73]
 global_load_dword v91, v65, s[74:75]
 global_load_dword v92, v65, s[76:77]
 global_load_dword v93, v65, s[78:79]
 global_load_ushort v94, v66, s[80:81]
 s_load_dwordx2 s[88:89], s[82:83], s93
 s_and_b32 s92, s28, 15
 s_lshl_b32 s92, s92, 18
 s_add_u32 s92, s92, s93
 v_lshrrev_b32 v65, 1, v0
 v_lshlrev_b32 v65, 11, v65
 buffer_load_dword v72, v65, s[84:87], s92 offen
 s_cmp_eq_u32 s29, 1
 s_cbranch_scc1 L_dispatch
 s_cmp_lg_u32 s26, 0
 s_cbranch_scc1 L_notfirst
 s_waitcnt vmcnt(8)
 s_mov_b64 exec, 1
 ds_write_b32 v2, v4
 s_mov_b64 exec, -1
L_notfirst:
 s_waitcnt lgkmcnt(0)
 s_barrier
 ds_read_b32 v4, v2
 s_waitcnt lgkmcnt(0)
 v_readfirstlane_b32 s25, v4
 s_cmp_ge_u32 s25, 32
 s_cbranch_scc1 L_odd
 s_cmp_lt_u32 s24, 8
 s_cbranch_scc1 L_dispatch
L_odd:
 v_mov_b32 v4, 1
 buffer_store_dword v4, off, s[12:15], s30 offset:8 sc1
 s_waitcnt vmcnt(0)
 v_mov_b32 v4, s34
 v_mov_b32 v5, s35
 v_bfrev_b32 v6, 1
 v_cmp_eq_u32 vcc, 64, v0
 s_nop 1
 v_cndmask_b32 v6, v6, 0, vcc
 buffer_atomic_add_x2 v[4:5], v6, s[12:15], s30 offen sc1
 s_mov_b32 s3, 0
L_rdy_1:
 buffer_load_dwordx4 v[8:11], off, s[12:15], s30 sc1
 s_add_u32 s3, s3, 1
 s_cmp_gt_u32 s3, 400000
 s_cbranch_scc1 L_exit
 s_waitcnt vmcnt(0)
 v_readfirstlane_b32 s32, v8
 v_readfirstlane_b32 s33, v9
 v_readfirstlane_b32 vcc_hi, v10
 s_and_b32 vcc_lo, s32, 0xffff
 s_cmp_lt_u32 vcc_lo, 256
 s_cbranch_scc1 L_rdy_1
 s_cmp_lg_u32 vcc_hi, 0
 s_cbranch_scc1 L_general
L_general:
 s_waitcnt vmcnt(0) lgkmcnt(0)
 s_barrier
 s_mov_b32 s29, 1
 s_mov_b32 s30, 240
 s_mov_b32 s27, 0
 s_lshr_b32 s24, s2, 5
 s_and_b32 s25, s2, 31
 s_add_u32 s4, s4, 0x200000
 s_addc_u32 s5, s5, 0
 s_load_dwordx16 s[68:83], s[0:1], 64
 s_load_dwordx2 s[84:85], s[0:1], 56
 s_waitcnt lgkmcnt(0)
 s_branch L_start
L_dispatch:
 s_cmp_eq_u32 s24, 4
 s_cbranch_scc1 L_role_K
 s_cmp_eq_u32 s24, 5
 s_cbranch_scc1 L_role_Q
 s_cmp_eq_u32 s24, 6
 s_cbranch_scc1 L_role_V
 s_cmp_eq_u32 s24, 7
 s_cbranch_scc1 L_role_O
 s_cmp_eq_u32 s29, 1
 s_cbranch_scc1 L_role_G
 s_mov_b32 s10, 8388608
 s_mov_b32 s11, 0x20000
 v_and_b32 v1, 63, v0
 v_lshrrev_b32 v32, 2, v1
 v_and_b32 v33, 3, v1
 v_lshlrev_b32 v33, 4, v33
 v_lshl_add_u32 v39, v32, 13, v33
 v_lshl_add_u32 v40, v32, 11, v33
 s_lshl_b32 s59, s24, 5
 s_add_u32 s59, s59, s25
 s_lshl_b32 s59, s59, 6
 s_lshl_b32 s60, s26, 21
 s_add_u32 s44, s59, s60
 s_lshl_b32 s59, s24, 21
 s_lshl_b32 s60, s25, 6
 s_add_u32 s59, s59, s60
 s_lshl_b32 s60, s26, 19
 s_add_u32 s46, s59, s60
 s_lshl_b32 s48, s26, 13
 s_and_b32 s59, s25, 1
 s_mul_i32 s59, s59, 2
 s_lshl_b32 s60, s59, 17
 s_sub_u32 s45, s44, s60
 s_add_u32 s44, s44, s60
 s_lshl_b32 s60, s59, 15
 s_sub_u32 s47, s46, s60
 s_add_u32 s46, s46, s60
 s_lshl_b32 s60, s59, 10
 s_sub_u32 s49, s48, s60
 s_add_u32 s48, s48, s60
 s_mov_b64 s[8:9], s[16:17]
 s_add_u32 m0, s48, 0
 s_add_u32 s59, s44, 0
 buffer_load_dwordx4 v39, s[8:11], s59 offen  lds
 s_add_u32 m0, s48, 1024
 s_add_u32 s59, s44, 131072
 buffer_load_dwordx4 v39, s[8:11], s59 offen  lds
 s_add_u32 m0, s49, 2048
 s_add_u32 s59, s45, 262144
 buffer_load_dwordx4 v39, s[8:11], s59 offen  lds
 s_add_u32 m0, s49, 3072
 s_add_u32 s59, s45, 393216
 buffer_load_dwordx4 v39, s[8:11], s59 offen  lds
 s_add_u32 m0, s48, 4096
 s_add_u32 s59, s44, 524288
 buffer_load_dwordx4 v39, s[8:11], s59 offen  lds
 s_add_u32 m0, s48, 5120
 s_add_u32 s59, s44, 655360
 buffer_load_dwordx4 v39, s[8:11], s59 offen  lds
 s_add_u32 m0, s49, 6144
 s_add_u32 s59, s45, 786432
 buffer_load_dwordx4 v39, s[8:11], s59 offen  lds
 s_add_u32 m0, s49, 7168
 s_add_u32 s59, s45, 917504
 buffer_load_dwordx4 v39, s[8:11], s59 offen  lds
 s_cmp_lg_u32 s26, 1
 s_cbranch_scc1 L_voted_2
 s_bfe_u32 s83, s2, 0x30003
 s_lshl_b32 s76, s83, 21
 s_lshr_b32 s77, s2, 6
 s_lshl_b32 s77, s77, 3
 s_and_b32 s78, s2, 7
 s_add_u32 s77, s77, s78
 s_lshl_b32 s77, s77, 8
 s_add_u32 s76, s76, s77
 s_add_u32 s76, s76, 135790592
 s_add_u32 s77, s76, 8192
 s_load_dword s82, s[4:5], s76 glc
 s_load_dword s82, s[4:5], s77 glc
 s_waitcnt lgkmcnt(0)
 s_memtime s[78:79]
 s_load_dword s82, s[4:5], s76 glc
 s_waitcnt lgkmcnt(0)
 s_memtime s[80:81]
 s_load_dword s82, s[4:5], s77 glc
 s_waitcnt lgkmcnt(0)
 s_memtime s[32:33]
 s_sub_u32 s78, s80, s78
 s_waitcnt lgkmcnt(0)
 s_sub_u32 s80, s32, s80
 s_cmp_lt_u32 s80, s78
 s_cselect_b32 s78, 1, 0
 s_bfe_u32 s79, s24, 0x10002
 s_xor_b32 s78, s78, s79
 s_mov_b32 s79, 0
 s_mul_i32 s83, s83, 6
 s_add_u32 s83, s83, 16
 s_lshl_b64 s[34:35], s[78:79], s83
 s_or_b32 s34, s34, 1
L_voted_2:
 v_and_b32 v1, 63, v0
 v_lshlrev_b32 v2, 4, v1
 v_lshlrev_b32 v3, 3, v1
 v_lshlrev_b32 v4, 2, v1
 v_mov_b32 v50, -1
 v_mov_b32 v51, -1
 v_mov_b32 v52, -1
 v_mov_b32 v53, -1
 v_bfrev_b32 v31, 1
 v_mov_b32 v37, 0
 v_mov_b32 v30, 0
 v_bfe_u32 v32, v1, 1, 1
 v_mul_u32_u24 v32, 0xaaaa, v32
 v_add_u32 v5, 0x4444, v32
 s_lshl_b32 s59, s26, 12
 v_add_u32 v6, s59, v2
 v_and_b32 v34, 15, v1
 v_lshrrev_b32 v35, 4, v1
 s_mul_i32 s59, s26, 2304
 s_add_u32 s59, s59, 4096
 v_mul_u32_u24 v32, 288, v35
 v_lshl_add_u32 v32, v34, 2, v32
 v_add_u32 v7, s59, v32
 v_add_u32 v8, 1152, v7
 v_mul_u32_u24 v32, 144, v34
 v_lshl_add_u32 v9, v35, 5, v32
 s_lshl_b32 s59, s26, 10
 v_add_u32 v10, s59, v2
 v_mov_b32 v32, 0x3e0293ee
 v_cmp_gt_u32 vcc, 8, v34
 s_nop 1
 v_cndmask_b32 v54, 1.0, v32, vcc
 s_mul_i32 s59, s25, 1280
 v_add_u32 v22, s59, v2
 v_cmp_gt_u32 vcc, 8, v34
 s_nop 1
 v_cndmask_b32 v11, v31, v22, vcc
 v_cmp_gt_u32 vcc, 16, v1
 s_nop 1
 v_cndmask_b32 v23, v31, v22, vcc
 v_lshlrev_b32 v32, 5, v34
 v_lshl_add_u32 v32, v35, 4, v32
 s_add_u32 s60, s59, 768
 v_add_u32 v32, s60, v32
 v_cmp_le_u32 vcc, 8, v34
 s_nop 1
 v_cndmask_b32 v32, v31, v32, vcc
 v_cmp_gt_u32 vcc, 2, v35
 s_nop 1
 v_cndmask_b32 v12, v31, v32, vcc
 s_xor_b32 s59, s25, 1
 s_mul_i32 s59, s59, 1280
 v_add_u32 v47, s59, v2
 s_xor_b32 s59, s25, 2
 s_mul_i32 s59, s59, 1280
 v_add_u32 v48, s59, v2
 s_xor_b32 s59, s25, 3
 s_mul_i32 s59, s59, 1280
 v_add_u32 v49, s59, v2
 s_and_b32 s59, s25, 28
 s_mul_i32 s59, s59, 1280
 s_add_u32 s59, s59, 1024
 v_add_u32 v13, s59, v4
 s_lshl_b32 s59, s25, 9
 v_lshlrev_b32 v32, 4, v34
 v_lshl_add_u32 v32, v35, 7, v32
 v_add_u32 v32, s59, v32
 v_cmp_gt_u32 vcc, 8, v34
 s_nop 1
 v_cndmask_b32 v14, v31, v32, vcc
 v_lshrrev_b32 v32, 2, v34
 v_and_b32 v36, 1, v34
 v_lshl_add_u32 v32, v32, 1, v36
 v_bfe_u32 v36, v34, 1, 1
 v_lshl_add_u32 v32, v36, 3, v32
 v_lshl_add_u32 v32, v35, 4, v32
 v_lshlrev_b32 v20, 4, v32
 v_add_u32 v32, s59, v2
 v_cmp_gt_u32 vcc, 32, v1
 s_nop 1
 v_cndmask_b32 v21, v31, v32, vcc
 v_lshrrev_b32 v32, 5, v1
 v_lshlrev_b32 v32, 8, v32
 v_bfe_u32 v36, v1, 1, 3
 v_lshl_add_u32 v32, v36, 5, v32
 v_bfe_u32 v36, v1, 4, 1
 v_lshl_add_u32 v32, v36, 4, v32
 v_and_b32 v36, 1, v1
 v_lshl_add_u32 v32, v36, 3, v32
 v_add_u32 v16, s59, v32
 s_lshr_b32 s59, s25, 1
 s_lshl_b32 s59, s59, 14
 s_and_b32 s60, s25, 1
 s_lshl_b32 s60, s60, 12
 s_add_u32 s59, s59, s60
 v_mov_b32 v29, v31
 s_add_u32 s60, s24, 1
 s_and_b32 s60, s60, 3
 s_lshl_b32 s60, s60, 10
 s_add_u32 s60, s60, s59
 v_add_u32 v44, s60, v2
 s_add_u32 s60, s60, 0
 v_writelane_b32 v29, s60, 0
 s_mov_b32 s74, s60
 s_add_u32 s60, s24, 2
 s_and_b32 s60, s60, 3
 s_lshl_b32 s60, s60, 10
 s_add_u32 s60, s60, s59
 v_add_u32 v45, s60, v2
 s_add_u32 s60, s60, 4
 v_writelane_b32 v29, s60, 1
 s_mov_b32 s75, s60
 s_add_u32 s60, s24, 3
 s_and_b32 s60, s60, 3
 s_lshl_b32 s60, s60, 10
 s_add_u32 s60, s60, s59
 v_add_u32 v46, s60, v2
 s_add_u32 s60, s60, 8
 v_writelane_b32 v29, s60, 2
 s_mov_b32 s76, s60
 s_lshl_b32 s60, s24, 10
 s_add_u32 s59, s59, s60
 v_add_u32 v24, s59, v2
 s_mov_b32 s73, s59
 s_and_b32 s60, s26, 1
 s_lshl_b32 s60, s60, 9
 s_add_u32 s59, s59, s60
 v_add_u32 v15, s59, v4
 v_lshrrev_b32 v32, 2, v34
 v_and_b32 v36, 3, v34
 v_lshl_add_u32 v32, v32, 3, v36
 v_lshlrev_b32 v32, 4, v32
 v_lshl_add_u32 v17, v35, 9, v32
 v_lshlrev_b32 v32, 4, v34
 v_lshl_add_u32 v18, v35, 9, v32
 v_lshl_add_u32 v32, v35, 7, v32
 v_subrev_u32 v32, 128, v32
 v_cmp_le_u32 vcc, 8, v34
 s_nop 1
 v_cndmask_b32 v19, v31, v32, vcc
 s_lshl_b32 s59, s24, 3
 s_lshr_b32 s60, s25, 2
 s_add_u32 s59, s59, s60
 s_lshl_b32 s59, s59, 7
 s_and_b32 s60, s25, 3
 s_lshl_b32 s60, s60, 2
 s_add_u32 s59, s59, s60
 s_add_u32 s77, s59, 3735552
 s_add_u32 s78, s59, 3735568
 s_add_u32 s59, s59, 3735584
 v_mov_b32 v32, s59
 v_cmp_eq_u32 vcc, 0, v1
 s_nop 1
 v_cndmask_b32 v42, v31, v32, vcc
 s_lshr_b32 s59, s25, 3
 s_lshl_b32 s60, s25, 2
 v_lshl_add_u32 v32, v1, 8, s60
 v_cmp_gt_u32 vcc, 4, v1
 s_nop 1
 v_cndmask_b32 v25, v31, v32, vcc
 v_cmp_ne_u32 vcc, s59, v1
 s_nop 1
 v_cndmask_b32 v25, v31, v25, vcc
 v_lshrrev_b32 v36, 3, v1
 s_and_b32 s60, s60, 28
 s_sub_u32 s60, s60, 3072
 v_lshl_add_u32 v32, v1, 7, s60
 s_add_u32 s60, s59, 4
 v_cmp_eq_u32 vcc, s60, v36
 s_nop 1
 v_cndmask_b32 v25, v25, v32, vcc
 s_add_u32 s60, s25, 32
 v_cmp_ne_u32 vcc, s60, v1
 s_nop 1
 v_cndmask_b32 v25, v31, v25, vcc
 s_lshl_b32 s60, s59, 8
 v_add_u32 v26, s60, v4
 s_lshl_b32 s60, s25, 7
 s_add_u32 s60, s60, 1024
 v_and_b32 v32, 28, v4
 v_add_u32 v32, s60, v32
 v_cmp_eq_u32 vcc, s59, v36
 s_nop 1
 v_cndmask_b32 v26, v26, v32, vcc
 s_lshl_b32 s71, 1, s25
 s_not_b32 s71, s71
 s_lshr_b32 s59, s25, 2
 s_lshl_b32 s59, s59, 8
 s_add_u32 s59, s59, 6144
 v_add_u32 v28, s59, v4
 s_and_b32 s60, s25, 3
 v_cmp_eq_u32 vcc, s60, v1
 s_nop 1
 v_cndmask_b32 v27, v31, v28, vcc
 s_mov_b32 s66, 0x42200000
 s_lshl_b32 s67, s24, 16
 s_lshl_b32 s68, s24, 18
 s_add_u32 s68, s68, 2621440
 s_add_u32 s67, s67, 2097152
 s_lshl_b32 s69, s24, 14
 s_add_u32 s69, s69, 3670016
 s_add_u32 s70, s69, 8192
 s_lshl_b32 s59, s26, 14
 s_add_u32 s53, s67, s59
 s_add_u32 s54, s53, 262144
 s_lshl_b32 s59, s26, 16
 s_add_u32 s55, s68, s59
 s_lshl_b32 s56, s26, 18
 s_add_u32 s56, s56, 134217728
 s_add_u32 s65, s56, 8192
 s_mov_b32 s72, 150732800
 s_mov_b32 s63, 150740992
 buffer_load_dwordx4 v[216:219], v21, s[4:7], s53 offen sc1
 buffer_load_dwordx4 v[220:223], v21, s[4:7], s54 offen sc1
 buffer_load_dwordx4 v[224:227], v22, s[4:7], s55 offen sc1
 buffer_load_dwordx4 v[228:231], v23, s[4:7], s55 offen offset:1024 sc1
 buffer_load_dword v236, v25, s[4:7], s69 offen sc1
 buffer_load_dword v237, v27, s[4:7], s69 offen sc1
 buffer_load_dword v238, v25, s[4:7], s70 offen sc1
 s_load_dwordx2 s[40:41], s[0:1], 8
 v_lshrrev_b32 v36, 2, v34
 v_lshlrev_b32 v36, 1, v36
 v_and_b32 v32, 1, v34
 v_add_u32 v36, v36, v32
 v_lshlrev_b32 v36, 11, v36
 v_lshl_add_u32 v36, v35, 5, v36
 v_bfe_u32 v32, v34, 1, 1
 v_lshl_add_u32 v36, v32, 4, v36
 s_lshl_b32 s59, s25, 6
 s_mov_b32 s42, 16384
 s_mov_b32 s43, 0x20000
 s_waitcnt lgkmcnt(0)
 buffer_load_dwordx4 v[232:235], v36, s[40:43], s59 offen
 v_bfe_u32 v41, v1, 2, 1
 v_bfe_u32 v32, v1, 3, 1
 v_lshl_add_u32 v41, v32, 3, v41
 v_bfe_u32 v32, v1, 4, 1
 v_lshl_add_u32 v41, v32, 2, v41
 v_bfe_u32 v32, v1, 5, 1
 v_lshl_add_u32 v41, v32, 4, v41
 v_lshlrev_b32 v41, 6, v41
 v_and_b32 v32, 3, v1
 v_lshl_add_u32 v41, v32, 3, v41
 v_bfe_u32 v38, v1, 2, 1
 v_bfe_u32 v32, v1, 3, 1
 v_lshl_add_u32 v38, v32, 2, v38
 v_bfe_u32 v32, v1, 4, 1
 v_lshl_add_u32 v38, v32, 4, v38
 v_bfe_u32 v32, v1, 5, 1
 v_lshl_add_u32 v38, v32, 3, v38
 v_lshlrev_b32 v38, 6, v38
 v_and_b32 v32, 3, v1
 v_lshl_add_u32 v38, v32, 3, v38
 s_lshl_b32 s60, s26, 13
 v_add_u32 v41, s60, v41
 s_and_b32 s60, s26, 1
 s_lshl_b32 s60, s60, 5
 v_add_u32 v38, s60, v38
 s_add_u32 m0, s48, 32768
 s_add_u32 s59, s44, 1048576
 buffer_load_dwordx4 v39, s[8:11], s59 offen  lds
 s_add_u32 m0, s48, 33792
 s_add_u32 s59, s44, 1179648
 buffer_load_dwordx4 v39, s[8:11], s59 offen  lds
 s_add_u32 m0, s49, 34816
 s_add_u32 s59, s45, 1310720
 buffer_load_dwordx4 v39, s[8:11], s59 offen  lds
 s_add_u32 m0, s49, 35840
 s_add_u32 s59, s45, 1441792
 buffer_load_dwordx4 v39, s[8:11], s59 offen  lds
 s_add_u32 m0, s48, 36864
 s_add_u32 s59, s44, 1572864
 buffer_load_dwordx4 v39, s[8:11], s59 offen  lds
 s_add_u32 m0, s48, 37888
 s_add_u32 s59, s44, 1703936
 buffer_load_dwordx4 v39, s[8:11], s59 offen  lds
 s_add_u32 m0, s49, 38912
 s_add_u32 s59, s45, 1835008
 buffer_load_dwordx4 v39, s[8:11], s59 offen  lds
 s_add_u32 m0, s49, 39936
 s_add_u32 s59, s45, 1966080
 buffer_load_dwordx4 v39, s[8:11], s59 offen  lds
 v_and_b32 v67, 15, v64
 v_lshrrev_b32 v68, 4, v64
 v_cvt_f32_u32 v200, v67
 v_mul_f32 v206, 0x41800000, v200
 v_lshl_add_u32 v65, v67, 1, 0
 v_add_u32 v65, 256, v65
 v_and_b32 v66, 3, v67
 v_lshlrev_b32 v66, 2, v66
 v_lshrrev_b32 v69, 2, v67
 v_lshl_add_u32 v66, v69, 8, v66
 v_cmp_gt_u32 vcc, 8, v67
 s_nop 1
 v_cndmask_b32 v65, v66, v65, vcc
 v_cvt_f32_u32 v202, v65
 v_and_b32 v65, 1, v67
 v_lshlrev_b32 v65, 3, v65
 v_lshrrev_b32 v66, 1, v67
 v_min_u32 v66, 4, v66
 v_lshl_add_u32 v65, v66, 8, v65
 v_add_u32 v65, 1024, v65
 v_cvt_f32_u32 v204, v65
 s_waitcnt vmcnt(25)
 v_lshlrev_b32 v95, 16, v94
 v_mul_f32 v95, 0x3fb8aa3b, v95
 v_exp_f32 v95, v95
 s_nop 0
 v_cvt_pk_bf16_f32 v95, v95, v95
 v_and_b32 v95, s98, v95
 v_lshl_add_u32 v65, v64, 5, s94
 v_lshlrev_b32 v96, 16, v88
 v_lshlrev_b32 v97, 16, v89
 v_lshlrev_b32 v98, 16, v90
 v_lshlrev_b32 v99, 16, v91
 v_lshlrev_b32 v100, 16, v92
 v_lshlrev_b32 v101, 16, v93
 v_mul_f32 v96, v95, v96
 v_mul_f32 v97, v95, v97
 v_mul_f32 v98, v95, v98
 v_mul_f32 v99, v95, v99
 v_mul_f32 v104, 0x3fb8aa3b, v96
 v_mul_f32 v105, 0x3e22f983, v97
 v_mul_f32 v106, v100, v98
 v_fma_f32 v106, -v101, v99, v106
 v_mul_f32 v107, v100, v99
 v_fma_f32 v107, v101, v98, v107
 ds_write_b128 v65, v[104:107] offset:4160
 v_and_b32 v96, s98, v88
 v_and_b32 v97, s98, v89
 v_and_b32 v98, s98, v90
 v_and_b32 v99, s98, v91
 v_and_b32 v100, s98, v92
 v_and_b32 v101, s98, v93
 v_mul_f32 v96, v95, v96
 v_mul_f32 v97, v95, v97
 v_mul_f32 v98, v95, v98
 v_mul_f32 v99, v95, v99
 v_mul_f32 v108, 0x3fb8aa3b, v96
 v_mul_f32 v109, 0x3e22f983, v97
 v_mul_f32 v110, v100, v98
 v_fma_f32 v110, -v101, v99, v110
 v_mul_f32 v111, v100, v99
 v_fma_f32 v111, v101, v98, v111
 ds_write_b128 v65, v[108:111] offset:4176
 v_mov_b32 v120, 0
 v_mov_b32 v121, 0
 v_mov_b32 v122, 0
 v_mov_b32 v123, 0
 v_mov_b32 v124, 0
 v_mov_b32 v125, 0
 v_mov_b32 v126, 0
 v_mov_b32 v127, 0
 v_mov_b32 v128, 0
 v_mov_b32 v129, 0
 v_mov_b32 v130, 0
 v_mov_b32 v131, 0
 v_lshl_add_u32 v69, v68, 6, s94
 s_mov_b32 s95, 0
 s_waitcnt lgkmcnt(0)
L_cfb_kg0:
 ds_read_b128 v[88:91], v69 offset:4160
 ds_read_b128 v[92:95], v69 offset:4176
 ds_read_b128 v[96:99], v69 offset:4192
 ds_read_b128 v[100:103], v69 offset:4208
 v_add_u32 v69, 256, v69
 s_waitcnt lgkmcnt(3)
 v_pk_mul_f32 v[132:133], v[88:89], v[200:201] op_sel_hi:[1,0]
 v_pk_mul_f32 v[136:137], v[88:89], v[202:203] op_sel_hi:[1,0]
 v_pk_mul_f32 v[140:141], v[88:89], v[204:205] op_sel_hi:[1,0]
 v_pk_mul_f32 v[144:145], v[88:89], v[206:207] op_sel_hi:[1,0]
 v_fract_f32 v133, v133
 v_fract_f32 v137, v137
 v_fract_f32 v141, v141
 v_fract_f32 v145, v145
 v_exp_f32 v132, v132
 v_cos_f32 v134, v133
 v_sin_f32 v135, v133
 v_exp_f32 v136, v136
 v_cos_f32 v138, v137
 v_sin_f32 v139, v137
 v_exp_f32 v140, v140
 v_cos_f32 v142, v141
 v_sin_f32 v143, v141
 v_exp_f32 v144, v144
 v_cos_f32 v146, v145
 v_sin_f32 v147, v145
 v_pk_mul_f32 v[134:135], v[134:135], v[132:133] op_sel_hi:[1,0]
 v_pk_mul_f32 v[138:139], v[138:139], v[136:137] op_sel_hi:[1,0]
 v_pk_mul_f32 v[142:143], v[142:143], v[140:141] op_sel_hi:[1,0]
 v_pk_mul_f32 v[146:147], v[146:147], v[144:145] op_sel_hi:[1,0]
 v_pk_mul_f32 v[144:145], v[146:147], v[90:91] op_sel_hi:[0,1] neg_hi:[0,1]
 v_cvt_pk_bf16_f32 v104, v134, v135
 v_cvt_pk_bf16_f32 v108, v138, v139
 v_cvt_pk_bf16_f32 v112, v142, v143
 v_pk_fma_f32 v[144:145], v[146:147], v[90:91], v[144:145] op_sel:[1,1,0] op_sel_hi:[1,0,1] neg_lo:[0,1,0] neg_hi:[0,1,0]
 v_cvt_pk_bf16_f32 v116, v144, v145
 s_waitcnt lgkmcnt(2)
 v_pk_mul_f32 v[132:133], v[92:93], v[200:201] op_sel_hi:[1,0]
 v_pk_mul_f32 v[136:137], v[92:93], v[202:203] op_sel_hi:[1,0]
 v_pk_mul_f32 v[140:141], v[92:93], v[204:205] op_sel_hi:[1,0]
 v_pk_mul_f32 v[144:145], v[92:93], v[206:207] op_sel_hi:[1,0]
 v_fract_f32 v133, v133
 v_fract_f32 v137, v137
 v_fract_f32 v141, v141
 v_fract_f32 v145, v145
 v_exp_f32 v132, v132
 v_cos_f32 v134, v133
 v_sin_f32 v135, v133
 v_exp_f32 v136, v136
 v_cos_f32 v138, v137
 v_sin_f32 v139, v137
 v_exp_f32 v140, v140
 v_cos_f32 v142, v141
 v_sin_f32 v143, v141
 v_exp_f32 v144, v144
 v_cos_f32 v146, v145
 v_sin_f32 v147, v145
 v_pk_mul_f32 v[134:135], v[134:135], v[132:133] op_sel_hi:[1,0]
 v_pk_mul_f32 v[138:139], v[138:139], v[136:137] op_sel_hi:[1,0]
 v_pk_mul_f32 v[142:143], v[142:143], v[140:141] op_sel_hi:[1,0]
 v_pk_mul_f32 v[146:147], v[146:147], v[144:145] op_sel_hi:[1,0]
 v_pk_mul_f32 v[144:145], v[146:147], v[94:95] op_sel_hi:[0,1] neg_hi:[0,1]
 v_cvt_pk_bf16_f32 v105, v134, v135
 v_cvt_pk_bf16_f32 v109, v138, v139
 v_cvt_pk_bf16_f32 v113, v142, v143
 v_pk_fma_f32 v[144:145], v[146:147], v[94:95], v[144:145] op_sel:[1,1,0] op_sel_hi:[1,0,1] neg_lo:[0,1,0] neg_hi:[0,1,0]
 v_cvt_pk_bf16_f32 v117, v144, v145
 s_waitcnt lgkmcnt(1)
 v_pk_mul_f32 v[132:133], v[96:97], v[200:201] op_sel_hi:[1,0]
 v_pk_mul_f32 v[136:137], v[96:97], v[202:203] op_sel_hi:[1,0]
 v_pk_mul_f32 v[140:141], v[96:97], v[204:205] op_sel_hi:[1,0]
 v_pk_mul_f32 v[144:145], v[96:97], v[206:207] op_sel_hi:[1,0]
 v_fract_f32 v133, v133
 v_fract_f32 v137, v137
 v_fract_f32 v141, v141
 v_fract_f32 v145, v145
 v_exp_f32 v132, v132
 v_cos_f32 v134, v133
 v_sin_f32 v135, v133
 v_exp_f32 v136, v136
 v_cos_f32 v138, v137
 v_sin_f32 v139, v137
 v_exp_f32 v140, v140
 v_cos_f32 v142, v141
 v_sin_f32 v143, v141
 v_exp_f32 v144, v144
 v_cos_f32 v146, v145
 v_sin_f32 v147, v145
 v_pk_mul_f32 v[134:135], v[134:135], v[132:133] op_sel_hi:[1,0]
 v_pk_mul_f32 v[138:139], v[138:139], v[136:137] op_sel_hi:[1,0]
 v_pk_mul_f32 v[142:143], v[142:143], v[140:141] op_sel_hi:[1,0]
 v_pk_mul_f32 v[146:147], v[146:147], v[144:145] op_sel_hi:[1,0]
 v_pk_mul_f32 v[144:145], v[146:147], v[98:99] op_sel_hi:[0,1] neg_hi:[0,1]
 v_cvt_pk_bf16_f32 v106, v134, v135
 v_cvt_pk_bf16_f32 v110, v138, v139
 v_cvt_pk_bf16_f32 v114, v142, v143
 v_pk_fma_f32 v[144:145], v[146:147], v[98:99], v[144:145] op_sel:[1,1,0] op_sel_hi:[1,0,1] neg_lo:[0,1,0] neg_hi:[0,1,0]
 v_cvt_pk_bf16_f32 v118, v144, v145
 s_waitcnt lgkmcnt(0)
 v_pk_mul_f32 v[132:133], v[100:101], v[200:201] op_sel_hi:[1,0]
 v_pk_mul_f32 v[136:137], v[100:101], v[202:203] op_sel_hi:[1,0]
 v_pk_mul_f32 v[140:141], v[100:101], v[204:205] op_sel_hi:[1,0]
 v_pk_mul_f32 v[144:145], v[100:101], v[206:207] op_sel_hi:[1,0]
 v_fract_f32 v133, v133
 v_fract_f32 v137, v137
 v_fract_f32 v141, v141
 v_fract_f32 v145, v145
 v_exp_f32 v132, v132
 v_cos_f32 v134, v133
 v_sin_f32 v135, v133
 v_exp_f32 v136, v136
 v_cos_f32 v138, v137
 v_sin_f32 v139, v137
 v_exp_f32 v140, v140
 v_cos_f32 v142, v141
 v_sin_f32 v143, v141
 v_exp_f32 v144, v144
 v_cos_f32 v146, v145
 v_sin_f32 v147, v145
 v_pk_mul_f32 v[134:135], v[134:135], v[132:133] op_sel_hi:[1,0]
 v_pk_mul_f32 v[138:139], v[138:139], v[136:137] op_sel_hi:[1,0]
 v_pk_mul_f32 v[142:143], v[142:143], v[140:141] op_sel_hi:[1,0]
 v_pk_mul_f32 v[146:147], v[146:147], v[144:145] op_sel_hi:[1,0]
 v_pk_mul_f32 v[144:145], v[146:147], v[102:103] op_sel_hi:[0,1] neg_hi:[0,1]
 v_cvt_pk_bf16_f32 v107, v134, v135
 v_cvt_pk_bf16_f32 v111, v138, v139
 v_cvt_pk_bf16_f32 v115, v142, v143
 v_pk_fma_f32 v[144:145], v[146:147], v[102:103], v[144:145] op_sel:[1,1,0] op_sel_hi:[1,0,1] neg_lo:[0,1,0] neg_hi:[0,1,0]
 v_cvt_pk_bf16_f32 v119, v144, v145
 s_add_u32 s95, s95, 1
 s_cmp_lt_u32 s95, 2
 v_mfma_f32_16x16x32_bf16 v[120:123], v[104:107], v[116:119], v[120:123]
 v_mfma_f32_16x16x32_bf16 v[124:127], v[108:111], v[116:119], v[124:127]
 v_mfma_f32_16x16x32_bf16 v[128:131], v[112:115], v[116:119], v[128:131]
 s_cbranch_scc1 L_cfb_kg0
 s_waitcnt vmcnt(8)
 s_cmp_eq_u32 s26, 0
 s_cselect_b64 vcc, -1, 0
 v_min_u32 v232, -2, v232
 v_cndmask_b32 v232, -1, v232, vcc
 v_min_u32 v233, -2, v233
 v_cndmask_b32 v233, -1, v233, vcc
 v_min_u32 v234, -2, v234
 v_cndmask_b32 v234, -1, v234, vcc
 v_min_u32 v235, -2, v235
 v_cndmask_b32 v235, -1, v235, vcc
 buffer_store_dwordx4 v[232:235], v21, s[4:7], s53 offen
 buffer_store_dwordx4 v[50:53], v21, s[4:7], s54 offen
 buffer_store_dwordx4 v[50:53], v22, s[4:7], s55 offen
 buffer_store_dwordx4 v[50:53], v23, s[4:7], s55 offen offset:1024
 buffer_store_dwordx4 v[50:53], v24, s[4:7], s56 offen sc1
 buffer_store_dwordx4 v[50:53], v24, s[4:7], s65 offen sc1
 buffer_store_dword v37, v29, s[4:7], s63 offen sc1
 buffer_store_dword v37, v25, s[4:7], s69 offen
 buffer_store_dword v37, v27, s[4:7], s69 offen
 buffer_store_dword v37, v25, s[4:7], s70 offen
 buffer_store_dword v37, v29, s[4:7], s72 offen sc1
 buffer_store_dword v37, v42, s[4:7], 0 offen sc1
 s_waitcnt vmcnt(28)
 ds_read_b64_tr_b16 a[0:1], v41 offset:0
 ds_read_b64_tr_b16 a[2:3], v41 offset:128
 ds_read_b64_tr_b16 a[4:5], v41 offset:2048
 ds_read_b64_tr_b16 a[6:7], v41 offset:2176
 ds_read_b64_tr_b16 a[8:9], v41 offset:32
 ds_read_b64_tr_b16 a[10:11], v41 offset:160
 ds_read_b64_tr_b16 a[12:13], v41 offset:2080
 ds_read_b64_tr_b16 a[14:15], v41 offset:2208
 s_waitcnt lgkmcnt(0)
 ds_read_b64_tr_b16 a[48:49], v41 offset:4096
 ds_read_b64_tr_b16 a[50:51], v41 offset:4224
 ds_read_b64_tr_b16 a[52:53], v41 offset:6144
 ds_read_b64_tr_b16 a[54:55], v41 offset:6272
 ds_read_b64_tr_b16 a[56:57], v41 offset:4128
 ds_read_b64_tr_b16 a[58:59], v41 offset:4256
 ds_read_b64_tr_b16 a[60:61], v41 offset:6176
 ds_read_b64_tr_b16 a[62:63], v41 offset:6304
 s_waitcnt lgkmcnt(0)
 s_mov_b64 s[8:9], s[18:19]
 s_add_u32 m0, s48, 0
 s_add_u32 s59, s44, 0
 buffer_load_dwordx4 v39, s[8:11], s59 offen  lds
 s_add_u32 m0, s48, 1024
 s_add_u32 s59, s44, 131072
 buffer_load_dwordx4 v39, s[8:11], s59 offen  lds
 s_add_u32 m0, s49, 2048
 s_add_u32 s59, s45, 262144
 buffer_load_dwordx4 v39, s[8:11], s59 offen  lds
 s_add_u32 m0, s49, 3072
 s_add_u32 s59, s45, 393216
 buffer_load_dwordx4 v39, s[8:11], s59 offen  lds
 s_add_u32 m0, s48, 4096
 s_add_u32 s59, s44, 524288
 buffer_load_dwordx4 v39, s[8:11], s59 offen  lds
 s_add_u32 m0, s48, 5120
 s_add_u32 s59, s44, 655360
 buffer_load_dwordx4 v39, s[8:11], s59 offen  lds
 s_add_u32 m0, s49, 6144
 s_add_u32 s59, s45, 786432
 buffer_load_dwordx4 v39, s[8:11], s59 offen  lds
 s_add_u32 m0, s49, 7168
 s_add_u32 s59, s45, 917504
 buffer_load_dwordx4 v39, s[8:11], s59 offen  lds
L_cfb_kg1:
 ds_read_b128 v[88:91], v69 offset:4160
 ds_read_b128 v[92:95], v69 offset:4176
 ds_read_b128 v[96:99], v69 offset:4192
 ds_read_b128 v[100:103], v69 offset:4208
 v_add_u32 v69, 256, v69
 s_waitcnt lgkmcnt(3)
 v_pk_mul_f32 v[132:133], v[88:89], v[200:201] op_sel_hi:[1,0]
 v_pk_mul_f32 v[136:137], v[88:89], v[202:203] op_sel_hi:[1,0]
 v_pk_mul_f32 v[140:141], v[88:89], v[204:205] op_sel_hi:[1,0]
 v_pk_mul_f32 v[144:145], v[88:89], v[206:207] op_sel_hi:[1,0]
 v_fract_f32 v133, v133
 v_fract_f32 v137, v137
 v_fract_f32 v141, v141
 v_fract_f32 v145, v145
 v_exp_f32 v132, v132
 v_cos_f32 v134, v133
 v_sin_f32 v135, v133
 v_exp_f32 v136, v136
 v_cos_f32 v138, v137
 v_sin_f32 v139, v137
 v_exp_f32 v140, v140
 v_cos_f32 v142, v141
 v_sin_f32 v143, v141
 v_exp_f32 v144, v144
 v_cos_f32 v146, v145
 v_sin_f32 v147, v145
 v_pk_mul_f32 v[134:135], v[134:135], v[132:133] op_sel_hi:[1,0]
 v_pk_mul_f32 v[138:139], v[138:139], v[136:137] op_sel_hi:[1,0]
 v_pk_mul_f32 v[142:143], v[142:143], v[140:141] op_sel_hi:[1,0]
 v_pk_mul_f32 v[146:147], v[146:147], v[144:145] op_sel_hi:[1,0]
 v_pk_mul_f32 v[144:145], v[146:147], v[90:91] op_sel_hi:[0,1] neg_hi:[0,1]
 v_cvt_pk_bf16_f32 v104, v134, v135
 v_cvt_pk_bf16_f32 v108, v138, v139
 v_cvt_pk_bf16_f32 v112, v142, v143
 v_pk_fma_f32 v[144:145], v[146:147], v[90:91], v[144:145] op_sel:[1,1,0] op_sel_hi:[1,0,1] neg_lo:[0,1,0] neg_hi:[0,1,0]
 v_cvt_pk_bf16_f32 v116, v144, v145
 s_waitcnt lgkmcnt(2)
 v_pk_mul_f32 v[132:133], v[92:93], v[200:201] op_sel_hi:[1,0]
 v_pk_mul_f32 v[136:137], v[92:93], v[202:203] op_sel_hi:[1,0]
 v_pk_mul_f32 v[140:141], v[92:93], v[204:205] op_sel_hi:[1,0]
 v_pk_mul_f32 v[144:145], v[92:93], v[206:207] op_sel_hi:[1,0]
 v_fract_f32 v133, v133
 v_fract_f32 v137, v137
 v_fract_f32 v141, v141
 v_fract_f32 v145, v145
 v_exp_f32 v132, v132
 v_cos_f32 v134, v133
 v_sin_f32 v135, v133
 v_exp_f32 v136, v136
 v_cos_f32 v138, v137
 v_sin_f32 v139, v137
 v_exp_f32 v140, v140
 v_cos_f32 v142, v141
 v_sin_f32 v143, v141
 v_exp_f32 v144, v144
 v_cos_f32 v146, v145
 v_sin_f32 v147, v145
 v_pk_mul_f32 v[134:135], v[134:135], v[132:133] op_sel_hi:[1,0]
 v_pk_mul_f32 v[138:139], v[138:139], v[136:137] op_sel_hi:[1,0]
 v_pk_mul_f32 v[142:143], v[142:143], v[140:141] op_sel_hi:[1,0]
 v_pk_mul_f32 v[146:147], v[146:147], v[144:145] op_sel_hi:[1,0]
 v_pk_mul_f32 v[144:145], v[146:147], v[94:95] op_sel_hi:[0,1] neg_hi:[0,1]
 v_cvt_pk_bf16_f32 v105, v134, v135
 v_cvt_pk_bf16_f32 v109, v138, v139
 v_cvt_pk_bf16_f32 v113, v142, v143
 v_pk_fma_f32 v[144:145], v[146:147], v[94:95], v[144:145] op_sel:[1,1,0] op_sel_hi:[1,0,1] neg_lo:[0,1,0] neg_hi:[0,1,0]
 v_cvt_pk_bf16_f32 v117, v144, v145
 s_waitcnt lgkmcnt(1)
 v_pk_mul_f32 v[132:133], v[96:97], v[200:201] op_sel_hi:[1,0]
 v_pk_mul_f32 v[136:137], v[96:97], v[202:203] op_sel_hi:[1,0]
 v_pk_mul_f32 v[140:141], v[96:97], v[204:205] op_sel_hi:[1,0]
 v_pk_mul_f32 v[144:145], v[96:97], v[206:207] op_sel_hi:[1,0]
 v_fract_f32 v133, v133
 v_fract_f32 v137, v137
 v_fract_f32 v141, v141
 v_fract_f32 v145, v145
 v_exp_f32 v132, v132
 v_cos_f32 v134, v133
 v_sin_f32 v135, v133
 v_exp_f32 v136, v136
 v_cos_f32 v138, v137
 v_sin_f32 v139, v137
 v_exp_f32 v140, v140
 v_cos_f32 v142, v141
 v_sin_f32 v143, v141
 v_exp_f32 v144, v144
 v_cos_f32 v146, v145
 v_sin_f32 v147, v145
 v_pk_mul_f32 v[134:135], v[134:135], v[132:133] op_sel_hi:[1,0]
 v_pk_mul_f32 v[138:139], v[138:139], v[136:137] op_sel_hi:[1,0]
 v_pk_mul_f32 v[142:143], v[142:143], v[140:141] op_sel_hi:[1,0]
 v_pk_mul_f32 v[146:147], v[146:147], v[144:145] op_sel_hi:[1,0]
 v_pk_mul_f32 v[144:145], v[146:147], v[98:99] op_sel_hi:[0,1] neg_hi:[0,1]
 v_cvt_pk_bf16_f32 v106, v134, v135
 v_cvt_pk_bf16_f32 v110, v138, v139
 v_cvt_pk_bf16_f32 v114, v142, v143
 v_pk_fma_f32 v[144:145], v[146:147], v[98:99], v[144:145] op_sel:[1,1,0] op_sel_hi:[1,0,1] neg_lo:[0,1,0] neg_hi:[0,1,0]
 v_cvt_pk_bf16_f32 v118, v144, v145
 s_waitcnt lgkmcnt(0)
 v_pk_mul_f32 v[132:133], v[100:101], v[200:201] op_sel_hi:[1,0]
 v_pk_mul_f32 v[136:137], v[100:101], v[202:203] op_sel_hi:[1,0]
 v_pk_mul_f32 v[140:141], v[100:101], v[204:205] op_sel_hi:[1,0]
 v_pk_mul_f32 v[144:145], v[100:101], v[206:207] op_sel_hi:[1,0]
 v_fract_f32 v133, v133
 v_fract_f32 v137, v137
 v_fract_f32 v141, v141
 v_fract_f32 v145, v145
 v_exp_f32 v132, v132
 v_cos_f32 v134, v133
 v_sin_f32 v135, v133
 v_exp_f32 v136, v136
 v_cos_f32 v138, v137
 v_sin_f32 v139, v137
 v_exp_f32 v140, v140
 v_cos_f32 v142, v141
 v_sin_f32 v143, v141
 v_exp_f32 v144, v144
 v_cos_f32 v146, v145
 v_sin_f32 v147, v145
 v_pk_mul_f32 v[134:135], v[134:135], v[132:133] op_sel_hi:[1,0]
 v_pk_mul_f32 v[138:139], v[138:139], v[136:137] op_sel_hi:[1,0]
 v_pk_mul_f32 v[142:143], v[142:143], v[140:141] op_sel_hi:[1,0]
 v_pk_mul_f32 v[146:147], v[146:147], v[144:145] op_sel_hi:[1,0]
 v_pk_mul_f32 v[144:145], v[146:147], v[102:103] op_sel_hi:[0,1] neg_hi:[0,1]
 v_cvt_pk_bf16_f32 v107, v134, v135
 v_cvt_pk_bf16_f32 v111, v138, v139
 v_cvt_pk_bf16_f32 v115, v142, v143
 v_pk_fma_f32 v[144:145], v[146:147], v[102:103], v[144:145] op_sel:[1,1,0] op_sel_hi:[1,0,1] neg_lo:[0,1,0] neg_hi:[0,1,0]
 v_cvt_pk_bf16_f32 v119, v144, v145
 s_add_u32 s95, s95, 1
 s_cmp_lt_u32 s95, 5
 v_mfma_f32_16x16x32_bf16 v[120:123], v[104:107], v[116:119], v[120:123]
 v_mfma_f32_16x16x32_bf16 v[124:127], v[108:111], v[116:119], v[124:127]
 v_mfma_f32_16x16x32_bf16 v[128:131], v[112:115], v[116:119], v[128:131]
 s_cbranch_scc1 L_cfb_kg1
 s_lshl_b32 s93, s28, 3
 buffer_load_dwordx2 v[72:73], v70, s[84:87], s93 offen offset:0
 buffer_load_dwordx2 v[74:75], v70, s[84:87], s93 offen offset:2048
 s_add_u32 s93, s93, 4096
 buffer_load_dwordx2 v[76:77], v70, s[84:87], s93 offen offset:0
 buffer_load_dwordx2 v[78:79], v70, s[84:87], s93 offen offset:2048
 s_add_u32 s93, s93, 4096
 buffer_load_dwordx2 v[80:81], v70, s[84:87], s93 offen offset:0
 buffer_load_dwordx2 v[82:83], v70, s[84:87], s93 offen offset:2048
 s_add_u32 s93, s93, 4096
 buffer_load_dwordx2 v[84:85], v70, s[84:87], s93 offen offset:0
 buffer_load_dwordx2 v[86:87], v70, s[84:87], s93 offen offset:2048
 s_waitcnt vmcnt(28)
 ds_read_b64_tr_b16 a[96:97], v41 offset:32768
 ds_read_b64_tr_b16 a[98:99], v41 offset:32896
 ds_read_b64_tr_b16 a[100:101], v41 offset:34816
 ds_read_b64_tr_b16 a[102:103], v41 offset:34944
 ds_read_b64_tr_b16 a[104:105], v41 offset:32800
 ds_read_b64_tr_b16 a[106:107], v41 offset:32928
 ds_read_b64_tr_b16 a[108:109], v41 offset:34848
 ds_read_b64_tr_b16 a[110:111], v41 offset:34976
 s_waitcnt lgkmcnt(0)
 ds_read_b64_tr_b16 a[144:145], v41 offset:36864
 ds_read_b64_tr_b16 a[146:147], v41 offset:36992
 ds_read_b64_tr_b16 a[148:149], v41 offset:38912
 ds_read_b64_tr_b16 a[150:151], v41 offset:39040
 ds_read_b64_tr_b16 a[152:153], v41 offset:36896
 ds_read_b64_tr_b16 a[154:155], v41 offset:37024
 ds_read_b64_tr_b16 a[156:157], v41 offset:38944
 ds_read_b64_tr_b16 a[158:159], v41 offset:39072
 s_waitcnt lgkmcnt(0)
 s_add_u32 m0, s48, 32768
 s_add_u32 s59, s44, 1048576
 buffer_load_dwordx4 v39, s[8:11], s59 offen  lds
 s_add_u32 m0, s48, 33792
 s_add_u32 s59, s44, 1179648
 buffer_load_dwordx4 v39, s[8:11], s59 offen  lds
 s_add_u32 m0, s49, 34816
 s_add_u32 s59, s45, 1310720
 buffer_load_dwordx4 v39, s[8:11], s59 offen  lds
 s_add_u32 m0, s49, 35840
 s_add_u32 s59, s45, 1441792
 buffer_load_dwordx4 v39, s[8:11], s59 offen  lds
 s_add_u32 m0, s48, 36864
 s_add_u32 s59, s44, 1572864
 buffer_load_dwordx4 v39, s[8:11], s59 offen  lds
 s_add_u32 m0, s48, 37888
 s_add_u32 s59, s44, 1703936
 buffer_load_dwordx4 v39, s[8:11], s59 offen  lds
 s_add_u32 m0, s49, 38912
 s_add_u32 s59, s45, 1835008
 buffer_load_dwordx4 v39, s[8:11], s59 offen  lds
 s_add_u32 m0, s49, 39936
 s_add_u32 s59, s45, 1966080
 buffer_load_dwordx4 v39, s[8:11], s59 offen  lds
L_cfb_kg2:
 ds_read_b128 v[88:91], v69 offset:4160
 ds_read_b128 v[92:95], v69 offset:4176
 ds_read_b128 v[96:99], v69 offset:4192
 ds_read_b128 v[100:103], v69 offset:4208
 v_add_u32 v69, 256, v69
 s_waitcnt lgkmcnt(3)
 v_pk_mul_f32 v[132:133], v[88:89], v[200:201] op_sel_hi:[1,0]
 v_pk_mul_f32 v[136:137], v[88:89], v[202:203] op_sel_hi:[1,0]
 v_pk_mul_f32 v[140:141], v[88:89], v[204:205] op_sel_hi:[1,0]
 v_pk_mul_f32 v[144:145], v[88:89], v[206:207] op_sel_hi:[1,0]
 v_fract_f32 v133, v133
 v_fract_f32 v137, v137
 v_fract_f32 v141, v141
 v_fract_f32 v145, v145
 v_exp_f32 v132, v132
 v_cos_f32 v134, v133
 v_sin_f32 v135, v133
 v_exp_f32 v136, v136
 v_cos_f32 v138, v137
 v_sin_f32 v139, v137
 v_exp_f32 v140, v140
 v_cos_f32 v142, v141
 v_sin_f32 v143, v141
 v_exp_f32 v144, v144
 v_cos_f32 v146, v145
 v_sin_f32 v147, v145
 v_pk_mul_f32 v[134:135], v[134:135], v[132:133] op_sel_hi:[1,0]
 v_pk_mul_f32 v[138:139], v[138:139], v[136:137] op_sel_hi:[1,0]
 v_pk_mul_f32 v[142:143], v[142:143], v[140:141] op_sel_hi:[1,0]
 v_pk_mul_f32 v[146:147], v[146:147], v[144:145] op_sel_hi:[1,0]
 v_pk_mul_f32 v[144:145], v[146:147], v[90:91] op_sel_hi:[0,1] neg_hi:[0,1]
 v_cvt_pk_bf16_f32 v104, v134, v135
 v_cvt_pk_bf16_f32 v108, v138, v139
 v_cvt_pk_bf16_f32 v112, v142, v143
 v_pk_fma_f32 v[144:145], v[146:147], v[90:91], v[144:145] op_sel:[1,1,0] op_sel_hi:[1,0,1] neg_lo:[0,1,0] neg_hi:[0,1,0]
 v_cvt_pk_bf16_f32 v116, v144, v145
 s_waitcnt lgkmcnt(2)
 v_pk_mul_f32 v[132:133], v[92:93], v[200:201] op_sel_hi:[1,0]
 v_pk_mul_f32 v[136:137], v[92:93], v[202:203] op_sel_hi:[1,0]
 v_pk_mul_f32 v[140:141], v[92:93], v[204:205] op_sel_hi:[1,0]
 v_pk_mul_f32 v[144:145], v[92:93], v[206:207] op_sel_hi:[1,0]
 v_fract_f32 v133, v133
 v_fract_f32 v137, v137
 v_fract_f32 v141, v141
 v_fract_f32 v145, v145
 v_exp_f32 v132, v132
 v_cos_f32 v134, v133
 v_sin_f32 v135, v133
 v_exp_f32 v136, v136
 v_cos_f32 v138, v137
 v_sin_f32 v139, v137
 v_exp_f32 v140, v140
 v_cos_f32 v142, v141
 v_sin_f32 v143, v141
 v_exp_f32 v144, v144
 v_cos_f32 v146, v145
 v_sin_f32 v147, v145
 v_pk_mul_f32 v[134:135], v[134:135], v[132:133] op_sel_hi:[1,0]
 v_pk_mul_f32 v[138:139], v[138:139], v[136:137] op_sel_hi:[1,0]
 v_pk_mul_f32 v[142:143], v[142:143], v[140:141] op_sel_hi:[1,0]
 v_pk_mul_f32 v[146:147], v[146:147], v[144:145] op_sel_hi:[1,0]
 v_pk_mul_f32 v[144:145], v[146:147], v[94:95] op_sel_hi:[0,1] neg_hi:[0,1]
 v_cvt_pk_bf16_f32 v105, v134, v135
 v_cvt_pk_bf16_f32 v109, v138, v139
 v_cvt_pk_bf16_f32 v113, v142, v143
 v_pk_fma_f32 v[144:145], v[146:147], v[94:95], v[144:145] op_sel:[1,1,0] op_sel_hi:[1,0,1] neg_lo:[0,1,0] neg_hi:[0,1,0]
 v_cvt_pk_bf16_f32 v117, v144, v145
 s_waitcnt lgkmcnt(1)
 v_pk_mul_f32 v[132:133], v[96:97], v[200:201] op_sel_hi:[1,0]
 v_pk_mul_f32 v[136:137], v[96:97], v[202:203] op_sel_hi:[1,0]
 v_pk_mul_f32 v[140:141], v[96:97], v[204:205] op_sel_hi:[1,0]
 v_pk_mul_f32 v[144:145], v[96:97], v[206:207] op_sel_hi:[1,0]
 v_fract_f32 v133, v133
 v_fract_f32 v137, v137
 v_fract_f32 v141, v141
 v_fract_f32 v145, v145
 v_exp_f32 v132, v132
 v_cos_f32 v134, v133
 v_sin_f32 v135, v133
 v_exp_f32 v136, v136
 v_cos_f32 v138, v137
 v_sin_f32 v139, v137
 v_exp_f32 v140, v140
 v_cos_f32 v142, v141
 v_sin_f32 v143, v141
 v_exp_f32 v144, v144
 v_cos_f32 v146, v145
 v_sin_f32 v147, v145
 v_pk_mul_f32 v[134:135], v[134:135], v[132:133] op_sel_hi:[1,0]
 v_pk_mul_f32 v[138:139], v[138:139], v[136:137] op_sel_hi:[1,0]
 v_pk_mul_f32 v[142:143], v[142:143], v[140:141] op_sel_hi:[1,0]
 v_pk_mul_f32 v[146:147], v[146:147], v[144:145] op_sel_hi:[1,0]
 v_pk_mul_f32 v[144:145], v[146:147], v[98:99] op_sel_hi:[0,1] neg_hi:[0,1]
 v_cvt_pk_bf16_f32 v106, v134, v135
 v_cvt_pk_bf16_f32 v110, v138, v139
 v_cvt_pk_bf16_f32 v114, v142, v143
 v_pk_fma_f32 v[144:145], v[146:147], v[98:99], v[144:145] op_sel:[1,1,0] op_sel_hi:[1,0,1] neg_lo:[0,1,0] neg_hi:[0,1,0]
 v_cvt_pk_bf16_f32 v118, v144, v145
 s_waitcnt lgkmcnt(0)
 v_pk_mul_f32 v[132:133], v[100:101], v[200:201] op_sel_hi:[1,0]
 v_pk_mul_f32 v[136:137], v[100:101], v[202:203] op_sel_hi:[1,0]
 v_pk_mul_f32 v[140:141], v[100:101], v[204:205] op_sel_hi:[1,0]
 v_pk_mul_f32 v[144:145], v[100:101], v[206:207] op_sel_hi:[1,0]
 v_fract_f32 v133, v133
 v_fract_f32 v137, v137
 v_fract_f32 v141, v141
 v_fract_f32 v145, v145
 v_exp_f32 v132, v132
 v_cos_f32 v134, v133
 v_sin_f32 v135, v133
 v_exp_f32 v136, v136
 v_cos_f32 v138, v137
 v_sin_f32 v139, v137
 v_exp_f32 v140, v140
 v_cos_f32 v142, v141
 v_sin_f32 v143, v141
 v_exp_f32 v144, v144
 v_cos_f32 v146, v145
 v_sin_f32 v147, v145
 v_pk_mul_f32 v[134:135], v[134:135], v[132:133] op_sel_hi:[1,0]
 v_pk_mul_f32 v[138:139], v[138:139], v[136:137] op_sel_hi:[1,0]
 v_pk_mul_f32 v[142:143], v[142:143], v[140:141] op_sel_hi:[1,0]
 v_pk_mul_f32 v[146:147], v[146:147], v[144:145] op_sel_hi:[1,0]
 v_pk_mul_f32 v[144:145], v[146:147], v[102:103] op_sel_hi:[0,1] neg_hi:[0,1]
 v_cvt_pk_bf16_f32 v107, v134, v135
 v_cvt_pk_bf16_f32 v111, v138, v139
 v_cvt_pk_bf16_f32 v115, v142, v143
 v_pk_fma_f32 v[144:145], v[146:147], v[102:103], v[144:145] op_sel:[1,1,0] op_sel_hi:[1,0,1] neg_lo:[0,1,0] neg_hi:[0,1,0]
 v_cvt_pk_bf16_f32 v119, v144, v145
 s_add_u32 s95, s95, 1
 s_cmp_lt_u32 s95, 8
 v_mfma_f32_16x16x32_bf16 v[120:123], v[104:107], v[116:119], v[120:123]
 v_mfma_f32_16x16x32_bf16 v[124:127], v[108:111], v[116:119], v[124:127]
 v_mfma_f32_16x16x32_bf16 v[128:131], v[112:115], v[116:119], v[128:131]
 s_cbranch_scc1 L_cfb_kg2
 s_waitcnt vmcnt(16)
 ds_read_b64_tr_b16 a[16:17], v41 offset:0
 ds_read_b64_tr_b16 a[18:19], v41 offset:128
 ds_read_b64_tr_b16 a[20:21], v41 offset:2048
 ds_read_b64_tr_b16 a[22:23], v41 offset:2176
 ds_read_b64_tr_b16 a[24:25], v41 offset:32
 ds_read_b64_tr_b16 a[26:27], v41 offset:160
 ds_read_b64_tr_b16 a[28:29], v41 offset:2080
 ds_read_b64_tr_b16 a[30:31], v41 offset:2208
 s_waitcnt lgkmcnt(0)
 ds_read_b64_tr_b16 a[64:65], v41 offset:4096
 ds_read_b64_tr_b16 a[66:67], v41 offset:4224
 ds_read_b64_tr_b16 a[68:69], v41 offset:6144
 ds_read_b64_tr_b16 a[70:71], v41 offset:6272
 ds_read_b64_tr_b16 a[72:73], v41 offset:4128
 ds_read_b64_tr_b16 a[74:75], v41 offset:4256
 ds_read_b64_tr_b16 a[76:77], v41 offset:6176
 ds_read_b64_tr_b16 a[78:79], v41 offset:6304
 s_waitcnt lgkmcnt(0)
 s_mov_b64 s[8:9], s[20:21]
 s_add_u32 m0, s48, 0
 s_add_u32 s59, s44, 0
 buffer_load_dwordx4 v39, s[8:11], s59 offen  lds
 s_add_u32 m0, s48, 1024
 s_add_u32 s59, s44, 131072
 buffer_load_dwordx4 v39, s[8:11], s59 offen  lds
 s_add_u32 m0, s49, 2048
 s_add_u32 s59, s45, 262144
 buffer_load_dwordx4 v39, s[8:11], s59 offen  lds
 s_add_u32 m0, s49, 3072
 s_add_u32 s59, s45, 393216
 buffer_load_dwordx4 v39, s[8:11], s59 offen  lds
 s_add_u32 m0, s48, 4096
 s_add_u32 s59, s44, 524288
 buffer_load_dwordx4 v39, s[8:11], s59 offen  lds
 s_add_u32 m0, s48, 5120
 s_add_u32 s59, s44, 655360
 buffer_load_dwordx4 v39, s[8:11], s59 offen  lds
 s_add_u32 m0, s49, 6144
 s_add_u32 s59, s45, 786432
 buffer_load_dwordx4 v39, s[8:11], s59 offen  lds
 s_add_u32 m0, s49, 7168
 s_add_u32 s59, s45, 917504
 buffer_load_dwordx4 v39, s[8:11], s59 offen  lds
 v_lshlrev_b32 v65, 5, v67
 v_lshl_add_u32 v65, v68, 3, v65
 v_add_u32 v65, s94, v65
 v_lshlrev_b32 v66, 4, v67
 v_lshl_add_u32 v66, v68, 3, v66
 v_lshlrev_b32 v69, 3, v67
 v_lshl_add_u32 v69, v68, 7, v69
 v_cmp_gt_u32 vcc, 2, v68
 s_nop 1
 v_cndmask_b32 v66, v69, v66, vcc
 v_add_u32 v66, s94, v66
 v_lshlrev_b32 v69, 2, v67
 v_lshl_add_u32 v69, v68, 7, v69
 v_add_u32 v69, s94, v69
 v_cvt_pk_bf16_f32 v132, v120, v121
 v_cvt_pk_bf16_f32 v133, v122, v123
 v_cvt_pk_bf16_f32 v134, v124, v125
 v_cvt_pk_bf16_f32 v135, v126, v127
 v_cvt_pk_bf16_f32 v136, v128, v129
 v_cvt_pk_bf16_f32 v137, v130, v131
 ds_write_b64 v65, v[132:133]
 ds_write_b64 v66, v[134:135] offset:512
 ds_write_b32 v69, v136 offset:1024
 ds_write_b32 v69, v137 offset:1088
 v_lshrrev_b32 v65, 2, v0
 v_mul_u32_u24 v65, 80, v65
 v_and_b32 v66, 3, v0
 v_lshl_add_u32 v69, v66, 4, v65
 v_add_u32 v69, 82256, v69
 v_add_u32 v215, 43776, v69
 s_waitcnt vmcnt(16)
 v_perm_b32 v140, v74, v72, s96
 v_perm_b32 v141, v78, v76, s96
 v_perm_b32 v142, v82, v80, s96
 v_perm_b32 v143, v86, v84, s96
 ds_write_b128 v69, v[140:143] offset:0
 v_perm_b32 v144, v74, v72, s97
 v_perm_b32 v145, v78, v76, s97
 v_perm_b32 v146, v82, v80, s97
 v_perm_b32 v147, v86, v84, s97
 ds_write_b128 v69, v[144:147] offset:21888
 v_perm_b32 v148, v75, v73, s96
 v_perm_b32 v149, v79, v77, s96
 v_perm_b32 v150, v83, v81, s96
 v_perm_b32 v151, v87, v85, s96
 ds_write_b128 v215, v[148:151] offset:0
 v_perm_b32 v152, v75, v73, s97
 v_perm_b32 v153, v79, v77, s97
 v_perm_b32 v154, v83, v81, s97
 v_perm_b32 v155, v87, v85, s97
 ds_write_b128 v215, v[152:155] offset:21888
 v_lshlrev_b32 v65, 3, v64
 v_sub_u32 v65, 2047, v65
 v_cvt_f32_u32 v66, v65
 s_sub_u32 s92, s94, 34048
 s_waitcnt lgkmcnt(0)
 v_subrev_f32 v120, 0x0, v66
 v_subrev_f32 v121, 0x3f800000, v66
 v_cvt_pk_bf16_f32 v122, v120, v121
 v_and_b32 v120, 0xffff, v122
 v_lshrrev_b32 v121, 16, v122
 v_lshl_add_u32 v132, v120, 1, s92
 v_lshl_add_u32 v133, v121, 1, s92
 v_subrev_f32 v120, 0x40000000, v66
 v_subrev_f32 v121, 0x40400000, v66
 v_cvt_pk_bf16_f32 v122, v120, v121
 v_and_b32 v120, 0xffff, v122
 v_lshrrev_b32 v121, 16, v122
 v_lshl_add_u32 v134, v120, 1, s92
 v_lshl_add_u32 v135, v121, 1, s92
 v_subrev_f32 v120, 0x40800000, v66
 v_subrev_f32 v121, 0x40a00000, v66
 v_cvt_pk_bf16_f32 v122, v120, v121
 v_and_b32 v120, 0xffff, v122
 v_lshrrev_b32 v121, 16, v122
 v_lshl_add_u32 v136, v120, 1, s92
 v_lshl_add_u32 v137, v121, 1, s92
 v_subrev_f32 v120, 0x40c00000, v66
 v_subrev_f32 v121, 0x40e00000, v66
 v_cvt_pk_bf16_f32 v122, v120, v121
 v_and_b32 v120, 0xffff, v122
 v_lshrrev_b32 v121, 16, v122
 v_lshl_add_u32 v138, v120, 1, s92
 v_lshl_add_u32 v139, v121, 1, s92
 s_waitcnt lgkmcnt(0)
 ds_read_u16 v88, v132
 ds_read_u16 v92, v133
 ds_read_u16 v89, v134
 ds_read_u16 v93, v135
 ds_read_u16 v90, v136
 ds_read_u16 v94, v137
 ds_read_u16 v91, v138
 ds_read_u16 v95, v139
 v_subrev_f32 v120, 0x44000000, v66
 v_subrev_f32 v121, 0x44004000, v66
 v_cvt_pk_bf16_f32 v122, v120, v121
 v_and_b32 v120, 0xffff, v122
 v_lshrrev_b32 v121, 16, v122
 v_lshl_add_u32 v132, v120, 1, s92
 v_lshl_add_u32 v133, v121, 1, s92
 v_subrev_f32 v120, 0x44008000, v66
 v_subrev_f32 v121, 0x4400c000, v66
 v_cvt_pk_bf16_f32 v122, v120, v121
 v_and_b32 v120, 0xffff, v122
 v_lshrrev_b32 v121, 16, v122
 v_lshl_add_u32 v134, v120, 1, s92
 v_lshl_add_u32 v135, v121, 1, s92
 v_subrev_f32 v120, 0x44010000, v66
 v_subrev_f32 v121, 0x44014000, v66
 v_cvt_pk_bf16_f32 v122, v120, v121
 v_and_b32 v120, 0xffff, v122
 v_lshrrev_b32 v121, 16, v122
 v_lshl_add_u32 v136, v120, 1, s92
 v_lshl_add_u32 v137, v121, 1, s92
 v_subrev_f32 v120, 0x44018000, v66
 v_subrev_f32 v121, 0x4401c000, v66
 v_cvt_pk_bf16_f32 v122, v120, v121
 v_and_b32 v120, 0xffff, v122
 v_lshrrev_b32 v121, 16, v122
 v_lshl_add_u32 v138, v120, 1, s92
 v_lshl_add_u32 v139, v121, 1, s92
 s_waitcnt lgkmcnt(0)
 ds_read_u16 v96, v132
 ds_read_u16 v100, v133
 ds_read_u16 v97, v134
 ds_read_u16 v101, v135
 ds_read_u16 v98, v136
 ds_read_u16 v102, v137
 ds_read_u16 v99, v138
 ds_read_u16 v103, v139
 v_subrev_f32 v120, 0x44800000, v66
 v_subrev_f32 v121, 0x44802000, v66
 v_cvt_pk_bf16_f32 v122, v120, v121
 v_and_b32 v120, 0xffff, v122
 v_lshrrev_b32 v121, 16, v122
 v_lshl_add_u32 v132, v120, 1, s92
 v_lshl_add_u32 v133, v121, 1, s92
 v_subrev_f32 v120, 0x44804000, v66
 v_subrev_f32 v121, 0x44806000, v66
 v_cvt_pk_bf16_f32 v122, v120, v121
 v_and_b32 v120, 0xffff, v122
 v_lshrrev_b32 v121, 16, v122
 v_lshl_add_u32 v134, v120, 1, s92
 v_lshl_add_u32 v135, v121, 1, s92
 v_subrev_f32 v120, 0x44808000, v66
 v_subrev_f32 v121, 0x4480a000, v66
 v_cvt_pk_bf16_f32 v122, v120, v121
 v_and_b32 v120, 0xffff, v122
 v_lshrrev_b32 v121, 16, v122
 v_lshl_add_u32 v136, v120, 1, s92
 v_lshl_add_u32 v137, v121, 1, s92
 v_subrev_f32 v120, 0x4480c000, v66
 v_subrev_f32 v121, 0x4480e000, v66
 v_cvt_pk_bf16_f32 v122, v120, v121
 v_and_b32 v120, 0xffff, v122
 v_lshrrev_b32 v121, 16, v122
 v_lshl_add_u32 v138, v120, 1, s92
 v_lshl_add_u32 v139, v121, 1, s92
 s_waitcnt lgkmcnt(0)
 ds_read_u16 v104, v132
 ds_read_u16 v108, v133
 ds_read_u16 v105, v134
 ds_read_u16 v109, v135
 ds_read_u16 v106, v136
 ds_read_u16 v110, v137
 ds_read_u16 v107, v138
 ds_read_u16 v111, v139
 v_subrev_f32 v120, 0x44c00000, v66
 v_subrev_f32 v121, 0x44c02000, v66
 v_cvt_pk_bf16_f32 v122, v120, v121
 v_and_b32 v120, 0xffff, v122
 v_lshrrev_b32 v121, 16, v122
 v_subrev_u32 v122, 1536, v65
 v_min_u32 v122, 128, v122
 v_add_u32 v122, 17024, v122
 v_max_u32 v120, v120, v122
 v_subrev_u32 v122, 1537, v65
 v_min_u32 v122, 128, v122
 v_add_u32 v122, 17024, v122
 v_max_u32 v121, v121, v122
 v_lshl_add_u32 v132, v120, 1, s92
 v_lshl_add_u32 v133, v121, 1, s92
 v_subrev_f32 v120, 0x44c04000, v66
 v_subrev_f32 v121, 0x44c06000, v66
 v_cvt_pk_bf16_f32 v122, v120, v121
 v_and_b32 v120, 0xffff, v122
 v_lshrrev_b32 v121, 16, v122
 v_subrev_u32 v122, 1538, v65
 v_min_u32 v122, 128, v122
 v_add_u32 v122, 17024, v122
 v_max_u32 v120, v120, v122
 v_subrev_u32 v122, 1539, v65
 v_min_u32 v122, 128, v122
 v_add_u32 v122, 17024, v122
 v_max_u32 v121, v121, v122
 v_lshl_add_u32 v134, v120, 1, s92
 v_lshl_add_u32 v135, v121, 1, s92
 v_subrev_f32 v120, 0x44c08000, v66
 v_subrev_f32 v121, 0x44c0a000, v66
 v_cvt_pk_bf16_f32 v122, v120, v121
 v_and_b32 v120, 0xffff, v122
 v_lshrrev_b32 v121, 16, v122
 v_subrev_u32 v122, 1540, v65
 v_min_u32 v122, 128, v122
 v_add_u32 v122, 17024, v122
 v_max_u32 v120, v120, v122
 v_subrev_u32 v122, 1541, v65
 v_min_u32 v122, 128, v122
 v_add_u32 v122, 17024, v122
 v_max_u32 v121, v121, v122
 v_lshl_add_u32 v136, v120, 1, s92
 v_lshl_add_u32 v137, v121, 1, s92
 v_subrev_f32 v120, 0x44c0c000, v66
 v_subrev_f32 v121, 0x44c0e000, v66
 v_cvt_pk_bf16_f32 v122, v120, v121
 v_and_b32 v120, 0xffff, v122
 v_lshrrev_b32 v121, 16, v122
 v_subrev_u32 v122, 1542, v65
 v_min_u32 v122, 128, v122
 v_add_u32 v122, 17024, v122
 v_max_u32 v120, v120, v122
 v_subrev_u32 v122, 1543, v65
 v_min_u32 v122, 128, v122
 v_add_u32 v122, 17024, v122
 v_max_u32 v121, v121, v122
 v_lshl_add_u32 v138, v120, 1, s92
 v_lshl_add_u32 v139, v121, 1, s92
 s_waitcnt lgkmcnt(0)
 ds_read_u16 v112, v132
 ds_read_u16 v116, v133
 ds_read_u16 v113, v134
 ds_read_u16 v117, v135
 ds_read_u16 v114, v136
 ds_read_u16 v118, v137
 ds_read_u16 v115, v138
 ds_read_u16 v119, v139
 v_lshl_add_u32 v65, v64, 4, s94
 v_mov_b32 v120, 0
 v_mov_b32 v121, 0
 v_mov_b32 v122, 0
 v_mov_b32 v123, 0
 v_lshrrev_b32 v66, 2, v64
 v_mul_u32_u24 v66, 4096, v66
 v_add_u32 v66, 4096, v66
 v_cmp_gt_u32 vcc, 16, v64
 v_mov_b32 v67, 16384
 s_nop 0
 v_cndmask_b32 v66, v67, v66, vcc
 v_add_u32 v66, v66, v65
 s_waitcnt lgkmcnt(0)
 s_mov_b64 exec, 0x1fffff
 ds_write_b128 v66, v[120:123]
 s_mov_b64 exec, -1
 v_lshl_or_b32 v88, v92, 16, v88
 v_lshl_or_b32 v89, v93, 16, v89
 v_lshl_or_b32 v90, v94, 16, v90
 v_lshl_or_b32 v91, v95, 16, v91
 ds_write_b128 v65, v[88:91] offset:12480
 v_lshl_or_b32 v96, v100, 16, v96
 v_lshl_or_b32 v97, v101, 16, v97
 v_lshl_or_b32 v98, v102, 16, v98
 v_lshl_or_b32 v99, v103, 16, v99
 ds_write_b128 v65, v[96:99] offset:13504
 v_lshl_or_b32 v104, v108, 16, v104
 v_lshl_or_b32 v105, v109, 16, v105
 v_lshl_or_b32 v106, v110, 16, v106
 v_lshl_or_b32 v107, v111, 16, v107
 ds_write_b128 v65, v[104:107] offset:14528
 v_lshl_or_b32 v112, v116, 16, v112
 v_lshl_or_b32 v113, v117, 16, v113
 v_lshl_or_b32 v114, v118, 16, v114
 v_lshl_or_b32 v115, v119, 16, v115
 ds_write_b128 v65, v[112:115] offset:15552
 s_waitcnt lgkmcnt(0)
 ds_read_b64 v[92:93], v65 offset:12496
 ds_read_b64 v[100:101], v65 offset:13520
 ds_read_b64 v[108:109], v65 offset:14544
 ds_read_b64 v[116:117], v65 offset:15568
 s_waitcnt lgkmcnt(0)
 v_alignbit_b32 v132, v89, v88, 16
 v_mov_b32 v136, v89
 v_alignbit_b32 v140, v90, v89, 16
 v_alignbit_b32 v133, v90, v89, 16
 v_mov_b32 v137, v90
 v_alignbit_b32 v141, v91, v90, 16
 v_alignbit_b32 v134, v91, v90, 16
 v_mov_b32 v138, v91
 v_alignbit_b32 v142, v92, v91, 16
 v_alignbit_b32 v135, v92, v91, 16
 v_mov_b32 v139, v92
 v_alignbit_b32 v143, v93, v92, 16
 ds_write_b128 v65, v[132:135] offset:8320
 ds_write_b128 v65, v[136:139] offset:4160
 ds_write_b128 v65, v[140:143] offset:0
 v_alignbit_b32 v144, v97, v96, 16
 v_mov_b32 v148, v97
 v_alignbit_b32 v152, v98, v97, 16
 v_alignbit_b32 v145, v98, v97, 16
 v_mov_b32 v149, v98
 v_alignbit_b32 v153, v99, v98, 16
 v_alignbit_b32 v146, v99, v98, 16
 v_mov_b32 v150, v99
 v_alignbit_b32 v154, v100, v99, 16
 v_alignbit_b32 v147, v100, v99, 16
 v_mov_b32 v151, v100
 v_alignbit_b32 v155, v101, v100, 16
 ds_write_b128 v65, v[144:147] offset:9344
 ds_write_b128 v65, v[148:151] offset:5184
 ds_write_b128 v65, v[152:155] offset:1024
 v_alignbit_b32 v132, v105, v104, 16
 v_mov_b32 v136, v105
 v_alignbit_b32 v140, v106, v105, 16
 v_alignbit_b32 v133, v106, v105, 16
 v_mov_b32 v137, v106
 v_alignbit_b32 v141, v107, v106, 16
 v_alignbit_b32 v134, v107, v106, 16
 v_mov_b32 v138, v107
 v_alignbit_b32 v142, v108, v107, 16
 v_alignbit_b32 v135, v108, v107, 16
 v_mov_b32 v139, v108
 v_alignbit_b32 v143, v109, v108, 16
 ds_write_b128 v65, v[132:135] offset:10368
 ds_write_b128 v65, v[136:139] offset:6208
 ds_write_b128 v65, v[140:143] offset:2048
 v_alignbit_b32 v144, v113, v112, 16
 v_mov_b32 v148, v113
 v_alignbit_b32 v152, v114, v113, 16
 v_alignbit_b32 v145, v114, v113, 16
 v_mov_b32 v149, v114
 v_alignbit_b32 v153, v115, v114, 16
 v_alignbit_b32 v146, v115, v114, 16
 v_mov_b32 v150, v115
 v_alignbit_b32 v154, v116, v115, 16
 v_alignbit_b32 v147, v116, v115, 16
 v_mov_b32 v151, v116
 v_alignbit_b32 v155, v117, v116, 16
 ds_write_b128 v65, v[144:147] offset:11392
 ds_write_b128 v65, v[148:151] offset:7232
 ds_write_b128 v65, v[152:155] offset:3072
 v_and_b32 v66, 3, v64
 v_mul_u32_u24 v65, 4160, v66
 v_bfe_u32 v66, v64, 3, 1
 v_bfe_u32 v67, v64, 2, 1
 v_lshl_add_u32 v66, v67, 1, v66
 v_bfe_u32 v67, v64, 4, 1
 v_lshl_add_u32 v66, v67, 2, v66
 v_lshlrev_b32 v66, 3, v66
 v_sub_u32 v65, v65, v66
 v_lshrrev_b32 v67, 5, v64
 v_lshl_add_u32 v65, v67, 4, v65
 s_add_u32 s92, s94, 2040
 v_add_u32 v65, s92, v65
 v_and_b32 v66, 31, v64
 v_mul_u32_u24 v66, 80, v66
 v_lshl_add_u32 v67, v67, 4, v66
 s_add_u32 s92, s94, 16720
 v_add_u32 v67, s92, v67
 v_mov_b32 v214, v67
 v_mov_b32 v68, v67
 s_sub_u32 s93, s92, 80
 v_mov_b32 v88, 0
 v_mov_b32 v89, 0
 v_mov_b32 v90, 0
 v_mov_b32 v91, 0
 v_mov_b32 v92, 0
 v_mov_b32 v93, 0
 v_mov_b32 v94, 0
 v_mov_b32 v95, 0
 v_mov_b32 v96, 0
 v_mov_b32 v97, 0
 v_mov_b32 v98, 0
 v_mov_b32 v99, 0
 v_mov_b32 v100, 0
 v_mov_b32 v101, 0
 v_mov_b32 v102, 0
 v_mov_b32 v103, 0
 v_mov_b32 v104, 0
 v_mov_b32 v105, 0
 v_mov_b32 v106, 0
 v_mov_b32 v107, 0
 v_mov_b32 v108, 0
 v_mov_b32 v109, 0
 v_mov_b32 v110, 0
 v_mov_b32 v111, 0
 v_mov_b32 v112, 0
 v_mov_b32 v113, 0
 v_mov_b32 v114, 0
 v_mov_b32 v115, 0
 v_mov_b32 v116, 0
 v_mov_b32 v117, 0
 v_mov_b32 v118, 0
 v_mov_b32 v119, 0
 s_waitcnt lgkmcnt(0)
 s_barrier
 s_waitcnt vmcnt(8)
 ds_read_b64_tr_b16 a[112:113], v41 offset:32768
 ds_read_b64_tr_b16 a[114:115], v41 offset:32896
 ds_read_b64_tr_b16 a[116:117], v41 offset:34816
 ds_read_b64_tr_b16 a[118:119], v41 offset:34944
 ds_read_b64_tr_b16 a[120:121], v41 offset:32800
 ds_read_b64_tr_b16 a[122:123], v41 offset:32928
 ds_read_b64_tr_b16 a[124:125], v41 offset:34848
 ds_read_b64_tr_b16 a[126:127], v41 offset:34976
 s_waitcnt lgkmcnt(0)
 ds_read_b64_tr_b16 a[160:161], v41 offset:36864
 ds_read_b64_tr_b16 a[162:163], v41 offset:36992
 ds_read_b64_tr_b16 a[164:165], v41 offset:38912
 ds_read_b64_tr_b16 a[166:167], v41 offset:39040
 ds_read_b64_tr_b16 a[168:169], v41 offset:36896
 ds_read_b64_tr_b16 a[170:171], v41 offset:37024
 ds_read_b64_tr_b16 a[172:173], v41 offset:38944
 ds_read_b64_tr_b16 a[174:175], v41 offset:39072
 s_waitcnt lgkmcnt(0)
 s_add_u32 m0, s48, 32768
 s_add_u32 s59, s44, 1048576
 buffer_load_dwordx4 v39, s[8:11], s59 offen  lds
 s_add_u32 m0, s48, 33792
 s_add_u32 s59, s44, 1179648
 buffer_load_dwordx4 v39, s[8:11], s59 offen  lds
 s_add_u32 m0, s49, 34816
 s_add_u32 s59, s45, 1310720
 buffer_load_dwordx4 v39, s[8:11], s59 offen  lds
 s_add_u32 m0, s49, 35840
 s_add_u32 s59, s45, 1441792
 buffer_load_dwordx4 v39, s[8:11], s59 offen  lds
 s_add_u32 m0, s48, 36864
 s_add_u32 s59, s44, 1572864
 buffer_load_dwordx4 v39, s[8:11], s59 offen  lds
 s_add_u32 m0, s48, 37888
 s_add_u32 s59, s44, 1703936
 buffer_load_dwordx4 v39, s[8:11], s59 offen  lds
 s_add_u32 m0, s49, 38912
 s_add_u32 s59, s45, 1835008
 buffer_load_dwordx4 v39, s[8:11], s59 offen  lds
 s_add_u32 m0, s49, 39936
 s_add_u32 s59, s45, 1966080
 buffer_load_dwordx4 v39, s[8:11], s59 offen  lds
 v_mov_b32 v216, s34
 v_mov_b32 v217, s35
 v_bfrev_b32 v218, 1
 v_cmp_eq_u32 vcc, 64, v0
 s_nop 1
 v_cndmask_b32 v218, v218, 0, vcc
 buffer_atomic_add_x2 v[216:217], v218, s[12:15], s30 offen sc1
 ds_read_b64 v[120:121], v65 offset:2080
 ds_read_b64 v[122:123], v65 offset:2088
 ds_read_b128 v[128:131], v67 offset:2592
 ds_read_b128 v[132:135], v68 offset:32
 ds_read_b64 v[124:125], v65 offset:32
 ds_read_b64 v[126:127], v65 offset:40
 s_mov_b32 s95, 0
L_cfb_cv0:
 ds_read_b64 v[136:137], v65 offset:2048
 ds_read_b64 v[138:139], v65 offset:2056
 ds_read_b128 v[144:147], v67 offset:2560
 ds_read_b128 v[148:151], v68 offset:0
 ds_read_b64 v[140:141], v65 offset:0
 ds_read_b64 v[142:143], v65 offset:8
 s_waitcnt lgkmcnt(6)
 v_mfma_f32_32x32x16_bf16 v[104:119], v[120:123], v[128:131], v[104:119]
 v_subrev_u32 v65, 64, v65
 v_subrev_u32 v67, 80, v67
 v_max_i32 v68, s93, v67
 v_mfma_f32_32x32x16_bf16 v[88:103], v[120:123], v[132:135], v[88:103]
 v_mfma_f32_32x32x16_bf16 v[104:119], v[124:127], v[132:135], v[104:119]
 ds_read_b64 v[120:121], v65 offset:2080
 ds_read_b64 v[122:123], v65 offset:2088
 ds_read_b128 v[128:131], v67 offset:2592
 ds_read_b128 v[132:135], v68 offset:32
 ds_read_b64 v[124:125], v65 offset:32
 ds_read_b64 v[126:127], v65 offset:40
 s_waitcnt lgkmcnt(6)
 v_mfma_f32_32x32x16_bf16 v[104:119], v[136:139], v[144:147], v[104:119]
 s_add_u32 s95, s95, 1
 s_cmp_lt_u32 s95, 8
 v_mfma_f32_32x32x16_bf16 v[88:103], v[136:139], v[148:151], v[88:103]
 v_mfma_f32_32x32x16_bf16 v[104:119], v[140:143], v[148:151], v[104:119]
 s_cbranch_scc1 L_cfb_cv0
 s_waitcnt vmcnt(9)
 ds_read_b64_tr_b16 a[32:33], v41 offset:0
 ds_read_b64_tr_b16 a[34:35], v41 offset:128
 ds_read_b64_tr_b16 a[36:37], v41 offset:2048
 ds_read_b64_tr_b16 a[38:39], v41 offset:2176
 ds_read_b64_tr_b16 a[40:41], v41 offset:32
 ds_read_b64_tr_b16 a[42:43], v41 offset:160
 ds_read_b64_tr_b16 a[44:45], v41 offset:2080
 ds_read_b64_tr_b16 a[46:47], v41 offset:2208
 s_waitcnt lgkmcnt(0)
 ds_read_b64_tr_b16 a[80:81], v41 offset:4096
 ds_read_b64_tr_b16 a[82:83], v41 offset:4224
 ds_read_b64_tr_b16 a[84:85], v41 offset:6144
 ds_read_b64_tr_b16 a[86:87], v41 offset:6272
 ds_read_b64_tr_b16 a[88:89], v41 offset:4128
 ds_read_b64_tr_b16 a[90:91], v41 offset:4256
 ds_read_b64_tr_b16 a[92:93], v41 offset:6176
 ds_read_b64_tr_b16 a[94:95], v41 offset:6304
 s_waitcnt lgkmcnt(0)
 s_mov_b64 s[8:9], s[22:23]
 s_add_u32 m0, s48, 0
 s_add_u32 s59, s46, 0
 buffer_load_dwordx4 v40, s[8:11], s59 offen  lds
 s_add_u32 m0, s48, 1024
 s_add_u32 s59, s46, 32768
 buffer_load_dwordx4 v40, s[8:11], s59 offen  lds
 s_add_u32 m0, s49, 2048
 s_add_u32 s59, s47, 65536
 buffer_load_dwordx4 v40, s[8:11], s59 offen  lds
 s_add_u32 m0, s49, 3072
 s_add_u32 s59, s47, 98304
 buffer_load_dwordx4 v40, s[8:11], s59 offen  lds
 s_add_u32 m0, s48, 4096
 s_add_u32 s59, s46, 131072
 buffer_load_dwordx4 v40, s[8:11], s59 offen  lds
 s_add_u32 m0, s48, 5120
 s_add_u32 s59, s46, 163840
 buffer_load_dwordx4 v40, s[8:11], s59 offen  lds
 s_add_u32 m0, s49, 6144
 s_add_u32 s59, s47, 196608
 buffer_load_dwordx4 v40, s[8:11], s59 offen  lds
 s_add_u32 m0, s49, 7168
 s_add_u32 s59, s47, 229376
 buffer_load_dwordx4 v40, s[8:11], s59 offen  lds
 s_mov_b32 s95, 0
L_cfb_cv1:
 ds_read_b64 v[136:137], v65 offset:2048
 ds_read_b64 v[138:139], v65 offset:2056
 ds_read_b128 v[144:147], v67 offset:2560
 ds_read_b128 v[148:151], v68 offset:0
 ds_read_b64 v[140:141], v65 offset:0
 ds_read_b64 v[142:143], v65 offset:8
 s_waitcnt lgkmcnt(6)
 v_mfma_f32_32x32x16_bf16 v[104:119], v[120:123], v[128:131], v[104:119]
 v_subrev_u32 v65, 64, v65
 v_subrev_u32 v67, 80, v67
 v_max_i32 v68, s93, v67
 v_mfma_f32_32x32x16_bf16 v[88:103], v[120:123], v[132:135], v[88:103]
 v_mfma_f32_32x32x16_bf16 v[104:119], v[124:127], v[132:135], v[104:119]
 ds_read_b64 v[120:121], v65 offset:2080
 ds_read_b64 v[122:123], v65 offset:2088
 ds_read_b128 v[128:131], v67 offset:2592
 ds_read_b128 v[132:135], v68 offset:32
 ds_read_b64 v[124:125], v65 offset:32
 ds_read_b64 v[126:127], v65 offset:40
 s_waitcnt lgkmcnt(6)
 v_mfma_f32_32x32x16_bf16 v[104:119], v[136:139], v[144:147], v[104:119]
 s_add_u32 s95, s95, 1
 s_cmp_lt_u32 s95, 8
 v_mfma_f32_32x32x16_bf16 v[88:103], v[136:139], v[148:151], v[88:103]
 v_mfma_f32_32x32x16_bf16 v[104:119], v[140:143], v[148:151], v[104:119]
 s_cbranch_scc1 L_cfb_cv1
 s_waitcnt vmcnt(9)
 ds_read_b64_tr_b16 a[128:129], v41 offset:32768
 ds_read_b64_tr_b16 a[130:131], v41 offset:32896
 ds_read_b64_tr_b16 a[132:133], v41 offset:34816
 ds_read_b64_tr_b16 a[134:135], v41 offset:34944
 ds_read_b64_tr_b16 a[136:137], v41 offset:32800
 ds_read_b64_tr_b16 a[138:139], v41 offset:32928
 ds_read_b64_tr_b16 a[140:141], v41 offset:34848
 ds_read_b64_tr_b16 a[142:143], v41 offset:34976
 s_waitcnt lgkmcnt(0)
 ds_read_b64_tr_b16 a[176:177], v41 offset:36864
 ds_read_b64_tr_b16 a[178:179], v41 offset:36992
 ds_read_b64_tr_b16 a[180:181], v41 offset:38912
 ds_read_b64_tr_b16 a[182:183], v41 offset:39040
 ds_read_b64_tr_b16 a[184:185], v41 offset:36896
 ds_read_b64_tr_b16 a[186:187], v41 offset:37024
 ds_read_b64_tr_b16 a[188:189], v41 offset:38944
 ds_read_b64_tr_b16 a[190:191], v41 offset:39072
 s_waitcnt lgkmcnt(0)
 s_add_u32 m0, s48, 32768
 s_add_u32 s59, s46, 262144
 buffer_load_dwordx4 v40, s[8:11], s59 offen  lds
 s_add_u32 m0, s48, 33792
 s_add_u32 s59, s46, 294912
 buffer_load_dwordx4 v40, s[8:11], s59 offen  lds
 s_add_u32 m0, s49, 34816
 s_add_u32 s59, s47, 327680
 buffer_load_dwordx4 v40, s[8:11], s59 offen  lds
 s_add_u32 m0, s49, 35840
 s_add_u32 s59, s47, 360448
 buffer_load_dwordx4 v40, s[8:11], s59 offen  lds
 s_add_u32 m0, s48, 36864
 s_add_u32 s59, s46, 393216
 buffer_load_dwordx4 v40, s[8:11], s59 offen  lds
 s_add_u32 m0, s48, 37888
 s_add_u32 s59, s46, 425984
 buffer_load_dwordx4 v40, s[8:11], s59 offen  lds
 s_add_u32 m0, s49, 38912
 s_add_u32 s59, s47, 458752
 buffer_load_dwordx4 v40, s[8:11], s59 offen  lds
 s_add_u32 m0, s49, 39936
 s_add_u32 s59, s47, 491520
 buffer_load_dwordx4 v40, s[8:11], s59 offen  lds
 s_mov_b32 s95, 0
L_cfb_cv2:
 ds_read_b64 v[136:137], v65 offset:2048
 ds_read_b64 v[138:139], v65 offset:2056
 ds_read_b128 v[144:147], v67 offset:2560
 ds_read_b128 v[148:151], v68 offset:0
 ds_read_b64 v[140:141], v65 offset:0
 ds_read_b64 v[142:143], v65 offset:8
 s_waitcnt lgkmcnt(6)
 v_mfma_f32_32x32x16_bf16 v[104:119], v[120:123], v[128:131], v[104:119]
 v_subrev_u32 v65, 64, v65
 v_subrev_u32 v67, 80, v67
 v_max_i32 v68, s93, v67
 v_mfma_f32_32x32x16_bf16 v[88:103], v[120:123], v[132:135], v[88:103]
 v_mfma_f32_32x32x16_bf16 v[104:119], v[124:127], v[132:135], v[104:119]
 ds_read_b64 v[120:121], v65 offset:2080
 ds_read_b64 v[122:123], v65 offset:2088
 ds_read_b128 v[128:131], v67 offset:2592
 ds_read_b128 v[132:135], v68 offset:32
 ds_read_b64 v[124:125], v65 offset:32
 ds_read_b64 v[126:127], v65 offset:40
 s_waitcnt lgkmcnt(6)
 v_mfma_f32_32x32x16_bf16 v[104:119], v[136:139], v[144:147], v[104:119]
 s_add_u32 s95, s95, 1
 s_cmp_lt_u32 s95, 8
 v_mfma_f32_32x32x16_bf16 v[88:103], v[136:139], v[148:151], v[88:103]
 v_mfma_f32_32x32x16_bf16 v[104:119], v[140:143], v[148:151], v[104:119]
 s_cbranch_scc1 L_cfb_cv2
 s_waitcnt vmcnt(8)
 s_barrier
 ds_read_b64_tr_b16 a[192:193], v38 offset:0
 ds_read_b64_tr_b16 a[194:195], v38 offset:128
 ds_read_b64_tr_b16 a[196:197], v38 offset:2048
 ds_read_b64_tr_b16 a[198:199], v38 offset:2176
 ds_read_b64_tr_b16 a[200:201], v38 offset:4096
 ds_read_b64_tr_b16 a[202:203], v38 offset:4224
 ds_read_b64_tr_b16 a[204:205], v38 offset:6144
 ds_read_b64_tr_b16 a[206:207], v38 offset:6272
 s_waitcnt lgkmcnt(0)
 ds_read_b64_tr_b16 a[208:209], v38 offset:8192
 ds_read_b64_tr_b16 a[210:211], v38 offset:8320
 ds_read_b64_tr_b16 a[212:213], v38 offset:10240
 ds_read_b64_tr_b16 a[214:215], v38 offset:10368
 ds_read_b64_tr_b16 a[216:217], v38 offset:12288
 ds_read_b64_tr_b16 a[218:219], v38 offset:12416
 ds_read_b64_tr_b16 a[220:221], v38 offset:14336
 ds_read_b64_tr_b16 a[222:223], v38 offset:14464
 s_waitcnt lgkmcnt(0)
 ds_read_b64_tr_b16 a[224:225], v38 offset:16384
 ds_read_b64_tr_b16 a[226:227], v38 offset:16512
 ds_read_b64_tr_b16 a[228:229], v38 offset:18432
 ds_read_b64_tr_b16 a[230:231], v38 offset:18560
 ds_read_b64_tr_b16 a[232:233], v38 offset:20480
 ds_read_b64_tr_b16 a[234:235], v38 offset:20608
 ds_read_b64_tr_b16 a[236:237], v38 offset:22528
 ds_read_b64_tr_b16 a[238:239], v38 offset:22656
 s_waitcnt lgkmcnt(0)
 ds_read_b64_tr_b16 a[240:241], v38 offset:24576
 ds_read_b64_tr_b16 a[242:243], v38 offset:24704
 ds_read_b64_tr_b16 a[244:245], v38 offset:26624
 ds_read_b64_tr_b16 a[246:247], v38 offset:26752
 ds_read_b64_tr_b16 a[248:249], v38 offset:28672
 ds_read_b64_tr_b16 a[250:251], v38 offset:28800
 ds_read_b64_tr_b16 a[252:253], v38 offset:30720
 ds_read_b64_tr_b16 a[254:255], v38 offset:30848
 s_waitcnt lgkmcnt(0)
 s_mov_b32 s95, 0
L_cfb_cv3:
 ds_read_b64 v[136:137], v65 offset:2048
 ds_read_b64 v[138:139], v65 offset:2056
 ds_read_b128 v[144:147], v67 offset:2560
 ds_read_b128 v[148:151], v68 offset:0
 ds_read_b64 v[140:141], v65 offset:0
 ds_read_b64 v[142:143], v65 offset:8
 s_waitcnt lgkmcnt(6)
 v_mfma_f32_32x32x16_bf16 v[104:119], v[120:123], v[128:131], v[104:119]
 v_subrev_u32 v65, 64, v65
 v_subrev_u32 v67, 80, v67
 v_max_i32 v68, s93, v67
 v_mfma_f32_32x32x16_bf16 v[88:103], v[120:123], v[132:135], v[88:103]
 v_mfma_f32_32x32x16_bf16 v[104:119], v[124:127], v[132:135], v[104:119]
 ds_read_b64 v[120:121], v65 offset:2080
 ds_read_b64 v[122:123], v65 offset:2088
 ds_read_b128 v[128:131], v67 offset:2592
 ds_read_b128 v[132:135], v68 offset:32
 ds_read_b64 v[124:125], v65 offset:32
 ds_read_b64 v[126:127], v65 offset:40
 s_waitcnt lgkmcnt(6)
 v_mfma_f32_32x32x16_bf16 v[104:119], v[136:139], v[144:147], v[104:119]
 s_add_u32 s95, s95, 1
 s_cmp_lt_u32 s95, 8
 v_mfma_f32_32x32x16_bf16 v[88:103], v[136:139], v[148:151], v[88:103]
 v_mfma_f32_32x32x16_bf16 v[104:119], v[140:143], v[148:151], v[104:119]
 s_cbranch_scc1 L_cfb_cv3
 s_load_dwordx2 s[84:85], s[0:1], 128
 s_mov_b32 s86, 8388608
 s_mov_b32 s87, 0x20000
 s_lshl_b32 s90, s89, 16
 s_and_b32 s91, s89, s98
 s_and_b32 s89, s88, s98
 s_lshl_b32 s88, s88, 16
 v_lshlrev_b32 v70, 1, v70
 s_lshl_b32 s93, s28, 3
 s_add_u32 s93, s93, 2048
 s_waitcnt lgkmcnt(0)
 s_nop 1
 v_cvt_pk_bf16_f32 v152, v88, v89
 v_cvt_pk_bf16_f32 v153, v90, v91
 v_cvt_pk_bf16_f32 v154, v92, v93
 v_cvt_pk_bf16_f32 v155, v94, v95
 v_cvt_pk_bf16_f32 v156, v96, v97
 v_cvt_pk_bf16_f32 v157, v98, v99
 v_cvt_pk_bf16_f32 v158, v100, v101
 v_cvt_pk_bf16_f32 v159, v102, v103
 ds_write_b128 v214, v[152:155] offset:0
 ds_write_b128 v214, v[156:159] offset:32
 v_cvt_pk_bf16_f32 v160, v104, v105
 v_cvt_pk_bf16_f32 v161, v106, v107
 v_cvt_pk_bf16_f32 v162, v108, v109
 v_cvt_pk_bf16_f32 v163, v110, v111
 v_cvt_pk_bf16_f32 v164, v112, v113
 v_cvt_pk_bf16_f32 v165, v114, v115
 v_cvt_pk_bf16_f32 v166, v116, v117
 v_cvt_pk_bf16_f32 v167, v118, v119
 ds_write_b128 v214, v[160:163] offset:2560
 ds_write_b128 v214, v[164:167] offset:2592
 s_waitcnt lgkmcnt(0)
 s_barrier
 ds_read_b128 v[88:91], v69 offset:0
 ds_read_b128 v[92:95], v69 offset:21888
 ds_read_b128 v[96:99], v215 offset:0
 ds_read_b128 v[100:103], v215 offset:21888
 v_lshlrev_b32 v104, 16, v72
 v_and_b32 v105, s98, v72
 v_pk_mul_f32 v[104:105], v[104:105], s[88:89]
 v_cvt_pk_bf16_f32 v72, v104, v105
 v_lshlrev_b32 v104, 16, v72
 v_and_b32 v105, s98, v72
 v_lshlrev_b32 v106, 16, v73
 v_and_b32 v107, s98, v73
 v_pk_mul_f32 v[106:107], v[106:107], s[90:91]
 v_cvt_pk_bf16_f32 v73, v106, v107
 v_lshlrev_b32 v106, 16, v73
 v_and_b32 v107, s98, v73
 v_lshlrev_b32 v108, 16, v74
 v_and_b32 v109, s98, v74
 v_pk_mul_f32 v[108:109], v[108:109], s[88:89]
 v_cvt_pk_bf16_f32 v74, v108, v109
 v_lshlrev_b32 v108, 16, v74
 v_and_b32 v109, s98, v74
 v_lshlrev_b32 v110, 16, v75
 v_and_b32 v111, s98, v75
 v_pk_mul_f32 v[110:111], v[110:111], s[90:91]
 v_cvt_pk_bf16_f32 v75, v110, v111
 v_lshlrev_b32 v110, 16, v75
 v_and_b32 v111, s98, v75
 v_lshlrev_b32 v112, 16, v76
 v_and_b32 v113, s98, v76
 v_pk_mul_f32 v[112:113], v[112:113], s[88:89]
 v_cvt_pk_bf16_f32 v76, v112, v113
 v_lshlrev_b32 v112, 16, v76
 v_and_b32 v113, s98, v76
 v_lshlrev_b32 v114, 16, v77
 v_and_b32 v115, s98, v77
 v_pk_mul_f32 v[114:115], v[114:115], s[90:91]
 v_cvt_pk_bf16_f32 v77, v114, v115
 v_lshlrev_b32 v114, 16, v77
 v_and_b32 v115, s98, v77
 v_lshlrev_b32 v116, 16, v78
 v_and_b32 v117, s98, v78
 v_pk_mul_f32 v[116:117], v[116:117], s[88:89]
 v_cvt_pk_bf16_f32 v78, v116, v117
 v_lshlrev_b32 v116, 16, v78
 v_and_b32 v117, s98, v78
 v_lshlrev_b32 v118, 16, v79
 v_and_b32 v119, s98, v79
 v_pk_mul_f32 v[118:119], v[118:119], s[90:91]
 v_cvt_pk_bf16_f32 v79, v118, v119
 v_lshlrev_b32 v118, 16, v79
 v_and_b32 v119, s98, v79
 v_lshlrev_b32 v120, 16, v80
 v_and_b32 v121, s98, v80
 v_pk_mul_f32 v[120:121], v[120:121], s[88:89]
 v_cvt_pk_bf16_f32 v80, v120, v121
 v_lshlrev_b32 v120, 16, v80
 v_and_b32 v121, s98, v80
 v_lshlrev_b32 v122, 16, v81
 v_and_b32 v123, s98, v81
 v_pk_mul_f32 v[122:123], v[122:123], s[90:91]
 v_cvt_pk_bf16_f32 v81, v122, v123
 v_lshlrev_b32 v122, 16, v81
 v_and_b32 v123, s98, v81
 v_lshlrev_b32 v124, 16, v82
 v_and_b32 v125, s98, v82
 v_pk_mul_f32 v[124:125], v[124:125], s[88:89]
 v_cvt_pk_bf16_f32 v82, v124, v125
 v_lshlrev_b32 v124, 16, v82
 v_and_b32 v125, s98, v82
 v_lshlrev_b32 v126, 16, v83
 v_and_b32 v127, s98, v83
 v_pk_mul_f32 v[126:127], v[126:127], s[90:91]
 v_cvt_pk_bf16_f32 v83, v126, v127
 v_lshlrev_b32 v126, 16, v83
 v_and_b32 v127, s98, v83
 v_lshlrev_b32 v128, 16, v84
 v_and_b32 v129, s98, v84
 v_pk_mul_f32 v[128:129], v[128:129], s[88:89]
 v_cvt_pk_bf16_f32 v84, v128, v129
 v_lshlrev_b32 v128, 16, v84
 v_and_b32 v129, s98, v84
 v_lshlrev_b32 v130, 16, v85
 v_and_b32 v131, s98, v85
 v_pk_mul_f32 v[130:131], v[130:131], s[90:91]
 v_cvt_pk_bf16_f32 v85, v130, v131
 v_lshlrev_b32 v130, 16, v85
 v_and_b32 v131, s98, v85
 v_lshlrev_b32 v132, 16, v86
 v_and_b32 v133, s98, v86
 v_pk_mul_f32 v[132:133], v[132:133], s[88:89]
 v_cvt_pk_bf16_f32 v86, v132, v133
 v_lshlrev_b32 v132, 16, v86
 v_and_b32 v133, s98, v86
 v_lshlrev_b32 v134, 16, v87
 v_and_b32 v135, s98, v87
 v_pk_mul_f32 v[134:135], v[134:135], s[90:91]
 v_cvt_pk_bf16_f32 v87, v134, v135
 v_lshlrev_b32 v134, 16, v87
 v_and_b32 v135, s98, v87
 s_waitcnt lgkmcnt(0)
 v_lshlrev_b32 v136, 16, v88
 v_lshlrev_b32 v137, 16, v92
 v_lshlrev_b32 v138, 16, v96
 v_lshlrev_b32 v139, 16, v100
 v_pk_add_f32 v[104:105], v[104:105], v[136:137]
 v_cvt_pk_bf16_f32 v72, v104, v105
 v_pk_add_f32 v[106:107], v[106:107], v[138:139]
 v_cvt_pk_bf16_f32 v73, v106, v107
 buffer_store_dwordx2 v[72:73], v70, s[84:87], s93 offen
 s_add_u32 s93, s93, 4096
 v_and_b32 v136, s98, v88
 v_and_b32 v137, s98, v92
 v_and_b32 v138, s98, v96
 v_and_b32 v139, s98, v100
 v_pk_add_f32 v[108:109], v[108:109], v[136:137]
 v_cvt_pk_bf16_f32 v74, v108, v109
 v_pk_add_f32 v[110:111], v[110:111], v[138:139]
 v_cvt_pk_bf16_f32 v75, v110, v111
 buffer_store_dwordx2 v[74:75], v70, s[84:87], s93 offen
 s_add_u32 s93, s93, 4096
 v_lshlrev_b32 v136, 16, v89
 v_lshlrev_b32 v137, 16, v93
 v_lshlrev_b32 v138, 16, v97
 v_lshlrev_b32 v139, 16, v101
 v_pk_add_f32 v[112:113], v[112:113], v[136:137]
 v_cvt_pk_bf16_f32 v76, v112, v113
 v_pk_add_f32 v[114:115], v[114:115], v[138:139]
 v_cvt_pk_bf16_f32 v77, v114, v115
 buffer_store_dwordx2 v[76:77], v70, s[84:87], s93 offen
 s_add_u32 s93, s93, 4096
 v_and_b32 v136, s98, v89
 v_and_b32 v137, s98, v93
 v_and_b32 v138, s98, v97
 v_and_b32 v139, s98, v101
 v_pk_add_f32 v[116:117], v[116:117], v[136:137]
 v_cvt_pk_bf16_f32 v78, v116, v117
 v_pk_add_f32 v[118:119], v[118:119], v[138:139]
 v_cvt_pk_bf16_f32 v79, v118, v119
 buffer_store_dwordx2 v[78:79], v70, s[84:87], s93 offen
 s_add_u32 s93, s93, 4096
 v_lshlrev_b32 v136, 16, v90
 v_lshlrev_b32 v137, 16, v94
 v_lshlrev_b32 v138, 16, v98
 v_lshlrev_b32 v139, 16, v102
 v_pk_add_f32 v[120:121], v[120:121], v[136:137]
 v_cvt_pk_bf16_f32 v80, v120, v121
 v_pk_add_f32 v[122:123], v[122:123], v[138:139]
 v_cvt_pk_bf16_f32 v81, v122, v123
 buffer_store_dwordx2 v[80:81], v70, s[84:87], s93 offen
 s_add_u32 s93, s93, 4096
 v_and_b32 v136, s98, v90
 v_and_b32 v137, s98, v94
 v_and_b32 v138, s98, v98
 v_and_b32 v139, s98, v102
 v_pk_add_f32 v[124:125], v[124:125], v[136:137]
 v_cvt_pk_bf16_f32 v82, v124, v125
 v_pk_add_f32 v[126:127], v[126:127], v[138:139]
 v_cvt_pk_bf16_f32 v83, v126, v127
 buffer_store_dwordx2 v[82:83], v70, s[84:87], s93 offen
 s_add_u32 s93, s93, 4096
 v_lshlrev_b32 v136, 16, v91
 v_lshlrev_b32 v137, 16, v95
 v_lshlrev_b32 v138, 16, v99
 v_lshlrev_b32 v139, 16, v103
 v_pk_add_f32 v[128:129], v[128:129], v[136:137]
 v_cvt_pk_bf16_f32 v84, v128, v129
 v_pk_add_f32 v[130:131], v[130:131], v[138:139]
 v_cvt_pk_bf16_f32 v85, v130, v131
 buffer_store_dwordx2 v[84:85], v70, s[84:87], s93 offen
 s_add_u32 s93, s93, 4096
 v_and_b32 v136, s98, v91
 v_and_b32 v137, s98, v95
 v_and_b32 v138, s98, v99
 v_and_b32 v139, s98, v103
 v_pk_add_f32 v[132:133], v[132:133], v[136:137]
 v_cvt_pk_bf16_f32 v86, v132, v133
 v_pk_add_f32 v[134:135], v[134:135], v[138:139]
 v_cvt_pk_bf16_f32 v87, v134, v135
 buffer_store_dwordx2 v[86:87], v70, s[84:87], s93 offen
 s_add_u32 s93, s93, 4096
 s_waitcnt vmcnt(8)
 s_barrier
 ds_read_b64_tr_b16 v[172:173], v38 offset:32768
 ds_read_b64_tr_b16 v[174:175], v38 offset:32896
 ds_read_b64_tr_b16 v[176:177], v38 offset:34816
 ds_read_b64_tr_b16 v[178:179], v38 offset:34944
 ds_read_b64_tr_b16 v[180:181], v38 offset:36864
 ds_read_b64_tr_b16 v[182:183], v38 offset:36992
 ds_read_b64_tr_b16 v[184:185], v38 offset:38912
 ds_read_b64_tr_b16 v[186:187], v38 offset:39040
 s_waitcnt lgkmcnt(0)
 ds_read_b64_tr_b16 v[188:189], v38 offset:40960
 ds_read_b64_tr_b16 v[190:191], v38 offset:41088
 ds_read_b64_tr_b16 v[192:193], v38 offset:43008
 ds_read_b64_tr_b16 v[194:195], v38 offset:43136
 ds_read_b64_tr_b16 v[196:197], v38 offset:45056
 ds_read_b64_tr_b16 v[198:199], v38 offset:45184
 ds_read_b64_tr_b16 v[200:201], v38 offset:47104
 ds_read_b64_tr_b16 v[202:203], v38 offset:47232
 s_waitcnt lgkmcnt(0)
 ds_read_b64_tr_b16 v[204:205], v38 offset:49152
 ds_read_b64_tr_b16 v[206:207], v38 offset:49280
 ds_read_b64_tr_b16 v[208:209], v38 offset:51200
 ds_read_b64_tr_b16 v[210:211], v38 offset:51328
 ds_read_b64_tr_b16 v[212:213], v38 offset:53248
 ds_read_b64_tr_b16 v[214:215], v38 offset:53376
 ds_read_b64_tr_b16 v[216:217], v38 offset:55296
 ds_read_b64_tr_b16 v[218:219], v38 offset:55424
 s_waitcnt lgkmcnt(0)
 ds_read_b64_tr_b16 v[220:221], v38 offset:57344
 ds_read_b64_tr_b16 v[222:223], v38 offset:57472
 ds_read_b64_tr_b16 v[224:225], v38 offset:59392
 ds_read_b64_tr_b16 v[226:227], v38 offset:59520
 ds_read_b64_tr_b16 v[228:229], v38 offset:61440
 ds_read_b64_tr_b16 v[230:231], v38 offset:61568
 ds_read_b64_tr_b16 v[232:233], v38 offset:63488
 ds_read_b64_tr_b16 v[234:235], v38 offset:63616
 s_waitcnt lgkmcnt(0)
 s_barrier
 v_mov_b32 v39, 0
 v_mov_b32 v40, 0
 v_mov_b32 v41, 0
 s_mov_b32 s3, 0
L_rdy_3:
 buffer_load_dwordx4 v[88:91], off, s[12:15], s30 sc1
 s_add_u32 s3, s3, 1
 s_cmp_gt_u32 s3, 400000
 s_cbranch_scc1 L_exit
 s_waitcnt vmcnt(0)
 v_readfirstlane_b32 s32, v88
 v_readfirstlane_b32 s33, v89
 v_readfirstlane_b32 vcc_hi, v90
 s_and_b32 vcc_lo, s32, 0xffff
 s_cmp_lt_u32 vcc_lo, 256
 s_cbranch_scc1 L_rdy_3
 s_cmp_lg_u32 vcc_hi, 0
 s_cbranch_scc1 L_general
 s_mov_b32 s3, 0
 s_bfe_u64 vcc, s[32:33], 0x60010
 s_add_i32 s3, s3, vcc_lo
 s_bfe_u64 vcc, s[32:33], 0x60016
 s_sub_i32 s3, s3, vcc_lo
 s_bfe_u64 vcc, s[32:33], 0x6001c
 s_add_i32 s3, s3, vcc_lo
 s_bfe_u64 vcc, s[32:33], 0x60022
 s_sub_i32 s3, s3, vcc_lo
 s_bfe_u64 vcc, s[32:33], 0x60028
 s_add_i32 s3, s3, vcc_lo
 s_bfe_u64 vcc, s[32:33], 0x6002e
 s_sub_i32 s3, s3, vcc_lo
 s_bfe_u64 vcc, s[32:33], 0x60034
 s_add_i32 s3, s3, vcc_lo
 s_bfe_u64 vcc, s[32:33], 0x6003a
 s_sub_i32 s3, s3, vcc_lo
 s_cmp_gt_i32 s3, 0
 s_cselect_b32 s3, 8, 24
 s_bfe_u64 vcc, s[32:33], 0x60010
 s_cmp_gt_u32 vcc_lo, s3
 s_cselect_b32 vcc_lo, 1, 0
 s_or_b32 s27, s27, vcc_lo
 s_sub_u32 s3, 32, s3
 s_bfe_u64 vcc, s[32:33], 0x60016
 s_cmp_gt_u32 vcc_lo, s3
 s_cselect_b32 vcc_lo, 2, 0
 s_or_b32 s27, s27, vcc_lo
 s_sub_u32 s3, 32, s3
 s_bfe_u64 vcc, s[32:33], 0x6001c
 s_cmp_gt_u32 vcc_lo, s3
 s_cselect_b32 vcc_lo, 4, 0
 s_or_b32 s27, s27, vcc_lo
 s_sub_u32 s3, 32, s3
 s_bfe_u64 vcc, s[32:33], 0x60022
 s_cmp_gt_u32 vcc_lo, s3
 s_cselect_b32 vcc_lo, 8, 0
 s_or_b32 s27, s27, vcc_lo
 s_sub_u32 s3, 32, s3
 s_bfe_u64 vcc, s[32:33], 0x60028
 s_cmp_gt_u32 vcc_lo, s3
 s_cselect_b32 vcc_lo, 16, 0
 s_or_b32 s27, s27, vcc_lo
 s_sub_u32 s3, 32, s3
 s_bfe_u64 vcc, s[32:33], 0x6002e
 s_cmp_gt_u32 vcc_lo, s3
 s_cselect_b32 vcc_lo, 32, 0
 s_or_b32 s27, s27, vcc_lo
 s_sub_u32 s3, 32, s3
 s_bfe_u64 vcc, s[32:33], 0x60034
 s_cmp_gt_u32 vcc_lo, s3
 s_cselect_b32 vcc_lo, 64, 0
 s_or_b32 s27, s27, vcc_lo
 s_sub_u32 s3, 32, s3
 s_bfe_u64 vcc, s[32:33], 0x6003a
 s_cmp_gt_u32 vcc_lo, s3
 s_cselect_b32 vcc_lo, 128, 0
 s_or_b32 s27, s27, vcc_lo
 s_sub_u32 s3, 32, s3
 s_mov_b32 s59, 63
 s_lshr_b32 s60, s59, 3
 s_lshr_b32 s60, s27, s60
 s_and_b32 s60, s60, 1
 s_lshl_b32 s60, s60, 13
 s_lshl_b32 s72, s59, 18
 s_add_u32 s72, s72, s60
 s_add_u32 s72, s72, 134217728
 s_add_u32 s73, s73, s72
 s_add_u32 s74, s74, s72
 s_add_u32 s75, s75, s72
 s_add_u32 s76, s76, s72
 s_mov_b32 s52, 0
 s_mov_b32 s53, s67
 s_lshl_b32 s59, s24, 5
 s_add_u32 s59, s59, s25
 s_lshl_b32 s57, s59, 11
 s_add_u32 s57, s57, 16777216
 s_lshl_b32 s58, s59, 9
 s_add_u32 s58, s58, 4194304
 s_mov_b32 s62, 0
 s_mov_b32 s40, 0
 s_mov_b32 s41, 0
 s_mov_b32 s42, 0
 s_mov_b32 s43, 0
 s_cmp_eq_u32 s26, 1
 s_cbranch_scc1 L_cf_w1
 s_cmp_eq_u32 s26, 2
 s_cbranch_scc1 L_cf_w2
 s_cmp_eq_u32 s26, 3
 s_cbranch_scc1 L_cf_w3
L_cf_w0:
 v_mov_b32 v205, 0
 v_mov_b32 v207, 0
 v_mov_b32 v209, 0
 v_mov_b32 v56, 0
 v_mov_b32 v57, 0
 v_mov_b32 v58, 0
 v_mov_b32 v59, 0
 v_mov_b32 v60, 0
 v_mov_b32 v61, 0
 v_mov_b32 v62, 0
 v_mov_b32 v63, 0
 v_mov_b32 v64, 0
 v_mov_b32 v65, 0
 v_mov_b32 v66, 0
 v_mov_b32 v67, 0
 v_mov_b32 v68, 0
 v_mov_b32 v69, 0
 v_mov_b32 v70, 0
 v_mov_b32 v71, 0
 v_mov_b32 v72, 0
 v_mov_b32 v73, 0
 v_mov_b32 v74, 0
 v_mov_b32 v75, 0
 v_mov_b32 v76, 0
 v_mov_b32 v77, 0
 v_mov_b32 v78, 0
 v_mov_b32 v79, 0
 s_waitcnt vmcnt(0)
 s_barrier
 buffer_load_dwordx4 v[92:95], v6, s[4:7], s53 offen offset:0 sc1
 s_nop 3
 buffer_load_dwordx4 v[96:99], v6, s[4:7], s53 offen offset:1024 sc1
 s_nop 3
 buffer_load_dwordx4 v[100:103], v6, s[4:7], s53 offen offset:2048 sc1
 s_nop 3
 buffer_load_dwordx4 v[104:107], v6, s[4:7], s53 offen offset:3072 sc1
L_cf_w0_loop:
 s_and_b32 s59, s52, 3
 s_add_u32 s54, s53, 262144
 s_lshl_b32 s60, s59, 16
 s_add_u32 s55, s68, s60
 v_add_u32 v30, 1, v30
 ds_read_b128 v[172:175], v17 offset:49152
 ds_read_b128 v[176:179], v17 offset:49216
 ds_read_b128 v[180:183], v18 offset:51200
 ds_read_b128 v[184:187], v18 offset:51456
L_cf_w0_dtry:
 s_waitcnt vmcnt(3)
 v_smfmac_f32_16x16x64_bf16 v[56:59], v[92:95], a[0:7], v5
 v_smfmac_f32_16x16x64_bf16 v[60:63], v[92:95], a[8:15], v5
 v_smfmac_f32_16x16x64_bf16 v[64:67], v[92:95], a[16:23], v5
 v_smfmac_f32_16x16x64_bf16 v[68:71], v[92:95], a[24:31], v5
 s_waitcnt vmcnt(2)
 v_smfmac_f32_16x16x64_bf16 v[56:59], v[96:99], a[48:55], v5
 v_smfmac_f32_16x16x64_bf16 v[60:63], v[96:99], a[56:63], v5
 v_smfmac_f32_16x16x64_bf16 v[64:67], v[96:99], a[64:71], v5
 v_smfmac_f32_16x16x64_bf16 v[68:71], v[96:99], a[72:79], v5
 s_waitcnt vmcnt(1)
 v_smfmac_f32_16x16x64_bf16 v[56:59], v[100:103], a[96:103], v5
 v_smfmac_f32_16x16x64_bf16 v[60:63], v[100:103], a[104:111], v5
 v_smfmac_f32_16x16x64_bf16 v[64:67], v[100:103], a[112:119], v5
 v_smfmac_f32_16x16x64_bf16 v[68:71], v[100:103], a[120:127], v5
 s_waitcnt vmcnt(0)
 v_smfmac_f32_16x16x64_bf16 v[56:59], v[104:107], a[144:151], v5
 v_smfmac_f32_16x16x64_bf16 v[60:63], v[104:107], a[152:159], v5
 v_smfmac_f32_16x16x64_bf16 v[64:67], v[104:107], a[160:167], v5
 v_smfmac_f32_16x16x64_bf16 v[68:71], v[104:107], a[168:175], v5
 s_nop 4
 v_pk_add_f32 v[84:85], v[56:57], v[58:59]
 ds_write2_b32 v7, v84, v85 offset0:0 offset1:36
 v_cmp_u_f32 vcc, v84, v85
 v_pk_add_f32 v[86:87], v[60:61], v[62:63]
 ds_write2_b32 v7, v86, v87 offset0:16 offset1:52
 v_pk_add_f32 v[88:89], v[64:65], v[66:67]
 ds_write2_b32 v8, v88, v89 offset0:0 offset1:36
 v_pk_add_f32 v[90:91], v[68:69], v[70:71]
 ds_write2_b32 v8, v90, v91 offset0:16 offset1:52
 s_cbranch_vccnz L_cf_w0_dslow
L_cf_w0_dgood:
 v_smfmac_f32_16x16x64_bf16 v[72:75], v[92:95], a[32:39], v5
 v_smfmac_f32_16x16x64_bf16 v[76:79], v[92:95], a[40:47], v5
 v_smfmac_f32_16x16x64_bf16 v[72:75], v[96:99], a[80:87], v5
 v_smfmac_f32_16x16x64_bf16 v[76:79], v[96:99], a[88:95], v5
 s_waitcnt lgkmcnt(0)
 s_barrier
 ds_read_b128 v[108:111], v9 offset:4096
 ds_read_b128 v[112:115], v9 offset:4112
 ds_read_b128 v[116:119], v9 offset:6400
 ds_read_b128 v[120:123], v9 offset:6416
 ds_read_b128 v[124:127], v9 offset:8704
 ds_read_b128 v[128:131], v9 offset:8720
 ds_read_b128 v[132:135], v9 offset:11008
 ds_read_b128 v[136:139], v9 offset:11024
 v_smfmac_f32_16x16x64_bf16 v[72:75], v[100:103], a[128:135], v5
 s_waitcnt lgkmcnt(6)
 v_pk_mul_f32 v[108:109], v[108:109], v[54:55] op_sel_hi:[1,0]
 v_pk_mul_f32 v[110:111], v[110:111], v[54:55] op_sel_hi:[1,0]
 v_pk_mul_f32 v[112:113], v[112:113], v[54:55] op_sel_hi:[1,0]
 v_pk_mul_f32 v[114:115], v[114:115], v[54:55] op_sel_hi:[1,0]
 s_waitcnt lgkmcnt(4)
 v_pk_fma_f32 v[108:109], v[116:117], v[54:55], v[108:109] op_sel_hi:[1,0,1]
 v_pk_fma_f32 v[110:111], v[118:119], v[54:55], v[110:111] op_sel_hi:[1,0,1]
 v_pk_fma_f32 v[112:113], v[120:121], v[54:55], v[112:113] op_sel_hi:[1,0,1]
 v_pk_fma_f32 v[114:115], v[122:123], v[54:55], v[114:115] op_sel_hi:[1,0,1]
 s_waitcnt lgkmcnt(2)
 v_pk_fma_f32 v[108:109], v[124:125], v[54:55], v[108:109] op_sel_hi:[1,0,1]
 v_pk_fma_f32 v[110:111], v[126:127], v[54:55], v[110:111] op_sel_hi:[1,0,1]
 v_pk_fma_f32 v[112:113], v[128:129], v[54:55], v[112:113] op_sel_hi:[1,0,1]
 v_pk_fma_f32 v[114:115], v[130:131], v[54:55], v[114:115] op_sel_hi:[1,0,1]
 s_waitcnt lgkmcnt(0)
 v_pk_fma_f32 v[108:109], v[132:133], v[54:55], v[108:109] op_sel_hi:[1,0,1]
 v_pk_fma_f32 v[110:111], v[134:135], v[54:55], v[110:111] op_sel_hi:[1,0,1]
 v_pk_fma_f32 v[112:113], v[136:137], v[54:55], v[112:113] op_sel_hi:[1,0,1]
 v_pk_fma_f32 v[114:115], v[138:139], v[54:55], v[114:115] op_sel_hi:[1,0,1]
 v_cvt_pk_bf16_f32 v188, v108, v109
 v_cvt_pk_bf16_f32 v189, v110, v111
 v_cvt_pk_bf16_f32 v190, v112, v113
 v_cvt_pk_bf16_f32 v191, v114, v115
 s_nop 1
 v_mfma_f32_16x16x32_bf16 v[192:195], v[172:175], v[188:191], 0
 v_mfma_f32_16x16x32_bf16 v[196:199], v[176:179], v[188:191], 0
 v_mfma_f32_16x16x32_bf16 v[200:203], v[188:191], v[188:191], 0
 s_nop 5
 buffer_store_dwordx4 v[192:195], v11, s[4:7], s55 offen
 buffer_store_dwordx4 v[196:199], v11, s[4:7], s55 offen offset:128
 buffer_store_dwordx4 v[200:203], v12, s[4:7], s55 offen
 v_smfmac_f32_16x16x64_bf16 v[76:79], v[100:103], a[136:143], v5
 v_smfmac_f32_16x16x64_bf16 v[72:75], v[104:107], a[176:183], v5
 v_smfmac_f32_16x16x64_bf16 v[76:79], v[104:107], a[184:191], v5
 s_barrier
 buffer_load_dwordx4 v[108:111], v47, s[4:7], s55 offen sc1
 buffer_load_dwordx4 v[112:115], v48, s[4:7], s55 offen sc1
 buffer_load_dwordx4 v[116:119], v49, s[4:7], s55 offen sc1
 buffer_load_dword v120, v13, s[4:7], s55 offen offset:0 sc1
 buffer_load_dword v121, v13, s[4:7], s55 offen offset:1280 sc1
 buffer_load_dword v122, v13, s[4:7], s55 offen offset:2560 sc1
 buffer_load_dword v123, v13, s[4:7], s55 offen offset:3840 sc1
 ds_read_b128 v[124:127], v2 offset:15360
 ds_read_b128 v[128:131], v2 offset:16384
 ds_read_b128 v[132:135], v2 offset:17408
 v_pk_add_f32 v[84:85], v[72:73], v[74:75]
 v_pk_add_f32 v[86:87], v[76:77], v[78:79]
 v_mov_b32_dpp v192, v196 row_ror:8 row_mask:0xf bank_mask:0xc
 v_mov_b32_dpp v193, v197 row_ror:8 row_mask:0xf bank_mask:0xc
 v_mov_b32_dpp v194, v198 row_ror:8 row_mask:0xf bank_mask:0xc
 v_mov_b32_dpp v195, v199 row_ror:8 row_mask:0xf bank_mask:0xc
 s_waitcnt lgkmcnt(2)
 v_pk_add_f32 v[84:85], v[84:85], v[124:125]
 v_pk_add_f32 v[86:87], v[86:87], v[126:127]
 s_waitcnt lgkmcnt(1)
 v_pk_add_f32 v[84:85], v[84:85], v[128:129]
 v_pk_add_f32 v[86:87], v[86:87], v[130:131]
 s_waitcnt lgkmcnt(0)
 v_pk_add_f32 v[84:85], v[84:85], v[132:133]
 v_pk_add_f32 v[86:87], v[86:87], v[134:135]
 v_cvt_pk_bf16_f32 v206, v84, v85
 v_cvt_pk_bf16_f32 v208, v86, v87
 s_cmp_eq_u32 s52, 63
 s_cbranch_scc1 L_cf_w0_done
L_cf_w0_atry:
 s_waitcnt vmcnt(6)
 v_pk_add_f32 v[230:231], v[192:193], v[108:109]
 v_pk_add_f32 v[232:233], v[194:195], v[110:111]
 s_waitcnt vmcnt(5)
 v_pk_add_f32 v[230:231], v[230:231], v[112:113]
 v_pk_add_f32 v[232:233], v[232:233], v[114:115]
 s_waitcnt vmcnt(4)
 v_pk_add_f32 v[230:231], v[230:231], v[116:117]
 v_pk_add_f32 v[232:233], v[232:233], v[118:119]
 v_maximum3_f32 v36, |v230|, |v231|, |v232|
 s_waitcnt vmcnt(0)
 v_pk_add_f32 v[234:235], v[120:121], v[122:123]
 v_add_f32 v234, v234, v235
 v_maximum3_f32 v36, v36, |v233|, |v234|
 v_cmp_ngt_f32 vcc, s66, v36
 v_exp_f32 v214, v230
 v_exp_f32 v215, v231
 v_exp_f32 v216, v232
 v_exp_f32 v217, v233
 v_exp_f32 v136, v234
 s_cbranch_vccnz L_cf_w0_abad
L_cf_w0_agood:
 buffer_store_dword v30, v25, s[4:7], s69 offen
 v_cvt_pk_bf16_f32 v210, v214, v215
 v_cvt_pk_bf16_f32 v211, v216, v217
 v_mov_b32_dpp v138, v136 row_ror:8 row_mask:0xf bank_mask:0xf
 v_mov_b32_dpp v212, v210 row_ror:8 row_mask:0xf bank_mask:0xf
 v_mov_b32_dpp v213, v211 row_ror:8 row_mask:0xf bank_mask:0xf
 v_cvt_pk_bf16_f32 v204, v136, v138
 v_pk_add_f32 v[214:215], v[214:215], v[216:217]
 v_mfma_f32_16x16x32_bf16 v[218:221], v[180:183], v[210:213], 0
 v_add_f32 v137, v214, v215
 v_add_f32 v137, v137, v136
 v_mfma_f32_16x16x32_bf16 v[222:225], v[184:187], v[210:213], 0
 s_nop 0
 v_add_f32_dpp v138, v137, v137 row_ror:8 row_mask:0xf bank_mask:0xf
 v_add_f32_dpp v139, v137, v137 row_ror:8 row_mask:0xf bank_mask:0xf
 v_mfma_f32_16x16x16_bf16 v[218:221], v[206:207], v[204:205], v[218:221]
 s_nop 0
 v_permlane16_swap_b32 v138, v139
 v_mfma_f32_16x16x16_bf16 v[222:225], v[208:209], v[204:205], v[222:225]
 v_add_f32 v137, v138, v139
 v_add_f32 v138, v138, v139
 s_nop 1
 v_permlane32_swap_b32 v137, v138
 s_nop 0
 v_add_f32 v137, v137, v138
 v_rcp_f32 v214, v137
 s_mov_b32 m0, 20480
 v_pk_mul_f32 v[218:219], v[218:219], v[214:215] op_sel_hi:[1,0]
 v_pk_mul_f32 v[220:221], v[220:221], v[214:215] op_sel_hi:[1,0]
 v_pk_mul_f32 v[222:223], v[222:223], v[214:215] op_sel_hi:[1,0]
 v_pk_mul_f32 v[224:225], v[224:225], v[214:215] op_sel_hi:[1,0]
 v_cvt_pk_bf16_f32 v226, v218, v219
 v_cvt_pk_bf16_f32 v227, v220, v221
 v_cvt_pk_bf16_f32 v228, v222, v223
 v_cvt_pk_bf16_f32 v229, v224, v225
 buffer_store_dwordx4 v[226:229], v14, s[4:7], s54 offen
 s_barrier
 buffer_load_dwordx4 v6, s[4:7], s54 offen offset:0 sc1 lds
 s_nop 3
 buffer_load_dwordx4 v6, s[4:7], s54 offen offset:1024 sc1 lds
 s_nop 3
 buffer_load_dwordx4 v6, s[4:7], s54 offen offset:2048 sc1 lds
 s_nop 3
 buffer_load_dwordx4 v6, s[4:7], s54 offen offset:3072 sc1 lds
 s_add_u32 s52, s52, 1
 s_and_b32 s61, s52, 3
 s_lshl_b32 s61, s61, 14
 s_add_u32 s53, s67, s61
 v_mov_b32 v56, 0
 v_mov_b32 v57, 0
 v_mov_b32 v58, 0
 v_mov_b32 v59, 0
 v_mov_b32 v60, 0
 v_mov_b32 v61, 0
 v_mov_b32 v62, 0
 v_mov_b32 v63, 0
 v_mov_b32 v64, 0
 v_mov_b32 v65, 0
 v_mov_b32 v66, 0
 v_mov_b32 v67, 0
 v_mov_b32 v68, 0
 v_mov_b32 v69, 0
 v_mov_b32 v70, 0
 v_mov_b32 v71, 0
 v_mov_b32 v72, 0
 v_mov_b32 v73, 0
 v_mov_b32 v74, 0
 v_mov_b32 v75, 0
 v_mov_b32 v76, 0
 v_mov_b32 v77, 0
 v_mov_b32 v78, 0
 v_mov_b32 v79, 0
 s_add_u32 s61, s58, 4194304
 s_waitcnt vmcnt(3)
 s_barrier
 s_waitcnt vmcnt(2)
 s_barrier
 buffer_store_dwordx4 v[188:191], v19, s[4:7], s58 offen sc1
 s_waitcnt vmcnt(2)
 s_barrier
 buffer_store_dword v206, v4, s[4:7], s61 offen sc1
 buffer_store_dword v208, v4, s[4:7], s61 offen offset:256 sc1
 s_load_dwordx4 s[40:43], s[4:5], s73 glc
 s_waitcnt vmcnt(3)
 s_barrier
 s_add_u32 s58, s58, 0x10000
L_cf_w0_cpoll:
 s_load_dwordx4 s[40:43], s[4:5], s73 glc
 s_min_u32 s59, s40, s41
 s_min_u32 s59, s59, s42
 s_cmp_ge_u32 s59, s52
 s_cbranch_scc1 L_cf_w0_cgo
 s_min_u32 s59, s40, s41
 s_min_u32 s59, s59, s42
 s_cmp_ge_u32 s59, s52
 s_cbranch_scc1 L_cf_w0_cgo
 s_min_u32 s59, s40, s41
 s_min_u32 s59, s59, s42
 s_cmp_ge_u32 s59, s52
 s_cbranch_scc1 L_cf_w0_cgo
 s_waitcnt lgkmcnt(8)
 s_add_u32 s62, s62, 1
 s_cmp_lt_u32 s62, 400000
 s_cbranch_scc1 L_cf_w0_cpoll
 s_branch L_done
L_cf_w0_cgo:
L_cf_w0_bjoin:
 s_barrier
 v_mov_b32 v32, 1
 ds_read_b32 v32, v37 offset:19456
L_cf_w0_fspin:
 v_cmp_eq_u32 vcc, 1, v32
 s_cbranch_vccnz L_cf_w0_fspin
 v_cmp_ne_u32 vcc, 0, v32
 s_cbranch_vccnz L_cf_w0_bretry
 s_add_u32 s60, s77, 32
 s_waitcnt vmcnt(0)
 s_atomic_umax s52, s[4:5], s60
 s_barrier
 buffer_load_dwordx4 v[92:95], v6, s[4:7], s53 offen offset:0 sc1
 s_nop 3
 buffer_load_dwordx4 v[96:99], v6, s[4:7], s53 offen offset:1024 sc1
 s_nop 3
 buffer_load_dwordx4 v[100:103], v6, s[4:7], s53 offen offset:2048 sc1
 s_nop 3
 buffer_load_dwordx4 v[104:107], v6, s[4:7], s53 offen offset:3072 sc1
 s_branch L_cf_w0_loop
L_cf_w0_dslow:
 v_max_u32 v36, v92, v93
 v_max3_u32 v36, v36, v94, v95
 v_max3_u32 v36, v36, v96, v97
 v_max3_u32 v36, v36, v98, v99
 v_max3_u32 v36, v36, v100, v101
 v_max3_u32 v36, v36, v102, v103
 v_max3_u32 v36, v36, v104, v105
 v_max3_u32 v36, v36, v106, v107
 v_cmp_eq_u32 vcc, -1, v36
 s_cbranch_vccz L_cf_w0_dgood
L_cf_w0_dagain:
 buffer_load_dwordx4 v[92:95], v6, s[4:7], s53 offen offset:0 sc1
 buffer_load_dwordx4 v[96:99], v6, s[4:7], s53 offen offset:1024 sc1
 buffer_load_dwordx4 v[100:103], v6, s[4:7], s53 offen offset:2048 sc1
 buffer_load_dwordx4 v[104:107], v6, s[4:7], s53 offen offset:3072 sc1
 v_mov_b32 v56, 0
 v_mov_b32 v57, 0
 v_mov_b32 v58, 0
 v_mov_b32 v59, 0
 v_mov_b32 v60, 0
 v_mov_b32 v61, 0
 v_mov_b32 v62, 0
 v_mov_b32 v63, 0
 v_mov_b32 v64, 0
 v_mov_b32 v65, 0
 v_mov_b32 v66, 0
 v_mov_b32 v67, 0
 v_mov_b32 v68, 0
 v_mov_b32 v69, 0
 v_mov_b32 v70, 0
 v_mov_b32 v71, 0
 s_add_u32 s62, s62, 1
 s_cmp_gt_u32 s62, 400000
 s_cbranch_scc1 L_done
 s_waitcnt vmcnt(0)
 v_max_u32 v36, v92, v93
 v_max3_u32 v36, v36, v94, v95
 v_max3_u32 v36, v36, v96, v97
 v_max3_u32 v36, v36, v98, v99
 v_max3_u32 v36, v36, v100, v101
 v_max3_u32 v36, v36, v102, v103
 v_max3_u32 v36, v36, v104, v105
 v_max3_u32 v36, v36, v106, v107
 v_cmp_eq_u32 vcc, -1, v36
 s_cbranch_vccnz L_cf_w0_dagain
 s_branch L_cf_w0_dtry
L_cf_w0_bretry:
 s_add_u32 s62, s62, 1
 s_cmp_gt_u32 s62, 400000
 s_cbranch_scc1 L_done
 s_mov_b32 m0, 20480
 s_nop 0
 buffer_load_dwordx4 v6, s[4:7], s54 offen offset:0 sc1 lds
 s_nop 3
 buffer_load_dwordx4 v6, s[4:7], s54 offen offset:1024 sc1 lds
 s_nop 3
 buffer_load_dwordx4 v6, s[4:7], s54 offen offset:2048 sc1 lds
 s_nop 3
 buffer_load_dwordx4 v6, s[4:7], s54 offen offset:3072 sc1 lds
 s_waitcnt vmcnt(3)
 s_barrier
 s_waitcnt vmcnt(2)
 s_barrier
 s_waitcnt vmcnt(1)
 s_barrier
 s_waitcnt vmcnt(0)
 s_barrier
 s_branch L_cf_w0_bjoin
L_cf_w0_abad:
 v_max3_u32 v36, v120, v121, v122
 v_max_u32 v36, v36, v123
 v_max3_u32 v36, v36, v108, v109
 v_max3_u32 v36, v36, v110, v111
 v_max3_u32 v36, v36, v112, v113
 v_max3_u32 v36, v36, v114, v115
 v_max3_u32 v36, v36, v116, v117
 v_max3_u32 v36, v36, v118, v119
 v_cmp_eq_u32 vcc, -1, v36
 buffer_load_dwordx4 v[108:111], v47, s[4:7], s55 offen sc1
 buffer_load_dwordx4 v[112:115], v48, s[4:7], s55 offen sc1
 buffer_load_dwordx4 v[116:119], v49, s[4:7], s55 offen sc1
 buffer_load_dword v120, v13, s[4:7], s55 offen offset:0 sc1
 buffer_load_dword v121, v13, s[4:7], s55 offen offset:1280 sc1
 buffer_load_dword v122, v13, s[4:7], s55 offen offset:2560 sc1
 buffer_load_dword v123, v13, s[4:7], s55 offen offset:3840 sc1
 s_add_u32 s62, s62, 1
 s_cmp_gt_u32 s62, 400000
 s_cbranch_scc1 L_done
 s_cbranch_vccnz L_cf_w0_atry
 v_max3_f32 v36, v230, v231, v232
 v_max3_f32 v36, v36, v233, v234
 s_nop 1
 v_max_f32_dpp v138, v36, v36 row_ror:8 row_mask:0xf bank_mask:0xf
 v_max_f32_dpp v139, v36, v36 row_ror:8 row_mask:0xf bank_mask:0xf
 s_nop 1
 v_permlane16_swap_b32 v138, v139
 s_nop 1
 v_max_f32 v36, v138, v139
 v_max_f32 v138, v138, v139
 s_nop 1
 v_permlane32_swap_b32 v36, v138
 s_nop 1
 v_max_f32 v36, v36, v138
 v_sub_f32 v230, v230, v36
 v_sub_f32 v231, v231, v36
 v_sub_f32 v232, v232, v36
 v_sub_f32 v233, v233, v36
 v_sub_f32 v234, v234, v36
 v_exp_f32 v214, v230
 v_exp_f32 v215, v231
 v_exp_f32 v216, v232
 v_exp_f32 v217, v233
 v_exp_f32 v136, v234
 s_branch L_cf_w0_agood
L_cf_w0_done:
 s_add_u32 s59, s58, 4194304
 buffer_store_dwordx4 v[188:191], v19, s[4:7], s58 offen sc1
 buffer_store_dword v206, v4, s[4:7], s59 offen sc1
 buffer_store_dword v208, v4, s[4:7], s59 offen offset:256 sc1
 s_waitcnt vmcnt(0)
 buffer_store_dword v30, v42, s[4:7], 0 offen sc1
 s_branch L_done
L_cf_w1:
 s_mov_b32 s79, 0
 s_mov_b32 s80, 0
L_cf_w1_kv0:
 s_min_u32 s59, s79, s80
 s_cmp_gt_u32 s59, 0
 s_cbranch_scc1 L_cf_w1_kv0_ok
 s_load_dword s79, s[4:5], s77 glc
 s_load_dword s80, s[4:5], s78 glc
 s_add_u32 s62, s62, 1
 s_cmp_gt_u32 s62, 400000
 s_cbranch_scc1 L_done
 s_waitcnt lgkmcnt(0)
 s_branch L_cf_w1_kv0
L_cf_w1_kv0_ok:
 s_mov_b32 m0, 49152
 s_add_u32 s59, s57, 16775168
 buffer_load_dwordx4 v2, s[4:7], s57 offen sc1 lds
 buffer_load_dwordx4 v2, s[4:7], s57 offen offset:1024 sc1 lds
 buffer_load_dwordx4 v2, s[4:7], s59 offen offset:2048 sc1 lds
 buffer_load_dwordx4 v2, s[4:7], s59 offen offset:3072 sc1 lds
 v_mov_b32 v56, 0
 v_mov_b32 v57, 0
 v_mov_b32 v58, 0
 v_mov_b32 v59, 0
 v_mov_b32 v60, 0
 v_mov_b32 v61, 0
 v_mov_b32 v62, 0
 v_mov_b32 v63, 0
 v_mov_b32 v64, 0
 v_mov_b32 v65, 0
 v_mov_b32 v66, 0
 v_mov_b32 v67, 0
 v_mov_b32 v68, 0
 v_mov_b32 v69, 0
 v_mov_b32 v70, 0
 v_mov_b32 v71, 0
 v_mov_b32 v72, 0
 v_mov_b32 v73, 0
 v_mov_b32 v74, 0
 v_mov_b32 v75, 0
 v_mov_b32 v76, 0
 v_mov_b32 v77, 0
 v_mov_b32 v78, 0
 v_mov_b32 v79, 0
 s_waitcnt vmcnt(0)
 s_barrier
 buffer_load_dwordx4 v[96:99], v6, s[4:7], s53 offen offset:1024 sc1
 s_nop 3
 buffer_load_dwordx4 v[92:95], v6, s[4:7], s53 offen offset:0 sc1
 s_nop 3
 buffer_load_dwordx4 v[104:107], v6, s[4:7], s53 offen offset:3072 sc1
 s_nop 3
 buffer_load_dwordx4 v[100:103], v6, s[4:7], s53 offen offset:2048 sc1
L_cf_w1_loop:
 s_and_b32 s59, s52, 3
 s_add_u32 s54, s53, 262144
 s_lshl_b32 s60, s59, 16
 s_add_u32 s55, s68, s60
 v_add_u32 v30, 1, v30
L_cf_w1_dtry:
 s_waitcnt vmcnt(3)
 v_smfmac_f32_16x16x64_bf16 v[56:59], v[96:99], a[48:55], v5
 v_smfmac_f32_16x16x64_bf16 v[60:63], v[96:99], a[56:63], v5
 v_smfmac_f32_16x16x64_bf16 v[64:67], v[96:99], a[64:71], v5
 v_smfmac_f32_16x16x64_bf16 v[68:71], v[96:99], a[72:79], v5
 s_waitcnt vmcnt(2)
 v_smfmac_f32_16x16x64_bf16 v[56:59], v[92:95], a[0:7], v5
 v_smfmac_f32_16x16x64_bf16 v[60:63], v[92:95], a[8:15], v5
 v_smfmac_f32_16x16x64_bf16 v[64:67], v[92:95], a[16:23], v5
 v_smfmac_f32_16x16x64_bf16 v[68:71], v[92:95], a[24:31], v5
 s_waitcnt vmcnt(1)
 v_smfmac_f32_16x16x64_bf16 v[56:59], v[104:107], a[144:151], v5
 v_smfmac_f32_16x16x64_bf16 v[60:63], v[104:107], a[152:159], v5
 v_smfmac_f32_16x16x64_bf16 v[64:67], v[104:107], a[160:167], v5
 v_smfmac_f32_16x16x64_bf16 v[68:71], v[104:107], a[168:175], v5
 s_waitcnt vmcnt(0)
 v_smfmac_f32_16x16x64_bf16 v[56:59], v[100:103], a[96:103], v5
 v_smfmac_f32_16x16x64_bf16 v[60:63], v[100:103], a[104:111], v5
 v_smfmac_f32_16x16x64_bf16 v[64:67], v[100:103], a[112:119], v5
 v_smfmac_f32_16x16x64_bf16 v[68:71], v[100:103], a[120:127], v5
 s_nop 4
 v_pk_add_f32 v[84:85], v[56:57], v[58:59]
 ds_write2_b32 v7, v84, v85 offset0:0 offset1:36
 v_cmp_u_f32 vcc, v84, v85
 v_pk_add_f32 v[86:87], v[60:61], v[62:63]
 ds_write2_b32 v7, v86, v87 offset0:16 offset1:52
 v_pk_add_f32 v[88:89], v[64:65], v[66:67]
 ds_write2_b32 v8, v88, v89 offset0:0 offset1:36
 v_pk_add_f32 v[90:91], v[68:69], v[70:71]
 ds_write2_b32 v8, v90, v91 offset0:16 offset1:52
 s_cbranch_vccnz L_cf_w1_dslow
L_cf_w1_dgood:
 v_smfmac_f32_16x16x64_bf16 v[72:75], v[92:95], a[32:39], v5
 v_smfmac_f32_16x16x64_bf16 v[76:79], v[92:95], a[40:47], v5
 v_smfmac_f32_16x16x64_bf16 v[72:75], v[96:99], a[80:87], v5
 v_smfmac_f32_16x16x64_bf16 v[76:79], v[96:99], a[88:95], v5
 s_waitcnt lgkmcnt(0)
 s_barrier
 v_smfmac_f32_16x16x64_bf16 v[72:75], v[100:103], a[128:135], v5
 v_smfmac_f32_16x16x64_bf16 v[76:79], v[100:103], a[136:143], v5
 v_smfmac_f32_16x16x64_bf16 v[72:75], v[104:107], a[176:183], v5
 v_smfmac_f32_16x16x64_bf16 v[76:79], v[104:107], a[184:191], v5
 buffer_store_dword v30, v27, s[4:7], s69 offen
 s_nop 7
 v_pk_add_f32 v[84:85], v[72:73], v[74:75]
 v_pk_add_f32 v[86:87], v[76:77], v[78:79]
 ds_write_b128 v10, v[84:87] offset:14336
 s_mov_b32 exec_lo, 15
 s_mov_b32 exec_hi, 0
L_cf_w1_apoll:
 v_cmp_gt_u32 vcc, v30, v39
 buffer_load_dword v39, v28, s[4:7], s69 offen sc1
 s_nop 2
 buffer_load_dword v39, v28, s[4:7], s69 offen sc1
 s_cbranch_vccz L_cf_w1_ago
 v_cmp_gt_u32 vcc, v30, v39
 buffer_load_dword v39, v28, s[4:7], s69 offen sc1
 s_nop 2
 buffer_load_dword v39, v28, s[4:7], s69 offen sc1
 s_cbranch_vccz L_cf_w1_ago
 v_cmp_gt_u32 vcc, v30, v39
 buffer_load_dword v39, v28, s[4:7], s69 offen sc1
 s_nop 2
 buffer_load_dword v39, v28, s[4:7], s69 offen sc1
 s_cbranch_vccz L_cf_w1_ago
 v_cmp_gt_u32 vcc, v30, v39
 buffer_load_dword v39, v28, s[4:7], s69 offen sc1
 s_nop 2
 buffer_load_dword v39, v28, s[4:7], s69 offen sc1
 s_cbranch_vccz L_cf_w1_ago
 v_cmp_gt_u32 vcc, v30, v39
 buffer_load_dword v39, v28, s[4:7], s69 offen sc1
 s_nop 2
 buffer_load_dword v39, v28, s[4:7], s69 offen sc1
 s_cbranch_vccz L_cf_w1_ago
 v_cmp_gt_u32 vcc, v30, v39
 buffer_load_dword v39, v28, s[4:7], s69 offen sc1
 s_nop 2
 buffer_load_dword v39, v28, s[4:7], s69 offen sc1
 s_cbranch_vccz L_cf_w1_ago
 v_cmp_gt_u32 vcc, v30, v39
 buffer_load_dword v39, v28, s[4:7], s69 offen sc1
 s_nop 2
 buffer_load_dword v39, v28, s[4:7], s69 offen sc1
 s_cbranch_vccz L_cf_w1_ago
 v_cmp_gt_u32 vcc, v30, v39
 buffer_load_dword v39, v28, s[4:7], s69 offen sc1
 s_nop 2
 buffer_load_dword v39, v28, s[4:7], s69 offen sc1
 s_cbranch_vccz L_cf_w1_ago
 v_cmp_gt_u32 vcc, v30, v39
 buffer_load_dword v39, v28, s[4:7], s69 offen sc1
 s_nop 2
 buffer_load_dword v39, v28, s[4:7], s69 offen sc1
 s_cbranch_vccz L_cf_w1_ago
 v_cmp_gt_u32 vcc, v30, v39
 buffer_load_dword v39, v28, s[4:7], s69 offen sc1
 s_nop 2
 buffer_load_dword v39, v28, s[4:7], s69 offen sc1
 s_cbranch_vccz L_cf_w1_ago
 s_waitcnt vmcnt(36)
 s_add_u32 s62, s62, 1
 s_cmp_lt_u32 s62, 400000
 s_cbranch_scc1 L_cf_w1_apoll
 s_branch L_done
L_cf_w1_ago:
 s_mov_b64 exec, -1
 s_waitcnt lgkmcnt(0)
 s_barrier
 s_cmp_eq_u32 s52, 63
 s_cbranch_scc1 L_cf_w1_done
 s_lshr_b32 s60, s52, 3
 s_lshr_b32 s60, s27, s60
 s_and_b32 s60, s60, 1
 s_lshl_b32 s60, s60, 13
 s_lshl_b32 s56, s52, 18
 s_add_u32 s56, s56, s60
 s_add_u32 s56, s56, 134217728
 s_mov_b32 m0, 24576
 s_add_u32 s61, s52, 4
 s_lshr_b32 s60, s61, 3
 s_lshr_b32 s60, s27, s60
 s_and_b32 s60, s60, 1
 s_lshl_b32 s60, s60, 13
 s_lshl_b32 s65, s61, 18
 s_add_u32 s65, s65, s60
 s_add_u32 s65, s65, 134217728
 s_cmp_gt_u32 s61, 62
 s_cselect_b32 s65, 1073741824, s65
 s_add_u32 s57, s57, 0x40000
 s_add_u32 s61, s52, 1
L_cf_w1_kv:
 s_min_u32 s59, s79, s80
 s_cmp_gt_u32 s59, s61
 s_cbranch_scc1 L_cf_w1_kv_ok
 s_load_dword s79, s[4:5], s77 glc
 s_load_dword s80, s[4:5], s78 glc
 s_add_u32 s62, s62, 1
 s_cmp_gt_u32 s62, 400000
 s_cbranch_scc1 L_done
 s_waitcnt lgkmcnt(0)
 s_branch L_cf_w1_kv
L_cf_w1_kv_ok:
 s_add_u32 s60, s52, 3
 s_min_u32 s60, s60, 63
 s_cmp_gt_u32 s59, s60
 s_cbranch_scc1 L_cf_w1_kvfresh
 s_load_dword s79, s[4:5], s77 glc
 s_load_dword s80, s[4:5], s78 glc
L_cf_w1_kvfresh:
 s_mov_b32 exec_lo, s71
 s_mov_b32 exec_hi, 0
L_cf_w1_bpoll:
 v_cmp_gt_u32 vcc, v30, v40
 buffer_load_dword v40, v26, s[4:7], s69 offen sc1
 s_nop 2
 buffer_load_dword v40, v26, s[4:7], s69 offen sc1
 s_cbranch_vccz L_cf_w1_bgo
 v_cmp_gt_u32 vcc, v30, v40
 buffer_load_dword v40, v26, s[4:7], s69 offen sc1
 s_nop 2
 buffer_load_dword v40, v26, s[4:7], s69 offen sc1
 s_cbranch_vccz L_cf_w1_bgo
 v_cmp_gt_u32 vcc, v30, v40
 buffer_load_dword v40, v26, s[4:7], s69 offen sc1
 s_nop 2
 buffer_load_dword v40, v26, s[4:7], s69 offen sc1
 s_cbranch_vccz L_cf_w1_bgo
 v_cmp_gt_u32 vcc, v30, v40
 buffer_load_dword v40, v26, s[4:7], s69 offen sc1
 s_nop 2
 buffer_load_dword v40, v26, s[4:7], s69 offen sc1
 s_cbranch_vccz L_cf_w1_bgo
 v_cmp_gt_u32 vcc, v30, v40
 buffer_load_dword v40, v26, s[4:7], s69 offen sc1
 s_nop 2
 buffer_load_dword v40, v26, s[4:7], s69 offen sc1
 s_cbranch_vccz L_cf_w1_bgo
 v_cmp_gt_u32 vcc, v30, v40
 buffer_load_dword v40, v26, s[4:7], s69 offen sc1
 s_nop 2
 buffer_load_dword v40, v26, s[4:7], s69 offen sc1
 s_cbranch_vccz L_cf_w1_bgo
 v_cmp_gt_u32 vcc, v30, v40
 buffer_load_dword v40, v26, s[4:7], s69 offen sc1
 s_nop 2
 buffer_load_dword v40, v26, s[4:7], s69 offen sc1
 s_cbranch_vccz L_cf_w1_bgo
 v_cmp_gt_u32 vcc, v30, v40
 buffer_load_dword v40, v26, s[4:7], s69 offen sc1
 s_nop 2
 buffer_load_dword v40, v26, s[4:7], s69 offen sc1
 s_cbranch_vccz L_cf_w1_bgo
 v_cmp_gt_u32 vcc, v30, v40
 buffer_load_dword v40, v26, s[4:7], s69 offen sc1
 s_nop 2
 buffer_load_dword v40, v26, s[4:7], s69 offen sc1
 s_cbranch_vccz L_cf_w1_bgo
 v_cmp_gt_u32 vcc, v30, v40
 buffer_load_dword v40, v26, s[4:7], s69 offen sc1
 s_nop 2
 buffer_load_dword v40, v26, s[4:7], s69 offen sc1
 s_cbranch_vccz L_cf_w1_bgo
 s_waitcnt vmcnt(36)
 s_add_u32 s62, s62, 1
 s_cmp_lt_u32 s62, 400000
 s_cbranch_scc1 L_cf_w1_bpoll
 s_branch L_done
L_cf_w1_bgo:
 s_mov_b64 exec, -1
 s_barrier
 buffer_load_dwordx4 v6, s[4:7], s54 offen offset:1024 sc1 lds
 s_nop 3
 buffer_load_dwordx4 v6, s[4:7], s54 offen offset:0 sc1 lds
 s_nop 3
 buffer_load_dwordx4 v6, s[4:7], s54 offen offset:3072 sc1 lds
 s_nop 3
 buffer_load_dwordx4 v6, s[4:7], s54 offen offset:2048 sc1 lds
 s_add_u32 s52, s52, 1
 s_and_b32 s61, s52, 3
 s_lshl_b32 s61, s61, 14
 s_add_u32 s53, s67, s61
 v_mov_b32 v56, 0
 v_mov_b32 v57, 0
 v_mov_b32 v58, 0
 v_mov_b32 v59, 0
 v_mov_b32 v60, 0
 v_mov_b32 v61, 0
 v_mov_b32 v62, 0
 v_mov_b32 v63, 0
 v_mov_b32 v64, 0
 v_mov_b32 v65, 0
 v_mov_b32 v66, 0
 v_mov_b32 v67, 0
 v_mov_b32 v68, 0
 v_mov_b32 v69, 0
 v_mov_b32 v70, 0
 v_mov_b32 v71, 0
 v_mov_b32 v72, 0
 v_mov_b32 v73, 0
 v_mov_b32 v74, 0
 v_mov_b32 v75, 0
 v_mov_b32 v76, 0
 v_mov_b32 v77, 0
 v_mov_b32 v78, 0
 v_mov_b32 v79, 0
 s_waitcnt vmcnt(3)
 s_barrier
 s_nop 5
 s_atomic_umax s52, s[4:5], s74
 s_atomic_umax s52, s[4:5], s75
 s_atomic_umax s52, s[4:5], s76
 s_waitcnt vmcnt(2)
 s_barrier
 s_nop 1
 s_mov_b32 m0, 49152
 s_add_u32 s59, s57, 16775168
 buffer_load_dwordx4 v2, s[4:7], s57 offen sc1 lds
 buffer_load_dwordx4 v2, s[4:7], s57 offen offset:1024 sc1 lds
 buffer_load_dwordx4 v2, s[4:7], s59 offen offset:2048 sc1 lds
 buffer_load_dwordx4 v2, s[4:7], s59 offen offset:3072 sc1 lds
 s_waitcnt vmcnt(5)
 s_barrier
 buffer_store_dwordx4 v[50:53], v24, s[4:7], s65 offen sc1
 s_waitcnt vmcnt(5)
 s_barrier
L_cf_w1_bjoin:
 s_barrier
 buffer_load_dwordx4 v[108:111], v44, s[4:7], s56 offen sc1
 buffer_load_dwordx4 v[112:115], v45, s[4:7], s56 offen sc1
 buffer_load_dwordx4 v[116:119], v46, s[4:7], s56 offen sc1
 ds_read_b32 v32, v37 offset:19456
 ds_read_b128 v[120:123], v2 offset:18432
 s_waitcnt lgkmcnt(0)
 v_cmp_ne_u32 vcc, 0, v32
 s_cbranch_vccnz L_cf_w1_bretry
 s_waitcnt vmcnt(2)
 buffer_store_dword v30, v25, s[4:7], s70 offen
 v_pk_add_f32 v[124:125], v[120:121], v[108:109]
 v_pk_add_f32 v[126:127], v[122:123], v[110:111]
 s_waitcnt vmcnt(2)
 v_pk_add_f32 v[124:125], v[124:125], v[112:113]
 v_pk_add_f32 v[126:127], v[126:127], v[114:115]
 s_waitcnt vmcnt(1)
 v_pk_add_f32 v[124:125], v[124:125], v[116:117]
 v_pk_add_f32 v[126:127], v[126:127], v[118:119]
 v_cmpx_o_f32 vcc, v124, v125
 v_cmpx_o_f32 vcc, v126, v127
 v_cvt_pk_bf16_f32 v128, v124, v125
 v_cvt_pk_bf16_f32 v129, v126, v127
 buffer_store_dwordx2 v[128:129], v16, s[4:7], s53 offen
 s_cmp_eq_u64 exec, -1
 s_cbranch_scc0 L_cf_w1_cslow
L_cf_w1_cgood:
 s_barrier
 buffer_load_dwordx4 v[96:99], v6, s[4:7], s53 offen offset:1024 sc1
 s_nop 3
 buffer_load_dwordx4 v[92:95], v6, s[4:7], s53 offen offset:0 sc1
 s_nop 3
 buffer_load_dwordx4 v[104:107], v6, s[4:7], s53 offen offset:3072 sc1
 s_nop 3
 buffer_load_dwordx4 v[100:103], v6, s[4:7], s53 offen offset:2048 sc1
 s_branch L_cf_w1_loop
L_cf_w1_dslow:
 v_max_u32 v36, v92, v93
 v_max3_u32 v36, v36, v94, v95
 v_max3_u32 v36, v36, v96, v97
 v_max3_u32 v36, v36, v98, v99
 v_max3_u32 v36, v36, v100, v101
 v_max3_u32 v36, v36, v102, v103
 v_max3_u32 v36, v36, v104, v105
 v_max3_u32 v36, v36, v106, v107
 v_cmp_eq_u32 vcc, -1, v36
 s_cbranch_vccz L_cf_w1_dgood
L_cf_w1_dagain:
 buffer_load_dwordx4 v[96:99], v6, s[4:7], s53 offen offset:1024 sc1
 buffer_load_dwordx4 v[92:95], v6, s[4:7], s53 offen offset:0 sc1
 buffer_load_dwordx4 v[104:107], v6, s[4:7], s53 offen offset:3072 sc1
 buffer_load_dwordx4 v[100:103], v6, s[4:7], s53 offen offset:2048 sc1
 v_mov_b32 v56, 0
 v_mov_b32 v57, 0
 v_mov_b32 v58, 0
 v_mov_b32 v59, 0
 v_mov_b32 v60, 0
 v_mov_b32 v61, 0
 v_mov_b32 v62, 0
 v_mov_b32 v63, 0
 v_mov_b32 v64, 0
 v_mov_b32 v65, 0
 v_mov_b32 v66, 0
 v_mov_b32 v67, 0
 v_mov_b32 v68, 0
 v_mov_b32 v69, 0
 v_mov_b32 v70, 0
 v_mov_b32 v71, 0
 s_add_u32 s62, s62, 1
 s_cmp_gt_u32 s62, 400000
 s_cbranch_scc1 L_done
 s_waitcnt vmcnt(0)
 v_max_u32 v36, v92, v93
 v_max3_u32 v36, v36, v94, v95
 v_max3_u32 v36, v36, v96, v97
 v_max3_u32 v36, v36, v98, v99
 v_max3_u32 v36, v36, v100, v101
 v_max3_u32 v36, v36, v102, v103
 v_max3_u32 v36, v36, v104, v105
 v_max3_u32 v36, v36, v106, v107
 v_cmp_eq_u32 vcc, -1, v36
 s_cbranch_vccnz L_cf_w1_dagain
 s_branch L_cf_w1_dtry
L_cf_w1_bretry:
 s_add_u32 s62, s62, 1
 s_cmp_gt_u32 s62, 400000
 s_cbranch_scc1 L_done
 s_mov_b32 m0, 24576
 s_nop 0
 buffer_load_dwordx4 v6, s[4:7], s54 offen offset:1024 sc1 lds
 s_nop 3
 buffer_load_dwordx4 v6, s[4:7], s54 offen offset:0 sc1 lds
 s_nop 3
 buffer_load_dwordx4 v6, s[4:7], s54 offen offset:3072 sc1 lds
 s_nop 3
 buffer_load_dwordx4 v6, s[4:7], s54 offen offset:2048 sc1 lds
 s_waitcnt vmcnt(3)
 s_barrier
 s_waitcnt vmcnt(2)
 s_barrier
 s_waitcnt vmcnt(1)
 s_barrier
 s_waitcnt vmcnt(0)
 s_barrier
 s_branch L_cf_w1_bjoin
L_cf_w1_cslow:
 s_mov_b64 exec, -1
 v_max_u32 v36, v108, v109
 v_max3_u32 v36, v36, v110, v111
 v_max3_u32 v36, v36, v112, v113
 v_max3_u32 v36, v36, v114, v115
 v_max3_u32 v36, v36, v116, v117
 v_max3_u32 v36, v36, v118, v119
 v_cmp_eq_u32 vcc, -1, v36
 s_cbranch_vccz L_cf_w1_cfull
 buffer_load_dwordx4 v[108:111], v44, s[4:7], s56 offen sc1
 buffer_load_dwordx4 v[112:115], v45, s[4:7], s56 offen sc1
 buffer_load_dwordx4 v[116:119], v46, s[4:7], s56 offen sc1
 s_add_u32 s62, s62, 1
 s_cmp_gt_u32 s62, 400000
 s_cbranch_scc1 L_done
 s_waitcnt vmcnt(2)
 v_pk_add_f32 v[124:125], v[120:121], v[108:109]
 v_pk_add_f32 v[126:127], v[122:123], v[110:111]
 s_waitcnt vmcnt(1)
 v_pk_add_f32 v[124:125], v[124:125], v[112:113]
 v_pk_add_f32 v[126:127], v[126:127], v[114:115]
 s_waitcnt vmcnt(0)
 v_pk_add_f32 v[124:125], v[124:125], v[116:117]
 v_pk_add_f32 v[126:127], v[126:127], v[118:119]
 s_branch L_cf_w1_cslow
L_cf_w1_cfull:
 v_cvt_pk_bf16_f32 v128, v124, v125
 v_cvt_pk_bf16_f32 v129, v126, v127
 buffer_store_dwordx2 v[128:129], v16, s[4:7], s53 offen
 s_branch L_cf_w1_cgood
L_cf_w1_done:
 s_branch L_done
L_cf_w2:
 v_mov_b32 v56, 0
 v_mov_b32 v57, 0
 v_mov_b32 v58, 0
 v_mov_b32 v59, 0
 v_mov_b32 v60, 0
 v_mov_b32 v61, 0
 v_mov_b32 v62, 0
 v_mov_b32 v63, 0
 v_mov_b32 v64, 0
 v_mov_b32 v65, 0
 v_mov_b32 v66, 0
 v_mov_b32 v67, 0
 v_mov_b32 v68, 0
 v_mov_b32 v69, 0
 v_mov_b32 v70, 0
 v_mov_b32 v71, 0
 v_mov_b32 v72, 0
 v_mov_b32 v73, 0
 v_mov_b32 v74, 0
 v_mov_b32 v75, 0
 v_mov_b32 v76, 0
 v_mov_b32 v77, 0
 v_mov_b32 v78, 0
 v_mov_b32 v79, 0
 s_waitcnt vmcnt(0)
 s_barrier
 buffer_load_dwordx4 v[100:103], v6, s[4:7], s53 offen offset:2048 sc1
 s_nop 3
 buffer_load_dwordx4 v[104:107], v6, s[4:7], s53 offen offset:3072 sc1
 s_nop 3
 buffer_load_dwordx4 v[92:95], v6, s[4:7], s53 offen offset:0 sc1
 s_nop 3
 buffer_load_dwordx4 v[96:99], v6, s[4:7], s53 offen offset:1024 sc1
L_cf_w2_loop:
 s_and_b32 s59, s52, 3
 s_add_u32 s54, s53, 262144
 s_lshl_b32 s60, s59, 16
 s_add_u32 s55, s68, s60
 v_add_u32 v30, 1, v30
L_cf_w2_dtry:
 s_waitcnt vmcnt(3)
 v_smfmac_f32_16x16x64_bf16 v[56:59], v[100:103], a[96:103], v5
 v_smfmac_f32_16x16x64_bf16 v[60:63], v[100:103], a[104:111], v5
 v_smfmac_f32_16x16x64_bf16 v[64:67], v[100:103], a[112:119], v5
 v_smfmac_f32_16x16x64_bf16 v[68:71], v[100:103], a[120:127], v5
 s_waitcnt vmcnt(2)
 v_smfmac_f32_16x16x64_bf16 v[56:59], v[104:107], a[144:151], v5
 v_smfmac_f32_16x16x64_bf16 v[60:63], v[104:107], a[152:159], v5
 v_smfmac_f32_16x16x64_bf16 v[64:67], v[104:107], a[160:167], v5
 v_smfmac_f32_16x16x64_bf16 v[68:71], v[104:107], a[168:175], v5
 s_waitcnt vmcnt(1)
 v_smfmac_f32_16x16x64_bf16 v[56:59], v[92:95], a[0:7], v5
 v_smfmac_f32_16x16x64_bf16 v[60:63], v[92:95], a[8:15], v5
 v_smfmac_f32_16x16x64_bf16 v[64:67], v[92:95], a[16:23], v5
 v_smfmac_f32_16x16x64_bf16 v[68:71], v[92:95], a[24:31], v5
 s_waitcnt vmcnt(0)
 v_smfmac_f32_16x16x64_bf16 v[56:59], v[96:99], a[48:55], v5
 v_smfmac_f32_16x16x64_bf16 v[60:63], v[96:99], a[56:63], v5
 v_smfmac_f32_16x16x64_bf16 v[64:67], v[96:99], a[64:71], v5
 v_smfmac_f32_16x16x64_bf16 v[68:71], v[96:99], a[72:79], v5
 s_nop 4
 v_pk_add_f32 v[84:85], v[56:57], v[58:59]
 ds_write2_b32 v7, v84, v85 offset0:0 offset1:36
 v_cmp_u_f32 vcc, v84, v85
 v_pk_add_f32 v[86:87], v[60:61], v[62:63]
 ds_write2_b32 v7, v86, v87 offset0:16 offset1:52
 v_pk_add_f32 v[88:89], v[64:65], v[66:67]
 ds_write2_b32 v8, v88, v89 offset0:0 offset1:36
 v_pk_add_f32 v[90:91], v[68:69], v[70:71]
 ds_write2_b32 v8, v90, v91 offset0:16 offset1:52
 s_cbranch_vccnz L_cf_w2_dslow
L_cf_w2_dgood:
 v_smfmac_f32_16x16x64_bf16 v[72:75], v[92:95], a[32:39], v5
 v_smfmac_f32_16x16x64_bf16 v[76:79], v[92:95], a[40:47], v5
 v_smfmac_f32_16x16x64_bf16 v[72:75], v[96:99], a[80:87], v5
 v_smfmac_f32_16x16x64_bf16 v[76:79], v[96:99], a[88:95], v5
 s_waitcnt lgkmcnt(0)
 s_barrier
 v_smfmac_f32_16x16x64_bf16 v[72:75], v[100:103], a[128:135], v5
 v_smfmac_f32_16x16x64_bf16 v[76:79], v[100:103], a[136:143], v5
 v_smfmac_f32_16x16x64_bf16 v[72:75], v[104:107], a[176:183], v5
 v_smfmac_f32_16x16x64_bf16 v[76:79], v[104:107], a[184:191], v5
 s_nop 7
 v_pk_add_f32 v[84:85], v[72:73], v[74:75]
 v_pk_add_f32 v[86:87], v[76:77], v[78:79]
 ds_write_b128 v10, v[84:87] offset:14336
 s_waitcnt lgkmcnt(0)
 s_barrier
 s_cmp_eq_u32 s52, 63
 s_cbranch_scc1 L_cf_w2_done
 s_lshr_b32 s60, s52, 3
 s_lshr_b32 s60, s27, s60
 s_and_b32 s60, s60, 1
 s_lshl_b32 s60, s60, 13
 s_lshl_b32 s56, s52, 18
 s_add_u32 s56, s56, s60
 s_add_u32 s56, s56, 134217728
 s_mov_b32 m0, 28672
 v_mov_b32 v80, 0
 v_mov_b32 v81, 0
 v_mov_b32 v82, 0
 v_mov_b32 v83, 0
 s_barrier
 buffer_load_dwordx4 v6, s[4:7], s54 offen offset:2048 sc1 lds
 s_nop 3
 buffer_load_dwordx4 v6, s[4:7], s54 offen offset:3072 sc1 lds
 s_nop 3
 buffer_load_dwordx4 v6, s[4:7], s54 offen offset:0 sc1 lds
 s_nop 3
 buffer_load_dwordx4 v6, s[4:7], s54 offen offset:1024 sc1 lds
 s_add_u32 s52, s52, 1
 s_and_b32 s61, s52, 3
 s_lshl_b32 s61, s61, 14
 s_add_u32 s53, s67, s61
 v_mov_b32 v56, 0
 v_mov_b32 v57, 0
 v_mov_b32 v58, 0
 v_mov_b32 v59, 0
 v_mov_b32 v60, 0
 v_mov_b32 v61, 0
 v_mov_b32 v62, 0
 v_mov_b32 v63, 0
 v_mov_b32 v64, 0
 v_mov_b32 v65, 0
 v_mov_b32 v66, 0
 v_mov_b32 v67, 0
 v_mov_b32 v68, 0
 v_mov_b32 v69, 0
 v_mov_b32 v70, 0
 v_mov_b32 v71, 0
 v_mov_b32 v72, 0
 v_mov_b32 v73, 0
 v_mov_b32 v74, 0
 v_mov_b32 v75, 0
 v_mov_b32 v76, 0
 v_mov_b32 v77, 0
 v_mov_b32 v78, 0
 v_mov_b32 v79, 0
L_cf_w2_bwait:
 s_waitcnt vmcnt(3)
 s_barrier
 ds_read_b128 v[108:111], v20 offset:20480
 ds_read_b128 v[128:131], v20 offset:25600
 ds_read_b128 v[148:151], v20 offset:30720
 ds_read_b128 v[168:171], v20 offset:35840
 s_waitcnt lgkmcnt(3)
 v_smfmac_f32_16x16x64_bf16 v[80:83], v[108:111], a[192:199], v5
 s_waitcnt vmcnt(2)
 s_barrier
 ds_read_b128 v[112:115], v20 offset:21504
 ds_read_b128 v[124:127], v20 offset:24576
 ds_read_b128 v[152:155], v20 offset:31744
 ds_read_b128 v[164:167], v20 offset:34816
 s_waitcnt lgkmcnt(6)
 v_smfmac_f32_16x16x64_bf16 v[80:83], v[128:131], a[216:223], v5
 s_waitcnt lgkmcnt(5)
 v_smfmac_f32_16x16x64_bf16 v[80:83], v[148:151], v[204:211], v5
 s_waitcnt lgkmcnt(4)
 v_smfmac_f32_16x16x64_bf16 v[80:83], v[168:171], v[228:235], v5
 s_waitcnt lgkmcnt(3)
 v_smfmac_f32_16x16x64_bf16 v[80:83], v[112:115], a[200:207], v5
 s_waitcnt vmcnt(1)
 s_barrier
 ds_read_b128 v[116:119], v20 offset:22528
 ds_read_b128 v[136:139], v20 offset:27648
 ds_read_b128 v[140:143], v20 offset:28672
 ds_read_b128 v[160:163], v20 offset:33792
 s_waitcnt lgkmcnt(6)
 v_smfmac_f32_16x16x64_bf16 v[80:83], v[124:127], a[208:215], v5
 s_waitcnt lgkmcnt(5)
 v_smfmac_f32_16x16x64_bf16 v[80:83], v[152:155], v[212:219], v5
 s_waitcnt lgkmcnt(4)
 v_smfmac_f32_16x16x64_bf16 v[80:83], v[164:167], v[220:227], v5
 s_waitcnt lgkmcnt(3)
 v_smfmac_f32_16x16x64_bf16 v[80:83], v[116:119], v[172:179], v5
 s_waitcnt vmcnt(0)
 s_barrier
 ds_read_b128 v[120:123], v20 offset:23552
 ds_read_b128 v[132:135], v20 offset:26624
 ds_read_b128 v[144:147], v20 offset:29696
 ds_read_b128 v[156:159], v20 offset:32768
 s_waitcnt lgkmcnt(6)
 v_smfmac_f32_16x16x64_bf16 v[80:83], v[136:139], v[196:203], v5
 s_waitcnt lgkmcnt(5)
 v_smfmac_f32_16x16x64_bf16 v[80:83], v[140:143], a[224:231], v5
 s_waitcnt lgkmcnt(4)
 v_smfmac_f32_16x16x64_bf16 v[80:83], v[160:163], a[248:255], v5
 s_waitcnt lgkmcnt(3)
 v_smfmac_f32_16x16x64_bf16 v[80:83], v[120:123], v[180:187], v5
 s_waitcnt lgkmcnt(2)
 v_smfmac_f32_16x16x64_bf16 v[80:83], v[132:135], v[188:195], v5
 s_waitcnt lgkmcnt(1)
 v_smfmac_f32_16x16x64_bf16 v[80:83], v[144:147], a[232:239], v5
 s_waitcnt lgkmcnt(0)
 v_smfmac_f32_16x16x64_bf16 v[80:83], v[156:159], a[240:247], v5
 s_nop 7
 v_pk_add_f32 v[84:85], v[80:81], v[82:83]
 v_cmpx_o_f32 vcc, v84, v85
 buffer_store_dword v84, v15, s[4:7], s56 offen sc1
 buffer_store_dword v85, v15, s[4:7], s56 offen offset:256 sc1
 s_cmp_eq_u64 exec, -1
 s_cbranch_scc0 L_cf_w2_bslow
L_cf_w2_bgood:
 ds_write2st64_b32 v4, v84, v85 offset0:72 offset1:73
 ds_write_b32 v37, v37 offset:19456
 s_nop 15
 s_nop 15
 s_nop 15
 s_nop 15
 s_nop 5
 s_waitcnt lgkmcnt(0)
 s_barrier
 s_nop 15
 s_nop 15
 s_nop 15
 s_nop 11
 s_mov_b32 exec_lo, s71
 s_mov_b32 exec_hi, 0
L_cf_w2_spoll:
 v_cmp_gt_u32 vcc, v30, v41
 buffer_load_dword v41, v26, s[4:7], s70 offen sc1
 s_nop 2
 buffer_load_dword v41, v26, s[4:7], s70 offen sc1
 s_cbranch_vccz L_cf_w2_sgo
 v_cmp_gt_u32 vcc, v30, v41
 buffer_load_dword v41, v26, s[4:7], s70 offen sc1
 s_nop 2
 buffer_load_dword v41, v26, s[4:7], s70 offen sc1
 s_cbranch_vccz L_cf_w2_sgo
 v_cmp_gt_u32 vcc, v30, v41
 buffer_load_dword v41, v26, s[4:7], s70 offen sc1
 s_nop 2
 buffer_load_dword v41, v26, s[4:7], s70 offen sc1
 s_cbranch_vccz L_cf_w2_sgo
 v_cmp_gt_u32 vcc, v30, v41
 buffer_load_dword v41, v26, s[4:7], s70 offen sc1
 s_nop 2
 buffer_load_dword v41, v26, s[4:7], s70 offen sc1
 s_cbranch_vccz L_cf_w2_sgo
 v_cmp_gt_u32 vcc, v30, v41
 buffer_load_dword v41, v26, s[4:7], s70 offen sc1
 s_nop 2
 buffer_load_dword v41, v26, s[4:7], s70 offen sc1
 s_cbranch_vccz L_cf_w2_sgo
 v_cmp_gt_u32 vcc, v30, v41
 buffer_load_dword v41, v26, s[4:7], s70 offen sc1
 s_nop 2
 buffer_load_dword v41, v26, s[4:7], s70 offen sc1
 s_cbranch_vccz L_cf_w2_sgo
 v_cmp_gt_u32 vcc, v30, v41
 buffer_load_dword v41, v26, s[4:7], s70 offen sc1
 s_nop 2
 buffer_load_dword v41, v26, s[4:7], s70 offen sc1
 s_cbranch_vccz L_cf_w2_sgo
 v_cmp_gt_u32 vcc, v30, v41
 buffer_load_dword v41, v26, s[4:7], s70 offen sc1
 s_nop 2
 buffer_load_dword v41, v26, s[4:7], s70 offen sc1
 s_cbranch_vccz L_cf_w2_sgo
 v_cmp_gt_u32 vcc, v30, v41
 buffer_load_dword v41, v26, s[4:7], s70 offen sc1
 s_nop 2
 buffer_load_dword v41, v26, s[4:7], s70 offen sc1
 s_cbranch_vccz L_cf_w2_sgo
 v_cmp_gt_u32 vcc, v30, v41
 buffer_load_dword v41, v26, s[4:7], s70 offen sc1
 s_nop 2
 buffer_load_dword v41, v26, s[4:7], s70 offen sc1
 s_cbranch_vccz L_cf_w2_sgo
 s_waitcnt vmcnt(36)
 s_add_u32 s62, s62, 1
 s_cmp_lt_u32 s62, 400000
 s_cbranch_scc1 L_cf_w2_spoll
 s_branch L_done
L_cf_w2_sgo:
 s_mov_b64 exec, -1
 s_barrier
 buffer_load_dwordx4 v[100:103], v6, s[4:7], s53 offen offset:2048 sc1
 s_nop 3
 buffer_load_dwordx4 v[104:107], v6, s[4:7], s53 offen offset:3072 sc1
 s_nop 3
 buffer_load_dwordx4 v[92:95], v6, s[4:7], s53 offen offset:0 sc1
 s_nop 3
 buffer_load_dwordx4 v[96:99], v6, s[4:7], s53 offen offset:1024 sc1
 s_branch L_cf_w2_loop
L_cf_w2_dslow:
 v_max_u32 v36, v92, v93
 v_max3_u32 v36, v36, v94, v95
 v_max3_u32 v36, v36, v96, v97
 v_max3_u32 v36, v36, v98, v99
 v_max3_u32 v36, v36, v100, v101
 v_max3_u32 v36, v36, v102, v103
 v_max3_u32 v36, v36, v104, v105
 v_max3_u32 v36, v36, v106, v107
 v_cmp_eq_u32 vcc, -1, v36
 s_cbranch_vccz L_cf_w2_dgood
L_cf_w2_dagain:
 buffer_load_dwordx4 v[100:103], v6, s[4:7], s53 offen offset:2048 sc1
 buffer_load_dwordx4 v[104:107], v6, s[4:7], s53 offen offset:3072 sc1
 buffer_load_dwordx4 v[92:95], v6, s[4:7], s53 offen offset:0 sc1
 buffer_load_dwordx4 v[96:99], v6, s[4:7], s53 offen offset:1024 sc1
 v_mov_b32 v56, 0
 v_mov_b32 v57, 0
 v_mov_b32 v58, 0
 v_mov_b32 v59, 0
 v_mov_b32 v60, 0
 v_mov_b32 v61, 0
 v_mov_b32 v62, 0
 v_mov_b32 v63, 0
 v_mov_b32 v64, 0
 v_mov_b32 v65, 0
 v_mov_b32 v66, 0
 v_mov_b32 v67, 0
 v_mov_b32 v68, 0
 v_mov_b32 v69, 0
 v_mov_b32 v70, 0
 v_mov_b32 v71, 0
 s_add_u32 s62, s62, 1
 s_cmp_gt_u32 s62, 400000
 s_cbranch_scc1 L_done
 s_waitcnt vmcnt(0)
 v_max_u32 v36, v92, v93
 v_max3_u32 v36, v36, v94, v95
 v_max3_u32 v36, v36, v96, v97
 v_max3_u32 v36, v36, v98, v99
 v_max3_u32 v36, v36, v100, v101
 v_max3_u32 v36, v36, v102, v103
 v_max3_u32 v36, v36, v104, v105
 v_max3_u32 v36, v36, v106, v107
 v_cmp_eq_u32 vcc, -1, v36
 s_cbranch_vccnz L_cf_w2_dagain
 s_branch L_cf_w2_dtry
L_cf_w2_bslow:
 s_mov_b64 exec, -1
 v_max_u32 v36, v108, v109
 v_max3_u32 v36, v36, v110, v111
 v_max3_u32 v36, v36, v112, v113
 v_max3_u32 v36, v36, v114, v115
 v_max3_u32 v36, v36, v116, v117
 v_max3_u32 v36, v36, v118, v119
 v_max3_u32 v36, v36, v120, v121
 v_max3_u32 v36, v36, v122, v123
 v_max3_u32 v36, v36, v124, v125
 v_max3_u32 v36, v36, v126, v127
 v_max3_u32 v36, v36, v128, v129
 v_max3_u32 v36, v36, v130, v131
 v_max3_u32 v36, v36, v132, v133
 v_max3_u32 v36, v36, v134, v135
 v_max3_u32 v36, v36, v136, v137
 v_max3_u32 v36, v36, v138, v139
 v_max3_u32 v36, v36, v140, v141
 v_max3_u32 v36, v36, v142, v143
 v_max3_u32 v36, v36, v144, v145
 v_max3_u32 v36, v36, v146, v147
 v_max3_u32 v36, v36, v148, v149
 v_max3_u32 v36, v36, v150, v151
 v_max3_u32 v36, v36, v152, v153
 v_max3_u32 v36, v36, v154, v155
 v_max3_u32 v36, v36, v156, v157
 v_max3_u32 v36, v36, v158, v159
 v_max3_u32 v36, v36, v160, v161
 v_max3_u32 v36, v36, v162, v163
 v_max3_u32 v36, v36, v164, v165
 v_max3_u32 v36, v36, v166, v167
 v_max3_u32 v36, v36, v168, v169
 v_max3_u32 v36, v36, v170, v171
 v_cmp_eq_u32 vcc, -1, v36
 s_cbranch_vccnz L_cf_w2_bagain
 buffer_store_dword v84, v15, s[4:7], s56 offen sc1
 buffer_store_dword v85, v15, s[4:7], s56 offen offset:256 sc1
 s_branch L_cf_w2_bgood
L_cf_w2_bagain:
 ds_write_b32 v37, v50 offset:19456
 v_mov_b32 v80, 0
 v_mov_b32 v81, 0
 v_mov_b32 v82, 0
 v_mov_b32 v83, 0
 s_add_u32 s62, s62, 1
 s_cmp_gt_u32 s62, 400000
 s_cbranch_scc1 L_done
 s_waitcnt lgkmcnt(0)
 s_barrier
 buffer_load_dwordx4 v6, s[4:7], s54 offen offset:2048 sc1 lds
 s_nop 3
 buffer_load_dwordx4 v6, s[4:7], s54 offen offset:3072 sc1 lds
 s_nop 3
 buffer_load_dwordx4 v6, s[4:7], s54 offen offset:0 sc1 lds
 s_nop 3
 buffer_load_dwordx4 v6, s[4:7], s54 offen offset:1024 sc1 lds
 s_branch L_cf_w2_bwait
L_cf_w2_done:
 s_branch L_done
L_cf_w3:
 v_mov_b32 v56, 0
 v_mov_b32 v57, 0
 v_mov_b32 v58, 0
 v_mov_b32 v59, 0
 v_mov_b32 v60, 0
 v_mov_b32 v61, 0
 v_mov_b32 v62, 0
 v_mov_b32 v63, 0
 v_mov_b32 v64, 0
 v_mov_b32 v65, 0
 v_mov_b32 v66, 0
 v_mov_b32 v67, 0
 v_mov_b32 v68, 0
 v_mov_b32 v69, 0
 v_mov_b32 v70, 0
 v_mov_b32 v71, 0
 v_mov_b32 v72, 0
 v_mov_b32 v73, 0
 v_mov_b32 v74, 0
 v_mov_b32 v75, 0
 v_mov_b32 v76, 0
 v_mov_b32 v77, 0
 v_mov_b32 v78, 0
 v_mov_b32 v79, 0
 s_waitcnt vmcnt(0)
 s_barrier
 buffer_load_dwordx4 v[104:107], v6, s[4:7], s53 offen offset:3072 sc1
 s_nop 3
 buffer_load_dwordx4 v[100:103], v6, s[4:7], s53 offen offset:2048 sc1
 s_nop 3
 buffer_load_dwordx4 v[96:99], v6, s[4:7], s53 offen offset:1024 sc1
 s_nop 3
 buffer_load_dwordx4 v[92:95], v6, s[4:7], s53 offen offset:0 sc1
L_cf_w3_loop:
 s_and_b32 s59, s52, 3
 s_add_u32 s54, s53, 262144
 s_lshl_b32 s60, s59, 16
 s_add_u32 s55, s68, s60
 v_add_u32 v30, 1, v30
L_cf_w3_dtry:
 s_waitcnt vmcnt(3)
 v_smfmac_f32_16x16x64_bf16 v[56:59], v[104:107], a[144:151], v5
 v_smfmac_f32_16x16x64_bf16 v[60:63], v[104:107], a[152:159], v5
 v_smfmac_f32_16x16x64_bf16 v[64:67], v[104:107], a[160:167], v5
 v_smfmac_f32_16x16x64_bf16 v[68:71], v[104:107], a[168:175], v5
 s_waitcnt vmcnt(2)
 v_smfmac_f32_16x16x64_bf16 v[56:59], v[100:103], a[96:103], v5
 v_smfmac_f32_16x16x64_bf16 v[60:63], v[100:103], a[104:111], v5
 v_smfmac_f32_16x16x64_bf16 v[64:67], v[100:103], a[112:119], v5
 v_smfmac_f32_16x16x64_bf16 v[68:71], v[100:103], a[120:127], v5
 s_waitcnt vmcnt(1)
 v_smfmac_f32_16x16x64_bf16 v[56:59], v[96:99], a[48:55], v5
 v_smfmac_f32_16x16x64_bf16 v[60:63], v[96:99], a[56:63], v5
 v_smfmac_f32_16x16x64_bf16 v[64:67], v[96:99], a[64:71], v5
 v_smfmac_f32_16x16x64_bf16 v[68:71], v[96:99], a[72:79], v5
 s_waitcnt vmcnt(0)
 v_smfmac_f32_16x16x64_bf16 v[56:59], v[92:95], a[0:7], v5
 v_smfmac_f32_16x16x64_bf16 v[60:63], v[92:95], a[8:15], v5
 v_smfmac_f32_16x16x64_bf16 v[64:67], v[92:95], a[16:23], v5
 v_smfmac_f32_16x16x64_bf16 v[68:71], v[92:95], a[24:31], v5
 s_nop 4
 v_pk_add_f32 v[84:85], v[56:57], v[58:59]
 ds_write2_b32 v7, v84, v85 offset0:0 offset1:36
 v_cmp_u_f32 vcc, v84, v85
 v_pk_add_f32 v[86:87], v[60:61], v[62:63]
 ds_write2_b32 v7, v86, v87 offset0:16 offset1:52
 v_pk_add_f32 v[88:89], v[64:65], v[66:67]
 ds_write2_b32 v8, v88, v89 offset0:0 offset1:36
 v_pk_add_f32 v[90:91], v[68:69], v[70:71]
 ds_write2_b32 v8, v90, v91 offset0:16 offset1:52
 s_cbranch_vccnz L_cf_w3_dslow
L_cf_w3_dgood:
 v_smfmac_f32_16x16x64_bf16 v[72:75], v[92:95], a[32:39], v5
 v_smfmac_f32_16x16x64_bf16 v[76:79], v[92:95], a[40:47], v5
 v_smfmac_f32_16x16x64_bf16 v[72:75], v[96:99], a[80:87], v5
 v_smfmac_f32_16x16x64_bf16 v[76:79], v[96:99], a[88:95], v5
 s_waitcnt lgkmcnt(0)
 s_barrier
 v_smfmac_f32_16x16x64_bf16 v[72:75], v[100:103], a[128:135], v5
 v_smfmac_f32_16x16x64_bf16 v[76:79], v[100:103], a[136:143], v5
 v_smfmac_f32_16x16x64_bf16 v[72:75], v[104:107], a[176:183], v5
 v_smfmac_f32_16x16x64_bf16 v[76:79], v[104:107], a[184:191], v5
 s_nop 7
 v_pk_add_f32 v[84:85], v[72:73], v[74:75]
 v_pk_add_f32 v[86:87], v[76:77], v[78:79]
 ds_write_b128 v10, v[84:87] offset:14336
 s_waitcnt lgkmcnt(0)
 s_barrier
 s_cmp_eq_u32 s52, 63
 s_cbranch_scc1 L_cf_w3_done
 s_lshr_b32 s60, s52, 3
 s_lshr_b32 s60, s27, s60
 s_and_b32 s60, s60, 1
 s_lshl_b32 s60, s60, 13
 s_lshl_b32 s56, s52, 18
 s_add_u32 s56, s56, s60
 s_add_u32 s56, s56, 134217728
 s_mov_b32 m0, 32768
 v_mov_b32 v80, 0
 v_mov_b32 v81, 0
 v_mov_b32 v82, 0
 v_mov_b32 v83, 0
 s_xor_b32 s63, s53, 0x8000
 s_xor_b32 s64, s55, 0x20000
 s_barrier
 buffer_load_dwordx4 v6, s[4:7], s54 offen offset:3072 sc1 lds
 s_nop 3
 buffer_load_dwordx4 v6, s[4:7], s54 offen offset:2048 sc1 lds
 s_nop 3
 buffer_load_dwordx4 v6, s[4:7], s54 offen offset:1024 sc1 lds
 s_nop 3
 buffer_load_dwordx4 v6, s[4:7], s54 offen offset:0 sc1 lds
 s_add_u32 s52, s52, 1
 s_and_b32 s61, s52, 3
 s_lshl_b32 s61, s61, 14
 s_add_u32 s53, s67, s61
 v_mov_b32 v56, 0
 v_mov_b32 v57, 0
 v_mov_b32 v58, 0
 v_mov_b32 v59, 0
 v_mov_b32 v60, 0
 v_mov_b32 v61, 0
 v_mov_b32 v62, 0
 v_mov_b32 v63, 0
 v_mov_b32 v64, 0
 v_mov_b32 v65, 0
 v_mov_b32 v66, 0
 v_mov_b32 v67, 0
 v_mov_b32 v68, 0
 v_mov_b32 v69, 0
 v_mov_b32 v70, 0
 v_mov_b32 v71, 0
 v_mov_b32 v72, 0
 v_mov_b32 v73, 0
 v_mov_b32 v74, 0
 v_mov_b32 v75, 0
 v_mov_b32 v76, 0
 v_mov_b32 v77, 0
 v_mov_b32 v78, 0
 v_mov_b32 v79, 0
L_cf_w3_bwait:
 s_waitcnt vmcnt(3)
 s_barrier
 ds_read_b128 v[108:111], v20 offset:20480
 ds_read_b128 v[128:131], v20 offset:25600
 ds_read_b128 v[148:151], v20 offset:30720
 ds_read_b128 v[168:171], v20 offset:35840
 s_waitcnt lgkmcnt(3)
 v_smfmac_f32_16x16x64_bf16 v[80:83], v[108:111], a[192:199], v5
 s_waitcnt vmcnt(2)
 s_barrier
 ds_read_b128 v[112:115], v20 offset:21504
 ds_read_b128 v[124:127], v20 offset:24576
 ds_read_b128 v[152:155], v20 offset:31744
 ds_read_b128 v[164:167], v20 offset:34816
 s_waitcnt lgkmcnt(6)
 v_smfmac_f32_16x16x64_bf16 v[80:83], v[128:131], a[216:223], v5
 s_waitcnt lgkmcnt(5)
 v_smfmac_f32_16x16x64_bf16 v[80:83], v[148:151], v[204:211], v5
 s_waitcnt lgkmcnt(4)
 v_smfmac_f32_16x16x64_bf16 v[80:83], v[168:171], v[228:235], v5
 s_waitcnt lgkmcnt(3)
 v_smfmac_f32_16x16x64_bf16 v[80:83], v[112:115], a[200:207], v5
 s_waitcnt vmcnt(1)
 s_barrier
 ds_read_b128 v[116:119], v20 offset:22528
 ds_read_b128 v[136:139], v20 offset:27648
 ds_read_b128 v[140:143], v20 offset:28672
 ds_read_b128 v[160:163], v20 offset:33792
 s_waitcnt lgkmcnt(6)
 v_smfmac_f32_16x16x64_bf16 v[80:83], v[124:127], a[208:215], v5
 s_waitcnt lgkmcnt(5)
 v_smfmac_f32_16x16x64_bf16 v[80:83], v[152:155], v[212:219], v5
 s_waitcnt lgkmcnt(4)
 v_smfmac_f32_16x16x64_bf16 v[80:83], v[164:167], v[220:227], v5
 s_waitcnt lgkmcnt(3)
 v_smfmac_f32_16x16x64_bf16 v[80:83], v[116:119], v[172:179], v5
 s_waitcnt vmcnt(0)
 s_barrier
 ds_read_b128 v[120:123], v20 offset:23552
 ds_read_b128 v[132:135], v20 offset:26624
 ds_read_b128 v[144:147], v20 offset:29696
 ds_read_b128 v[156:159], v20 offset:32768
 s_waitcnt lgkmcnt(6)
 v_smfmac_f32_16x16x64_bf16 v[80:83], v[136:139], v[196:203], v5
 s_waitcnt lgkmcnt(5)
 v_smfmac_f32_16x16x64_bf16 v[80:83], v[140:143], a[224:231], v5
 s_waitcnt lgkmcnt(4)
 v_smfmac_f32_16x16x64_bf16 v[80:83], v[160:163], a[248:255], v5
 s_waitcnt lgkmcnt(3)
 v_smfmac_f32_16x16x64_bf16 v[80:83], v[120:123], v[180:187], v5
 s_waitcnt lgkmcnt(2)
 v_smfmac_f32_16x16x64_bf16 v[80:83], v[132:135], v[188:195], v5
 s_waitcnt lgkmcnt(1)
 v_smfmac_f32_16x16x64_bf16 v[80:83], v[144:147], a[232:239], v5
 s_waitcnt lgkmcnt(0)
 v_smfmac_f32_16x16x64_bf16 v[80:83], v[156:159], a[240:247], v5
 s_nop 7
 v_pk_add_f32 v[84:85], v[80:81], v[82:83]
 v_cmpx_o_f32 vcc, v84, v85
 buffer_store_dword v84, v15, s[4:7], s56 offen sc1
 buffer_store_dword v85, v15, s[4:7], s56 offen offset:256 sc1
 s_cmp_eq_u64 exec, -1
 s_cbranch_scc0 L_cf_w3_bslow
L_cf_w3_bgood:
 ds_write2st64_b32 v4, v84, v85 offset0:74 offset1:75
 s_add_u32 s60, s63, 262144
 buffer_store_dwordx4 v[50:53], v21, s[4:7], s63 offen
 buffer_store_dwordx4 v[50:53], v21, s[4:7], s60 offen
 buffer_store_dwordx4 v[50:53], v22, s[4:7], s64 offen
 buffer_store_dwordx4 v[50:53], v23, s[4:7], s64 offen offset:1024
 s_waitcnt lgkmcnt(0)
 s_barrier
 s_barrier
 buffer_load_dwordx4 v[104:107], v6, s[4:7], s53 offen offset:3072 sc1
 s_nop 3
 buffer_load_dwordx4 v[100:103], v6, s[4:7], s53 offen offset:2048 sc1
 s_nop 3
 buffer_load_dwordx4 v[96:99], v6, s[4:7], s53 offen offset:1024 sc1
 s_nop 3
 buffer_load_dwordx4 v[92:95], v6, s[4:7], s53 offen offset:0 sc1
 s_branch L_cf_w3_loop
L_cf_w3_dslow:
 v_max_u32 v36, v92, v93
 v_max3_u32 v36, v36, v94, v95
 v_max3_u32 v36, v36, v96, v97
 v_max3_u32 v36, v36, v98, v99
 v_max3_u32 v36, v36, v100, v101
 v_max3_u32 v36, v36, v102, v103
 v_max3_u32 v36, v36, v104, v105
 v_max3_u32 v36, v36, v106, v107
 v_cmp_eq_u32 vcc, -1, v36
 s_cbranch_vccz L_cf_w3_dgood
L_cf_w3_dagain:
 buffer_load_dwordx4 v[104:107], v6, s[4:7], s53 offen offset:3072 sc1
 buffer_load_dwordx4 v[100:103], v6, s[4:7], s53 offen offset:2048 sc1
 buffer_load_dwordx4 v[96:99], v6, s[4:7], s53 offen offset:1024 sc1
 buffer_load_dwordx4 v[92:95], v6, s[4:7], s53 offen offset:0 sc1
 v_mov_b32 v56, 0
 v_mov_b32 v57, 0
 v_mov_b32 v58, 0
 v_mov_b32 v59, 0
 v_mov_b32 v60, 0
 v_mov_b32 v61, 0
 v_mov_b32 v62, 0
 v_mov_b32 v63, 0
 v_mov_b32 v64, 0
 v_mov_b32 v65, 0
 v_mov_b32 v66, 0
 v_mov_b32 v67, 0
 v_mov_b32 v68, 0
 v_mov_b32 v69, 0
 v_mov_b32 v70, 0
 v_mov_b32 v71, 0
 s_add_u32 s62, s62, 1
 s_cmp_gt_u32 s62, 400000
 s_cbranch_scc1 L_done
 s_waitcnt vmcnt(0)
 v_max_u32 v36, v92, v93
 v_max3_u32 v36, v36, v94, v95
 v_max3_u32 v36, v36, v96, v97
 v_max3_u32 v36, v36, v98, v99
 v_max3_u32 v36, v36, v100, v101
 v_max3_u32 v36, v36, v102, v103
 v_max3_u32 v36, v36, v104, v105
 v_max3_u32 v36, v36, v106, v107
 v_cmp_eq_u32 vcc, -1, v36
 s_cbranch_vccnz L_cf_w3_dagain
 s_branch L_cf_w3_dtry
L_cf_w3_bslow:
 s_mov_b64 exec, -1
 v_max_u32 v36, v108, v109
 v_max3_u32 v36, v36, v110, v111
 v_max3_u32 v36, v36, v112, v113
 v_max3_u32 v36, v36, v114, v115
 v_max3_u32 v36, v36, v116, v117
 v_max3_u32 v36, v36, v118, v119
 v_max3_u32 v36, v36, v120, v121
 v_max3_u32 v36, v36, v122, v123
 v_max3_u32 v36, v36, v124, v125
 v_max3_u32 v36, v36, v126, v127
 v_max3_u32 v36, v36, v128, v129
 v_max3_u32 v36, v36, v130, v131
 v_max3_u32 v36, v36, v132, v133
 v_max3_u32 v36, v36, v134, v135
 v_max3_u32 v36, v36, v136, v137
 v_max3_u32 v36, v36, v138, v139
 v_max3_u32 v36, v36, v140, v141
 v_max3_u32 v36, v36, v142, v143
 v_max3_u32 v36, v36, v144, v145
 v_max3_u32 v36, v36, v146, v147
 v_max3_u32 v36, v36, v148, v149
 v_max3_u32 v36, v36, v150, v151
 v_max3_u32 v36, v36, v152, v153
 v_max3_u32 v36, v36, v154, v155
 v_max3_u32 v36, v36, v156, v157
 v_max3_u32 v36, v36, v158, v159
 v_max3_u32 v36, v36, v160, v161
 v_max3_u32 v36, v36, v162, v163
 v_max3_u32 v36, v36, v164, v165
 v_max3_u32 v36, v36, v166, v167
 v_max3_u32 v36, v36, v168, v169
 v_max3_u32 v36, v36, v170, v171
 v_cmp_eq_u32 vcc, -1, v36
 s_cbranch_vccnz L_cf_w3_bagain
 buffer_store_dword v84, v15, s[4:7], s56 offen sc1
 buffer_store_dword v85, v15, s[4:7], s56 offen offset:256 sc1
 s_branch L_cf_w3_bgood
L_cf_w3_bagain:
 v_mov_b32 v80, 0
 v_mov_b32 v81, 0
 v_mov_b32 v82, 0
 v_mov_b32 v83, 0
 s_add_u32 s62, s62, 1
 s_cmp_gt_u32 s62, 400000
 s_cbranch_scc1 L_done
 s_waitcnt lgkmcnt(0)
 s_barrier
 buffer_load_dwordx4 v6, s[4:7], s54 offen offset:3072 sc1 lds
 s_nop 3
 buffer_load_dwordx4 v6, s[4:7], s54 offen offset:2048 sc1 lds
 s_nop 3
 buffer_load_dwordx4 v6, s[4:7], s54 offen offset:1024 sc1 lds
 s_nop 3
 buffer_load_dwordx4 v6, s[4:7], s54 offen offset:0 sc1 lds
 s_branch L_cf_w3_bwait
L_cf_w3_done:
 s_branch L_done
L_done:
L_exit:
 s_endpgm
L_role_K:
 s_mov_b64 s[8:9], s[18:19]
 s_mov_b32 s10, 8388608
 s_mov_b32 s11, 0x20000
 v_and_b32 v1, 63, v0
 v_lshrrev_b32 v12, 4, v1
 v_lshlrev_b32 v12, 13, v12
 v_and_b32 v3, 15, v1
 v_lshl_add_u32 v12, v3, 4, v12
 s_lshl_b32 s44, s25, 8
 s_lshl_b32 s42, s26, 18
 s_add_u32 s44, s44, s42
 s_lshl_b32 s45, s26, 13
 s_add_u32 m0, s45, 0
 s_add_u32 s43, s44, 0
 buffer_load_dwordx4 v12, s[8:11], s43 offen  lds
 s_add_u32 m0, s45, 1024
 s_add_u32 s43, s44, 32768
 buffer_load_dwordx4 v12, s[8:11], s43 offen  lds
 s_add_u32 m0, s45, 2048
 s_add_u32 s43, s44, 65536
 buffer_load_dwordx4 v12, s[8:11], s43 offen  lds
 s_add_u32 m0, s45, 3072
 s_add_u32 s43, s44, 98304
 buffer_load_dwordx4 v12, s[8:11], s43 offen  lds
 s_add_u32 m0, s45, 4096
 s_add_u32 s43, s44, 131072
 buffer_load_dwordx4 v12, s[8:11], s43 offen  lds
 s_add_u32 m0, s45, 5120
 s_add_u32 s43, s44, 163840
 buffer_load_dwordx4 v12, s[8:11], s43 offen  lds
 s_add_u32 m0, s45, 6144
 s_add_u32 s43, s44, 196608
 buffer_load_dwordx4 v12, s[8:11], s43 offen  lds
 s_add_u32 m0, s45, 7168
 s_add_u32 s43, s44, 229376
 buffer_load_dwordx4 v12, s[8:11], s43 offen  lds
 s_cmp_lg_u32 s26, 1
 s_cbranch_scc1 L_voted_4
 s_bfe_u32 s63, s2, 0x30003
 s_lshl_b32 s56, s63, 21
 s_lshr_b32 s57, s2, 6
 s_lshl_b32 s57, s57, 3
 s_and_b32 s58, s2, 7
 s_add_u32 s57, s57, s58
 s_lshl_b32 s57, s57, 8
 s_add_u32 s56, s56, s57
 s_add_u32 s56, s56, 135790592
 s_add_u32 s57, s56, 8192
 s_load_dword s62, s[4:5], s56 glc
 s_load_dword s62, s[4:5], s57 glc
 s_waitcnt lgkmcnt(0)
 s_memtime s[58:59]
 s_load_dword s62, s[4:5], s56 glc
 s_waitcnt lgkmcnt(0)
 s_memtime s[60:61]
 s_load_dword s62, s[4:5], s57 glc
 s_waitcnt lgkmcnt(0)
 s_memtime s[32:33]
 s_sub_u32 s58, s60, s58
 s_waitcnt lgkmcnt(0)
 s_sub_u32 s60, s32, s60
 s_cmp_lt_u32 s60, s58
 s_cselect_b32 s58, 1, 0
 s_bfe_u32 s59, s24, 0x10002
 s_xor_b32 s58, s58, s59
 s_mov_b32 s59, 0
 s_mul_i32 s63, s63, 6
 s_add_u32 s63, s63, 16
 s_lshl_b64 s[34:35], s[58:59], s63
 s_or_b32 s34, s34, 1
L_voted_4:
 v_and_b32 v1, 63, v0
 v_lshlrev_b32 v2, 4, v1
 v_bfrev_b32 v7, 1
 s_mov_b32 s48, 0
 v_and_b32 v5, 0x13, v1
 v_bfe_u32 v3, v1, 2, 1
 v_lshl_add_u32 v5, v3, 3, v5
 v_bfe_u32 v3, v1, 3, 1
 v_lshl_add_u32 v5, v3, 2, v5
 v_lshrrev_b32 v4, 5, v1
 v_lshlrev_b32 v3, 9, v4
 v_lshl_add_u32 v6, v5, 4, v3
 v_and_b32 v3, 31, v1
 v_mul_u32_u24 v3, 2064, v3
 v_lshl_add_u32 v10, v4, 4, v3
 v_add_u32 v11, 66048, v10
 s_lshr_b32 s50, s25, 3
 s_add_u32 s50, s50, 8
 s_and_b32 s51, s25, 7
 s_lshl_b32 s51, s51, 2
 s_add_u32 s51, s51, s26
 v_mad_u32_u24 v3, v1, 12, s50
 v_cmp_gt_u32 vcc, 64, v3
 s_lshl_b32 s41, s51, 2
 s_add_u32 s41, s41, 3760128
 v_lshl_add_u32 v3, v3, 7, s41
 v_cndmask_b32 v14, v7, v3, vcc
 s_lshl_b32 s41, s25, 7
 s_add_u32 s41, s41, 3735552
 s_lshl_b32 s42, s26, 2
 s_add_u32 s41, s41, s42
 v_mov_b32 v3, s41
 v_cmp_eq_u32 vcc, 0, v1
 v_mov_b32 v9, 0
 s_nop 0
 v_cndmask_b32 v8, v7, v3, vcc
 v_bfe_u32 v13, v1, 2, 2
 v_lshrrev_b32 v3, 5, v1
 v_lshl_add_u32 v13, v3, 3, v13
 v_lshlrev_b32 v13, 8, v13
 v_bfe_u32 v3, v1, 4, 1
 v_lshl_add_u32 v13, v3, 5, v13
 v_and_b32 v3, 1, v1
 v_lshl_add_u32 v13, v3, 4, v13
 v_bfe_u32 v3, v1, 1, 1
 v_lshl_add_u32 v13, v3, 3, v13
 s_lshl_b32 s43, s26, 6
 v_add_u32 v13, s43, v13
 buffer_store_dword v9, v8, s[4:7], 0 offen sc1
 buffer_store_dword v9, v14, s[4:7], 0 offen sc1
 s_add_u32 m0, s45, 32768
 s_add_u32 s43, s44, 1048576
 buffer_load_dwordx4 v12, s[8:11], s43 offen  lds
 s_add_u32 m0, s45, 33792
 s_add_u32 s43, s44, 1081344
 buffer_load_dwordx4 v12, s[8:11], s43 offen  lds
 s_add_u32 m0, s45, 34816
 s_add_u32 s43, s44, 1114112
 buffer_load_dwordx4 v12, s[8:11], s43 offen  lds
 s_add_u32 m0, s45, 35840
 s_add_u32 s43, s44, 1146880
 buffer_load_dwordx4 v12, s[8:11], s43 offen  lds
 s_add_u32 m0, s45, 36864
 s_add_u32 s43, s44, 1179648
 buffer_load_dwordx4 v12, s[8:11], s43 offen  lds
 s_add_u32 m0, s45, 37888
 s_add_u32 s43, s44, 1212416
 buffer_load_dwordx4 v12, s[8:11], s43 offen  lds
 s_add_u32 m0, s45, 38912
 s_add_u32 s43, s44, 1245184
 buffer_load_dwordx4 v12, s[8:11], s43 offen  lds
 s_add_u32 m0, s45, 39936
 s_add_u32 s43, s44, 1277952
 buffer_load_dwordx4 v12, s[8:11], s43 offen  lds
 v_and_b32 v67, 15, v64
 v_lshrrev_b32 v68, 4, v64
 v_cvt_f32_u32 v200, v67
 v_mul_f32 v206, 0x41800000, v200
 v_lshl_add_u32 v65, v67, 1, 0
 v_add_u32 v65, 256, v65
 v_and_b32 v66, 3, v67
 v_lshlrev_b32 v66, 2, v66
 v_lshrrev_b32 v69, 2, v67
 v_lshl_add_u32 v66, v69, 8, v66
 v_cmp_gt_u32 vcc, 8, v67
 s_nop 1
 v_cndmask_b32 v65, v66, v65, vcc
 v_cvt_f32_u32 v202, v65
 v_and_b32 v65, 1, v67
 v_lshlrev_b32 v65, 3, v65
 v_lshrrev_b32 v66, 1, v67
 v_min_u32 v66, 4, v66
 v_lshl_add_u32 v65, v66, 8, v65
 v_add_u32 v65, 1024, v65
 v_cvt_f32_u32 v204, v65
 s_waitcnt vmcnt(19)
 v_lshlrev_b32 v95, 16, v94
 v_mul_f32 v95, 0x3fb8aa3b, v95
 v_exp_f32 v95, v95
 s_nop 0
 v_cvt_pk_bf16_f32 v95, v95, v95
 v_and_b32 v95, s98, v95
 v_lshl_add_u32 v65, v64, 5, s94
 v_lshlrev_b32 v96, 16, v88
 v_lshlrev_b32 v97, 16, v89
 v_lshlrev_b32 v98, 16, v90
 v_lshlrev_b32 v99, 16, v91
 v_lshlrev_b32 v100, 16, v92
 v_lshlrev_b32 v101, 16, v93
 v_mul_f32 v96, v95, v96
 v_mul_f32 v97, v95, v97
 v_mul_f32 v98, v95, v98
 v_mul_f32 v99, v95, v99
 v_mul_f32 v104, 0x3fb8aa3b, v96
 v_mul_f32 v105, 0x3e22f983, v97
 v_mul_f32 v106, v100, v98
 v_fma_f32 v106, -v101, v99, v106
 v_mul_f32 v107, v100, v99
 v_fma_f32 v107, v101, v98, v107
 ds_write_b128 v65, v[104:107] offset:4160
 v_and_b32 v96, s98, v88
 v_and_b32 v97, s98, v89
 v_and_b32 v98, s98, v90
 v_and_b32 v99, s98, v91
 v_and_b32 v100, s98, v92
 v_and_b32 v101, s98, v93
 v_mul_f32 v96, v95, v96
 v_mul_f32 v97, v95, v97
 v_mul_f32 v98, v95, v98
 v_mul_f32 v99, v95, v99
 v_mul_f32 v108, 0x3fb8aa3b, v96
 v_mul_f32 v109, 0x3e22f983, v97
 v_mul_f32 v110, v100, v98
 v_fma_f32 v110, -v101, v99, v110
 v_mul_f32 v111, v100, v99
 v_fma_f32 v111, v101, v98, v111
 ds_write_b128 v65, v[108:111] offset:4176
 v_mov_b32 v120, 0
 v_mov_b32 v121, 0
 v_mov_b32 v122, 0
 v_mov_b32 v123, 0
 v_mov_b32 v124, 0
 v_mov_b32 v125, 0
 v_mov_b32 v126, 0
 v_mov_b32 v127, 0
 v_mov_b32 v128, 0
 v_mov_b32 v129, 0
 v_mov_b32 v130, 0
 v_mov_b32 v131, 0
 v_lshl_add_u32 v69, v68, 6, s94
 s_mov_b32 s95, 0
 s_waitcnt lgkmcnt(0)
L_rKb_kg0:
 ds_read_b128 v[88:91], v69 offset:4160
 ds_read_b128 v[92:95], v69 offset:4176
 ds_read_b128 v[96:99], v69 offset:4192
 ds_read_b128 v[100:103], v69 offset:4208
 v_add_u32 v69, 256, v69
 s_waitcnt lgkmcnt(3)
 v_pk_mul_f32 v[132:133], v[88:89], v[200:201] op_sel_hi:[1,0]
 v_pk_mul_f32 v[136:137], v[88:89], v[202:203] op_sel_hi:[1,0]
 v_pk_mul_f32 v[140:141], v[88:89], v[204:205] op_sel_hi:[1,0]
 v_pk_mul_f32 v[144:145], v[88:89], v[206:207] op_sel_hi:[1,0]
 v_fract_f32 v133, v133
 v_fract_f32 v137, v137
 v_fract_f32 v141, v141
 v_fract_f32 v145, v145
 v_exp_f32 v132, v132
 v_cos_f32 v134, v133
 v_sin_f32 v135, v133
 v_exp_f32 v136, v136
 v_cos_f32 v138, v137
 v_sin_f32 v139, v137
 v_exp_f32 v140, v140
 v_cos_f32 v142, v141
 v_sin_f32 v143, v141
 v_exp_f32 v144, v144
 v_cos_f32 v146, v145
 v_sin_f32 v147, v145
 v_pk_mul_f32 v[134:135], v[134:135], v[132:133] op_sel_hi:[1,0]
 v_pk_mul_f32 v[138:139], v[138:139], v[136:137] op_sel_hi:[1,0]
 v_pk_mul_f32 v[142:143], v[142:143], v[140:141] op_sel_hi:[1,0]
 v_pk_mul_f32 v[146:147], v[146:147], v[144:145] op_sel_hi:[1,0]
 v_pk_mul_f32 v[144:145], v[146:147], v[90:91] op_sel_hi:[0,1] neg_hi:[0,1]
 v_cvt_pk_bf16_f32 v104, v134, v135
 v_cvt_pk_bf16_f32 v108, v138, v139
 v_cvt_pk_bf16_f32 v112, v142, v143
 v_pk_fma_f32 v[144:145], v[146:147], v[90:91], v[144:145] op_sel:[1,1,0] op_sel_hi:[1,0,1] neg_lo:[0,1,0] neg_hi:[0,1,0]
 v_cvt_pk_bf16_f32 v116, v144, v145
 s_waitcnt lgkmcnt(2)
 v_pk_mul_f32 v[132:133], v[92:93], v[200:201] op_sel_hi:[1,0]
 v_pk_mul_f32 v[136:137], v[92:93], v[202:203] op_sel_hi:[1,0]
 v_pk_mul_f32 v[140:141], v[92:93], v[204:205] op_sel_hi:[1,0]
 v_pk_mul_f32 v[144:145], v[92:93], v[206:207] op_sel_hi:[1,0]
 v_fract_f32 v133, v133
 v_fract_f32 v137, v137
 v_fract_f32 v141, v141
 v_fract_f32 v145, v145
 v_exp_f32 v132, v132
 v_cos_f32 v134, v133
 v_sin_f32 v135, v133
 v_exp_f32 v136, v136
 v_cos_f32 v138, v137
 v_sin_f32 v139, v137
 v_exp_f32 v140, v140
 v_cos_f32 v142, v141
 v_sin_f32 v143, v141
 v_exp_f32 v144, v144
 v_cos_f32 v146, v145
 v_sin_f32 v147, v145
 v_pk_mul_f32 v[134:135], v[134:135], v[132:133] op_sel_hi:[1,0]
 v_pk_mul_f32 v[138:139], v[138:139], v[136:137] op_sel_hi:[1,0]
 v_pk_mul_f32 v[142:143], v[142:143], v[140:141] op_sel_hi:[1,0]
 v_pk_mul_f32 v[146:147], v[146:147], v[144:145] op_sel_hi:[1,0]
 v_pk_mul_f32 v[144:145], v[146:147], v[94:95] op_sel_hi:[0,1] neg_hi:[0,1]
 v_cvt_pk_bf16_f32 v105, v134, v135
 v_cvt_pk_bf16_f32 v109, v138, v139
 v_cvt_pk_bf16_f32 v113, v142, v143
 v_pk_fma_f32 v[144:145], v[146:147], v[94:95], v[144:145] op_sel:[1,1,0] op_sel_hi:[1,0,1] neg_lo:[0,1,0] neg_hi:[0,1,0]
 v_cvt_pk_bf16_f32 v117, v144, v145
 s_waitcnt lgkmcnt(1)
 v_pk_mul_f32 v[132:133], v[96:97], v[200:201] op_sel_hi:[1,0]
 v_pk_mul_f32 v[136:137], v[96:97], v[202:203] op_sel_hi:[1,0]
 v_pk_mul_f32 v[140:141], v[96:97], v[204:205] op_sel_hi:[1,0]
 v_pk_mul_f32 v[144:145], v[96:97], v[206:207] op_sel_hi:[1,0]
 v_fract_f32 v133, v133
 v_fract_f32 v137, v137
 v_fract_f32 v141, v141
 v_fract_f32 v145, v145
 v_exp_f32 v132, v132
 v_cos_f32 v134, v133
 v_sin_f32 v135, v133
 v_exp_f32 v136, v136
 v_cos_f32 v138, v137
 v_sin_f32 v139, v137
 v_exp_f32 v140, v140
 v_cos_f32 v142, v141
 v_sin_f32 v143, v141
 v_exp_f32 v144, v144
 v_cos_f32 v146, v145
 v_sin_f32 v147, v145
 v_pk_mul_f32 v[134:135], v[134:135], v[132:133] op_sel_hi:[1,0]
 v_pk_mul_f32 v[138:139], v[138:139], v[136:137] op_sel_hi:[1,0]
 v_pk_mul_f32 v[142:143], v[142:143], v[140:141] op_sel_hi:[1,0]
 v_pk_mul_f32 v[146:147], v[146:147], v[144:145] op_sel_hi:[1,0]
 v_pk_mul_f32 v[144:145], v[146:147], v[98:99] op_sel_hi:[0,1] neg_hi:[0,1]
 v_cvt_pk_bf16_f32 v106, v134, v135
 v_cvt_pk_bf16_f32 v110, v138, v139
 v_cvt_pk_bf16_f32 v114, v142, v143
 v_pk_fma_f32 v[144:145], v[146:147], v[98:99], v[144:145] op_sel:[1,1,0] op_sel_hi:[1,0,1] neg_lo:[0,1,0] neg_hi:[0,1,0]
 v_cvt_pk_bf16_f32 v118, v144, v145
 s_waitcnt lgkmcnt(0)
 v_pk_mul_f32 v[132:133], v[100:101], v[200:201] op_sel_hi:[1,0]
 v_pk_mul_f32 v[136:137], v[100:101], v[202:203] op_sel_hi:[1,0]
 v_pk_mul_f32 v[140:141], v[100:101], v[204:205] op_sel_hi:[1,0]
 v_pk_mul_f32 v[144:145], v[100:101], v[206:207] op_sel_hi:[1,0]
 v_fract_f32 v133, v133
 v_fract_f32 v137, v137
 v_fract_f32 v141, v141
 v_fract_f32 v145, v145
 v_exp_f32 v132, v132
 v_cos_f32 v134, v133
 v_sin_f32 v135, v133
 v_exp_f32 v136, v136
 v_cos_f32 v138, v137
 v_sin_f32 v139, v137
 v_exp_f32 v140, v140
 v_cos_f32 v142, v141
 v_sin_f32 v143, v141
 v_exp_f32 v144, v144
 v_cos_f32 v146, v145
 v_sin_f32 v147, v145
 v_pk_mul_f32 v[134:135], v[134:135], v[132:133] op_sel_hi:[1,0]
 v_pk_mul_f32 v[138:139], v[138:139], v[136:137] op_sel_hi:[1,0]
 v_pk_mul_f32 v[142:143], v[142:143], v[140:141] op_sel_hi:[1,0]
 v_pk_mul_f32 v[146:147], v[146:147], v[144:145] op_sel_hi:[1,0]
 v_pk_mul_f32 v[144:145], v[146:147], v[102:103] op_sel_hi:[0,1] neg_hi:[0,1]
 v_cvt_pk_bf16_f32 v107, v134, v135
 v_cvt_pk_bf16_f32 v111, v138, v139
 v_cvt_pk_bf16_f32 v115, v142, v143
 v_pk_fma_f32 v[144:145], v[146:147], v[102:103], v[144:145] op_sel:[1,1,0] op_sel_hi:[1,0,1] neg_lo:[0,1,0] neg_hi:[0,1,0]
 v_cvt_pk_bf16_f32 v119, v144, v145
 s_add_u32 s95, s95, 1
 s_cmp_lt_u32 s95, 2
 v_mfma_f32_16x16x32_bf16 v[120:123], v[104:107], v[116:119], v[120:123]
 v_mfma_f32_16x16x32_bf16 v[124:127], v[108:111], v[116:119], v[124:127]
 v_mfma_f32_16x16x32_bf16 v[128:131], v[112:115], v[116:119], v[128:131]
 s_cbranch_scc1 L_rKb_kg0
 s_waitcnt vmcnt(10)
 s_barrier
 ds_read_b64_tr_b16 a[0:1], v13 offset:0
 ds_read_b64_tr_b16 a[2:3], v13 offset:1024
 ds_read_b64_tr_b16 a[4:5], v13 offset:4096
 ds_read_b64_tr_b16 a[6:7], v13 offset:5120
 ds_read_b64_tr_b16 a[8:9], v13 offset:8192
 ds_read_b64_tr_b16 a[10:11], v13 offset:9216
 ds_read_b64_tr_b16 a[12:13], v13 offset:12288
 ds_read_b64_tr_b16 a[14:15], v13 offset:13312
 s_waitcnt lgkmcnt(0)
 ds_read_b64_tr_b16 a[16:17], v13 offset:16384
 ds_read_b64_tr_b16 a[18:19], v13 offset:17408
 ds_read_b64_tr_b16 a[20:21], v13 offset:20480
 ds_read_b64_tr_b16 a[22:23], v13 offset:21504
 ds_read_b64_tr_b16 a[24:25], v13 offset:24576
 ds_read_b64_tr_b16 a[26:27], v13 offset:25600
 ds_read_b64_tr_b16 a[28:29], v13 offset:28672
 ds_read_b64_tr_b16 a[30:31], v13 offset:29696
 s_waitcnt lgkmcnt(0)
 s_barrier
 s_add_u32 m0, s45, 0
 s_add_u32 s43, s44, 2097152
 buffer_load_dwordx4 v12, s[8:11], s43 offen  lds
 s_add_u32 m0, s45, 1024
 s_add_u32 s43, s44, 2129920
 buffer_load_dwordx4 v12, s[8:11], s43 offen  lds
 s_add_u32 m0, s45, 2048
 s_add_u32 s43, s44, 2162688
 buffer_load_dwordx4 v12, s[8:11], s43 offen  lds
 s_add_u32 m0, s45, 3072
 s_add_u32 s43, s44, 2195456
 buffer_load_dwordx4 v12, s[8:11], s43 offen  lds
 s_add_u32 m0, s45, 4096
 s_add_u32 s43, s44, 2228224
 buffer_load_dwordx4 v12, s[8:11], s43 offen  lds
 s_add_u32 m0, s45, 5120
 s_add_u32 s43, s44, 2260992
 buffer_load_dwordx4 v12, s[8:11], s43 offen  lds
 s_add_u32 m0, s45, 6144
 s_add_u32 s43, s44, 2293760
 buffer_load_dwordx4 v12, s[8:11], s43 offen  lds
 s_add_u32 m0, s45, 7168
 s_add_u32 s43, s44, 2326528
 buffer_load_dwordx4 v12, s[8:11], s43 offen  lds
L_rKb_kg1:
 ds_read_b128 v[88:91], v69 offset:4160
 ds_read_b128 v[92:95], v69 offset:4176
 ds_read_b128 v[96:99], v69 offset:4192
 ds_read_b128 v[100:103], v69 offset:4208
 v_add_u32 v69, 256, v69
 s_waitcnt lgkmcnt(3)
 v_pk_mul_f32 v[132:133], v[88:89], v[200:201] op_sel_hi:[1,0]
 v_pk_mul_f32 v[136:137], v[88:89], v[202:203] op_sel_hi:[1,0]
 v_pk_mul_f32 v[140:141], v[88:89], v[204:205] op_sel_hi:[1,0]
 v_pk_mul_f32 v[144:145], v[88:89], v[206:207] op_sel_hi:[1,0]
 v_fract_f32 v133, v133
 v_fract_f32 v137, v137
 v_fract_f32 v141, v141
 v_fract_f32 v145, v145
 v_exp_f32 v132, v132
 v_cos_f32 v134, v133
 v_sin_f32 v135, v133
 v_exp_f32 v136, v136
 v_cos_f32 v138, v137
 v_sin_f32 v139, v137
 v_exp_f32 v140, v140
 v_cos_f32 v142, v141
 v_sin_f32 v143, v141
 v_exp_f32 v144, v144
 v_cos_f32 v146, v145
 v_sin_f32 v147, v145
 v_pk_mul_f32 v[134:135], v[134:135], v[132:133] op_sel_hi:[1,0]
 v_pk_mul_f32 v[138:139], v[138:139], v[136:137] op_sel_hi:[1,0]
 v_pk_mul_f32 v[142:143], v[142:143], v[140:141] op_sel_hi:[1,0]
 v_pk_mul_f32 v[146:147], v[146:147], v[144:145] op_sel_hi:[1,0]
 v_pk_mul_f32 v[144:145], v[146:147], v[90:91] op_sel_hi:[0,1] neg_hi:[0,1]
 v_cvt_pk_bf16_f32 v104, v134, v135
 v_cvt_pk_bf16_f32 v108, v138, v139
 v_cvt_pk_bf16_f32 v112, v142, v143
 v_pk_fma_f32 v[144:145], v[146:147], v[90:91], v[144:145] op_sel:[1,1,0] op_sel_hi:[1,0,1] neg_lo:[0,1,0] neg_hi:[0,1,0]
 v_cvt_pk_bf16_f32 v116, v144, v145
 s_waitcnt lgkmcnt(2)
 v_pk_mul_f32 v[132:133], v[92:93], v[200:201] op_sel_hi:[1,0]
 v_pk_mul_f32 v[136:137], v[92:93], v[202:203] op_sel_hi:[1,0]
 v_pk_mul_f32 v[140:141], v[92:93], v[204:205] op_sel_hi:[1,0]
 v_pk_mul_f32 v[144:145], v[92:93], v[206:207] op_sel_hi:[1,0]
 v_fract_f32 v133, v133
 v_fract_f32 v137, v137
 v_fract_f32 v141, v141
 v_fract_f32 v145, v145
 v_exp_f32 v132, v132
 v_cos_f32 v134, v133
 v_sin_f32 v135, v133
 v_exp_f32 v136, v136
 v_cos_f32 v138, v137
 v_sin_f32 v139, v137
 v_exp_f32 v140, v140
 v_cos_f32 v142, v141
 v_sin_f32 v143, v141
 v_exp_f32 v144, v144
 v_cos_f32 v146, v145
 v_sin_f32 v147, v145
 v_pk_mul_f32 v[134:135], v[134:135], v[132:133] op_sel_hi:[1,0]
 v_pk_mul_f32 v[138:139], v[138:139], v[136:137] op_sel_hi:[1,0]
 v_pk_mul_f32 v[142:143], v[142:143], v[140:141] op_sel_hi:[1,0]
 v_pk_mul_f32 v[146:147], v[146:147], v[144:145] op_sel_hi:[1,0]
 v_pk_mul_f32 v[144:145], v[146:147], v[94:95] op_sel_hi:[0,1] neg_hi:[0,1]
 v_cvt_pk_bf16_f32 v105, v134, v135
 v_cvt_pk_bf16_f32 v109, v138, v139
 v_cvt_pk_bf16_f32 v113, v142, v143
 v_pk_fma_f32 v[144:145], v[146:147], v[94:95], v[144:145] op_sel:[1,1,0] op_sel_hi:[1,0,1] neg_lo:[0,1,0] neg_hi:[0,1,0]
 v_cvt_pk_bf16_f32 v117, v144, v145
 s_waitcnt lgkmcnt(1)
 v_pk_mul_f32 v[132:133], v[96:97], v[200:201] op_sel_hi:[1,0]
 v_pk_mul_f32 v[136:137], v[96:97], v[202:203] op_sel_hi:[1,0]
 v_pk_mul_f32 v[140:141], v[96:97], v[204:205] op_sel_hi:[1,0]
 v_pk_mul_f32 v[144:145], v[96:97], v[206:207] op_sel_hi:[1,0]
 v_fract_f32 v133, v133
 v_fract_f32 v137, v137
 v_fract_f32 v141, v141
 v_fract_f32 v145, v145
 v_exp_f32 v132, v132
 v_cos_f32 v134, v133
 v_sin_f32 v135, v133
 v_exp_f32 v136, v136
 v_cos_f32 v138, v137
 v_sin_f32 v139, v137
 v_exp_f32 v140, v140
 v_cos_f32 v142, v141
 v_sin_f32 v143, v141
 v_exp_f32 v144, v144
 v_cos_f32 v146, v145
 v_sin_f32 v147, v145
 v_pk_mul_f32 v[134:135], v[134:135], v[132:133] op_sel_hi:[1,0]
 v_pk_mul_f32 v[138:139], v[138:139], v[136:137] op_sel_hi:[1,0]
 v_pk_mul_f32 v[142:143], v[142:143], v[140:141] op_sel_hi:[1,0]
 v_pk_mul_f32 v[146:147], v[146:147], v[144:145] op_sel_hi:[1,0]
 v_pk_mul_f32 v[144:145], v[146:147], v[98:99] op_sel_hi:[0,1] neg_hi:[0,1]
 v_cvt_pk_bf16_f32 v106, v134, v135
 v_cvt_pk_bf16_f32 v110, v138, v139
 v_cvt_pk_bf16_f32 v114, v142, v143
 v_pk_fma_f32 v[144:145], v[146:147], v[98:99], v[144:145] op_sel:[1,1,0] op_sel_hi:[1,0,1] neg_lo:[0,1,0] neg_hi:[0,1,0]
 v_cvt_pk_bf16_f32 v118, v144, v145
 s_waitcnt lgkmcnt(0)
 v_pk_mul_f32 v[132:133], v[100:101], v[200:201] op_sel_hi:[1,0]
 v_pk_mul_f32 v[136:137], v[100:101], v[202:203] op_sel_hi:[1,0]
 v_pk_mul_f32 v[140:141], v[100:101], v[204:205] op_sel_hi:[1,0]
 v_pk_mul_f32 v[144:145], v[100:101], v[206:207] op_sel_hi:[1,0]
 v_fract_f32 v133, v133
 v_fract_f32 v137, v137
 v_fract_f32 v141, v141
 v_fract_f32 v145, v145
 v_exp_f32 v132, v132
 v_cos_f32 v134, v133
 v_sin_f32 v135, v133
 v_exp_f32 v136, v136
 v_cos_f32 v138, v137
 v_sin_f32 v139, v137
 v_exp_f32 v140, v140
 v_cos_f32 v142, v141
 v_sin_f32 v143, v141
 v_exp_f32 v144, v144
 v_cos_f32 v146, v145
 v_sin_f32 v147, v145
 v_pk_mul_f32 v[134:135], v[134:135], v[132:133] op_sel_hi:[1,0]
 v_pk_mul_f32 v[138:139], v[138:139], v[136:137] op_sel_hi:[1,0]
 v_pk_mul_f32 v[142:143], v[142:143], v[140:141] op_sel_hi:[1,0]
 v_pk_mul_f32 v[146:147], v[146:147], v[144:145] op_sel_hi:[1,0]
 v_pk_mul_f32 v[144:145], v[146:147], v[102:103] op_sel_hi:[0,1] neg_hi:[0,1]
 v_cvt_pk_bf16_f32 v107, v134, v135
 v_cvt_pk_bf16_f32 v111, v138, v139
 v_cvt_pk_bf16_f32 v115, v142, v143
 v_pk_fma_f32 v[144:145], v[146:147], v[102:103], v[144:145] op_sel:[1,1,0] op_sel_hi:[1,0,1] neg_lo:[0,1,0] neg_hi:[0,1,0]
 v_cvt_pk_bf16_f32 v119, v144, v145
 s_add_u32 s95, s95, 1
 s_cmp_lt_u32 s95, 5
 v_mfma_f32_16x16x32_bf16 v[120:123], v[104:107], v[116:119], v[120:123]
 v_mfma_f32_16x16x32_bf16 v[124:127], v[108:111], v[116:119], v[124:127]
 v_mfma_f32_16x16x32_bf16 v[128:131], v[112:115], v[116:119], v[128:131]
 s_cbranch_scc1 L_rKb_kg1
 s_lshl_b32 s93, s28, 3
 buffer_load_dwordx2 v[72:73], v70, s[84:87], s93 offen offset:0
 buffer_load_dwordx2 v[74:75], v70, s[84:87], s93 offen offset:2048
 s_add_u32 s93, s93, 4096
 buffer_load_dwordx2 v[76:77], v70, s[84:87], s93 offen offset:0
 buffer_load_dwordx2 v[78:79], v70, s[84:87], s93 offen offset:2048
 s_add_u32 s93, s93, 4096
 buffer_load_dwordx2 v[80:81], v70, s[84:87], s93 offen offset:0
 buffer_load_dwordx2 v[82:83], v70, s[84:87], s93 offen offset:2048
 s_add_u32 s93, s93, 4096
 buffer_load_dwordx2 v[84:85], v70, s[84:87], s93 offen offset:0
 buffer_load_dwordx2 v[86:87], v70, s[84:87], s93 offen offset:2048
 s_waitcnt vmcnt(16)
 s_barrier
 ds_read_b64_tr_b16 a[32:33], v13 offset:32768
 ds_read_b64_tr_b16 a[34:35], v13 offset:33792
 ds_read_b64_tr_b16 a[36:37], v13 offset:36864
 ds_read_b64_tr_b16 a[38:39], v13 offset:37888
 ds_read_b64_tr_b16 a[40:41], v13 offset:40960
 ds_read_b64_tr_b16 a[42:43], v13 offset:41984
 ds_read_b64_tr_b16 a[44:45], v13 offset:45056
 ds_read_b64_tr_b16 a[46:47], v13 offset:46080
 s_waitcnt lgkmcnt(0)
 ds_read_b64_tr_b16 a[48:49], v13 offset:49152
 ds_read_b64_tr_b16 a[50:51], v13 offset:50176
 ds_read_b64_tr_b16 a[52:53], v13 offset:53248
 ds_read_b64_tr_b16 a[54:55], v13 offset:54272
 ds_read_b64_tr_b16 a[56:57], v13 offset:57344
 ds_read_b64_tr_b16 a[58:59], v13 offset:58368
 ds_read_b64_tr_b16 a[60:61], v13 offset:61440
 ds_read_b64_tr_b16 a[62:63], v13 offset:62464
 s_waitcnt lgkmcnt(0)
 s_barrier
 s_add_u32 m0, s45, 32768
 s_add_u32 s43, s44, 3145728
 buffer_load_dwordx4 v12, s[8:11], s43 offen  lds
 s_add_u32 m0, s45, 33792
 s_add_u32 s43, s44, 3178496
 buffer_load_dwordx4 v12, s[8:11], s43 offen  lds
 s_add_u32 m0, s45, 34816
 s_add_u32 s43, s44, 3211264
 buffer_load_dwordx4 v12, s[8:11], s43 offen  lds
 s_add_u32 m0, s45, 35840
 s_add_u32 s43, s44, 3244032
 buffer_load_dwordx4 v12, s[8:11], s43 offen  lds
 s_add_u32 m0, s45, 36864
 s_add_u32 s43, s44, 3276800
 buffer_load_dwordx4 v12, s[8:11], s43 offen  lds
 s_add_u32 m0, s45, 37888
 s_add_u32 s43, s44, 3309568
 buffer_load_dwordx4 v12, s[8:11], s43 offen  lds
 s_add_u32 m0, s45, 38912
 s_add_u32 s43, s44, 3342336
 buffer_load_dwordx4 v12, s[8:11], s43 offen  lds
 s_add_u32 m0, s45, 39936
 s_add_u32 s43, s44, 3375104
 buffer_load_dwordx4 v12, s[8:11], s43 offen  lds
L_rKb_kg2:
 ds_read_b128 v[88:91], v69 offset:4160
 ds_read_b128 v[92:95], v69 offset:4176
 ds_read_b128 v[96:99], v69 offset:4192
 ds_read_b128 v[100:103], v69 offset:4208
 v_add_u32 v69, 256, v69
 s_waitcnt lgkmcnt(3)
 v_pk_mul_f32 v[132:133], v[88:89], v[200:201] op_sel_hi:[1,0]
 v_pk_mul_f32 v[136:137], v[88:89], v[202:203] op_sel_hi:[1,0]
 v_pk_mul_f32 v[140:141], v[88:89], v[204:205] op_sel_hi:[1,0]
 v_pk_mul_f32 v[144:145], v[88:89], v[206:207] op_sel_hi:[1,0]
 v_fract_f32 v133, v133
 v_fract_f32 v137, v137
 v_fract_f32 v141, v141
 v_fract_f32 v145, v145
 v_exp_f32 v132, v132
 v_cos_f32 v134, v133
 v_sin_f32 v135, v133
 v_exp_f32 v136, v136
 v_cos_f32 v138, v137
 v_sin_f32 v139, v137
 v_exp_f32 v140, v140
 v_cos_f32 v142, v141
 v_sin_f32 v143, v141
 v_exp_f32 v144, v144
 v_cos_f32 v146, v145
 v_sin_f32 v147, v145
 v_pk_mul_f32 v[134:135], v[134:135], v[132:133] op_sel_hi:[1,0]
 v_pk_mul_f32 v[138:139], v[138:139], v[136:137] op_sel_hi:[1,0]
 v_pk_mul_f32 v[142:143], v[142:143], v[140:141] op_sel_hi:[1,0]
 v_pk_mul_f32 v[146:147], v[146:147], v[144:145] op_sel_hi:[1,0]
 v_pk_mul_f32 v[144:145], v[146:147], v[90:91] op_sel_hi:[0,1] neg_hi:[0,1]
 v_cvt_pk_bf16_f32 v104, v134, v135
 v_cvt_pk_bf16_f32 v108, v138, v139
 v_cvt_pk_bf16_f32 v112, v142, v143
 v_pk_fma_f32 v[144:145], v[146:147], v[90:91], v[144:145] op_sel:[1,1,0] op_sel_hi:[1,0,1] neg_lo:[0,1,0] neg_hi:[0,1,0]
 v_cvt_pk_bf16_f32 v116, v144, v145
 s_waitcnt lgkmcnt(2)
 v_pk_mul_f32 v[132:133], v[92:93], v[200:201] op_sel_hi:[1,0]
 v_pk_mul_f32 v[136:137], v[92:93], v[202:203] op_sel_hi:[1,0]
 v_pk_mul_f32 v[140:141], v[92:93], v[204:205] op_sel_hi:[1,0]
 v_pk_mul_f32 v[144:145], v[92:93], v[206:207] op_sel_hi:[1,0]
 v_fract_f32 v133, v133
 v_fract_f32 v137, v137
 v_fract_f32 v141, v141
 v_fract_f32 v145, v145
 v_exp_f32 v132, v132
 v_cos_f32 v134, v133
 v_sin_f32 v135, v133
 v_exp_f32 v136, v136
 v_cos_f32 v138, v137
 v_sin_f32 v139, v137
 v_exp_f32 v140, v140
 v_cos_f32 v142, v141
 v_sin_f32 v143, v141
 v_exp_f32 v144, v144
 v_cos_f32 v146, v145
 v_sin_f32 v147, v145
 v_pk_mul_f32 v[134:135], v[134:135], v[132:133] op_sel_hi:[1,0]
 v_pk_mul_f32 v[138:139], v[138:139], v[136:137] op_sel_hi:[1,0]
 v_pk_mul_f32 v[142:143], v[142:143], v[140:141] op_sel_hi:[1,0]
 v_pk_mul_f32 v[146:147], v[146:147], v[144:145] op_sel_hi:[1,0]
 v_pk_mul_f32 v[144:145], v[146:147], v[94:95] op_sel_hi:[0,1] neg_hi:[0,1]
 v_cvt_pk_bf16_f32 v105, v134, v135
 v_cvt_pk_bf16_f32 v109, v138, v139
 v_cvt_pk_bf16_f32 v113, v142, v143
 v_pk_fma_f32 v[144:145], v[146:147], v[94:95], v[144:145] op_sel:[1,1,0] op_sel_hi:[1,0,1] neg_lo:[0,1,0] neg_hi:[0,1,0]
 v_cvt_pk_bf16_f32 v117, v144, v145
 s_waitcnt lgkmcnt(1)
 v_pk_mul_f32 v[132:133], v[96:97], v[200:201] op_sel_hi:[1,0]
 v_pk_mul_f32 v[136:137], v[96:97], v[202:203] op_sel_hi:[1,0]
 v_pk_mul_f32 v[140:141], v[96:97], v[204:205] op_sel_hi:[1,0]
 v_pk_mul_f32 v[144:145], v[96:97], v[206:207] op_sel_hi:[1,0]
 v_fract_f32 v133, v133
 v_fract_f32 v137, v137
 v_fract_f32 v141, v141
 v_fract_f32 v145, v145
 v_exp_f32 v132, v132
 v_cos_f32 v134, v133
 v_sin_f32 v135, v133
 v_exp_f32 v136, v136
 v_cos_f32 v138, v137
 v_sin_f32 v139, v137
 v_exp_f32 v140, v140
 v_cos_f32 v142, v141
 v_sin_f32 v143, v141
 v_exp_f32 v144, v144
 v_cos_f32 v146, v145
 v_sin_f32 v147, v145
 v_pk_mul_f32 v[134:135], v[134:135], v[132:133] op_sel_hi:[1,0]
 v_pk_mul_f32 v[138:139], v[138:139], v[136:137] op_sel_hi:[1,0]
 v_pk_mul_f32 v[142:143], v[142:143], v[140:141] op_sel_hi:[1,0]
 v_pk_mul_f32 v[146:147], v[146:147], v[144:145] op_sel_hi:[1,0]
 v_pk_mul_f32 v[144:145], v[146:147], v[98:99] op_sel_hi:[0,1] neg_hi:[0,1]
 v_cvt_pk_bf16_f32 v106, v134, v135
 v_cvt_pk_bf16_f32 v110, v138, v139
 v_cvt_pk_bf16_f32 v114, v142, v143
 v_pk_fma_f32 v[144:145], v[146:147], v[98:99], v[144:145] op_sel:[1,1,0] op_sel_hi:[1,0,1] neg_lo:[0,1,0] neg_hi:[0,1,0]
 v_cvt_pk_bf16_f32 v118, v144, v145
 s_waitcnt lgkmcnt(0)
 v_pk_mul_f32 v[132:133], v[100:101], v[200:201] op_sel_hi:[1,0]
 v_pk_mul_f32 v[136:137], v[100:101], v[202:203] op_sel_hi:[1,0]
 v_pk_mul_f32 v[140:141], v[100:101], v[204:205] op_sel_hi:[1,0]
 v_pk_mul_f32 v[144:145], v[100:101], v[206:207] op_sel_hi:[1,0]
 v_fract_f32 v133, v133
 v_fract_f32 v137, v137
 v_fract_f32 v141, v141
 v_fract_f32 v145, v145
 v_exp_f32 v132, v132
 v_cos_f32 v134, v133
 v_sin_f32 v135, v133
 v_exp_f32 v136, v136
 v_cos_f32 v138, v137
 v_sin_f32 v139, v137
 v_exp_f32 v140, v140
 v_cos_f32 v142, v141
 v_sin_f32 v143, v141
 v_exp_f32 v144, v144
 v_cos_f32 v146, v145
 v_sin_f32 v147, v145
 v_pk_mul_f32 v[134:135], v[134:135], v[132:133] op_sel_hi:[1,0]
 v_pk_mul_f32 v[138:139], v[138:139], v[136:137] op_sel_hi:[1,0]
 v_pk_mul_f32 v[142:143], v[142:143], v[140:141] op_sel_hi:[1,0]
 v_pk_mul_f32 v[146:147], v[146:147], v[144:145] op_sel_hi:[1,0]
 v_pk_mul_f32 v[144:145], v[146:147], v[102:103] op_sel_hi:[0,1] neg_hi:[0,1]
 v_cvt_pk_bf16_f32 v107, v134, v135
 v_cvt_pk_bf16_f32 v111, v138, v139
 v_cvt_pk_bf16_f32 v115, v142, v143
 v_pk_fma_f32 v[144:145], v[146:147], v[102:103], v[144:145] op_sel:[1,1,0] op_sel_hi:[1,0,1] neg_lo:[0,1,0] neg_hi:[0,1,0]
 v_cvt_pk_bf16_f32 v119, v144, v145
 s_add_u32 s95, s95, 1
 s_cmp_lt_u32 s95, 8
 v_mfma_f32_16x16x32_bf16 v[120:123], v[104:107], v[116:119], v[120:123]
 v_mfma_f32_16x16x32_bf16 v[124:127], v[108:111], v[116:119], v[124:127]
 v_mfma_f32_16x16x32_bf16 v[128:131], v[112:115], v[116:119], v[128:131]
 s_cbranch_scc1 L_rKb_kg2
 s_waitcnt vmcnt(16)
 s_barrier
 ds_read_b64_tr_b16 a[64:65], v13 offset:0
 ds_read_b64_tr_b16 a[66:67], v13 offset:1024
 ds_read_b64_tr_b16 a[68:69], v13 offset:4096
 ds_read_b64_tr_b16 a[70:71], v13 offset:5120
 ds_read_b64_tr_b16 a[72:73], v13 offset:8192
 ds_read_b64_tr_b16 a[74:75], v13 offset:9216
 ds_read_b64_tr_b16 a[76:77], v13 offset:12288
 ds_read_b64_tr_b16 a[78:79], v13 offset:13312
 s_waitcnt lgkmcnt(0)
 ds_read_b64_tr_b16 a[80:81], v13 offset:16384
 ds_read_b64_tr_b16 a[82:83], v13 offset:17408
 ds_read_b64_tr_b16 a[84:85], v13 offset:20480
 ds_read_b64_tr_b16 a[86:87], v13 offset:21504
 ds_read_b64_tr_b16 a[88:89], v13 offset:24576
 ds_read_b64_tr_b16 a[90:91], v13 offset:25600
 ds_read_b64_tr_b16 a[92:93], v13 offset:28672
 ds_read_b64_tr_b16 a[94:95], v13 offset:29696
 s_waitcnt lgkmcnt(0)
 s_barrier
 s_add_u32 m0, s45, 0
 s_add_u32 s43, s44, 4194304
 buffer_load_dwordx4 v12, s[8:11], s43 offen  lds
 s_add_u32 m0, s45, 1024
 s_add_u32 s43, s44, 4227072
 buffer_load_dwordx4 v12, s[8:11], s43 offen  lds
 s_add_u32 m0, s45, 2048
 s_add_u32 s43, s44, 4259840
 buffer_load_dwordx4 v12, s[8:11], s43 offen  lds
 s_add_u32 m0, s45, 3072
 s_add_u32 s43, s44, 4292608
 buffer_load_dwordx4 v12, s[8:11], s43 offen  lds
 s_add_u32 m0, s45, 4096
 s_add_u32 s43, s44, 4325376
 buffer_load_dwordx4 v12, s[8:11], s43 offen  lds
 s_add_u32 m0, s45, 5120
 s_add_u32 s43, s44, 4358144
 buffer_load_dwordx4 v12, s[8:11], s43 offen  lds
 s_add_u32 m0, s45, 6144
 s_add_u32 s43, s44, 4390912
 buffer_load_dwordx4 v12, s[8:11], s43 offen  lds
 s_add_u32 m0, s45, 7168
 s_add_u32 s43, s44, 4423680
 buffer_load_dwordx4 v12, s[8:11], s43 offen  lds
 v_mov_b32 v250, s34
 v_mov_b32 v251, s35
 v_bfrev_b32 v252, 1
 v_cmp_eq_u32 vcc, 64, v0
 s_nop 1
 v_cndmask_b32 v252, v252, 0, vcc
 buffer_atomic_add_x2 v[250:251], v252, s[12:15], s30 offen sc1
 v_lshlrev_b32 v65, 5, v67
 v_lshl_add_u32 v65, v68, 3, v65
 v_add_u32 v65, s94, v65
 v_lshlrev_b32 v66, 4, v67
 v_lshl_add_u32 v66, v68, 3, v66
 v_lshlrev_b32 v69, 3, v67
 v_lshl_add_u32 v69, v68, 7, v69
 v_cmp_gt_u32 vcc, 2, v68
 s_nop 1
 v_cndmask_b32 v66, v69, v66, vcc
 v_add_u32 v66, s94, v66
 v_lshlrev_b32 v69, 2, v67
 v_lshl_add_u32 v69, v68, 7, v69
 v_add_u32 v69, s94, v69
 v_cvt_pk_bf16_f32 v132, v120, v121
 v_cvt_pk_bf16_f32 v133, v122, v123
 v_cvt_pk_bf16_f32 v134, v124, v125
 v_cvt_pk_bf16_f32 v135, v126, v127
 v_cvt_pk_bf16_f32 v136, v128, v129
 v_cvt_pk_bf16_f32 v137, v130, v131
 ds_write_b64 v65, v[132:133]
 ds_write_b64 v66, v[134:135] offset:512
 ds_write_b32 v69, v136 offset:1024
 ds_write_b32 v69, v137 offset:1088
 v_lshrrev_b32 v65, 2, v0
 v_mul_u32_u24 v65, 80, v65
 v_and_b32 v66, 3, v0
 v_lshl_add_u32 v69, v66, 4, v65
 v_add_u32 v69, 82256, v69
 v_add_u32 v215, 43776, v69
 s_waitcnt vmcnt(17)
 v_perm_b32 v140, v74, v72, s96
 v_perm_b32 v141, v78, v76, s96
 v_perm_b32 v142, v82, v80, s96
 v_perm_b32 v143, v86, v84, s96
 ds_write_b128 v69, v[140:143] offset:0
 v_perm_b32 v144, v74, v72, s97
 v_perm_b32 v145, v78, v76, s97
 v_perm_b32 v146, v82, v80, s97
 v_perm_b32 v147, v86, v84, s97
 ds_write_b128 v69, v[144:147] offset:21888
 v_perm_b32 v148, v75, v73, s96
 v_perm_b32 v149, v79, v77, s96
 v_perm_b32 v150, v83, v81, s96
 v_perm_b32 v151, v87, v85, s96
 ds_write_b128 v215, v[148:151] offset:0
 v_perm_b32 v152, v75, v73, s97
 v_perm_b32 v153, v79, v77, s97
 v_perm_b32 v154, v83, v81, s97
 v_perm_b32 v155, v87, v85, s97
 ds_write_b128 v215, v[152:155] offset:21888
 v_lshlrev_b32 v65, 3, v64
 v_sub_u32 v65, 2047, v65
 v_cvt_f32_u32 v66, v65
 s_sub_u32 s92, s94, 34048
 s_waitcnt lgkmcnt(0)
 v_subrev_f32 v120, 0x0, v66
 v_subrev_f32 v121, 0x3f800000, v66
 v_cvt_pk_bf16_f32 v122, v120, v121
 v_and_b32 v120, 0xffff, v122
 v_lshrrev_b32 v121, 16, v122
 v_lshl_add_u32 v132, v120, 1, s92
 v_lshl_add_u32 v133, v121, 1, s92
 v_subrev_f32 v120, 0x40000000, v66
 v_subrev_f32 v121, 0x40400000, v66
 v_cvt_pk_bf16_f32 v122, v120, v121
 v_and_b32 v120, 0xffff, v122
 v_lshrrev_b32 v121, 16, v122
 v_lshl_add_u32 v134, v120, 1, s92
 v_lshl_add_u32 v135, v121, 1, s92
 v_subrev_f32 v120, 0x40800000, v66
 v_subrev_f32 v121, 0x40a00000, v66
 v_cvt_pk_bf16_f32 v122, v120, v121
 v_and_b32 v120, 0xffff, v122
 v_lshrrev_b32 v121, 16, v122
 v_lshl_add_u32 v136, v120, 1, s92
 v_lshl_add_u32 v137, v121, 1, s92
 v_subrev_f32 v120, 0x40c00000, v66
 v_subrev_f32 v121, 0x40e00000, v66
 v_cvt_pk_bf16_f32 v122, v120, v121
 v_and_b32 v120, 0xffff, v122
 v_lshrrev_b32 v121, 16, v122
 v_lshl_add_u32 v138, v120, 1, s92
 v_lshl_add_u32 v139, v121, 1, s92
 s_waitcnt lgkmcnt(0)
 ds_read_u16 v88, v132
 ds_read_u16 v92, v133
 ds_read_u16 v89, v134
 ds_read_u16 v93, v135
 ds_read_u16 v90, v136
 ds_read_u16 v94, v137
 ds_read_u16 v91, v138
 ds_read_u16 v95, v139
 v_subrev_f32 v120, 0x44000000, v66
 v_subrev_f32 v121, 0x44004000, v66
 v_cvt_pk_bf16_f32 v122, v120, v121
 v_and_b32 v120, 0xffff, v122
 v_lshrrev_b32 v121, 16, v122
 v_lshl_add_u32 v132, v120, 1, s92
 v_lshl_add_u32 v133, v121, 1, s92
 v_subrev_f32 v120, 0x44008000, v66
 v_subrev_f32 v121, 0x4400c000, v66
 v_cvt_pk_bf16_f32 v122, v120, v121
 v_and_b32 v120, 0xffff, v122
 v_lshrrev_b32 v121, 16, v122
 v_lshl_add_u32 v134, v120, 1, s92
 v_lshl_add_u32 v135, v121, 1, s92
 v_subrev_f32 v120, 0x44010000, v66
 v_subrev_f32 v121, 0x44014000, v66
 v_cvt_pk_bf16_f32 v122, v120, v121
 v_and_b32 v120, 0xffff, v122
 v_lshrrev_b32 v121, 16, v122
 v_lshl_add_u32 v136, v120, 1, s92
 v_lshl_add_u32 v137, v121, 1, s92
 v_subrev_f32 v120, 0x44018000, v66
 v_subrev_f32 v121, 0x4401c000, v66
 v_cvt_pk_bf16_f32 v122, v120, v121
 v_and_b32 v120, 0xffff, v122
 v_lshrrev_b32 v121, 16, v122
 v_lshl_add_u32 v138, v120, 1, s92
 v_lshl_add_u32 v139, v121, 1, s92
 s_waitcnt lgkmcnt(0)
 ds_read_u16 v96, v132
 ds_read_u16 v100, v133
 ds_read_u16 v97, v134
 ds_read_u16 v101, v135
 ds_read_u16 v98, v136
 ds_read_u16 v102, v137
 ds_read_u16 v99, v138
 ds_read_u16 v103, v139
 v_subrev_f32 v120, 0x44800000, v66
 v_subrev_f32 v121, 0x44802000, v66
 v_cvt_pk_bf16_f32 v122, v120, v121
 v_and_b32 v120, 0xffff, v122
 v_lshrrev_b32 v121, 16, v122
 v_lshl_add_u32 v132, v120, 1, s92
 v_lshl_add_u32 v133, v121, 1, s92
 v_subrev_f32 v120, 0x44804000, v66
 v_subrev_f32 v121, 0x44806000, v66
 v_cvt_pk_bf16_f32 v122, v120, v121
 v_and_b32 v120, 0xffff, v122
 v_lshrrev_b32 v121, 16, v122
 v_lshl_add_u32 v134, v120, 1, s92
 v_lshl_add_u32 v135, v121, 1, s92
 v_subrev_f32 v120, 0x44808000, v66
 v_subrev_f32 v121, 0x4480a000, v66
 v_cvt_pk_bf16_f32 v122, v120, v121
 v_and_b32 v120, 0xffff, v122
 v_lshrrev_b32 v121, 16, v122
 v_lshl_add_u32 v136, v120, 1, s92
 v_lshl_add_u32 v137, v121, 1, s92
 v_subrev_f32 v120, 0x4480c000, v66
 v_subrev_f32 v121, 0x4480e000, v66
 v_cvt_pk_bf16_f32 v122, v120, v121
 v_and_b32 v120, 0xffff, v122
 v_lshrrev_b32 v121, 16, v122
 v_lshl_add_u32 v138, v120, 1, s92
 v_lshl_add_u32 v139, v121, 1, s92
 s_waitcnt lgkmcnt(0)
 ds_read_u16 v104, v132
 ds_read_u16 v108, v133
 ds_read_u16 v105, v134
 ds_read_u16 v109, v135
 ds_read_u16 v106, v136
 ds_read_u16 v110, v137
 ds_read_u16 v107, v138
 ds_read_u16 v111, v139
 v_subrev_f32 v120, 0x44c00000, v66
 v_subrev_f32 v121, 0x44c02000, v66
 v_cvt_pk_bf16_f32 v122, v120, v121
 v_and_b32 v120, 0xffff, v122
 v_lshrrev_b32 v121, 16, v122
 v_subrev_u32 v122, 1536, v65
 v_min_u32 v122, 128, v122
 v_add_u32 v122, 17024, v122
 v_max_u32 v120, v120, v122
 v_subrev_u32 v122, 1537, v65
 v_min_u32 v122, 128, v122
 v_add_u32 v122, 17024, v122
 v_max_u32 v121, v121, v122
 v_lshl_add_u32 v132, v120, 1, s92
 v_lshl_add_u32 v133, v121, 1, s92
 v_subrev_f32 v120, 0x44c04000, v66
 v_subrev_f32 v121, 0x44c06000, v66
 v_cvt_pk_bf16_f32 v122, v120, v121
 v_and_b32 v120, 0xffff, v122
 v_lshrrev_b32 v121, 16, v122
 v_subrev_u32 v122, 1538, v65
 v_min_u32 v122, 128, v122
 v_add_u32 v122, 17024, v122
 v_max_u32 v120, v120, v122
 v_subrev_u32 v122, 1539, v65
 v_min_u32 v122, 128, v122
 v_add_u32 v122, 17024, v122
 v_max_u32 v121, v121, v122
 v_lshl_add_u32 v134, v120, 1, s92
 v_lshl_add_u32 v135, v121, 1, s92
 v_subrev_f32 v120, 0x44c08000, v66
 v_subrev_f32 v121, 0x44c0a000, v66
 v_cvt_pk_bf16_f32 v122, v120, v121
 v_and_b32 v120, 0xffff, v122
 v_lshrrev_b32 v121, 16, v122
 v_subrev_u32 v122, 1540, v65
 v_min_u32 v122, 128, v122
 v_add_u32 v122, 17024, v122
 v_max_u32 v120, v120, v122
 v_subrev_u32 v122, 1541, v65
 v_min_u32 v122, 128, v122
 v_add_u32 v122, 17024, v122
 v_max_u32 v121, v121, v122
 v_lshl_add_u32 v136, v120, 1, s92
 v_lshl_add_u32 v137, v121, 1, s92
 v_subrev_f32 v120, 0x44c0c000, v66
 v_subrev_f32 v121, 0x44c0e000, v66
 v_cvt_pk_bf16_f32 v122, v120, v121
 v_and_b32 v120, 0xffff, v122
 v_lshrrev_b32 v121, 16, v122
 v_subrev_u32 v122, 1542, v65
 v_min_u32 v122, 128, v122
 v_add_u32 v122, 17024, v122
 v_max_u32 v120, v120, v122
 v_subrev_u32 v122, 1543, v65
 v_min_u32 v122, 128, v122
 v_add_u32 v122, 17024, v122
 v_max_u32 v121, v121, v122
 v_lshl_add_u32 v138, v120, 1, s92
 v_lshl_add_u32 v139, v121, 1, s92
 s_waitcnt lgkmcnt(0)
 ds_read_u16 v112, v132
 ds_read_u16 v116, v133
 ds_read_u16 v113, v134
 ds_read_u16 v117, v135
 ds_read_u16 v114, v136
 ds_read_u16 v118, v137
 ds_read_u16 v115, v138
 ds_read_u16 v119, v139
 v_lshl_add_u32 v65, v64, 4, s94
 v_mov_b32 v120, 0
 v_mov_b32 v121, 0
 v_mov_b32 v122, 0
 v_mov_b32 v123, 0
 v_lshrrev_b32 v66, 2, v64
 v_mul_u32_u24 v66, 4096, v66
 v_add_u32 v66, 4096, v66
 v_cmp_gt_u32 vcc, 16, v64
 v_mov_b32 v67, 16384
 s_nop 0
 v_cndmask_b32 v66, v67, v66, vcc
 v_add_u32 v66, v66, v65
 s_waitcnt lgkmcnt(0)
 s_mov_b64 exec, 0x1fffff
 ds_write_b128 v66, v[120:123]
 s_mov_b64 exec, -1
 v_lshl_or_b32 v88, v92, 16, v88
 v_lshl_or_b32 v89, v93, 16, v89
 v_lshl_or_b32 v90, v94, 16, v90
 v_lshl_or_b32 v91, v95, 16, v91
 ds_write_b128 v65, v[88:91] offset:12480
 v_lshl_or_b32 v96, v100, 16, v96
 v_lshl_or_b32 v97, v101, 16, v97
 v_lshl_or_b32 v98, v102, 16, v98
 v_lshl_or_b32 v99, v103, 16, v99
 ds_write_b128 v65, v[96:99] offset:13504
 v_lshl_or_b32 v104, v108, 16, v104
 v_lshl_or_b32 v105, v109, 16, v105
 v_lshl_or_b32 v106, v110, 16, v106
 v_lshl_or_b32 v107, v111, 16, v107
 ds_write_b128 v65, v[104:107] offset:14528
 v_lshl_or_b32 v112, v116, 16, v112
 v_lshl_or_b32 v113, v117, 16, v113
 v_lshl_or_b32 v114, v118, 16, v114
 v_lshl_or_b32 v115, v119, 16, v115
 ds_write_b128 v65, v[112:115] offset:15552
 s_waitcnt lgkmcnt(0)
 ds_read_b64 v[92:93], v65 offset:12496
 ds_read_b64 v[100:101], v65 offset:13520
 ds_read_b64 v[108:109], v65 offset:14544
 ds_read_b64 v[116:117], v65 offset:15568
 s_waitcnt lgkmcnt(0)
 v_alignbit_b32 v132, v89, v88, 16
 v_mov_b32 v136, v89
 v_alignbit_b32 v140, v90, v89, 16
 v_alignbit_b32 v133, v90, v89, 16
 v_mov_b32 v137, v90
 v_alignbit_b32 v141, v91, v90, 16
 v_alignbit_b32 v134, v91, v90, 16
 v_mov_b32 v138, v91
 v_alignbit_b32 v142, v92, v91, 16
 v_alignbit_b32 v135, v92, v91, 16
 v_mov_b32 v139, v92
 v_alignbit_b32 v143, v93, v92, 16
 ds_write_b128 v65, v[132:135] offset:8320
 ds_write_b128 v65, v[136:139] offset:4160
 ds_write_b128 v65, v[140:143] offset:0
 v_alignbit_b32 v144, v97, v96, 16
 v_mov_b32 v148, v97
 v_alignbit_b32 v152, v98, v97, 16
 v_alignbit_b32 v145, v98, v97, 16
 v_mov_b32 v149, v98
 v_alignbit_b32 v153, v99, v98, 16
 v_alignbit_b32 v146, v99, v98, 16
 v_mov_b32 v150, v99
 v_alignbit_b32 v154, v100, v99, 16
 v_alignbit_b32 v147, v100, v99, 16
 v_mov_b32 v151, v100
 v_alignbit_b32 v155, v101, v100, 16
 ds_write_b128 v65, v[144:147] offset:9344
 ds_write_b128 v65, v[148:151] offset:5184
 ds_write_b128 v65, v[152:155] offset:1024
 v_alignbit_b32 v132, v105, v104, 16
 v_mov_b32 v136, v105
 v_alignbit_b32 v140, v106, v105, 16
 v_alignbit_b32 v133, v106, v105, 16
 v_mov_b32 v137, v106
 v_alignbit_b32 v141, v107, v106, 16
 v_alignbit_b32 v134, v107, v106, 16
 v_mov_b32 v138, v107
 v_alignbit_b32 v142, v108, v107, 16
 v_alignbit_b32 v135, v108, v107, 16
 v_mov_b32 v139, v108
 v_alignbit_b32 v143, v109, v108, 16
 ds_write_b128 v65, v[132:135] offset:10368
 ds_write_b128 v65, v[136:139] offset:6208
 ds_write_b128 v65, v[140:143] offset:2048
 v_alignbit_b32 v144, v113, v112, 16
 v_mov_b32 v148, v113
 v_alignbit_b32 v152, v114, v113, 16
 v_alignbit_b32 v145, v114, v113, 16
 v_mov_b32 v149, v114
 v_alignbit_b32 v153, v115, v114, 16
 v_alignbit_b32 v146, v115, v114, 16
 v_mov_b32 v150, v115
 v_alignbit_b32 v154, v116, v115, 16
 v_alignbit_b32 v147, v116, v115, 16
 v_mov_b32 v151, v116
 v_alignbit_b32 v155, v117, v116, 16
 ds_write_b128 v65, v[144:147] offset:11392
 ds_write_b128 v65, v[148:151] offset:7232
 ds_write_b128 v65, v[152:155] offset:3072
 v_and_b32 v66, 3, v64
 v_mul_u32_u24 v65, 4160, v66
 v_bfe_u32 v66, v64, 3, 1
 v_bfe_u32 v67, v64, 2, 1
 v_lshl_add_u32 v66, v67, 1, v66
 v_bfe_u32 v67, v64, 4, 1
 v_lshl_add_u32 v66, v67, 2, v66
 v_lshlrev_b32 v66, 3, v66
 v_sub_u32 v65, v65, v66
 v_lshrrev_b32 v67, 5, v64
 v_lshl_add_u32 v65, v67, 4, v65
 s_add_u32 s92, s94, 2040
 v_add_u32 v65, s92, v65
 v_and_b32 v66, 31, v64
 v_mul_u32_u24 v66, 80, v66
 v_lshl_add_u32 v67, v67, 4, v66
 s_add_u32 s92, s94, 16720
 v_add_u32 v67, s92, v67
 v_mov_b32 v214, v67
 v_mov_b32 v68, v67
 s_sub_u32 s93, s92, 80
 v_mov_b32 v88, 0
 v_mov_b32 v89, 0
 v_mov_b32 v90, 0
 v_mov_b32 v91, 0
 v_mov_b32 v92, 0
 v_mov_b32 v93, 0
 v_mov_b32 v94, 0
 v_mov_b32 v95, 0
 v_mov_b32 v96, 0
 v_mov_b32 v97, 0
 v_mov_b32 v98, 0
 v_mov_b32 v99, 0
 v_mov_b32 v100, 0
 v_mov_b32 v101, 0
 v_mov_b32 v102, 0
 v_mov_b32 v103, 0
 v_mov_b32 v104, 0
 v_mov_b32 v105, 0
 v_mov_b32 v106, 0
 v_mov_b32 v107, 0
 v_mov_b32 v108, 0
 v_mov_b32 v109, 0
 v_mov_b32 v110, 0
 v_mov_b32 v111, 0
 v_mov_b32 v112, 0
 v_mov_b32 v113, 0
 v_mov_b32 v114, 0
 v_mov_b32 v115, 0
 v_mov_b32 v116, 0
 v_mov_b32 v117, 0
 v_mov_b32 v118, 0
 v_mov_b32 v119, 0
 s_waitcnt lgkmcnt(0)
 s_barrier
 s_waitcnt vmcnt(9)
 s_barrier
 ds_read_b64_tr_b16 a[96:97], v13 offset:32768
 ds_read_b64_tr_b16 a[98:99], v13 offset:33792
 ds_read_b64_tr_b16 a[100:101], v13 offset:36864
 ds_read_b64_tr_b16 a[102:103], v13 offset:37888
 ds_read_b64_tr_b16 a[104:105], v13 offset:40960
 ds_read_b64_tr_b16 a[106:107], v13 offset:41984
 ds_read_b64_tr_b16 a[108:109], v13 offset:45056
 ds_read_b64_tr_b16 a[110:111], v13 offset:46080
 s_waitcnt lgkmcnt(0)
 ds_read_b64_tr_b16 a[112:113], v13 offset:49152
 ds_read_b64_tr_b16 a[114:115], v13 offset:50176
 ds_read_b64_tr_b16 a[116:117], v13 offset:53248
 ds_read_b64_tr_b16 a[118:119], v13 offset:54272
 ds_read_b64_tr_b16 a[120:121], v13 offset:57344
 ds_read_b64_tr_b16 a[122:123], v13 offset:58368
 ds_read_b64_tr_b16 a[124:125], v13 offset:61440
 ds_read_b64_tr_b16 a[126:127], v13 offset:62464
 s_waitcnt lgkmcnt(0)
 s_barrier
 s_add_u32 m0, s45, 32768
 s_add_u32 s43, s44, 5242880
 buffer_load_dwordx4 v12, s[8:11], s43 offen  lds
 s_add_u32 m0, s45, 33792
 s_add_u32 s43, s44, 5275648
 buffer_load_dwordx4 v12, s[8:11], s43 offen  lds
 s_add_u32 m0, s45, 34816
 s_add_u32 s43, s44, 5308416
 buffer_load_dwordx4 v12, s[8:11], s43 offen  lds
 s_add_u32 m0, s45, 35840
 s_add_u32 s43, s44, 5341184
 buffer_load_dwordx4 v12, s[8:11], s43 offen  lds
 s_add_u32 m0, s45, 36864
 s_add_u32 s43, s44, 5373952
 buffer_load_dwordx4 v12, s[8:11], s43 offen  lds
 s_add_u32 m0, s45, 37888
 s_add_u32 s43, s44, 5406720
 buffer_load_dwordx4 v12, s[8:11], s43 offen  lds
 s_add_u32 m0, s45, 38912
 s_add_u32 s43, s44, 5439488
 buffer_load_dwordx4 v12, s[8:11], s43 offen  lds
 s_add_u32 m0, s45, 39936
 s_add_u32 s43, s44, 5472256
 buffer_load_dwordx4 v12, s[8:11], s43 offen  lds
 ds_read_b64 v[120:121], v65 offset:2080
 ds_read_b64 v[122:123], v65 offset:2088
 ds_read_b128 v[128:131], v67 offset:2592
 ds_read_b128 v[132:135], v68 offset:32
 ds_read_b64 v[124:125], v65 offset:32
 ds_read_b64 v[126:127], v65 offset:40
 s_mov_b32 s95, 0
L_rKb_cv0:
 ds_read_b64 v[136:137], v65 offset:2048
 ds_read_b64 v[138:139], v65 offset:2056
 ds_read_b128 v[144:147], v67 offset:2560
 ds_read_b128 v[148:151], v68 offset:0
 ds_read_b64 v[140:141], v65 offset:0
 ds_read_b64 v[142:143], v65 offset:8
 s_waitcnt lgkmcnt(6)
 v_mfma_f32_32x32x16_bf16 v[104:119], v[120:123], v[128:131], v[104:119]
 v_subrev_u32 v65, 64, v65
 v_subrev_u32 v67, 80, v67
 v_max_i32 v68, s93, v67
 v_mfma_f32_32x32x16_bf16 v[88:103], v[120:123], v[132:135], v[88:103]
 v_mfma_f32_32x32x16_bf16 v[104:119], v[124:127], v[132:135], v[104:119]
 ds_read_b64 v[120:121], v65 offset:2080
 ds_read_b64 v[122:123], v65 offset:2088
 ds_read_b128 v[128:131], v67 offset:2592
 ds_read_b128 v[132:135], v68 offset:32
 ds_read_b64 v[124:125], v65 offset:32
 ds_read_b64 v[126:127], v65 offset:40
 s_waitcnt lgkmcnt(6)
 v_mfma_f32_32x32x16_bf16 v[104:119], v[136:139], v[144:147], v[104:119]
 s_add_u32 s95, s95, 1
 s_cmp_lt_u32 s95, 8
 v_mfma_f32_32x32x16_bf16 v[88:103], v[136:139], v[148:151], v[88:103]
 v_mfma_f32_32x32x16_bf16 v[104:119], v[140:143], v[148:151], v[104:119]
 s_cbranch_scc1 L_rKb_cv0
 s_waitcnt vmcnt(9)
 s_barrier
 ds_read_b64_tr_b16 a[128:129], v13 offset:0
 ds_read_b64_tr_b16 a[130:131], v13 offset:1024
 ds_read_b64_tr_b16 a[132:133], v13 offset:4096
 ds_read_b64_tr_b16 a[134:135], v13 offset:5120
 ds_read_b64_tr_b16 a[136:137], v13 offset:8192
 ds_read_b64_tr_b16 a[138:139], v13 offset:9216
 ds_read_b64_tr_b16 a[140:141], v13 offset:12288
 ds_read_b64_tr_b16 a[142:143], v13 offset:13312
 s_waitcnt lgkmcnt(0)
 ds_read_b64_tr_b16 a[144:145], v13 offset:16384
 ds_read_b64_tr_b16 a[146:147], v13 offset:17408
 ds_read_b64_tr_b16 a[148:149], v13 offset:20480
 ds_read_b64_tr_b16 a[150:151], v13 offset:21504
 ds_read_b64_tr_b16 a[152:153], v13 offset:24576
 ds_read_b64_tr_b16 a[154:155], v13 offset:25600
 ds_read_b64_tr_b16 a[156:157], v13 offset:28672
 ds_read_b64_tr_b16 a[158:159], v13 offset:29696
 s_waitcnt lgkmcnt(0)
 s_barrier
 s_add_u32 m0, s45, 0
 s_add_u32 s43, s44, 6291456
 buffer_load_dwordx4 v12, s[8:11], s43 offen  lds
 s_add_u32 m0, s45, 1024
 s_add_u32 s43, s44, 6324224
 buffer_load_dwordx4 v12, s[8:11], s43 offen  lds
 s_add_u32 m0, s45, 2048
 s_add_u32 s43, s44, 6356992
 buffer_load_dwordx4 v12, s[8:11], s43 offen  lds
 s_add_u32 m0, s45, 3072
 s_add_u32 s43, s44, 6389760
 buffer_load_dwordx4 v12, s[8:11], s43 offen  lds
 s_add_u32 m0, s45, 4096
 s_add_u32 s43, s44, 6422528
 buffer_load_dwordx4 v12, s[8:11], s43 offen  lds
 s_add_u32 m0, s45, 5120
 s_add_u32 s43, s44, 6455296
 buffer_load_dwordx4 v12, s[8:11], s43 offen  lds
 s_add_u32 m0, s45, 6144
 s_add_u32 s43, s44, 6488064
 buffer_load_dwordx4 v12, s[8:11], s43 offen  lds
 s_add_u32 m0, s45, 7168
 s_add_u32 s43, s44, 6520832
 buffer_load_dwordx4 v12, s[8:11], s43 offen  lds
 s_mov_b32 s95, 0
L_rKb_cv1:
 ds_read_b64 v[136:137], v65 offset:2048
 ds_read_b64 v[138:139], v65 offset:2056
 ds_read_b128 v[144:147], v67 offset:2560
 ds_read_b128 v[148:151], v68 offset:0
 ds_read_b64 v[140:141], v65 offset:0
 ds_read_b64 v[142:143], v65 offset:8
 s_waitcnt lgkmcnt(6)
 v_mfma_f32_32x32x16_bf16 v[104:119], v[120:123], v[128:131], v[104:119]
 v_subrev_u32 v65, 64, v65
 v_subrev_u32 v67, 80, v67
 v_max_i32 v68, s93, v67
 v_mfma_f32_32x32x16_bf16 v[88:103], v[120:123], v[132:135], v[88:103]
 v_mfma_f32_32x32x16_bf16 v[104:119], v[124:127], v[132:135], v[104:119]
 ds_read_b64 v[120:121], v65 offset:2080
 ds_read_b64 v[122:123], v65 offset:2088
 ds_read_b128 v[128:131], v67 offset:2592
 ds_read_b128 v[132:135], v68 offset:32
 ds_read_b64 v[124:125], v65 offset:32
 ds_read_b64 v[126:127], v65 offset:40
 s_waitcnt lgkmcnt(6)
 v_mfma_f32_32x32x16_bf16 v[104:119], v[136:139], v[144:147], v[104:119]
 s_add_u32 s95, s95, 1
 s_cmp_lt_u32 s95, 8
 v_mfma_f32_32x32x16_bf16 v[88:103], v[136:139], v[148:151], v[88:103]
 v_mfma_f32_32x32x16_bf16 v[104:119], v[140:143], v[148:151], v[104:119]
 s_cbranch_scc1 L_rKb_cv1
 s_waitcnt vmcnt(8)
 s_barrier
 ds_read_b64_tr_b16 a[160:161], v13 offset:32768
 ds_read_b64_tr_b16 a[162:163], v13 offset:33792
 ds_read_b64_tr_b16 a[164:165], v13 offset:36864
 ds_read_b64_tr_b16 a[166:167], v13 offset:37888
 ds_read_b64_tr_b16 a[168:169], v13 offset:40960
 ds_read_b64_tr_b16 a[170:171], v13 offset:41984
 ds_read_b64_tr_b16 a[172:173], v13 offset:45056
 ds_read_b64_tr_b16 a[174:175], v13 offset:46080
 s_waitcnt lgkmcnt(0)
 ds_read_b64_tr_b16 a[176:177], v13 offset:49152
 ds_read_b64_tr_b16 a[178:179], v13 offset:50176
 ds_read_b64_tr_b16 a[180:181], v13 offset:53248
 ds_read_b64_tr_b16 a[182:183], v13 offset:54272
 ds_read_b64_tr_b16 a[184:185], v13 offset:57344
 ds_read_b64_tr_b16 a[186:187], v13 offset:58368
 ds_read_b64_tr_b16 a[188:189], v13 offset:61440
 ds_read_b64_tr_b16 a[190:191], v13 offset:62464
 s_waitcnt lgkmcnt(0)
 s_barrier
 s_add_u32 m0, s45, 32768
 s_add_u32 s43, s44, 7340032
 buffer_load_dwordx4 v12, s[8:11], s43 offen  lds
 s_add_u32 m0, s45, 33792
 s_add_u32 s43, s44, 7372800
 buffer_load_dwordx4 v12, s[8:11], s43 offen  lds
 s_add_u32 m0, s45, 34816
 s_add_u32 s43, s44, 7405568
 buffer_load_dwordx4 v12, s[8:11], s43 offen  lds
 s_add_u32 m0, s45, 35840
 s_add_u32 s43, s44, 7438336
 buffer_load_dwordx4 v12, s[8:11], s43 offen  lds
 s_add_u32 m0, s45, 36864
 s_add_u32 s43, s44, 7471104
 buffer_load_dwordx4 v12, s[8:11], s43 offen  lds
 s_add_u32 m0, s45, 37888
 s_add_u32 s43, s44, 7503872
 buffer_load_dwordx4 v12, s[8:11], s43 offen  lds
 s_add_u32 m0, s45, 38912
 s_add_u32 s43, s44, 7536640
 buffer_load_dwordx4 v12, s[8:11], s43 offen  lds
 s_add_u32 m0, s45, 39936
 s_add_u32 s43, s44, 7569408
 buffer_load_dwordx4 v12, s[8:11], s43 offen  lds
 s_mov_b32 s95, 0
L_rKb_cv2:
 ds_read_b64 v[136:137], v65 offset:2048
 ds_read_b64 v[138:139], v65 offset:2056
 ds_read_b128 v[144:147], v67 offset:2560
 ds_read_b128 v[148:151], v68 offset:0
 ds_read_b64 v[140:141], v65 offset:0
 ds_read_b64 v[142:143], v65 offset:8
 s_waitcnt lgkmcnt(6)
 v_mfma_f32_32x32x16_bf16 v[104:119], v[120:123], v[128:131], v[104:119]
 v_subrev_u32 v65, 64, v65
 v_subrev_u32 v67, 80, v67
 v_max_i32 v68, s93, v67
 v_mfma_f32_32x32x16_bf16 v[88:103], v[120:123], v[132:135], v[88:103]
 v_mfma_f32_32x32x16_bf16 v[104:119], v[124:127], v[132:135], v[104:119]
 ds_read_b64 v[120:121], v65 offset:2080
 ds_read_b64 v[122:123], v65 offset:2088
 ds_read_b128 v[128:131], v67 offset:2592
 ds_read_b128 v[132:135], v68 offset:32
 ds_read_b64 v[124:125], v65 offset:32
 ds_read_b64 v[126:127], v65 offset:40
 s_waitcnt lgkmcnt(6)
 v_mfma_f32_32x32x16_bf16 v[104:119], v[136:139], v[144:147], v[104:119]
 s_add_u32 s95, s95, 1
 s_cmp_lt_u32 s95, 8
 v_mfma_f32_32x32x16_bf16 v[88:103], v[136:139], v[148:151], v[88:103]
 v_mfma_f32_32x32x16_bf16 v[104:119], v[140:143], v[148:151], v[104:119]
 s_cbranch_scc1 L_rKb_cv2
 s_waitcnt vmcnt(8)
 s_barrier
 ds_read_b64_tr_b16 a[192:193], v13 offset:0
 ds_read_b64_tr_b16 a[194:195], v13 offset:1024
 ds_read_b64_tr_b16 a[196:197], v13 offset:4096
 ds_read_b64_tr_b16 a[198:199], v13 offset:5120
 ds_read_b64_tr_b16 a[200:201], v13 offset:8192
 ds_read_b64_tr_b16 a[202:203], v13 offset:9216
 ds_read_b64_tr_b16 a[204:205], v13 offset:12288
 ds_read_b64_tr_b16 a[206:207], v13 offset:13312
 s_waitcnt lgkmcnt(0)
 ds_read_b64_tr_b16 a[208:209], v13 offset:16384
 ds_read_b64_tr_b16 a[210:211], v13 offset:17408
 ds_read_b64_tr_b16 a[212:213], v13 offset:20480
 ds_read_b64_tr_b16 a[214:215], v13 offset:21504
 ds_read_b64_tr_b16 a[216:217], v13 offset:24576
 ds_read_b64_tr_b16 a[218:219], v13 offset:25600
 ds_read_b64_tr_b16 a[220:221], v13 offset:28672
 ds_read_b64_tr_b16 a[222:223], v13 offset:29696
 s_waitcnt lgkmcnt(0)
 s_mov_b32 s95, 0
L_rKb_cv3:
 ds_read_b64 v[136:137], v65 offset:2048
 ds_read_b64 v[138:139], v65 offset:2056
 ds_read_b128 v[144:147], v67 offset:2560
 ds_read_b128 v[148:151], v68 offset:0
 ds_read_b64 v[140:141], v65 offset:0
 ds_read_b64 v[142:143], v65 offset:8
 s_waitcnt lgkmcnt(6)
 v_mfma_f32_32x32x16_bf16 v[104:119], v[120:123], v[128:131], v[104:119]
 v_subrev_u32 v65, 64, v65
 v_subrev_u32 v67, 80, v67
 v_max_i32 v68, s93, v67
 v_mfma_f32_32x32x16_bf16 v[88:103], v[120:123], v[132:135], v[88:103]
 v_mfma_f32_32x32x16_bf16 v[104:119], v[124:127], v[132:135], v[104:119]
 ds_read_b64 v[120:121], v65 offset:2080
 ds_read_b64 v[122:123], v65 offset:2088
 ds_read_b128 v[128:131], v67 offset:2592
 ds_read_b128 v[132:135], v68 offset:32
 ds_read_b64 v[124:125], v65 offset:32
 ds_read_b64 v[126:127], v65 offset:40
 s_waitcnt lgkmcnt(6)
 v_mfma_f32_32x32x16_bf16 v[104:119], v[136:139], v[144:147], v[104:119]
 s_add_u32 s95, s95, 1
 s_cmp_lt_u32 s95, 8
 v_mfma_f32_32x32x16_bf16 v[88:103], v[136:139], v[148:151], v[88:103]
 v_mfma_f32_32x32x16_bf16 v[104:119], v[140:143], v[148:151], v[104:119]
 s_cbranch_scc1 L_rKb_cv3
 s_waitcnt vmcnt(0)
 s_barrier
 ds_read_b64_tr_b16 a[224:225], v13 offset:32768
 ds_read_b64_tr_b16 a[226:227], v13 offset:33792
 ds_read_b64_tr_b16 a[228:229], v13 offset:36864
 ds_read_b64_tr_b16 a[230:231], v13 offset:37888
 ds_read_b64_tr_b16 a[232:233], v13 offset:40960
 ds_read_b64_tr_b16 a[234:235], v13 offset:41984
 ds_read_b64_tr_b16 a[236:237], v13 offset:45056
 ds_read_b64_tr_b16 a[238:239], v13 offset:46080
 s_waitcnt lgkmcnt(0)
 ds_read_b64_tr_b16 a[240:241], v13 offset:49152
 ds_read_b64_tr_b16 a[242:243], v13 offset:50176
 ds_read_b64_tr_b16 a[244:245], v13 offset:53248
 ds_read_b64_tr_b16 a[246:247], v13 offset:54272
 ds_read_b64_tr_b16 a[248:249], v13 offset:57344
 ds_read_b64_tr_b16 a[250:251], v13 offset:58368
 ds_read_b64_tr_b16 a[252:253], v13 offset:61440
 ds_read_b64_tr_b16 a[254:255], v13 offset:62464
 s_waitcnt lgkmcnt(0)
 s_load_dwordx2 s[84:85], s[0:1], 128
 s_mov_b32 s86, 8388608
 s_mov_b32 s87, 0x20000
 s_lshl_b32 s90, s89, 16
 s_and_b32 s91, s89, s98
 s_and_b32 s89, s88, s98
 s_lshl_b32 s88, s88, 16
 v_lshlrev_b32 v70, 1, v70
 s_lshl_b32 s93, s28, 3
 s_add_u32 s93, s93, 2048
 s_waitcnt lgkmcnt(0)
 s_nop 1
 v_cvt_pk_bf16_f32 v152, v88, v89
 v_cvt_pk_bf16_f32 v153, v90, v91
 v_cvt_pk_bf16_f32 v154, v92, v93
 v_cvt_pk_bf16_f32 v155, v94, v95
 v_cvt_pk_bf16_f32 v156, v96, v97
 v_cvt_pk_bf16_f32 v157, v98, v99
 v_cvt_pk_bf16_f32 v158, v100, v101
 v_cvt_pk_bf16_f32 v159, v102, v103
 ds_write_b128 v214, v[152:155] offset:0
 ds_write_b128 v214, v[156:159] offset:32
 v_cvt_pk_bf16_f32 v160, v104, v105
 v_cvt_pk_bf16_f32 v161, v106, v107
 v_cvt_pk_bf16_f32 v162, v108, v109
 v_cvt_pk_bf16_f32 v163, v110, v111
 v_cvt_pk_bf16_f32 v164, v112, v113
 v_cvt_pk_bf16_f32 v165, v114, v115
 v_cvt_pk_bf16_f32 v166, v116, v117
 v_cvt_pk_bf16_f32 v167, v118, v119
 ds_write_b128 v214, v[160:163] offset:2560
 ds_write_b128 v214, v[164:167] offset:2592
 s_waitcnt lgkmcnt(0)
 s_barrier
 ds_read_b128 v[88:91], v69 offset:0
 ds_read_b128 v[92:95], v69 offset:21888
 ds_read_b128 v[96:99], v215 offset:0
 ds_read_b128 v[100:103], v215 offset:21888
 v_lshlrev_b32 v104, 16, v72
 v_and_b32 v105, s98, v72
 v_pk_mul_f32 v[104:105], v[104:105], s[88:89]
 v_cvt_pk_bf16_f32 v72, v104, v105
 v_lshlrev_b32 v104, 16, v72
 v_and_b32 v105, s98, v72
 v_lshlrev_b32 v106, 16, v73
 v_and_b32 v107, s98, v73
 v_pk_mul_f32 v[106:107], v[106:107], s[90:91]
 v_cvt_pk_bf16_f32 v73, v106, v107
 v_lshlrev_b32 v106, 16, v73
 v_and_b32 v107, s98, v73
 v_lshlrev_b32 v108, 16, v74
 v_and_b32 v109, s98, v74
 v_pk_mul_f32 v[108:109], v[108:109], s[88:89]
 v_cvt_pk_bf16_f32 v74, v108, v109
 v_lshlrev_b32 v108, 16, v74
 v_and_b32 v109, s98, v74
 v_lshlrev_b32 v110, 16, v75
 v_and_b32 v111, s98, v75
 v_pk_mul_f32 v[110:111], v[110:111], s[90:91]
 v_cvt_pk_bf16_f32 v75, v110, v111
 v_lshlrev_b32 v110, 16, v75
 v_and_b32 v111, s98, v75
 v_lshlrev_b32 v112, 16, v76
 v_and_b32 v113, s98, v76
 v_pk_mul_f32 v[112:113], v[112:113], s[88:89]
 v_cvt_pk_bf16_f32 v76, v112, v113
 v_lshlrev_b32 v112, 16, v76
 v_and_b32 v113, s98, v76
 v_lshlrev_b32 v114, 16, v77
 v_and_b32 v115, s98, v77
 v_pk_mul_f32 v[114:115], v[114:115], s[90:91]
 v_cvt_pk_bf16_f32 v77, v114, v115
 v_lshlrev_b32 v114, 16, v77
 v_and_b32 v115, s98, v77
 v_lshlrev_b32 v116, 16, v78
 v_and_b32 v117, s98, v78
 v_pk_mul_f32 v[116:117], v[116:117], s[88:89]
 v_cvt_pk_bf16_f32 v78, v116, v117
 v_lshlrev_b32 v116, 16, v78
 v_and_b32 v117, s98, v78
 v_lshlrev_b32 v118, 16, v79
 v_and_b32 v119, s98, v79
 v_pk_mul_f32 v[118:119], v[118:119], s[90:91]
 v_cvt_pk_bf16_f32 v79, v118, v119
 v_lshlrev_b32 v118, 16, v79
 v_and_b32 v119, s98, v79
 v_lshlrev_b32 v120, 16, v80
 v_and_b32 v121, s98, v80
 v_pk_mul_f32 v[120:121], v[120:121], s[88:89]
 v_cvt_pk_bf16_f32 v80, v120, v121
 v_lshlrev_b32 v120, 16, v80
 v_and_b32 v121, s98, v80
 v_lshlrev_b32 v122, 16, v81
 v_and_b32 v123, s98, v81
 v_pk_mul_f32 v[122:123], v[122:123], s[90:91]
 v_cvt_pk_bf16_f32 v81, v122, v123
 v_lshlrev_b32 v122, 16, v81
 v_and_b32 v123, s98, v81
 v_lshlrev_b32 v124, 16, v82
 v_and_b32 v125, s98, v82
 v_pk_mul_f32 v[124:125], v[124:125], s[88:89]
 v_cvt_pk_bf16_f32 v82, v124, v125
 v_lshlrev_b32 v124, 16, v82
 v_and_b32 v125, s98, v82
 v_lshlrev_b32 v126, 16, v83
 v_and_b32 v127, s98, v83
 v_pk_mul_f32 v[126:127], v[126:127], s[90:91]
 v_cvt_pk_bf16_f32 v83, v126, v127
 v_lshlrev_b32 v126, 16, v83
 v_and_b32 v127, s98, v83
 v_lshlrev_b32 v128, 16, v84
 v_and_b32 v129, s98, v84
 v_pk_mul_f32 v[128:129], v[128:129], s[88:89]
 v_cvt_pk_bf16_f32 v84, v128, v129
 v_lshlrev_b32 v128, 16, v84
 v_and_b32 v129, s98, v84
 v_lshlrev_b32 v130, 16, v85
 v_and_b32 v131, s98, v85
 v_pk_mul_f32 v[130:131], v[130:131], s[90:91]
 v_cvt_pk_bf16_f32 v85, v130, v131
 v_lshlrev_b32 v130, 16, v85
 v_and_b32 v131, s98, v85
 v_lshlrev_b32 v132, 16, v86
 v_and_b32 v133, s98, v86
 v_pk_mul_f32 v[132:133], v[132:133], s[88:89]
 v_cvt_pk_bf16_f32 v86, v132, v133
 v_lshlrev_b32 v132, 16, v86
 v_and_b32 v133, s98, v86
 v_lshlrev_b32 v134, 16, v87
 v_and_b32 v135, s98, v87
 v_pk_mul_f32 v[134:135], v[134:135], s[90:91]
 v_cvt_pk_bf16_f32 v87, v134, v135
 v_lshlrev_b32 v134, 16, v87
 v_and_b32 v135, s98, v87
 s_waitcnt lgkmcnt(0)
 v_lshlrev_b32 v136, 16, v88
 v_lshlrev_b32 v137, 16, v92
 v_lshlrev_b32 v138, 16, v96
 v_lshlrev_b32 v139, 16, v100
 v_pk_add_f32 v[104:105], v[104:105], v[136:137]
 v_cvt_pk_bf16_f32 v72, v104, v105
 v_pk_add_f32 v[106:107], v[106:107], v[138:139]
 v_cvt_pk_bf16_f32 v73, v106, v107
 buffer_store_dwordx2 v[72:73], v70, s[84:87], s93 offen
 s_add_u32 s93, s93, 4096
 v_and_b32 v136, s98, v88
 v_and_b32 v137, s98, v92
 v_and_b32 v138, s98, v96
 v_and_b32 v139, s98, v100
 v_pk_add_f32 v[108:109], v[108:109], v[136:137]
 v_cvt_pk_bf16_f32 v74, v108, v109
 v_pk_add_f32 v[110:111], v[110:111], v[138:139]
 v_cvt_pk_bf16_f32 v75, v110, v111
 buffer_store_dwordx2 v[74:75], v70, s[84:87], s93 offen
 s_add_u32 s93, s93, 4096
 v_lshlrev_b32 v136, 16, v89
 v_lshlrev_b32 v137, 16, v93
 v_lshlrev_b32 v138, 16, v97
 v_lshlrev_b32 v139, 16, v101
 v_pk_add_f32 v[112:113], v[112:113], v[136:137]
 v_cvt_pk_bf16_f32 v76, v112, v113
 v_pk_add_f32 v[114:115], v[114:115], v[138:139]
 v_cvt_pk_bf16_f32 v77, v114, v115
 buffer_store_dwordx2 v[76:77], v70, s[84:87], s93 offen
 s_add_u32 s93, s93, 4096
 v_and_b32 v136, s98, v89
 v_and_b32 v137, s98, v93
 v_and_b32 v138, s98, v97
 v_and_b32 v139, s98, v101
 v_pk_add_f32 v[116:117], v[116:117], v[136:137]
 v_cvt_pk_bf16_f32 v78, v116, v117
 v_pk_add_f32 v[118:119], v[118:119], v[138:139]
 v_cvt_pk_bf16_f32 v79, v118, v119
 buffer_store_dwordx2 v[78:79], v70, s[84:87], s93 offen
 s_add_u32 s93, s93, 4096
 v_lshlrev_b32 v136, 16, v90
 v_lshlrev_b32 v137, 16, v94
 v_lshlrev_b32 v138, 16, v98
 v_lshlrev_b32 v139, 16, v102
 v_pk_add_f32 v[120:121], v[120:121], v[136:137]
 v_cvt_pk_bf16_f32 v80, v120, v121
 v_pk_add_f32 v[122:123], v[122:123], v[138:139]
 v_cvt_pk_bf16_f32 v81, v122, v123
 buffer_store_dwordx2 v[80:81], v70, s[84:87], s93 offen
 s_add_u32 s93, s93, 4096
 v_and_b32 v136, s98, v90
 v_and_b32 v137, s98, v94
 v_and_b32 v138, s98, v98
 v_and_b32 v139, s98, v102
 v_pk_add_f32 v[124:125], v[124:125], v[136:137]
 v_cvt_pk_bf16_f32 v82, v124, v125
 v_pk_add_f32 v[126:127], v[126:127], v[138:139]
 v_cvt_pk_bf16_f32 v83, v126, v127
 buffer_store_dwordx2 v[82:83], v70, s[84:87], s93 offen
 s_add_u32 s93, s93, 4096
 v_lshlrev_b32 v136, 16, v91
 v_lshlrev_b32 v137, 16, v95
 v_lshlrev_b32 v138, 16, v99
 v_lshlrev_b32 v139, 16, v103
 v_pk_add_f32 v[128:129], v[128:129], v[136:137]
 v_cvt_pk_bf16_f32 v84, v128, v129
 v_pk_add_f32 v[130:131], v[130:131], v[138:139]
 v_cvt_pk_bf16_f32 v85, v130, v131
 buffer_store_dwordx2 v[84:85], v70, s[84:87], s93 offen
 s_add_u32 s93, s93, 4096
 v_and_b32 v136, s98, v91
 v_and_b32 v137, s98, v95
 v_and_b32 v138, s98, v99
 v_and_b32 v139, s98, v103
 v_pk_add_f32 v[132:133], v[132:133], v[136:137]
 v_cvt_pk_bf16_f32 v86, v132, v133
 v_pk_add_f32 v[134:135], v[134:135], v[138:139]
 v_cvt_pk_bf16_f32 v87, v134, v135
 buffer_store_dwordx2 v[86:87], v70, s[84:87], s93 offen
 s_add_u32 s93, s93, 4096
 s_barrier
 s_mov_b32 s3, 0
L_rdy_5:
 buffer_load_dwordx4 v[84:87], off, s[12:15], s30 sc1
 s_add_u32 s3, s3, 1
 s_cmp_gt_u32 s3, 400000
 s_cbranch_scc1 L_exit
 s_waitcnt vmcnt(0)
 v_readfirstlane_b32 s32, v84
 v_readfirstlane_b32 s33, v85
 v_readfirstlane_b32 vcc_hi, v86
 s_and_b32 vcc_lo, s32, 0xffff
 s_cmp_lt_u32 vcc_lo, 256
 s_cbranch_scc1 L_rdy_5
 s_cmp_lg_u32 vcc_hi, 0
 s_cbranch_scc1 L_general
 s_load_dwordx2 s[36:37], s[0:1], 0
 s_mov_b32 s38, 4194304
 s_mov_b32 s39, 0x20000
 s_lshl_b32 s44, s26, 14
 s_mul_i32 s45, s26, 16512
 s_lshl_b32 s41, s25, 2
 s_add_u32 s41, s41, s26
 s_lshl_b32 s46, s41, 11
 s_add_u32 s46, s46, 16777216
 s_waitcnt lgkmcnt(0)
 v_mov_b32 v15, 0
 v_and_b32 v255, 15, v1
 v_lshlrev_b32 v255, 2, v255
 s_mov_b32 s56, 0
 s_mov_b32 s57, 0
 s_mov_b32 s58, 0
 s_mov_b32 s59, 0
 s_mov_b32 s60, 0
 s_mov_b32 s61, 0
 s_mov_b32 s62, 0
 s_mov_b32 s63, 0
 s_mov_b32 s64, 0
 s_mov_b32 s65, 0
 s_mov_b32 s66, 0
 s_mov_b32 s67, 0
 s_mov_b32 s68, 0
 s_mov_b32 s69, 0
 s_mov_b32 s70, 0
 s_mov_b32 s71, 0
 s_mov_b32 s40, 0
 s_add_u32 m0, s45, 0
 s_add_u32 s43, s44, 0
 buffer_load_dwordx4 v2, s[36:39], s43 offen offset:0 lds
 buffer_load_dwordx4 v2, s[36:39], s43 offen offset:1024 lds
 s_add_u32 m0, s45, 2064
 s_add_u32 s43, s44, 2048
 buffer_load_dwordx4 v2, s[36:39], s43 offen offset:0 lds
 buffer_load_dwordx4 v2, s[36:39], s43 offen offset:1024 lds
 s_add_u32 m0, s45, 4128
 s_add_u32 s43, s44, 4096
 buffer_load_dwordx4 v2, s[36:39], s43 offen offset:0 lds
 buffer_load_dwordx4 v2, s[36:39], s43 offen offset:1024 lds
 s_add_u32 m0, s45, 6192
 s_add_u32 s43, s44, 6144
 buffer_load_dwordx4 v2, s[36:39], s43 offen offset:0 lds
 buffer_load_dwordx4 v2, s[36:39], s43 offen offset:1024 lds
 s_add_u32 m0, s45, 8256
 s_add_u32 s43, s44, 8192
 buffer_load_dwordx4 v2, s[36:39], s43 offen offset:0 lds
 buffer_load_dwordx4 v2, s[36:39], s43 offen offset:1024 lds
 s_add_u32 m0, s45, 10320
 s_add_u32 s43, s44, 10240
 buffer_load_dwordx4 v2, s[36:39], s43 offen offset:0 lds
 buffer_load_dwordx4 v2, s[36:39], s43 offen offset:1024 lds
 s_add_u32 m0, s45, 12384
 s_add_u32 s43, s44, 12288
 buffer_load_dwordx4 v2, s[36:39], s43 offen offset:0 lds
 buffer_load_dwordx4 v2, s[36:39], s43 offen offset:1024 lds
 s_add_u32 m0, s45, 14448
 s_add_u32 s43, s44, 14336
 buffer_load_dwordx4 v2, s[36:39], s43 offen offset:0 lds
 buffer_load_dwordx4 v2, s[36:39], s43 offen offset:1024 lds
 s_waitcnt vmcnt(0)
 s_barrier
 ds_read_b128 v[16:19], v10 offset:0
 ds_read_b128 v[20:23], v10 offset:32
 ds_read_b128 v[24:27], v10 offset:64
 ds_read_b128 v[28:31], v10 offset:96
 ds_read_b128 v[32:35], v10 offset:128
 ds_read_b128 v[36:39], v10 offset:160
 s_add_u32 s46, s46, 1073479680
 v_and_b32 v3, 31, v1
 v_lshrrev_b32 v4, 5, v1
 v_lshlrev_b32 v12, 4, v3
 v_lshl_add_u32 v12, v4, 7, v12
 v_cmp_gt_u32 vcc, 8, v3
 v_and_b32 v13, 15, v5
 v_lshlrev_b32 v13, 2, v13
 v_lshl_add_u32 v13, v4, 7, v13
 v_lshrrev_b32 v5, 4, v5
 v_lshl_add_u32 v13, v5, 8, v13
 v_cndmask_b32 v12, v7, v12, vcc
 v_lshlrev_b32 v4, 3, v4
 v_sub_u32 v3, v3, v4
 v_mov_b32 v4, 0xf149f2ca
 v_cmp_gt_i32 vcc, 0, v3
 s_nop 1
 v_cndmask_b32 v232, 0, v4, vcc
 v_cmp_gt_i32 vcc, 1, v3
 s_nop 1
 v_cndmask_b32 v233, 0, v4, vcc
 v_cmp_gt_i32 vcc, 2, v3
 s_nop 1
 v_cndmask_b32 v234, 0, v4, vcc
 v_cmp_gt_i32 vcc, 3, v3
 s_nop 1
 v_cndmask_b32 v235, 0, v4, vcc
 v_cmp_gt_i32 vcc, 4, v3
 s_nop 1
 v_cndmask_b32 v236, 0, v4, vcc
 v_cmp_gt_i32 vcc, 5, v3
 s_nop 1
 v_cndmask_b32 v237, 0, v4, vcc
 v_cmp_gt_i32 vcc, 6, v3
 s_nop 1
 v_cndmask_b32 v238, 0, v4, vcc
 v_cmp_gt_i32 vcc, 7, v3
 s_nop 1
 v_cndmask_b32 v239, 0, v4, vcc
 v_cmp_gt_i32 vcc, 16, v3
 s_nop 1
 v_cndmask_b32 v240, 0, v4, vcc
 v_cmp_gt_i32 vcc, 17, v3
 s_nop 1
 v_cndmask_b32 v241, 0, v4, vcc
 v_cmp_gt_i32 vcc, 18, v3
 s_nop 1
 v_cndmask_b32 v242, 0, v4, vcc
 v_cmp_gt_i32 vcc, 19, v3
 s_nop 1
 v_cndmask_b32 v243, 0, v4, vcc
 v_cmp_gt_i32 vcc, 20, v3
 s_nop 1
 v_cndmask_b32 v244, 0, v4, vcc
 v_cmp_gt_i32 vcc, 21, v3
 s_nop 1
 v_cndmask_b32 v245, 0, v4, vcc
 v_cmp_gt_i32 vcc, 22, v3
 s_nop 1
 v_cndmask_b32 v246, 0, v4, vcc
 v_cmp_gt_i32 vcc, 23, v3
 s_nop 1
 v_cndmask_b32 v247, 0, v4, vcc
 v_mov_b32 v248, 0x3e0293ee
 s_lshl_b32 s47, s51, 7
 s_add_u32 s47, s47, 3735552
 s_mov_b32 s53, 0x40000000
 v_cmp_eq_u32 vcc, 0, v1
 v_mov_b32 v252, 0
 s_nop 0
 v_cndmask_b32 v14, v7, 0, vcc
L_rK_loop:
 s_waitcnt lgkmcnt(5)
 v_mfma_f32_32x32x16_bf16 v[48:63], a[0:3], v[16:19], 0
 ds_read_b128 v[40:43], v10 offset:192
 s_add_u32 s44, s44, 65536
 s_add_u32 m0, s45, 66048
 s_add_u32 s43, s44, 0
 buffer_load_dwordx4 v2, s[36:39], s43 offen offset:0 lds
 s_waitcnt lgkmcnt(5)
 v_mfma_f32_32x32x16_bf16 v[48:63], a[4:7], v[20:23], v[48:63]
 ds_read_b128 v[44:47], v10 offset:224
 s_waitcnt lgkmcnt(5)
 v_mfma_f32_32x32x16_bf16 v[48:63], a[8:11], v[24:27], v[48:63]
 ds_read_b128 v[16:19], v10 offset:256
 buffer_load_dwordx4 v2, s[36:39], s43 offen offset:1024 lds
 s_waitcnt lgkmcnt(5)
 v_mfma_f32_32x32x16_bf16 v[48:63], a[12:15], v[28:31], v[48:63]
 ds_read_b128 v[20:23], v10 offset:288
 s_waitcnt lgkmcnt(5)
 v_mfma_f32_32x32x16_bf16 v[48:63], a[16:19], v[32:35], v[48:63]
 ds_read_b128 v[24:27], v10 offset:320
 s_add_u32 m0, s45, 68112
 s_add_u32 s43, s44, 2048
 buffer_load_dwordx4 v2, s[36:39], s43 offen offset:0 lds
 v_cvt_pk_bf16_f32 v80, v64, v65
 v_cvt_pk_bf16_f32 v81, v66, v67
 s_waitcnt lgkmcnt(5)
 v_mfma_f32_32x32x16_bf16 v[48:63], a[20:23], v[36:39], v[48:63]
 ds_read_b128 v[28:31], v10 offset:352
 v_cvt_pk_bf16_f32 v82, v68, v69
 v_cvt_pk_bf16_f32 v83, v70, v71
 s_waitcnt lgkmcnt(5)
 v_mfma_f32_32x32x16_bf16 v[48:63], a[24:27], v[40:43], v[48:63]
 ds_read_b128 v[32:35], v10 offset:384
 buffer_load_dwordx4 v2, s[36:39], s43 offen offset:1024 lds
 v_cvt_pk_bf16_f32 v84, v72, v73
 v_cvt_pk_bf16_f32 v85, v74, v75
 s_waitcnt lgkmcnt(5)
 v_mfma_f32_32x32x16_bf16 v[48:63], a[28:31], v[44:47], v[48:63]
 ds_read_b128 v[36:39], v10 offset:416
 v_cvt_pk_bf16_f32 v86, v76, v77
 v_cvt_pk_bf16_f32 v87, v78, v79
 s_waitcnt lgkmcnt(5)
 v_mfma_f32_32x32x16_bf16 v[48:63], a[32:35], v[16:19], v[48:63]
 ds_read_b128 v[40:43], v10 offset:448
 s_add_u32 m0, s45, 70176
 s_add_u32 s43, s44, 4096
 buffer_load_dwordx4 v2, s[36:39], s43 offen offset:0 lds
 s_waitcnt lgkmcnt(5)
 v_mfma_f32_32x32x16_bf16 v[48:63], a[36:39], v[20:23], v[48:63]
 ds_read_b128 v[44:47], v10 offset:480
 buffer_store_dwordx4 v[80:83], v2, s[4:7], s46 offen sc1
 s_waitcnt lgkmcnt(5)
 v_mfma_f32_32x32x16_bf16 v[48:63], a[40:43], v[24:27], v[48:63]
 ds_read_b128 v[16:19], v10 offset:512
 buffer_load_dwordx4 v2, s[36:39], s43 offen offset:1024 lds
 s_waitcnt lgkmcnt(5)
 v_mfma_f32_32x32x16_bf16 v[48:63], a[44:47], v[28:31], v[48:63]
 ds_read_b128 v[20:23], v10 offset:544
 buffer_store_dwordx4 v[84:87], v2, s[4:7], s46 offen offset:1024 sc1
 s_add_u32 s46, s46, 0x40000
 s_bitset0_b32 s46, 30
 s_waitcnt lgkmcnt(5)
 v_mfma_f32_32x32x16_bf16 v[48:63], a[48:51], v[32:35], v[48:63]
 ds_read_b128 v[24:27], v10 offset:576
 s_add_u32 m0, s45, 72240
 s_add_u32 s43, s44, 6144
 buffer_load_dwordx4 v2, s[36:39], s43 offen offset:0 lds
 s_waitcnt lgkmcnt(5)
 v_mfma_f32_32x32x16_bf16 v[48:63], a[52:55], v[36:39], v[48:63]
 ds_read_b128 v[28:31], v10 offset:608
 s_waitcnt lgkmcnt(5)
 v_mfma_f32_32x32x16_bf16 v[48:63], a[56:59], v[40:43], v[48:63]
 ds_read_b128 v[32:35], v10 offset:640
 buffer_load_dwordx4 v2, s[36:39], s43 offen offset:1024 lds
 s_waitcnt lgkmcnt(5)
 v_mfma_f32_32x32x16_bf16 v[48:63], a[60:63], v[44:47], v[48:63]
 ds_read_b128 v[36:39], v10 offset:672
 s_waitcnt lgkmcnt(5)
 v_mfma_f32_32x32x16_bf16 v[48:63], a[64:67], v[16:19], v[48:63]
 ds_read_b128 v[40:43], v10 offset:704
 s_add_u32 m0, s45, 74304
 s_add_u32 s43, s44, 8192
 buffer_load_dwordx4 v2, s[36:39], s43 offen offset:0 lds
 s_waitcnt lgkmcnt(5)
 v_mfma_f32_32x32x16_bf16 v[48:63], a[68:71], v[20:23], v[48:63]
 ds_read_b128 v[44:47], v10 offset:736
 s_waitcnt lgkmcnt(5)
 v_mfma_f32_32x32x16_bf16 v[48:63], a[72:75], v[24:27], v[48:63]
 ds_read_b128 v[16:19], v10 offset:768
 buffer_load_dwordx4 v2, s[36:39], s43 offen offset:1024 lds
 s_waitcnt lgkmcnt(5)
 v_mfma_f32_32x32x16_bf16 v[48:63], a[76:79], v[28:31], v[48:63]
 ds_read_b128 v[20:23], v10 offset:800
 s_waitcnt lgkmcnt(5)
 v_mfma_f32_32x32x16_bf16 v[48:63], a[80:83], v[32:35], v[48:63]
 ds_read_b128 v[24:27], v10 offset:832
 s_add_u32 m0, s45, 76368
 s_add_u32 s43, s44, 10240
 buffer_load_dwordx4 v2, s[36:39], s43 offen offset:0 lds
 s_waitcnt lgkmcnt(5)
 v_mfma_f32_32x32x16_bf16 v[48:63], a[84:87], v[36:39], v[48:63]
 ds_read_b128 v[28:31], v10 offset:864
 s_waitcnt lgkmcnt(5)
 v_mfma_f32_32x32x16_bf16 v[48:63], a[88:91], v[40:43], v[48:63]
 ds_read_b128 v[32:35], v10 offset:896
 buffer_load_dwordx4 v2, s[36:39], s43 offen offset:1024 lds
 s_waitcnt lgkmcnt(5)
 v_mfma_f32_32x32x16_bf16 v[48:63], a[92:95], v[44:47], v[48:63]
 ds_read_b128 v[36:39], v10 offset:928
 s_waitcnt lgkmcnt(5)
 v_mfma_f32_32x32x16_bf16 v[48:63], a[96:99], v[16:19], v[48:63]
 ds_read_b128 v[40:43], v10 offset:960
 s_add_u32 m0, s45, 78432
 s_add_u32 s43, s44, 12288
 buffer_load_dwordx4 v2, s[36:39], s43 offen offset:0 lds
 s_waitcnt lgkmcnt(5)
 v_mfma_f32_32x32x16_bf16 v[48:63], a[100:103], v[20:23], v[48:63]
 ds_read_b128 v[44:47], v10 offset:992
 s_waitcnt vmcnt(15)
 buffer_store_dword v252, v14, s[4:7], s53 offen sc1
 s_mov_b32 s53, 0x40000000
 s_waitcnt lgkmcnt(5)
 v_mfma_f32_32x32x16_bf16 v[48:63], a[104:107], v[24:27], v[48:63]
 ds_read_b128 v[16:19], v10 offset:1024
 buffer_load_dwordx4 v2, s[36:39], s43 offen offset:1024 lds
 s_waitcnt lgkmcnt(5)
 v_mfma_f32_32x32x16_bf16 v[48:63], a[108:111], v[28:31], v[48:63]
 ds_read_b128 v[20:23], v10 offset:1056
 s_waitcnt lgkmcnt(5)
 v_mfma_f32_32x32x16_bf16 v[48:63], a[112:115], v[32:35], v[48:63]
 ds_read_b128 v[24:27], v10 offset:1088
 s_add_u32 m0, s45, 80496
 s_add_u32 s43, s44, 14336
 buffer_load_dwordx4 v2, s[36:39], s43 offen offset:0 lds
 s_waitcnt lgkmcnt(5)
 v_mfma_f32_32x32x16_bf16 v[48:63], a[116:119], v[36:39], v[48:63]
 ds_read_b128 v[28:31], v10 offset:1120
 s_waitcnt lgkmcnt(5)
 v_mfma_f32_32x32x16_bf16 v[48:63], a[120:123], v[40:43], v[48:63]
 ds_read_b128 v[32:35], v10 offset:1152
 buffer_load_dwordx4 v2, s[36:39], s43 offen offset:1024 lds
 s_waitcnt lgkmcnt(5)
 v_mfma_f32_32x32x16_bf16 v[48:63], a[124:127], v[44:47], v[48:63]
 ds_read_b128 v[36:39], v10 offset:1184
 s_waitcnt lgkmcnt(5)
 v_mfma_f32_32x32x16_bf16 v[48:63], a[128:131], v[16:19], v[48:63]
 ds_read_b128 v[40:43], v10 offset:1216
 s_waitcnt lgkmcnt(5)
 v_mfma_f32_32x32x16_bf16 v[48:63], a[132:135], v[20:23], v[48:63]
 ds_read_b128 v[44:47], v10 offset:1248
 s_waitcnt lgkmcnt(5)
 v_mfma_f32_32x32x16_bf16 v[48:63], a[136:139], v[24:27], v[48:63]
 ds_read_b128 v[16:19], v10 offset:1280
 s_waitcnt lgkmcnt(5)
 v_mfma_f32_32x32x16_bf16 v[48:63], a[140:143], v[28:31], v[48:63]
 ds_read_b128 v[20:23], v10 offset:1312
 s_waitcnt lgkmcnt(5)
 v_mfma_f32_32x32x16_bf16 v[48:63], a[144:147], v[32:35], v[48:63]
 ds_read_b128 v[24:27], v10 offset:1344
 s_waitcnt lgkmcnt(5)
 v_mfma_f32_32x32x16_bf16 v[48:63], a[148:151], v[36:39], v[48:63]
 ds_read_b128 v[28:31], v10 offset:1376
 v_mov_b32 v9, s40
 s_waitcnt vmcnt(11)
 buffer_load_dword v15, v255, s[4:7], s47 offen sc1
 buffer_store_dword v9, v8, s[4:7], 0 offen sc1
 s_waitcnt lgkmcnt(5)
 v_mfma_f32_32x32x16_bf16 v[48:63], a[152:155], v[40:43], v[48:63]
 ds_read_b128 v[32:35], v10 offset:1408
 s_waitcnt lgkmcnt(5)
 v_mfma_f32_32x32x16_bf16 v[48:63], a[156:159], v[44:47], v[48:63]
 ds_read_b128 v[36:39], v10 offset:1440
 s_waitcnt lgkmcnt(5)
 v_mfma_f32_32x32x16_bf16 v[48:63], a[160:163], v[16:19], v[48:63]
 ds_read_b128 v[40:43], v10 offset:1472
 s_waitcnt lgkmcnt(5)
 v_mfma_f32_32x32x16_bf16 v[48:63], a[164:167], v[20:23], v[48:63]
 ds_read_b128 v[44:47], v10 offset:1504
 s_waitcnt lgkmcnt(5)
 v_mfma_f32_32x32x16_bf16 v[48:63], a[168:171], v[24:27], v[48:63]
 ds_read_b128 v[16:19], v10 offset:1536
 s_waitcnt lgkmcnt(5)
 v_mfma_f32_32x32x16_bf16 v[48:63], a[172:175], v[28:31], v[48:63]
 ds_read_b128 v[20:23], v10 offset:1568
 s_waitcnt lgkmcnt(5)
 v_mfma_f32_32x32x16_bf16 v[48:63], a[176:179], v[32:35], v[48:63]
 ds_read_b128 v[24:27], v10 offset:1600
 s_waitcnt lgkmcnt(5)
 v_mfma_f32_32x32x16_bf16 v[48:63], a[180:183], v[36:39], v[48:63]
 ds_read_b128 v[28:31], v10 offset:1632
 s_waitcnt lgkmcnt(5)
 v_mfma_f32_32x32x16_bf16 v[48:63], a[184:187], v[40:43], v[48:63]
 ds_read_b128 v[32:35], v10 offset:1664
 s_waitcnt lgkmcnt(5)
 v_mfma_f32_32x32x16_bf16 v[48:63], a[188:191], v[44:47], v[48:63]
 ds_read_b128 v[36:39], v10 offset:1696
 s_waitcnt lgkmcnt(5)
 v_mfma_f32_32x32x16_bf16 v[48:63], a[192:195], v[16:19], v[48:63]
 ds_read_b128 v[40:43], v10 offset:1728
 s_waitcnt lgkmcnt(5)
 v_mfma_f32_32x32x16_bf16 v[48:63], a[196:199], v[20:23], v[48:63]
 ds_read_b128 v[44:47], v10 offset:1760
 s_waitcnt lgkmcnt(5)
 v_mfma_f32_32x32x16_bf16 v[48:63], a[200:203], v[24:27], v[48:63]
 ds_read_b128 v[16:19], v10 offset:1792
 s_waitcnt lgkmcnt(5)
 v_mfma_f32_32x32x16_bf16 v[48:63], a[204:207], v[28:31], v[48:63]
 ds_read_b128 v[20:23], v10 offset:1824
 s_waitcnt lgkmcnt(5)
 v_mfma_f32_32x32x16_bf16 v[48:63], a[208:211], v[32:35], v[48:63]
 ds_read_b128 v[24:27], v10 offset:1856
 s_waitcnt lgkmcnt(5)
 v_mfma_f32_32x32x16_bf16 v[48:63], a[212:215], v[36:39], v[48:63]
 ds_read_b128 v[28:31], v10 offset:1888
 s_waitcnt lgkmcnt(5)
 v_mfma_f32_32x32x16_bf16 v[48:63], a[216:219], v[40:43], v[48:63]
 ds_read_b128 v[32:35], v10 offset:1920
 s_waitcnt lgkmcnt(5)
 v_mfma_f32_32x32x16_bf16 v[48:63], a[220:223], v[44:47], v[48:63]
 ds_read_b128 v[36:39], v10 offset:1952
 s_waitcnt lgkmcnt(5)
 v_mfma_f32_32x32x16_bf16 v[48:63], a[224:227], v[16:19], v[48:63]
 ds_read_b128 v[40:43], v10 offset:1984
 s_waitcnt lgkmcnt(5)
 v_mfma_f32_32x32x16_bf16 v[48:63], a[228:231], v[20:23], v[48:63]
 ds_read_b128 v[44:47], v10 offset:2016
 s_add_u32 s40, s40, 1
 s_mov_b32 s54, 0
 s_waitcnt lgkmcnt(5)
 v_mfma_f32_32x32x16_bf16 v[48:63], a[232:235], v[24:27], v[48:63]
 s_waitcnt lgkmcnt(4)
 v_mfma_f32_32x32x16_bf16 v[48:63], a[236:239], v[28:31], v[48:63]
 s_waitcnt lgkmcnt(0)
 s_waitcnt vmcnt(2)
 s_barrier
 ds_read_b128 v[16:19], v11 offset:0
 ds_read_b128 v[20:23], v11 offset:32
 v_mfma_f32_32x32x16_bf16 v[48:63], a[240:243], v[32:35], v[48:63]
 ds_read_b128 v[24:27], v11 offset:64
 ds_read_b128 v[28:31], v11 offset:96
 v_mfma_f32_32x32x16_bf16 v[48:63], a[244:247], v[36:39], v[48:63]
 ds_read_b128 v[32:35], v11 offset:128
 ds_read_b128 v[36:39], v11 offset:160
 v_mfma_f32_32x32x16_bf16 v[48:63], a[248:251], v[40:43], v[48:63]
 v_cmp_ge_u32 vcc, s50, v15
 v_mfma_f32_32x32x16_bf16 v[48:63], a[252:255], v[44:47], v[48:63]
 s_and_b32 vcc_lo, vcc_lo, 0xffff
 s_cbranch_scc0 L_rK_att
L_rK_ret0:
 s_waitcnt lgkmcnt(5)
 v_mfma_f32_32x32x16_bf16 v[64:79], a[0:3], v[16:19], 0
 ds_read_b128 v[40:43], v11 offset:192
 s_add_u32 s44, s44, 65536
 s_add_u32 m0, s45, 0
 s_add_u32 s43, s44, 0
 buffer_load_dwordx4 v2, s[36:39], s43 offen offset:0 lds
 s_waitcnt lgkmcnt(5)
 v_mfma_f32_32x32x16_bf16 v[64:79], a[4:7], v[20:23], v[64:79]
 ds_read_b128 v[44:47], v11 offset:224
 s_waitcnt lgkmcnt(5)
 v_mfma_f32_32x32x16_bf16 v[64:79], a[8:11], v[24:27], v[64:79]
 ds_read_b128 v[16:19], v11 offset:256
 buffer_load_dwordx4 v2, s[36:39], s43 offen offset:1024 lds
 s_waitcnt lgkmcnt(5)
 v_mfma_f32_32x32x16_bf16 v[64:79], a[12:15], v[28:31], v[64:79]
 ds_read_b128 v[20:23], v11 offset:288
 s_waitcnt lgkmcnt(5)
 v_mfma_f32_32x32x16_bf16 v[64:79], a[16:19], v[32:35], v[64:79]
 ds_read_b128 v[24:27], v11 offset:320
 s_add_u32 m0, s45, 2064
 s_add_u32 s43, s44, 2048
 buffer_load_dwordx4 v2, s[36:39], s43 offen offset:0 lds
 v_cvt_pk_bf16_f32 v80, v48, v49
 v_cvt_pk_bf16_f32 v81, v50, v51
 s_waitcnt lgkmcnt(5)
 v_mfma_f32_32x32x16_bf16 v[64:79], a[20:23], v[36:39], v[64:79]
 ds_read_b128 v[28:31], v11 offset:352
 v_cvt_pk_bf16_f32 v82, v52, v53
 v_cvt_pk_bf16_f32 v83, v54, v55
 s_waitcnt lgkmcnt(5)
 v_mfma_f32_32x32x16_bf16 v[64:79], a[24:27], v[40:43], v[64:79]
 ds_read_b128 v[32:35], v11 offset:384
 buffer_load_dwordx4 v2, s[36:39], s43 offen offset:1024 lds
 v_cvt_pk_bf16_f32 v84, v56, v57
 v_cvt_pk_bf16_f32 v85, v58, v59
 s_waitcnt lgkmcnt(5)
 v_mfma_f32_32x32x16_bf16 v[64:79], a[28:31], v[44:47], v[64:79]
 ds_read_b128 v[36:39], v11 offset:416
 v_cvt_pk_bf16_f32 v86, v60, v61
 v_cvt_pk_bf16_f32 v87, v62, v63
 s_waitcnt lgkmcnt(5)
 v_mfma_f32_32x32x16_bf16 v[64:79], a[32:35], v[16:19], v[64:79]
 ds_read_b128 v[40:43], v11 offset:448
 s_add_u32 m0, s45, 4128
 s_add_u32 s43, s44, 4096
 buffer_load_dwordx4 v2, s[36:39], s43 offen offset:0 lds
 s_waitcnt lgkmcnt(5)
 v_mfma_f32_32x32x16_bf16 v[64:79], a[36:39], v[20:23], v[64:79]
 ds_read_b128 v[44:47], v11 offset:480
 buffer_store_dwordx4 v[80:83], v2, s[4:7], s46 offen sc1
 s_waitcnt lgkmcnt(5)
 v_mfma_f32_32x32x16_bf16 v[64:79], a[40:43], v[24:27], v[64:79]
 ds_read_b128 v[16:19], v11 offset:512
 buffer_load_dwordx4 v2, s[36:39], s43 offen offset:1024 lds
 s_waitcnt lgkmcnt(5)
 v_mfma_f32_32x32x16_bf16 v[64:79], a[44:47], v[28:31], v[64:79]
 ds_read_b128 v[20:23], v11 offset:544
 buffer_store_dwordx4 v[84:87], v2, s[4:7], s46 offen offset:1024 sc1
 s_add_u32 s46, s46, 0x40000
 s_bitset0_b32 s46, 30
 s_waitcnt lgkmcnt(5)
 v_mfma_f32_32x32x16_bf16 v[64:79], a[48:51], v[32:35], v[64:79]
 ds_read_b128 v[24:27], v11 offset:576
 s_add_u32 m0, s45, 6192
 s_add_u32 s43, s44, 6144
 buffer_load_dwordx4 v2, s[36:39], s43 offen offset:0 lds
 s_waitcnt lgkmcnt(5)
 v_mfma_f32_32x32x16_bf16 v[64:79], a[52:55], v[36:39], v[64:79]
 ds_read_b128 v[28:31], v11 offset:608
 s_waitcnt lgkmcnt(5)
 v_mfma_f32_32x32x16_bf16 v[64:79], a[56:59], v[40:43], v[64:79]
 ds_read_b128 v[32:35], v11 offset:640
 buffer_load_dwordx4 v2, s[36:39], s43 offen offset:1024 lds
 s_waitcnt lgkmcnt(5)
 v_mfma_f32_32x32x16_bf16 v[64:79], a[60:63], v[44:47], v[64:79]
 ds_read_b128 v[36:39], v11 offset:672
 s_waitcnt lgkmcnt(5)
 v_mfma_f32_32x32x16_bf16 v[64:79], a[64:67], v[16:19], v[64:79]
 ds_read_b128 v[40:43], v11 offset:704
 s_add_u32 m0, s45, 8256
 s_add_u32 s43, s44, 8192
 buffer_load_dwordx4 v2, s[36:39], s43 offen offset:0 lds
 s_waitcnt lgkmcnt(5)
 v_mfma_f32_32x32x16_bf16 v[64:79], a[68:71], v[20:23], v[64:79]
 ds_read_b128 v[44:47], v11 offset:736
 s_waitcnt lgkmcnt(5)
 v_mfma_f32_32x32x16_bf16 v[64:79], a[72:75], v[24:27], v[64:79]
 ds_read_b128 v[16:19], v11 offset:768
 buffer_load_dwordx4 v2, s[36:39], s43 offen offset:1024 lds
 s_waitcnt lgkmcnt(5)
 v_mfma_f32_32x32x16_bf16 v[64:79], a[76:79], v[28:31], v[64:79]
 ds_read_b128 v[20:23], v11 offset:800
 s_waitcnt lgkmcnt(5)
 v_mfma_f32_32x32x16_bf16 v[64:79], a[80:83], v[32:35], v[64:79]
 ds_read_b128 v[24:27], v11 offset:832
 s_add_u32 m0, s45, 10320
 s_add_u32 s43, s44, 10240
 buffer_load_dwordx4 v2, s[36:39], s43 offen offset:0 lds
 s_waitcnt lgkmcnt(5)
 v_mfma_f32_32x32x16_bf16 v[64:79], a[84:87], v[36:39], v[64:79]
 ds_read_b128 v[28:31], v11 offset:864
 s_waitcnt lgkmcnt(5)
 v_mfma_f32_32x32x16_bf16 v[64:79], a[88:91], v[40:43], v[64:79]
 ds_read_b128 v[32:35], v11 offset:896
 buffer_load_dwordx4 v2, s[36:39], s43 offen offset:1024 lds
 s_waitcnt lgkmcnt(5)
 v_mfma_f32_32x32x16_bf16 v[64:79], a[92:95], v[44:47], v[64:79]
 ds_read_b128 v[36:39], v11 offset:928
 s_waitcnt lgkmcnt(5)
 v_mfma_f32_32x32x16_bf16 v[64:79], a[96:99], v[16:19], v[64:79]
 ds_read_b128 v[40:43], v11 offset:960
 s_add_u32 m0, s45, 12384
 s_add_u32 s43, s44, 12288
 buffer_load_dwordx4 v2, s[36:39], s43 offen offset:0 lds
 s_waitcnt lgkmcnt(5)
 v_mfma_f32_32x32x16_bf16 v[64:79], a[100:103], v[20:23], v[64:79]
 ds_read_b128 v[44:47], v11 offset:992
 s_waitcnt vmcnt(15)
 buffer_store_dword v252, v14, s[4:7], s53 offen sc1
 s_mov_b32 s53, 0x40000000
 s_waitcnt lgkmcnt(5)
 v_mfma_f32_32x32x16_bf16 v[64:79], a[104:107], v[24:27], v[64:79]
 ds_read_b128 v[16:19], v11 offset:1024
 buffer_load_dwordx4 v2, s[36:39], s43 offen offset:1024 lds
 s_waitcnt lgkmcnt(5)
 v_mfma_f32_32x32x16_bf16 v[64:79], a[108:111], v[28:31], v[64:79]
 ds_read_b128 v[20:23], v11 offset:1056
 s_waitcnt lgkmcnt(5)
 v_mfma_f32_32x32x16_bf16 v[64:79], a[112:115], v[32:35], v[64:79]
 ds_read_b128 v[24:27], v11 offset:1088
 s_add_u32 m0, s45, 14448
 s_add_u32 s43, s44, 14336
 buffer_load_dwordx4 v2, s[36:39], s43 offen offset:0 lds
 s_waitcnt lgkmcnt(5)
 v_mfma_f32_32x32x16_bf16 v[64:79], a[116:119], v[36:39], v[64:79]
 ds_read_b128 v[28:31], v11 offset:1120
 s_waitcnt lgkmcnt(5)
 v_mfma_f32_32x32x16_bf16 v[64:79], a[120:123], v[40:43], v[64:79]
 ds_read_b128 v[32:35], v11 offset:1152
 buffer_load_dwordx4 v2, s[36:39], s43 offen offset:1024 lds
 s_waitcnt lgkmcnt(5)
 v_mfma_f32_32x32x16_bf16 v[64:79], a[124:127], v[44:47], v[64:79]
 ds_read_b128 v[36:39], v11 offset:1184
 s_waitcnt lgkmcnt(5)
 v_mfma_f32_32x32x16_bf16 v[64:79], a[128:131], v[16:19], v[64:79]
 ds_read_b128 v[40:43], v11 offset:1216
 s_waitcnt lgkmcnt(5)
 v_mfma_f32_32x32x16_bf16 v[64:79], a[132:135], v[20:23], v[64:79]
 ds_read_b128 v[44:47], v11 offset:1248
 s_waitcnt lgkmcnt(5)
 v_mfma_f32_32x32x16_bf16 v[64:79], a[136:139], v[24:27], v[64:79]
 ds_read_b128 v[16:19], v11 offset:1280
 s_waitcnt lgkmcnt(5)
 v_mfma_f32_32x32x16_bf16 v[64:79], a[140:143], v[28:31], v[64:79]
 ds_read_b128 v[20:23], v11 offset:1312
 s_waitcnt lgkmcnt(5)
 v_mfma_f32_32x32x16_bf16 v[64:79], a[144:147], v[32:35], v[64:79]
 ds_read_b128 v[24:27], v11 offset:1344
 s_waitcnt lgkmcnt(5)
 v_mfma_f32_32x32x16_bf16 v[64:79], a[148:151], v[36:39], v[64:79]
 ds_read_b128 v[28:31], v11 offset:1376
 v_mov_b32 v9, s40
 s_waitcnt vmcnt(11)
 buffer_load_dword v15, v255, s[4:7], s47 offen sc1
 buffer_store_dword v9, v8, s[4:7], 0 offen sc1
 s_waitcnt lgkmcnt(5)
 v_mfma_f32_32x32x16_bf16 v[64:79], a[152:155], v[40:43], v[64:79]
 ds_read_b128 v[32:35], v11 offset:1408
 s_waitcnt lgkmcnt(5)
 v_mfma_f32_32x32x16_bf16 v[64:79], a[156:159], v[44:47], v[64:79]
 ds_read_b128 v[36:39], v11 offset:1440
 s_waitcnt lgkmcnt(5)
 v_mfma_f32_32x32x16_bf16 v[64:79], a[160:163], v[16:19], v[64:79]
 ds_read_b128 v[40:43], v11 offset:1472
 s_waitcnt lgkmcnt(5)
 v_mfma_f32_32x32x16_bf16 v[64:79], a[164:167], v[20:23], v[64:79]
 ds_read_b128 v[44:47], v11 offset:1504
 s_waitcnt lgkmcnt(5)
 v_mfma_f32_32x32x16_bf16 v[64:79], a[168:171], v[24:27], v[64:79]
 ds_read_b128 v[16:19], v11 offset:1536
 s_waitcnt lgkmcnt(5)
 v_mfma_f32_32x32x16_bf16 v[64:79], a[172:175], v[28:31], v[64:79]
 ds_read_b128 v[20:23], v11 offset:1568
 s_waitcnt lgkmcnt(5)
 v_mfma_f32_32x32x16_bf16 v[64:79], a[176:179], v[32:35], v[64:79]
 ds_read_b128 v[24:27], v11 offset:1600
 s_waitcnt lgkmcnt(5)
 v_mfma_f32_32x32x16_bf16 v[64:79], a[180:183], v[36:39], v[64:79]
 ds_read_b128 v[28:31], v11 offset:1632
 s_waitcnt lgkmcnt(5)
 v_mfma_f32_32x32x16_bf16 v[64:79], a[184:187], v[40:43], v[64:79]
 ds_read_b128 v[32:35], v11 offset:1664
 s_waitcnt lgkmcnt(5)
 v_mfma_f32_32x32x16_bf16 v[64:79], a[188:191], v[44:47], v[64:79]
 ds_read_b128 v[36:39], v11 offset:1696
 s_waitcnt lgkmcnt(5)
 v_mfma_f32_32x32x16_bf16 v[64:79], a[192:195], v[16:19], v[64:79]
 ds_read_b128 v[40:43], v11 offset:1728
 s_waitcnt lgkmcnt(5)
 v_mfma_f32_32x32x16_bf16 v[64:79], a[196:199], v[20:23], v[64:79]
 ds_read_b128 v[44:47], v11 offset:1760
 s_waitcnt lgkmcnt(5)
 v_mfma_f32_32x32x16_bf16 v[64:79], a[200:203], v[24:27], v[64:79]
 ds_read_b128 v[16:19], v11 offset:1792
 s_waitcnt lgkmcnt(5)
 v_mfma_f32_32x32x16_bf16 v[64:79], a[204:207], v[28:31], v[64:79]
 ds_read_b128 v[20:23], v11 offset:1824
 s_waitcnt lgkmcnt(5)
 v_mfma_f32_32x32x16_bf16 v[64:79], a[208:211], v[32:35], v[64:79]
 ds_read_b128 v[24:27], v11 offset:1856
 s_waitcnt lgkmcnt(5)
 v_mfma_f32_32x32x16_bf16 v[64:79], a[212:215], v[36:39], v[64:79]
 ds_read_b128 v[28:31], v11 offset:1888
 s_waitcnt lgkmcnt(5)
 v_mfma_f32_32x32x16_bf16 v[64:79], a[216:219], v[40:43], v[64:79]
 ds_read_b128 v[32:35], v11 offset:1920
 s_waitcnt lgkmcnt(5)
 v_mfma_f32_32x32x16_bf16 v[64:79], a[220:223], v[44:47], v[64:79]
 ds_read_b128 v[36:39], v11 offset:1952
 s_waitcnt lgkmcnt(5)
 v_mfma_f32_32x32x16_bf16 v[64:79], a[224:227], v[16:19], v[64:79]
 ds_read_b128 v[40:43], v11 offset:1984
 s_waitcnt lgkmcnt(5)
 v_mfma_f32_32x32x16_bf16 v[64:79], a[228:231], v[20:23], v[64:79]
 ds_read_b128 v[44:47], v11 offset:2016
 s_add_u32 s40, s40, 1
 s_mov_b32 s54, 1
 s_waitcnt lgkmcnt(5)
 v_mfma_f32_32x32x16_bf16 v[64:79], a[232:235], v[24:27], v[64:79]
 s_waitcnt lgkmcnt(4)
 v_mfma_f32_32x32x16_bf16 v[64:79], a[236:239], v[28:31], v[64:79]
 s_waitcnt lgkmcnt(0)
 s_waitcnt vmcnt(2)
 s_barrier
 ds_read_b128 v[16:19], v10 offset:0
 ds_read_b128 v[20:23], v10 offset:32
 v_mfma_f32_32x32x16_bf16 v[64:79], a[240:243], v[32:35], v[64:79]
 ds_read_b128 v[24:27], v10 offset:64
 ds_read_b128 v[28:31], v10 offset:96
 v_mfma_f32_32x32x16_bf16 v[64:79], a[244:247], v[36:39], v[64:79]
 ds_read_b128 v[32:35], v10 offset:128
 ds_read_b128 v[36:39], v10 offset:160
 v_mfma_f32_32x32x16_bf16 v[64:79], a[248:251], v[40:43], v[64:79]
 v_cmp_ge_u32 vcc, s50, v15
 v_mfma_f32_32x32x16_bf16 v[64:79], a[252:255], v[44:47], v[64:79]
 s_and_b32 vcc_lo, vcc_lo, 0xffff
 s_cbranch_scc0 L_rK_att
L_rK_ret1:
 s_cmp_lt_u32 s40, 64
 s_cbranch_scc1 L_rK_loop
 s_nop 11
 v_cvt_pk_bf16_f32 v80, v64, v65
 v_cvt_pk_bf16_f32 v81, v66, v67
 v_cvt_pk_bf16_f32 v82, v68, v69
 v_cvt_pk_bf16_f32 v83, v70, v71
 v_cvt_pk_bf16_f32 v84, v72, v73
 v_cvt_pk_bf16_f32 v85, v74, v75
 v_cvt_pk_bf16_f32 v86, v76, v77
 v_cvt_pk_bf16_f32 v87, v78, v79
 buffer_store_dwordx4 v[80:83], v2, s[4:7], s46 offen sc1
 buffer_store_dwordx4 v[84:87], v2, s[4:7], s46 offen offset:1024 sc1
 s_add_u32 s46, s46, 0x40000
 v_mov_b32 v9, 64
 s_mov_b32 s54, 2
L_rK_ret2:
 s_waitcnt vmcnt(0) lgkmcnt(0)
 buffer_store_dword v9, v8, s[4:7], 0 offen sc1
 buffer_store_dword v252, v14, s[4:7], s53 offen sc1
 s_mov_b32 s53, 0x40000000
 s_cmp_ge_u32 s50, 64
 s_cbranch_scc1 L_rK_end
L_rK_att:
L_rK_bkv:
 v_cmp_ge_u32 vcc, s50, v15
 s_and_b32 vcc_lo, vcc_lo, 0xf0ff
 s_cbranch_scc0 L_rK_bkvok
 buffer_load_dword v15, v255, s[4:7], s47 offen sc1
 s_add_u32 s48, s48, 1
 s_cmp_gt_u32 s48, 400000
 s_cbranch_scc1 L_done
 s_waitcnt vmcnt(0)
 s_branch L_rK_bkv
L_rK_bkvok:
 s_lshl_b32 s42, s50, 5
 s_add_u32 s42, s42, s51
 s_lshl_b32 s49, s42, 13
 s_lshl_b32 s53, s42, 2
 s_add_u32 s53, s53, 3760128
 s_add_u32 s43, s49, 16777216
 buffer_load_dwordx4 v[80:83], v6, s[4:7], s43 offen offset:0 sc1
 buffer_load_dwordx4 v[84:87], v6, s[4:7], s43 offen offset:1024 sc1
 buffer_load_dwordx4 v[88:91], v6, s[4:7], s43 offen offset:2048 sc1
 buffer_load_dwordx4 v[92:95], v6, s[4:7], s43 offen offset:3072 sc1
 s_add_u32 s43, s49, 16781312
 buffer_load_dwordx4 v[96:99], v6, s[4:7], s43 offen offset:0 sc1
 buffer_load_dwordx4 v[100:103], v6, s[4:7], s43 offen offset:1024 sc1
 buffer_load_dwordx4 v[104:107], v6, s[4:7], s43 offen offset:2048 sc1
 buffer_load_dwordx4 v[108:111], v6, s[4:7], s43 offen offset:3072 sc1
 s_add_u32 s43, s49, 50331648
 buffer_load_dwordx4 v[144:147], v2, s[4:7], s43 offen offset:0 sc1
 buffer_load_dwordx4 v[148:151], v2, s[4:7], s43 offen offset:1024 sc1
 buffer_load_dwordx4 v[152:155], v2, s[4:7], s43 offen offset:2048 sc1
 buffer_load_dwordx4 v[156:159], v2, s[4:7], s43 offen offset:3072 sc1
 s_add_u32 s43, s49, 50335744
 buffer_load_dwordx4 v[160:163], v2, s[4:7], s43 offen offset:0 sc1
 buffer_load_dwordx4 v[164:167], v2, s[4:7], s43 offen offset:1024 sc1
 buffer_load_dwordx4 v[168:171], v2, s[4:7], s43 offen offset:2048 sc1
 buffer_load_dwordx4 v[172:175], v2, s[4:7], s43 offen offset:3072 sc1
 s_add_u32 s43, s49, 33554432
 buffer_load_dwordx4 v[176:179], v6, s[4:7], s43 offen offset:0 sc1
 buffer_load_dwordx4 v[180:183], v6, s[4:7], s43 offen offset:1024 sc1
 buffer_load_dwordx4 v[184:187], v6, s[4:7], s43 offen offset:2048 sc1
 buffer_load_dwordx4 v[188:191], v6, s[4:7], s43 offen offset:3072 sc1
 s_add_u32 s43, s49, 33558528
 buffer_load_dwordx4 v[192:195], v6, s[4:7], s43 offen offset:0 sc1
 buffer_load_dwordx4 v[196:199], v6, s[4:7], s43 offen offset:1024 sc1
 buffer_load_dwordx4 v[200:203], v6, s[4:7], s43 offen offset:2048 sc1
 buffer_load_dwordx4 v[204:207], v6, s[4:7], s43 offen offset:3072 sc1
L_rK_bm:
 v_cmp_ge_u32 vcc, s50, v15
 s_and_b32 vcc_lo, vcc_lo, 0xf00
 s_cbranch_scc0 L_rK_bmok
 buffer_load_dword v15, v255, s[4:7], s47 offen sc1
 s_add_u32 s48, s48, 1
 s_cmp_gt_u32 s48, 400000
 s_cbranch_scc1 L_done
 s_waitcnt vmcnt(0)
 s_branch L_rK_bm
L_rK_bmok:
 s_lshr_b32 s42, s49, 2
 s_add_u32 s43, s42, 4194304
 buffer_load_dwordx4 v[112:115], v12, s[4:7], s43 offen offset:0 sc1
 buffer_load_dwordx4 v[116:119], v12, s[4:7], s43 offen offset:256 sc1
 buffer_load_dwordx4 v[120:123], v12, s[4:7], s43 offen offset:512 sc1
 buffer_load_dwordx4 v[124:127], v12, s[4:7], s43 offen offset:768 sc1
 buffer_load_dwordx4 v[128:131], v12, s[4:7], s43 offen offset:1024 sc1
 buffer_load_dwordx4 v[132:135], v12, s[4:7], s43 offen offset:1280 sc1
 buffer_load_dwordx4 v[136:139], v12, s[4:7], s43 offen offset:1536 sc1
 buffer_load_dwordx4 v[140:143], v12, s[4:7], s43 offen offset:1792 sc1
 s_add_u32 s43, s42, 8388608
 buffer_load_dword v208, v13, s[4:7], s43 offen offset:0 sc1
 buffer_load_dword v209, v13, s[4:7], s43 offen offset:64 sc1
 buffer_load_dword v210, v13, s[4:7], s43 offen offset:512 sc1
 buffer_load_dword v211, v13, s[4:7], s43 offen offset:576 sc1
 buffer_load_dword v212, v13, s[4:7], s43 offen offset:1024 sc1
 buffer_load_dword v213, v13, s[4:7], s43 offen offset:1088 sc1
 buffer_load_dword v214, v13, s[4:7], s43 offen offset:1536 sc1
 buffer_load_dword v215, v13, s[4:7], s43 offen offset:1600 sc1
 s_waitcnt vmcnt(24)
 v_mfma_f32_32x32x16_bf16 v[216:231], v[80:83], v[144:147], v[232:247]
 v_mfma_f32_32x32x16_bf16 v[216:231], v[84:87], v[148:151], v[216:231]
 v_mfma_f32_32x32x16_bf16 v[216:231], v[88:91], v[152:155], v[216:231]
 v_mfma_f32_32x32x16_bf16 v[216:231], v[92:95], v[156:159], v[216:231]
 v_mfma_f32_32x32x16_bf16 v[216:231], v[96:99], v[160:163], v[216:231]
 v_mfma_f32_32x32x16_bf16 v[216:231], v[100:103], v[164:167], v[216:231]
 v_mfma_f32_32x32x16_bf16 v[216:231], v[104:107], v[168:171], v[216:231]
 v_mfma_f32_32x32x16_bf16 v[216:231], v[108:111], v[172:175], v[216:231]
 s_waitcnt vmcnt(8)
 v_mfma_f32_32x32x16_bf16 v[80:95], v[112:115], v[144:147], 0
 v_mfma_f32_32x32x16_bf16 v[80:95], v[116:119], v[148:151], v[80:95]
 v_mfma_f32_32x32x16_bf16 v[80:95], v[120:123], v[152:155], v[80:95]
 v_mfma_f32_32x32x16_bf16 v[80:95], v[124:127], v[156:159], v[80:95]
 v_mfma_f32_32x32x16_bf16 v[80:95], v[128:131], v[160:163], v[80:95]
 v_mfma_f32_32x32x16_bf16 v[80:95], v[132:135], v[164:167], v[80:95]
 v_mfma_f32_32x32x16_bf16 v[80:95], v[136:139], v[168:171], v[80:95]
 v_mfma_f32_32x32x16_bf16 v[80:95], v[140:143], v[172:175], v[80:95]
 s_nop 3
 v_max3_f32 v3, v216, v217, v218
 v_max3_f32 v3, v3, v219, v220
 v_max3_f32 v3, v3, v221, v222
 v_max3_f32 v3, v3, v223, v224
 v_max3_f32 v3, v3, v225, v226
 v_max3_f32 v3, v3, v227, v228
 v_max3_f32 v3, v3, v229, v230
 v_max_f32 v3, v3, v231
 v_max3_f32 v3, v3, v80, v81
 v_max3_f32 v3, v3, v82, v83
 v_mov_b32 v4, v3
 s_nop 1
 v_permlane32_swap_b32 v3, v4
 s_nop 0
 v_max_f32 v3, v3, v4
 v_mul_f32 v3, v248, v3
 v_fma_f32 v216, v216, v248, -v3
 v_fma_f32 v217, v217, v248, -v3
 v_fma_f32 v218, v218, v248, -v3
 v_fma_f32 v219, v219, v248, -v3
 v_fma_f32 v220, v220, v248, -v3
 v_fma_f32 v221, v221, v248, -v3
 v_fma_f32 v222, v222, v248, -v3
 v_fma_f32 v223, v223, v248, -v3
 v_fma_f32 v224, v224, v248, -v3
 v_fma_f32 v225, v225, v248, -v3
 v_fma_f32 v226, v226, v248, -v3
 v_fma_f32 v227, v227, v248, -v3
 v_fma_f32 v228, v228, v248, -v3
 v_fma_f32 v229, v229, v248, -v3
 v_fma_f32 v230, v230, v248, -v3
 v_fma_f32 v231, v231, v248, -v3
 v_fma_f32 v80, v80, v248, -v3
 v_fma_f32 v81, v81, v248, -v3
 v_fma_f32 v82, v82, v248, -v3
 v_fma_f32 v83, v83, v248, -v3
 v_exp_f32 v216, v216
 v_exp_f32 v217, v217
 v_exp_f32 v218, v218
 v_exp_f32 v219, v219
 v_exp_f32 v220, v220
 v_exp_f32 v221, v221
 v_exp_f32 v222, v222
 v_exp_f32 v223, v223
 v_exp_f32 v224, v224
 v_exp_f32 v225, v225
 v_exp_f32 v226, v226
 v_exp_f32 v227, v227
 v_exp_f32 v228, v228
 v_exp_f32 v229, v229
 v_exp_f32 v230, v230
 v_exp_f32 v231, v231
 v_exp_f32 v80, v80
 v_exp_f32 v81, v81
 v_exp_f32 v82, v82
 v_exp_f32 v83, v83
 v_pk_add_f32 v[250:251], v[216:217], v[218:219]
 v_pk_add_f32 v[250:251], v[250:251], v[220:221]
 v_pk_add_f32 v[250:251], v[250:251], v[222:223]
 v_pk_add_f32 v[250:251], v[250:251], v[224:225]
 v_pk_add_f32 v[250:251], v[250:251], v[226:227]
 v_pk_add_f32 v[250:251], v[250:251], v[228:229]
 v_pk_add_f32 v[250:251], v[250:251], v[230:231]
 v_pk_add_f32 v[250:251], v[250:251], v[80:81]
 v_pk_add_f32 v[250:251], v[250:251], v[82:83]
 v_add_f32 v3, v250, v251
 v_add_f32 v4, v250, v251
 s_nop 1
 v_permlane32_swap_b32 v3, v4
 s_nop 0
 v_add_f32 v3, v3, v4
 v_rcp_f32 v250, v3
 s_nop 0
 v_pk_mul_f32 v[216:217], v[216:217], v[250:251] op_sel_hi:[1,0]
 v_pk_mul_f32 v[218:219], v[218:219], v[250:251] op_sel_hi:[1,0]
 v_pk_mul_f32 v[220:221], v[220:221], v[250:251] op_sel_hi:[1,0]
 v_pk_mul_f32 v[222:223], v[222:223], v[250:251] op_sel_hi:[1,0]
 v_pk_mul_f32 v[224:225], v[224:225], v[250:251] op_sel_hi:[1,0]
 v_pk_mul_f32 v[226:227], v[226:227], v[250:251] op_sel_hi:[1,0]
 v_pk_mul_f32 v[228:229], v[228:229], v[250:251] op_sel_hi:[1,0]
 v_pk_mul_f32 v[230:231], v[230:231], v[250:251] op_sel_hi:[1,0]
 v_pk_mul_f32 v[80:81], v[80:81], v[250:251] op_sel_hi:[1,0]
 v_pk_mul_f32 v[82:83], v[82:83], v[250:251] op_sel_hi:[1,0]
 v_cvt_pk_bf16_f32 v144, v216, v217
 v_cvt_pk_bf16_f32 v145, v218, v219
 v_cvt_pk_bf16_f32 v146, v220, v221
 v_cvt_pk_bf16_f32 v147, v222, v223
 v_cvt_pk_bf16_f32 v148, v224, v225
 v_cvt_pk_bf16_f32 v149, v226, v227
 v_cvt_pk_bf16_f32 v150, v228, v229
 v_cvt_pk_bf16_f32 v151, v230, v231
 v_cvt_pk_bf16_f32 v152, v80, v81
 v_cvt_pk_bf16_f32 v153, v82, v83
 s_waitcnt vmcnt(0)
 s_add_u32 s43, s49, 67108864
 s_add_u32 s42, s43, 4096
 v_mfma_f32_32x32x16_bf16 v[80:95], v[176:179], v[144:147], 0
 v_mfma_f32_32x32x16_bf16 v[80:95], v[180:183], v[148:151], v[80:95]
 v_mfma_f32_32x32x8_bf16 v[80:95], v[208:209], v[152:153], v[80:95]
 v_mfma_f32_32x32x16_bf16 v[96:111], v[184:187], v[144:147], 0
 v_mfma_f32_32x32x16_bf16 v[96:111], v[188:191], v[148:151], v[96:111]
 v_mfma_f32_32x32x8_bf16 v[96:111], v[210:211], v[152:153], v[96:111]
 v_mfma_f32_32x32x16_bf16 v[112:127], v[192:195], v[144:147], 0
 v_mfma_f32_32x32x16_bf16 v[112:127], v[196:199], v[148:151], v[112:127]
 v_mfma_f32_32x32x8_bf16 v[112:127], v[212:213], v[152:153], v[112:127]
 v_mfma_f32_32x32x16_bf16 v[128:143], v[200:203], v[144:147], 0
 v_mfma_f32_32x32x16_bf16 v[128:143], v[204:207], v[148:151], v[128:143]
 v_mfma_f32_32x32x8_bf16 v[128:143], v[214:215], v[152:153], v[128:143]
 s_nop 2
 v_cvt_pk_bf16_f32 v176, v80, v81
 v_cvt_pk_bf16_f32 v177, v82, v83
 v_cvt_pk_bf16_f32 v178, v84, v85
 v_cvt_pk_bf16_f32 v179, v86, v87
 v_cvt_pk_bf16_f32 v180, v88, v89
 v_cvt_pk_bf16_f32 v181, v90, v91
 v_cvt_pk_bf16_f32 v182, v92, v93
 v_cvt_pk_bf16_f32 v183, v94, v95
 buffer_store_dwordx4 v[176:179], v2, s[4:7], s43 offen offset:0 sc1
 buffer_store_dwordx4 v[180:183], v2, s[4:7], s43 offen offset:1024 sc1
 v_cvt_pk_bf16_f32 v184, v96, v97
 v_cvt_pk_bf16_f32 v185, v98, v99
 v_cvt_pk_bf16_f32 v186, v100, v101
 v_cvt_pk_bf16_f32 v187, v102, v103
 v_cvt_pk_bf16_f32 v188, v104, v105
 v_cvt_pk_bf16_f32 v189, v106, v107
 v_cvt_pk_bf16_f32 v190, v108, v109
 v_cvt_pk_bf16_f32 v191, v110, v111
 buffer_store_dwordx4 v[184:187], v2, s[4:7], s43 offen offset:2048 sc1
 buffer_store_dwordx4 v[188:191], v2, s[4:7], s43 offen offset:3072 sc1
 v_cvt_pk_bf16_f32 v192, v112, v113
 v_cvt_pk_bf16_f32 v193, v114, v115
 v_cvt_pk_bf16_f32 v194, v116, v117
 v_cvt_pk_bf16_f32 v195, v118, v119
 v_cvt_pk_bf16_f32 v196, v120, v121
 v_cvt_pk_bf16_f32 v197, v122, v123
 v_cvt_pk_bf16_f32 v198, v124, v125
 v_cvt_pk_bf16_f32 v199, v126, v127
 buffer_store_dwordx4 v[192:195], v2, s[4:7], s42 offen offset:0 sc1
 buffer_store_dwordx4 v[196:199], v2, s[4:7], s42 offen offset:1024 sc1
 v_cvt_pk_bf16_f32 v200, v128, v129
 v_cvt_pk_bf16_f32 v201, v130, v131
 v_cvt_pk_bf16_f32 v202, v132, v133
 v_cvt_pk_bf16_f32 v203, v134, v135
 v_cvt_pk_bf16_f32 v204, v136, v137
 v_cvt_pk_bf16_f32 v205, v138, v139
 v_cvt_pk_bf16_f32 v206, v140, v141
 v_cvt_pk_bf16_f32 v207, v142, v143
 buffer_store_dwordx4 v[200:203], v2, s[4:7], s42 offen offset:2048 sc1
 buffer_store_dwordx4 v[204:207], v2, s[4:7], s42 offen offset:3072 sc1
 s_add_u32 s41, s50, 1
 v_mov_b32 v252, s41
 s_add_u32 s50, s50, 12
 s_cmp_eq_u32 s54, 0
 s_cbranch_scc1 L_rK_ret0
 s_cmp_eq_u32 s54, 1
 s_cbranch_scc1 L_rK_ret1
 s_branch L_rK_ret2
L_rK_end:
 s_waitcnt vmcnt(0) lgkmcnt(0)
 s_barrier
 s_branch L_done
L_role_V:
 s_mov_b64 s[8:9], s[20:21]
 s_mov_b32 s10, 8388608
 s_mov_b32 s11, 0x20000
 v_and_b32 v1, 63, v0
 v_lshrrev_b32 v12, 4, v1
 v_lshlrev_b32 v12, 13, v12
 v_and_b32 v3, 15, v1
 v_lshl_add_u32 v12, v3, 4, v12
 s_lshl_b32 s44, s25, 8
 s_lshl_b32 s42, s26, 18
 s_add_u32 s44, s44, s42
 s_lshl_b32 s45, s26, 13
 s_add_u32 m0, s45, 0
 s_add_u32 s43, s44, 0
 buffer_load_dwordx4 v12, s[8:11], s43 offen  lds
 s_add_u32 m0, s45, 1024
 s_add_u32 s43, s44, 32768
 buffer_load_dwordx4 v12, s[8:11], s43 offen  lds
 s_add_u32 m0, s45, 2048
 s_add_u32 s43, s44, 65536
 buffer_load_dwordx4 v12, s[8:11], s43 offen  lds
 s_add_u32 m0, s45, 3072
 s_add_u32 s43, s44, 98304
 buffer_load_dwordx4 v12, s[8:11], s43 offen  lds
 s_add_u32 m0, s45, 4096
 s_add_u32 s43, s44, 131072
 buffer_load_dwordx4 v12, s[8:11], s43 offen  lds
 s_add_u32 m0, s45, 5120
 s_add_u32 s43, s44, 163840
 buffer_load_dwordx4 v12, s[8:11], s43 offen  lds
 s_add_u32 m0, s45, 6144
 s_add_u32 s43, s44, 196608
 buffer_load_dwordx4 v12, s[8:11], s43 offen  lds
 s_add_u32 m0, s45, 7168
 s_add_u32 s43, s44, 229376
 buffer_load_dwordx4 v12, s[8:11], s43 offen  lds
 s_cmp_lg_u32 s26, 1
 s_cbranch_scc1 L_voted_6
 s_bfe_u32 s63, s2, 0x30003
 s_lshl_b32 s56, s63, 21
 s_lshr_b32 s57, s2, 6
 s_lshl_b32 s57, s57, 3
 s_and_b32 s58, s2, 7
 s_add_u32 s57, s57, s58
 s_lshl_b32 s57, s57, 8
 s_add_u32 s56, s56, s57
 s_add_u32 s56, s56, 135790592
 s_add_u32 s57, s56, 8192
 s_load_dword s62, s[4:5], s56 glc
 s_load_dword s62, s[4:5], s57 glc
 s_waitcnt lgkmcnt(0)
 s_memtime s[58:59]
 s_load_dword s62, s[4:5], s56 glc
 s_waitcnt lgkmcnt(0)
 s_memtime s[60:61]
 s_load_dword s62, s[4:5], s57 glc
 s_waitcnt lgkmcnt(0)
 s_memtime s[32:33]
 s_sub_u32 s58, s60, s58
 s_waitcnt lgkmcnt(0)
 s_sub_u32 s60, s32, s60
 s_cmp_lt_u32 s60, s58
 s_cselect_b32 s58, 1, 0
 s_bfe_u32 s59, s24, 0x10002
 s_xor_b32 s58, s58, s59
 s_mov_b32 s59, 0
 s_mul_i32 s63, s63, 6
 s_add_u32 s63, s63, 16
 s_lshl_b64 s[34:35], s[58:59], s63
 s_or_b32 s34, s34, 1
L_voted_6:
 v_and_b32 v1, 63, v0
 v_lshlrev_b32 v2, 4, v1
 v_bfrev_b32 v7, 1
 s_mov_b32 s48, 0
 v_and_b32 v5, 0x13, v1
 v_bfe_u32 v3, v1, 2, 1
 v_lshl_add_u32 v5, v3, 3, v5
 v_bfe_u32 v3, v1, 3, 1
 v_lshl_add_u32 v5, v3, 2, v5
 v_lshrrev_b32 v4, 5, v1
 v_lshlrev_b32 v3, 9, v4
 v_lshl_add_u32 v6, v5, 4, v3
 v_mul_u32_u24 v3, 2064, v5
 v_lshl_add_u32 v10, v4, 4, v3
 v_add_u32 v11, 66048, v10
 s_lshr_b32 s50, s25, 3
 s_add_u32 s50, s50, 4
 s_and_b32 s51, s25, 7
 s_lshl_b32 s51, s51, 2
 s_add_u32 s51, s51, s26
 v_mad_u32_u24 v3, v1, 12, s50
 v_cmp_gt_u32 vcc, 64, v3
 s_lshl_b32 s41, s51, 2
 s_add_u32 s41, s41, 3760128
 v_lshl_add_u32 v3, v3, 7, s41
 v_cndmask_b32 v14, v7, v3, vcc
 s_lshl_b32 s41, s25, 7
 s_add_u32 s41, s41, 3735568
 s_lshl_b32 s42, s26, 2
 s_add_u32 s41, s41, s42
 v_mov_b32 v3, s41
 v_cmp_eq_u32 vcc, 0, v1
 v_mov_b32 v9, 0
 s_nop 0
 v_cndmask_b32 v8, v7, v3, vcc
 v_bfe_u32 v13, v1, 2, 2
 v_lshrrev_b32 v3, 5, v1
 v_lshl_add_u32 v13, v3, 3, v13
 v_lshlrev_b32 v13, 8, v13
 v_bfe_u32 v3, v1, 4, 1
 v_lshl_add_u32 v13, v3, 5, v13
 v_and_b32 v3, 1, v1
 v_lshl_add_u32 v13, v3, 3, v13
 v_bfe_u32 v3, v1, 1, 1
 v_lshl_add_u32 v13, v3, 4, v13
 s_lshl_b32 s43, s26, 6
 v_add_u32 v13, s43, v13
 buffer_store_dword v9, v8, s[4:7], 0 offen sc1
 buffer_store_dword v9, v14, s[4:7], 0 offen sc1
 s_add_u32 m0, s45, 32768
 s_add_u32 s43, s44, 1048576
 buffer_load_dwordx4 v12, s[8:11], s43 offen  lds
 s_add_u32 m0, s45, 33792
 s_add_u32 s43, s44, 1081344
 buffer_load_dwordx4 v12, s[8:11], s43 offen  lds
 s_add_u32 m0, s45, 34816
 s_add_u32 s43, s44, 1114112
 buffer_load_dwordx4 v12, s[8:11], s43 offen  lds
 s_add_u32 m0, s45, 35840
 s_add_u32 s43, s44, 1146880
 buffer_load_dwordx4 v12, s[8:11], s43 offen  lds
 s_add_u32 m0, s45, 36864
 s_add_u32 s43, s44, 1179648
 buffer_load_dwordx4 v12, s[8:11], s43 offen  lds
 s_add_u32 m0, s45, 37888
 s_add_u32 s43, s44, 1212416
 buffer_load_dwordx4 v12, s[8:11], s43 offen  lds
 s_add_u32 m0, s45, 38912
 s_add_u32 s43, s44, 1245184
 buffer_load_dwordx4 v12, s[8:11], s43 offen  lds
 s_add_u32 m0, s45, 39936
 s_add_u32 s43, s44, 1277952
 buffer_load_dwordx4 v12, s[8:11], s43 offen  lds
 v_and_b32 v67, 15, v64
 v_lshrrev_b32 v68, 4, v64
 v_cvt_f32_u32 v200, v67
 v_mul_f32 v206, 0x41800000, v200
 v_lshl_add_u32 v65, v67, 1, 0
 v_add_u32 v65, 256, v65
 v_and_b32 v66, 3, v67
 v_lshlrev_b32 v66, 2, v66
 v_lshrrev_b32 v69, 2, v67
 v_lshl_add_u32 v66, v69, 8, v66
 v_cmp_gt_u32 vcc, 8, v67
 s_nop 1
 v_cndmask_b32 v65, v66, v65, vcc
 v_cvt_f32_u32 v202, v65
 v_and_b32 v65, 1, v67
 v_lshlrev_b32 v65, 3, v65
 v_lshrrev_b32 v66, 1, v67
 v_min_u32 v66, 4, v66
 v_lshl_add_u32 v65, v66, 8, v65
 v_add_u32 v65, 1024, v65
 v_cvt_f32_u32 v204, v65
 s_waitcnt vmcnt(19)
 v_lshlrev_b32 v95, 16, v94
 v_mul_f32 v95, 0x3fb8aa3b, v95
 v_exp_f32 v95, v95
 s_nop 0
 v_cvt_pk_bf16_f32 v95, v95, v95
 v_and_b32 v95, s98, v95
 v_lshl_add_u32 v65, v64, 5, s94
 v_lshlrev_b32 v96, 16, v88
 v_lshlrev_b32 v97, 16, v89
 v_lshlrev_b32 v98, 16, v90
 v_lshlrev_b32 v99, 16, v91
 v_lshlrev_b32 v100, 16, v92
 v_lshlrev_b32 v101, 16, v93
 v_mul_f32 v96, v95, v96
 v_mul_f32 v97, v95, v97
 v_mul_f32 v98, v95, v98
 v_mul_f32 v99, v95, v99
 v_mul_f32 v104, 0x3fb8aa3b, v96
 v_mul_f32 v105, 0x3e22f983, v97
 v_mul_f32 v106, v100, v98
 v_fma_f32 v106, -v101, v99, v106
 v_mul_f32 v107, v100, v99
 v_fma_f32 v107, v101, v98, v107
 ds_write_b128 v65, v[104:107] offset:4160
 v_and_b32 v96, s98, v88
 v_and_b32 v97, s98, v89
 v_and_b32 v98, s98, v90
 v_and_b32 v99, s98, v91
 v_and_b32 v100, s98, v92
 v_and_b32 v101, s98, v93
 v_mul_f32 v96, v95, v96
 v_mul_f32 v97, v95, v97
 v_mul_f32 v98, v95, v98
 v_mul_f32 v99, v95, v99
 v_mul_f32 v108, 0x3fb8aa3b, v96
 v_mul_f32 v109, 0x3e22f983, v97
 v_mul_f32 v110, v100, v98
 v_fma_f32 v110, -v101, v99, v110
 v_mul_f32 v111, v100, v99
 v_fma_f32 v111, v101, v98, v111
 ds_write_b128 v65, v[108:111] offset:4176
 v_mov_b32 v120, 0
 v_mov_b32 v121, 0
 v_mov_b32 v122, 0
 v_mov_b32 v123, 0
 v_mov_b32 v124, 0
 v_mov_b32 v125, 0
 v_mov_b32 v126, 0
 v_mov_b32 v127, 0
 v_mov_b32 v128, 0
 v_mov_b32 v129, 0
 v_mov_b32 v130, 0
 v_mov_b32 v131, 0
 v_lshl_add_u32 v69, v68, 6, s94
 s_mov_b32 s95, 0
 s_waitcnt lgkmcnt(0)
L_rVb_kg0:
 ds_read_b128 v[88:91], v69 offset:4160
 ds_read_b128 v[92:95], v69 offset:4176
 ds_read_b128 v[96:99], v69 offset:4192
 ds_read_b128 v[100:103], v69 offset:4208
 v_add_u32 v69, 256, v69
 s_waitcnt lgkmcnt(3)
 v_pk_mul_f32 v[132:133], v[88:89], v[200:201] op_sel_hi:[1,0]
 v_pk_mul_f32 v[136:137], v[88:89], v[202:203] op_sel_hi:[1,0]
 v_pk_mul_f32 v[140:141], v[88:89], v[204:205] op_sel_hi:[1,0]
 v_pk_mul_f32 v[144:145], v[88:89], v[206:207] op_sel_hi:[1,0]
 v_fract_f32 v133, v133
 v_fract_f32 v137, v137
 v_fract_f32 v141, v141
 v_fract_f32 v145, v145
 v_exp_f32 v132, v132
 v_cos_f32 v134, v133
 v_sin_f32 v135, v133
 v_exp_f32 v136, v136
 v_cos_f32 v138, v137
 v_sin_f32 v139, v137
 v_exp_f32 v140, v140
 v_cos_f32 v142, v141
 v_sin_f32 v143, v141
 v_exp_f32 v144, v144
 v_cos_f32 v146, v145
 v_sin_f32 v147, v145
 v_pk_mul_f32 v[134:135], v[134:135], v[132:133] op_sel_hi:[1,0]
 v_pk_mul_f32 v[138:139], v[138:139], v[136:137] op_sel_hi:[1,0]
 v_pk_mul_f32 v[142:143], v[142:143], v[140:141] op_sel_hi:[1,0]
 v_pk_mul_f32 v[146:147], v[146:147], v[144:145] op_sel_hi:[1,0]
 v_pk_mul_f32 v[144:145], v[146:147], v[90:91] op_sel_hi:[0,1] neg_hi:[0,1]
 v_cvt_pk_bf16_f32 v104, v134, v135
 v_cvt_pk_bf16_f32 v108, v138, v139
 v_cvt_pk_bf16_f32 v112, v142, v143
 v_pk_fma_f32 v[144:145], v[146:147], v[90:91], v[144:145] op_sel:[1,1,0] op_sel_hi:[1,0,1] neg_lo:[0,1,0] neg_hi:[0,1,0]
 v_cvt_pk_bf16_f32 v116, v144, v145
 s_waitcnt lgkmcnt(2)
 v_pk_mul_f32 v[132:133], v[92:93], v[200:201] op_sel_hi:[1,0]
 v_pk_mul_f32 v[136:137], v[92:93], v[202:203] op_sel_hi:[1,0]
 v_pk_mul_f32 v[140:141], v[92:93], v[204:205] op_sel_hi:[1,0]
 v_pk_mul_f32 v[144:145], v[92:93], v[206:207] op_sel_hi:[1,0]
 v_fract_f32 v133, v133
 v_fract_f32 v137, v137
 v_fract_f32 v141, v141
 v_fract_f32 v145, v145
 v_exp_f32 v132, v132
 v_cos_f32 v134, v133
 v_sin_f32 v135, v133
 v_exp_f32 v136, v136
 v_cos_f32 v138, v137
 v_sin_f32 v139, v137
 v_exp_f32 v140, v140
 v_cos_f32 v142, v141
 v_sin_f32 v143, v141
 v_exp_f32 v144, v144
 v_cos_f32 v146, v145
 v_sin_f32 v147, v145
 v_pk_mul_f32 v[134:135], v[134:135], v[132:133] op_sel_hi:[1,0]
 v_pk_mul_f32 v[138:139], v[138:139], v[136:137] op_sel_hi:[1,0]
 v_pk_mul_f32 v[142:143], v[142:143], v[140:141] op_sel_hi:[1,0]
 v_pk_mul_f32 v[146:147], v[146:147], v[144:145] op_sel_hi:[1,0]
 v_pk_mul_f32 v[144:145], v[146:147], v[94:95] op_sel_hi:[0,1] neg_hi:[0,1]
 v_cvt_pk_bf16_f32 v105, v134, v135
 v_cvt_pk_bf16_f32 v109, v138, v139
 v_cvt_pk_bf16_f32 v113, v142, v143
 v_pk_fma_f32 v[144:145], v[146:147], v[94:95], v[144:145] op_sel:[1,1,0] op_sel_hi:[1,0,1] neg_lo:[0,1,0] neg_hi:[0,1,0]
 v_cvt_pk_bf16_f32 v117, v144, v145
 s_waitcnt lgkmcnt(1)
 v_pk_mul_f32 v[132:133], v[96:97], v[200:201] op_sel_hi:[1,0]
 v_pk_mul_f32 v[136:137], v[96:97], v[202:203] op_sel_hi:[1,0]
 v_pk_mul_f32 v[140:141], v[96:97], v[204:205] op_sel_hi:[1,0]
 v_pk_mul_f32 v[144:145], v[96:97], v[206:207] op_sel_hi:[1,0]
 v_fract_f32 v133, v133
 v_fract_f32 v137, v137
 v_fract_f32 v141, v141
 v_fract_f32 v145, v145
 v_exp_f32 v132, v132
 v_cos_f32 v134, v133
 v_sin_f32 v135, v133
 v_exp_f32 v136, v136
 v_cos_f32 v138, v137
 v_sin_f32 v139, v137
 v_exp_f32 v140, v140
 v_cos_f32 v142, v141
 v_sin_f32 v143, v141
 v_exp_f32 v144, v144
 v_cos_f32 v146, v145
 v_sin_f32 v147, v145
 v_pk_mul_f32 v[134:135], v[134:135], v[132:133] op_sel_hi:[1,0]
 v_pk_mul_f32 v[138:139], v[138:139], v[136:137] op_sel_hi:[1,0]
 v_pk_mul_f32 v[142:143], v[142:143], v[140:141] op_sel_hi:[1,0]
 v_pk_mul_f32 v[146:147], v[146:147], v[144:145] op_sel_hi:[1,0]
 v_pk_mul_f32 v[144:145], v[146:147], v[98:99] op_sel_hi:[0,1] neg_hi:[0,1]
 v_cvt_pk_bf16_f32 v106, v134, v135
 v_cvt_pk_bf16_f32 v110, v138, v139
 v_cvt_pk_bf16_f32 v114, v142, v143
 v_pk_fma_f32 v[144:145], v[146:147], v[98:99], v[144:145] op_sel:[1,1,0] op_sel_hi:[1,0,1] neg_lo:[0,1,0] neg_hi:[0,1,0]
 v_cvt_pk_bf16_f32 v118, v144, v145
 s_waitcnt lgkmcnt(0)
 v_pk_mul_f32 v[132:133], v[100:101], v[200:201] op_sel_hi:[1,0]
 v_pk_mul_f32 v[136:137], v[100:101], v[202:203] op_sel_hi:[1,0]
 v_pk_mul_f32 v[140:141], v[100:101], v[204:205] op_sel_hi:[1,0]
 v_pk_mul_f32 v[144:145], v[100:101], v[206:207] op_sel_hi:[1,0]
 v_fract_f32 v133, v133
 v_fract_f32 v137, v137
 v_fract_f32 v141, v141
 v_fract_f32 v145, v145
 v_exp_f32 v132, v132
 v_cos_f32 v134, v133
 v_sin_f32 v135, v133
 v_exp_f32 v136, v136
 v_cos_f32 v138, v137
 v_sin_f32 v139, v137
 v_exp_f32 v140, v140
 v_cos_f32 v142, v141
 v_sin_f32 v143, v141
 v_exp_f32 v144, v144
 v_cos_f32 v146, v145
 v_sin_f32 v147, v145
 v_pk_mul_f32 v[134:135], v[134:135], v[132:133] op_sel_hi:[1,0]
 v_pk_mul_f32 v[138:139], v[138:139], v[136:137] op_sel_hi:[1,0]
 v_pk_mul_f32 v[142:143], v[142:143], v[140:141] op_sel_hi:[1,0]
 v_pk_mul_f32 v[146:147], v[146:147], v[144:145] op_sel_hi:[1,0]
 v_pk_mul_f32 v[144:145], v[146:147], v[102:103] op_sel_hi:[0,1] neg_hi:[0,1]
 v_cvt_pk_bf16_f32 v107, v134, v135
 v_cvt_pk_bf16_f32 v111, v138, v139
 v_cvt_pk_bf16_f32 v115, v142, v143
 v_pk_fma_f32 v[144:145], v[146:147], v[102:103], v[144:145] op_sel:[1,1,0] op_sel_hi:[1,0,1] neg_lo:[0,1,0] neg_hi:[0,1,0]
 v_cvt_pk_bf16_f32 v119, v144, v145
 s_add_u32 s95, s95, 1
 s_cmp_lt_u32 s95, 2
 v_mfma_f32_16x16x32_bf16 v[120:123], v[104:107], v[116:119], v[120:123]
 v_mfma_f32_16x16x32_bf16 v[124:127], v[108:111], v[116:119], v[124:127]
 v_mfma_f32_16x16x32_bf16 v[128:131], v[112:115], v[116:119], v[128:131]
 s_cbranch_scc1 L_rVb_kg0
 s_waitcnt vmcnt(10)
 s_barrier
 ds_read_b64_tr_b16 a[0:1], v13 offset:0
 ds_read_b64_tr_b16 a[2:3], v13 offset:1024
 ds_read_b64_tr_b16 a[4:5], v13 offset:4096
 ds_read_b64_tr_b16 a[6:7], v13 offset:5120
 ds_read_b64_tr_b16 a[8:9], v13 offset:8192
 ds_read_b64_tr_b16 a[10:11], v13 offset:9216
 ds_read_b64_tr_b16 a[12:13], v13 offset:12288
 ds_read_b64_tr_b16 a[14:15], v13 offset:13312
 s_waitcnt lgkmcnt(0)
 ds_read_b64_tr_b16 a[16:17], v13 offset:16384
 ds_read_b64_tr_b16 a[18:19], v13 offset:17408
 ds_read_b64_tr_b16 a[20:21], v13 offset:20480
 ds_read_b64_tr_b16 a[22:23], v13 offset:21504
 ds_read_b64_tr_b16 a[24:25], v13 offset:24576
 ds_read_b64_tr_b16 a[26:27], v13 offset:25600
 ds_read_b64_tr_b16 a[28:29], v13 offset:28672
 ds_read_b64_tr_b16 a[30:31], v13 offset:29696
 s_waitcnt lgkmcnt(0)
 s_barrier
 s_add_u32 m0, s45, 0
 s_add_u32 s43, s44, 2097152
 buffer_load_dwordx4 v12, s[8:11], s43 offen  lds
 s_add_u32 m0, s45, 1024
 s_add_u32 s43, s44, 2129920
 buffer_load_dwordx4 v12, s[8:11], s43 offen  lds
 s_add_u32 m0, s45, 2048
 s_add_u32 s43, s44, 2162688
 buffer_load_dwordx4 v12, s[8:11], s43 offen  lds
 s_add_u32 m0, s45, 3072
 s_add_u32 s43, s44, 2195456
 buffer_load_dwordx4 v12, s[8:11], s43 offen  lds
 s_add_u32 m0, s45, 4096
 s_add_u32 s43, s44, 2228224
 buffer_load_dwordx4 v12, s[8:11], s43 offen  lds
 s_add_u32 m0, s45, 5120
 s_add_u32 s43, s44, 2260992
 buffer_load_dwordx4 v12, s[8:11], s43 offen  lds
 s_add_u32 m0, s45, 6144
 s_add_u32 s43, s44, 2293760
 buffer_load_dwordx4 v12, s[8:11], s43 offen  lds
 s_add_u32 m0, s45, 7168
 s_add_u32 s43, s44, 2326528
 buffer_load_dwordx4 v12, s[8:11], s43 offen  lds
L_rVb_kg1:
 ds_read_b128 v[88:91], v69 offset:4160
 ds_read_b128 v[92:95], v69 offset:4176
 ds_read_b128 v[96:99], v69 offset:4192
 ds_read_b128 v[100:103], v69 offset:4208
 v_add_u32 v69, 256, v69
 s_waitcnt lgkmcnt(3)
 v_pk_mul_f32 v[132:133], v[88:89], v[200:201] op_sel_hi:[1,0]
 v_pk_mul_f32 v[136:137], v[88:89], v[202:203] op_sel_hi:[1,0]
 v_pk_mul_f32 v[140:141], v[88:89], v[204:205] op_sel_hi:[1,0]
 v_pk_mul_f32 v[144:145], v[88:89], v[206:207] op_sel_hi:[1,0]
 v_fract_f32 v133, v133
 v_fract_f32 v137, v137
 v_fract_f32 v141, v141
 v_fract_f32 v145, v145
 v_exp_f32 v132, v132
 v_cos_f32 v134, v133
 v_sin_f32 v135, v133
 v_exp_f32 v136, v136
 v_cos_f32 v138, v137
 v_sin_f32 v139, v137
 v_exp_f32 v140, v140
 v_cos_f32 v142, v141
 v_sin_f32 v143, v141
 v_exp_f32 v144, v144
 v_cos_f32 v146, v145
 v_sin_f32 v147, v145
 v_pk_mul_f32 v[134:135], v[134:135], v[132:133] op_sel_hi:[1,0]
 v_pk_mul_f32 v[138:139], v[138:139], v[136:137] op_sel_hi:[1,0]
 v_pk_mul_f32 v[142:143], v[142:143], v[140:141] op_sel_hi:[1,0]
 v_pk_mul_f32 v[146:147], v[146:147], v[144:145] op_sel_hi:[1,0]
 v_pk_mul_f32 v[144:145], v[146:147], v[90:91] op_sel_hi:[0,1] neg_hi:[0,1]
 v_cvt_pk_bf16_f32 v104, v134, v135
 v_cvt_pk_bf16_f32 v108, v138, v139
 v_cvt_pk_bf16_f32 v112, v142, v143
 v_pk_fma_f32 v[144:145], v[146:147], v[90:91], v[144:145] op_sel:[1,1,0] op_sel_hi:[1,0,1] neg_lo:[0,1,0] neg_hi:[0,1,0]
 v_cvt_pk_bf16_f32 v116, v144, v145
 s_waitcnt lgkmcnt(2)
 v_pk_mul_f32 v[132:133], v[92:93], v[200:201] op_sel_hi:[1,0]
 v_pk_mul_f32 v[136:137], v[92:93], v[202:203] op_sel_hi:[1,0]
 v_pk_mul_f32 v[140:141], v[92:93], v[204:205] op_sel_hi:[1,0]
 v_pk_mul_f32 v[144:145], v[92:93], v[206:207] op_sel_hi:[1,0]
 v_fract_f32 v133, v133
 v_fract_f32 v137, v137
 v_fract_f32 v141, v141
 v_fract_f32 v145, v145
 v_exp_f32 v132, v132
 v_cos_f32 v134, v133
 v_sin_f32 v135, v133
 v_exp_f32 v136, v136
 v_cos_f32 v138, v137
 v_sin_f32 v139, v137
 v_exp_f32 v140, v140
 v_cos_f32 v142, v141
 v_sin_f32 v143, v141
 v_exp_f32 v144, v144
 v_cos_f32 v146, v145
 v_sin_f32 v147, v145
 v_pk_mul_f32 v[134:135], v[134:135], v[132:133] op_sel_hi:[1,0]
 v_pk_mul_f32 v[138:139], v[138:139], v[136:137] op_sel_hi:[1,0]
 v_pk_mul_f32 v[142:143], v[142:143], v[140:141] op_sel_hi:[1,0]
 v_pk_mul_f32 v[146:147], v[146:147], v[144:145] op_sel_hi:[1,0]
 v_pk_mul_f32 v[144:145], v[146:147], v[94:95] op_sel_hi:[0,1] neg_hi:[0,1]
 v_cvt_pk_bf16_f32 v105, v134, v135
 v_cvt_pk_bf16_f32 v109, v138, v139
 v_cvt_pk_bf16_f32 v113, v142, v143
 v_pk_fma_f32 v[144:145], v[146:147], v[94:95], v[144:145] op_sel:[1,1,0] op_sel_hi:[1,0,1] neg_lo:[0,1,0] neg_hi:[0,1,0]
 v_cvt_pk_bf16_f32 v117, v144, v145
 s_waitcnt lgkmcnt(1)
 v_pk_mul_f32 v[132:133], v[96:97], v[200:201] op_sel_hi:[1,0]
 v_pk_mul_f32 v[136:137], v[96:97], v[202:203] op_sel_hi:[1,0]
 v_pk_mul_f32 v[140:141], v[96:97], v[204:205] op_sel_hi:[1,0]
 v_pk_mul_f32 v[144:145], v[96:97], v[206:207] op_sel_hi:[1,0]
 v_fract_f32 v133, v133
 v_fract_f32 v137, v137
 v_fract_f32 v141, v141
 v_fract_f32 v145, v145
 v_exp_f32 v132, v132
 v_cos_f32 v134, v133
 v_sin_f32 v135, v133
 v_exp_f32 v136, v136
 v_cos_f32 v138, v137
 v_sin_f32 v139, v137
 v_exp_f32 v140, v140
 v_cos_f32 v142, v141
 v_sin_f32 v143, v141
 v_exp_f32 v144, v144
 v_cos_f32 v146, v145
 v_sin_f32 v147, v145
 v_pk_mul_f32 v[134:135], v[134:135], v[132:133] op_sel_hi:[1,0]
 v_pk_mul_f32 v[138:139], v[138:139], v[136:137] op_sel_hi:[1,0]
 v_pk_mul_f32 v[142:143], v[142:143], v[140:141] op_sel_hi:[1,0]
 v_pk_mul_f32 v[146:147], v[146:147], v[144:145] op_sel_hi:[1,0]
 v_pk_mul_f32 v[144:145], v[146:147], v[98:99] op_sel_hi:[0,1] neg_hi:[0,1]
 v_cvt_pk_bf16_f32 v106, v134, v135
 v_cvt_pk_bf16_f32 v110, v138, v139
 v_cvt_pk_bf16_f32 v114, v142, v143
 v_pk_fma_f32 v[144:145], v[146:147], v[98:99], v[144:145] op_sel:[1,1,0] op_sel_hi:[1,0,1] neg_lo:[0,1,0] neg_hi:[0,1,0]
 v_cvt_pk_bf16_f32 v118, v144, v145
 s_waitcnt lgkmcnt(0)
 v_pk_mul_f32 v[132:133], v[100:101], v[200:201] op_sel_hi:[1,0]
 v_pk_mul_f32 v[136:137], v[100:101], v[202:203] op_sel_hi:[1,0]
 v_pk_mul_f32 v[140:141], v[100:101], v[204:205] op_sel_hi:[1,0]
 v_pk_mul_f32 v[144:145], v[100:101], v[206:207] op_sel_hi:[1,0]
 v_fract_f32 v133, v133
 v_fract_f32 v137, v137
 v_fract_f32 v141, v141
 v_fract_f32 v145, v145
 v_exp_f32 v132, v132
 v_cos_f32 v134, v133
 v_sin_f32 v135, v133
 v_exp_f32 v136, v136
 v_cos_f32 v138, v137
 v_sin_f32 v139, v137
 v_exp_f32 v140, v140
 v_cos_f32 v142, v141
 v_sin_f32 v143, v141
 v_exp_f32 v144, v144
 v_cos_f32 v146, v145
 v_sin_f32 v147, v145
 v_pk_mul_f32 v[134:135], v[134:135], v[132:133] op_sel_hi:[1,0]
 v_pk_mul_f32 v[138:139], v[138:139], v[136:137] op_sel_hi:[1,0]
 v_pk_mul_f32 v[142:143], v[142:143], v[140:141] op_sel_hi:[1,0]
 v_pk_mul_f32 v[146:147], v[146:147], v[144:145] op_sel_hi:[1,0]
 v_pk_mul_f32 v[144:145], v[146:147], v[102:103] op_sel_hi:[0,1] neg_hi:[0,1]
 v_cvt_pk_bf16_f32 v107, v134, v135
 v_cvt_pk_bf16_f32 v111, v138, v139
 v_cvt_pk_bf16_f32 v115, v142, v143
 v_pk_fma_f32 v[144:145], v[146:147], v[102:103], v[144:145] op_sel:[1,1,0] op_sel_hi:[1,0,1] neg_lo:[0,1,0] neg_hi:[0,1,0]
 v_cvt_pk_bf16_f32 v119, v144, v145
 s_add_u32 s95, s95, 1
 s_cmp_lt_u32 s95, 5
 v_mfma_f32_16x16x32_bf16 v[120:123], v[104:107], v[116:119], v[120:123]
 v_mfma_f32_16x16x32_bf16 v[124:127], v[108:111], v[116:119], v[124:127]
 v_mfma_f32_16x16x32_bf16 v[128:131], v[112:115], v[116:119], v[128:131]
 s_cbranch_scc1 L_rVb_kg1
 s_lshl_b32 s93, s28, 3
 buffer_load_dwordx2 v[72:73], v70, s[84:87], s93 offen offset:0
 buffer_load_dwordx2 v[74:75], v70, s[84:87], s93 offen offset:2048
 s_add_u32 s93, s93, 4096
 buffer_load_dwordx2 v[76:77], v70, s[84:87], s93 offen offset:0
 buffer_load_dwordx2 v[78:79], v70, s[84:87], s93 offen offset:2048
 s_add_u32 s93, s93, 4096
 buffer_load_dwordx2 v[80:81], v70, s[84:87], s93 offen offset:0
 buffer_load_dwordx2 v[82:83], v70, s[84:87], s93 offen offset:2048
 s_add_u32 s93, s93, 4096
 buffer_load_dwordx2 v[84:85], v70, s[84:87], s93 offen offset:0
 buffer_load_dwordx2 v[86:87], v70, s[84:87], s93 offen offset:2048
 s_waitcnt vmcnt(16)
 s_barrier
 ds_read_b64_tr_b16 a[32:33], v13 offset:32768
 ds_read_b64_tr_b16 a[34:35], v13 offset:33792
 ds_read_b64_tr_b16 a[36:37], v13 offset:36864
 ds_read_b64_tr_b16 a[38:39], v13 offset:37888
 ds_read_b64_tr_b16 a[40:41], v13 offset:40960
 ds_read_b64_tr_b16 a[42:43], v13 offset:41984
 ds_read_b64_tr_b16 a[44:45], v13 offset:45056
 ds_read_b64_tr_b16 a[46:47], v13 offset:46080
 s_waitcnt lgkmcnt(0)
 ds_read_b64_tr_b16 a[48:49], v13 offset:49152
 ds_read_b64_tr_b16 a[50:51], v13 offset:50176
 ds_read_b64_tr_b16 a[52:53], v13 offset:53248
 ds_read_b64_tr_b16 a[54:55], v13 offset:54272
 ds_read_b64_tr_b16 a[56:57], v13 offset:57344
 ds_read_b64_tr_b16 a[58:59], v13 offset:58368
 ds_read_b64_tr_b16 a[60:61], v13 offset:61440
 ds_read_b64_tr_b16 a[62:63], v13 offset:62464
 s_waitcnt lgkmcnt(0)
 s_barrier
 s_add_u32 m0, s45, 32768
 s_add_u32 s43, s44, 3145728
 buffer_load_dwordx4 v12, s[8:11], s43 offen  lds
 s_add_u32 m0, s45, 33792
 s_add_u32 s43, s44, 3178496
 buffer_load_dwordx4 v12, s[8:11], s43 offen  lds
 s_add_u32 m0, s45, 34816
 s_add_u32 s43, s44, 3211264
 buffer_load_dwordx4 v12, s[8:11], s43 offen  lds
 s_add_u32 m0, s45, 35840
 s_add_u32 s43, s44, 3244032
 buffer_load_dwordx4 v12, s[8:11], s43 offen  lds
 s_add_u32 m0, s45, 36864
 s_add_u32 s43, s44, 3276800
 buffer_load_dwordx4 v12, s[8:11], s43 offen  lds
 s_add_u32 m0, s45, 37888
 s_add_u32 s43, s44, 3309568
 buffer_load_dwordx4 v12, s[8:11], s43 offen  lds
 s_add_u32 m0, s45, 38912
 s_add_u32 s43, s44, 3342336
 buffer_load_dwordx4 v12, s[8:11], s43 offen  lds
 s_add_u32 m0, s45, 39936
 s_add_u32 s43, s44, 3375104
 buffer_load_dwordx4 v12, s[8:11], s43 offen  lds
L_rVb_kg2:
 ds_read_b128 v[88:91], v69 offset:4160
 ds_read_b128 v[92:95], v69 offset:4176
 ds_read_b128 v[96:99], v69 offset:4192
 ds_read_b128 v[100:103], v69 offset:4208
 v_add_u32 v69, 256, v69
 s_waitcnt lgkmcnt(3)
 v_pk_mul_f32 v[132:133], v[88:89], v[200:201] op_sel_hi:[1,0]
 v_pk_mul_f32 v[136:137], v[88:89], v[202:203] op_sel_hi:[1,0]
 v_pk_mul_f32 v[140:141], v[88:89], v[204:205] op_sel_hi:[1,0]
 v_pk_mul_f32 v[144:145], v[88:89], v[206:207] op_sel_hi:[1,0]
 v_fract_f32 v133, v133
 v_fract_f32 v137, v137
 v_fract_f32 v141, v141
 v_fract_f32 v145, v145
 v_exp_f32 v132, v132
 v_cos_f32 v134, v133
 v_sin_f32 v135, v133
 v_exp_f32 v136, v136
 v_cos_f32 v138, v137
 v_sin_f32 v139, v137
 v_exp_f32 v140, v140
 v_cos_f32 v142, v141
 v_sin_f32 v143, v141
 v_exp_f32 v144, v144
 v_cos_f32 v146, v145
 v_sin_f32 v147, v145
 v_pk_mul_f32 v[134:135], v[134:135], v[132:133] op_sel_hi:[1,0]
 v_pk_mul_f32 v[138:139], v[138:139], v[136:137] op_sel_hi:[1,0]
 v_pk_mul_f32 v[142:143], v[142:143], v[140:141] op_sel_hi:[1,0]
 v_pk_mul_f32 v[146:147], v[146:147], v[144:145] op_sel_hi:[1,0]
 v_pk_mul_f32 v[144:145], v[146:147], v[90:91] op_sel_hi:[0,1] neg_hi:[0,1]
 v_cvt_pk_bf16_f32 v104, v134, v135
 v_cvt_pk_bf16_f32 v108, v138, v139
 v_cvt_pk_bf16_f32 v112, v142, v143
 v_pk_fma_f32 v[144:145], v[146:147], v[90:91], v[144:145] op_sel:[1,1,0] op_sel_hi:[1,0,1] neg_lo:[0,1,0] neg_hi:[0,1,0]
 v_cvt_pk_bf16_f32 v116, v144, v145
 s_waitcnt lgkmcnt(2)
 v_pk_mul_f32 v[132:133], v[92:93], v[200:201] op_sel_hi:[1,0]
 v_pk_mul_f32 v[136:137], v[92:93], v[202:203] op_sel_hi:[1,0]
 v_pk_mul_f32 v[140:141], v[92:93], v[204:205] op_sel_hi:[1,0]
 v_pk_mul_f32 v[144:145], v[92:93], v[206:207] op_sel_hi:[1,0]
 v_fract_f32 v133, v133
 v_fract_f32 v137, v137
 v_fract_f32 v141, v141
 v_fract_f32 v145, v145
 v_exp_f32 v132, v132
 v_cos_f32 v134, v133
 v_sin_f32 v135, v133
 v_exp_f32 v136, v136
 v_cos_f32 v138, v137
 v_sin_f32 v139, v137
 v_exp_f32 v140, v140
 v_cos_f32 v142, v141
 v_sin_f32 v143, v141
 v_exp_f32 v144, v144
 v_cos_f32 v146, v145
 v_sin_f32 v147, v145
 v_pk_mul_f32 v[134:135], v[134:135], v[132:133] op_sel_hi:[1,0]
 v_pk_mul_f32 v[138:139], v[138:139], v[136:137] op_sel_hi:[1,0]
 v_pk_mul_f32 v[142:143], v[142:143], v[140:141] op_sel_hi:[1,0]
 v_pk_mul_f32 v[146:147], v[146:147], v[144:145] op_sel_hi:[1,0]
 v_pk_mul_f32 v[144:145], v[146:147], v[94:95] op_sel_hi:[0,1] neg_hi:[0,1]
 v_cvt_pk_bf16_f32 v105, v134, v135
 v_cvt_pk_bf16_f32 v109, v138, v139
 v_cvt_pk_bf16_f32 v113, v142, v143
 v_pk_fma_f32 v[144:145], v[146:147], v[94:95], v[144:145] op_sel:[1,1,0] op_sel_hi:[1,0,1] neg_lo:[0,1,0] neg_hi:[0,1,0]
 v_cvt_pk_bf16_f32 v117, v144, v145
 s_waitcnt lgkmcnt(1)
 v_pk_mul_f32 v[132:133], v[96:97], v[200:201] op_sel_hi:[1,0]
 v_pk_mul_f32 v[136:137], v[96:97], v[202:203] op_sel_hi:[1,0]
 v_pk_mul_f32 v[140:141], v[96:97], v[204:205] op_sel_hi:[1,0]
 v_pk_mul_f32 v[144:145], v[96:97], v[206:207] op_sel_hi:[1,0]
 v_fract_f32 v133, v133
 v_fract_f32 v137, v137
 v_fract_f32 v141, v141
 v_fract_f32 v145, v145
 v_exp_f32 v132, v132
 v_cos_f32 v134, v133
 v_sin_f32 v135, v133
 v_exp_f32 v136, v136
 v_cos_f32 v138, v137
 v_sin_f32 v139, v137
 v_exp_f32 v140, v140
 v_cos_f32 v142, v141
 v_sin_f32 v143, v141
 v_exp_f32 v144, v144
 v_cos_f32 v146, v145
 v_sin_f32 v147, v145
 v_pk_mul_f32 v[134:135], v[134:135], v[132:133] op_sel_hi:[1,0]
 v_pk_mul_f32 v[138:139], v[138:139], v[136:137] op_sel_hi:[1,0]
 v_pk_mul_f32 v[142:143], v[142:143], v[140:141] op_sel_hi:[1,0]
 v_pk_mul_f32 v[146:147], v[146:147], v[144:145] op_sel_hi:[1,0]
 v_pk_mul_f32 v[144:145], v[146:147], v[98:99] op_sel_hi:[0,1] neg_hi:[0,1]
 v_cvt_pk_bf16_f32 v106, v134, v135
 v_cvt_pk_bf16_f32 v110, v138, v139
 v_cvt_pk_bf16_f32 v114, v142, v143
 v_pk_fma_f32 v[144:145], v[146:147], v[98:99], v[144:145] op_sel:[1,1,0] op_sel_hi:[1,0,1] neg_lo:[0,1,0] neg_hi:[0,1,0]
 v_cvt_pk_bf16_f32 v118, v144, v145
 s_waitcnt lgkmcnt(0)
 v_pk_mul_f32 v[132:133], v[100:101], v[200:201] op_sel_hi:[1,0]
 v_pk_mul_f32 v[136:137], v[100:101], v[202:203] op_sel_hi:[1,0]
 v_pk_mul_f32 v[140:141], v[100:101], v[204:205] op_sel_hi:[1,0]
 v_pk_mul_f32 v[144:145], v[100:101], v[206:207] op_sel_hi:[1,0]
 v_fract_f32 v133, v133
 v_fract_f32 v137, v137
 v_fract_f32 v141, v141
 v_fract_f32 v145, v145
 v_exp_f32 v132, v132
 v_cos_f32 v134, v133
 v_sin_f32 v135, v133
 v_exp_f32 v136, v136
 v_cos_f32 v138, v137
 v_sin_f32 v139, v137
 v_exp_f32 v140, v140
 v_cos_f32 v142, v141
 v_sin_f32 v143, v141
 v_exp_f32 v144, v144
 v_cos_f32 v146, v145
 v_sin_f32 v147, v145
 v_pk_mul_f32 v[134:135], v[134:135], v[132:133] op_sel_hi:[1,0]
 v_pk_mul_f32 v[138:139], v[138:139], v[136:137] op_sel_hi:[1,0]
 v_pk_mul_f32 v[142:143], v[142:143], v[140:141] op_sel_hi:[1,0]
 v_pk_mul_f32 v[146:147], v[146:147], v[144:145] op_sel_hi:[1,0]
 v_pk_mul_f32 v[144:145], v[146:147], v[102:103] op_sel_hi:[0,1] neg_hi:[0,1]
 v_cvt_pk_bf16_f32 v107, v134, v135
 v_cvt_pk_bf16_f32 v111, v138, v139
 v_cvt_pk_bf16_f32 v115, v142, v143
 v_pk_fma_f32 v[144:145], v[146:147], v[102:103], v[144:145] op_sel:[1,1,0] op_sel_hi:[1,0,1] neg_lo:[0,1,0] neg_hi:[0,1,0]
 v_cvt_pk_bf16_f32 v119, v144, v145
 s_add_u32 s95, s95, 1
 s_cmp_lt_u32 s95, 8
 v_mfma_f32_16x16x32_bf16 v[120:123], v[104:107], v[116:119], v[120:123]
 v_mfma_f32_16x16x32_bf16 v[124:127], v[108:111], v[116:119], v[124:127]
 v_mfma_f32_16x16x32_bf16 v[128:131], v[112:115], v[116:119], v[128:131]
 s_cbranch_scc1 L_rVb_kg2
 s_waitcnt vmcnt(16)
 s_barrier
 ds_read_b64_tr_b16 a[64:65], v13 offset:0
 ds_read_b64_tr_b16 a[66:67], v13 offset:1024
 ds_read_b64_tr_b16 a[68:69], v13 offset:4096
 ds_read_b64_tr_b16 a[70:71], v13 offset:5120
 ds_read_b64_tr_b16 a[72:73], v13 offset:8192
 ds_read_b64_tr_b16 a[74:75], v13 offset:9216
 ds_read_b64_tr_b16 a[76:77], v13 offset:12288
 ds_read_b64_tr_b16 a[78:79], v13 offset:13312
 s_waitcnt lgkmcnt(0)
 ds_read_b64_tr_b16 a[80:81], v13 offset:16384
 ds_read_b64_tr_b16 a[82:83], v13 offset:17408
 ds_read_b64_tr_b16 a[84:85], v13 offset:20480
 ds_read_b64_tr_b16 a[86:87], v13 offset:21504
 ds_read_b64_tr_b16 a[88:89], v13 offset:24576
 ds_read_b64_tr_b16 a[90:91], v13 offset:25600
 ds_read_b64_tr_b16 a[92:93], v13 offset:28672
 ds_read_b64_tr_b16 a[94:95], v13 offset:29696
 s_waitcnt lgkmcnt(0)
 s_barrier
 s_add_u32 m0, s45, 0
 s_add_u32 s43, s44, 4194304
 buffer_load_dwordx4 v12, s[8:11], s43 offen  lds
 s_add_u32 m0, s45, 1024
 s_add_u32 s43, s44, 4227072
 buffer_load_dwordx4 v12, s[8:11], s43 offen  lds
 s_add_u32 m0, s45, 2048
 s_add_u32 s43, s44, 4259840
 buffer_load_dwordx4 v12, s[8:11], s43 offen  lds
 s_add_u32 m0, s45, 3072
 s_add_u32 s43, s44, 4292608
 buffer_load_dwordx4 v12, s[8:11], s43 offen  lds
 s_add_u32 m0, s45, 4096
 s_add_u32 s43, s44, 4325376
 buffer_load_dwordx4 v12, s[8:11], s43 offen  lds
 s_add_u32 m0, s45, 5120
 s_add_u32 s43, s44, 4358144
 buffer_load_dwordx4 v12, s[8:11], s43 offen  lds
 s_add_u32 m0, s45, 6144
 s_add_u32 s43, s44, 4390912
 buffer_load_dwordx4 v12, s[8:11], s43 offen  lds
 s_add_u32 m0, s45, 7168
 s_add_u32 s43, s44, 4423680
 buffer_load_dwordx4 v12, s[8:11], s43 offen  lds
 v_mov_b32 v250, s34
 v_mov_b32 v251, s35
 v_bfrev_b32 v252, 1
 v_cmp_eq_u32 vcc, 64, v0
 s_nop 1
 v_cndmask_b32 v252, v252, 0, vcc
 buffer_atomic_add_x2 v[250:251], v252, s[12:15], s30 offen sc1
 v_lshlrev_b32 v65, 5, v67
 v_lshl_add_u32 v65, v68, 3, v65
 v_add_u32 v65, s94, v65
 v_lshlrev_b32 v66, 4, v67
 v_lshl_add_u32 v66, v68, 3, v66
 v_lshlrev_b32 v69, 3, v67
 v_lshl_add_u32 v69, v68, 7, v69
 v_cmp_gt_u32 vcc, 2, v68
 s_nop 1
 v_cndmask_b32 v66, v69, v66, vcc
 v_add_u32 v66, s94, v66
 v_lshlrev_b32 v69, 2, v67
 v_lshl_add_u32 v69, v68, 7, v69
 v_add_u32 v69, s94, v69
 v_cvt_pk_bf16_f32 v132, v120, v121
 v_cvt_pk_bf16_f32 v133, v122, v123
 v_cvt_pk_bf16_f32 v134, v124, v125
 v_cvt_pk_bf16_f32 v135, v126, v127
 v_cvt_pk_bf16_f32 v136, v128, v129
 v_cvt_pk_bf16_f32 v137, v130, v131
 ds_write_b64 v65, v[132:133]
 ds_write_b64 v66, v[134:135] offset:512
 ds_write_b32 v69, v136 offset:1024
 ds_write_b32 v69, v137 offset:1088
 v_lshrrev_b32 v65, 2, v0
 v_mul_u32_u24 v65, 80, v65
 v_and_b32 v66, 3, v0
 v_lshl_add_u32 v69, v66, 4, v65
 v_add_u32 v69, 82256, v69
 v_add_u32 v215, 43776, v69
 s_waitcnt vmcnt(17)
 v_perm_b32 v140, v74, v72, s96
 v_perm_b32 v141, v78, v76, s96
 v_perm_b32 v142, v82, v80, s96
 v_perm_b32 v143, v86, v84, s96
 ds_write_b128 v69, v[140:143] offset:0
 v_perm_b32 v144, v74, v72, s97
 v_perm_b32 v145, v78, v76, s97
 v_perm_b32 v146, v82, v80, s97
 v_perm_b32 v147, v86, v84, s97
 ds_write_b128 v69, v[144:147] offset:21888
 v_perm_b32 v148, v75, v73, s96
 v_perm_b32 v149, v79, v77, s96
 v_perm_b32 v150, v83, v81, s96
 v_perm_b32 v151, v87, v85, s96
 ds_write_b128 v215, v[148:151] offset:0
 v_perm_b32 v152, v75, v73, s97
 v_perm_b32 v153, v79, v77, s97
 v_perm_b32 v154, v83, v81, s97
 v_perm_b32 v155, v87, v85, s97
 ds_write_b128 v215, v[152:155] offset:21888
 v_lshlrev_b32 v65, 3, v64
 v_sub_u32 v65, 2047, v65
 v_cvt_f32_u32 v66, v65
 s_sub_u32 s92, s94, 34048
 s_waitcnt lgkmcnt(0)
 v_subrev_f32 v120, 0x0, v66
 v_subrev_f32 v121, 0x3f800000, v66
 v_cvt_pk_bf16_f32 v122, v120, v121
 v_and_b32 v120, 0xffff, v122
 v_lshrrev_b32 v121, 16, v122
 v_lshl_add_u32 v132, v120, 1, s92
 v_lshl_add_u32 v133, v121, 1, s92
 v_subrev_f32 v120, 0x40000000, v66
 v_subrev_f32 v121, 0x40400000, v66
 v_cvt_pk_bf16_f32 v122, v120, v121
 v_and_b32 v120, 0xffff, v122
 v_lshrrev_b32 v121, 16, v122
 v_lshl_add_u32 v134, v120, 1, s92
 v_lshl_add_u32 v135, v121, 1, s92
 v_subrev_f32 v120, 0x40800000, v66
 v_subrev_f32 v121, 0x40a00000, v66
 v_cvt_pk_bf16_f32 v122, v120, v121
 v_and_b32 v120, 0xffff, v122
 v_lshrrev_b32 v121, 16, v122
 v_lshl_add_u32 v136, v120, 1, s92
 v_lshl_add_u32 v137, v121, 1, s92
 v_subrev_f32 v120, 0x40c00000, v66
 v_subrev_f32 v121, 0x40e00000, v66
 v_cvt_pk_bf16_f32 v122, v120, v121
 v_and_b32 v120, 0xffff, v122
 v_lshrrev_b32 v121, 16, v122
 v_lshl_add_u32 v138, v120, 1, s92
 v_lshl_add_u32 v139, v121, 1, s92
 s_waitcnt lgkmcnt(0)
 ds_read_u16 v88, v132
 ds_read_u16 v92, v133
 ds_read_u16 v89, v134
 ds_read_u16 v93, v135
 ds_read_u16 v90, v136
 ds_read_u16 v94, v137
 ds_read_u16 v91, v138
 ds_read_u16 v95, v139
 v_subrev_f32 v120, 0x44000000, v66
 v_subrev_f32 v121, 0x44004000, v66
 v_cvt_pk_bf16_f32 v122, v120, v121
 v_and_b32 v120, 0xffff, v122
 v_lshrrev_b32 v121, 16, v122
 v_lshl_add_u32 v132, v120, 1, s92
 v_lshl_add_u32 v133, v121, 1, s92
 v_subrev_f32 v120, 0x44008000, v66
 v_subrev_f32 v121, 0x4400c000, v66
 v_cvt_pk_bf16_f32 v122, v120, v121
 v_and_b32 v120, 0xffff, v122
 v_lshrrev_b32 v121, 16, v122
 v_lshl_add_u32 v134, v120, 1, s92
 v_lshl_add_u32 v135, v121, 1, s92
 v_subrev_f32 v120, 0x44010000, v66
 v_subrev_f32 v121, 0x44014000, v66
 v_cvt_pk_bf16_f32 v122, v120, v121
 v_and_b32 v120, 0xffff, v122
 v_lshrrev_b32 v121, 16, v122
 v_lshl_add_u32 v136, v120, 1, s92
 v_lshl_add_u32 v137, v121, 1, s92
 v_subrev_f32 v120, 0x44018000, v66
 v_subrev_f32 v121, 0x4401c000, v66
 v_cvt_pk_bf16_f32 v122, v120, v121
 v_and_b32 v120, 0xffff, v122
 v_lshrrev_b32 v121, 16, v122
 v_lshl_add_u32 v138, v120, 1, s92
 v_lshl_add_u32 v139, v121, 1, s92
 s_waitcnt lgkmcnt(0)
 ds_read_u16 v96, v132
 ds_read_u16 v100, v133
 ds_read_u16 v97, v134
 ds_read_u16 v101, v135
 ds_read_u16 v98, v136
 ds_read_u16 v102, v137
 ds_read_u16 v99, v138
 ds_read_u16 v103, v139
 v_subrev_f32 v120, 0x44800000, v66
 v_subrev_f32 v121, 0x44802000, v66
 v_cvt_pk_bf16_f32 v122, v120, v121
 v_and_b32 v120, 0xffff, v122
 v_lshrrev_b32 v121, 16, v122
 v_lshl_add_u32 v132, v120, 1, s92
 v_lshl_add_u32 v133, v121, 1, s92
 v_subrev_f32 v120, 0x44804000, v66
 v_subrev_f32 v121, 0x44806000, v66
 v_cvt_pk_bf16_f32 v122, v120, v121
 v_and_b32 v120, 0xffff, v122
 v_lshrrev_b32 v121, 16, v122
 v_lshl_add_u32 v134, v120, 1, s92
 v_lshl_add_u32 v135, v121, 1, s92
 v_subrev_f32 v120, 0x44808000, v66
 v_subrev_f32 v121, 0x4480a000, v66
 v_cvt_pk_bf16_f32 v122, v120, v121
 v_and_b32 v120, 0xffff, v122
 v_lshrrev_b32 v121, 16, v122
 v_lshl_add_u32 v136, v120, 1, s92
 v_lshl_add_u32 v137, v121, 1, s92
 v_subrev_f32 v120, 0x4480c000, v66
 v_subrev_f32 v121, 0x4480e000, v66
 v_cvt_pk_bf16_f32 v122, v120, v121
 v_and_b32 v120, 0xffff, v122
 v_lshrrev_b32 v121, 16, v122
 v_lshl_add_u32 v138, v120, 1, s92
 v_lshl_add_u32 v139, v121, 1, s92
 s_waitcnt lgkmcnt(0)
 ds_read_u16 v104, v132
 ds_read_u16 v108, v133
 ds_read_u16 v105, v134
 ds_read_u16 v109, v135
 ds_read_u16 v106, v136
 ds_read_u16 v110, v137
 ds_read_u16 v107, v138
 ds_read_u16 v111, v139
 v_subrev_f32 v120, 0x44c00000, v66
 v_subrev_f32 v121, 0x44c02000, v66
 v_cvt_pk_bf16_f32 v122, v120, v121
 v_and_b32 v120, 0xffff, v122
 v_lshrrev_b32 v121, 16, v122
 v_subrev_u32 v122, 1536, v65
 v_min_u32 v122, 128, v122
 v_add_u32 v122, 17024, v122
 v_max_u32 v120, v120, v122
 v_subrev_u32 v122, 1537, v65
 v_min_u32 v122, 128, v122
 v_add_u32 v122, 17024, v122
 v_max_u32 v121, v121, v122
 v_lshl_add_u32 v132, v120, 1, s92
 v_lshl_add_u32 v133, v121, 1, s92
 v_subrev_f32 v120, 0x44c04000, v66
 v_subrev_f32 v121, 0x44c06000, v66
 v_cvt_pk_bf16_f32 v122, v120, v121
 v_and_b32 v120, 0xffff, v122
 v_lshrrev_b32 v121, 16, v122
 v_subrev_u32 v122, 1538, v65
 v_min_u32 v122, 128, v122
 v_add_u32 v122, 17024, v122
 v_max_u32 v120, v120, v122
 v_subrev_u32 v122, 1539, v65
 v_min_u32 v122, 128, v122
 v_add_u32 v122, 17024, v122
 v_max_u32 v121, v121, v122
 v_lshl_add_u32 v134, v120, 1, s92
 v_lshl_add_u32 v135, v121, 1, s92
 v_subrev_f32 v120, 0x44c08000, v66
 v_subrev_f32 v121, 0x44c0a000, v66
 v_cvt_pk_bf16_f32 v122, v120, v121
 v_and_b32 v120, 0xffff, v122
 v_lshrrev_b32 v121, 16, v122
 v_subrev_u32 v122, 1540, v65
 v_min_u32 v122, 128, v122
 v_add_u32 v122, 17024, v122
 v_max_u32 v120, v120, v122
 v_subrev_u32 v122, 1541, v65
 v_min_u32 v122, 128, v122
 v_add_u32 v122, 17024, v122
 v_max_u32 v121, v121, v122
 v_lshl_add_u32 v136, v120, 1, s92
 v_lshl_add_u32 v137, v121, 1, s92
 v_subrev_f32 v120, 0x44c0c000, v66
 v_subrev_f32 v121, 0x44c0e000, v66
 v_cvt_pk_bf16_f32 v122, v120, v121
 v_and_b32 v120, 0xffff, v122
 v_lshrrev_b32 v121, 16, v122
 v_subrev_u32 v122, 1542, v65
 v_min_u32 v122, 128, v122
 v_add_u32 v122, 17024, v122
 v_max_u32 v120, v120, v122
 v_subrev_u32 v122, 1543, v65
 v_min_u32 v122, 128, v122
 v_add_u32 v122, 17024, v122
 v_max_u32 v121, v121, v122
 v_lshl_add_u32 v138, v120, 1, s92
 v_lshl_add_u32 v139, v121, 1, s92
 s_waitcnt lgkmcnt(0)
 ds_read_u16 v112, v132
 ds_read_u16 v116, v133
 ds_read_u16 v113, v134
 ds_read_u16 v117, v135
 ds_read_u16 v114, v136
 ds_read_u16 v118, v137
 ds_read_u16 v115, v138
 ds_read_u16 v119, v139
 v_lshl_add_u32 v65, v64, 4, s94
 v_mov_b32 v120, 0
 v_mov_b32 v121, 0
 v_mov_b32 v122, 0
 v_mov_b32 v123, 0
 v_lshrrev_b32 v66, 2, v64
 v_mul_u32_u24 v66, 4096, v66
 v_add_u32 v66, 4096, v66
 v_cmp_gt_u32 vcc, 16, v64
 v_mov_b32 v67, 16384
 s_nop 0
 v_cndmask_b32 v66, v67, v66, vcc
 v_add_u32 v66, v66, v65
 s_waitcnt lgkmcnt(0)
 s_mov_b64 exec, 0x1fffff
 ds_write_b128 v66, v[120:123]
 s_mov_b64 exec, -1
 v_lshl_or_b32 v88, v92, 16, v88
 v_lshl_or_b32 v89, v93, 16, v89
 v_lshl_or_b32 v90, v94, 16, v90
 v_lshl_or_b32 v91, v95, 16, v91
 ds_write_b128 v65, v[88:91] offset:12480
 v_lshl_or_b32 v96, v100, 16, v96
 v_lshl_or_b32 v97, v101, 16, v97
 v_lshl_or_b32 v98, v102, 16, v98
 v_lshl_or_b32 v99, v103, 16, v99
 ds_write_b128 v65, v[96:99] offset:13504
 v_lshl_or_b32 v104, v108, 16, v104
 v_lshl_or_b32 v105, v109, 16, v105
 v_lshl_or_b32 v106, v110, 16, v106
 v_lshl_or_b32 v107, v111, 16, v107
 ds_write_b128 v65, v[104:107] offset:14528
 v_lshl_or_b32 v112, v116, 16, v112
 v_lshl_or_b32 v113, v117, 16, v113
 v_lshl_or_b32 v114, v118, 16, v114
 v_lshl_or_b32 v115, v119, 16, v115
 ds_write_b128 v65, v[112:115] offset:15552
 s_waitcnt lgkmcnt(0)
 ds_read_b64 v[92:93], v65 offset:12496
 ds_read_b64 v[100:101], v65 offset:13520
 ds_read_b64 v[108:109], v65 offset:14544
 ds_read_b64 v[116:117], v65 offset:15568
 s_waitcnt lgkmcnt(0)
 v_alignbit_b32 v132, v89, v88, 16
 v_mov_b32 v136, v89
 v_alignbit_b32 v140, v90, v89, 16
 v_alignbit_b32 v133, v90, v89, 16
 v_mov_b32 v137, v90
 v_alignbit_b32 v141, v91, v90, 16
 v_alignbit_b32 v134, v91, v90, 16
 v_mov_b32 v138, v91
 v_alignbit_b32 v142, v92, v91, 16
 v_alignbit_b32 v135, v92, v91, 16
 v_mov_b32 v139, v92
 v_alignbit_b32 v143, v93, v92, 16
 ds_write_b128 v65, v[132:135] offset:8320
 ds_write_b128 v65, v[136:139] offset:4160
 ds_write_b128 v65, v[140:143] offset:0
 v_alignbit_b32 v144, v97, v96, 16
 v_mov_b32 v148, v97
 v_alignbit_b32 v152, v98, v97, 16
 v_alignbit_b32 v145, v98, v97, 16
 v_mov_b32 v149, v98
 v_alignbit_b32 v153, v99, v98, 16
 v_alignbit_b32 v146, v99, v98, 16
 v_mov_b32 v150, v99
 v_alignbit_b32 v154, v100, v99, 16
 v_alignbit_b32 v147, v100, v99, 16
 v_mov_b32 v151, v100
 v_alignbit_b32 v155, v101, v100, 16
 ds_write_b128 v65, v[144:147] offset:9344
 ds_write_b128 v65, v[148:151] offset:5184
 ds_write_b128 v65, v[152:155] offset:1024
 v_alignbit_b32 v132, v105, v104, 16
 v_mov_b32 v136, v105
 v_alignbit_b32 v140, v106, v105, 16
 v_alignbit_b32 v133, v106, v105, 16
 v_mov_b32 v137, v106
 v_alignbit_b32 v141, v107, v106, 16
 v_alignbit_b32 v134, v107, v106, 16
 v_mov_b32 v138, v107
 v_alignbit_b32 v142, v108, v107, 16
 v_alignbit_b32 v135, v108, v107, 16
 v_mov_b32 v139, v108
 v_alignbit_b32 v143, v109, v108, 16
 ds_write_b128 v65, v[132:135] offset:10368
 ds_write_b128 v65, v[136:139] offset:6208
 ds_write_b128 v65, v[140:143] offset:2048
 v_alignbit_b32 v144, v113, v112, 16
 v_mov_b32 v148, v113
 v_alignbit_b32 v152, v114, v113, 16
 v_alignbit_b32 v145, v114, v113, 16
 v_mov_b32 v149, v114
 v_alignbit_b32 v153, v115, v114, 16
 v_alignbit_b32 v146, v115, v114, 16
 v_mov_b32 v150, v115
 v_alignbit_b32 v154, v116, v115, 16
 v_alignbit_b32 v147, v116, v115, 16
 v_mov_b32 v151, v116
 v_alignbit_b32 v155, v117, v116, 16
 ds_write_b128 v65, v[144:147] offset:11392
 ds_write_b128 v65, v[148:151] offset:7232
 ds_write_b128 v65, v[152:155] offset:3072
 v_and_b32 v66, 3, v64
 v_mul_u32_u24 v65, 4160, v66
 v_bfe_u32 v66, v64, 3, 1
 v_bfe_u32 v67, v64, 2, 1
 v_lshl_add_u32 v66, v67, 1, v66
 v_bfe_u32 v67, v64, 4, 1
 v_lshl_add_u32 v66, v67, 2, v66
 v_lshlrev_b32 v66, 3, v66
 v_sub_u32 v65, v65, v66
 v_lshrrev_b32 v67, 5, v64
 v_lshl_add_u32 v65, v67, 4, v65
 s_add_u32 s92, s94, 2040
 v_add_u32 v65, s92, v65
 v_and_b32 v66, 31, v64
 v_mul_u32_u24 v66, 80, v66
 v_lshl_add_u32 v67, v67, 4, v66
 s_add_u32 s92, s94, 16720
 v_add_u32 v67, s92, v67
 v_mov_b32 v214, v67
 v_mov_b32 v68, v67
 s_sub_u32 s93, s92, 80
 v_mov_b32 v88, 0
 v_mov_b32 v89, 0
 v_mov_b32 v90, 0
 v_mov_b32 v91, 0
 v_mov_b32 v92, 0
 v_mov_b32 v93, 0
 v_mov_b32 v94, 0
 v_mov_b32 v95, 0
 v_mov_b32 v96, 0
 v_mov_b32 v97, 0
 v_mov_b32 v98, 0
 v_mov_b32 v99, 0
 v_mov_b32 v100, 0
 v_mov_b32 v101, 0
 v_mov_b32 v102, 0
 v_mov_b32 v103, 0
 v_mov_b32 v104, 0
 v_mov_b32 v105, 0
 v_mov_b32 v106, 0
 v_mov_b32 v107, 0
 v_mov_b32 v108, 0
 v_mov_b32 v109, 0
 v_mov_b32 v110, 0
 v_mov_b32 v111, 0
 v_mov_b32 v112, 0
 v_mov_b32 v113, 0
 v_mov_b32 v114, 0
 v_mov_b32 v115, 0
 v_mov_b32 v116, 0
 v_mov_b32 v117, 0
 v_mov_b32 v118, 0
 v_mov_b32 v119, 0
 s_waitcnt lgkmcnt(0)
 s_barrier
 s_waitcnt vmcnt(9)
 s_barrier
 ds_read_b64_tr_b16 a[96:97], v13 offset:32768
 ds_read_b64_tr_b16 a[98:99], v13 offset:33792
 ds_read_b64_tr_b16 a[100:101], v13 offset:36864
 ds_read_b64_tr_b16 a[102:103], v13 offset:37888
 ds_read_b64_tr_b16 a[104:105], v13 offset:40960
 ds_read_b64_tr_b16 a[106:107], v13 offset:41984
 ds_read_b64_tr_b16 a[108:109], v13 offset:45056
 ds_read_b64_tr_b16 a[110:111], v13 offset:46080
 s_waitcnt lgkmcnt(0)
 ds_read_b64_tr_b16 a[112:113], v13 offset:49152
 ds_read_b64_tr_b16 a[114:115], v13 offset:50176
 ds_read_b64_tr_b16 a[116:117], v13 offset:53248
 ds_read_b64_tr_b16 a[118:119], v13 offset:54272
 ds_read_b64_tr_b16 a[120:121], v13 offset:57344
 ds_read_b64_tr_b16 a[122:123], v13 offset:58368
 ds_read_b64_tr_b16 a[124:125], v13 offset:61440
 ds_read_b64_tr_b16 a[126:127], v13 offset:62464
 s_waitcnt lgkmcnt(0)
 s_barrier
 s_add_u32 m0, s45, 32768
 s_add_u32 s43, s44, 5242880
 buffer_load_dwordx4 v12, s[8:11], s43 offen  lds
 s_add_u32 m0, s45, 33792
 s_add_u32 s43, s44, 5275648
 buffer_load_dwordx4 v12, s[8:11], s43 offen  lds
 s_add_u32 m0, s45, 34816
 s_add_u32 s43, s44, 5308416
 buffer_load_dwordx4 v12, s[8:11], s43 offen  lds
 s_add_u32 m0, s45, 35840
 s_add_u32 s43, s44, 5341184
 buffer_load_dwordx4 v12, s[8:11], s43 offen  lds
 s_add_u32 m0, s45, 36864
 s_add_u32 s43, s44, 5373952
 buffer_load_dwordx4 v12, s[8:11], s43 offen  lds
 s_add_u32 m0, s45, 37888
 s_add_u32 s43, s44, 5406720
 buffer_load_dwordx4 v12, s[8:11], s43 offen  lds
 s_add_u32 m0, s45, 38912
 s_add_u32 s43, s44, 5439488
 buffer_load_dwordx4 v12, s[8:11], s43 offen  lds
 s_add_u32 m0, s45, 39936
 s_add_u32 s43, s44, 5472256
 buffer_load_dwordx4 v12, s[8:11], s43 offen  lds
 ds_read_b64 v[120:121], v65 offset:2080
 ds_read_b64 v[122:123], v65 offset:2088
 ds_read_b128 v[128:131], v67 offset:2592
 ds_read_b128 v[132:135], v68 offset:32
 ds_read_b64 v[124:125], v65 offset:32
 ds_read_b64 v[126:127], v65 offset:40
 s_mov_b32 s95, 0
L_rVb_cv0:
 ds_read_b64 v[136:137], v65 offset:2048
 ds_read_b64 v[138:139], v65 offset:2056
 ds_read_b128 v[144:147], v67 offset:2560
 ds_read_b128 v[148:151], v68 offset:0
 ds_read_b64 v[140:141], v65 offset:0
 ds_read_b64 v[142:143], v65 offset:8
 s_waitcnt lgkmcnt(6)
 v_mfma_f32_32x32x16_bf16 v[104:119], v[120:123], v[128:131], v[104:119]
 v_subrev_u32 v65, 64, v65
 v_subrev_u32 v67, 80, v67
 v_max_i32 v68, s93, v67
 v_mfma_f32_32x32x16_bf16 v[88:103], v[120:123], v[132:135], v[88:103]
 v_mfma_f32_32x32x16_bf16 v[104:119], v[124:127], v[132:135], v[104:119]
 ds_read_b64 v[120:121], v65 offset:2080
 ds_read_b64 v[122:123], v65 offset:2088
 ds_read_b128 v[128:131], v67 offset:2592
 ds_read_b128 v[132:135], v68 offset:32
 ds_read_b64 v[124:125], v65 offset:32
 ds_read_b64 v[126:127], v65 offset:40
 s_waitcnt lgkmcnt(6)
 v_mfma_f32_32x32x16_bf16 v[104:119], v[136:139], v[144:147], v[104:119]
 s_add_u32 s95, s95, 1
 s_cmp_lt_u32 s95, 8
 v_mfma_f32_32x32x16_bf16 v[88:103], v[136:139], v[148:151], v[88:103]
 v_mfma_f32_32x32x16_bf16 v[104:119], v[140:143], v[148:151], v[104:119]
 s_cbranch_scc1 L_rVb_cv0
 s_waitcnt vmcnt(9)
 s_barrier
 ds_read_b64_tr_b16 a[128:129], v13 offset:0
 ds_read_b64_tr_b16 a[130:131], v13 offset:1024
 ds_read_b64_tr_b16 a[132:133], v13 offset:4096
 ds_read_b64_tr_b16 a[134:135], v13 offset:5120
 ds_read_b64_tr_b16 a[136:137], v13 offset:8192
 ds_read_b64_tr_b16 a[138:139], v13 offset:9216
 ds_read_b64_tr_b16 a[140:141], v13 offset:12288
 ds_read_b64_tr_b16 a[142:143], v13 offset:13312
 s_waitcnt lgkmcnt(0)
 ds_read_b64_tr_b16 a[144:145], v13 offset:16384
 ds_read_b64_tr_b16 a[146:147], v13 offset:17408
 ds_read_b64_tr_b16 a[148:149], v13 offset:20480
 ds_read_b64_tr_b16 a[150:151], v13 offset:21504
 ds_read_b64_tr_b16 a[152:153], v13 offset:24576
 ds_read_b64_tr_b16 a[154:155], v13 offset:25600
 ds_read_b64_tr_b16 a[156:157], v13 offset:28672
 ds_read_b64_tr_b16 a[158:159], v13 offset:29696
 s_waitcnt lgkmcnt(0)
 s_barrier
 s_add_u32 m0, s45, 0
 s_add_u32 s43, s44, 6291456
 buffer_load_dwordx4 v12, s[8:11], s43 offen  lds
 s_add_u32 m0, s45, 1024
 s_add_u32 s43, s44, 6324224
 buffer_load_dwordx4 v12, s[8:11], s43 offen  lds
 s_add_u32 m0, s45, 2048
 s_add_u32 s43, s44, 6356992
 buffer_load_dwordx4 v12, s[8:11], s43 offen  lds
 s_add_u32 m0, s45, 3072
 s_add_u32 s43, s44, 6389760
 buffer_load_dwordx4 v12, s[8:11], s43 offen  lds
 s_add_u32 m0, s45, 4096
 s_add_u32 s43, s44, 6422528
 buffer_load_dwordx4 v12, s[8:11], s43 offen  lds
 s_add_u32 m0, s45, 5120
 s_add_u32 s43, s44, 6455296
 buffer_load_dwordx4 v12, s[8:11], s43 offen  lds
 s_add_u32 m0, s45, 6144
 s_add_u32 s43, s44, 6488064
 buffer_load_dwordx4 v12, s[8:11], s43 offen  lds
 s_add_u32 m0, s45, 7168
 s_add_u32 s43, s44, 6520832
 buffer_load_dwordx4 v12, s[8:11], s43 offen  lds
 s_mov_b32 s95, 0
L_rVb_cv1:
 ds_read_b64 v[136:137], v65 offset:2048
 ds_read_b64 v[138:139], v65 offset:2056
 ds_read_b128 v[144:147], v67 offset:2560
 ds_read_b128 v[148:151], v68 offset:0
 ds_read_b64 v[140:141], v65 offset:0
 ds_read_b64 v[142:143], v65 offset:8
 s_waitcnt lgkmcnt(6)
 v_mfma_f32_32x32x16_bf16 v[104:119], v[120:123], v[128:131], v[104:119]
 v_subrev_u32 v65, 64, v65
 v_subrev_u32 v67, 80, v67
 v_max_i32 v68, s93, v67
 v_mfma_f32_32x32x16_bf16 v[88:103], v[120:123], v[132:135], v[88:103]
 v_mfma_f32_32x32x16_bf16 v[104:119], v[124:127], v[132:135], v[104:119]
 ds_read_b64 v[120:121], v65 offset:2080
 ds_read_b64 v[122:123], v65 offset:2088
 ds_read_b128 v[128:131], v67 offset:2592
 ds_read_b128 v[132:135], v68 offset:32
 ds_read_b64 v[124:125], v65 offset:32
 ds_read_b64 v[126:127], v65 offset:40
 s_waitcnt lgkmcnt(6)
 v_mfma_f32_32x32x16_bf16 v[104:119], v[136:139], v[144:147], v[104:119]
 s_add_u32 s95, s95, 1
 s_cmp_lt_u32 s95, 8
 v_mfma_f32_32x32x16_bf16 v[88:103], v[136:139], v[148:151], v[88:103]
 v_mfma_f32_32x32x16_bf16 v[104:119], v[140:143], v[148:151], v[104:119]
 s_cbranch_scc1 L_rVb_cv1
 s_waitcnt vmcnt(8)
 s_barrier
 ds_read_b64_tr_b16 a[160:161], v13 offset:32768
 ds_read_b64_tr_b16 a[162:163], v13 offset:33792
 ds_read_b64_tr_b16 a[164:165], v13 offset:36864
 ds_read_b64_tr_b16 a[166:167], v13 offset:37888
 ds_read_b64_tr_b16 a[168:169], v13 offset:40960
 ds_read_b64_tr_b16 a[170:171], v13 offset:41984
 ds_read_b64_tr_b16 a[172:173], v13 offset:45056
 ds_read_b64_tr_b16 a[174:175], v13 offset:46080
 s_waitcnt lgkmcnt(0)
 ds_read_b64_tr_b16 a[176:177], v13 offset:49152
 ds_read_b64_tr_b16 a[178:179], v13 offset:50176
 ds_read_b64_tr_b16 a[180:181], v13 offset:53248
 ds_read_b64_tr_b16 a[182:183], v13 offset:54272
 ds_read_b64_tr_b16 a[184:185], v13 offset:57344
 ds_read_b64_tr_b16 a[186:187], v13 offset:58368
 ds_read_b64_tr_b16 a[188:189], v13 offset:61440
 ds_read_b64_tr_b16 a[190:191], v13 offset:62464
 s_waitcnt lgkmcnt(0)
 s_barrier
 s_add_u32 m0, s45, 32768
 s_add_u32 s43, s44, 7340032
 buffer_load_dwordx4 v12, s[8:11], s43 offen  lds
 s_add_u32 m0, s45, 33792
 s_add_u32 s43, s44, 7372800
 buffer_load_dwordx4 v12, s[8:11], s43 offen  lds
 s_add_u32 m0, s45, 34816
 s_add_u32 s43, s44, 7405568
 buffer_load_dwordx4 v12, s[8:11], s43 offen  lds
 s_add_u32 m0, s45, 35840
 s_add_u32 s43, s44, 7438336
 buffer_load_dwordx4 v12, s[8:11], s43 offen  lds
 s_add_u32 m0, s45, 36864
 s_add_u32 s43, s44, 7471104
 buffer_load_dwordx4 v12, s[8:11], s43 offen  lds
 s_add_u32 m0, s45, 37888
 s_add_u32 s43, s44, 7503872
 buffer_load_dwordx4 v12, s[8:11], s43 offen  lds
 s_add_u32 m0, s45, 38912
 s_add_u32 s43, s44, 7536640
 buffer_load_dwordx4 v12, s[8:11], s43 offen  lds
 s_add_u32 m0, s45, 39936
 s_add_u32 s43, s44, 7569408
 buffer_load_dwordx4 v12, s[8:11], s43 offen  lds
 s_mov_b32 s95, 0
L_rVb_cv2:
 ds_read_b64 v[136:137], v65 offset:2048
 ds_read_b64 v[138:139], v65 offset:2056
 ds_read_b128 v[144:147], v67 offset:2560
 ds_read_b128 v[148:151], v68 offset:0
 ds_read_b64 v[140:141], v65 offset:0
 ds_read_b64 v[142:143], v65 offset:8
 s_waitcnt lgkmcnt(6)
 v_mfma_f32_32x32x16_bf16 v[104:119], v[120:123], v[128:131], v[104:119]
 v_subrev_u32 v65, 64, v65
 v_subrev_u32 v67, 80, v67
 v_max_i32 v68, s93, v67
 v_mfma_f32_32x32x16_bf16 v[88:103], v[120:123], v[132:135], v[88:103]
 v_mfma_f32_32x32x16_bf16 v[104:119], v[124:127], v[132:135], v[104:119]
 ds_read_b64 v[120:121], v65 offset:2080
 ds_read_b64 v[122:123], v65 offset:2088
 ds_read_b128 v[128:131], v67 offset:2592
 ds_read_b128 v[132:135], v68 offset:32
 ds_read_b64 v[124:125], v65 offset:32
 ds_read_b64 v[126:127], v65 offset:40
 s_waitcnt lgkmcnt(6)
 v_mfma_f32_32x32x16_bf16 v[104:119], v[136:139], v[144:147], v[104:119]
 s_add_u32 s95, s95, 1
 s_cmp_lt_u32 s95, 8
 v_mfma_f32_32x32x16_bf16 v[88:103], v[136:139], v[148:151], v[88:103]
 v_mfma_f32_32x32x16_bf16 v[104:119], v[140:143], v[148:151], v[104:119]
 s_cbranch_scc1 L_rVb_cv2
 s_waitcnt vmcnt(8)
 s_barrier
 ds_read_b64_tr_b16 a[192:193], v13 offset:0
 ds_read_b64_tr_b16 a[194:195], v13 offset:1024
 ds_read_b64_tr_b16 a[196:197], v13 offset:4096
 ds_read_b64_tr_b16 a[198:199], v13 offset:5120
 ds_read_b64_tr_b16 a[200:201], v13 offset:8192
 ds_read_b64_tr_b16 a[202:203], v13 offset:9216
 ds_read_b64_tr_b16 a[204:205], v13 offset:12288
 ds_read_b64_tr_b16 a[206:207], v13 offset:13312
 s_waitcnt lgkmcnt(0)
 ds_read_b64_tr_b16 a[208:209], v13 offset:16384
 ds_read_b64_tr_b16 a[210:211], v13 offset:17408
 ds_read_b64_tr_b16 a[212:213], v13 offset:20480
 ds_read_b64_tr_b16 a[214:215], v13 offset:21504
 ds_read_b64_tr_b16 a[216:217], v13 offset:24576
 ds_read_b64_tr_b16 a[218:219], v13 offset:25600
 ds_read_b64_tr_b16 a[220:221], v13 offset:28672
 ds_read_b64_tr_b16 a[222:223], v13 offset:29696
 s_waitcnt lgkmcnt(0)
 s_mov_b32 s95, 0
L_rVb_cv3:
 ds_read_b64 v[136:137], v65 offset:2048
 ds_read_b64 v[138:139], v65 offset:2056
 ds_read_b128 v[144:147], v67 offset:2560
 ds_read_b128 v[148:151], v68 offset:0
 ds_read_b64 v[140:141], v65 offset:0
 ds_read_b64 v[142:143], v65 offset:8
 s_waitcnt lgkmcnt(6)
 v_mfma_f32_32x32x16_bf16 v[104:119], v[120:123], v[128:131], v[104:119]
 v_subrev_u32 v65, 64, v65
 v_subrev_u32 v67, 80, v67
 v_max_i32 v68, s93, v67
 v_mfma_f32_32x32x16_bf16 v[88:103], v[120:123], v[132:135], v[88:103]
 v_mfma_f32_32x32x16_bf16 v[104:119], v[124:127], v[132:135], v[104:119]
 ds_read_b64 v[120:121], v65 offset:2080
 ds_read_b64 v[122:123], v65 offset:2088
 ds_read_b128 v[128:131], v67 offset:2592
 ds_read_b128 v[132:135], v68 offset:32
 ds_read_b64 v[124:125], v65 offset:32
 ds_read_b64 v[126:127], v65 offset:40
 s_waitcnt lgkmcnt(6)
 v_mfma_f32_32x32x16_bf16 v[104:119], v[136:139], v[144:147], v[104:119]
 s_add_u32 s95, s95, 1
 s_cmp_lt_u32 s95, 8
 v_mfma_f32_32x32x16_bf16 v[88:103], v[136:139], v[148:151], v[88:103]
 v_mfma_f32_32x32x16_bf16 v[104:119], v[140:143], v[148:151], v[104:119]
 s_cbranch_scc1 L_rVb_cv3
 s_waitcnt vmcnt(0)
 s_barrier
 ds_read_b64_tr_b16 a[224:225], v13 offset:32768
 ds_read_b64_tr_b16 a[226:227], v13 offset:33792
 ds_read_b64_tr_b16 a[228:229], v13 offset:36864
 ds_read_b64_tr_b16 a[230:231], v13 offset:37888
 ds_read_b64_tr_b16 a[232:233], v13 offset:40960
 ds_read_b64_tr_b16 a[234:235], v13 offset:41984
 ds_read_b64_tr_b16 a[236:237], v13 offset:45056
 ds_read_b64_tr_b16 a[238:239], v13 offset:46080
 s_waitcnt lgkmcnt(0)
 ds_read_b64_tr_b16 a[240:241], v13 offset:49152
 ds_read_b64_tr_b16 a[242:243], v13 offset:50176
 ds_read_b64_tr_b16 a[244:245], v13 offset:53248
 ds_read_b64_tr_b16 a[246:247], v13 offset:54272
 ds_read_b64_tr_b16 a[248:249], v13 offset:57344
 ds_read_b64_tr_b16 a[250:251], v13 offset:58368
 ds_read_b64_tr_b16 a[252:253], v13 offset:61440
 ds_read_b64_tr_b16 a[254:255], v13 offset:62464
 s_waitcnt lgkmcnt(0)
 s_load_dwordx2 s[84:85], s[0:1], 128
 s_mov_b32 s86, 8388608
 s_mov_b32 s87, 0x20000
 s_lshl_b32 s90, s89, 16
 s_and_b32 s91, s89, s98
 s_and_b32 s89, s88, s98
 s_lshl_b32 s88, s88, 16
 v_lshlrev_b32 v70, 1, v70
 s_lshl_b32 s93, s28, 3
 s_add_u32 s93, s93, 2048
 s_waitcnt lgkmcnt(0)
 s_nop 1
 v_cvt_pk_bf16_f32 v152, v88, v89
 v_cvt_pk_bf16_f32 v153, v90, v91
 v_cvt_pk_bf16_f32 v154, v92, v93
 v_cvt_pk_bf16_f32 v155, v94, v95
 v_cvt_pk_bf16_f32 v156, v96, v97
 v_cvt_pk_bf16_f32 v157, v98, v99
 v_cvt_pk_bf16_f32 v158, v100, v101
 v_cvt_pk_bf16_f32 v159, v102, v103
 ds_write_b128 v214, v[152:155] offset:0
 ds_write_b128 v214, v[156:159] offset:32
 v_cvt_pk_bf16_f32 v160, v104, v105
 v_cvt_pk_bf16_f32 v161, v106, v107
 v_cvt_pk_bf16_f32 v162, v108, v109
 v_cvt_pk_bf16_f32 v163, v110, v111
 v_cvt_pk_bf16_f32 v164, v112, v113
 v_cvt_pk_bf16_f32 v165, v114, v115
 v_cvt_pk_bf16_f32 v166, v116, v117
 v_cvt_pk_bf16_f32 v167, v118, v119
 ds_write_b128 v214, v[160:163] offset:2560
 ds_write_b128 v214, v[164:167] offset:2592
 s_waitcnt lgkmcnt(0)
 s_barrier
 ds_read_b128 v[88:91], v69 offset:0
 ds_read_b128 v[92:95], v69 offset:21888
 ds_read_b128 v[96:99], v215 offset:0
 ds_read_b128 v[100:103], v215 offset:21888
 v_lshlrev_b32 v104, 16, v72
 v_and_b32 v105, s98, v72
 v_pk_mul_f32 v[104:105], v[104:105], s[88:89]
 v_cvt_pk_bf16_f32 v72, v104, v105
 v_lshlrev_b32 v104, 16, v72
 v_and_b32 v105, s98, v72
 v_lshlrev_b32 v106, 16, v73
 v_and_b32 v107, s98, v73
 v_pk_mul_f32 v[106:107], v[106:107], s[90:91]
 v_cvt_pk_bf16_f32 v73, v106, v107
 v_lshlrev_b32 v106, 16, v73
 v_and_b32 v107, s98, v73
 v_lshlrev_b32 v108, 16, v74
 v_and_b32 v109, s98, v74
 v_pk_mul_f32 v[108:109], v[108:109], s[88:89]
 v_cvt_pk_bf16_f32 v74, v108, v109
 v_lshlrev_b32 v108, 16, v74
 v_and_b32 v109, s98, v74
 v_lshlrev_b32 v110, 16, v75
 v_and_b32 v111, s98, v75
 v_pk_mul_f32 v[110:111], v[110:111], s[90:91]
 v_cvt_pk_bf16_f32 v75, v110, v111
 v_lshlrev_b32 v110, 16, v75
 v_and_b32 v111, s98, v75
 v_lshlrev_b32 v112, 16, v76
 v_and_b32 v113, s98, v76
 v_pk_mul_f32 v[112:113], v[112:113], s[88:89]
 v_cvt_pk_bf16_f32 v76, v112, v113
 v_lshlrev_b32 v112, 16, v76
 v_and_b32 v113, s98, v76
 v_lshlrev_b32 v114, 16, v77
 v_and_b32 v115, s98, v77
 v_pk_mul_f32 v[114:115], v[114:115], s[90:91]
 v_cvt_pk_bf16_f32 v77, v114, v115
 v_lshlrev_b32 v114, 16, v77
 v_and_b32 v115, s98, v77
 v_lshlrev_b32 v116, 16, v78
 v_and_b32 v117, s98, v78
 v_pk_mul_f32 v[116:117], v[116:117], s[88:89]
 v_cvt_pk_bf16_f32 v78, v116, v117
 v_lshlrev_b32 v116, 16, v78
 v_and_b32 v117, s98, v78
 v_lshlrev_b32 v118, 16, v79
 v_and_b32 v119, s98, v79
 v_pk_mul_f32 v[118:119], v[118:119], s[90:91]
 v_cvt_pk_bf16_f32 v79, v118, v119
 v_lshlrev_b32 v118, 16, v79
 v_and_b32 v119, s98, v79
 v_lshlrev_b32 v120, 16, v80
 v_and_b32 v121, s98, v80
 v_pk_mul_f32 v[120:121], v[120:121], s[88:89]
 v_cvt_pk_bf16_f32 v80, v120, v121
 v_lshlrev_b32 v120, 16, v80
 v_and_b32 v121, s98, v80
 v_lshlrev_b32 v122, 16, v81
 v_and_b32 v123, s98, v81
 v_pk_mul_f32 v[122:123], v[122:123], s[90:91]
 v_cvt_pk_bf16_f32 v81, v122, v123
 v_lshlrev_b32 v122, 16, v81
 v_and_b32 v123, s98, v81
 v_lshlrev_b32 v124, 16, v82
 v_and_b32 v125, s98, v82
 v_pk_mul_f32 v[124:125], v[124:125], s[88:89]
 v_cvt_pk_bf16_f32 v82, v124, v125
 v_lshlrev_b32 v124, 16, v82
 v_and_b32 v125, s98, v82
 v_lshlrev_b32 v126, 16, v83
 v_and_b32 v127, s98, v83
 v_pk_mul_f32 v[126:127], v[126:127], s[90:91]
 v_cvt_pk_bf16_f32 v83, v126, v127
 v_lshlrev_b32 v126, 16, v83
 v_and_b32 v127, s98, v83
 v_lshlrev_b32 v128, 16, v84
 v_and_b32 v129, s98, v84
 v_pk_mul_f32 v[128:129], v[128:129], s[88:89]
 v_cvt_pk_bf16_f32 v84, v128, v129
 v_lshlrev_b32 v128, 16, v84
 v_and_b32 v129, s98, v84
 v_lshlrev_b32 v130, 16, v85
 v_and_b32 v131, s98, v85
 v_pk_mul_f32 v[130:131], v[130:131], s[90:91]
 v_cvt_pk_bf16_f32 v85, v130, v131
 v_lshlrev_b32 v130, 16, v85
 v_and_b32 v131, s98, v85
 v_lshlrev_b32 v132, 16, v86
 v_and_b32 v133, s98, v86
 v_pk_mul_f32 v[132:133], v[132:133], s[88:89]
 v_cvt_pk_bf16_f32 v86, v132, v133
 v_lshlrev_b32 v132, 16, v86
 v_and_b32 v133, s98, v86
 v_lshlrev_b32 v134, 16, v87
 v_and_b32 v135, s98, v87
 v_pk_mul_f32 v[134:135], v[134:135], s[90:91]
 v_cvt_pk_bf16_f32 v87, v134, v135
 v_lshlrev_b32 v134, 16, v87
 v_and_b32 v135, s98, v87
 s_waitcnt lgkmcnt(0)
 v_lshlrev_b32 v136, 16, v88
 v_lshlrev_b32 v137, 16, v92
 v_lshlrev_b32 v138, 16, v96
 v_lshlrev_b32 v139, 16, v100
 v_pk_add_f32 v[104:105], v[104:105], v[136:137]
 v_cvt_pk_bf16_f32 v72, v104, v105
 v_pk_add_f32 v[106:107], v[106:107], v[138:139]
 v_cvt_pk_bf16_f32 v73, v106, v107
 buffer_store_dwordx2 v[72:73], v70, s[84:87], s93 offen
 s_add_u32 s93, s93, 4096
 v_and_b32 v136, s98, v88
 v_and_b32 v137, s98, v92
 v_and_b32 v138, s98, v96
 v_and_b32 v139, s98, v100
 v_pk_add_f32 v[108:109], v[108:109], v[136:137]
 v_cvt_pk_bf16_f32 v74, v108, v109
 v_pk_add_f32 v[110:111], v[110:111], v[138:139]
 v_cvt_pk_bf16_f32 v75, v110, v111
 buffer_store_dwordx2 v[74:75], v70, s[84:87], s93 offen
 s_add_u32 s93, s93, 4096
 v_lshlrev_b32 v136, 16, v89
 v_lshlrev_b32 v137, 16, v93
 v_lshlrev_b32 v138, 16, v97
 v_lshlrev_b32 v139, 16, v101
 v_pk_add_f32 v[112:113], v[112:113], v[136:137]
 v_cvt_pk_bf16_f32 v76, v112, v113
 v_pk_add_f32 v[114:115], v[114:115], v[138:139]
 v_cvt_pk_bf16_f32 v77, v114, v115
 buffer_store_dwordx2 v[76:77], v70, s[84:87], s93 offen
 s_add_u32 s93, s93, 4096
 v_and_b32 v136, s98, v89
 v_and_b32 v137, s98, v93
 v_and_b32 v138, s98, v97
 v_and_b32 v139, s98, v101
 v_pk_add_f32 v[116:117], v[116:117], v[136:137]
 v_cvt_pk_bf16_f32 v78, v116, v117
 v_pk_add_f32 v[118:119], v[118:119], v[138:139]
 v_cvt_pk_bf16_f32 v79, v118, v119
 buffer_store_dwordx2 v[78:79], v70, s[84:87], s93 offen
 s_add_u32 s93, s93, 4096
 v_lshlrev_b32 v136, 16, v90
 v_lshlrev_b32 v137, 16, v94
 v_lshlrev_b32 v138, 16, v98
 v_lshlrev_b32 v139, 16, v102
 v_pk_add_f32 v[120:121], v[120:121], v[136:137]
 v_cvt_pk_bf16_f32 v80, v120, v121
 v_pk_add_f32 v[122:123], v[122:123], v[138:139]
 v_cvt_pk_bf16_f32 v81, v122, v123
 buffer_store_dwordx2 v[80:81], v70, s[84:87], s93 offen
 s_add_u32 s93, s93, 4096
 v_and_b32 v136, s98, v90
 v_and_b32 v137, s98, v94
 v_and_b32 v138, s98, v98
 v_and_b32 v139, s98, v102
 v_pk_add_f32 v[124:125], v[124:125], v[136:137]
 v_cvt_pk_bf16_f32 v82, v124, v125
 v_pk_add_f32 v[126:127], v[126:127], v[138:139]
 v_cvt_pk_bf16_f32 v83, v126, v127
 buffer_store_dwordx2 v[82:83], v70, s[84:87], s93 offen
 s_add_u32 s93, s93, 4096
 v_lshlrev_b32 v136, 16, v91
 v_lshlrev_b32 v137, 16, v95
 v_lshlrev_b32 v138, 16, v99
 v_lshlrev_b32 v139, 16, v103
 v_pk_add_f32 v[128:129], v[128:129], v[136:137]
 v_cvt_pk_bf16_f32 v84, v128, v129
 v_pk_add_f32 v[130:131], v[130:131], v[138:139]
 v_cvt_pk_bf16_f32 v85, v130, v131
 buffer_store_dwordx2 v[84:85], v70, s[84:87], s93 offen
 s_add_u32 s93, s93, 4096
 v_and_b32 v136, s98, v91
 v_and_b32 v137, s98, v95
 v_and_b32 v138, s98, v99
 v_and_b32 v139, s98, v103
 v_pk_add_f32 v[132:133], v[132:133], v[136:137]
 v_cvt_pk_bf16_f32 v86, v132, v133
 v_pk_add_f32 v[134:135], v[134:135], v[138:139]
 v_cvt_pk_bf16_f32 v87, v134, v135
 buffer_store_dwordx2 v[86:87], v70, s[84:87], s93 offen
 s_add_u32 s93, s93, 4096
 s_barrier
 s_mov_b32 s3, 0
L_rdy_7:
 buffer_load_dwordx4 v[84:87], off, s[12:15], s30 sc1
 s_add_u32 s3, s3, 1
 s_cmp_gt_u32 s3, 400000
 s_cbranch_scc1 L_exit
 s_waitcnt vmcnt(0)
 v_readfirstlane_b32 s32, v84
 v_readfirstlane_b32 s33, v85
 v_readfirstlane_b32 vcc_hi, v86
 s_and_b32 vcc_lo, s32, 0xffff
 s_cmp_lt_u32 vcc_lo, 256
 s_cbranch_scc1 L_rdy_7
 s_cmp_lg_u32 vcc_hi, 0
 s_cbranch_scc1 L_general
 s_load_dwordx2 s[36:37], s[0:1], 0
 s_mov_b32 s38, 4194304
 s_mov_b32 s39, 0x20000
 s_lshl_b32 s44, s26, 14
 s_mul_i32 s45, s26, 16512
 s_lshl_b32 s41, s25, 2
 s_add_u32 s41, s41, s26
 s_lshl_b32 s46, s41, 11
 s_add_u32 s46, s46, 33554432
 s_waitcnt lgkmcnt(0)
 v_mov_b32 v15, 0
 v_and_b32 v255, 15, v1
 v_lshlrev_b32 v255, 2, v255
 s_mov_b32 s56, 0
 s_mov_b32 s57, 0
 s_mov_b32 s58, 0
 s_mov_b32 s59, 0
 s_mov_b32 s60, 0
 s_mov_b32 s61, 0
 s_mov_b32 s62, 0
 s_mov_b32 s63, 0
 s_mov_b32 s64, 0
 s_mov_b32 s65, 0
 s_mov_b32 s66, 0
 s_mov_b32 s67, 0
 s_mov_b32 s68, 0
 s_mov_b32 s69, 0
 s_mov_b32 s70, 0
 s_mov_b32 s71, 0
 s_mov_b32 s40, 0
 s_add_u32 m0, s45, 0
 s_add_u32 s43, s44, 0
 buffer_load_dwordx4 v2, s[36:39], s43 offen offset:0 lds
 buffer_load_dwordx4 v2, s[36:39], s43 offen offset:1024 lds
 s_add_u32 m0, s45, 2064
 s_add_u32 s43, s44, 2048
 buffer_load_dwordx4 v2, s[36:39], s43 offen offset:0 lds
 buffer_load_dwordx4 v2, s[36:39], s43 offen offset:1024 lds
 s_add_u32 m0, s45, 4128
 s_add_u32 s43, s44, 4096
 buffer_load_dwordx4 v2, s[36:39], s43 offen offset:0 lds
 buffer_load_dwordx4 v2, s[36:39], s43 offen offset:1024 lds
 s_add_u32 m0, s45, 6192
 s_add_u32 s43, s44, 6144
 buffer_load_dwordx4 v2, s[36:39], s43 offen offset:0 lds
 buffer_load_dwordx4 v2, s[36:39], s43 offen offset:1024 lds
 s_add_u32 m0, s45, 8256
 s_add_u32 s43, s44, 8192
 buffer_load_dwordx4 v2, s[36:39], s43 offen offset:0 lds
 buffer_load_dwordx4 v2, s[36:39], s43 offen offset:1024 lds
 s_add_u32 m0, s45, 10320
 s_add_u32 s43, s44, 10240
 buffer_load_dwordx4 v2, s[36:39], s43 offen offset:0 lds
 buffer_load_dwordx4 v2, s[36:39], s43 offen offset:1024 lds
 s_add_u32 m0, s45, 12384
 s_add_u32 s43, s44, 12288
 buffer_load_dwordx4 v2, s[36:39], s43 offen offset:0 lds
 buffer_load_dwordx4 v2, s[36:39], s43 offen offset:1024 lds
 s_add_u32 m0, s45, 14448
 s_add_u32 s43, s44, 14336
 buffer_load_dwordx4 v2, s[36:39], s43 offen offset:0 lds
 buffer_load_dwordx4 v2, s[36:39], s43 offen offset:1024 lds
 s_waitcnt vmcnt(0)
 s_barrier
 ds_read_b128 v[16:19], v10 offset:0
 ds_read_b128 v[20:23], v10 offset:32
 ds_read_b128 v[24:27], v10 offset:64
 ds_read_b128 v[28:31], v10 offset:96
 ds_read_b128 v[32:35], v10 offset:128
 ds_read_b128 v[36:39], v10 offset:160
 s_add_u32 s46, s46, 1073479680
 v_and_b32 v3, 31, v1
 v_lshrrev_b32 v4, 5, v1
 v_lshlrev_b32 v12, 4, v3
 v_lshl_add_u32 v12, v4, 7, v12
 v_cmp_gt_u32 vcc, 8, v3
 v_and_b32 v13, 15, v5
 v_lshlrev_b32 v13, 2, v13
 v_lshl_add_u32 v13, v4, 7, v13
 v_lshrrev_b32 v5, 4, v5
 v_lshl_add_u32 v13, v5, 8, v13
 v_cndmask_b32 v12, v7, v12, vcc
 v_lshlrev_b32 v4, 3, v4
 v_sub_u32 v3, v3, v4
 v_mov_b32 v4, 0xf149f2ca
 v_cmp_gt_i32 vcc, 0, v3
 s_nop 1
 v_cndmask_b32 v232, 0, v4, vcc
 v_cmp_gt_i32 vcc, 1, v3
 s_nop 1
 v_cndmask_b32 v233, 0, v4, vcc
 v_cmp_gt_i32 vcc, 2, v3
 s_nop 1
 v_cndmask_b32 v234, 0, v4, vcc
 v_cmp_gt_i32 vcc, 3, v3
 s_nop 1
 v_cndmask_b32 v235, 0, v4, vcc
 v_cmp_gt_i32 vcc, 4, v3
 s_nop 1
 v_cndmask_b32 v236, 0, v4, vcc
 v_cmp_gt_i32 vcc, 5, v3
 s_nop 1
 v_cndmask_b32 v237, 0, v4, vcc
 v_cmp_gt_i32 vcc, 6, v3
 s_nop 1
 v_cndmask_b32 v238, 0, v4, vcc
 v_cmp_gt_i32 vcc, 7, v3
 s_nop 1
 v_cndmask_b32 v239, 0, v4, vcc
 v_cmp_gt_i32 vcc, 16, v3
 s_nop 1
 v_cndmask_b32 v240, 0, v4, vcc
 v_cmp_gt_i32 vcc, 17, v3
 s_nop 1
 v_cndmask_b32 v241, 0, v4, vcc
 v_cmp_gt_i32 vcc, 18, v3
 s_nop 1
 v_cndmask_b32 v242, 0, v4, vcc
 v_cmp_gt_i32 vcc, 19, v3
 s_nop 1
 v_cndmask_b32 v243, 0, v4, vcc
 v_cmp_gt_i32 vcc, 20, v3
 s_nop 1
 v_cndmask_b32 v244, 0, v4, vcc
 v_cmp_gt_i32 vcc, 21, v3
 s_nop 1
 v_cndmask_b32 v245, 0, v4, vcc
 v_cmp_gt_i32 vcc, 22, v3
 s_nop 1
 v_cndmask_b32 v246, 0, v4, vcc
 v_cmp_gt_i32 vcc, 23, v3
 s_nop 1
 v_cndmask_b32 v247, 0, v4, vcc
 v_mov_b32 v248, 0x3e0293ee
 s_lshl_b32 s47, s51, 7
 s_add_u32 s47, s47, 3735552
 s_mov_b32 s53, 0x40000000
 v_cmp_eq_u32 vcc, 0, v1
 v_mov_b32 v252, 0
 s_nop 0
 v_cndmask_b32 v14, v7, 0, vcc
L_rV_loop:
 s_waitcnt lgkmcnt(5)
 v_mfma_f32_32x32x16_bf16 v[48:63], v[16:19], a[0:3], 0
 ds_read_b128 v[40:43], v10 offset:192
 s_add_u32 s44, s44, 65536
 s_add_u32 m0, s45, 66048
 s_add_u32 s43, s44, 0
 buffer_load_dwordx4 v2, s[36:39], s43 offen offset:0 lds
 s_waitcnt lgkmcnt(5)
 v_mfma_f32_32x32x16_bf16 v[48:63], v[20:23], a[4:7], v[48:63]
 ds_read_b128 v[44:47], v10 offset:224
 s_waitcnt lgkmcnt(5)
 v_mfma_f32_32x32x16_bf16 v[48:63], v[24:27], a[8:11], v[48:63]
 ds_read_b128 v[16:19], v10 offset:256
 buffer_load_dwordx4 v2, s[36:39], s43 offen offset:1024 lds
 s_waitcnt lgkmcnt(5)
 v_mfma_f32_32x32x16_bf16 v[48:63], v[28:31], a[12:15], v[48:63]
 ds_read_b128 v[20:23], v10 offset:288
 s_waitcnt lgkmcnt(5)
 v_mfma_f32_32x32x16_bf16 v[48:63], v[32:35], a[16:19], v[48:63]
 ds_read_b128 v[24:27], v10 offset:320
 s_add_u32 m0, s45, 68112
 s_add_u32 s43, s44, 2048
 buffer_load_dwordx4 v2, s[36:39], s43 offen offset:0 lds
 v_cvt_pk_bf16_f32 v80, v64, v65
 v_cvt_pk_bf16_f32 v81, v66, v67
 s_waitcnt lgkmcnt(5)
 v_mfma_f32_32x32x16_bf16 v[48:63], v[36:39], a[20:23], v[48:63]
 ds_read_b128 v[28:31], v10 offset:352
 v_cvt_pk_bf16_f32 v82, v68, v69
 v_cvt_pk_bf16_f32 v83, v70, v71
 s_waitcnt lgkmcnt(5)
 v_mfma_f32_32x32x16_bf16 v[48:63], v[40:43], a[24:27], v[48:63]
 ds_read_b128 v[32:35], v10 offset:384
 buffer_load_dwordx4 v2, s[36:39], s43 offen offset:1024 lds
 v_cvt_pk_bf16_f32 v84, v72, v73
 v_cvt_pk_bf16_f32 v85, v74, v75
 s_waitcnt lgkmcnt(5)
 v_mfma_f32_32x32x16_bf16 v[48:63], v[44:47], a[28:31], v[48:63]
 ds_read_b128 v[36:39], v10 offset:416
 v_cvt_pk_bf16_f32 v86, v76, v77
 v_cvt_pk_bf16_f32 v87, v78, v79
 s_waitcnt lgkmcnt(5)
 v_mfma_f32_32x32x16_bf16 v[48:63], v[16:19], a[32:35], v[48:63]
 ds_read_b128 v[40:43], v10 offset:448
 s_add_u32 m0, s45, 70176
 s_add_u32 s43, s44, 4096
 buffer_load_dwordx4 v2, s[36:39], s43 offen offset:0 lds
 s_waitcnt lgkmcnt(5)
 v_mfma_f32_32x32x16_bf16 v[48:63], v[20:23], a[36:39], v[48:63]
 ds_read_b128 v[44:47], v10 offset:480
 buffer_store_dwordx4 v[80:83], v2, s[4:7], s46 offen sc1
 s_waitcnt lgkmcnt(5)
 v_mfma_f32_32x32x16_bf16 v[48:63], v[24:27], a[40:43], v[48:63]
 ds_read_b128 v[16:19], v10 offset:512
 buffer_load_dwordx4 v2, s[36:39], s43 offen offset:1024 lds
 s_waitcnt lgkmcnt(5)
 v_mfma_f32_32x32x16_bf16 v[48:63], v[28:31], a[44:47], v[48:63]
 ds_read_b128 v[20:23], v10 offset:544
 buffer_store_dwordx4 v[84:87], v2, s[4:7], s46 offen offset:1024 sc1
 s_add_u32 s46, s46, 0x40000
 s_bitset0_b32 s46, 30
 s_waitcnt lgkmcnt(5)
 v_mfma_f32_32x32x16_bf16 v[48:63], v[32:35], a[48:51], v[48:63]
 ds_read_b128 v[24:27], v10 offset:576
 s_add_u32 m0, s45, 72240
 s_add_u32 s43, s44, 6144
 buffer_load_dwordx4 v2, s[36:39], s43 offen offset:0 lds
 s_waitcnt lgkmcnt(5)
 v_mfma_f32_32x32x16_bf16 v[48:63], v[36:39], a[52:55], v[48:63]
 ds_read_b128 v[28:31], v10 offset:608
 s_waitcnt lgkmcnt(5)
 v_mfma_f32_32x32x16_bf16 v[48:63], v[40:43], a[56:59], v[48:63]
 ds_read_b128 v[32:35], v10 offset:640
 buffer_load_dwordx4 v2, s[36:39], s43 offen offset:1024 lds
 s_waitcnt lgkmcnt(5)
 v_mfma_f32_32x32x16_bf16 v[48:63], v[44:47], a[60:63], v[48:63]
 ds_read_b128 v[36:39], v10 offset:672
 s_waitcnt lgkmcnt(5)
 v_mfma_f32_32x32x16_bf16 v[48:63], v[16:19], a[64:67], v[48:63]
 ds_read_b128 v[40:43], v10 offset:704
 s_add_u32 m0, s45, 74304
 s_add_u32 s43, s44, 8192
 buffer_load_dwordx4 v2, s[36:39], s43 offen offset:0 lds
 s_waitcnt lgkmcnt(5)
 v_mfma_f32_32x32x16_bf16 v[48:63], v[20:23], a[68:71], v[48:63]
 ds_read_b128 v[44:47], v10 offset:736
 s_waitcnt lgkmcnt(5)
 v_mfma_f32_32x32x16_bf16 v[48:63], v[24:27], a[72:75], v[48:63]
 ds_read_b128 v[16:19], v10 offset:768
 buffer_load_dwordx4 v2, s[36:39], s43 offen offset:1024 lds
 s_waitcnt lgkmcnt(5)
 v_mfma_f32_32x32x16_bf16 v[48:63], v[28:31], a[76:79], v[48:63]
 ds_read_b128 v[20:23], v10 offset:800
 s_waitcnt lgkmcnt(5)
 v_mfma_f32_32x32x16_bf16 v[48:63], v[32:35], a[80:83], v[48:63]
 ds_read_b128 v[24:27], v10 offset:832
 s_add_u32 m0, s45, 76368
 s_add_u32 s43, s44, 10240
 buffer_load_dwordx4 v2, s[36:39], s43 offen offset:0 lds
 s_waitcnt lgkmcnt(5)
 v_mfma_f32_32x32x16_bf16 v[48:63], v[36:39], a[84:87], v[48:63]
 ds_read_b128 v[28:31], v10 offset:864
 s_waitcnt lgkmcnt(5)
 v_mfma_f32_32x32x16_bf16 v[48:63], v[40:43], a[88:91], v[48:63]
 ds_read_b128 v[32:35], v10 offset:896
 buffer_load_dwordx4 v2, s[36:39], s43 offen offset:1024 lds
 s_waitcnt lgkmcnt(5)
 v_mfma_f32_32x32x16_bf16 v[48:63], v[44:47], a[92:95], v[48:63]
 ds_read_b128 v[36:39], v10 offset:928
 s_waitcnt lgkmcnt(5)
 v_mfma_f32_32x32x16_bf16 v[48:63], v[16:19], a[96:99], v[48:63]
 ds_read_b128 v[40:43], v10 offset:960
 s_add_u32 m0, s45, 78432
 s_add_u32 s43, s44, 12288
 buffer_load_dwordx4 v2, s[36:39], s43 offen offset:0 lds
 s_waitcnt lgkmcnt(5)
 v_mfma_f32_32x32x16_bf16 v[48:63], v[20:23], a[100:103], v[48:63]
 ds_read_b128 v[44:47], v10 offset:992
 s_waitcnt vmcnt(15)
 buffer_store_dword v252, v14, s[4:7], s53 offen sc1
 s_mov_b32 s53, 0x40000000
 s_waitcnt lgkmcnt(5)
 v_mfma_f32_32x32x16_bf16 v[48:63], v[24:27], a[104:107], v[48:63]
 ds_read_b128 v[16:19], v10 offset:1024
 buffer_load_dwordx4 v2, s[36:39], s43 offen offset:1024 lds
 s_waitcnt lgkmcnt(5)
 v_mfma_f32_32x32x16_bf16 v[48:63], v[28:31], a[108:111], v[48:63]
 ds_read_b128 v[20:23], v10 offset:1056
 s_waitcnt lgkmcnt(5)
 v_mfma_f32_32x32x16_bf16 v[48:63], v[32:35], a[112:115], v[48:63]
 ds_read_b128 v[24:27], v10 offset:1088
 s_add_u32 m0, s45, 80496
 s_add_u32 s43, s44, 14336
 buffer_load_dwordx4 v2, s[36:39], s43 offen offset:0 lds
 s_waitcnt lgkmcnt(5)
 v_mfma_f32_32x32x16_bf16 v[48:63], v[36:39], a[116:119], v[48:63]
 ds_read_b128 v[28:31], v10 offset:1120
 s_waitcnt lgkmcnt(5)
 v_mfma_f32_32x32x16_bf16 v[48:63], v[40:43], a[120:123], v[48:63]
 ds_read_b128 v[32:35], v10 offset:1152
 buffer_load_dwordx4 v2, s[36:39], s43 offen offset:1024 lds
 s_waitcnt lgkmcnt(5)
 v_mfma_f32_32x32x16_bf16 v[48:63], v[44:47], a[124:127], v[48:63]
 ds_read_b128 v[36:39], v10 offset:1184
 s_waitcnt lgkmcnt(5)
 v_mfma_f32_32x32x16_bf16 v[48:63], v[16:19], a[128:131], v[48:63]
 ds_read_b128 v[40:43], v10 offset:1216
 s_waitcnt lgkmcnt(5)
 v_mfma_f32_32x32x16_bf16 v[48:63], v[20:23], a[132:135], v[48:63]
 ds_read_b128 v[44:47], v10 offset:1248
 s_waitcnt lgkmcnt(5)
 v_mfma_f32_32x32x16_bf16 v[48:63], v[24:27], a[136:139], v[48:63]
 ds_read_b128 v[16:19], v10 offset:1280
 s_waitcnt lgkmcnt(5)
 v_mfma_f32_32x32x16_bf16 v[48:63], v[28:31], a[140:143], v[48:63]
 ds_read_b128 v[20:23], v10 offset:1312
 s_waitcnt lgkmcnt(5)
 v_mfma_f32_32x32x16_bf16 v[48:63], v[32:35], a[144:147], v[48:63]
 ds_read_b128 v[24:27], v10 offset:1344
 s_waitcnt lgkmcnt(5)
 v_mfma_f32_32x32x16_bf16 v[48:63], v[36:39], a[148:151], v[48:63]
 ds_read_b128 v[28:31], v10 offset:1376
 v_mov_b32 v9, s40
 s_waitcnt vmcnt(11)
 buffer_load_dword v15, v255, s[4:7], s47 offen sc1
 buffer_store_dword v9, v8, s[4:7], 0 offen sc1
 s_waitcnt lgkmcnt(5)
 v_mfma_f32_32x32x16_bf16 v[48:63], v[40:43], a[152:155], v[48:63]
 ds_read_b128 v[32:35], v10 offset:1408
 s_waitcnt lgkmcnt(5)
 v_mfma_f32_32x32x16_bf16 v[48:63], v[44:47], a[156:159], v[48:63]
 ds_read_b128 v[36:39], v10 offset:1440
 s_waitcnt lgkmcnt(5)
 v_mfma_f32_32x32x16_bf16 v[48:63], v[16:19], a[160:163], v[48:63]
 ds_read_b128 v[40:43], v10 offset:1472
 s_waitcnt lgkmcnt(5)
 v_mfma_f32_32x32x16_bf16 v[48:63], v[20:23], a[164:167], v[48:63]
 ds_read_b128 v[44:47], v10 offset:1504
 s_waitcnt lgkmcnt(5)
 v_mfma_f32_32x32x16_bf16 v[48:63], v[24:27], a[168:171], v[48:63]
 ds_read_b128 v[16:19], v10 offset:1536
 s_waitcnt lgkmcnt(5)
 v_mfma_f32_32x32x16_bf16 v[48:63], v[28:31], a[172:175], v[48:63]
 ds_read_b128 v[20:23], v10 offset:1568
 s_waitcnt lgkmcnt(5)
 v_mfma_f32_32x32x16_bf16 v[48:63], v[32:35], a[176:179], v[48:63]
 ds_read_b128 v[24:27], v10 offset:1600
 s_waitcnt lgkmcnt(5)
 v_mfma_f32_32x32x16_bf16 v[48:63], v[36:39], a[180:183], v[48:63]
 ds_read_b128 v[28:31], v10 offset:1632
 s_waitcnt lgkmcnt(5)
 v_mfma_f32_32x32x16_bf16 v[48:63], v[40:43], a[184:187], v[48:63]
 ds_read_b128 v[32:35], v10 offset:1664
 s_waitcnt lgkmcnt(5)
 v_mfma_f32_32x32x16_bf16 v[48:63], v[44:47], a[188:191], v[48:63]
 ds_read_b128 v[36:39], v10 offset:1696
 s_waitcnt lgkmcnt(5)
 v_mfma_f32_32x32x16_bf16 v[48:63], v[16:19], a[192:195], v[48:63]
 ds_read_b128 v[40:43], v10 offset:1728
 s_waitcnt lgkmcnt(5)
 v_mfma_f32_32x32x16_bf16 v[48:63], v[20:23], a[196:199], v[48:63]
 ds_read_b128 v[44:47], v10 offset:1760
 s_waitcnt lgkmcnt(5)
 v_mfma_f32_32x32x16_bf16 v[48:63], v[24:27], a[200:203], v[48:63]
 ds_read_b128 v[16:19], v10 offset:1792
 s_waitcnt lgkmcnt(5)
 v_mfma_f32_32x32x16_bf16 v[48:63], v[28:31], a[204:207], v[48:63]
 ds_read_b128 v[20:23], v10 offset:1824
 s_waitcnt lgkmcnt(5)
 v_mfma_f32_32x32x16_bf16 v[48:63], v[32:35], a[208:211], v[48:63]
 ds_read_b128 v[24:27], v10 offset:1856
 s_waitcnt lgkmcnt(5)
 v_mfma_f32_32x32x16_bf16 v[48:63], v[36:39], a[212:215], v[48:63]
 ds_read_b128 v[28:31], v10 offset:1888
 s_waitcnt lgkmcnt(5)
 v_mfma_f32_32x32x16_bf16 v[48:63], v[40:43], a[216:219], v[48:63]
 ds_read_b128 v[32:35], v10 offset:1920
 s_waitcnt lgkmcnt(5)
 v_mfma_f32_32x32x16_bf16 v[48:63], v[44:47], a[220:223], v[48:63]
 ds_read_b128 v[36:39], v10 offset:1952
 s_waitcnt lgkmcnt(5)
 v_mfma_f32_32x32x16_bf16 v[48:63], v[16:19], a[224:227], v[48:63]
 ds_read_b128 v[40:43], v10 offset:1984
 s_waitcnt lgkmcnt(5)
 v_mfma_f32_32x32x16_bf16 v[48:63], v[20:23], a[228:231], v[48:63]
 ds_read_b128 v[44:47], v10 offset:2016
 s_add_u32 s40, s40, 1
 s_mov_b32 s54, 0
 s_waitcnt lgkmcnt(5)
 v_mfma_f32_32x32x16_bf16 v[48:63], v[24:27], a[232:235], v[48:63]
 s_waitcnt lgkmcnt(4)
 v_mfma_f32_32x32x16_bf16 v[48:63], v[28:31], a[236:239], v[48:63]
 s_waitcnt lgkmcnt(0)
 s_waitcnt vmcnt(2)
 s_barrier
 ds_read_b128 v[16:19], v11 offset:0
 ds_read_b128 v[20:23], v11 offset:32
 v_mfma_f32_32x32x16_bf16 v[48:63], v[32:35], a[240:243], v[48:63]
 ds_read_b128 v[24:27], v11 offset:64
 ds_read_b128 v[28:31], v11 offset:96
 v_mfma_f32_32x32x16_bf16 v[48:63], v[36:39], a[244:247], v[48:63]
 ds_read_b128 v[32:35], v11 offset:128
 ds_read_b128 v[36:39], v11 offset:160
 v_mfma_f32_32x32x16_bf16 v[48:63], v[40:43], a[248:251], v[48:63]
 v_cmp_ge_u32 vcc, s50, v15
 v_mfma_f32_32x32x16_bf16 v[48:63], v[44:47], a[252:255], v[48:63]
 s_and_b32 vcc_lo, vcc_lo, 0xffff
 s_cbranch_scc0 L_rV_att
L_rV_ret0:
 s_waitcnt lgkmcnt(5)
 v_mfma_f32_32x32x16_bf16 v[64:79], v[16:19], a[0:3], 0
 ds_read_b128 v[40:43], v11 offset:192
 s_add_u32 s44, s44, 65536
 s_add_u32 m0, s45, 0
 s_add_u32 s43, s44, 0
 buffer_load_dwordx4 v2, s[36:39], s43 offen offset:0 lds
 s_waitcnt lgkmcnt(5)
 v_mfma_f32_32x32x16_bf16 v[64:79], v[20:23], a[4:7], v[64:79]
 ds_read_b128 v[44:47], v11 offset:224
 s_waitcnt lgkmcnt(5)
 v_mfma_f32_32x32x16_bf16 v[64:79], v[24:27], a[8:11], v[64:79]
 ds_read_b128 v[16:19], v11 offset:256
 buffer_load_dwordx4 v2, s[36:39], s43 offen offset:1024 lds
 s_waitcnt lgkmcnt(5)
 v_mfma_f32_32x32x16_bf16 v[64:79], v[28:31], a[12:15], v[64:79]
 ds_read_b128 v[20:23], v11 offset:288
 s_waitcnt lgkmcnt(5)
 v_mfma_f32_32x32x16_bf16 v[64:79], v[32:35], a[16:19], v[64:79]
 ds_read_b128 v[24:27], v11 offset:320
 s_add_u32 m0, s45, 2064
 s_add_u32 s43, s44, 2048
 buffer_load_dwordx4 v2, s[36:39], s43 offen offset:0 lds
 v_cvt_pk_bf16_f32 v80, v48, v49
 v_cvt_pk_bf16_f32 v81, v50, v51
 s_waitcnt lgkmcnt(5)
 v_mfma_f32_32x32x16_bf16 v[64:79], v[36:39], a[20:23], v[64:79]
 ds_read_b128 v[28:31], v11 offset:352
 v_cvt_pk_bf16_f32 v82, v52, v53
 v_cvt_pk_bf16_f32 v83, v54, v55
 s_waitcnt lgkmcnt(5)
 v_mfma_f32_32x32x16_bf16 v[64:79], v[40:43], a[24:27], v[64:79]
 ds_read_b128 v[32:35], v11 offset:384
 buffer_load_dwordx4 v2, s[36:39], s43 offen offset:1024 lds
 v_cvt_pk_bf16_f32 v84, v56, v57
 v_cvt_pk_bf16_f32 v85, v58, v59
 s_waitcnt lgkmcnt(5)
 v_mfma_f32_32x32x16_bf16 v[64:79], v[44:47], a[28:31], v[64:79]
 ds_read_b128 v[36:39], v11 offset:416
 v_cvt_pk_bf16_f32 v86, v60, v61
 v_cvt_pk_bf16_f32 v87, v62, v63
 s_waitcnt lgkmcnt(5)
 v_mfma_f32_32x32x16_bf16 v[64:79], v[16:19], a[32:35], v[64:79]
 ds_read_b128 v[40:43], v11 offset:448
 s_add_u32 m0, s45, 4128
 s_add_u32 s43, s44, 4096
 buffer_load_dwordx4 v2, s[36:39], s43 offen offset:0 lds
 s_waitcnt lgkmcnt(5)
 v_mfma_f32_32x32x16_bf16 v[64:79], v[20:23], a[36:39], v[64:79]
 ds_read_b128 v[44:47], v11 offset:480
 buffer_store_dwordx4 v[80:83], v2, s[4:7], s46 offen sc1
 s_waitcnt lgkmcnt(5)
 v_mfma_f32_32x32x16_bf16 v[64:79], v[24:27], a[40:43], v[64:79]
 ds_read_b128 v[16:19], v11 offset:512
 buffer_load_dwordx4 v2, s[36:39], s43 offen offset:1024 lds
 s_waitcnt lgkmcnt(5)
 v_mfma_f32_32x32x16_bf16 v[64:79], v[28:31], a[44:47], v[64:79]
 ds_read_b128 v[20:23], v11 offset:544
 buffer_store_dwordx4 v[84:87], v2, s[4:7], s46 offen offset:1024 sc1
 s_add_u32 s46, s46, 0x40000
 s_bitset0_b32 s46, 30
 s_waitcnt lgkmcnt(5)
 v_mfma_f32_32x32x16_bf16 v[64:79], v[32:35], a[48:51], v[64:79]
 ds_read_b128 v[24:27], v11 offset:576
 s_add_u32 m0, s45, 6192
 s_add_u32 s43, s44, 6144
 buffer_load_dwordx4 v2, s[36:39], s43 offen offset:0 lds
 s_waitcnt lgkmcnt(5)
 v_mfma_f32_32x32x16_bf16 v[64:79], v[36:39], a[52:55], v[64:79]
 ds_read_b128 v[28:31], v11 offset:608
 s_waitcnt lgkmcnt(5)
 v_mfma_f32_32x32x16_bf16 v[64:79], v[40:43], a[56:59], v[64:79]
 ds_read_b128 v[32:35], v11 offset:640
 buffer_load_dwordx4 v2, s[36:39], s43 offen offset:1024 lds
 s_waitcnt lgkmcnt(5)
 v_mfma_f32_32x32x16_bf16 v[64:79], v[44:47], a[60:63], v[64:79]
 ds_read_b128 v[36:39], v11 offset:672
 s_waitcnt lgkmcnt(5)
 v_mfma_f32_32x32x16_bf16 v[64:79], v[16:19], a[64:67], v[64:79]
 ds_read_b128 v[40:43], v11 offset:704
 s_add_u32 m0, s45, 8256
 s_add_u32 s43, s44, 8192
 buffer_load_dwordx4 v2, s[36:39], s43 offen offset:0 lds
 s_waitcnt lgkmcnt(5)
 v_mfma_f32_32x32x16_bf16 v[64:79], v[20:23], a[68:71], v[64:79]
 ds_read_b128 v[44:47], v11 offset:736
 s_waitcnt lgkmcnt(5)
 v_mfma_f32_32x32x16_bf16 v[64:79], v[24:27], a[72:75], v[64:79]
 ds_read_b128 v[16:19], v11 offset:768
 buffer_load_dwordx4 v2, s[36:39], s43 offen offset:1024 lds
 s_waitcnt lgkmcnt(5)
 v_mfma_f32_32x32x16_bf16 v[64:79], v[28:31], a[76:79], v[64:79]
 ds_read_b128 v[20:23], v11 offset:800
 s_waitcnt lgkmcnt(5)
 v_mfma_f32_32x32x16_bf16 v[64:79], v[32:35], a[80:83], v[64:79]
 ds_read_b128 v[24:27], v11 offset:832
 s_add_u32 m0, s45, 10320
 s_add_u32 s43, s44, 10240
 buffer_load_dwordx4 v2, s[36:39], s43 offen offset:0 lds
 s_waitcnt lgkmcnt(5)
 v_mfma_f32_32x32x16_bf16 v[64:79], v[36:39], a[84:87], v[64:79]
 ds_read_b128 v[28:31], v11 offset:864
 s_waitcnt lgkmcnt(5)
 v_mfma_f32_32x32x16_bf16 v[64:79], v[40:43], a[88:91], v[64:79]
 ds_read_b128 v[32:35], v11 offset:896
 buffer_load_dwordx4 v2, s[36:39], s43 offen offset:1024 lds
 s_waitcnt lgkmcnt(5)
 v_mfma_f32_32x32x16_bf16 v[64:79], v[44:47], a[92:95], v[64:79]
 ds_read_b128 v[36:39], v11 offset:928
 s_waitcnt lgkmcnt(5)
 v_mfma_f32_32x32x16_bf16 v[64:79], v[16:19], a[96:99], v[64:79]
 ds_read_b128 v[40:43], v11 offset:960
 s_add_u32 m0, s45, 12384
 s_add_u32 s43, s44, 12288
 buffer_load_dwordx4 v2, s[36:39], s43 offen offset:0 lds
 s_waitcnt lgkmcnt(5)
 v_mfma_f32_32x32x16_bf16 v[64:79], v[20:23], a[100:103], v[64:79]
 ds_read_b128 v[44:47], v11 offset:992
 s_waitcnt vmcnt(15)
 buffer_store_dword v252, v14, s[4:7], s53 offen sc1
 s_mov_b32 s53, 0x40000000
 s_waitcnt lgkmcnt(5)
 v_mfma_f32_32x32x16_bf16 v[64:79], v[24:27], a[104:107], v[64:79]
 ds_read_b128 v[16:19], v11 offset:1024
 buffer_load_dwordx4 v2, s[36:39], s43 offen offset:1024 lds
 s_waitcnt lgkmcnt(5)
 v_mfma_f32_32x32x16_bf16 v[64:79], v[28:31], a[108:111], v[64:79]
 ds_read_b128 v[20:23], v11 offset:1056
 s_waitcnt lgkmcnt(5)
 v_mfma_f32_32x32x16_bf16 v[64:79], v[32:35], a[112:115], v[64:79]
 ds_read_b128 v[24:27], v11 offset:1088
 s_add_u32 m0, s45, 14448
 s_add_u32 s43, s44, 14336
 buffer_load_dwordx4 v2, s[36:39], s43 offen offset:0 lds
 s_waitcnt lgkmcnt(5)
 v_mfma_f32_32x32x16_bf16 v[64:79], v[36:39], a[116:119], v[64:79]
 ds_read_b128 v[28:31], v11 offset:1120
 s_waitcnt lgkmcnt(5)
 v_mfma_f32_32x32x16_bf16 v[64:79], v[40:43], a[120:123], v[64:79]
 ds_read_b128 v[32:35], v11 offset:1152
 buffer_load_dwordx4 v2, s[36:39], s43 offen offset:1024 lds
 s_waitcnt lgkmcnt(5)
 v_mfma_f32_32x32x16_bf16 v[64:79], v[44:47], a[124:127], v[64:79]
 ds_read_b128 v[36:39], v11 offset:1184
 s_waitcnt lgkmcnt(5)
 v_mfma_f32_32x32x16_bf16 v[64:79], v[16:19], a[128:131], v[64:79]
 ds_read_b128 v[40:43], v11 offset:1216
 s_waitcnt lgkmcnt(5)
 v_mfma_f32_32x32x16_bf16 v[64:79], v[20:23], a[132:135], v[64:79]
 ds_read_b128 v[44:47], v11 offset:1248
 s_waitcnt lgkmcnt(5)
 v_mfma_f32_32x32x16_bf16 v[64:79], v[24:27], a[136:139], v[64:79]
 ds_read_b128 v[16:19], v11 offset:1280
 s_waitcnt lgkmcnt(5)
 v_mfma_f32_32x32x16_bf16 v[64:79], v[28:31], a[140:143], v[64:79]
 ds_read_b128 v[20:23], v11 offset:1312
 s_waitcnt lgkmcnt(5)
 v_mfma_f32_32x32x16_bf16 v[64:79], v[32:35], a[144:147], v[64:79]
 ds_read_b128 v[24:27], v11 offset:1344
 s_waitcnt lgkmcnt(5)
 v_mfma_f32_32x32x16_bf16 v[64:79], v[36:39], a[148:151], v[64:79]
 ds_read_b128 v[28:31], v11 offset:1376
 v_mov_b32 v9, s40
 s_waitcnt vmcnt(11)
 buffer_load_dword v15, v255, s[4:7], s47 offen sc1
 buffer_store_dword v9, v8, s[4:7], 0 offen sc1
 s_waitcnt lgkmcnt(5)
 v_mfma_f32_32x32x16_bf16 v[64:79], v[40:43], a[152:155], v[64:79]
 ds_read_b128 v[32:35], v11 offset:1408
 s_waitcnt lgkmcnt(5)
 v_mfma_f32_32x32x16_bf16 v[64:79], v[44:47], a[156:159], v[64:79]
 ds_read_b128 v[36:39], v11 offset:1440
 s_waitcnt lgkmcnt(5)
 v_mfma_f32_32x32x16_bf16 v[64:79], v[16:19], a[160:163], v[64:79]
 ds_read_b128 v[40:43], v11 offset:1472
 s_waitcnt lgkmcnt(5)
 v_mfma_f32_32x32x16_bf16 v[64:79], v[20:23], a[164:167], v[64:79]
 ds_read_b128 v[44:47], v11 offset:1504
 s_waitcnt lgkmcnt(5)
 v_mfma_f32_32x32x16_bf16 v[64:79], v[24:27], a[168:171], v[64:79]
 ds_read_b128 v[16:19], v11 offset:1536
 s_waitcnt lgkmcnt(5)
 v_mfma_f32_32x32x16_bf16 v[64:79], v[28:31], a[172:175], v[64:79]
 ds_read_b128 v[20:23], v11 offset:1568
 s_waitcnt lgkmcnt(5)
 v_mfma_f32_32x32x16_bf16 v[64:79], v[32:35], a[176:179], v[64:79]
 ds_read_b128 v[24:27], v11 offset:1600
 s_waitcnt lgkmcnt(5)
 v_mfma_f32_32x32x16_bf16 v[64:79], v[36:39], a[180:183], v[64:79]
 ds_read_b128 v[28:31], v11 offset:1632
 s_waitcnt lgkmcnt(5)
 v_mfma_f32_32x32x16_bf16 v[64:79], v[40:43], a[184:187], v[64:79]
 ds_read_b128 v[32:35], v11 offset:1664
 s_waitcnt lgkmcnt(5)
 v_mfma_f32_32x32x16_bf16 v[64:79], v[44:47], a[188:191], v[64:79]
 ds_read_b128 v[36:39], v11 offset:1696
 s_waitcnt lgkmcnt(5)
 v_mfma_f32_32x32x16_bf16 v[64:79], v[16:19], a[192:195], v[64:79]
 ds_read_b128 v[40:43], v11 offset:1728
 s_waitcnt lgkmcnt(5)
 v_mfma_f32_32x32x16_bf16 v[64:79], v[20:23], a[196:199], v[64:79]
 ds_read_b128 v[44:47], v11 offset:1760
 s_waitcnt lgkmcnt(5)
 v_mfma_f32_32x32x16_bf16 v[64:79], v[24:27], a[200:203], v[64:79]
 ds_read_b128 v[16:19], v11 offset:1792
 s_waitcnt lgkmcnt(5)
 v_mfma_f32_32x32x16_bf16 v[64:79], v[28:31], a[204:207], v[64:79]
 ds_read_b128 v[20:23], v11 offset:1824
 s_waitcnt lgkmcnt(5)
 v_mfma_f32_32x32x16_bf16 v[64:79], v[32:35], a[208:211], v[64:79]
 ds_read_b128 v[24:27], v11 offset:1856
 s_waitcnt lgkmcnt(5)
 v_mfma_f32_32x32x16_bf16 v[64:79], v[36:39], a[212:215], v[64:79]
 ds_read_b128 v[28:31], v11 offset:1888
 s_waitcnt lgkmcnt(5)
 v_mfma_f32_32x32x16_bf16 v[64:79], v[40:43], a[216:219], v[64:79]
 ds_read_b128 v[32:35], v11 offset:1920
 s_waitcnt lgkmcnt(5)
 v_mfma_f32_32x32x16_bf16 v[64:79], v[44:47], a[220:223], v[64:79]
 ds_read_b128 v[36:39], v11 offset:1952
 s_waitcnt lgkmcnt(5)
 v_mfma_f32_32x32x16_bf16 v[64:79], v[16:19], a[224:227], v[64:79]
 ds_read_b128 v[40:43], v11 offset:1984
 s_waitcnt lgkmcnt(5)
 v_mfma_f32_32x32x16_bf16 v[64:79], v[20:23], a[228:231], v[64:79]
 ds_read_b128 v[44:47], v11 offset:2016
 s_add_u32 s40, s40, 1
 s_mov_b32 s54, 1
 s_waitcnt lgkmcnt(5)
 v_mfma_f32_32x32x16_bf16 v[64:79], v[24:27], a[232:235], v[64:79]
 s_waitcnt lgkmcnt(4)
 v_mfma_f32_32x32x16_bf16 v[64:79], v[28:31], a[236:239], v[64:79]
 s_waitcnt lgkmcnt(0)
 s_waitcnt vmcnt(2)
 s_barrier
 ds_read_b128 v[16:19], v10 offset:0
 ds_read_b128 v[20:23], v10 offset:32
 v_mfma_f32_32x32x16_bf16 v[64:79], v[32:35], a[240:243], v[64:79]
 ds_read_b128 v[24:27], v10 offset:64
 ds_read_b128 v[28:31], v10 offset:96
 v_mfma_f32_32x32x16_bf16 v[64:79], v[36:39], a[244:247], v[64:79]
 ds_read_b128 v[32:35], v10 offset:128
 ds_read_b128 v[36:39], v10 offset:160
 v_mfma_f32_32x32x16_bf16 v[64:79], v[40:43], a[248:251], v[64:79]
 v_cmp_ge_u32 vcc, s50, v15
 v_mfma_f32_32x32x16_bf16 v[64:79], v[44:47], a[252:255], v[64:79]
 s_and_b32 vcc_lo, vcc_lo, 0xffff
 s_cbranch_scc0 L_rV_att
L_rV_ret1:
 s_cmp_lt_u32 s40, 64
 s_cbranch_scc1 L_rV_loop
 s_nop 11
 v_cvt_pk_bf16_f32 v80, v64, v65
 v_cvt_pk_bf16_f32 v81, v66, v67
 v_cvt_pk_bf16_f32 v82, v68, v69
 v_cvt_pk_bf16_f32 v83, v70, v71
 v_cvt_pk_bf16_f32 v84, v72, v73
 v_cvt_pk_bf16_f32 v85, v74, v75
 v_cvt_pk_bf16_f32 v86, v76, v77
 v_cvt_pk_bf16_f32 v87, v78, v79
 buffer_store_dwordx4 v[80:83], v2, s[4:7], s46 offen sc1
 buffer_store_dwordx4 v[84:87], v2, s[4:7], s46 offen offset:1024 sc1
 s_add_u32 s46, s46, 0x40000
 v_mov_b32 v9, 64
 s_mov_b32 s54, 2
L_rV_ret2:
 s_waitcnt vmcnt(0) lgkmcnt(0)
 buffer_store_dword v9, v8, s[4:7], 0 offen sc1
 buffer_store_dword v252, v14, s[4:7], s53 offen sc1
 s_mov_b32 s53, 0x40000000
 s_cmp_ge_u32 s50, 64
 s_cbranch_scc1 L_rV_end
L_rV_att:
L_rV_bkv:
 v_cmp_ge_u32 vcc, s50, v15
 s_and_b32 vcc_lo, vcc_lo, 0xf0ff
 s_cbranch_scc0 L_rV_bkvok
 buffer_load_dword v15, v255, s[4:7], s47 offen sc1
 s_add_u32 s48, s48, 1
 s_cmp_gt_u32 s48, 400000
 s_cbranch_scc1 L_done
 s_waitcnt vmcnt(0)
 s_branch L_rV_bkv
L_rV_bkvok:
 s_lshl_b32 s42, s50, 5
 s_add_u32 s42, s42, s51
 s_lshl_b32 s49, s42, 13
 s_lshl_b32 s53, s42, 2
 s_add_u32 s53, s53, 3760128
 s_add_u32 s43, s49, 16777216
 buffer_load_dwordx4 v[80:83], v6, s[4:7], s43 offen offset:0 sc1
 buffer_load_dwordx4 v[84:87], v6, s[4:7], s43 offen offset:1024 sc1
 buffer_load_dwordx4 v[88:91], v6, s[4:7], s43 offen offset:2048 sc1
 buffer_load_dwordx4 v[92:95], v6, s[4:7], s43 offen offset:3072 sc1
 s_add_u32 s43, s49, 16781312
 buffer_load_dwordx4 v[96:99], v6, s[4:7], s43 offen offset:0 sc1
 buffer_load_dwordx4 v[100:103], v6, s[4:7], s43 offen offset:1024 sc1
 buffer_load_dwordx4 v[104:107], v6, s[4:7], s43 offen offset:2048 sc1
 buffer_load_dwordx4 v[108:111], v6, s[4:7], s43 offen offset:3072 sc1
 s_add_u32 s43, s49, 50331648
 buffer_load_dwordx4 v[144:147], v2, s[4:7], s43 offen offset:0 sc1
 buffer_load_dwordx4 v[148:151], v2, s[4:7], s43 offen offset:1024 sc1
 buffer_load_dwordx4 v[152:155], v2, s[4:7], s43 offen offset:2048 sc1
 buffer_load_dwordx4 v[156:159], v2, s[4:7], s43 offen offset:3072 sc1
 s_add_u32 s43, s49, 50335744
 buffer_load_dwordx4 v[160:163], v2, s[4:7], s43 offen offset:0 sc1
 buffer_load_dwordx4 v[164:167], v2, s[4:7], s43 offen offset:1024 sc1
 buffer_load_dwordx4 v[168:171], v2, s[4:7], s43 offen offset:2048 sc1
 buffer_load_dwordx4 v[172:175], v2, s[4:7], s43 offen offset:3072 sc1
 s_add_u32 s43, s49, 33554432
 buffer_load_dwordx4 v[176:179], v6, s[4:7], s43 offen offset:0 sc1
 buffer_load_dwordx4 v[180:183], v6, s[4:7], s43 offen offset:1024 sc1
 buffer_load_dwordx4 v[184:187], v6, s[4:7], s43 offen offset:2048 sc1
 buffer_load_dwordx4 v[188:191], v6, s[4:7], s43 offen offset:3072 sc1
 s_add_u32 s43, s49, 33558528
 buffer_load_dwordx4 v[192:195], v6, s[4:7], s43 offen offset:0 sc1
 buffer_load_dwordx4 v[196:199], v6, s[4:7], s43 offen offset:1024 sc1
 buffer_load_dwordx4 v[200:203], v6, s[4:7], s43 offen offset:2048 sc1
 buffer_load_dwordx4 v[204:207], v6, s[4:7], s43 offen offset:3072 sc1
L_rV_bm:
 v_cmp_ge_u32 vcc, s50, v15
 s_and_b32 vcc_lo, vcc_lo, 0xf00
 s_cbranch_scc0 L_rV_bmok
 buffer_load_dword v15, v255, s[4:7], s47 offen sc1
 s_add_u32 s48, s48, 1
 s_cmp_gt_u32 s48, 400000
 s_cbranch_scc1 L_done
 s_waitcnt vmcnt(0)
 s_branch L_rV_bm
L_rV_bmok:
 s_lshr_b32 s42, s49, 2
 s_add_u32 s43, s42, 4194304
 buffer_load_dwordx4 v[112:115], v12, s[4:7], s43 offen offset:0 sc1
 buffer_load_dwordx4 v[116:119], v12, s[4:7], s43 offen offset:256 sc1
 buffer_load_dwordx4 v[120:123], v12, s[4:7], s43 offen offset:512 sc1
 buffer_load_dwordx4 v[124:127], v12, s[4:7], s43 offen offset:768 sc1
 buffer_load_dwordx4 v[128:131], v12, s[4:7], s43 offen offset:1024 sc1
 buffer_load_dwordx4 v[132:135], v12, s[4:7], s43 offen offset:1280 sc1
 buffer_load_dwordx4 v[136:139], v12, s[4:7], s43 offen offset:1536 sc1
 buffer_load_dwordx4 v[140:143], v12, s[4:7], s43 offen offset:1792 sc1
 s_add_u32 s43, s42, 8388608
 buffer_load_dword v208, v13, s[4:7], s43 offen offset:0 sc1
 buffer_load_dword v209, v13, s[4:7], s43 offen offset:64 sc1
 buffer_load_dword v210, v13, s[4:7], s43 offen offset:512 sc1
 buffer_load_dword v211, v13, s[4:7], s43 offen offset:576 sc1
 buffer_load_dword v212, v13, s[4:7], s43 offen offset:1024 sc1
 buffer_load_dword v213, v13, s[4:7], s43 offen offset:1088 sc1
 buffer_load_dword v214, v13, s[4:7], s43 offen offset:1536 sc1
 buffer_load_dword v215, v13, s[4:7], s43 offen offset:1600 sc1
 s_waitcnt vmcnt(24)
 v_mfma_f32_32x32x16_bf16 v[216:231], v[80:83], v[144:147], v[232:247]
 v_mfma_f32_32x32x16_bf16 v[216:231], v[84:87], v[148:151], v[216:231]
 v_mfma_f32_32x32x16_bf16 v[216:231], v[88:91], v[152:155], v[216:231]
 v_mfma_f32_32x32x16_bf16 v[216:231], v[92:95], v[156:159], v[216:231]
 v_mfma_f32_32x32x16_bf16 v[216:231], v[96:99], v[160:163], v[216:231]
 v_mfma_f32_32x32x16_bf16 v[216:231], v[100:103], v[164:167], v[216:231]
 v_mfma_f32_32x32x16_bf16 v[216:231], v[104:107], v[168:171], v[216:231]
 v_mfma_f32_32x32x16_bf16 v[216:231], v[108:111], v[172:175], v[216:231]
 s_waitcnt vmcnt(8)
 v_mfma_f32_32x32x16_bf16 v[80:95], v[112:115], v[144:147], 0
 v_mfma_f32_32x32x16_bf16 v[80:95], v[116:119], v[148:151], v[80:95]
 v_mfma_f32_32x32x16_bf16 v[80:95], v[120:123], v[152:155], v[80:95]
 v_mfma_f32_32x32x16_bf16 v[80:95], v[124:127], v[156:159], v[80:95]
 v_mfma_f32_32x32x16_bf16 v[80:95], v[128:131], v[160:163], v[80:95]
 v_mfma_f32_32x32x16_bf16 v[80:95], v[132:135], v[164:167], v[80:95]
 v_mfma_f32_32x32x16_bf16 v[80:95], v[136:139], v[168:171], v[80:95]
 v_mfma_f32_32x32x16_bf16 v[80:95], v[140:143], v[172:175], v[80:95]
 s_nop 3
 v_max3_f32 v3, v216, v217, v218
 v_max3_f32 v3, v3, v219, v220
 v_max3_f32 v3, v3, v221, v222
 v_max3_f32 v3, v3, v223, v224
 v_max3_f32 v3, v3, v225, v226
 v_max3_f32 v3, v3, v227, v228
 v_max3_f32 v3, v3, v229, v230
 v_max_f32 v3, v3, v231
 v_max3_f32 v3, v3, v80, v81
 v_max3_f32 v3, v3, v82, v83
 v_mov_b32 v4, v3
 s_nop 1
 v_permlane32_swap_b32 v3, v4
 s_nop 0
 v_max_f32 v3, v3, v4
 v_mul_f32 v3, v248, v3
 v_fma_f32 v216, v216, v248, -v3
 v_fma_f32 v217, v217, v248, -v3
 v_fma_f32 v218, v218, v248, -v3
 v_fma_f32 v219, v219, v248, -v3
 v_fma_f32 v220, v220, v248, -v3
 v_fma_f32 v221, v221, v248, -v3
 v_fma_f32 v222, v222, v248, -v3
 v_fma_f32 v223, v223, v248, -v3
 v_fma_f32 v224, v224, v248, -v3
 v_fma_f32 v225, v225, v248, -v3
 v_fma_f32 v226, v226, v248, -v3
 v_fma_f32 v227, v227, v248, -v3
 v_fma_f32 v228, v228, v248, -v3
 v_fma_f32 v229, v229, v248, -v3
 v_fma_f32 v230, v230, v248, -v3
 v_fma_f32 v231, v231, v248, -v3
 v_fma_f32 v80, v80, v248, -v3
 v_fma_f32 v81, v81, v248, -v3
 v_fma_f32 v82, v82, v248, -v3
 v_fma_f32 v83, v83, v248, -v3
 v_exp_f32 v216, v216
 v_exp_f32 v217, v217
 v_exp_f32 v218, v218
 v_exp_f32 v219, v219
 v_exp_f32 v220, v220
 v_exp_f32 v221, v221
 v_exp_f32 v222, v222
 v_exp_f32 v223, v223
 v_exp_f32 v224, v224
 v_exp_f32 v225, v225
 v_exp_f32 v226, v226
 v_exp_f32 v227, v227
 v_exp_f32 v228, v228
 v_exp_f32 v229, v229
 v_exp_f32 v230, v230
 v_exp_f32 v231, v231
 v_exp_f32 v80, v80
 v_exp_f32 v81, v81
 v_exp_f32 v82, v82
 v_exp_f32 v83, v83
 v_pk_add_f32 v[250:251], v[216:217], v[218:219]
 v_pk_add_f32 v[250:251], v[250:251], v[220:221]
 v_pk_add_f32 v[250:251], v[250:251], v[222:223]
 v_pk_add_f32 v[250:251], v[250:251], v[224:225]
 v_pk_add_f32 v[250:251], v[250:251], v[226:227]
 v_pk_add_f32 v[250:251], v[250:251], v[228:229]
 v_pk_add_f32 v[250:251], v[250:251], v[230:231]
 v_pk_add_f32 v[250:251], v[250:251], v[80:81]
 v_pk_add_f32 v[250:251], v[250:251], v[82:83]
 v_add_f32 v3, v250, v251
 v_add_f32 v4, v250, v251
 s_nop 1
 v_permlane32_swap_b32 v3, v4
 s_nop 0
 v_add_f32 v3, v3, v4
 v_rcp_f32 v250, v3
 s_nop 0
 v_pk_mul_f32 v[216:217], v[216:217], v[250:251] op_sel_hi:[1,0]
 v_pk_mul_f32 v[218:219], v[218:219], v[250:251] op_sel_hi:[1,0]
 v_pk_mul_f32 v[220:221], v[220:221], v[250:251] op_sel_hi:[1,0]
 v_pk_mul_f32 v[222:223], v[222:223], v[250:251] op_sel_hi:[1,0]
 v_pk_mul_f32 v[224:225], v[224:225], v[250:251] op_sel_hi:[1,0]
 v_pk_mul_f32 v[226:227], v[226:227], v[250:251] op_sel_hi:[1,0]
 v_pk_mul_f32 v[228:229], v[228:229], v[250:251] op_sel_hi:[1,0]
 v_pk_mul_f32 v[230:231], v[230:231], v[250:251] op_sel_hi:[1,0]
 v_pk_mul_f32 v[80:81], v[80:81], v[250:251] op_sel_hi:[1,0]
 v_pk_mul_f32 v[82:83], v[82:83], v[250:251] op_sel_hi:[1,0]
 v_cvt_pk_bf16_f32 v144, v216, v217
 v_cvt_pk_bf16_f32 v145, v218, v219
 v_cvt_pk_bf16_f32 v146, v220, v221
 v_cvt_pk_bf16_f32 v147, v222, v223
 v_cvt_pk_bf16_f32 v148, v224, v225
 v_cvt_pk_bf16_f32 v149, v226, v227
 v_cvt_pk_bf16_f32 v150, v228, v229
 v_cvt_pk_bf16_f32 v151, v230, v231
 v_cvt_pk_bf16_f32 v152, v80, v81
 v_cvt_pk_bf16_f32 v153, v82, v83
 s_waitcnt vmcnt(0)
 s_add_u32 s43, s49, 67108864
 s_add_u32 s42, s43, 4096
 v_mfma_f32_32x32x16_bf16 v[80:95], v[176:179], v[144:147], 0
 v_mfma_f32_32x32x16_bf16 v[80:95], v[180:183], v[148:151], v[80:95]
 v_mfma_f32_32x32x8_bf16 v[80:95], v[208:209], v[152:153], v[80:95]
 v_mfma_f32_32x32x16_bf16 v[96:111], v[184:187], v[144:147], 0
 v_mfma_f32_32x32x16_bf16 v[96:111], v[188:191], v[148:151], v[96:111]
 v_mfma_f32_32x32x8_bf16 v[96:111], v[210:211], v[152:153], v[96:111]
 v_mfma_f32_32x32x16_bf16 v[112:127], v[192:195], v[144:147], 0
 v_mfma_f32_32x32x16_bf16 v[112:127], v[196:199], v[148:151], v[112:127]
 v_mfma_f32_32x32x8_bf16 v[112:127], v[212:213], v[152:153], v[112:127]
 v_mfma_f32_32x32x16_bf16 v[128:143], v[200:203], v[144:147], 0
 v_mfma_f32_32x32x16_bf16 v[128:143], v[204:207], v[148:151], v[128:143]
 v_mfma_f32_32x32x8_bf16 v[128:143], v[214:215], v[152:153], v[128:143]
 s_nop 2
 v_cvt_pk_bf16_f32 v176, v80, v81
 v_cvt_pk_bf16_f32 v177, v82, v83
 v_cvt_pk_bf16_f32 v178, v84, v85
 v_cvt_pk_bf16_f32 v179, v86, v87
 v_cvt_pk_bf16_f32 v180, v88, v89
 v_cvt_pk_bf16_f32 v181, v90, v91
 v_cvt_pk_bf16_f32 v182, v92, v93
 v_cvt_pk_bf16_f32 v183, v94, v95
 buffer_store_dwordx4 v[176:179], v2, s[4:7], s43 offen offset:0 sc1
 buffer_store_dwordx4 v[180:183], v2, s[4:7], s43 offen offset:1024 sc1
 v_cvt_pk_bf16_f32 v184, v96, v97
 v_cvt_pk_bf16_f32 v185, v98, v99
 v_cvt_pk_bf16_f32 v186, v100, v101
 v_cvt_pk_bf16_f32 v187, v102, v103
 v_cvt_pk_bf16_f32 v188, v104, v105
 v_cvt_pk_bf16_f32 v189, v106, v107
 v_cvt_pk_bf16_f32 v190, v108, v109
 v_cvt_pk_bf16_f32 v191, v110, v111
 buffer_store_dwordx4 v[184:187], v2, s[4:7], s43 offen offset:2048 sc1
 buffer_store_dwordx4 v[188:191], v2, s[4:7], s43 offen offset:3072 sc1
 v_cvt_pk_bf16_f32 v192, v112, v113
 v_cvt_pk_bf16_f32 v193, v114, v115
 v_cvt_pk_bf16_f32 v194, v116, v117
 v_cvt_pk_bf16_f32 v195, v118, v119
 v_cvt_pk_bf16_f32 v196, v120, v121
 v_cvt_pk_bf16_f32 v197, v122, v123
 v_cvt_pk_bf16_f32 v198, v124, v125
 v_cvt_pk_bf16_f32 v199, v126, v127
 buffer_store_dwordx4 v[192:195], v2, s[4:7], s42 offen offset:0 sc1
 buffer_store_dwordx4 v[196:199], v2, s[4:7], s42 offen offset:1024 sc1
 v_cvt_pk_bf16_f32 v200, v128, v129
 v_cvt_pk_bf16_f32 v201, v130, v131
 v_cvt_pk_bf16_f32 v202, v132, v133
 v_cvt_pk_bf16_f32 v203, v134, v135
 v_cvt_pk_bf16_f32 v204, v136, v137
 v_cvt_pk_bf16_f32 v205, v138, v139
 v_cvt_pk_bf16_f32 v206, v140, v141
 v_cvt_pk_bf16_f32 v207, v142, v143
 buffer_store_dwordx4 v[200:203], v2, s[4:7], s42 offen offset:2048 sc1
 buffer_store_dwordx4 v[204:207], v2, s[4:7], s42 offen offset:3072 sc1
 s_add_u32 s41, s50, 1
 v_mov_b32 v252, s41
 s_add_u32 s50, s50, 12
 s_cmp_eq_u32 s54, 0
 s_cbranch_scc1 L_rV_ret0
 s_cmp_eq_u32 s54, 1
 s_cbranch_scc1 L_rV_ret1
 s_branch L_rV_ret2
L_rV_end:
 s_waitcnt vmcnt(0) lgkmcnt(0)
 s_barrier
 s_branch L_done
L_role_Q:
 s_mov_b64 s[8:9], s[16:17]
 s_mov_b32 s10, 8388608
 s_mov_b32 s11, 0x20000
 v_and_b32 v1, 63, v0
 v_lshrrev_b32 v12, 4, v1
 v_lshlrev_b32 v12, 13, v12
 v_and_b32 v3, 15, v1
 v_lshl_add_u32 v12, v3, 4, v12
 s_lshl_b32 s44, s25, 8
 s_lshl_b32 s42, s26, 18
 s_add_u32 s44, s44, s42
 s_lshl_b32 s45, s26, 13
 s_add_u32 m0, s45, 0
 s_add_u32 s43, s44, 0
 buffer_load_dwordx4 v12, s[8:11], s43 offen  lds
 s_add_u32 m0, s45, 1024
 s_add_u32 s43, s44, 32768
 buffer_load_dwordx4 v12, s[8:11], s43 offen  lds
 s_add_u32 m0, s45, 2048
 s_add_u32 s43, s44, 65536
 buffer_load_dwordx4 v12, s[8:11], s43 offen  lds
 s_add_u32 m0, s45, 3072
 s_add_u32 s43, s44, 98304
 buffer_load_dwordx4 v12, s[8:11], s43 offen  lds
 s_add_u32 m0, s45, 4096
 s_add_u32 s43, s44, 131072
 buffer_load_dwordx4 v12, s[8:11], s43 offen  lds
 s_add_u32 m0, s45, 5120
 s_add_u32 s43, s44, 163840
 buffer_load_dwordx4 v12, s[8:11], s43 offen  lds
 s_add_u32 m0, s45, 6144
 s_add_u32 s43, s44, 196608
 buffer_load_dwordx4 v12, s[8:11], s43 offen  lds
 s_add_u32 m0, s45, 7168
 s_add_u32 s43, s44, 229376
 buffer_load_dwordx4 v12, s[8:11], s43 offen  lds
 s_cmp_lg_u32 s26, 1
 s_cbranch_scc1 L_voted_8
 s_bfe_u32 s63, s2, 0x30003
 s_lshl_b32 s56, s63, 21
 s_lshr_b32 s57, s2, 6
 s_lshl_b32 s57, s57, 3
 s_and_b32 s58, s2, 7
 s_add_u32 s57, s57, s58
 s_lshl_b32 s57, s57, 8
 s_add_u32 s56, s56, s57
 s_add_u32 s56, s56, 135790592
 s_add_u32 s57, s56, 8192
 s_load_dword s62, s[4:5], s56 glc
 s_load_dword s62, s[4:5], s57 glc
 s_waitcnt lgkmcnt(0)
 s_memtime s[58:59]
 s_load_dword s62, s[4:5], s56 glc
 s_waitcnt lgkmcnt(0)
 s_memtime s[60:61]
 s_load_dword s62, s[4:5], s57 glc
 s_waitcnt lgkmcnt(0)
 s_memtime s[32:33]
 s_sub_u32 s58, s60, s58
 s_waitcnt lgkmcnt(0)
 s_sub_u32 s60, s32, s60
 s_cmp_lt_u32 s60, s58
 s_cselect_b32 s58, 1, 0
 s_bfe_u32 s59, s24, 0x10002
 s_xor_b32 s58, s58, s59
 s_mov_b32 s59, 0
 s_mul_i32 s63, s63, 6
 s_add_u32 s63, s63, 16
 s_lshl_b64 s[34:35], s[58:59], s63
 s_or_b32 s34, s34, 1
L_voted_8:
 v_and_b32 v1, 63, v0
 v_lshlrev_b32 v2, 4, v1
 v_bfrev_b32 v7, 1
 s_mov_b32 s48, 0
 v_and_b32 v5, 0x13, v1
 v_bfe_u32 v3, v1, 2, 1
 v_lshl_add_u32 v5, v3, 3, v5
 v_bfe_u32 v3, v1, 3, 1
 v_lshl_add_u32 v5, v3, 2, v5
 v_lshrrev_b32 v4, 5, v1
 v_lshlrev_b32 v3, 9, v4
 v_lshl_add_u32 v6, v5, 4, v3
 v_and_b32 v3, 31, v1
 v_mul_u32_u24 v3, 2064, v3
 v_lshl_add_u32 v10, v4, 4, v3
 v_add_u32 v11, 66048, v10
 s_lshr_b32 s50, s25, 3
 s_add_u32 s50, s50, 0
 s_and_b32 s51, s25, 7
 s_lshl_b32 s51, s51, 2
 s_add_u32 s51, s51, s26
 v_mad_u32_u24 v3, v1, 12, s50
 v_cmp_gt_u32 vcc, 64, v3
 s_lshl_b32 s41, s51, 2
 s_add_u32 s41, s41, 3760128
 v_lshl_add_u32 v3, v3, 7, s41
 v_cndmask_b32 v14, v7, v3, vcc
 s_lshl_b32 s41, s25, 7
 s_add_u32 s41, s41, 3735600
 s_lshl_b32 s42, s26, 2
 s_add_u32 s41, s41, s42
 v_mov_b32 v3, s41
 v_cmp_eq_u32 vcc, 0, v1
 v_mov_b32 v9, 0
 s_nop 0
 v_cndmask_b32 v8, v7, v3, vcc
 v_bfe_u32 v13, v1, 2, 2
 v_lshrrev_b32 v3, 5, v1
 v_lshl_add_u32 v13, v3, 3, v13
 v_lshlrev_b32 v13, 8, v13
 v_bfe_u32 v3, v1, 4, 1
 v_lshl_add_u32 v13, v3, 5, v13
 v_and_b32 v3, 1, v1
 v_lshl_add_u32 v13, v3, 4, v13
 v_bfe_u32 v3, v1, 1, 1
 v_lshl_add_u32 v13, v3, 3, v13
 s_lshl_b32 s43, s26, 6
 v_add_u32 v13, s43, v13
 buffer_store_dword v9, v8, s[4:7], 0 offen sc1
 buffer_store_dword v9, v14, s[4:7], 0 offen sc1
 s_add_u32 m0, s45, 32768
 s_add_u32 s43, s44, 1048576
 buffer_load_dwordx4 v12, s[8:11], s43 offen  lds
 s_add_u32 m0, s45, 33792
 s_add_u32 s43, s44, 1081344
 buffer_load_dwordx4 v12, s[8:11], s43 offen  lds
 s_add_u32 m0, s45, 34816
 s_add_u32 s43, s44, 1114112
 buffer_load_dwordx4 v12, s[8:11], s43 offen  lds
 s_add_u32 m0, s45, 35840
 s_add_u32 s43, s44, 1146880
 buffer_load_dwordx4 v12, s[8:11], s43 offen  lds
 s_add_u32 m0, s45, 36864
 s_add_u32 s43, s44, 1179648
 buffer_load_dwordx4 v12, s[8:11], s43 offen  lds
 s_add_u32 m0, s45, 37888
 s_add_u32 s43, s44, 1212416
 buffer_load_dwordx4 v12, s[8:11], s43 offen  lds
 s_add_u32 m0, s45, 38912
 s_add_u32 s43, s44, 1245184
 buffer_load_dwordx4 v12, s[8:11], s43 offen  lds
 s_add_u32 m0, s45, 39936
 s_add_u32 s43, s44, 1277952
 buffer_load_dwordx4 v12, s[8:11], s43 offen  lds
 v_and_b32 v67, 15, v64
 v_lshrrev_b32 v68, 4, v64
 v_cvt_f32_u32 v200, v67
 v_mul_f32 v206, 0x41800000, v200
 v_lshl_add_u32 v65, v67, 1, 0
 v_add_u32 v65, 256, v65
 v_and_b32 v66, 3, v67
 v_lshlrev_b32 v66, 2, v66
 v_lshrrev_b32 v69, 2, v67
 v_lshl_add_u32 v66, v69, 8, v66
 v_cmp_gt_u32 vcc, 8, v67
 s_nop 1
 v_cndmask_b32 v65, v66, v65, vcc
 v_cvt_f32_u32 v202, v65
 v_and_b32 v65, 1, v67
 v_lshlrev_b32 v65, 3, v65
 v_lshrrev_b32 v66, 1, v67
 v_min_u32 v66, 4, v66
 v_lshl_add_u32 v65, v66, 8, v65
 v_add_u32 v65, 1024, v65
 v_cvt_f32_u32 v204, v65
 s_waitcnt vmcnt(19)
 v_lshlrev_b32 v95, 16, v94
 v_mul_f32 v95, 0x3fb8aa3b, v95
 v_exp_f32 v95, v95
 s_nop 0
 v_cvt_pk_bf16_f32 v95, v95, v95
 v_and_b32 v95, s98, v95
 v_lshl_add_u32 v65, v64, 5, s94
 v_lshlrev_b32 v96, 16, v88
 v_lshlrev_b32 v97, 16, v89
 v_lshlrev_b32 v98, 16, v90
 v_lshlrev_b32 v99, 16, v91
 v_lshlrev_b32 v100, 16, v92
 v_lshlrev_b32 v101, 16, v93
 v_mul_f32 v96, v95, v96
 v_mul_f32 v97, v95, v97
 v_mul_f32 v98, v95, v98
 v_mul_f32 v99, v95, v99
 v_mul_f32 v104, 0x3fb8aa3b, v96
 v_mul_f32 v105, 0x3e22f983, v97
 v_mul_f32 v106, v100, v98
 v_fma_f32 v106, -v101, v99, v106
 v_mul_f32 v107, v100, v99
 v_fma_f32 v107, v101, v98, v107
 ds_write_b128 v65, v[104:107] offset:4160
 v_and_b32 v96, s98, v88
 v_and_b32 v97, s98, v89
 v_and_b32 v98, s98, v90
 v_and_b32 v99, s98, v91
 v_and_b32 v100, s98, v92
 v_and_b32 v101, s98, v93
 v_mul_f32 v96, v95, v96
 v_mul_f32 v97, v95, v97
 v_mul_f32 v98, v95, v98
 v_mul_f32 v99, v95, v99
 v_mul_f32 v108, 0x3fb8aa3b, v96
 v_mul_f32 v109, 0x3e22f983, v97
 v_mul_f32 v110, v100, v98
 v_fma_f32 v110, -v101, v99, v110
 v_mul_f32 v111, v100, v99
 v_fma_f32 v111, v101, v98, v111
 ds_write_b128 v65, v[108:111] offset:4176
 v_mov_b32 v120, 0
 v_mov_b32 v121, 0
 v_mov_b32 v122, 0
 v_mov_b32 v123, 0
 v_mov_b32 v124, 0
 v_mov_b32 v125, 0
 v_mov_b32 v126, 0
 v_mov_b32 v127, 0
 v_mov_b32 v128, 0
 v_mov_b32 v129, 0
 v_mov_b32 v130, 0
 v_mov_b32 v131, 0
 v_lshl_add_u32 v69, v68, 6, s94
 s_mov_b32 s95, 0
 s_waitcnt lgkmcnt(0)
L_rQb_kg0:
 ds_read_b128 v[88:91], v69 offset:4160
 ds_read_b128 v[92:95], v69 offset:4176
 ds_read_b128 v[96:99], v69 offset:4192
 ds_read_b128 v[100:103], v69 offset:4208
 v_add_u32 v69, 256, v69
 s_waitcnt lgkmcnt(3)
 v_pk_mul_f32 v[132:133], v[88:89], v[200:201] op_sel_hi:[1,0]
 v_pk_mul_f32 v[136:137], v[88:89], v[202:203] op_sel_hi:[1,0]
 v_pk_mul_f32 v[140:141], v[88:89], v[204:205] op_sel_hi:[1,0]
 v_pk_mul_f32 v[144:145], v[88:89], v[206:207] op_sel_hi:[1,0]
 v_fract_f32 v133, v133
 v_fract_f32 v137, v137
 v_fract_f32 v141, v141
 v_fract_f32 v145, v145
 v_exp_f32 v132, v132
 v_cos_f32 v134, v133
 v_sin_f32 v135, v133
 v_exp_f32 v136, v136
 v_cos_f32 v138, v137
 v_sin_f32 v139, v137
 v_exp_f32 v140, v140
 v_cos_f32 v142, v141
 v_sin_f32 v143, v141
 v_exp_f32 v144, v144
 v_cos_f32 v146, v145
 v_sin_f32 v147, v145
 v_pk_mul_f32 v[134:135], v[134:135], v[132:133] op_sel_hi:[1,0]
 v_pk_mul_f32 v[138:139], v[138:139], v[136:137] op_sel_hi:[1,0]
 v_pk_mul_f32 v[142:143], v[142:143], v[140:141] op_sel_hi:[1,0]
 v_pk_mul_f32 v[146:147], v[146:147], v[144:145] op_sel_hi:[1,0]
 v_pk_mul_f32 v[144:145], v[146:147], v[90:91] op_sel_hi:[0,1] neg_hi:[0,1]
 v_cvt_pk_bf16_f32 v104, v134, v135
 v_cvt_pk_bf16_f32 v108, v138, v139
 v_cvt_pk_bf16_f32 v112, v142, v143
 v_pk_fma_f32 v[144:145], v[146:147], v[90:91], v[144:145] op_sel:[1,1,0] op_sel_hi:[1,0,1] neg_lo:[0,1,0] neg_hi:[0,1,0]
 v_cvt_pk_bf16_f32 v116, v144, v145
 s_waitcnt lgkmcnt(2)
 v_pk_mul_f32 v[132:133], v[92:93], v[200:201] op_sel_hi:[1,0]
 v_pk_mul_f32 v[136:137], v[92:93], v[202:203] op_sel_hi:[1,0]
 v_pk_mul_f32 v[140:141], v[92:93], v[204:205] op_sel_hi:[1,0]
 v_pk_mul_f32 v[144:145], v[92:93], v[206:207] op_sel_hi:[1,0]
 v_fract_f32 v133, v133
 v_fract_f32 v137, v137
 v_fract_f32 v141, v141
 v_fract_f32 v145, v145
 v_exp_f32 v132, v132
 v_cos_f32 v134, v133
 v_sin_f32 v135, v133
 v_exp_f32 v136, v136
 v_cos_f32 v138, v137
 v_sin_f32 v139, v137
 v_exp_f32 v140, v140
 v_cos_f32 v142, v141
 v_sin_f32 v143, v141
 v_exp_f32 v144, v144
 v_cos_f32 v146, v145
 v_sin_f32 v147, v145
 v_pk_mul_f32 v[134:135], v[134:135], v[132:133] op_sel_hi:[1,0]
 v_pk_mul_f32 v[138:139], v[138:139], v[136:137] op_sel_hi:[1,0]
 v_pk_mul_f32 v[142:143], v[142:143], v[140:141] op_sel_hi:[1,0]
 v_pk_mul_f32 v[146:147], v[146:147], v[144:145] op_sel_hi:[1,0]
 v_pk_mul_f32 v[144:145], v[146:147], v[94:95] op_sel_hi:[0,1] neg_hi:[0,1]
 v_cvt_pk_bf16_f32 v105, v134, v135
 v_cvt_pk_bf16_f32 v109, v138, v139
 v_cvt_pk_bf16_f32 v113, v142, v143
 v_pk_fma_f32 v[144:145], v[146:147], v[94:95], v[144:145] op_sel:[1,1,0] op_sel_hi:[1,0,1] neg_lo:[0,1,0] neg_hi:[0,1,0]
 v_cvt_pk_bf16_f32 v117, v144, v145
 s_waitcnt lgkmcnt(1)
 v_pk_mul_f32 v[132:133], v[96:97], v[200:201] op_sel_hi:[1,0]
 v_pk_mul_f32 v[136:137], v[96:97], v[202:203] op_sel_hi:[1,0]
 v_pk_mul_f32 v[140:141], v[96:97], v[204:205] op_sel_hi:[1,0]
 v_pk_mul_f32 v[144:145], v[96:97], v[206:207] op_sel_hi:[1,0]
 v_fract_f32 v133, v133
 v_fract_f32 v137, v137
 v_fract_f32 v141, v141
 v_fract_f32 v145, v145
 v_exp_f32 v132, v132
 v_cos_f32 v134, v133
 v_sin_f32 v135, v133
 v_exp_f32 v136, v136
 v_cos_f32 v138, v137
 v_sin_f32 v139, v137
 v_exp_f32 v140, v140
 v_cos_f32 v142, v141
 v_sin_f32 v143, v141
 v_exp_f32 v144, v144
 v_cos_f32 v146, v145
 v_sin_f32 v147, v145
 v_pk_mul_f32 v[134:135], v[134:135], v[132:133] op_sel_hi:[1,0]
 v_pk_mul_f32 v[138:139], v[138:139], v[136:137] op_sel_hi:[1,0]
 v_pk_mul_f32 v[142:143], v[142:143], v[140:141] op_sel_hi:[1,0]
 v_pk_mul_f32 v[146:147], v[146:147], v[144:145] op_sel_hi:[1,0]
 v_pk_mul_f32 v[144:145], v[146:147], v[98:99] op_sel_hi:[0,1] neg_hi:[0,1]
 v_cvt_pk_bf16_f32 v106, v134, v135
 v_cvt_pk_bf16_f32 v110, v138, v139
 v_cvt_pk_bf16_f32 v114, v142, v143
 v_pk_fma_f32 v[144:145], v[146:147], v[98:99], v[144:145] op_sel:[1,1,0] op_sel_hi:[1,0,1] neg_lo:[0,1,0] neg_hi:[0,1,0]
 v_cvt_pk_bf16_f32 v118, v144, v145
 s_waitcnt lgkmcnt(0)
 v_pk_mul_f32 v[132:133], v[100:101], v[200:201] op_sel_hi:[1,0]
 v_pk_mul_f32 v[136:137], v[100:101], v[202:203] op_sel_hi:[1,0]
 v_pk_mul_f32 v[140:141], v[100:101], v[204:205] op_sel_hi:[1,0]
 v_pk_mul_f32 v[144:145], v[100:101], v[206:207] op_sel_hi:[1,0]
 v_fract_f32 v133, v133
 v_fract_f32 v137, v137
 v_fract_f32 v141, v141
 v_fract_f32 v145, v145
 v_exp_f32 v132, v132
 v_cos_f32 v134, v133
 v_sin_f32 v135, v133
 v_exp_f32 v136, v136
 v_cos_f32 v138, v137
 v_sin_f32 v139, v137
 v_exp_f32 v140, v140
 v_cos_f32 v142, v141
 v_sin_f32 v143, v141
 v_exp_f32 v144, v144
 v_cos_f32 v146, v145
 v_sin_f32 v147, v145
 v_pk_mul_f32 v[134:135], v[134:135], v[132:133] op_sel_hi:[1,0]
 v_pk_mul_f32 v[138:139], v[138:139], v[136:137] op_sel_hi:[1,0]
 v_pk_mul_f32 v[142:143], v[142:143], v[140:141] op_sel_hi:[1,0]
 v_pk_mul_f32 v[146:147], v[146:147], v[144:145] op_sel_hi:[1,0]
 v_pk_mul_f32 v[144:145], v[146:147], v[102:103] op_sel_hi:[0,1] neg_hi:[0,1]
 v_cvt_pk_bf16_f32 v107, v134, v135
 v_cvt_pk_bf16_f32 v111, v138, v139
 v_cvt_pk_bf16_f32 v115, v142, v143
 v_pk_fma_f32 v[144:145], v[146:147], v[102:103], v[144:145] op_sel:[1,1,0] op_sel_hi:[1,0,1] neg_lo:[0,1,0] neg_hi:[0,1,0]
 v_cvt_pk_bf16_f32 v119, v144, v145
 s_add_u32 s95, s95, 1
 s_cmp_lt_u32 s95, 2
 v_mfma_f32_16x16x32_bf16 v[120:123], v[104:107], v[116:119], v[120:123]
 v_mfma_f32_16x16x32_bf16 v[124:127], v[108:111], v[116:119], v[124:127]
 v_mfma_f32_16x16x32_bf16 v[128:131], v[112:115], v[116:119], v[128:131]
 s_cbranch_scc1 L_rQb_kg0
 s_waitcnt vmcnt(10)
 s_barrier
 ds_read_b64_tr_b16 a[0:1], v13 offset:0
 ds_read_b64_tr_b16 a[2:3], v13 offset:1024
 ds_read_b64_tr_b16 a[4:5], v13 offset:4096
 ds_read_b64_tr_b16 a[6:7], v13 offset:5120
 ds_read_b64_tr_b16 a[8:9], v13 offset:8192
 ds_read_b64_tr_b16 a[10:11], v13 offset:9216
 ds_read_b64_tr_b16 a[12:13], v13 offset:12288
 ds_read_b64_tr_b16 a[14:15], v13 offset:13312
 s_waitcnt lgkmcnt(0)
 ds_read_b64_tr_b16 a[16:17], v13 offset:16384
 ds_read_b64_tr_b16 a[18:19], v13 offset:17408
 ds_read_b64_tr_b16 a[20:21], v13 offset:20480
 ds_read_b64_tr_b16 a[22:23], v13 offset:21504
 ds_read_b64_tr_b16 a[24:25], v13 offset:24576
 ds_read_b64_tr_b16 a[26:27], v13 offset:25600
 ds_read_b64_tr_b16 a[28:29], v13 offset:28672
 ds_read_b64_tr_b16 a[30:31], v13 offset:29696
 s_waitcnt lgkmcnt(0)
 s_barrier
 s_add_u32 m0, s45, 0
 s_add_u32 s43, s44, 2097152
 buffer_load_dwordx4 v12, s[8:11], s43 offen  lds
 s_add_u32 m0, s45, 1024
 s_add_u32 s43, s44, 2129920
 buffer_load_dwordx4 v12, s[8:11], s43 offen  lds
 s_add_u32 m0, s45, 2048
 s_add_u32 s43, s44, 2162688
 buffer_load_dwordx4 v12, s[8:11], s43 offen  lds
 s_add_u32 m0, s45, 3072
 s_add_u32 s43, s44, 2195456
 buffer_load_dwordx4 v12, s[8:11], s43 offen  lds
 s_add_u32 m0, s45, 4096
 s_add_u32 s43, s44, 2228224
 buffer_load_dwordx4 v12, s[8:11], s43 offen  lds
 s_add_u32 m0, s45, 5120
 s_add_u32 s43, s44, 2260992
 buffer_load_dwordx4 v12, s[8:11], s43 offen  lds
 s_add_u32 m0, s45, 6144
 s_add_u32 s43, s44, 2293760
 buffer_load_dwordx4 v12, s[8:11], s43 offen  lds
 s_add_u32 m0, s45, 7168
 s_add_u32 s43, s44, 2326528
 buffer_load_dwordx4 v12, s[8:11], s43 offen  lds
L_rQb_kg1:
 ds_read_b128 v[88:91], v69 offset:4160
 ds_read_b128 v[92:95], v69 offset:4176
 ds_read_b128 v[96:99], v69 offset:4192
 ds_read_b128 v[100:103], v69 offset:4208
 v_add_u32 v69, 256, v69
 s_waitcnt lgkmcnt(3)
 v_pk_mul_f32 v[132:133], v[88:89], v[200:201] op_sel_hi:[1,0]
 v_pk_mul_f32 v[136:137], v[88:89], v[202:203] op_sel_hi:[1,0]
 v_pk_mul_f32 v[140:141], v[88:89], v[204:205] op_sel_hi:[1,0]
 v_pk_mul_f32 v[144:145], v[88:89], v[206:207] op_sel_hi:[1,0]
 v_fract_f32 v133, v133
 v_fract_f32 v137, v137
 v_fract_f32 v141, v141
 v_fract_f32 v145, v145
 v_exp_f32 v132, v132
 v_cos_f32 v134, v133
 v_sin_f32 v135, v133
 v_exp_f32 v136, v136
 v_cos_f32 v138, v137
 v_sin_f32 v139, v137
 v_exp_f32 v140, v140
 v_cos_f32 v142, v141
 v_sin_f32 v143, v141
 v_exp_f32 v144, v144
 v_cos_f32 v146, v145
 v_sin_f32 v147, v145
 v_pk_mul_f32 v[134:135], v[134:135], v[132:133] op_sel_hi:[1,0]
 v_pk_mul_f32 v[138:139], v[138:139], v[136:137] op_sel_hi:[1,0]
 v_pk_mul_f32 v[142:143], v[142:143], v[140:141] op_sel_hi:[1,0]
 v_pk_mul_f32 v[146:147], v[146:147], v[144:145] op_sel_hi:[1,0]
 v_pk_mul_f32 v[144:145], v[146:147], v[90:91] op_sel_hi:[0,1] neg_hi:[0,1]
 v_cvt_pk_bf16_f32 v104, v134, v135
 v_cvt_pk_bf16_f32 v108, v138, v139
 v_cvt_pk_bf16_f32 v112, v142, v143
 v_pk_fma_f32 v[144:145], v[146:147], v[90:91], v[144:145] op_sel:[1,1,0] op_sel_hi:[1,0,1] neg_lo:[0,1,0] neg_hi:[0,1,0]
 v_cvt_pk_bf16_f32 v116, v144, v145
 s_waitcnt lgkmcnt(2)
 v_pk_mul_f32 v[132:133], v[92:93], v[200:201] op_sel_hi:[1,0]
 v_pk_mul_f32 v[136:137], v[92:93], v[202:203] op_sel_hi:[1,0]
 v_pk_mul_f32 v[140:141], v[92:93], v[204:205] op_sel_hi:[1,0]
 v_pk_mul_f32 v[144:145], v[92:93], v[206:207] op_sel_hi:[1,0]
 v_fract_f32 v133, v133
 v_fract_f32 v137, v137
 v_fract_f32 v141, v141
 v_fract_f32 v145, v145
 v_exp_f32 v132, v132
 v_cos_f32 v134, v133
 v_sin_f32 v135, v133
 v_exp_f32 v136, v136
 v_cos_f32 v138, v137
 v_sin_f32 v139, v137
 v_exp_f32 v140, v140
 v_cos_f32 v142, v141
 v_sin_f32 v143, v141
 v_exp_f32 v144, v144
 v_cos_f32 v146, v145
 v_sin_f32 v147, v145
 v_pk_mul_f32 v[134:135], v[134:135], v[132:133] op_sel_hi:[1,0]
 v_pk_mul_f32 v[138:139], v[138:139], v[136:137] op_sel_hi:[1,0]
 v_pk_mul_f32 v[142:143], v[142:143], v[140:141] op_sel_hi:[1,0]
 v_pk_mul_f32 v[146:147], v[146:147], v[144:145] op_sel_hi:[1,0]
 v_pk_mul_f32 v[144:145], v[146:147], v[94:95] op_sel_hi:[0,1] neg_hi:[0,1]
 v_cvt_pk_bf16_f32 v105, v134, v135
 v_cvt_pk_bf16_f32 v109, v138, v139
 v_cvt_pk_bf16_f32 v113, v142, v143
 v_pk_fma_f32 v[144:145], v[146:147], v[94:95], v[144:145] op_sel:[1,1,0] op_sel_hi:[1,0,1] neg_lo:[0,1,0] neg_hi:[0,1,0]
 v_cvt_pk_bf16_f32 v117, v144, v145
 s_waitcnt lgkmcnt(1)
 v_pk_mul_f32 v[132:133], v[96:97], v[200:201] op_sel_hi:[1,0]
 v_pk_mul_f32 v[136:137], v[96:97], v[202:203] op_sel_hi:[1,0]
 v_pk_mul_f32 v[140:141], v[96:97], v[204:205] op_sel_hi:[1,0]
 v_pk_mul_f32 v[144:145], v[96:97], v[206:207] op_sel_hi:[1,0]
 v_fract_f32 v133, v133
 v_fract_f32 v137, v137
 v_fract_f32 v141, v141
 v_fract_f32 v145, v145
 v_exp_f32 v132, v132
 v_cos_f32 v134, v133
 v_sin_f32 v135, v133
 v_exp_f32 v136, v136
 v_cos_f32 v138, v137
 v_sin_f32 v139, v137
 v_exp_f32 v140, v140
 v_cos_f32 v142, v141
 v_sin_f32 v143, v141
 v_exp_f32 v144, v144
 v_cos_f32 v146, v145
 v_sin_f32 v147, v145
 v_pk_mul_f32 v[134:135], v[134:135], v[132:133] op_sel_hi:[1,0]
 v_pk_mul_f32 v[138:139], v[138:139], v[136:137] op_sel_hi:[1,0]
 v_pk_mul_f32 v[142:143], v[142:143], v[140:141] op_sel_hi:[1,0]
 v_pk_mul_f32 v[146:147], v[146:147], v[144:145] op_sel_hi:[1,0]
 v_pk_mul_f32 v[144:145], v[146:147], v[98:99] op_sel_hi:[0,1] neg_hi:[0,1]
 v_cvt_pk_bf16_f32 v106, v134, v135
 v_cvt_pk_bf16_f32 v110, v138, v139
 v_cvt_pk_bf16_f32 v114, v142, v143
 v_pk_fma_f32 v[144:145], v[146:147], v[98:99], v[144:145] op_sel:[1,1,0] op_sel_hi:[1,0,1] neg_lo:[0,1,0] neg_hi:[0,1,0]
 v_cvt_pk_bf16_f32 v118, v144, v145
 s_waitcnt lgkmcnt(0)
 v_pk_mul_f32 v[132:133], v[100:101], v[200:201] op_sel_hi:[1,0]
 v_pk_mul_f32 v[136:137], v[100:101], v[202:203] op_sel_hi:[1,0]
 v_pk_mul_f32 v[140:141], v[100:101], v[204:205] op_sel_hi:[1,0]
 v_pk_mul_f32 v[144:145], v[100:101], v[206:207] op_sel_hi:[1,0]
 v_fract_f32 v133, v133
 v_fract_f32 v137, v137
 v_fract_f32 v141, v141
 v_fract_f32 v145, v145
 v_exp_f32 v132, v132
 v_cos_f32 v134, v133
 v_sin_f32 v135, v133
 v_exp_f32 v136, v136
 v_cos_f32 v138, v137
 v_sin_f32 v139, v137
 v_exp_f32 v140, v140
 v_cos_f32 v142, v141
 v_sin_f32 v143, v141
 v_exp_f32 v144, v144
 v_cos_f32 v146, v145
 v_sin_f32 v147, v145
 v_pk_mul_f32 v[134:135], v[134:135], v[132:133] op_sel_hi:[1,0]
 v_pk_mul_f32 v[138:139], v[138:139], v[136:137] op_sel_hi:[1,0]
 v_pk_mul_f32 v[142:143], v[142:143], v[140:141] op_sel_hi:[1,0]
 v_pk_mul_f32 v[146:147], v[146:147], v[144:145] op_sel_hi:[1,0]
 v_pk_mul_f32 v[144:145], v[146:147], v[102:103] op_sel_hi:[0,1] neg_hi:[0,1]
 v_cvt_pk_bf16_f32 v107, v134, v135
 v_cvt_pk_bf16_f32 v111, v138, v139
 v_cvt_pk_bf16_f32 v115, v142, v143
 v_pk_fma_f32 v[144:145], v[146:147], v[102:103], v[144:145] op_sel:[1,1,0] op_sel_hi:[1,0,1] neg_lo:[0,1,0] neg_hi:[0,1,0]
 v_cvt_pk_bf16_f32 v119, v144, v145
 s_add_u32 s95, s95, 1
 s_cmp_lt_u32 s95, 5
 v_mfma_f32_16x16x32_bf16 v[120:123], v[104:107], v[116:119], v[120:123]
 v_mfma_f32_16x16x32_bf16 v[124:127], v[108:111], v[116:119], v[124:127]
 v_mfma_f32_16x16x32_bf16 v[128:131], v[112:115], v[116:119], v[128:131]
 s_cbranch_scc1 L_rQb_kg1
 s_lshl_b32 s93, s28, 3
 buffer_load_dwordx2 v[72:73], v70, s[84:87], s93 offen offset:0
 buffer_load_dwordx2 v[74:75], v70, s[84:87], s93 offen offset:2048
 s_add_u32 s93, s93, 4096
 buffer_load_dwordx2 v[76:77], v70, s[84:87], s93 offen offset:0
 buffer_load_dwordx2 v[78:79], v70, s[84:87], s93 offen offset:2048
 s_add_u32 s93, s93, 4096
 buffer_load_dwordx2 v[80:81], v70, s[84:87], s93 offen offset:0
 buffer_load_dwordx2 v[82:83], v70, s[84:87], s93 offen offset:2048
 s_add_u32 s93, s93, 4096
 buffer_load_dwordx2 v[84:85], v70, s[84:87], s93 offen offset:0
 buffer_load_dwordx2 v[86:87], v70, s[84:87], s93 offen offset:2048
 s_waitcnt vmcnt(16)
 s_barrier
 ds_read_b64_tr_b16 a[32:33], v13 offset:32768
 ds_read_b64_tr_b16 a[34:35], v13 offset:33792
 ds_read_b64_tr_b16 a[36:37], v13 offset:36864
 ds_read_b64_tr_b16 a[38:39], v13 offset:37888
 ds_read_b64_tr_b16 a[40:41], v13 offset:40960
 ds_read_b64_tr_b16 a[42:43], v13 offset:41984
 ds_read_b64_tr_b16 a[44:45], v13 offset:45056
 ds_read_b64_tr_b16 a[46:47], v13 offset:46080
 s_waitcnt lgkmcnt(0)
 ds_read_b64_tr_b16 a[48:49], v13 offset:49152
 ds_read_b64_tr_b16 a[50:51], v13 offset:50176
 ds_read_b64_tr_b16 a[52:53], v13 offset:53248
 ds_read_b64_tr_b16 a[54:55], v13 offset:54272
 ds_read_b64_tr_b16 a[56:57], v13 offset:57344
 ds_read_b64_tr_b16 a[58:59], v13 offset:58368
 ds_read_b64_tr_b16 a[60:61], v13 offset:61440
 ds_read_b64_tr_b16 a[62:63], v13 offset:62464
 s_waitcnt lgkmcnt(0)
 s_barrier
 s_add_u32 m0, s45, 32768
 s_add_u32 s43, s44, 3145728
 buffer_load_dwordx4 v12, s[8:11], s43 offen  lds
 s_add_u32 m0, s45, 33792
 s_add_u32 s43, s44, 3178496
 buffer_load_dwordx4 v12, s[8:11], s43 offen  lds
 s_add_u32 m0, s45, 34816
 s_add_u32 s43, s44, 3211264
 buffer_load_dwordx4 v12, s[8:11], s43 offen  lds
 s_add_u32 m0, s45, 35840
 s_add_u32 s43, s44, 3244032
 buffer_load_dwordx4 v12, s[8:11], s43 offen  lds
 s_add_u32 m0, s45, 36864
 s_add_u32 s43, s44, 3276800
 buffer_load_dwordx4 v12, s[8:11], s43 offen  lds
 s_add_u32 m0, s45, 37888
 s_add_u32 s43, s44, 3309568
 buffer_load_dwordx4 v12, s[8:11], s43 offen  lds
 s_add_u32 m0, s45, 38912
 s_add_u32 s43, s44, 3342336
 buffer_load_dwordx4 v12, s[8:11], s43 offen  lds
 s_add_u32 m0, s45, 39936
 s_add_u32 s43, s44, 3375104
 buffer_load_dwordx4 v12, s[8:11], s43 offen  lds
L_rQb_kg2:
 ds_read_b128 v[88:91], v69 offset:4160
 ds_read_b128 v[92:95], v69 offset:4176
 ds_read_b128 v[96:99], v69 offset:4192
 ds_read_b128 v[100:103], v69 offset:4208
 v_add_u32 v69, 256, v69
 s_waitcnt lgkmcnt(3)
 v_pk_mul_f32 v[132:133], v[88:89], v[200:201] op_sel_hi:[1,0]
 v_pk_mul_f32 v[136:137], v[88:89], v[202:203] op_sel_hi:[1,0]
 v_pk_mul_f32 v[140:141], v[88:89], v[204:205] op_sel_hi:[1,0]
 v_pk_mul_f32 v[144:145], v[88:89], v[206:207] op_sel_hi:[1,0]
 v_fract_f32 v133, v133
 v_fract_f32 v137, v137
 v_fract_f32 v141, v141
 v_fract_f32 v145, v145
 v_exp_f32 v132, v132
 v_cos_f32 v134, v133
 v_sin_f32 v135, v133
 v_exp_f32 v136, v136
 v_cos_f32 v138, v137
 v_sin_f32 v139, v137
 v_exp_f32 v140, v140
 v_cos_f32 v142, v141
 v_sin_f32 v143, v141
 v_exp_f32 v144, v144
 v_cos_f32 v146, v145
 v_sin_f32 v147, v145
 v_pk_mul_f32 v[134:135], v[134:135], v[132:133] op_sel_hi:[1,0]
 v_pk_mul_f32 v[138:139], v[138:139], v[136:137] op_sel_hi:[1,0]
 v_pk_mul_f32 v[142:143], v[142:143], v[140:141] op_sel_hi:[1,0]
 v_pk_mul_f32 v[146:147], v[146:147], v[144:145] op_sel_hi:[1,0]
 v_pk_mul_f32 v[144:145], v[146:147], v[90:91] op_sel_hi:[0,1] neg_hi:[0,1]
 v_cvt_pk_bf16_f32 v104, v134, v135
 v_cvt_pk_bf16_f32 v108, v138, v139
 v_cvt_pk_bf16_f32 v112, v142, v143
 v_pk_fma_f32 v[144:145], v[146:147], v[90:91], v[144:145] op_sel:[1,1,0] op_sel_hi:[1,0,1] neg_lo:[0,1,0] neg_hi:[0,1,0]
 v_cvt_pk_bf16_f32 v116, v144, v145
 s_waitcnt lgkmcnt(2)
 v_pk_mul_f32 v[132:133], v[92:93], v[200:201] op_sel_hi:[1,0]
 v_pk_mul_f32 v[136:137], v[92:93], v[202:203] op_sel_hi:[1,0]
 v_pk_mul_f32 v[140:141], v[92:93], v[204:205] op_sel_hi:[1,0]
 v_pk_mul_f32 v[144:145], v[92:93], v[206:207] op_sel_hi:[1,0]
 v_fract_f32 v133, v133
 v_fract_f32 v137, v137
 v_fract_f32 v141, v141
 v_fract_f32 v145, v145
 v_exp_f32 v132, v132
 v_cos_f32 v134, v133
 v_sin_f32 v135, v133
 v_exp_f32 v136, v136
 v_cos_f32 v138, v137
 v_sin_f32 v139, v137
 v_exp_f32 v140, v140
 v_cos_f32 v142, v141
 v_sin_f32 v143, v141
 v_exp_f32 v144, v144
 v_cos_f32 v146, v145
 v_sin_f32 v147, v145
 v_pk_mul_f32 v[134:135], v[134:135], v[132:133] op_sel_hi:[1,0]
 v_pk_mul_f32 v[138:139], v[138:139], v[136:137] op_sel_hi:[1,0]
 v_pk_mul_f32 v[142:143], v[142:143], v[140:141] op_sel_hi:[1,0]
 v_pk_mul_f32 v[146:147], v[146:147], v[144:145] op_sel_hi:[1,0]
 v_pk_mul_f32 v[144:145], v[146:147], v[94:95] op_sel_hi:[0,1] neg_hi:[0,1]
 v_cvt_pk_bf16_f32 v105, v134, v135
 v_cvt_pk_bf16_f32 v109, v138, v139
 v_cvt_pk_bf16_f32 v113, v142, v143
 v_pk_fma_f32 v[144:145], v[146:147], v[94:95], v[144:145] op_sel:[1,1,0] op_sel_hi:[1,0,1] neg_lo:[0,1,0] neg_hi:[0,1,0]
 v_cvt_pk_bf16_f32 v117, v144, v145
 s_waitcnt lgkmcnt(1)
 v_pk_mul_f32 v[132:133], v[96:97], v[200:201] op_sel_hi:[1,0]
 v_pk_mul_f32 v[136:137], v[96:97], v[202:203] op_sel_hi:[1,0]
 v_pk_mul_f32 v[140:141], v[96:97], v[204:205] op_sel_hi:[1,0]
 v_pk_mul_f32 v[144:145], v[96:97], v[206:207] op_sel_hi:[1,0]
 v_fract_f32 v133, v133
 v_fract_f32 v137, v137
 v_fract_f32 v141, v141
 v_fract_f32 v145, v145
 v_exp_f32 v132, v132
 v_cos_f32 v134, v133
 v_sin_f32 v135, v133
 v_exp_f32 v136, v136
 v_cos_f32 v138, v137
 v_sin_f32 v139, v137
 v_exp_f32 v140, v140
 v_cos_f32 v142, v141
 v_sin_f32 v143, v141
 v_exp_f32 v144, v144
 v_cos_f32 v146, v145
 v_sin_f32 v147, v145
 v_pk_mul_f32 v[134:135], v[134:135], v[132:133] op_sel_hi:[1,0]
 v_pk_mul_f32 v[138:139], v[138:139], v[136:137] op_sel_hi:[1,0]
 v_pk_mul_f32 v[142:143], v[142:143], v[140:141] op_sel_hi:[1,0]
 v_pk_mul_f32 v[146:147], v[146:147], v[144:145] op_sel_hi:[1,0]
 v_pk_mul_f32 v[144:145], v[146:147], v[98:99] op_sel_hi:[0,1] neg_hi:[0,1]
 v_cvt_pk_bf16_f32 v106, v134, v135
 v_cvt_pk_bf16_f32 v110, v138, v139
 v_cvt_pk_bf16_f32 v114, v142, v143
 v_pk_fma_f32 v[144:145], v[146:147], v[98:99], v[144:145] op_sel:[1,1,0] op_sel_hi:[1,0,1] neg_lo:[0,1,0] neg_hi:[0,1,0]
 v_cvt_pk_bf16_f32 v118, v144, v145
 s_waitcnt lgkmcnt(0)
 v_pk_mul_f32 v[132:133], v[100:101], v[200:201] op_sel_hi:[1,0]
 v_pk_mul_f32 v[136:137], v[100:101], v[202:203] op_sel_hi:[1,0]
 v_pk_mul_f32 v[140:141], v[100:101], v[204:205] op_sel_hi:[1,0]
 v_pk_mul_f32 v[144:145], v[100:101], v[206:207] op_sel_hi:[1,0]
 v_fract_f32 v133, v133
 v_fract_f32 v137, v137
 v_fract_f32 v141, v141
 v_fract_f32 v145, v145
 v_exp_f32 v132, v132
 v_cos_f32 v134, v133
 v_sin_f32 v135, v133
 v_exp_f32 v136, v136
 v_cos_f32 v138, v137
 v_sin_f32 v139, v137
 v_exp_f32 v140, v140
 v_cos_f32 v142, v141
 v_sin_f32 v143, v141
 v_exp_f32 v144, v144
 v_cos_f32 v146, v145
 v_sin_f32 v147, v145
 v_pk_mul_f32 v[134:135], v[134:135], v[132:133] op_sel_hi:[1,0]
 v_pk_mul_f32 v[138:139], v[138:139], v[136:137] op_sel_hi:[1,0]
 v_pk_mul_f32 v[142:143], v[142:143], v[140:141] op_sel_hi:[1,0]
 v_pk_mul_f32 v[146:147], v[146:147], v[144:145] op_sel_hi:[1,0]
 v_pk_mul_f32 v[144:145], v[146:147], v[102:103] op_sel_hi:[0,1] neg_hi:[0,1]
 v_cvt_pk_bf16_f32 v107, v134, v135
 v_cvt_pk_bf16_f32 v111, v138, v139
 v_cvt_pk_bf16_f32 v115, v142, v143
 v_pk_fma_f32 v[144:145], v[146:147], v[102:103], v[144:145] op_sel:[1,1,0] op_sel_hi:[1,0,1] neg_lo:[0,1,0] neg_hi:[0,1,0]
 v_cvt_pk_bf16_f32 v119, v144, v145
 s_add_u32 s95, s95, 1
 s_cmp_lt_u32 s95, 8
 v_mfma_f32_16x16x32_bf16 v[120:123], v[104:107], v[116:119], v[120:123]
 v_mfma_f32_16x16x32_bf16 v[124:127], v[108:111], v[116:119], v[124:127]
 v_mfma_f32_16x16x32_bf16 v[128:131], v[112:115], v[116:119], v[128:131]
 s_cbranch_scc1 L_rQb_kg2
 s_waitcnt vmcnt(16)
 s_barrier
 ds_read_b64_tr_b16 a[64:65], v13 offset:0
 ds_read_b64_tr_b16 a[66:67], v13 offset:1024
 ds_read_b64_tr_b16 a[68:69], v13 offset:4096
 ds_read_b64_tr_b16 a[70:71], v13 offset:5120
 ds_read_b64_tr_b16 a[72:73], v13 offset:8192
 ds_read_b64_tr_b16 a[74:75], v13 offset:9216
 ds_read_b64_tr_b16 a[76:77], v13 offset:12288
 ds_read_b64_tr_b16 a[78:79], v13 offset:13312
 s_waitcnt lgkmcnt(0)
 ds_read_b64_tr_b16 a[80:81], v13 offset:16384
 ds_read_b64_tr_b16 a[82:83], v13 offset:17408
 ds_read_b64_tr_b16 a[84:85], v13 offset:20480
 ds_read_b64_tr_b16 a[86:87], v13 offset:21504
 ds_read_b64_tr_b16 a[88:89], v13 offset:24576
 ds_read_b64_tr_b16 a[90:91], v13 offset:25600
 ds_read_b64_tr_b16 a[92:93], v13 offset:28672
 ds_read_b64_tr_b16 a[94:95], v13 offset:29696
 s_waitcnt lgkmcnt(0)
 s_barrier
 s_add_u32 m0, s45, 0
 s_add_u32 s43, s44, 4194304
 buffer_load_dwordx4 v12, s[8:11], s43 offen  lds
 s_add_u32 m0, s45, 1024
 s_add_u32 s43, s44, 4227072
 buffer_load_dwordx4 v12, s[8:11], s43 offen  lds
 s_add_u32 m0, s45, 2048
 s_add_u32 s43, s44, 4259840
 buffer_load_dwordx4 v12, s[8:11], s43 offen  lds
 s_add_u32 m0, s45, 3072
 s_add_u32 s43, s44, 4292608
 buffer_load_dwordx4 v12, s[8:11], s43 offen  lds
 s_add_u32 m0, s45, 4096
 s_add_u32 s43, s44, 4325376
 buffer_load_dwordx4 v12, s[8:11], s43 offen  lds
 s_add_u32 m0, s45, 5120
 s_add_u32 s43, s44, 4358144
 buffer_load_dwordx4 v12, s[8:11], s43 offen  lds
 s_add_u32 m0, s45, 6144
 s_add_u32 s43, s44, 4390912
 buffer_load_dwordx4 v12, s[8:11], s43 offen  lds
 s_add_u32 m0, s45, 7168
 s_add_u32 s43, s44, 4423680
 buffer_load_dwordx4 v12, s[8:11], s43 offen  lds
 v_mov_b32 v250, s34
 v_mov_b32 v251, s35
 v_bfrev_b32 v252, 1
 v_cmp_eq_u32 vcc, 64, v0
 s_nop 1
 v_cndmask_b32 v252, v252, 0, vcc
 buffer_atomic_add_x2 v[250:251], v252, s[12:15], s30 offen sc1
 v_lshlrev_b32 v65, 5, v67
 v_lshl_add_u32 v65, v68, 3, v65
 v_add_u32 v65, s94, v65
 v_lshlrev_b32 v66, 4, v67
 v_lshl_add_u32 v66, v68, 3, v66
 v_lshlrev_b32 v69, 3, v67
 v_lshl_add_u32 v69, v68, 7, v69
 v_cmp_gt_u32 vcc, 2, v68
 s_nop 1
 v_cndmask_b32 v66, v69, v66, vcc
 v_add_u32 v66, s94, v66
 v_lshlrev_b32 v69, 2, v67
 v_lshl_add_u32 v69, v68, 7, v69
 v_add_u32 v69, s94, v69
 v_cvt_pk_bf16_f32 v132, v120, v121
 v_cvt_pk_bf16_f32 v133, v122, v123
 v_cvt_pk_bf16_f32 v134, v124, v125
 v_cvt_pk_bf16_f32 v135, v126, v127
 v_cvt_pk_bf16_f32 v136, v128, v129
 v_cvt_pk_bf16_f32 v137, v130, v131
 ds_write_b64 v65, v[132:133]
 ds_write_b64 v66, v[134:135] offset:512
 ds_write_b32 v69, v136 offset:1024
 ds_write_b32 v69, v137 offset:1088
 v_lshrrev_b32 v65, 2, v0
 v_mul_u32_u24 v65, 80, v65
 v_and_b32 v66, 3, v0
 v_lshl_add_u32 v69, v66, 4, v65
 v_add_u32 v69, 82256, v69
 v_add_u32 v215, 43776, v69
 s_waitcnt vmcnt(17)
 v_perm_b32 v140, v74, v72, s96
 v_perm_b32 v141, v78, v76, s96
 v_perm_b32 v142, v82, v80, s96
 v_perm_b32 v143, v86, v84, s96
 ds_write_b128 v69, v[140:143] offset:0
 v_perm_b32 v144, v74, v72, s97
 v_perm_b32 v145, v78, v76, s97
 v_perm_b32 v146, v82, v80, s97
 v_perm_b32 v147, v86, v84, s97
 ds_write_b128 v69, v[144:147] offset:21888
 v_perm_b32 v148, v75, v73, s96
 v_perm_b32 v149, v79, v77, s96
 v_perm_b32 v150, v83, v81, s96
 v_perm_b32 v151, v87, v85, s96
 ds_write_b128 v215, v[148:151] offset:0
 v_perm_b32 v152, v75, v73, s97
 v_perm_b32 v153, v79, v77, s97
 v_perm_b32 v154, v83, v81, s97
 v_perm_b32 v155, v87, v85, s97
 ds_write_b128 v215, v[152:155] offset:21888
 v_lshlrev_b32 v65, 3, v64
 v_sub_u32 v65, 2047, v65
 v_cvt_f32_u32 v66, v65
 s_sub_u32 s92, s94, 34048
 s_waitcnt lgkmcnt(0)
 v_subrev_f32 v120, 0x0, v66
 v_subrev_f32 v121, 0x3f800000, v66
 v_cvt_pk_bf16_f32 v122, v120, v121
 v_and_b32 v120, 0xffff, v122
 v_lshrrev_b32 v121, 16, v122
 v_lshl_add_u32 v132, v120, 1, s92
 v_lshl_add_u32 v133, v121, 1, s92
 v_subrev_f32 v120, 0x40000000, v66
 v_subrev_f32 v121, 0x40400000, v66
 v_cvt_pk_bf16_f32 v122, v120, v121
 v_and_b32 v120, 0xffff, v122
 v_lshrrev_b32 v121, 16, v122
 v_lshl_add_u32 v134, v120, 1, s92
 v_lshl_add_u32 v135, v121, 1, s92
 v_subrev_f32 v120, 0x40800000, v66
 v_subrev_f32 v121, 0x40a00000, v66
 v_cvt_pk_bf16_f32 v122, v120, v121
 v_and_b32 v120, 0xffff, v122
 v_lshrrev_b32 v121, 16, v122
 v_lshl_add_u32 v136, v120, 1, s92
 v_lshl_add_u32 v137, v121, 1, s92
 v_subrev_f32 v120, 0x40c00000, v66
 v_subrev_f32 v121, 0x40e00000, v66
 v_cvt_pk_bf16_f32 v122, v120, v121
 v_and_b32 v120, 0xffff, v122
 v_lshrrev_b32 v121, 16, v122
 v_lshl_add_u32 v138, v120, 1, s92
 v_lshl_add_u32 v139, v121, 1, s92
 s_waitcnt lgkmcnt(0)
 ds_read_u16 v88, v132
 ds_read_u16 v92, v133
 ds_read_u16 v89, v134
 ds_read_u16 v93, v135
 ds_read_u16 v90, v136
 ds_read_u16 v94, v137
 ds_read_u16 v91, v138
 ds_read_u16 v95, v139
 v_subrev_f32 v120, 0x44000000, v66
 v_subrev_f32 v121, 0x44004000, v66
 v_cvt_pk_bf16_f32 v122, v120, v121
 v_and_b32 v120, 0xffff, v122
 v_lshrrev_b32 v121, 16, v122
 v_lshl_add_u32 v132, v120, 1, s92
 v_lshl_add_u32 v133, v121, 1, s92
 v_subrev_f32 v120, 0x44008000, v66
 v_subrev_f32 v121, 0x4400c000, v66
 v_cvt_pk_bf16_f32 v122, v120, v121
 v_and_b32 v120, 0xffff, v122
 v_lshrrev_b32 v121, 16, v122
 v_lshl_add_u32 v134, v120, 1, s92
 v_lshl_add_u32 v135, v121, 1, s92
 v_subrev_f32 v120, 0x44010000, v66
 v_subrev_f32 v121, 0x44014000, v66
 v_cvt_pk_bf16_f32 v122, v120, v121
 v_and_b32 v120, 0xffff, v122
 v_lshrrev_b32 v121, 16, v122
 v_lshl_add_u32 v136, v120, 1, s92
 v_lshl_add_u32 v137, v121, 1, s92
 v_subrev_f32 v120, 0x44018000, v66
 v_subrev_f32 v121, 0x4401c000, v66
 v_cvt_pk_bf16_f32 v122, v120, v121
 v_and_b32 v120, 0xffff, v122
 v_lshrrev_b32 v121, 16, v122
 v_lshl_add_u32 v138, v120, 1, s92
 v_lshl_add_u32 v139, v121, 1, s92
 s_waitcnt lgkmcnt(0)
 ds_read_u16 v96, v132
 ds_read_u16 v100, v133
 ds_read_u16 v97, v134
 ds_read_u16 v101, v135
 ds_read_u16 v98, v136
 ds_read_u16 v102, v137
 ds_read_u16 v99, v138
 ds_read_u16 v103, v139
 v_subrev_f32 v120, 0x44800000, v66
 v_subrev_f32 v121, 0x44802000, v66
 v_cvt_pk_bf16_f32 v122, v120, v121
 v_and_b32 v120, 0xffff, v122
 v_lshrrev_b32 v121, 16, v122
 v_lshl_add_u32 v132, v120, 1, s92
 v_lshl_add_u32 v133, v121, 1, s92
 v_subrev_f32 v120, 0x44804000, v66
 v_subrev_f32 v121, 0x44806000, v66
 v_cvt_pk_bf16_f32 v122, v120, v121
 v_and_b32 v120, 0xffff, v122
 v_lshrrev_b32 v121, 16, v122
 v_lshl_add_u32 v134, v120, 1, s92
 v_lshl_add_u32 v135, v121, 1, s92
 v_subrev_f32 v120, 0x44808000, v66
 v_subrev_f32 v121, 0x4480a000, v66
 v_cvt_pk_bf16_f32 v122, v120, v121
 v_and_b32 v120, 0xffff, v122
 v_lshrrev_b32 v121, 16, v122
 v_lshl_add_u32 v136, v120, 1, s92
 v_lshl_add_u32 v137, v121, 1, s92
 v_subrev_f32 v120, 0x4480c000, v66
 v_subrev_f32 v121, 0x4480e000, v66
 v_cvt_pk_bf16_f32 v122, v120, v121
 v_and_b32 v120, 0xffff, v122
 v_lshrrev_b32 v121, 16, v122
 v_lshl_add_u32 v138, v120, 1, s92
 v_lshl_add_u32 v139, v121, 1, s92
 s_waitcnt lgkmcnt(0)
 ds_read_u16 v104, v132
 ds_read_u16 v108, v133
 ds_read_u16 v105, v134
 ds_read_u16 v109, v135
 ds_read_u16 v106, v136
 ds_read_u16 v110, v137
 ds_read_u16 v107, v138
 ds_read_u16 v111, v139
 v_subrev_f32 v120, 0x44c00000, v66
 v_subrev_f32 v121, 0x44c02000, v66
 v_cvt_pk_bf16_f32 v122, v120, v121
 v_and_b32 v120, 0xffff, v122
 v_lshrrev_b32 v121, 16, v122
 v_subrev_u32 v122, 1536, v65
 v_min_u32 v122, 128, v122
 v_add_u32 v122, 17024, v122
 v_max_u32 v120, v120, v122
 v_subrev_u32 v122, 1537, v65
 v_min_u32 v122, 128, v122
 v_add_u32 v122, 17024, v122
 v_max_u32 v121, v121, v122
 v_lshl_add_u32 v132, v120, 1, s92
 v_lshl_add_u32 v133, v121, 1, s92
 v_subrev_f32 v120, 0x44c04000, v66
 v_subrev_f32 v121, 0x44c06000, v66
 v_cvt_pk_bf16_f32 v122, v120, v121
 v_and_b32 v120, 0xffff, v122
 v_lshrrev_b32 v121, 16, v122
 v_subrev_u32 v122, 1538, v65
 v_min_u32 v122, 128, v122
 v_add_u32 v122, 17024, v122
 v_max_u32 v120, v120, v122
 v_subrev_u32 v122, 1539, v65
 v_min_u32 v122, 128, v122
 v_add_u32 v122, 17024, v122
 v_max_u32 v121, v121, v122
 v_lshl_add_u32 v134, v120, 1, s92
 v_lshl_add_u32 v135, v121, 1, s92
 v_subrev_f32 v120, 0x44c08000, v66
 v_subrev_f32 v121, 0x44c0a000, v66
 v_cvt_pk_bf16_f32 v122, v120, v121
 v_and_b32 v120, 0xffff, v122
 v_lshrrev_b32 v121, 16, v122
 v_subrev_u32 v122, 1540, v65
 v_min_u32 v122, 128, v122
 v_add_u32 v122, 17024, v122
 v_max_u32 v120, v120, v122
 v_subrev_u32 v122, 1541, v65
 v_min_u32 v122, 128, v122
 v_add_u32 v122, 17024, v122
 v_max_u32 v121, v121, v122
 v_lshl_add_u32 v136, v120, 1, s92
 v_lshl_add_u32 v137, v121, 1, s92
 v_subrev_f32 v120, 0x44c0c000, v66
 v_subrev_f32 v121, 0x44c0e000, v66
 v_cvt_pk_bf16_f32 v122, v120, v121
 v_and_b32 v120, 0xffff, v122
 v_lshrrev_b32 v121, 16, v122
 v_subrev_u32 v122, 1542, v65
 v_min_u32 v122, 128, v122
 v_add_u32 v122, 17024, v122
 v_max_u32 v120, v120, v122
 v_subrev_u32 v122, 1543, v65
 v_min_u32 v122, 128, v122
 v_add_u32 v122, 17024, v122
 v_max_u32 v121, v121, v122
 v_lshl_add_u32 v138, v120, 1, s92
 v_lshl_add_u32 v139, v121, 1, s92
 s_waitcnt lgkmcnt(0)
 ds_read_u16 v112, v132
 ds_read_u16 v116, v133
 ds_read_u16 v113, v134
 ds_read_u16 v117, v135
 ds_read_u16 v114, v136
 ds_read_u16 v118, v137
 ds_read_u16 v115, v138
 ds_read_u16 v119, v139
 v_lshl_add_u32 v65, v64, 4, s94
 v_mov_b32 v120, 0
 v_mov_b32 v121, 0
 v_mov_b32 v122, 0
 v_mov_b32 v123, 0
 v_lshrrev_b32 v66, 2, v64
 v_mul_u32_u24 v66, 4096, v66
 v_add_u32 v66, 4096, v66
 v_cmp_gt_u32 vcc, 16, v64
 v_mov_b32 v67, 16384
 s_nop 0
 v_cndmask_b32 v66, v67, v66, vcc
 v_add_u32 v66, v66, v65
 s_waitcnt lgkmcnt(0)
 s_mov_b64 exec, 0x1fffff
 ds_write_b128 v66, v[120:123]
 s_mov_b64 exec, -1
 v_lshl_or_b32 v88, v92, 16, v88
 v_lshl_or_b32 v89, v93, 16, v89
 v_lshl_or_b32 v90, v94, 16, v90
 v_lshl_or_b32 v91, v95, 16, v91
 ds_write_b128 v65, v[88:91] offset:12480
 v_lshl_or_b32 v96, v100, 16, v96
 v_lshl_or_b32 v97, v101, 16, v97
 v_lshl_or_b32 v98, v102, 16, v98
 v_lshl_or_b32 v99, v103, 16, v99
 ds_write_b128 v65, v[96:99] offset:13504
 v_lshl_or_b32 v104, v108, 16, v104
 v_lshl_or_b32 v105, v109, 16, v105
 v_lshl_or_b32 v106, v110, 16, v106
 v_lshl_or_b32 v107, v111, 16, v107
 ds_write_b128 v65, v[104:107] offset:14528
 v_lshl_or_b32 v112, v116, 16, v112
 v_lshl_or_b32 v113, v117, 16, v113
 v_lshl_or_b32 v114, v118, 16, v114
 v_lshl_or_b32 v115, v119, 16, v115
 ds_write_b128 v65, v[112:115] offset:15552
 s_waitcnt lgkmcnt(0)
 ds_read_b64 v[92:93], v65 offset:12496
 ds_read_b64 v[100:101], v65 offset:13520
 ds_read_b64 v[108:109], v65 offset:14544
 ds_read_b64 v[116:117], v65 offset:15568
 s_waitcnt lgkmcnt(0)
 v_alignbit_b32 v132, v89, v88, 16
 v_mov_b32 v136, v89
 v_alignbit_b32 v140, v90, v89, 16
 v_alignbit_b32 v133, v90, v89, 16
 v_mov_b32 v137, v90
 v_alignbit_b32 v141, v91, v90, 16
 v_alignbit_b32 v134, v91, v90, 16
 v_mov_b32 v138, v91
 v_alignbit_b32 v142, v92, v91, 16
 v_alignbit_b32 v135, v92, v91, 16
 v_mov_b32 v139, v92
 v_alignbit_b32 v143, v93, v92, 16
 ds_write_b128 v65, v[132:135] offset:8320
 ds_write_b128 v65, v[136:139] offset:4160
 ds_write_b128 v65, v[140:143] offset:0
 v_alignbit_b32 v144, v97, v96, 16
 v_mov_b32 v148, v97
 v_alignbit_b32 v152, v98, v97, 16
 v_alignbit_b32 v145, v98, v97, 16
 v_mov_b32 v149, v98
 v_alignbit_b32 v153, v99, v98, 16
 v_alignbit_b32 v146, v99, v98, 16
 v_mov_b32 v150, v99
 v_alignbit_b32 v154, v100, v99, 16
 v_alignbit_b32 v147, v100, v99, 16
 v_mov_b32 v151, v100
 v_alignbit_b32 v155, v101, v100, 16
 ds_write_b128 v65, v[144:147] offset:9344
 ds_write_b128 v65, v[148:151] offset:5184
 ds_write_b128 v65, v[152:155] offset:1024
 v_alignbit_b32 v132, v105, v104, 16
 v_mov_b32 v136, v105
 v_alignbit_b32 v140, v106, v105, 16
 v_alignbit_b32 v133, v106, v105, 16
 v_mov_b32 v137, v106
 v_alignbit_b32 v141, v107, v106, 16
 v_alignbit_b32 v134, v107, v106, 16
 v_mov_b32 v138, v107
 v_alignbit_b32 v142, v108, v107, 16
 v_alignbit_b32 v135, v108, v107, 16
 v_mov_b32 v139, v108
 v_alignbit_b32 v143, v109, v108, 16
 ds_write_b128 v65, v[132:135] offset:10368
 ds_write_b128 v65, v[136:139] offset:6208
 ds_write_b128 v65, v[140:143] offset:2048
 v_alignbit_b32 v144, v113, v112, 16
 v_mov_b32 v148, v113
 v_alignbit_b32 v152, v114, v113, 16
 v_alignbit_b32 v145, v114, v113, 16
 v_mov_b32 v149, v114
 v_alignbit_b32 v153, v115, v114, 16
 v_alignbit_b32 v146, v115, v114, 16
 v_mov_b32 v150, v115
 v_alignbit_b32 v154, v116, v115, 16
 v_alignbit_b32 v147, v116, v115, 16
 v_mov_b32 v151, v116
 v_alignbit_b32 v155, v117, v116, 16
 ds_write_b128 v65, v[144:147] offset:11392
 ds_write_b128 v65, v[148:151] offset:7232
 ds_write_b128 v65, v[152:155] offset:3072
 v_and_b32 v66, 3, v64
 v_mul_u32_u24 v65, 4160, v66
 v_bfe_u32 v66, v64, 3, 1
 v_bfe_u32 v67, v64, 2, 1
 v_lshl_add_u32 v66, v67, 1, v66
 v_bfe_u32 v67, v64, 4, 1
 v_lshl_add_u32 v66, v67, 2, v66
 v_lshlrev_b32 v66, 3, v66
 v_sub_u32 v65, v65, v66
 v_lshrrev_b32 v67, 5, v64
 v_lshl_add_u32 v65, v67, 4, v65
 s_add_u32 s92, s94, 2040
 v_add_u32 v65, s92, v65
 v_and_b32 v66, 31, v64
 v_mul_u32_u24 v66, 80, v66
 v_lshl_add_u32 v67, v67, 4, v66
 s_add_u32 s92, s94, 16720
 v_add_u32 v67, s92, v67
 v_mov_b32 v214, v67
 v_mov_b32 v68, v67
 s_sub_u32 s93, s92, 80
 v_mov_b32 v88, 0
 v_mov_b32 v89, 0
 v_mov_b32 v90, 0
 v_mov_b32 v91, 0
 v_mov_b32 v92, 0
 v_mov_b32 v93, 0
 v_mov_b32 v94, 0
 v_mov_b32 v95, 0
 v_mov_b32 v96, 0
 v_mov_b32 v97, 0
 v_mov_b32 v98, 0
 v_mov_b32 v99, 0
 v_mov_b32 v100, 0
 v_mov_b32 v101, 0
 v_mov_b32 v102, 0
 v_mov_b32 v103, 0
 v_mov_b32 v104, 0
 v_mov_b32 v105, 0
 v_mov_b32 v106, 0
 v_mov_b32 v107, 0
 v_mov_b32 v108, 0
 v_mov_b32 v109, 0
 v_mov_b32 v110, 0
 v_mov_b32 v111, 0
 v_mov_b32 v112, 0
 v_mov_b32 v113, 0
 v_mov_b32 v114, 0
 v_mov_b32 v115, 0
 v_mov_b32 v116, 0
 v_mov_b32 v117, 0
 v_mov_b32 v118, 0
 v_mov_b32 v119, 0
 s_waitcnt lgkmcnt(0)
 s_barrier
 s_waitcnt vmcnt(9)
 s_barrier
 ds_read_b64_tr_b16 a[96:97], v13 offset:32768
 ds_read_b64_tr_b16 a[98:99], v13 offset:33792
 ds_read_b64_tr_b16 a[100:101], v13 offset:36864
 ds_read_b64_tr_b16 a[102:103], v13 offset:37888
 ds_read_b64_tr_b16 a[104:105], v13 offset:40960
 ds_read_b64_tr_b16 a[106:107], v13 offset:41984
 ds_read_b64_tr_b16 a[108:109], v13 offset:45056
 ds_read_b64_tr_b16 a[110:111], v13 offset:46080
 s_waitcnt lgkmcnt(0)
 ds_read_b64_tr_b16 a[112:113], v13 offset:49152
 ds_read_b64_tr_b16 a[114:115], v13 offset:50176
 ds_read_b64_tr_b16 a[116:117], v13 offset:53248
 ds_read_b64_tr_b16 a[118:119], v13 offset:54272
 ds_read_b64_tr_b16 a[120:121], v13 offset:57344
 ds_read_b64_tr_b16 a[122:123], v13 offset:58368
 ds_read_b64_tr_b16 a[124:125], v13 offset:61440
 ds_read_b64_tr_b16 a[126:127], v13 offset:62464
 s_waitcnt lgkmcnt(0)
 s_barrier
 s_add_u32 m0, s45, 32768
 s_add_u32 s43, s44, 5242880
 buffer_load_dwordx4 v12, s[8:11], s43 offen  lds
 s_add_u32 m0, s45, 33792
 s_add_u32 s43, s44, 5275648
 buffer_load_dwordx4 v12, s[8:11], s43 offen  lds
 s_add_u32 m0, s45, 34816
 s_add_u32 s43, s44, 5308416
 buffer_load_dwordx4 v12, s[8:11], s43 offen  lds
 s_add_u32 m0, s45, 35840
 s_add_u32 s43, s44, 5341184
 buffer_load_dwordx4 v12, s[8:11], s43 offen  lds
 s_add_u32 m0, s45, 36864
 s_add_u32 s43, s44, 5373952
 buffer_load_dwordx4 v12, s[8:11], s43 offen  lds
 s_add_u32 m0, s45, 37888
 s_add_u32 s43, s44, 5406720
 buffer_load_dwordx4 v12, s[8:11], s43 offen  lds
 s_add_u32 m0, s45, 38912
 s_add_u32 s43, s44, 5439488
 buffer_load_dwordx4 v12, s[8:11], s43 offen  lds
 s_add_u32 m0, s45, 39936
 s_add_u32 s43, s44, 5472256
 buffer_load_dwordx4 v12, s[8:11], s43 offen  lds
 ds_read_b64 v[120:121], v65 offset:2080
 ds_read_b64 v[122:123], v65 offset:2088
 ds_read_b128 v[128:131], v67 offset:2592
 ds_read_b128 v[132:135], v68 offset:32
 ds_read_b64 v[124:125], v65 offset:32
 ds_read_b64 v[126:127], v65 offset:40
 s_mov_b32 s95, 0
L_rQb_cv0:
 ds_read_b64 v[136:137], v65 offset:2048
 ds_read_b64 v[138:139], v65 offset:2056
 ds_read_b128 v[144:147], v67 offset:2560
 ds_read_b128 v[148:151], v68 offset:0
 ds_read_b64 v[140:141], v65 offset:0
 ds_read_b64 v[142:143], v65 offset:8
 s_waitcnt lgkmcnt(6)
 v_mfma_f32_32x32x16_bf16 v[104:119], v[120:123], v[128:131], v[104:119]
 v_subrev_u32 v65, 64, v65
 v_subrev_u32 v67, 80, v67
 v_max_i32 v68, s93, v67
 v_mfma_f32_32x32x16_bf16 v[88:103], v[120:123], v[132:135], v[88:103]
 v_mfma_f32_32x32x16_bf16 v[104:119], v[124:127], v[132:135], v[104:119]
 ds_read_b64 v[120:121], v65 offset:2080
 ds_read_b64 v[122:123], v65 offset:2088
 ds_read_b128 v[128:131], v67 offset:2592
 ds_read_b128 v[132:135], v68 offset:32
 ds_read_b64 v[124:125], v65 offset:32
 ds_read_b64 v[126:127], v65 offset:40
 s_waitcnt lgkmcnt(6)
 v_mfma_f32_32x32x16_bf16 v[104:119], v[136:139], v[144:147], v[104:119]
 s_add_u32 s95, s95, 1
 s_cmp_lt_u32 s95, 8
 v_mfma_f32_32x32x16_bf16 v[88:103], v[136:139], v[148:151], v[88:103]
 v_mfma_f32_32x32x16_bf16 v[104:119], v[140:143], v[148:151], v[104:119]
 s_cbranch_scc1 L_rQb_cv0
 s_waitcnt vmcnt(9)
 s_barrier
 ds_read_b64_tr_b16 a[128:129], v13 offset:0
 ds_read_b64_tr_b16 a[130:131], v13 offset:1024
 ds_read_b64_tr_b16 a[132:133], v13 offset:4096
 ds_read_b64_tr_b16 a[134:135], v13 offset:5120
 ds_read_b64_tr_b16 a[136:137], v13 offset:8192
 ds_read_b64_tr_b16 a[138:139], v13 offset:9216
 ds_read_b64_tr_b16 a[140:141], v13 offset:12288
 ds_read_b64_tr_b16 a[142:143], v13 offset:13312
 s_waitcnt lgkmcnt(0)
 ds_read_b64_tr_b16 a[144:145], v13 offset:16384
 ds_read_b64_tr_b16 a[146:147], v13 offset:17408
 ds_read_b64_tr_b16 a[148:149], v13 offset:20480
 ds_read_b64_tr_b16 a[150:151], v13 offset:21504
 ds_read_b64_tr_b16 a[152:153], v13 offset:24576
 ds_read_b64_tr_b16 a[154:155], v13 offset:25600
 ds_read_b64_tr_b16 a[156:157], v13 offset:28672
 ds_read_b64_tr_b16 a[158:159], v13 offset:29696
 s_waitcnt lgkmcnt(0)
 s_barrier
 s_add_u32 m0, s45, 0
 s_add_u32 s43, s44, 6291456
 buffer_load_dwordx4 v12, s[8:11], s43 offen  lds
 s_add_u32 m0, s45, 1024
 s_add_u32 s43, s44, 6324224
 buffer_load_dwordx4 v12, s[8:11], s43 offen  lds
 s_add_u32 m0, s45, 2048
 s_add_u32 s43, s44, 6356992
 buffer_load_dwordx4 v12, s[8:11], s43 offen  lds
 s_add_u32 m0, s45, 3072
 s_add_u32 s43, s44, 6389760
 buffer_load_dwordx4 v12, s[8:11], s43 offen  lds
 s_add_u32 m0, s45, 4096
 s_add_u32 s43, s44, 6422528
 buffer_load_dwordx4 v12, s[8:11], s43 offen  lds
 s_add_u32 m0, s45, 5120
 s_add_u32 s43, s44, 6455296
 buffer_load_dwordx4 v12, s[8:11], s43 offen  lds
 s_add_u32 m0, s45, 6144
 s_add_u32 s43, s44, 6488064
 buffer_load_dwordx4 v12, s[8:11], s43 offen  lds
 s_add_u32 m0, s45, 7168
 s_add_u32 s43, s44, 6520832
 buffer_load_dwordx4 v12, s[8:11], s43 offen  lds
 s_mov_b32 s95, 0
L_rQb_cv1:
 ds_read_b64 v[136:137], v65 offset:2048
 ds_read_b64 v[138:139], v65 offset:2056
 ds_read_b128 v[144:147], v67 offset:2560
 ds_read_b128 v[148:151], v68 offset:0
 ds_read_b64 v[140:141], v65 offset:0
 ds_read_b64 v[142:143], v65 offset:8
 s_waitcnt lgkmcnt(6)
 v_mfma_f32_32x32x16_bf16 v[104:119], v[120:123], v[128:131], v[104:119]
 v_subrev_u32 v65, 64, v65
 v_subrev_u32 v67, 80, v67
 v_max_i32 v68, s93, v67
 v_mfma_f32_32x32x16_bf16 v[88:103], v[120:123], v[132:135], v[88:103]
 v_mfma_f32_32x32x16_bf16 v[104:119], v[124:127], v[132:135], v[104:119]
 ds_read_b64 v[120:121], v65 offset:2080
 ds_read_b64 v[122:123], v65 offset:2088
 ds_read_b128 v[128:131], v67 offset:2592
 ds_read_b128 v[132:135], v68 offset:32
 ds_read_b64 v[124:125], v65 offset:32
 ds_read_b64 v[126:127], v65 offset:40
 s_waitcnt lgkmcnt(6)
 v_mfma_f32_32x32x16_bf16 v[104:119], v[136:139], v[144:147], v[104:119]
 s_add_u32 s95, s95, 1
 s_cmp_lt_u32 s95, 8
 v_mfma_f32_32x32x16_bf16 v[88:103], v[136:139], v[148:151], v[88:103]
 v_mfma_f32_32x32x16_bf16 v[104:119], v[140:143], v[148:151], v[104:119]
 s_cbranch_scc1 L_rQb_cv1
 s_waitcnt vmcnt(8)
 s_barrier
 ds_read_b64_tr_b16 a[160:161], v13 offset:32768
 ds_read_b64_tr_b16 a[162:163], v13 offset:33792
 ds_read_b64_tr_b16 a[164:165], v13 offset:36864
 ds_read_b64_tr_b16 a[166:167], v13 offset:37888
 ds_read_b64_tr_b16 a[168:169], v13 offset:40960
 ds_read_b64_tr_b16 a[170:171], v13 offset:41984
 ds_read_b64_tr_b16 a[172:173], v13 offset:45056
 ds_read_b64_tr_b16 a[174:175], v13 offset:46080
 s_waitcnt lgkmcnt(0)
 ds_read_b64_tr_b16 a[176:177], v13 offset:49152
 ds_read_b64_tr_b16 a[178:179], v13 offset:50176
 ds_read_b64_tr_b16 a[180:181], v13 offset:53248
 ds_read_b64_tr_b16 a[182:183], v13 offset:54272
 ds_read_b64_tr_b16 a[184:185], v13 offset:57344
 ds_read_b64_tr_b16 a[186:187], v13 offset:58368
 ds_read_b64_tr_b16 a[188:189], v13 offset:61440
 ds_read_b64_tr_b16 a[190:191], v13 offset:62464
 s_waitcnt lgkmcnt(0)
 s_barrier
 s_add_u32 m0, s45, 32768
 s_add_u32 s43, s44, 7340032
 buffer_load_dwordx4 v12, s[8:11], s43 offen  lds
 s_add_u32 m0, s45, 33792
 s_add_u32 s43, s44, 7372800
 buffer_load_dwordx4 v12, s[8:11], s43 offen  lds
 s_add_u32 m0, s45, 34816
 s_add_u32 s43, s44, 7405568
 buffer_load_dwordx4 v12, s[8:11], s43 offen  lds
 s_add_u32 m0, s45, 35840
 s_add_u32 s43, s44, 7438336
 buffer_load_dwordx4 v12, s[8:11], s43 offen  lds
 s_add_u32 m0, s45, 36864
 s_add_u32 s43, s44, 7471104
 buffer_load_dwordx4 v12, s[8:11], s43 offen  lds
 s_add_u32 m0, s45, 37888
 s_add_u32 s43, s44, 7503872
 buffer_load_dwordx4 v12, s[8:11], s43 offen  lds
 s_add_u32 m0, s45, 38912
 s_add_u32 s43, s44, 7536640
 buffer_load_dwordx4 v12, s[8:11], s43 offen  lds
 s_add_u32 m0, s45, 39936
 s_add_u32 s43, s44, 7569408
 buffer_load_dwordx4 v12, s[8:11], s43 offen  lds
 s_mov_b32 s95, 0
L_rQb_cv2:
 ds_read_b64 v[136:137], v65 offset:2048
 ds_read_b64 v[138:139], v65 offset:2056
 ds_read_b128 v[144:147], v67 offset:2560
 ds_read_b128 v[148:151], v68 offset:0
 ds_read_b64 v[140:141], v65 offset:0
 ds_read_b64 v[142:143], v65 offset:8
 s_waitcnt lgkmcnt(6)
 v_mfma_f32_32x32x16_bf16 v[104:119], v[120:123], v[128:131], v[104:119]
 v_subrev_u32 v65, 64, v65
 v_subrev_u32 v67, 80, v67
 v_max_i32 v68, s93, v67
 v_mfma_f32_32x32x16_bf16 v[88:103], v[120:123], v[132:135], v[88:103]
 v_mfma_f32_32x32x16_bf16 v[104:119], v[124:127], v[132:135], v[104:119]
 ds_read_b64 v[120:121], v65 offset:2080
 ds_read_b64 v[122:123], v65 offset:2088
 ds_read_b128 v[128:131], v67 offset:2592
 ds_read_b128 v[132:135], v68 offset:32
 ds_read_b64 v[124:125], v65 offset:32
 ds_read_b64 v[126:127], v65 offset:40
 s_waitcnt lgkmcnt(6)
 v_mfma_f32_32x32x16_bf16 v[104:119], v[136:139], v[144:147], v[104:119]
 s_add_u32 s95, s95, 1
 s_cmp_lt_u32 s95, 8
 v_mfma_f32_32x32x16_bf16 v[88:103], v[136:139], v[148:151], v[88:103]
 v_mfma_f32_32x32x16_bf16 v[104:119], v[140:143], v[148:151], v[104:119]
 s_cbranch_scc1 L_rQb_cv2
 s_waitcnt vmcnt(8)
 s_barrier
 ds_read_b64_tr_b16 a[192:193], v13 offset:0
 ds_read_b64_tr_b16 a[194:195], v13 offset:1024
 ds_read_b64_tr_b16 a[196:197], v13 offset:4096
 ds_read_b64_tr_b16 a[198:199], v13 offset:5120
 ds_read_b64_tr_b16 a[200:201], v13 offset:8192
 ds_read_b64_tr_b16 a[202:203], v13 offset:9216
 ds_read_b64_tr_b16 a[204:205], v13 offset:12288
 ds_read_b64_tr_b16 a[206:207], v13 offset:13312
 s_waitcnt lgkmcnt(0)
 ds_read_b64_tr_b16 a[208:209], v13 offset:16384
 ds_read_b64_tr_b16 a[210:211], v13 offset:17408
 ds_read_b64_tr_b16 a[212:213], v13 offset:20480
 ds_read_b64_tr_b16 a[214:215], v13 offset:21504
 ds_read_b64_tr_b16 a[216:217], v13 offset:24576
 ds_read_b64_tr_b16 a[218:219], v13 offset:25600
 ds_read_b64_tr_b16 a[220:221], v13 offset:28672
 ds_read_b64_tr_b16 a[222:223], v13 offset:29696
 s_waitcnt lgkmcnt(0)
 s_mov_b32 s95, 0
L_rQb_cv3:
 ds_read_b64 v[136:137], v65 offset:2048
 ds_read_b64 v[138:139], v65 offset:2056
 ds_read_b128 v[144:147], v67 offset:2560
 ds_read_b128 v[148:151], v68 offset:0
 ds_read_b64 v[140:141], v65 offset:0
 ds_read_b64 v[142:143], v65 offset:8
 s_waitcnt lgkmcnt(6)
 v_mfma_f32_32x32x16_bf16 v[104:119], v[120:123], v[128:131], v[104:119]
 v_subrev_u32 v65, 64, v65
 v_subrev_u32 v67, 80, v67
 v_max_i32 v68, s93, v67
 v_mfma_f32_32x32x16_bf16 v[88:103], v[120:123], v[132:135], v[88:103]
 v_mfma_f32_32x32x16_bf16 v[104:119], v[124:127], v[132:135], v[104:119]
 ds_read_b64 v[120:121], v65 offset:2080
 ds_read_b64 v[122:123], v65 offset:2088
 ds_read_b128 v[128:131], v67 offset:2592
 ds_read_b128 v[132:135], v68 offset:32
 ds_read_b64 v[124:125], v65 offset:32
 ds_read_b64 v[126:127], v65 offset:40
 s_waitcnt lgkmcnt(6)
 v_mfma_f32_32x32x16_bf16 v[104:119], v[136:139], v[144:147], v[104:119]
 s_add_u32 s95, s95, 1
 s_cmp_lt_u32 s95, 8
 v_mfma_f32_32x32x16_bf16 v[88:103], v[136:139], v[148:151], v[88:103]
 v_mfma_f32_32x32x16_bf16 v[104:119], v[140:143], v[148:151], v[104:119]
 s_cbranch_scc1 L_rQb_cv3
 s_waitcnt vmcnt(0)
 s_barrier
 ds_read_b64_tr_b16 a[224:225], v13 offset:32768
 ds_read_b64_tr_b16 a[226:227], v13 offset:33792
 ds_read_b64_tr_b16 a[228:229], v13 offset:36864
 ds_read_b64_tr_b16 a[230:231], v13 offset:37888
 ds_read_b64_tr_b16 a[232:233], v13 offset:40960
 ds_read_b64_tr_b16 a[234:235], v13 offset:41984
 ds_read_b64_tr_b16 a[236:237], v13 offset:45056
 ds_read_b64_tr_b16 a[238:239], v13 offset:46080
 s_waitcnt lgkmcnt(0)
 ds_read_b64_tr_b16 a[240:241], v13 offset:49152
 ds_read_b64_tr_b16 a[242:243], v13 offset:50176
 ds_read_b64_tr_b16 a[244:245], v13 offset:53248
 ds_read_b64_tr_b16 a[246:247], v13 offset:54272
 ds_read_b64_tr_b16 a[248:249], v13 offset:57344
 ds_read_b64_tr_b16 a[250:251], v13 offset:58368
 ds_read_b64_tr_b16 a[252:253], v13 offset:61440
 ds_read_b64_tr_b16 a[254:255], v13 offset:62464
 s_waitcnt lgkmcnt(0)
 s_load_dwordx2 s[84:85], s[0:1], 128
 s_mov_b32 s86, 8388608
 s_mov_b32 s87, 0x20000
 s_lshl_b32 s90, s89, 16
 s_and_b32 s91, s89, s98
 s_and_b32 s89, s88, s98
 s_lshl_b32 s88, s88, 16
 v_lshlrev_b32 v70, 1, v70
 s_lshl_b32 s93, s28, 3
 s_add_u32 s93, s93, 2048
 s_waitcnt lgkmcnt(0)
 s_nop 1
 v_cvt_pk_bf16_f32 v152, v88, v89
 v_cvt_pk_bf16_f32 v153, v90, v91
 v_cvt_pk_bf16_f32 v154, v92, v93
 v_cvt_pk_bf16_f32 v155, v94, v95
 v_cvt_pk_bf16_f32 v156, v96, v97
 v_cvt_pk_bf16_f32 v157, v98, v99
 v_cvt_pk_bf16_f32 v158, v100, v101
 v_cvt_pk_bf16_f32 v159, v102, v103
 ds_write_b128 v214, v[152:155] offset:0
 ds_write_b128 v214, v[156:159] offset:32
 v_cvt_pk_bf16_f32 v160, v104, v105
 v_cvt_pk_bf16_f32 v161, v106, v107
 v_cvt_pk_bf16_f32 v162, v108, v109
 v_cvt_pk_bf16_f32 v163, v110, v111
 v_cvt_pk_bf16_f32 v164, v112, v113
 v_cvt_pk_bf16_f32 v165, v114, v115
 v_cvt_pk_bf16_f32 v166, v116, v117
 v_cvt_pk_bf16_f32 v167, v118, v119
 ds_write_b128 v214, v[160:163] offset:2560
 ds_write_b128 v214, v[164:167] offset:2592
 s_waitcnt lgkmcnt(0)
 s_barrier
 ds_read_b128 v[88:91], v69 offset:0
 ds_read_b128 v[92:95], v69 offset:21888
 ds_read_b128 v[96:99], v215 offset:0
 ds_read_b128 v[100:103], v215 offset:21888
 v_lshlrev_b32 v104, 16, v72
 v_and_b32 v105, s98, v72
 v_pk_mul_f32 v[104:105], v[104:105], s[88:89]
 v_cvt_pk_bf16_f32 v72, v104, v105
 v_lshlrev_b32 v104, 16, v72
 v_and_b32 v105, s98, v72
 v_lshlrev_b32 v106, 16, v73
 v_and_b32 v107, s98, v73
 v_pk_mul_f32 v[106:107], v[106:107], s[90:91]
 v_cvt_pk_bf16_f32 v73, v106, v107
 v_lshlrev_b32 v106, 16, v73
 v_and_b32 v107, s98, v73
 v_lshlrev_b32 v108, 16, v74
 v_and_b32 v109, s98, v74
 v_pk_mul_f32 v[108:109], v[108:109], s[88:89]
 v_cvt_pk_bf16_f32 v74, v108, v109
 v_lshlrev_b32 v108, 16, v74
 v_and_b32 v109, s98, v74
 v_lshlrev_b32 v110, 16, v75
 v_and_b32 v111, s98, v75
 v_pk_mul_f32 v[110:111], v[110:111], s[90:91]
 v_cvt_pk_bf16_f32 v75, v110, v111
 v_lshlrev_b32 v110, 16, v75
 v_and_b32 v111, s98, v75
 v_lshlrev_b32 v112, 16, v76
 v_and_b32 v113, s98, v76
 v_pk_mul_f32 v[112:113], v[112:113], s[88:89]
 v_cvt_pk_bf16_f32 v76, v112, v113
 v_lshlrev_b32 v112, 16, v76
 v_and_b32 v113, s98, v76
 v_lshlrev_b32 v114, 16, v77
 v_and_b32 v115, s98, v77
 v_pk_mul_f32 v[114:115], v[114:115], s[90:91]
 v_cvt_pk_bf16_f32 v77, v114, v115
 v_lshlrev_b32 v114, 16, v77
 v_and_b32 v115, s98, v77
 v_lshlrev_b32 v116, 16, v78
 v_and_b32 v117, s98, v78
 v_pk_mul_f32 v[116:117], v[116:117], s[88:89]
 v_cvt_pk_bf16_f32 v78, v116, v117
 v_lshlrev_b32 v116, 16, v78
 v_and_b32 v117, s98, v78
 v_lshlrev_b32 v118, 16, v79
 v_and_b32 v119, s98, v79
 v_pk_mul_f32 v[118:119], v[118:119], s[90:91]
 v_cvt_pk_bf16_f32 v79, v118, v119
 v_lshlrev_b32 v118, 16, v79
 v_and_b32 v119, s98, v79
 v_lshlrev_b32 v120, 16, v80
 v_and_b32 v121, s98, v80
 v_pk_mul_f32 v[120:121], v[120:121], s[88:89]
 v_cvt_pk_bf16_f32 v80, v120, v121
 v_lshlrev_b32 v120, 16, v80
 v_and_b32 v121, s98, v80
 v_lshlrev_b32 v122, 16, v81
 v_and_b32 v123, s98, v81
 v_pk_mul_f32 v[122:123], v[122:123], s[90:91]
 v_cvt_pk_bf16_f32 v81, v122, v123
 v_lshlrev_b32 v122, 16, v81
 v_and_b32 v123, s98, v81
 v_lshlrev_b32 v124, 16, v82
 v_and_b32 v125, s98, v82
 v_pk_mul_f32 v[124:125], v[124:125], s[88:89]
 v_cvt_pk_bf16_f32 v82, v124, v125
 v_lshlrev_b32 v124, 16, v82
 v_and_b32 v125, s98, v82
 v_lshlrev_b32 v126, 16, v83
 v_and_b32 v127, s98, v83
 v_pk_mul_f32 v[126:127], v[126:127], s[90:91]
 v_cvt_pk_bf16_f32 v83, v126, v127
 v_lshlrev_b32 v126, 16, v83
 v_and_b32 v127, s98, v83
 v_lshlrev_b32 v128, 16, v84
 v_and_b32 v129, s98, v84
 v_pk_mul_f32 v[128:129], v[128:129], s[88:89]
 v_cvt_pk_bf16_f32 v84, v128, v129
 v_lshlrev_b32 v128, 16, v84
 v_and_b32 v129, s98, v84
 v_lshlrev_b32 v130, 16, v85
 v_and_b32 v131, s98, v85
 v_pk_mul_f32 v[130:131], v[130:131], s[90:91]
 v_cvt_pk_bf16_f32 v85, v130, v131
 v_lshlrev_b32 v130, 16, v85
 v_and_b32 v131, s98, v85
 v_lshlrev_b32 v132, 16, v86
 v_and_b32 v133, s98, v86
 v_pk_mul_f32 v[132:133], v[132:133], s[88:89]
 v_cvt_pk_bf16_f32 v86, v132, v133
 v_lshlrev_b32 v132, 16, v86
 v_and_b32 v133, s98, v86
 v_lshlrev_b32 v134, 16, v87
 v_and_b32 v135, s98, v87
 v_pk_mul_f32 v[134:135], v[134:135], s[90:91]
 v_cvt_pk_bf16_f32 v87, v134, v135
 v_lshlrev_b32 v134, 16, v87
 v_and_b32 v135, s98, v87
 s_waitcnt lgkmcnt(0)
 v_lshlrev_b32 v136, 16, v88
 v_lshlrev_b32 v137, 16, v92
 v_lshlrev_b32 v138, 16, v96
 v_lshlrev_b32 v139, 16, v100
 v_pk_add_f32 v[104:105], v[104:105], v[136:137]
 v_cvt_pk_bf16_f32 v72, v104, v105
 v_pk_add_f32 v[106:107], v[106:107], v[138:139]
 v_cvt_pk_bf16_f32 v73, v106, v107
 buffer_store_dwordx2 v[72:73], v70, s[84:87], s93 offen
 s_add_u32 s93, s93, 4096
 v_and_b32 v136, s98, v88
 v_and_b32 v137, s98, v92
 v_and_b32 v138, s98, v96
 v_and_b32 v139, s98, v100
 v_pk_add_f32 v[108:109], v[108:109], v[136:137]
 v_cvt_pk_bf16_f32 v74, v108, v109
 v_pk_add_f32 v[110:111], v[110:111], v[138:139]
 v_cvt_pk_bf16_f32 v75, v110, v111
 buffer_store_dwordx2 v[74:75], v70, s[84:87], s93 offen
 s_add_u32 s93, s93, 4096
 v_lshlrev_b32 v136, 16, v89
 v_lshlrev_b32 v137, 16, v93
 v_lshlrev_b32 v138, 16, v97
 v_lshlrev_b32 v139, 16, v101
 v_pk_add_f32 v[112:113], v[112:113], v[136:137]
 v_cvt_pk_bf16_f32 v76, v112, v113
 v_pk_add_f32 v[114:115], v[114:115], v[138:139]
 v_cvt_pk_bf16_f32 v77, v114, v115
 buffer_store_dwordx2 v[76:77], v70, s[84:87], s93 offen
 s_add_u32 s93, s93, 4096
 v_and_b32 v136, s98, v89
 v_and_b32 v137, s98, v93
 v_and_b32 v138, s98, v97
 v_and_b32 v139, s98, v101
 v_pk_add_f32 v[116:117], v[116:117], v[136:137]
 v_cvt_pk_bf16_f32 v78, v116, v117
 v_pk_add_f32 v[118:119], v[118:119], v[138:139]
 v_cvt_pk_bf16_f32 v79, v118, v119
 buffer_store_dwordx2 v[78:79], v70, s[84:87], s93 offen
 s_add_u32 s93, s93, 4096
 v_lshlrev_b32 v136, 16, v90
 v_lshlrev_b32 v137, 16, v94
 v_lshlrev_b32 v138, 16, v98
 v_lshlrev_b32 v139, 16, v102
 v_pk_add_f32 v[120:121], v[120:121], v[136:137]
 v_cvt_pk_bf16_f32 v80, v120, v121
 v_pk_add_f32 v[122:123], v[122:123], v[138:139]
 v_cvt_pk_bf16_f32 v81, v122, v123
 buffer_store_dwordx2 v[80:81], v70, s[84:87], s93 offen
 s_add_u32 s93, s93, 4096
 v_and_b32 v136, s98, v90
 v_and_b32 v137, s98, v94
 v_and_b32 v138, s98, v98
 v_and_b32 v139, s98, v102
 v_pk_add_f32 v[124:125], v[124:125], v[136:137]
 v_cvt_pk_bf16_f32 v82, v124, v125
 v_pk_add_f32 v[126:127], v[126:127], v[138:139]
 v_cvt_pk_bf16_f32 v83, v126, v127
 buffer_store_dwordx2 v[82:83], v70, s[84:87], s93 offen
 s_add_u32 s93, s93, 4096
 v_lshlrev_b32 v136, 16, v91
 v_lshlrev_b32 v137, 16, v95
 v_lshlrev_b32 v138, 16, v99
 v_lshlrev_b32 v139, 16, v103
 v_pk_add_f32 v[128:129], v[128:129], v[136:137]
 v_cvt_pk_bf16_f32 v84, v128, v129
 v_pk_add_f32 v[130:131], v[130:131], v[138:139]
 v_cvt_pk_bf16_f32 v85, v130, v131
 buffer_store_dwordx2 v[84:85], v70, s[84:87], s93 offen
 s_add_u32 s93, s93, 4096
 v_and_b32 v136, s98, v91
 v_and_b32 v137, s98, v95
 v_and_b32 v138, s98, v99
 v_and_b32 v139, s98, v103
 v_pk_add_f32 v[132:133], v[132:133], v[136:137]
 v_cvt_pk_bf16_f32 v86, v132, v133
 v_pk_add_f32 v[134:135], v[134:135], v[138:139]
 v_cvt_pk_bf16_f32 v87, v134, v135
 buffer_store_dwordx2 v[86:87], v70, s[84:87], s93 offen
 s_add_u32 s93, s93, 4096
 s_barrier
 s_mov_b32 s3, 0
L_rdy_9:
 buffer_load_dwordx4 v[84:87], off, s[12:15], s30 sc1
 s_add_u32 s3, s3, 1
 s_cmp_gt_u32 s3, 400000
 s_cbranch_scc1 L_exit
 s_waitcnt vmcnt(0)
 v_readfirstlane_b32 s32, v84
 v_readfirstlane_b32 s33, v85
 v_readfirstlane_b32 vcc_hi, v86
 s_and_b32 vcc_lo, s32, 0xffff
 s_cmp_lt_u32 vcc_lo, 256
 s_cbranch_scc1 L_rdy_9
 s_cmp_lg_u32 vcc_hi, 0
 s_cbranch_scc1 L_general
 s_load_dwordx2 s[36:37], s[0:1], 0
 s_mov_b32 s38, 4194304
 s_mov_b32 s39, 0x20000
 s_lshl_b32 s44, s26, 14
 s_mul_i32 s45, s26, 16512
 s_lshl_b32 s41, s25, 2
 s_add_u32 s41, s41, s26
 s_lshl_b32 s46, s41, 11
 s_add_u32 s46, s46, 50331648
 s_waitcnt lgkmcnt(0)
 v_mov_b32 v15, 0
 v_and_b32 v255, 15, v1
 v_lshlrev_b32 v255, 2, v255
 s_mov_b32 s56, 0
 s_mov_b32 s57, 0
 s_mov_b32 s58, 0
 s_mov_b32 s59, 0
 s_mov_b32 s60, 0
 s_mov_b32 s61, 0
 s_mov_b32 s62, 0
 s_mov_b32 s63, 0
 s_mov_b32 s64, 0
 s_mov_b32 s65, 0
 s_mov_b32 s66, 0
 s_mov_b32 s67, 0
 s_mov_b32 s68, 0
 s_mov_b32 s69, 0
 s_mov_b32 s70, 0
 s_mov_b32 s71, 0
 s_mov_b32 s40, 0
 s_add_u32 m0, s45, 0
 s_add_u32 s43, s44, 0
 buffer_load_dwordx4 v2, s[36:39], s43 offen offset:0 lds
 buffer_load_dwordx4 v2, s[36:39], s43 offen offset:1024 lds
 s_add_u32 m0, s45, 2064
 s_add_u32 s43, s44, 2048
 buffer_load_dwordx4 v2, s[36:39], s43 offen offset:0 lds
 buffer_load_dwordx4 v2, s[36:39], s43 offen offset:1024 lds
 s_add_u32 m0, s45, 4128
 s_add_u32 s43, s44, 4096
 buffer_load_dwordx4 v2, s[36:39], s43 offen offset:0 lds
 buffer_load_dwordx4 v2, s[36:39], s43 offen offset:1024 lds
 s_add_u32 m0, s45, 6192
 s_add_u32 s43, s44, 6144
 buffer_load_dwordx4 v2, s[36:39], s43 offen offset:0 lds
 buffer_load_dwordx4 v2, s[36:39], s43 offen offset:1024 lds
 s_add_u32 m0, s45, 8256
 s_add_u32 s43, s44, 8192
 buffer_load_dwordx4 v2, s[36:39], s43 offen offset:0 lds
 buffer_load_dwordx4 v2, s[36:39], s43 offen offset:1024 lds
 s_add_u32 m0, s45, 10320
 s_add_u32 s43, s44, 10240
 buffer_load_dwordx4 v2, s[36:39], s43 offen offset:0 lds
 buffer_load_dwordx4 v2, s[36:39], s43 offen offset:1024 lds
 s_add_u32 m0, s45, 12384
 s_add_u32 s43, s44, 12288
 buffer_load_dwordx4 v2, s[36:39], s43 offen offset:0 lds
 buffer_load_dwordx4 v2, s[36:39], s43 offen offset:1024 lds
 s_add_u32 m0, s45, 14448
 s_add_u32 s43, s44, 14336
 buffer_load_dwordx4 v2, s[36:39], s43 offen offset:0 lds
 buffer_load_dwordx4 v2, s[36:39], s43 offen offset:1024 lds
 s_waitcnt vmcnt(0)
 s_barrier
 ds_read_b128 v[16:19], v10 offset:0
 ds_read_b128 v[20:23], v10 offset:32
 ds_read_b128 v[24:27], v10 offset:64
 ds_read_b128 v[28:31], v10 offset:96
 ds_read_b128 v[32:35], v10 offset:128
 ds_read_b128 v[36:39], v10 offset:160
 s_add_u32 s46, s46, 1073479680
 v_and_b32 v3, 31, v1
 v_lshrrev_b32 v4, 5, v1
 v_lshlrev_b32 v12, 4, v3
 v_lshl_add_u32 v12, v4, 7, v12
 v_cmp_gt_u32 vcc, 8, v3
 v_and_b32 v13, 15, v5
 v_lshlrev_b32 v13, 2, v13
 v_lshl_add_u32 v13, v4, 7, v13
 v_lshrrev_b32 v5, 4, v5
 v_lshl_add_u32 v13, v5, 8, v13
 v_cndmask_b32 v12, v7, v12, vcc
 v_lshlrev_b32 v4, 3, v4
 v_sub_u32 v3, v3, v4
 v_mov_b32 v4, 0xf149f2ca
 v_cmp_gt_i32 vcc, 0, v3
 s_nop 1
 v_cndmask_b32 v232, 0, v4, vcc
 v_cmp_gt_i32 vcc, 1, v3
 s_nop 1
 v_cndmask_b32 v233, 0, v4, vcc
 v_cmp_gt_i32 vcc, 2, v3
 s_nop 1
 v_cndmask_b32 v234, 0, v4, vcc
 v_cmp_gt_i32 vcc, 3, v3
 s_nop 1
 v_cndmask_b32 v235, 0, v4, vcc
 v_cmp_gt_i32 vcc, 4, v3
 s_nop 1
 v_cndmask_b32 v236, 0, v4, vcc
 v_cmp_gt_i32 vcc, 5, v3
 s_nop 1
 v_cndmask_b32 v237, 0, v4, vcc
 v_cmp_gt_i32 vcc, 6, v3
 s_nop 1
 v_cndmask_b32 v238, 0, v4, vcc
 v_cmp_gt_i32 vcc, 7, v3
 s_nop 1
 v_cndmask_b32 v239, 0, v4, vcc
 v_cmp_gt_i32 vcc, 16, v3
 s_nop 1
 v_cndmask_b32 v240, 0, v4, vcc
 v_cmp_gt_i32 vcc, 17, v3
 s_nop 1
 v_cndmask_b32 v241, 0, v4, vcc
 v_cmp_gt_i32 vcc, 18, v3
 s_nop 1
 v_cndmask_b32 v242, 0, v4, vcc
 v_cmp_gt_i32 vcc, 19, v3
 s_nop 1
 v_cndmask_b32 v243, 0, v4, vcc
 v_cmp_gt_i32 vcc, 20, v3
 s_nop 1
 v_cndmask_b32 v244, 0, v4, vcc
 v_cmp_gt_i32 vcc, 21, v3
 s_nop 1
 v_cndmask_b32 v245, 0, v4, vcc
 v_cmp_gt_i32 vcc, 22, v3
 s_nop 1
 v_cndmask_b32 v246, 0, v4, vcc
 v_cmp_gt_i32 vcc, 23, v3
 s_nop 1
 v_cndmask_b32 v247, 0, v4, vcc
 v_mov_b32 v248, 0x3e0293ee
 s_lshl_b32 s47, s51, 7
 s_add_u32 s47, s47, 3735552
 s_mov_b32 s53, 0x40000000
 v_cmp_eq_u32 vcc, 0, v1
 v_mov_b32 v252, 0
 s_nop 0
 v_cndmask_b32 v14, v7, 0, vcc
L_rQ_loop:
 s_waitcnt lgkmcnt(5)
 v_mfma_f32_32x32x16_bf16 v[48:63], a[0:3], v[16:19], 0
 ds_read_b128 v[40:43], v10 offset:192
 s_add_u32 s44, s44, 65536
 s_add_u32 m0, s45, 66048
 s_add_u32 s43, s44, 0
 buffer_load_dwordx4 v2, s[36:39], s43 offen offset:0 lds
 s_waitcnt lgkmcnt(5)
 v_mfma_f32_32x32x16_bf16 v[48:63], a[4:7], v[20:23], v[48:63]
 ds_read_b128 v[44:47], v10 offset:224
 s_waitcnt lgkmcnt(5)
 v_mfma_f32_32x32x16_bf16 v[48:63], a[8:11], v[24:27], v[48:63]
 ds_read_b128 v[16:19], v10 offset:256
 buffer_load_dwordx4 v2, s[36:39], s43 offen offset:1024 lds
 s_waitcnt lgkmcnt(5)
 v_mfma_f32_32x32x16_bf16 v[48:63], a[12:15], v[28:31], v[48:63]
 ds_read_b128 v[20:23], v10 offset:288
 s_waitcnt lgkmcnt(5)
 v_mfma_f32_32x32x16_bf16 v[48:63], a[16:19], v[32:35], v[48:63]
 ds_read_b128 v[24:27], v10 offset:320
 s_add_u32 m0, s45, 68112
 s_add_u32 s43, s44, 2048
 buffer_load_dwordx4 v2, s[36:39], s43 offen offset:0 lds
 v_cvt_pk_bf16_f32 v80, v64, v65
 v_cvt_pk_bf16_f32 v81, v66, v67
 s_waitcnt lgkmcnt(5)
 v_mfma_f32_32x32x16_bf16 v[48:63], a[20:23], v[36:39], v[48:63]
 ds_read_b128 v[28:31], v10 offset:352
 v_cvt_pk_bf16_f32 v82, v68, v69
 v_cvt_pk_bf16_f32 v83, v70, v71
 s_waitcnt lgkmcnt(5)
 v_mfma_f32_32x32x16_bf16 v[48:63], a[24:27], v[40:43], v[48:63]
 ds_read_b128 v[32:35], v10 offset:384
 buffer_load_dwordx4 v2, s[36:39], s43 offen offset:1024 lds
 v_cvt_pk_bf16_f32 v84, v72, v73
 v_cvt_pk_bf16_f32 v85, v74, v75
 s_waitcnt lgkmcnt(5)
 v_mfma_f32_32x32x16_bf16 v[48:63], a[28:31], v[44:47], v[48:63]
 ds_read_b128 v[36:39], v10 offset:416
 v_cvt_pk_bf16_f32 v86, v76, v77
 v_cvt_pk_bf16_f32 v87, v78, v79
 s_waitcnt lgkmcnt(5)
 v_mfma_f32_32x32x16_bf16 v[48:63], a[32:35], v[16:19], v[48:63]
 ds_read_b128 v[40:43], v10 offset:448
 s_add_u32 m0, s45, 70176
 s_add_u32 s43, s44, 4096
 buffer_load_dwordx4 v2, s[36:39], s43 offen offset:0 lds
 s_waitcnt lgkmcnt(5)
 v_mfma_f32_32x32x16_bf16 v[48:63], a[36:39], v[20:23], v[48:63]
 ds_read_b128 v[44:47], v10 offset:480
 buffer_store_dwordx4 v[80:83], v2, s[4:7], s46 offen sc1
 s_waitcnt lgkmcnt(5)
 v_mfma_f32_32x32x16_bf16 v[48:63], a[40:43], v[24:27], v[48:63]
 ds_read_b128 v[16:19], v10 offset:512
 buffer_load_dwordx4 v2, s[36:39], s43 offen offset:1024 lds
 s_waitcnt lgkmcnt(5)
 v_mfma_f32_32x32x16_bf16 v[48:63], a[44:47], v[28:31], v[48:63]
 ds_read_b128 v[20:23], v10 offset:544
 buffer_store_dwordx4 v[84:87], v2, s[4:7], s46 offen offset:1024 sc1
 s_add_u32 s46, s46, 0x40000
 s_bitset0_b32 s46, 30
 s_waitcnt lgkmcnt(5)
 v_mfma_f32_32x32x16_bf16 v[48:63], a[48:51], v[32:35], v[48:63]
 ds_read_b128 v[24:27], v10 offset:576
 s_add_u32 m0, s45, 72240
 s_add_u32 s43, s44, 6144
 buffer_load_dwordx4 v2, s[36:39], s43 offen offset:0 lds
 s_waitcnt lgkmcnt(5)
 v_mfma_f32_32x32x16_bf16 v[48:63], a[52:55], v[36:39], v[48:63]
 ds_read_b128 v[28:31], v10 offset:608
 s_waitcnt lgkmcnt(5)
 v_mfma_f32_32x32x16_bf16 v[48:63], a[56:59], v[40:43], v[48:63]
 ds_read_b128 v[32:35], v10 offset:640
 buffer_load_dwordx4 v2, s[36:39], s43 offen offset:1024 lds
 s_waitcnt lgkmcnt(5)
 v_mfma_f32_32x32x16_bf16 v[48:63], a[60:63], v[44:47], v[48:63]
 ds_read_b128 v[36:39], v10 offset:672
 s_waitcnt lgkmcnt(5)
 v_mfma_f32_32x32x16_bf16 v[48:63], a[64:67], v[16:19], v[48:63]
 ds_read_b128 v[40:43], v10 offset:704
 s_add_u32 m0, s45, 74304
 s_add_u32 s43, s44, 8192
 buffer_load_dwordx4 v2, s[36:39], s43 offen offset:0 lds
 s_waitcnt lgkmcnt(5)
 v_mfma_f32_32x32x16_bf16 v[48:63], a[68:71], v[20:23], v[48:63]
 ds_read_b128 v[44:47], v10 offset:736
 s_waitcnt lgkmcnt(5)
 v_mfma_f32_32x32x16_bf16 v[48:63], a[72:75], v[24:27], v[48:63]
 ds_read_b128 v[16:19], v10 offset:768
 buffer_load_dwordx4 v2, s[36:39], s43 offen offset:1024 lds
 s_waitcnt lgkmcnt(5)
 v_mfma_f32_32x32x16_bf16 v[48:63], a[76:79], v[28:31], v[48:63]
 ds_read_b128 v[20:23], v10 offset:800
 s_waitcnt lgkmcnt(5)
 v_mfma_f32_32x32x16_bf16 v[48:63], a[80:83], v[32:35], v[48:63]
 ds_read_b128 v[24:27], v10 offset:832
 s_add_u32 m0, s45, 76368
 s_add_u32 s43, s44, 10240
 buffer_load_dwordx4 v2, s[36:39], s43 offen offset:0 lds
 s_waitcnt lgkmcnt(5)
 v_mfma_f32_32x32x16_bf16 v[48:63], a[84:87], v[36:39], v[48:63]
 ds_read_b128 v[28:31], v10 offset:864
 s_waitcnt lgkmcnt(5)
 v_mfma_f32_32x32x16_bf16 v[48:63], a[88:91], v[40:43], v[48:63]
 ds_read_b128 v[32:35], v10 offset:896
 buffer_load_dwordx4 v2, s[36:39], s43 offen offset:1024 lds
 s_waitcnt lgkmcnt(5)
 v_mfma_f32_32x32x16_bf16 v[48:63], a[92:95], v[44:47], v[48:63]
 ds_read_b128 v[36:39], v10 offset:928
 s_waitcnt lgkmcnt(5)
 v_mfma_f32_32x32x16_bf16 v[48:63], a[96:99], v[16:19], v[48:63]
 ds_read_b128 v[40:43], v10 offset:960
 s_add_u32 m0, s45, 78432
 s_add_u32 s43, s44, 12288
 buffer_load_dwordx4 v2, s[36:39], s43 offen offset:0 lds
 s_waitcnt lgkmcnt(5)
 v_mfma_f32_32x32x16_bf16 v[48:63], a[100:103], v[20:23], v[48:63]
 ds_read_b128 v[44:47], v10 offset:992
 s_waitcnt vmcnt(15)
 buffer_store_dword v252, v14, s[4:7], s53 offen sc1
 s_mov_b32 s53, 0x40000000
 s_waitcnt lgkmcnt(5)
 v_mfma_f32_32x32x16_bf16 v[48:63], a[104:107], v[24:27], v[48:63]
 ds_read_b128 v[16:19], v10 offset:1024
 buffer_load_dwordx4 v2, s[36:39], s43 offen offset:1024 lds
 s_waitcnt lgkmcnt(5)
 v_mfma_f32_32x32x16_bf16 v[48:63], a[108:111], v[28:31], v[48:63]
 ds_read_b128 v[20:23], v10 offset:1056
 s_waitcnt lgkmcnt(5)
 v_mfma_f32_32x32x16_bf16 v[48:63], a[112:115], v[32:35], v[48:63]
 ds_read_b128 v[24:27], v10 offset:1088
 s_add_u32 m0, s45, 80496
 s_add_u32 s43, s44, 14336
 buffer_load_dwordx4 v2, s[36:39], s43 offen offset:0 lds
 s_waitcnt lgkmcnt(5)
 v_mfma_f32_32x32x16_bf16 v[48:63], a[116:119], v[36:39], v[48:63]
 ds_read_b128 v[28:31], v10 offset:1120
 s_waitcnt lgkmcnt(5)
 v_mfma_f32_32x32x16_bf16 v[48:63], a[120:123], v[40:43], v[48:63]
 ds_read_b128 v[32:35], v10 offset:1152
 buffer_load_dwordx4 v2, s[36:39], s43 offen offset:1024 lds
 s_waitcnt lgkmcnt(5)
 v_mfma_f32_32x32x16_bf16 v[48:63], a[124:127], v[44:47], v[48:63]
 ds_read_b128 v[36:39], v10 offset:1184
 s_waitcnt lgkmcnt(5)
 v_mfma_f32_32x32x16_bf16 v[48:63], a[128:131], v[16:19], v[48:63]
 ds_read_b128 v[40:43], v10 offset:1216
 s_waitcnt lgkmcnt(5)
 v_mfma_f32_32x32x16_bf16 v[48:63], a[132:135], v[20:23], v[48:63]
 ds_read_b128 v[44:47], v10 offset:1248
 s_waitcnt lgkmcnt(5)
 v_mfma_f32_32x32x16_bf16 v[48:63], a[136:139], v[24:27], v[48:63]
 ds_read_b128 v[16:19], v10 offset:1280
 s_waitcnt lgkmcnt(5)
 v_mfma_f32_32x32x16_bf16 v[48:63], a[140:143], v[28:31], v[48:63]
 ds_read_b128 v[20:23], v10 offset:1312
 s_waitcnt lgkmcnt(5)
 v_mfma_f32_32x32x16_bf16 v[48:63], a[144:147], v[32:35], v[48:63]
 ds_read_b128 v[24:27], v10 offset:1344
 s_waitcnt lgkmcnt(5)
 v_mfma_f32_32x32x16_bf16 v[48:63], a[148:151], v[36:39], v[48:63]
 ds_read_b128 v[28:31], v10 offset:1376
 v_mov_b32 v9, s40
 s_waitcnt vmcnt(11)
 buffer_load_dword v15, v255, s[4:7], s47 offen sc1
 buffer_store_dword v9, v8, s[4:7], 0 offen sc1
 s_waitcnt lgkmcnt(5)
 v_mfma_f32_32x32x16_bf16 v[48:63], a[152:155], v[40:43], v[48:63]
 ds_read_b128 v[32:35], v10 offset:1408
 s_waitcnt lgkmcnt(5)
 v_mfma_f32_32x32x16_bf16 v[48:63], a[156:159], v[44:47], v[48:63]
 ds_read_b128 v[36:39], v10 offset:1440
 s_waitcnt lgkmcnt(5)
 v_mfma_f32_32x32x16_bf16 v[48:63], a[160:163], v[16:19], v[48:63]
 ds_read_b128 v[40:43], v10 offset:1472
 s_waitcnt lgkmcnt(5)
 v_mfma_f32_32x32x16_bf16 v[48:63], a[164:167], v[20:23], v[48:63]
 ds_read_b128 v[44:47], v10 offset:1504
 s_waitcnt lgkmcnt(5)
 v_mfma_f32_32x32x16_bf16 v[48:63], a[168:171], v[24:27], v[48:63]
 ds_read_b128 v[16:19], v10 offset:1536
 s_waitcnt lgkmcnt(5)
 v_mfma_f32_32x32x16_bf16 v[48:63], a[172:175], v[28:31], v[48:63]
 ds_read_b128 v[20:23], v10 offset:1568
 s_waitcnt lgkmcnt(5)
 v_mfma_f32_32x32x16_bf16 v[48:63], a[176:179], v[32:35], v[48:63]
 ds_read_b128 v[24:27], v10 offset:1600
 s_waitcnt lgkmcnt(5)
 v_mfma_f32_32x32x16_bf16 v[48:63], a[180:183], v[36:39], v[48:63]
 ds_read_b128 v[28:31], v10 offset:1632
 s_waitcnt lgkmcnt(5)
 v_mfma_f32_32x32x16_bf16 v[48:63], a[184:187], v[40:43], v[48:63]
 ds_read_b128 v[32:35], v10 offset:1664
 s_waitcnt lgkmcnt(5)
 v_mfma_f32_32x32x16_bf16 v[48:63], a[188:191], v[44:47], v[48:63]
 ds_read_b128 v[36:39], v10 offset:1696
 s_waitcnt lgkmcnt(5)
 v_mfma_f32_32x32x16_bf16 v[48:63], a[192:195], v[16:19], v[48:63]
 ds_read_b128 v[40:43], v10 offset:1728
 s_waitcnt lgkmcnt(5)
 v_mfma_f32_32x32x16_bf16 v[48:63], a[196:199], v[20:23], v[48:63]
 ds_read_b128 v[44:47], v10 offset:1760
 s_waitcnt lgkmcnt(5)
 v_mfma_f32_32x32x16_bf16 v[48:63], a[200:203], v[24:27], v[48:63]
 ds_read_b128 v[16:19], v10 offset:1792
 s_waitcnt lgkmcnt(5)
 v_mfma_f32_32x32x16_bf16 v[48:63], a[204:207], v[28:31], v[48:63]
 ds_read_b128 v[20:23], v10 offset:1824
 s_waitcnt lgkmcnt(5)
 v_mfma_f32_32x32x16_bf16 v[48:63], a[208:211], v[32:35], v[48:63]
 ds_read_b128 v[24:27], v10 offset:1856
 s_waitcnt lgkmcnt(5)
 v_mfma_f32_32x32x16_bf16 v[48:63], a[212:215], v[36:39], v[48:63]
 ds_read_b128 v[28:31], v10 offset:1888
 s_waitcnt lgkmcnt(5)
 v_mfma_f32_32x32x16_bf16 v[48:63], a[216:219], v[40:43], v[48:63]
 ds_read_b128 v[32:35], v10 offset:1920
 s_waitcnt lgkmcnt(5)
 v_mfma_f32_32x32x16_bf16 v[48:63], a[220:223], v[44:47], v[48:63]
 ds_read_b128 v[36:39], v10 offset:1952
 s_waitcnt lgkmcnt(5)
 v_mfma_f32_32x32x16_bf16 v[48:63], a[224:227], v[16:19], v[48:63]
 ds_read_b128 v[40:43], v10 offset:1984
 s_waitcnt lgkmcnt(5)
 v_mfma_f32_32x32x16_bf16 v[48:63], a[228:231], v[20:23], v[48:63]
 ds_read_b128 v[44:47], v10 offset:2016
 s_add_u32 s40, s40, 1
 s_mov_b32 s54, 0
 s_waitcnt lgkmcnt(5)
 v_mfma_f32_32x32x16_bf16 v[48:63], a[232:235], v[24:27], v[48:63]
 s_waitcnt lgkmcnt(4)
 v_mfma_f32_32x32x16_bf16 v[48:63], a[236:239], v[28:31], v[48:63]
 s_waitcnt lgkmcnt(0)
 s_waitcnt vmcnt(2)
 s_barrier
 ds_read_b128 v[16:19], v11 offset:0
 ds_read_b128 v[20:23], v11 offset:32
 v_mfma_f32_32x32x16_bf16 v[48:63], a[240:243], v[32:35], v[48:63]
 ds_read_b128 v[24:27], v11 offset:64
 ds_read_b128 v[28:31], v11 offset:96
 v_mfma_f32_32x32x16_bf16 v[48:63], a[244:247], v[36:39], v[48:63]
 ds_read_b128 v[32:35], v11 offset:128
 ds_read_b128 v[36:39], v11 offset:160
 v_mfma_f32_32x32x16_bf16 v[48:63], a[248:251], v[40:43], v[48:63]
 v_cmp_ge_u32 vcc, s50, v15
 v_mfma_f32_32x32x16_bf16 v[48:63], a[252:255], v[44:47], v[48:63]
 s_and_b32 vcc_lo, vcc_lo, 0xffff
 s_cbranch_scc0 L_rQ_att
L_rQ_ret0:
 s_waitcnt lgkmcnt(5)
 v_mfma_f32_32x32x16_bf16 v[64:79], a[0:3], v[16:19], 0
 ds_read_b128 v[40:43], v11 offset:192
 s_add_u32 s44, s44, 65536
 s_add_u32 m0, s45, 0
 s_add_u32 s43, s44, 0
 buffer_load_dwordx4 v2, s[36:39], s43 offen offset:0 lds
 s_waitcnt lgkmcnt(5)
 v_mfma_f32_32x32x16_bf16 v[64:79], a[4:7], v[20:23], v[64:79]
 ds_read_b128 v[44:47], v11 offset:224
 s_waitcnt lgkmcnt(5)
 v_mfma_f32_32x32x16_bf16 v[64:79], a[8:11], v[24:27], v[64:79]
 ds_read_b128 v[16:19], v11 offset:256
 buffer_load_dwordx4 v2, s[36:39], s43 offen offset:1024 lds
 s_waitcnt lgkmcnt(5)
 v_mfma_f32_32x32x16_bf16 v[64:79], a[12:15], v[28:31], v[64:79]
 ds_read_b128 v[20:23], v11 offset:288
 s_waitcnt lgkmcnt(5)
 v_mfma_f32_32x32x16_bf16 v[64:79], a[16:19], v[32:35], v[64:79]
 ds_read_b128 v[24:27], v11 offset:320
 s_add_u32 m0, s45, 2064
 s_add_u32 s43, s44, 2048
 buffer_load_dwordx4 v2, s[36:39], s43 offen offset:0 lds
 v_cvt_pk_bf16_f32 v80, v48, v49
 v_cvt_pk_bf16_f32 v81, v50, v51
 s_waitcnt lgkmcnt(5)
 v_mfma_f32_32x32x16_bf16 v[64:79], a[20:23], v[36:39], v[64:79]
 ds_read_b128 v[28:31], v11 offset:352
 v_cvt_pk_bf16_f32 v82, v52, v53
 v_cvt_pk_bf16_f32 v83, v54, v55
 s_waitcnt lgkmcnt(5)
 v_mfma_f32_32x32x16_bf16 v[64:79], a[24:27], v[40:43], v[64:79]
 ds_read_b128 v[32:35], v11 offset:384
 buffer_load_dwordx4 v2, s[36:39], s43 offen offset:1024 lds
 v_cvt_pk_bf16_f32 v84, v56, v57
 v_cvt_pk_bf16_f32 v85, v58, v59
 s_waitcnt lgkmcnt(5)
 v_mfma_f32_32x32x16_bf16 v[64:79], a[28:31], v[44:47], v[64:79]
 ds_read_b128 v[36:39], v11 offset:416
 v_cvt_pk_bf16_f32 v86, v60, v61
 v_cvt_pk_bf16_f32 v87, v62, v63
 s_waitcnt lgkmcnt(5)
 v_mfma_f32_32x32x16_bf16 v[64:79], a[32:35], v[16:19], v[64:79]
 ds_read_b128 v[40:43], v11 offset:448
 s_add_u32 m0, s45, 4128
 s_add_u32 s43, s44, 4096
 buffer_load_dwordx4 v2, s[36:39], s43 offen offset:0 lds
 s_waitcnt lgkmcnt(5)
 v_mfma_f32_32x32x16_bf16 v[64:79], a[36:39], v[20:23], v[64:79]
 ds_read_b128 v[44:47], v11 offset:480
 buffer_store_dwordx4 v[80:83], v2, s[4:7], s46 offen sc1
 s_waitcnt lgkmcnt(5)
 v_mfma_f32_32x32x16_bf16 v[64:79], a[40:43], v[24:27], v[64:79]
 ds_read_b128 v[16:19], v11 offset:512
 buffer_load_dwordx4 v2, s[36:39], s43 offen offset:1024 lds
 s_waitcnt lgkmcnt(5)
 v_mfma_f32_32x32x16_bf16 v[64:79], a[44:47], v[28:31], v[64:79]
 ds_read_b128 v[20:23], v11 offset:544
 buffer_store_dwordx4 v[84:87], v2, s[4:7], s46 offen offset:1024 sc1
 s_add_u32 s46, s46, 0x40000
 s_bitset0_b32 s46, 30
 s_waitcnt lgkmcnt(5)
 v_mfma_f32_32x32x16_bf16 v[64:79], a[48:51], v[32:35], v[64:79]
 ds_read_b128 v[24:27], v11 offset:576
 s_add_u32 m0, s45, 6192
 s_add_u32 s43, s44, 6144
 buffer_load_dwordx4 v2, s[36:39], s43 offen offset:0 lds
 s_waitcnt lgkmcnt(5)
 v_mfma_f32_32x32x16_bf16 v[64:79], a[52:55], v[36:39], v[64:79]
 ds_read_b128 v[28:31], v11 offset:608
 s_waitcnt lgkmcnt(5)
 v_mfma_f32_32x32x16_bf16 v[64:79], a[56:59], v[40:43], v[64:79]
 ds_read_b128 v[32:35], v11 offset:640
 buffer_load_dwordx4 v2, s[36:39], s43 offen offset:1024 lds
 s_waitcnt lgkmcnt(5)
 v_mfma_f32_32x32x16_bf16 v[64:79], a[60:63], v[44:47], v[64:79]
 ds_read_b128 v[36:39], v11 offset:672
 s_waitcnt lgkmcnt(5)
 v_mfma_f32_32x32x16_bf16 v[64:79], a[64:67], v[16:19], v[64:79]
 ds_read_b128 v[40:43], v11 offset:704
 s_add_u32 m0, s45, 8256
 s_add_u32 s43, s44, 8192
 buffer_load_dwordx4 v2, s[36:39], s43 offen offset:0 lds
 s_waitcnt lgkmcnt(5)
 v_mfma_f32_32x32x16_bf16 v[64:79], a[68:71], v[20:23], v[64:79]
 ds_read_b128 v[44:47], v11 offset:736
 s_waitcnt lgkmcnt(5)
 v_mfma_f32_32x32x16_bf16 v[64:79], a[72:75], v[24:27], v[64:79]
 ds_read_b128 v[16:19], v11 offset:768
 buffer_load_dwordx4 v2, s[36:39], s43 offen offset:1024 lds
 s_waitcnt lgkmcnt(5)
 v_mfma_f32_32x32x16_bf16 v[64:79], a[76:79], v[28:31], v[64:79]
 ds_read_b128 v[20:23], v11 offset:800
 s_waitcnt lgkmcnt(5)
 v_mfma_f32_32x32x16_bf16 v[64:79], a[80:83], v[32:35], v[64:79]
 ds_read_b128 v[24:27], v11 offset:832
 s_add_u32 m0, s45, 10320
 s_add_u32 s43, s44, 10240
 buffer_load_dwordx4 v2, s[36:39], s43 offen offset:0 lds
 s_waitcnt lgkmcnt(5)
 v_mfma_f32_32x32x16_bf16 v[64:79], a[84:87], v[36:39], v[64:79]
 ds_read_b128 v[28:31], v11 offset:864
 s_waitcnt lgkmcnt(5)
 v_mfma_f32_32x32x16_bf16 v[64:79], a[88:91], v[40:43], v[64:79]
 ds_read_b128 v[32:35], v11 offset:896
 buffer_load_dwordx4 v2, s[36:39], s43 offen offset:1024 lds
 s_waitcnt lgkmcnt(5)
 v_mfma_f32_32x32x16_bf16 v[64:79], a[92:95], v[44:47], v[64:79]
 ds_read_b128 v[36:39], v11 offset:928
 s_waitcnt lgkmcnt(5)
 v_mfma_f32_32x32x16_bf16 v[64:79], a[96:99], v[16:19], v[64:79]
 ds_read_b128 v[40:43], v11 offset:960
 s_add_u32 m0, s45, 12384
 s_add_u32 s43, s44, 12288
 buffer_load_dwordx4 v2, s[36:39], s43 offen offset:0 lds
 s_waitcnt lgkmcnt(5)
 v_mfma_f32_32x32x16_bf16 v[64:79], a[100:103], v[20:23], v[64:79]
 ds_read_b128 v[44:47], v11 offset:992
 s_waitcnt vmcnt(15)
 buffer_store_dword v252, v14, s[4:7], s53 offen sc1
 s_mov_b32 s53, 0x40000000
 s_waitcnt lgkmcnt(5)
 v_mfma_f32_32x32x16_bf16 v[64:79], a[104:107], v[24:27], v[64:79]
 ds_read_b128 v[16:19], v11 offset:1024
 buffer_load_dwordx4 v2, s[36:39], s43 offen offset:1024 lds
 s_waitcnt lgkmcnt(5)
 v_mfma_f32_32x32x16_bf16 v[64:79], a[108:111], v[28:31], v[64:79]
 ds_read_b128 v[20:23], v11 offset:1056
 s_waitcnt lgkmcnt(5)
 v_mfma_f32_32x32x16_bf16 v[64:79], a[112:115], v[32:35], v[64:79]
 ds_read_b128 v[24:27], v11 offset:1088
 s_add_u32 m0, s45, 14448
 s_add_u32 s43, s44, 14336
 buffer_load_dwordx4 v2, s[36:39], s43 offen offset:0 lds
 s_waitcnt lgkmcnt(5)
 v_mfma_f32_32x32x16_bf16 v[64:79], a[116:119], v[36:39], v[64:79]
 ds_read_b128 v[28:31], v11 offset:1120
 s_waitcnt lgkmcnt(5)
 v_mfma_f32_32x32x16_bf16 v[64:79], a[120:123], v[40:43], v[64:79]
 ds_read_b128 v[32:35], v11 offset:1152
 buffer_load_dwordx4 v2, s[36:39], s43 offen offset:1024 lds
 s_waitcnt lgkmcnt(5)
 v_mfma_f32_32x32x16_bf16 v[64:79], a[124:127], v[44:47], v[64:79]
 ds_read_b128 v[36:39], v11 offset:1184
 s_waitcnt lgkmcnt(5)
 v_mfma_f32_32x32x16_bf16 v[64:79], a[128:131], v[16:19], v[64:79]
 ds_read_b128 v[40:43], v11 offset:1216
 s_waitcnt lgkmcnt(5)
 v_mfma_f32_32x32x16_bf16 v[64:79], a[132:135], v[20:23], v[64:79]
 ds_read_b128 v[44:47], v11 offset:1248
 s_waitcnt lgkmcnt(5)
 v_mfma_f32_32x32x16_bf16 v[64:79], a[136:139], v[24:27], v[64:79]
 ds_read_b128 v[16:19], v11 offset:1280
 s_waitcnt lgkmcnt(5)
 v_mfma_f32_32x32x16_bf16 v[64:79], a[140:143], v[28:31], v[64:79]
 ds_read_b128 v[20:23], v11 offset:1312
 s_waitcnt lgkmcnt(5)
 v_mfma_f32_32x32x16_bf16 v[64:79], a[144:147], v[32:35], v[64:79]
 ds_read_b128 v[24:27], v11 offset:1344
 s_waitcnt lgkmcnt(5)
 v_mfma_f32_32x32x16_bf16 v[64:79], a[148:151], v[36:39], v[64:79]
 ds_read_b128 v[28:31], v11 offset:1376
 v_mov_b32 v9, s40
 s_waitcnt vmcnt(11)
 buffer_load_dword v15, v255, s[4:7], s47 offen sc1
 buffer_store_dword v9, v8, s[4:7], 0 offen sc1
 s_waitcnt lgkmcnt(5)
 v_mfma_f32_32x32x16_bf16 v[64:79], a[152:155], v[40:43], v[64:79]
 ds_read_b128 v[32:35], v11 offset:1408
 s_waitcnt lgkmcnt(5)
 v_mfma_f32_32x32x16_bf16 v[64:79], a[156:159], v[44:47], v[64:79]
 ds_read_b128 v[36:39], v11 offset:1440
 s_waitcnt lgkmcnt(5)
 v_mfma_f32_32x32x16_bf16 v[64:79], a[160:163], v[16:19], v[64:79]
 ds_read_b128 v[40:43], v11 offset:1472
 s_waitcnt lgkmcnt(5)
 v_mfma_f32_32x32x16_bf16 v[64:79], a[164:167], v[20:23], v[64:79]
 ds_read_b128 v[44:47], v11 offset:1504
 s_waitcnt lgkmcnt(5)
 v_mfma_f32_32x32x16_bf16 v[64:79], a[168:171], v[24:27], v[64:79]
 ds_read_b128 v[16:19], v11 offset:1536
 s_waitcnt lgkmcnt(5)
 v_mfma_f32_32x32x16_bf16 v[64:79], a[172:175], v[28:31], v[64:79]
 ds_read_b128 v[20:23], v11 offset:1568
 s_waitcnt lgkmcnt(5)
 v_mfma_f32_32x32x16_bf16 v[64:79], a[176:179], v[32:35], v[64:79]
 ds_read_b128 v[24:27], v11 offset:1600
 s_waitcnt lgkmcnt(5)
 v_mfma_f32_32x32x16_bf16 v[64:79], a[180:183], v[36:39], v[64:79]
 ds_read_b128 v[28:31], v11 offset:1632
 s_waitcnt lgkmcnt(5)
 v_mfma_f32_32x32x16_bf16 v[64:79], a[184:187], v[40:43], v[64:79]
 ds_read_b128 v[32:35], v11 offset:1664
 s_waitcnt lgkmcnt(5)
 v_mfma_f32_32x32x16_bf16 v[64:79], a[188:191], v[44:47], v[64:79]
 ds_read_b128 v[36:39], v11 offset:1696
 s_waitcnt lgkmcnt(5)
 v_mfma_f32_32x32x16_bf16 v[64:79], a[192:195], v[16:19], v[64:79]
 ds_read_b128 v[40:43], v11 offset:1728
 s_waitcnt lgkmcnt(5)
 v_mfma_f32_32x32x16_bf16 v[64:79], a[196:199], v[20:23], v[64:79]
 ds_read_b128 v[44:47], v11 offset:1760
 s_waitcnt lgkmcnt(5)
 v_mfma_f32_32x32x16_bf16 v[64:79], a[200:203], v[24:27], v[64:79]
 ds_read_b128 v[16:19], v11 offset:1792
 s_waitcnt lgkmcnt(5)
 v_mfma_f32_32x32x16_bf16 v[64:79], a[204:207], v[28:31], v[64:79]
 ds_read_b128 v[20:23], v11 offset:1824
 s_waitcnt lgkmcnt(5)
 v_mfma_f32_32x32x16_bf16 v[64:79], a[208:211], v[32:35], v[64:79]
 ds_read_b128 v[24:27], v11 offset:1856
 s_waitcnt lgkmcnt(5)
 v_mfma_f32_32x32x16_bf16 v[64:79], a[212:215], v[36:39], v[64:79]
 ds_read_b128 v[28:31], v11 offset:1888
 s_waitcnt lgkmcnt(5)
 v_mfma_f32_32x32x16_bf16 v[64:79], a[216:219], v[40:43], v[64:79]
 ds_read_b128 v[32:35], v11 offset:1920
 s_waitcnt lgkmcnt(5)
 v_mfma_f32_32x32x16_bf16 v[64:79], a[220:223], v[44:47], v[64:79]
 ds_read_b128 v[36:39], v11 offset:1952
 s_waitcnt lgkmcnt(5)
 v_mfma_f32_32x32x16_bf16 v[64:79], a[224:227], v[16:19], v[64:79]
 ds_read_b128 v[40:43], v11 offset:1984
 s_waitcnt lgkmcnt(5)
 v_mfma_f32_32x32x16_bf16 v[64:79], a[228:231], v[20:23], v[64:79]
 ds_read_b128 v[44:47], v11 offset:2016
 s_add_u32 s40, s40, 1
 s_mov_b32 s54, 1
 s_waitcnt lgkmcnt(5)
 v_mfma_f32_32x32x16_bf16 v[64:79], a[232:235], v[24:27], v[64:79]
 s_waitcnt lgkmcnt(4)
 v_mfma_f32_32x32x16_bf16 v[64:79], a[236:239], v[28:31], v[64:79]
 s_waitcnt lgkmcnt(0)
 s_waitcnt vmcnt(2)
 s_barrier
 ds_read_b128 v[16:19], v10 offset:0
 ds_read_b128 v[20:23], v10 offset:32
 v_mfma_f32_32x32x16_bf16 v[64:79], a[240:243], v[32:35], v[64:79]
 ds_read_b128 v[24:27], v10 offset:64
 ds_read_b128 v[28:31], v10 offset:96
 v_mfma_f32_32x32x16_bf16 v[64:79], a[244:247], v[36:39], v[64:79]
 ds_read_b128 v[32:35], v10 offset:128
 ds_read_b128 v[36:39], v10 offset:160
 v_mfma_f32_32x32x16_bf16 v[64:79], a[248:251], v[40:43], v[64:79]
 v_cmp_ge_u32 vcc, s50, v15
 v_mfma_f32_32x32x16_bf16 v[64:79], a[252:255], v[44:47], v[64:79]
 s_and_b32 vcc_lo, vcc_lo, 0xffff
 s_cbranch_scc0 L_rQ_att
L_rQ_ret1:
 s_cmp_lt_u32 s40, 64
 s_cbranch_scc1 L_rQ_loop
 s_nop 11
 v_cvt_pk_bf16_f32 v80, v64, v65
 v_cvt_pk_bf16_f32 v81, v66, v67
 v_cvt_pk_bf16_f32 v82, v68, v69
 v_cvt_pk_bf16_f32 v83, v70, v71
 v_cvt_pk_bf16_f32 v84, v72, v73
 v_cvt_pk_bf16_f32 v85, v74, v75
 v_cvt_pk_bf16_f32 v86, v76, v77
 v_cvt_pk_bf16_f32 v87, v78, v79
 buffer_store_dwordx4 v[80:83], v2, s[4:7], s46 offen sc1
 buffer_store_dwordx4 v[84:87], v2, s[4:7], s46 offen offset:1024 sc1
 s_add_u32 s46, s46, 0x40000
 v_mov_b32 v9, 64
 s_mov_b32 s54, 2
L_rQ_ret2:
 s_waitcnt vmcnt(0) lgkmcnt(0)
 buffer_store_dword v9, v8, s[4:7], 0 offen sc1
 buffer_store_dword v252, v14, s[4:7], s53 offen sc1
 s_mov_b32 s53, 0x40000000
 s_cmp_ge_u32 s50, 64
 s_cbranch_scc1 L_rQ_end
L_rQ_att:
L_rQ_bkv:
 v_cmp_ge_u32 vcc, s50, v15
 s_and_b32 vcc_lo, vcc_lo, 0xf0ff
 s_cbranch_scc0 L_rQ_bkvok
 buffer_load_dword v15, v255, s[4:7], s47 offen sc1
 s_add_u32 s48, s48, 1
 s_cmp_gt_u32 s48, 400000
 s_cbranch_scc1 L_done
 s_waitcnt vmcnt(0)
 s_branch L_rQ_bkv
L_rQ_bkvok:
 s_lshl_b32 s42, s50, 5
 s_add_u32 s42, s42, s51
 s_lshl_b32 s49, s42, 13
 s_lshl_b32 s53, s42, 2
 s_add_u32 s53, s53, 3760128
 s_add_u32 s43, s49, 16777216
 buffer_load_dwordx4 v[80:83], v6, s[4:7], s43 offen offset:0 sc1
 buffer_load_dwordx4 v[84:87], v6, s[4:7], s43 offen offset:1024 sc1
 buffer_load_dwordx4 v[88:91], v6, s[4:7], s43 offen offset:2048 sc1
 buffer_load_dwordx4 v[92:95], v6, s[4:7], s43 offen offset:3072 sc1
 s_add_u32 s43, s49, 16781312
 buffer_load_dwordx4 v[96:99], v6, s[4:7], s43 offen offset:0 sc1
 buffer_load_dwordx4 v[100:103], v6, s[4:7], s43 offen offset:1024 sc1
 buffer_load_dwordx4 v[104:107], v6, s[4:7], s43 offen offset:2048 sc1
 buffer_load_dwordx4 v[108:111], v6, s[4:7], s43 offen offset:3072 sc1
 s_add_u32 s43, s49, 50331648
 buffer_load_dwordx4 v[144:147], v2, s[4:7], s43 offen offset:0 sc1
 buffer_load_dwordx4 v[148:151], v2, s[4:7], s43 offen offset:1024 sc1
 buffer_load_dwordx4 v[152:155], v2, s[4:7], s43 offen offset:2048 sc1
 buffer_load_dwordx4 v[156:159], v2, s[4:7], s43 offen offset:3072 sc1
 s_add_u32 s43, s49, 50335744
 buffer_load_dwordx4 v[160:163], v2, s[4:7], s43 offen offset:0 sc1
 buffer_load_dwordx4 v[164:167], v2, s[4:7], s43 offen offset:1024 sc1
 buffer_load_dwordx4 v[168:171], v2, s[4:7], s43 offen offset:2048 sc1
 buffer_load_dwordx4 v[172:175], v2, s[4:7], s43 offen offset:3072 sc1
 s_add_u32 s43, s49, 33554432
 buffer_load_dwordx4 v[176:179], v6, s[4:7], s43 offen offset:0 sc1
 buffer_load_dwordx4 v[180:183], v6, s[4:7], s43 offen offset:1024 sc1
 buffer_load_dwordx4 v[184:187], v6, s[4:7], s43 offen offset:2048 sc1
 buffer_load_dwordx4 v[188:191], v6, s[4:7], s43 offen offset:3072 sc1
 s_add_u32 s43, s49, 33558528
 buffer_load_dwordx4 v[192:195], v6, s[4:7], s43 offen offset:0 sc1
 buffer_load_dwordx4 v[196:199], v6, s[4:7], s43 offen offset:1024 sc1
 buffer_load_dwordx4 v[200:203], v6, s[4:7], s43 offen offset:2048 sc1
 buffer_load_dwordx4 v[204:207], v6, s[4:7], s43 offen offset:3072 sc1
L_rQ_bm:
 v_cmp_ge_u32 vcc, s50, v15
 s_and_b32 vcc_lo, vcc_lo, 0xf00
 s_cbranch_scc0 L_rQ_bmok
 buffer_load_dword v15, v255, s[4:7], s47 offen sc1
 s_add_u32 s48, s48, 1
 s_cmp_gt_u32 s48, 400000
 s_cbranch_scc1 L_done
 s_waitcnt vmcnt(0)
 s_branch L_rQ_bm
L_rQ_bmok:
 s_lshr_b32 s42, s49, 2
 s_add_u32 s43, s42, 4194304
 buffer_load_dwordx4 v[112:115], v12, s[4:7], s43 offen offset:0 sc1
 buffer_load_dwordx4 v[116:119], v12, s[4:7], s43 offen offset:256 sc1
 buffer_load_dwordx4 v[120:123], v12, s[4:7], s43 offen offset:512 sc1
 buffer_load_dwordx4 v[124:127], v12, s[4:7], s43 offen offset:768 sc1
 buffer_load_dwordx4 v[128:131], v12, s[4:7], s43 offen offset:1024 sc1
 buffer_load_dwordx4 v[132:135], v12, s[4:7], s43 offen offset:1280 sc1
 buffer_load_dwordx4 v[136:139], v12, s[4:7], s43 offen offset:1536 sc1
 buffer_load_dwordx4 v[140:143], v12, s[4:7], s43 offen offset:1792 sc1
 s_add_u32 s43, s42, 8388608
 buffer_load_dword v208, v13, s[4:7], s43 offen offset:0 sc1
 buffer_load_dword v209, v13, s[4:7], s43 offen offset:64 sc1
 buffer_load_dword v210, v13, s[4:7], s43 offen offset:512 sc1
 buffer_load_dword v211, v13, s[4:7], s43 offen offset:576 sc1
 buffer_load_dword v212, v13, s[4:7], s43 offen offset:1024 sc1
 buffer_load_dword v213, v13, s[4:7], s43 offen offset:1088 sc1
 buffer_load_dword v214, v13, s[4:7], s43 offen offset:1536 sc1
 buffer_load_dword v215, v13, s[4:7], s43 offen offset:1600 sc1
 s_waitcnt vmcnt(24)
 v_mfma_f32_32x32x16_bf16 v[216:231], v[80:83], v[144:147], v[232:247]
 v_mfma_f32_32x32x16_bf16 v[216:231], v[84:87], v[148:151], v[216:231]
 v_mfma_f32_32x32x16_bf16 v[216:231], v[88:91], v[152:155], v[216:231]
 v_mfma_f32_32x32x16_bf16 v[216:231], v[92:95], v[156:159], v[216:231]
 v_mfma_f32_32x32x16_bf16 v[216:231], v[96:99], v[160:163], v[216:231]
 v_mfma_f32_32x32x16_bf16 v[216:231], v[100:103], v[164:167], v[216:231]
 v_mfma_f32_32x32x16_bf16 v[216:231], v[104:107], v[168:171], v[216:231]
 v_mfma_f32_32x32x16_bf16 v[216:231], v[108:111], v[172:175], v[216:231]
 s_waitcnt vmcnt(8)
 v_mfma_f32_32x32x16_bf16 v[80:95], v[112:115], v[144:147], 0
 v_mfma_f32_32x32x16_bf16 v[80:95], v[116:119], v[148:151], v[80:95]
 v_mfma_f32_32x32x16_bf16 v[80:95], v[120:123], v[152:155], v[80:95]
 v_mfma_f32_32x32x16_bf16 v[80:95], v[124:127], v[156:159], v[80:95]
 v_mfma_f32_32x32x16_bf16 v[80:95], v[128:131], v[160:163], v[80:95]
 v_mfma_f32_32x32x16_bf16 v[80:95], v[132:135], v[164:167], v[80:95]
 v_mfma_f32_32x32x16_bf16 v[80:95], v[136:139], v[168:171], v[80:95]
 v_mfma_f32_32x32x16_bf16 v[80:95], v[140:143], v[172:175], v[80:95]
 s_nop 3
 v_max3_f32 v3, v216, v217, v218
 v_max3_f32 v3, v3, v219, v220
 v_max3_f32 v3, v3, v221, v222
 v_max3_f32 v3, v3, v223, v224
 v_max3_f32 v3, v3, v225, v226
 v_max3_f32 v3, v3, v227, v228
 v_max3_f32 v3, v3, v229, v230
 v_max_f32 v3, v3, v231
 v_max3_f32 v3, v3, v80, v81
 v_max3_f32 v3, v3, v82, v83
 v_mov_b32 v4, v3
 s_nop 1
 v_permlane32_swap_b32 v3, v4
 s_nop 0
 v_max_f32 v3, v3, v4
 v_mul_f32 v3, v248, v3
 v_fma_f32 v216, v216, v248, -v3
 v_fma_f32 v217, v217, v248, -v3
 v_fma_f32 v218, v218, v248, -v3
 v_fma_f32 v219, v219, v248, -v3
 v_fma_f32 v220, v220, v248, -v3
 v_fma_f32 v221, v221, v248, -v3
 v_fma_f32 v222, v222, v248, -v3
 v_fma_f32 v223, v223, v248, -v3
 v_fma_f32 v224, v224, v248, -v3
 v_fma_f32 v225, v225, v248, -v3
 v_fma_f32 v226, v226, v248, -v3
 v_fma_f32 v227, v227, v248, -v3
 v_fma_f32 v228, v228, v248, -v3
 v_fma_f32 v229, v229, v248, -v3
 v_fma_f32 v230, v230, v248, -v3
 v_fma_f32 v231, v231, v248, -v3
 v_fma_f32 v80, v80, v248, -v3
 v_fma_f32 v81, v81, v248, -v3
 v_fma_f32 v82, v82, v248, -v3
 v_fma_f32 v83, v83, v248, -v3
 v_exp_f32 v216, v216
 v_exp_f32 v217, v217
 v_exp_f32 v218, v218
 v_exp_f32 v219, v219
 v_exp_f32 v220, v220
 v_exp_f32 v221, v221
 v_exp_f32 v222, v222
 v_exp_f32 v223, v223
 v_exp_f32 v224, v224
 v_exp_f32 v225, v225
 v_exp_f32 v226, v226
 v_exp_f32 v227, v227
 v_exp_f32 v228, v228
 v_exp_f32 v229, v229
 v_exp_f32 v230, v230
 v_exp_f32 v231, v231
 v_exp_f32 v80, v80
 v_exp_f32 v81, v81
 v_exp_f32 v82, v82
 v_exp_f32 v83, v83
 v_pk_add_f32 v[250:251], v[216:217], v[218:219]
 v_pk_add_f32 v[250:251], v[250:251], v[220:221]
 v_pk_add_f32 v[250:251], v[250:251], v[222:223]
 v_pk_add_f32 v[250:251], v[250:251], v[224:225]
 v_pk_add_f32 v[250:251], v[250:251], v[226:227]
 v_pk_add_f32 v[250:251], v[250:251], v[228:229]
 v_pk_add_f32 v[250:251], v[250:251], v[230:231]
 v_pk_add_f32 v[250:251], v[250:251], v[80:81]
 v_pk_add_f32 v[250:251], v[250:251], v[82:83]
 v_add_f32 v3, v250, v251
 v_add_f32 v4, v250, v251
 s_nop 1
 v_permlane32_swap_b32 v3, v4
 s_nop 0
 v_add_f32 v3, v3, v4
 v_rcp_f32 v250, v3
 s_nop 0
 v_pk_mul_f32 v[216:217], v[216:217], v[250:251] op_sel_hi:[1,0]
 v_pk_mul_f32 v[218:219], v[218:219], v[250:251] op_sel_hi:[1,0]
 v_pk_mul_f32 v[220:221], v[220:221], v[250:251] op_sel_hi:[1,0]
 v_pk_mul_f32 v[222:223], v[222:223], v[250:251] op_sel_hi:[1,0]
 v_pk_mul_f32 v[224:225], v[224:225], v[250:251] op_sel_hi:[1,0]
 v_pk_mul_f32 v[226:227], v[226:227], v[250:251] op_sel_hi:[1,0]
 v_pk_mul_f32 v[228:229], v[228:229], v[250:251] op_sel_hi:[1,0]
 v_pk_mul_f32 v[230:231], v[230:231], v[250:251] op_sel_hi:[1,0]
 v_pk_mul_f32 v[80:81], v[80:81], v[250:251] op_sel_hi:[1,0]
 v_pk_mul_f32 v[82:83], v[82:83], v[250:251] op_sel_hi:[1,0]
 v_cvt_pk_bf16_f32 v144, v216, v217
 v_cvt_pk_bf16_f32 v145, v218, v219
 v_cvt_pk_bf16_f32 v146, v220, v221
 v_cvt_pk_bf16_f32 v147, v222, v223
 v_cvt_pk_bf16_f32 v148, v224, v225
 v_cvt_pk_bf16_f32 v149, v226, v227
 v_cvt_pk_bf16_f32 v150, v228, v229
 v_cvt_pk_bf16_f32 v151, v230, v231
 v_cvt_pk_bf16_f32 v152, v80, v81
 v_cvt_pk_bf16_f32 v153, v82, v83
 s_waitcnt vmcnt(0)
 s_add_u32 s43, s49, 67108864
 s_add_u32 s42, s43, 4096
 v_mfma_f32_32x32x16_bf16 v[80:95], v[176:179], v[144:147], 0
 v_mfma_f32_32x32x16_bf16 v[80:95], v[180:183], v[148:151], v[80:95]
 v_mfma_f32_32x32x8_bf16 v[80:95], v[208:209], v[152:153], v[80:95]
 v_mfma_f32_32x32x16_bf16 v[96:111], v[184:187], v[144:147], 0
 v_mfma_f32_32x32x16_bf16 v[96:111], v[188:191], v[148:151], v[96:111]
 v_mfma_f32_32x32x8_bf16 v[96:111], v[210:211], v[152:153], v[96:111]
 v_mfma_f32_32x32x16_bf16 v[112:127], v[192:195], v[144:147], 0
 v_mfma_f32_32x32x16_bf16 v[112:127], v[196:199], v[148:151], v[112:127]
 v_mfma_f32_32x32x8_bf16 v[112:127], v[212:213], v[152:153], v[112:127]
 v_mfma_f32_32x32x16_bf16 v[128:143], v[200:203], v[144:147], 0
 v_mfma_f32_32x32x16_bf16 v[128:143], v[204:207], v[148:151], v[128:143]
 v_mfma_f32_32x32x8_bf16 v[128:143], v[214:215], v[152:153], v[128:143]
 s_nop 2
 v_cvt_pk_bf16_f32 v176, v80, v81
 v_cvt_pk_bf16_f32 v177, v82, v83
 v_cvt_pk_bf16_f32 v178, v84, v85
 v_cvt_pk_bf16_f32 v179, v86, v87
 v_cvt_pk_bf16_f32 v180, v88, v89
 v_cvt_pk_bf16_f32 v181, v90, v91
 v_cvt_pk_bf16_f32 v182, v92, v93
 v_cvt_pk_bf16_f32 v183, v94, v95
 buffer_store_dwordx4 v[176:179], v2, s[4:7], s43 offen offset:0 sc1
 buffer_store_dwordx4 v[180:183], v2, s[4:7], s43 offen offset:1024 sc1
 v_cvt_pk_bf16_f32 v184, v96, v97
 v_cvt_pk_bf16_f32 v185, v98, v99
 v_cvt_pk_bf16_f32 v186, v100, v101
 v_cvt_pk_bf16_f32 v187, v102, v103
 v_cvt_pk_bf16_f32 v188, v104, v105
 v_cvt_pk_bf16_f32 v189, v106, v107
 v_cvt_pk_bf16_f32 v190, v108, v109
 v_cvt_pk_bf16_f32 v191, v110, v111
 buffer_store_dwordx4 v[184:187], v2, s[4:7], s43 offen offset:2048 sc1
 buffer_store_dwordx4 v[188:191], v2, s[4:7], s43 offen offset:3072 sc1
 v_cvt_pk_bf16_f32 v192, v112, v113
 v_cvt_pk_bf16_f32 v193, v114, v115
 v_cvt_pk_bf16_f32 v194, v116, v117
 v_cvt_pk_bf16_f32 v195, v118, v119
 v_cvt_pk_bf16_f32 v196, v120, v121
 v_cvt_pk_bf16_f32 v197, v122, v123
 v_cvt_pk_bf16_f32 v198, v124, v125
 v_cvt_pk_bf16_f32 v199, v126, v127
 buffer_store_dwordx4 v[192:195], v2, s[4:7], s42 offen offset:0 sc1
 buffer_store_dwordx4 v[196:199], v2, s[4:7], s42 offen offset:1024 sc1
 v_cvt_pk_bf16_f32 v200, v128, v129
 v_cvt_pk_bf16_f32 v201, v130, v131
 v_cvt_pk_bf16_f32 v202, v132, v133
 v_cvt_pk_bf16_f32 v203, v134, v135
 v_cvt_pk_bf16_f32 v204, v136, v137
 v_cvt_pk_bf16_f32 v205, v138, v139
 v_cvt_pk_bf16_f32 v206, v140, v141
 v_cvt_pk_bf16_f32 v207, v142, v143
 buffer_store_dwordx4 v[200:203], v2, s[4:7], s42 offen offset:2048 sc1
 buffer_store_dwordx4 v[204:207], v2, s[4:7], s42 offen offset:3072 sc1
 s_add_u32 s41, s50, 1
 v_mov_b32 v252, s41
 s_add_u32 s50, s50, 12
 s_cmp_eq_u32 s54, 0
 s_cbranch_scc1 L_rQ_ret0
 s_cmp_eq_u32 s54, 1
 s_cbranch_scc1 L_rQ_ret1
 s_branch L_rQ_ret2
L_rQ_end:
 s_waitcnt vmcnt(0) lgkmcnt(0)
 s_barrier
 s_branch L_done
L_role_O:
 s_mov_b64 s[8:9], s[22:23]
 s_mov_b32 s10, 8388608
 s_mov_b32 s11, 0x20000
 v_and_b32 v1, 63, v0
 v_lshrrev_b32 v12, 4, v1
 v_lshlrev_b32 v12, 11, v12
 v_and_b32 v3, 15, v1
 v_lshl_add_u32 v12, v3, 4, v12
 s_lshr_b32 s44, s25, 3
 s_lshl_b32 s44, s44, 21
 s_and_b32 s42, s25, 7
 s_lshl_b32 s42, s42, 8
 s_add_u32 s44, s44, s42
 s_lshl_b32 s42, s26, 16
 s_add_u32 s44, s44, s42
 s_lshl_b32 s45, s26, 13
 s_add_u32 m0, s45, 0
 s_add_u32 s43, s44, 0
 buffer_load_dwordx4 v12, s[8:11], s43 offen  lds
 s_add_u32 m0, s45, 1024
 s_add_u32 s43, s44, 8192
 buffer_load_dwordx4 v12, s[8:11], s43 offen  lds
 s_add_u32 m0, s45, 2048
 s_add_u32 s43, s44, 16384
 buffer_load_dwordx4 v12, s[8:11], s43 offen  lds
 s_add_u32 m0, s45, 3072
 s_add_u32 s43, s44, 24576
 buffer_load_dwordx4 v12, s[8:11], s43 offen  lds
 s_add_u32 m0, s45, 4096
 s_add_u32 s43, s44, 32768
 buffer_load_dwordx4 v12, s[8:11], s43 offen  lds
 s_add_u32 m0, s45, 5120
 s_add_u32 s43, s44, 40960
 buffer_load_dwordx4 v12, s[8:11], s43 offen  lds
 s_add_u32 m0, s45, 6144
 s_add_u32 s43, s44, 49152
 buffer_load_dwordx4 v12, s[8:11], s43 offen  lds
 s_add_u32 m0, s45, 7168
 s_add_u32 s43, s44, 57344
 buffer_load_dwordx4 v12, s[8:11], s43 offen  lds
 s_cmp_lg_u32 s26, 1
 s_cbranch_scc1 L_voted_10
 s_bfe_u32 s63, s2, 0x30003
 s_lshl_b32 s56, s63, 21
 s_lshr_b32 s57, s2, 6
 s_lshl_b32 s57, s57, 3
 s_and_b32 s58, s2, 7
 s_add_u32 s57, s57, s58
 s_lshl_b32 s57, s57, 8
 s_add_u32 s56, s56, s57
 s_add_u32 s56, s56, 135790592
 s_add_u32 s57, s56, 8192
 s_load_dword s62, s[4:5], s56 glc
 s_load_dword s62, s[4:5], s57 glc
 s_waitcnt lgkmcnt(0)
 s_memtime s[58:59]
 s_load_dword s62, s[4:5], s56 glc
 s_waitcnt lgkmcnt(0)
 s_memtime s[60:61]
 s_load_dword s62, s[4:5], s57 glc
 s_waitcnt lgkmcnt(0)
 s_memtime s[32:33]
 s_sub_u32 s58, s60, s58
 s_waitcnt lgkmcnt(0)
 s_sub_u32 s60, s32, s60
 s_cmp_lt_u32 s60, s58
 s_cselect_b32 s58, 1, 0
 s_bfe_u32 s59, s24, 0x10002
 s_xor_b32 s58, s58, s59
 s_mov_b32 s59, 0
 s_mul_i32 s63, s63, 6
 s_add_u32 s63, s63, 16
 s_lshl_b64 s[34:35], s[58:59], s63
 s_or_b32 s34, s34, 1
L_voted_10:
 v_and_b32 v1, 63, v0
 v_lshlrev_b32 v2, 4, v1
 v_bfrev_b32 v7, 1
 s_mov_b32 s48, 0
 v_and_b32 v5, 0x13, v1
 v_bfe_u32 v3, v1, 2, 1
 v_lshl_add_u32 v5, v3, 3, v5
 v_bfe_u32 v3, v1, 3, 1
 v_lshl_add_u32 v5, v3, 2, v5
 v_lshrrev_b32 v4, 5, v1
 v_lshlrev_b32 v3, 9, v4
 v_lshl_add_u32 v6, v5, 4, v3
 v_mov_b32 v10, v2
 v_add_u32 v11, 65536, v10
 s_and_b32 s41, s25, 7
 s_lshl_b32 s41, s41, 2
 s_add_u32 s41, s41, s26
 s_lshl_b32 s41, s41, 7
 s_add_u32 s41, s41, 3751936
 s_mov_b32 s49, s41
 s_lshr_b32 s42, s25, 3
 s_lshl_b32 s42, s42, 2
 s_add_u32 s41, s41, s42
 v_mov_b32 v3, s41
 v_cmp_eq_u32 vcc, 0, v1
 v_mov_b32 v9, 0
 s_nop 0
 v_cndmask_b32 v8, v7, v3, vcc
 v_bfe_u32 v13, v1, 2, 2
 v_lshrrev_b32 v3, 5, v1
 v_lshl_add_u32 v13, v3, 3, v13
 v_lshlrev_b32 v13, 8, v13
 v_bfe_u32 v3, v1, 4, 1
 v_lshl_add_u32 v13, v3, 5, v13
 v_and_b32 v3, 1, v1
 v_lshl_add_u32 v13, v3, 3, v13
 v_bfe_u32 v3, v1, 1, 1
 v_lshl_add_u32 v13, v3, 4, v13
 s_lshr_b32 s43, s25, 3
 s_lshl_b32 s43, s43, 4
 v_xor_b32 v13, s43, v13
 s_lshl_b32 s43, s26, 6
 v_add_u32 v13, s43, v13
 buffer_store_dword v9, v8, s[4:7], 0 offen sc1
 s_add_u32 m0, s45, 32768
 s_add_u32 s43, s44, 262144
 buffer_load_dwordx4 v12, s[8:11], s43 offen  lds
 s_add_u32 m0, s45, 33792
 s_add_u32 s43, s44, 270336
 buffer_load_dwordx4 v12, s[8:11], s43 offen  lds
 s_add_u32 m0, s45, 34816
 s_add_u32 s43, s44, 278528
 buffer_load_dwordx4 v12, s[8:11], s43 offen  lds
 s_add_u32 m0, s45, 35840
 s_add_u32 s43, s44, 286720
 buffer_load_dwordx4 v12, s[8:11], s43 offen  lds
 s_add_u32 m0, s45, 36864
 s_add_u32 s43, s44, 294912
 buffer_load_dwordx4 v12, s[8:11], s43 offen  lds
 s_add_u32 m0, s45, 37888
 s_add_u32 s43, s44, 303104
 buffer_load_dwordx4 v12, s[8:11], s43 offen  lds
 s_add_u32 m0, s45, 38912
 s_add_u32 s43, s44, 311296
 buffer_load_dwordx4 v12, s[8:11], s43 offen  lds
 s_add_u32 m0, s45, 39936
 s_add_u32 s43, s44, 319488
 buffer_load_dwordx4 v12, s[8:11], s43 offen  lds
 s_load_dwordx2 s[36:37], s[0:1], 0
 s_mov_b32 s38, 4194304
 s_mov_b32 s39, 0x20000
 v_lshlrev_b32 v4, 7, v0
 s_lshl_b32 s46, s25, 15
 v_and_b32 v67, 15, v64
 v_lshrrev_b32 v68, 4, v64
 v_cvt_f32_u32 v200, v67
 v_mul_f32 v206, 0x41800000, v200
 v_lshl_add_u32 v65, v67, 1, 0
 v_add_u32 v65, 256, v65
 v_and_b32 v66, 3, v67
 v_lshlrev_b32 v66, 2, v66
 v_lshrrev_b32 v69, 2, v67
 v_lshl_add_u32 v66, v69, 8, v66
 v_cmp_gt_u32 vcc, 8, v67
 s_nop 1
 v_cndmask_b32 v65, v66, v65, vcc
 v_cvt_f32_u32 v202, v65
 v_and_b32 v65, 1, v67
 v_lshlrev_b32 v65, 3, v65
 v_lshrrev_b32 v66, 1, v67
 v_min_u32 v66, 4, v66
 v_lshl_add_u32 v65, v66, 8, v65
 v_add_u32 v65, 1024, v65
 v_cvt_f32_u32 v204, v65
 s_waitcnt vmcnt(18)
 v_lshlrev_b32 v95, 16, v94
 v_mul_f32 v95, 0x3fb8aa3b, v95
 v_exp_f32 v95, v95
 s_nop 0
 v_cvt_pk_bf16_f32 v95, v95, v95
 v_and_b32 v95, s98, v95
 v_lshl_add_u32 v65, v64, 5, s94
 v_lshlrev_b32 v96, 16, v88
 v_lshlrev_b32 v97, 16, v89
 v_lshlrev_b32 v98, 16, v90
 v_lshlrev_b32 v99, 16, v91
 v_lshlrev_b32 v100, 16, v92
 v_lshlrev_b32 v101, 16, v93
 v_mul_f32 v96, v95, v96
 v_mul_f32 v97, v95, v97
 v_mul_f32 v98, v95, v98
 v_mul_f32 v99, v95, v99
 v_mul_f32 v104, 0x3fb8aa3b, v96
 v_mul_f32 v105, 0x3e22f983, v97
 v_mul_f32 v106, v100, v98
 v_fma_f32 v106, -v101, v99, v106
 v_mul_f32 v107, v100, v99
 v_fma_f32 v107, v101, v98, v107
 ds_write_b128 v65, v[104:107] offset:4160
 v_and_b32 v96, s98, v88
 v_and_b32 v97, s98, v89
 v_and_b32 v98, s98, v90
 v_and_b32 v99, s98, v91
 v_and_b32 v100, s98, v92
 v_and_b32 v101, s98, v93
 v_mul_f32 v96, v95, v96
 v_mul_f32 v97, v95, v97
 v_mul_f32 v98, v95, v98
 v_mul_f32 v99, v95, v99
 v_mul_f32 v108, 0x3fb8aa3b, v96
 v_mul_f32 v109, 0x3e22f983, v97
 v_mul_f32 v110, v100, v98
 v_fma_f32 v110, -v101, v99, v110
 v_mul_f32 v111, v100, v99
 v_fma_f32 v111, v101, v98, v111
 ds_write_b128 v65, v[108:111] offset:4176
 v_mov_b32 v120, 0
 v_mov_b32 v121, 0
 v_mov_b32 v122, 0
 v_mov_b32 v123, 0
 v_mov_b32 v124, 0
 v_mov_b32 v125, 0
 v_mov_b32 v126, 0
 v_mov_b32 v127, 0
 v_mov_b32 v128, 0
 v_mov_b32 v129, 0
 v_mov_b32 v130, 0
 v_mov_b32 v131, 0
 v_lshl_add_u32 v69, v68, 6, s94
 s_mov_b32 s95, 0
 s_waitcnt lgkmcnt(0)
L_rOb_kg0:
 ds_read_b128 v[88:91], v69 offset:4160
 ds_read_b128 v[92:95], v69 offset:4176
 ds_read_b128 v[96:99], v69 offset:4192
 ds_read_b128 v[100:103], v69 offset:4208
 v_add_u32 v69, 256, v69
 s_waitcnt lgkmcnt(3)
 v_pk_mul_f32 v[132:133], v[88:89], v[200:201] op_sel_hi:[1,0]
 v_pk_mul_f32 v[136:137], v[88:89], v[202:203] op_sel_hi:[1,0]
 v_pk_mul_f32 v[140:141], v[88:89], v[204:205] op_sel_hi:[1,0]
 v_pk_mul_f32 v[144:145], v[88:89], v[206:207] op_sel_hi:[1,0]
 v_fract_f32 v133, v133
 v_fract_f32 v137, v137
 v_fract_f32 v141, v141
 v_fract_f32 v145, v145
 v_exp_f32 v132, v132
 v_cos_f32 v134, v133
 v_sin_f32 v135, v133
 v_exp_f32 v136, v136
 v_cos_f32 v138, v137
 v_sin_f32 v139, v137
 v_exp_f32 v140, v140
 v_cos_f32 v142, v141
 v_sin_f32 v143, v141
 v_exp_f32 v144, v144
 v_cos_f32 v146, v145
 v_sin_f32 v147, v145
 v_pk_mul_f32 v[134:135], v[134:135], v[132:133] op_sel_hi:[1,0]
 v_pk_mul_f32 v[138:139], v[138:139], v[136:137] op_sel_hi:[1,0]
 v_pk_mul_f32 v[142:143], v[142:143], v[140:141] op_sel_hi:[1,0]
 v_pk_mul_f32 v[146:147], v[146:147], v[144:145] op_sel_hi:[1,0]
 v_pk_mul_f32 v[144:145], v[146:147], v[90:91] op_sel_hi:[0,1] neg_hi:[0,1]
 v_cvt_pk_bf16_f32 v104, v134, v135
 v_cvt_pk_bf16_f32 v108, v138, v139
 v_cvt_pk_bf16_f32 v112, v142, v143
 v_pk_fma_f32 v[144:145], v[146:147], v[90:91], v[144:145] op_sel:[1,1,0] op_sel_hi:[1,0,1] neg_lo:[0,1,0] neg_hi:[0,1,0]
 v_cvt_pk_bf16_f32 v116, v144, v145
 s_waitcnt lgkmcnt(2)
 v_pk_mul_f32 v[132:133], v[92:93], v[200:201] op_sel_hi:[1,0]
 v_pk_mul_f32 v[136:137], v[92:93], v[202:203] op_sel_hi:[1,0]
 v_pk_mul_f32 v[140:141], v[92:93], v[204:205] op_sel_hi:[1,0]
 v_pk_mul_f32 v[144:145], v[92:93], v[206:207] op_sel_hi:[1,0]
 v_fract_f32 v133, v133
 v_fract_f32 v137, v137
 v_fract_f32 v141, v141
 v_fract_f32 v145, v145
 v_exp_f32 v132, v132
 v_cos_f32 v134, v133
 v_sin_f32 v135, v133
 v_exp_f32 v136, v136
 v_cos_f32 v138, v137
 v_sin_f32 v139, v137
 v_exp_f32 v140, v140
 v_cos_f32 v142, v141
 v_sin_f32 v143, v141
 v_exp_f32 v144, v144
 v_cos_f32 v146, v145
 v_sin_f32 v147, v145
 v_pk_mul_f32 v[134:135], v[134:135], v[132:133] op_sel_hi:[1,0]
 v_pk_mul_f32 v[138:139], v[138:139], v[136:137] op_sel_hi:[1,0]
 v_pk_mul_f32 v[142:143], v[142:143], v[140:141] op_sel_hi:[1,0]
 v_pk_mul_f32 v[146:147], v[146:147], v[144:145] op_sel_hi:[1,0]
 v_pk_mul_f32 v[144:145], v[146:147], v[94:95] op_sel_hi:[0,1] neg_hi:[0,1]
 v_cvt_pk_bf16_f32 v105, v134, v135
 v_cvt_pk_bf16_f32 v109, v138, v139
 v_cvt_pk_bf16_f32 v113, v142, v143
 v_pk_fma_f32 v[144:145], v[146:147], v[94:95], v[144:145] op_sel:[1,1,0] op_sel_hi:[1,0,1] neg_lo:[0,1,0] neg_hi:[0,1,0]
 v_cvt_pk_bf16_f32 v117, v144, v145
 s_waitcnt lgkmcnt(1)
 v_pk_mul_f32 v[132:133], v[96:97], v[200:201] op_sel_hi:[1,0]
 v_pk_mul_f32 v[136:137], v[96:97], v[202:203] op_sel_hi:[1,0]
 v_pk_mul_f32 v[140:141], v[96:97], v[204:205] op_sel_hi:[1,0]
 v_pk_mul_f32 v[144:145], v[96:97], v[206:207] op_sel_hi:[1,0]
 v_fract_f32 v133, v133
 v_fract_f32 v137, v137
 v_fract_f32 v141, v141
 v_fract_f32 v145, v145
 v_exp_f32 v132, v132
 v_cos_f32 v134, v133
 v_sin_f32 v135, v133
 v_exp_f32 v136, v136
 v_cos_f32 v138, v137
 v_sin_f32 v139, v137
 v_exp_f32 v140, v140
 v_cos_f32 v142, v141
 v_sin_f32 v143, v141
 v_exp_f32 v144, v144
 v_cos_f32 v146, v145
 v_sin_f32 v147, v145
 v_pk_mul_f32 v[134:135], v[134:135], v[132:133] op_sel_hi:[1,0]
 v_pk_mul_f32 v[138:139], v[138:139], v[136:137] op_sel_hi:[1,0]
 v_pk_mul_f32 v[142:143], v[142:143], v[140:141] op_sel_hi:[1,0]
 v_pk_mul_f32 v[146:147], v[146:147], v[144:145] op_sel_hi:[1,0]
 v_pk_mul_f32 v[144:145], v[146:147], v[98:99] op_sel_hi:[0,1] neg_hi:[0,1]
 v_cvt_pk_bf16_f32 v106, v134, v135
 v_cvt_pk_bf16_f32 v110, v138, v139
 v_cvt_pk_bf16_f32 v114, v142, v143
 v_pk_fma_f32 v[144:145], v[146:147], v[98:99], v[144:145] op_sel:[1,1,0] op_sel_hi:[1,0,1] neg_lo:[0,1,0] neg_hi:[0,1,0]
 v_cvt_pk_bf16_f32 v118, v144, v145
 s_waitcnt lgkmcnt(0)
 v_pk_mul_f32 v[132:133], v[100:101], v[200:201] op_sel_hi:[1,0]
 v_pk_mul_f32 v[136:137], v[100:101], v[202:203] op_sel_hi:[1,0]
 v_pk_mul_f32 v[140:141], v[100:101], v[204:205] op_sel_hi:[1,0]
 v_pk_mul_f32 v[144:145], v[100:101], v[206:207] op_sel_hi:[1,0]
 v_fract_f32 v133, v133
 v_fract_f32 v137, v137
 v_fract_f32 v141, v141
 v_fract_f32 v145, v145
 v_exp_f32 v132, v132
 v_cos_f32 v134, v133
 v_sin_f32 v135, v133
 v_exp_f32 v136, v136
 v_cos_f32 v138, v137
 v_sin_f32 v139, v137
 v_exp_f32 v140, v140
 v_cos_f32 v142, v141
 v_sin_f32 v143, v141
 v_exp_f32 v144, v144
 v_cos_f32 v146, v145
 v_sin_f32 v147, v145
 v_pk_mul_f32 v[134:135], v[134:135], v[132:133] op_sel_hi:[1,0]
 v_pk_mul_f32 v[138:139], v[138:139], v[136:137] op_sel_hi:[1,0]
 v_pk_mul_f32 v[142:143], v[142:143], v[140:141] op_sel_hi:[1,0]
 v_pk_mul_f32 v[146:147], v[146:147], v[144:145] op_sel_hi:[1,0]
 v_pk_mul_f32 v[144:145], v[146:147], v[102:103] op_sel_hi:[0,1] neg_hi:[0,1]
 v_cvt_pk_bf16_f32 v107, v134, v135
 v_cvt_pk_bf16_f32 v111, v138, v139
 v_cvt_pk_bf16_f32 v115, v142, v143
 v_pk_fma_f32 v[144:145], v[146:147], v[102:103], v[144:145] op_sel:[1,1,0] op_sel_hi:[1,0,1] neg_lo:[0,1,0] neg_hi:[0,1,0]
 v_cvt_pk_bf16_f32 v119, v144, v145
 s_add_u32 s95, s95, 1
 s_cmp_lt_u32 s95, 2
 v_mfma_f32_16x16x32_bf16 v[120:123], v[104:107], v[116:119], v[120:123]
 v_mfma_f32_16x16x32_bf16 v[124:127], v[108:111], v[116:119], v[124:127]
 v_mfma_f32_16x16x32_bf16 v[128:131], v[112:115], v[116:119], v[128:131]
 s_cbranch_scc1 L_rOb_kg0
 s_waitcnt vmcnt(9)
 s_barrier
 ds_read_b64_tr_b16 a[0:1], v13 offset:0
 ds_read_b64_tr_b16 a[2:3], v13 offset:1024
 ds_read_b64_tr_b16 a[4:5], v13 offset:4096
 ds_read_b64_tr_b16 a[6:7], v13 offset:5120
 ds_read_b64_tr_b16 a[8:9], v13 offset:8192
 ds_read_b64_tr_b16 a[10:11], v13 offset:9216
 ds_read_b64_tr_b16 a[12:13], v13 offset:12288
 ds_read_b64_tr_b16 a[14:15], v13 offset:13312
 s_waitcnt lgkmcnt(0)
 ds_read_b64_tr_b16 a[16:17], v13 offset:16384
 ds_read_b64_tr_b16 a[18:19], v13 offset:17408
 ds_read_b64_tr_b16 a[20:21], v13 offset:20480
 ds_read_b64_tr_b16 a[22:23], v13 offset:21504
 ds_read_b64_tr_b16 a[24:25], v13 offset:24576
 ds_read_b64_tr_b16 a[26:27], v13 offset:25600
 ds_read_b64_tr_b16 a[28:29], v13 offset:28672
 ds_read_b64_tr_b16 a[30:31], v13 offset:29696
 s_waitcnt lgkmcnt(0)
 s_barrier
 s_add_u32 m0, s45, 0
 s_add_u32 s43, s44, 524288
 buffer_load_dwordx4 v12, s[8:11], s43 offen  lds
 s_add_u32 m0, s45, 1024
 s_add_u32 s43, s44, 532480
 buffer_load_dwordx4 v12, s[8:11], s43 offen  lds
 s_add_u32 m0, s45, 2048
 s_add_u32 s43, s44, 540672
 buffer_load_dwordx4 v12, s[8:11], s43 offen  lds
 s_add_u32 m0, s45, 3072
 s_add_u32 s43, s44, 548864
 buffer_load_dwordx4 v12, s[8:11], s43 offen  lds
 s_add_u32 m0, s45, 4096
 s_add_u32 s43, s44, 557056
 buffer_load_dwordx4 v12, s[8:11], s43 offen  lds
 s_add_u32 m0, s45, 5120
 s_add_u32 s43, s44, 565248
 buffer_load_dwordx4 v12, s[8:11], s43 offen  lds
 s_add_u32 m0, s45, 6144
 s_add_u32 s43, s44, 573440
 buffer_load_dwordx4 v12, s[8:11], s43 offen  lds
 s_add_u32 m0, s45, 7168
 s_add_u32 s43, s44, 581632
 buffer_load_dwordx4 v12, s[8:11], s43 offen  lds
 buffer_load_dword v14, v4, s[36:39], s46 offen
 s_add_u32 s46, s46, 1048576
L_rOb_kg1:
 ds_read_b128 v[88:91], v69 offset:4160
 ds_read_b128 v[92:95], v69 offset:4176
 ds_read_b128 v[96:99], v69 offset:4192
 ds_read_b128 v[100:103], v69 offset:4208
 v_add_u32 v69, 256, v69
 s_waitcnt lgkmcnt(3)
 v_pk_mul_f32 v[132:133], v[88:89], v[200:201] op_sel_hi:[1,0]
 v_pk_mul_f32 v[136:137], v[88:89], v[202:203] op_sel_hi:[1,0]
 v_pk_mul_f32 v[140:141], v[88:89], v[204:205] op_sel_hi:[1,0]
 v_pk_mul_f32 v[144:145], v[88:89], v[206:207] op_sel_hi:[1,0]
 v_fract_f32 v133, v133
 v_fract_f32 v137, v137
 v_fract_f32 v141, v141
 v_fract_f32 v145, v145
 v_exp_f32 v132, v132
 v_cos_f32 v134, v133
 v_sin_f32 v135, v133
 v_exp_f32 v136, v136
 v_cos_f32 v138, v137
 v_sin_f32 v139, v137
 v_exp_f32 v140, v140
 v_cos_f32 v142, v141
 v_sin_f32 v143, v141
 v_exp_f32 v144, v144
 v_cos_f32 v146, v145
 v_sin_f32 v147, v145
 v_pk_mul_f32 v[134:135], v[134:135], v[132:133] op_sel_hi:[1,0]
 v_pk_mul_f32 v[138:139], v[138:139], v[136:137] op_sel_hi:[1,0]
 v_pk_mul_f32 v[142:143], v[142:143], v[140:141] op_sel_hi:[1,0]
 v_pk_mul_f32 v[146:147], v[146:147], v[144:145] op_sel_hi:[1,0]
 v_pk_mul_f32 v[144:145], v[146:147], v[90:91] op_sel_hi:[0,1] neg_hi:[0,1]
 v_cvt_pk_bf16_f32 v104, v134, v135
 v_cvt_pk_bf16_f32 v108, v138, v139
 v_cvt_pk_bf16_f32 v112, v142, v143
 v_pk_fma_f32 v[144:145], v[146:147], v[90:91], v[144:145] op_sel:[1,1,0] op_sel_hi:[1,0,1] neg_lo:[0,1,0] neg_hi:[0,1,0]
 v_cvt_pk_bf16_f32 v116, v144, v145
 s_waitcnt lgkmcnt(2)
 v_pk_mul_f32 v[132:133], v[92:93], v[200:201] op_sel_hi:[1,0]
 v_pk_mul_f32 v[136:137], v[92:93], v[202:203] op_sel_hi:[1,0]
 v_pk_mul_f32 v[140:141], v[92:93], v[204:205] op_sel_hi:[1,0]
 v_pk_mul_f32 v[144:145], v[92:93], v[206:207] op_sel_hi:[1,0]
 v_fract_f32 v133, v133
 v_fract_f32 v137, v137
 v_fract_f32 v141, v141
 v_fract_f32 v145, v145
 v_exp_f32 v132, v132
 v_cos_f32 v134, v133
 v_sin_f32 v135, v133
 v_exp_f32 v136, v136
 v_cos_f32 v138, v137
 v_sin_f32 v139, v137
 v_exp_f32 v140, v140
 v_cos_f32 v142, v141
 v_sin_f32 v143, v141
 v_exp_f32 v144, v144
 v_cos_f32 v146, v145
 v_sin_f32 v147, v145
 v_pk_mul_f32 v[134:135], v[134:135], v[132:133] op_sel_hi:[1,0]
 v_pk_mul_f32 v[138:139], v[138:139], v[136:137] op_sel_hi:[1,0]
 v_pk_mul_f32 v[142:143], v[142:143], v[140:141] op_sel_hi:[1,0]
 v_pk_mul_f32 v[146:147], v[146:147], v[144:145] op_sel_hi:[1,0]
 v_pk_mul_f32 v[144:145], v[146:147], v[94:95] op_sel_hi:[0,1] neg_hi:[0,1]
 v_cvt_pk_bf16_f32 v105, v134, v135
 v_cvt_pk_bf16_f32 v109, v138, v139
 v_cvt_pk_bf16_f32 v113, v142, v143
 v_pk_fma_f32 v[144:145], v[146:147], v[94:95], v[144:145] op_sel:[1,1,0] op_sel_hi:[1,0,1] neg_lo:[0,1,0] neg_hi:[0,1,0]
 v_cvt_pk_bf16_f32 v117, v144, v145
 s_waitcnt lgkmcnt(1)
 v_pk_mul_f32 v[132:133], v[96:97], v[200:201] op_sel_hi:[1,0]
 v_pk_mul_f32 v[136:137], v[96:97], v[202:203] op_sel_hi:[1,0]
 v_pk_mul_f32 v[140:141], v[96:97], v[204:205] op_sel_hi:[1,0]
 v_pk_mul_f32 v[144:145], v[96:97], v[206:207] op_sel_hi:[1,0]
 v_fract_f32 v133, v133
 v_fract_f32 v137, v137
 v_fract_f32 v141, v141
 v_fract_f32 v145, v145
 v_exp_f32 v132, v132
 v_cos_f32 v134, v133
 v_sin_f32 v135, v133
 v_exp_f32 v136, v136
 v_cos_f32 v138, v137
 v_sin_f32 v139, v137
 v_exp_f32 v140, v140
 v_cos_f32 v142, v141
 v_sin_f32 v143, v141
 v_exp_f32 v144, v144
 v_cos_f32 v146, v145
 v_sin_f32 v147, v145
 v_pk_mul_f32 v[134:135], v[134:135], v[132:133] op_sel_hi:[1,0]
 v_pk_mul_f32 v[138:139], v[138:139], v[136:137] op_sel_hi:[1,0]
 v_pk_mul_f32 v[142:143], v[142:143], v[140:141] op_sel_hi:[1,0]
 v_pk_mul_f32 v[146:147], v[146:147], v[144:145] op_sel_hi:[1,0]
 v_pk_mul_f32 v[144:145], v[146:147], v[98:99] op_sel_hi:[0,1] neg_hi:[0,1]
 v_cvt_pk_bf16_f32 v106, v134, v135
 v_cvt_pk_bf16_f32 v110, v138, v139
 v_cvt_pk_bf16_f32 v114, v142, v143
 v_pk_fma_f32 v[144:145], v[146:147], v[98:99], v[144:145] op_sel:[1,1,0] op_sel_hi:[1,0,1] neg_lo:[0,1,0] neg_hi:[0,1,0]
 v_cvt_pk_bf16_f32 v118, v144, v145
 s_waitcnt lgkmcnt(0)
 v_pk_mul_f32 v[132:133], v[100:101], v[200:201] op_sel_hi:[1,0]
 v_pk_mul_f32 v[136:137], v[100:101], v[202:203] op_sel_hi:[1,0]
 v_pk_mul_f32 v[140:141], v[100:101], v[204:205] op_sel_hi:[1,0]
 v_pk_mul_f32 v[144:145], v[100:101], v[206:207] op_sel_hi:[1,0]
 v_fract_f32 v133, v133
 v_fract_f32 v137, v137
 v_fract_f32 v141, v141
 v_fract_f32 v145, v145
 v_exp_f32 v132, v132
 v_cos_f32 v134, v133
 v_sin_f32 v135, v133
 v_exp_f32 v136, v136
 v_cos_f32 v138, v137
 v_sin_f32 v139, v137
 v_exp_f32 v140, v140
 v_cos_f32 v142, v141
 v_sin_f32 v143, v141
 v_exp_f32 v144, v144
 v_cos_f32 v146, v145
 v_sin_f32 v147, v145
 v_pk_mul_f32 v[134:135], v[134:135], v[132:133] op_sel_hi:[1,0]
 v_pk_mul_f32 v[138:139], v[138:139], v[136:137] op_sel_hi:[1,0]
 v_pk_mul_f32 v[142:143], v[142:143], v[140:141] op_sel_hi:[1,0]
 v_pk_mul_f32 v[146:147], v[146:147], v[144:145] op_sel_hi:[1,0]
 v_pk_mul_f32 v[144:145], v[146:147], v[102:103] op_sel_hi:[0,1] neg_hi:[0,1]
 v_cvt_pk_bf16_f32 v107, v134, v135
 v_cvt_pk_bf16_f32 v111, v138, v139
 v_cvt_pk_bf16_f32 v115, v142, v143
 v_pk_fma_f32 v[144:145], v[146:147], v[102:103], v[144:145] op_sel:[1,1,0] op_sel_hi:[1,0,1] neg_lo:[0,1,0] neg_hi:[0,1,0]
 v_cvt_pk_bf16_f32 v119, v144, v145
 s_add_u32 s95, s95, 1
 s_cmp_lt_u32 s95, 5
 v_mfma_f32_16x16x32_bf16 v[120:123], v[104:107], v[116:119], v[120:123]
 v_mfma_f32_16x16x32_bf16 v[124:127], v[108:111], v[116:119], v[124:127]
 v_mfma_f32_16x16x32_bf16 v[128:131], v[112:115], v[116:119], v[128:131]
 s_cbranch_scc1 L_rOb_kg1
 s_lshl_b32 s93, s28, 3
 buffer_load_dwordx2 v[72:73], v70, s[84:87], s93 offen offset:0
 buffer_load_dwordx2 v[74:75], v70, s[84:87], s93 offen offset:2048
 s_add_u32 s93, s93, 4096
 buffer_load_dwordx2 v[76:77], v70, s[84:87], s93 offen offset:0
 buffer_load_dwordx2 v[78:79], v70, s[84:87], s93 offen offset:2048
 s_add_u32 s93, s93, 4096
 buffer_load_dwordx2 v[80:81], v70, s[84:87], s93 offen offset:0
 buffer_load_dwordx2 v[82:83], v70, s[84:87], s93 offen offset:2048
 s_add_u32 s93, s93, 4096
 buffer_load_dwordx2 v[84:85], v70, s[84:87], s93 offen offset:0
 buffer_load_dwordx2 v[86:87], v70, s[84:87], s93 offen offset:2048
 s_waitcnt vmcnt(17)
 s_barrier
 ds_read_b64_tr_b16 a[32:33], v13 offset:32768
 ds_read_b64_tr_b16 a[34:35], v13 offset:33792
 ds_read_b64_tr_b16 a[36:37], v13 offset:36864
 ds_read_b64_tr_b16 a[38:39], v13 offset:37888
 ds_read_b64_tr_b16 a[40:41], v13 offset:40960
 ds_read_b64_tr_b16 a[42:43], v13 offset:41984
 ds_read_b64_tr_b16 a[44:45], v13 offset:45056
 ds_read_b64_tr_b16 a[46:47], v13 offset:46080
 s_waitcnt lgkmcnt(0)
 ds_read_b64_tr_b16 a[48:49], v13 offset:49152
 ds_read_b64_tr_b16 a[50:51], v13 offset:50176
 ds_read_b64_tr_b16 a[52:53], v13 offset:53248
 ds_read_b64_tr_b16 a[54:55], v13 offset:54272
 ds_read_b64_tr_b16 a[56:57], v13 offset:57344
 ds_read_b64_tr_b16 a[58:59], v13 offset:58368
 ds_read_b64_tr_b16 a[60:61], v13 offset:61440
 ds_read_b64_tr_b16 a[62:63], v13 offset:62464
 s_waitcnt lgkmcnt(0)
 s_barrier
 s_add_u32 m0, s45, 32768
 s_add_u32 s43, s44, 786432
 buffer_load_dwordx4 v12, s[8:11], s43 offen  lds
 s_add_u32 m0, s45, 33792
 s_add_u32 s43, s44, 794624
 buffer_load_dwordx4 v12, s[8:11], s43 offen  lds
 s_add_u32 m0, s45, 34816
 s_add_u32 s43, s44, 802816
 buffer_load_dwordx4 v12, s[8:11], s43 offen  lds
 s_add_u32 m0, s45, 35840
 s_add_u32 s43, s44, 811008
 buffer_load_dwordx4 v12, s[8:11], s43 offen  lds
 s_add_u32 m0, s45, 36864
 s_add_u32 s43, s44, 819200
 buffer_load_dwordx4 v12, s[8:11], s43 offen  lds
 s_add_u32 m0, s45, 37888
 s_add_u32 s43, s44, 827392
 buffer_load_dwordx4 v12, s[8:11], s43 offen  lds
 s_add_u32 m0, s45, 38912
 s_add_u32 s43, s44, 835584
 buffer_load_dwordx4 v12, s[8:11], s43 offen  lds
 s_add_u32 m0, s45, 39936
 s_add_u32 s43, s44, 843776
 buffer_load_dwordx4 v12, s[8:11], s43 offen  lds
L_rOb_kg2:
 ds_read_b128 v[88:91], v69 offset:4160
 ds_read_b128 v[92:95], v69 offset:4176
 ds_read_b128 v[96:99], v69 offset:4192
 ds_read_b128 v[100:103], v69 offset:4208
 v_add_u32 v69, 256, v69
 s_waitcnt lgkmcnt(3)
 v_pk_mul_f32 v[132:133], v[88:89], v[200:201] op_sel_hi:[1,0]
 v_pk_mul_f32 v[136:137], v[88:89], v[202:203] op_sel_hi:[1,0]
 v_pk_mul_f32 v[140:141], v[88:89], v[204:205] op_sel_hi:[1,0]
 v_pk_mul_f32 v[144:145], v[88:89], v[206:207] op_sel_hi:[1,0]
 v_fract_f32 v133, v133
 v_fract_f32 v137, v137
 v_fract_f32 v141, v141
 v_fract_f32 v145, v145
 v_exp_f32 v132, v132
 v_cos_f32 v134, v133
 v_sin_f32 v135, v133
 v_exp_f32 v136, v136
 v_cos_f32 v138, v137
 v_sin_f32 v139, v137
 v_exp_f32 v140, v140
 v_cos_f32 v142, v141
 v_sin_f32 v143, v141
 v_exp_f32 v144, v144
 v_cos_f32 v146, v145
 v_sin_f32 v147, v145
 v_pk_mul_f32 v[134:135], v[134:135], v[132:133] op_sel_hi:[1,0]
 v_pk_mul_f32 v[138:139], v[138:139], v[136:137] op_sel_hi:[1,0]
 v_pk_mul_f32 v[142:143], v[142:143], v[140:141] op_sel_hi:[1,0]
 v_pk_mul_f32 v[146:147], v[146:147], v[144:145] op_sel_hi:[1,0]
 v_pk_mul_f32 v[144:145], v[146:147], v[90:91] op_sel_hi:[0,1] neg_hi:[0,1]
 v_cvt_pk_bf16_f32 v104, v134, v135
 v_cvt_pk_bf16_f32 v108, v138, v139
 v_cvt_pk_bf16_f32 v112, v142, v143
 v_pk_fma_f32 v[144:145], v[146:147], v[90:91], v[144:145] op_sel:[1,1,0] op_sel_hi:[1,0,1] neg_lo:[0,1,0] neg_hi:[0,1,0]
 v_cvt_pk_bf16_f32 v116, v144, v145
 s_waitcnt lgkmcnt(2)
 v_pk_mul_f32 v[132:133], v[92:93], v[200:201] op_sel_hi:[1,0]
 v_pk_mul_f32 v[136:137], v[92:93], v[202:203] op_sel_hi:[1,0]
 v_pk_mul_f32 v[140:141], v[92:93], v[204:205] op_sel_hi:[1,0]
 v_pk_mul_f32 v[144:145], v[92:93], v[206:207] op_sel_hi:[1,0]
 v_fract_f32 v133, v133
 v_fract_f32 v137, v137
 v_fract_f32 v141, v141
 v_fract_f32 v145, v145
 v_exp_f32 v132, v132
 v_cos_f32 v134, v133
 v_sin_f32 v135, v133
 v_exp_f32 v136, v136
 v_cos_f32 v138, v137
 v_sin_f32 v139, v137
 v_exp_f32 v140, v140
 v_cos_f32 v142, v141
 v_sin_f32 v143, v141
 v_exp_f32 v144, v144
 v_cos_f32 v146, v145
 v_sin_f32 v147, v145
 v_pk_mul_f32 v[134:135], v[134:135], v[132:133] op_sel_hi:[1,0]
 v_pk_mul_f32 v[138:139], v[138:139], v[136:137] op_sel_hi:[1,0]
 v_pk_mul_f32 v[142:143], v[142:143], v[140:141] op_sel_hi:[1,0]
 v_pk_mul_f32 v[146:147], v[146:147], v[144:145] op_sel_hi:[1,0]
 v_pk_mul_f32 v[144:145], v[146:147], v[94:95] op_sel_hi:[0,1] neg_hi:[0,1]
 v_cvt_pk_bf16_f32 v105, v134, v135
 v_cvt_pk_bf16_f32 v109, v138, v139
 v_cvt_pk_bf16_f32 v113, v142, v143
 v_pk_fma_f32 v[144:145], v[146:147], v[94:95], v[144:145] op_sel:[1,1,0] op_sel_hi:[1,0,1] neg_lo:[0,1,0] neg_hi:[0,1,0]
 v_cvt_pk_bf16_f32 v117, v144, v145
 s_waitcnt lgkmcnt(1)
 v_pk_mul_f32 v[132:133], v[96:97], v[200:201] op_sel_hi:[1,0]
 v_pk_mul_f32 v[136:137], v[96:97], v[202:203] op_sel_hi:[1,0]
 v_pk_mul_f32 v[140:141], v[96:97], v[204:205] op_sel_hi:[1,0]
 v_pk_mul_f32 v[144:145], v[96:97], v[206:207] op_sel_hi:[1,0]
 v_fract_f32 v133, v133
 v_fract_f32 v137, v137
 v_fract_f32 v141, v141
 v_fract_f32 v145, v145
 v_exp_f32 v132, v132
 v_cos_f32 v134, v133
 v_sin_f32 v135, v133
 v_exp_f32 v136, v136
 v_cos_f32 v138, v137
 v_sin_f32 v139, v137
 v_exp_f32 v140, v140
 v_cos_f32 v142, v141
 v_sin_f32 v143, v141
 v_exp_f32 v144, v144
 v_cos_f32 v146, v145
 v_sin_f32 v147, v145
 v_pk_mul_f32 v[134:135], v[134:135], v[132:133] op_sel_hi:[1,0]
 v_pk_mul_f32 v[138:139], v[138:139], v[136:137] op_sel_hi:[1,0]
 v_pk_mul_f32 v[142:143], v[142:143], v[140:141] op_sel_hi:[1,0]
 v_pk_mul_f32 v[146:147], v[146:147], v[144:145] op_sel_hi:[1,0]
 v_pk_mul_f32 v[144:145], v[146:147], v[98:99] op_sel_hi:[0,1] neg_hi:[0,1]
 v_cvt_pk_bf16_f32 v106, v134, v135
 v_cvt_pk_bf16_f32 v110, v138, v139
 v_cvt_pk_bf16_f32 v114, v142, v143
 v_pk_fma_f32 v[144:145], v[146:147], v[98:99], v[144:145] op_sel:[1,1,0] op_sel_hi:[1,0,1] neg_lo:[0,1,0] neg_hi:[0,1,0]
 v_cvt_pk_bf16_f32 v118, v144, v145
 s_waitcnt lgkmcnt(0)
 v_pk_mul_f32 v[132:133], v[100:101], v[200:201] op_sel_hi:[1,0]
 v_pk_mul_f32 v[136:137], v[100:101], v[202:203] op_sel_hi:[1,0]
 v_pk_mul_f32 v[140:141], v[100:101], v[204:205] op_sel_hi:[1,0]
 v_pk_mul_f32 v[144:145], v[100:101], v[206:207] op_sel_hi:[1,0]
 v_fract_f32 v133, v133
 v_fract_f32 v137, v137
 v_fract_f32 v141, v141
 v_fract_f32 v145, v145
 v_exp_f32 v132, v132
 v_cos_f32 v134, v133
 v_sin_f32 v135, v133
 v_exp_f32 v136, v136
 v_cos_f32 v138, v137
 v_sin_f32 v139, v137
 v_exp_f32 v140, v140
 v_cos_f32 v142, v141
 v_sin_f32 v143, v141
 v_exp_f32 v144, v144
 v_cos_f32 v146, v145
 v_sin_f32 v147, v145
 v_pk_mul_f32 v[134:135], v[134:135], v[132:133] op_sel_hi:[1,0]
 v_pk_mul_f32 v[138:139], v[138:139], v[136:137] op_sel_hi:[1,0]
 v_pk_mul_f32 v[142:143], v[142:143], v[140:141] op_sel_hi:[1,0]
 v_pk_mul_f32 v[146:147], v[146:147], v[144:145] op_sel_hi:[1,0]
 v_pk_mul_f32 v[144:145], v[146:147], v[102:103] op_sel_hi:[0,1] neg_hi:[0,1]
 v_cvt_pk_bf16_f32 v107, v134, v135
 v_cvt_pk_bf16_f32 v111, v138, v139
 v_cvt_pk_bf16_f32 v115, v142, v143
 v_pk_fma_f32 v[144:145], v[146:147], v[102:103], v[144:145] op_sel:[1,1,0] op_sel_hi:[1,0,1] neg_lo:[0,1,0] neg_hi:[0,1,0]
 v_cvt_pk_bf16_f32 v119, v144, v145
 s_add_u32 s95, s95, 1
 s_cmp_lt_u32 s95, 8
 v_mfma_f32_16x16x32_bf16 v[120:123], v[104:107], v[116:119], v[120:123]
 v_mfma_f32_16x16x32_bf16 v[124:127], v[108:111], v[116:119], v[124:127]
 v_mfma_f32_16x16x32_bf16 v[128:131], v[112:115], v[116:119], v[128:131]
 s_cbranch_scc1 L_rOb_kg2
 s_waitcnt vmcnt(17)
 s_barrier
 ds_read_b64_tr_b16 a[64:65], v13 offset:0
 ds_read_b64_tr_b16 a[66:67], v13 offset:1024
 ds_read_b64_tr_b16 a[68:69], v13 offset:4096
 ds_read_b64_tr_b16 a[70:71], v13 offset:5120
 ds_read_b64_tr_b16 a[72:73], v13 offset:8192
 ds_read_b64_tr_b16 a[74:75], v13 offset:9216
 ds_read_b64_tr_b16 a[76:77], v13 offset:12288
 ds_read_b64_tr_b16 a[78:79], v13 offset:13312
 s_waitcnt lgkmcnt(0)
 ds_read_b64_tr_b16 a[80:81], v13 offset:16384
 ds_read_b64_tr_b16 a[82:83], v13 offset:17408
 ds_read_b64_tr_b16 a[84:85], v13 offset:20480
 ds_read_b64_tr_b16 a[86:87], v13 offset:21504
 ds_read_b64_tr_b16 a[88:89], v13 offset:24576
 ds_read_b64_tr_b16 a[90:91], v13 offset:25600
 ds_read_b64_tr_b16 a[92:93], v13 offset:28672
 ds_read_b64_tr_b16 a[94:95], v13 offset:29696
 s_waitcnt lgkmcnt(0)
 s_barrier
 s_add_u32 m0, s45, 0
 s_add_u32 s43, s44, 1048576
 buffer_load_dwordx4 v12, s[8:11], s43 offen  lds
 s_add_u32 m0, s45, 1024
 s_add_u32 s43, s44, 1056768
 buffer_load_dwordx4 v12, s[8:11], s43 offen  lds
 s_add_u32 m0, s45, 2048
 s_add_u32 s43, s44, 1064960
 buffer_load_dwordx4 v12, s[8:11], s43 offen  lds
 s_add_u32 m0, s45, 3072
 s_add_u32 s43, s44, 1073152
 buffer_load_dwordx4 v12, s[8:11], s43 offen  lds
 s_add_u32 m0, s45, 4096
 s_add_u32 s43, s44, 1081344
 buffer_load_dwordx4 v12, s[8:11], s43 offen  lds
 s_add_u32 m0, s45, 5120
 s_add_u32 s43, s44, 1089536
 buffer_load_dwordx4 v12, s[8:11], s43 offen  lds
 s_add_u32 m0, s45, 6144
 s_add_u32 s43, s44, 1097728
 buffer_load_dwordx4 v12, s[8:11], s43 offen  lds
 s_add_u32 m0, s45, 7168
 s_add_u32 s43, s44, 1105920
 buffer_load_dwordx4 v12, s[8:11], s43 offen  lds
 buffer_load_dword v14, v4, s[36:39], s46 offen
 s_add_u32 s46, s46, 1048576
 v_mov_b32 v250, s34
 v_mov_b32 v251, s35
 v_bfrev_b32 v252, 1
 v_cmp_eq_u32 vcc, 64, v0
 s_nop 1
 v_cndmask_b32 v252, v252, 0, vcc
 buffer_atomic_add_x2 v[250:251], v252, s[12:15], s30 offen sc1
 v_lshlrev_b32 v65, 5, v67
 v_lshl_add_u32 v65, v68, 3, v65
 v_add_u32 v65, s94, v65
 v_lshlrev_b32 v66, 4, v67
 v_lshl_add_u32 v66, v68, 3, v66
 v_lshlrev_b32 v69, 3, v67
 v_lshl_add_u32 v69, v68, 7, v69
 v_cmp_gt_u32 vcc, 2, v68
 s_nop 1
 v_cndmask_b32 v66, v69, v66, vcc
 v_add_u32 v66, s94, v66
 v_lshlrev_b32 v69, 2, v67
 v_lshl_add_u32 v69, v68, 7, v69
 v_add_u32 v69, s94, v69
 v_cvt_pk_bf16_f32 v132, v120, v121
 v_cvt_pk_bf16_f32 v133, v122, v123
 v_cvt_pk_bf16_f32 v134, v124, v125
 v_cvt_pk_bf16_f32 v135, v126, v127
 v_cvt_pk_bf16_f32 v136, v128, v129
 v_cvt_pk_bf16_f32 v137, v130, v131
 ds_write_b64 v65, v[132:133]
 ds_write_b64 v66, v[134:135] offset:512
 ds_write_b32 v69, v136 offset:1024
 ds_write_b32 v69, v137 offset:1088
 v_lshrrev_b32 v65, 2, v0
 v_mul_u32_u24 v65, 80, v65
 v_and_b32 v66, 3, v0
 v_lshl_add_u32 v69, v66, 4, v65
 v_add_u32 v69, 82256, v69
 v_add_u32 v215, 43776, v69
 s_waitcnt vmcnt(18)
 v_perm_b32 v140, v74, v72, s96
 v_perm_b32 v141, v78, v76, s96
 v_perm_b32 v142, v82, v80, s96
 v_perm_b32 v143, v86, v84, s96
 ds_write_b128 v69, v[140:143] offset:0
 v_perm_b32 v144, v74, v72, s97
 v_perm_b32 v145, v78, v76, s97
 v_perm_b32 v146, v82, v80, s97
 v_perm_b32 v147, v86, v84, s97
 ds_write_b128 v69, v[144:147] offset:21888
 v_perm_b32 v148, v75, v73, s96
 v_perm_b32 v149, v79, v77, s96
 v_perm_b32 v150, v83, v81, s96
 v_perm_b32 v151, v87, v85, s96
 ds_write_b128 v215, v[148:151] offset:0
 v_perm_b32 v152, v75, v73, s97
 v_perm_b32 v153, v79, v77, s97
 v_perm_b32 v154, v83, v81, s97
 v_perm_b32 v155, v87, v85, s97
 ds_write_b128 v215, v[152:155] offset:21888
 v_lshlrev_b32 v65, 3, v64
 v_sub_u32 v65, 2047, v65
 v_cvt_f32_u32 v66, v65
 s_sub_u32 s92, s94, 34048
 s_waitcnt lgkmcnt(0)
 v_subrev_f32 v120, 0x0, v66
 v_subrev_f32 v121, 0x3f800000, v66
 v_cvt_pk_bf16_f32 v122, v120, v121
 v_and_b32 v120, 0xffff, v122
 v_lshrrev_b32 v121, 16, v122
 v_lshl_add_u32 v132, v120, 1, s92
 v_lshl_add_u32 v133, v121, 1, s92
 v_subrev_f32 v120, 0x40000000, v66
 v_subrev_f32 v121, 0x40400000, v66
 v_cvt_pk_bf16_f32 v122, v120, v121
 v_and_b32 v120, 0xffff, v122
 v_lshrrev_b32 v121, 16, v122
 v_lshl_add_u32 v134, v120, 1, s92
 v_lshl_add_u32 v135, v121, 1, s92
 v_subrev_f32 v120, 0x40800000, v66
 v_subrev_f32 v121, 0x40a00000, v66
 v_cvt_pk_bf16_f32 v122, v120, v121
 v_and_b32 v120, 0xffff, v122
 v_lshrrev_b32 v121, 16, v122
 v_lshl_add_u32 v136, v120, 1, s92
 v_lshl_add_u32 v137, v121, 1, s92
 v_subrev_f32 v120, 0x40c00000, v66
 v_subrev_f32 v121, 0x40e00000, v66
 v_cvt_pk_bf16_f32 v122, v120, v121
 v_and_b32 v120, 0xffff, v122
 v_lshrrev_b32 v121, 16, v122
 v_lshl_add_u32 v138, v120, 1, s92
 v_lshl_add_u32 v139, v121, 1, s92
 s_waitcnt lgkmcnt(0)
 ds_read_u16 v88, v132
 ds_read_u16 v92, v133
 ds_read_u16 v89, v134
 ds_read_u16 v93, v135
 ds_read_u16 v90, v136
 ds_read_u16 v94, v137
 ds_read_u16 v91, v138
 ds_read_u16 v95, v139
 v_subrev_f32 v120, 0x44000000, v66
 v_subrev_f32 v121, 0x44004000, v66
 v_cvt_pk_bf16_f32 v122, v120, v121
 v_and_b32 v120, 0xffff, v122
 v_lshrrev_b32 v121, 16, v122
 v_lshl_add_u32 v132, v120, 1, s92
 v_lshl_add_u32 v133, v121, 1, s92
 v_subrev_f32 v120, 0x44008000, v66
 v_subrev_f32 v121, 0x4400c000, v66
 v_cvt_pk_bf16_f32 v122, v120, v121
 v_and_b32 v120, 0xffff, v122
 v_lshrrev_b32 v121, 16, v122
 v_lshl_add_u32 v134, v120, 1, s92
 v_lshl_add_u32 v135, v121, 1, s92
 v_subrev_f32 v120, 0x44010000, v66
 v_subrev_f32 v121, 0x44014000, v66
 v_cvt_pk_bf16_f32 v122, v120, v121
 v_and_b32 v120, 0xffff, v122
 v_lshrrev_b32 v121, 16, v122
 v_lshl_add_u32 v136, v120, 1, s92
 v_lshl_add_u32 v137, v121, 1, s92
 v_subrev_f32 v120, 0x44018000, v66
 v_subrev_f32 v121, 0x4401c000, v66
 v_cvt_pk_bf16_f32 v122, v120, v121
 v_and_b32 v120, 0xffff, v122
 v_lshrrev_b32 v121, 16, v122
 v_lshl_add_u32 v138, v120, 1, s92
 v_lshl_add_u32 v139, v121, 1, s92
 s_waitcnt lgkmcnt(0)
 ds_read_u16 v96, v132
 ds_read_u16 v100, v133
 ds_read_u16 v97, v134
 ds_read_u16 v101, v135
 ds_read_u16 v98, v136
 ds_read_u16 v102, v137
 ds_read_u16 v99, v138
 ds_read_u16 v103, v139
 v_subrev_f32 v120, 0x44800000, v66
 v_subrev_f32 v121, 0x44802000, v66
 v_cvt_pk_bf16_f32 v122, v120, v121
 v_and_b32 v120, 0xffff, v122
 v_lshrrev_b32 v121, 16, v122
 v_lshl_add_u32 v132, v120, 1, s92
 v_lshl_add_u32 v133, v121, 1, s92
 v_subrev_f32 v120, 0x44804000, v66
 v_subrev_f32 v121, 0x44806000, v66
 v_cvt_pk_bf16_f32 v122, v120, v121
 v_and_b32 v120, 0xffff, v122
 v_lshrrev_b32 v121, 16, v122
 v_lshl_add_u32 v134, v120, 1, s92
 v_lshl_add_u32 v135, v121, 1, s92
 v_subrev_f32 v120, 0x44808000, v66
 v_subrev_f32 v121, 0x4480a000, v66
 v_cvt_pk_bf16_f32 v122, v120, v121
 v_and_b32 v120, 0xffff, v122
 v_lshrrev_b32 v121, 16, v122
 v_lshl_add_u32 v136, v120, 1, s92
 v_lshl_add_u32 v137, v121, 1, s92
 v_subrev_f32 v120, 0x4480c000, v66
 v_subrev_f32 v121, 0x4480e000, v66
 v_cvt_pk_bf16_f32 v122, v120, v121
 v_and_b32 v120, 0xffff, v122
 v_lshrrev_b32 v121, 16, v122
 v_lshl_add_u32 v138, v120, 1, s92
 v_lshl_add_u32 v139, v121, 1, s92
 s_waitcnt lgkmcnt(0)
 ds_read_u16 v104, v132
 ds_read_u16 v108, v133
 ds_read_u16 v105, v134
 ds_read_u16 v109, v135
 ds_read_u16 v106, v136
 ds_read_u16 v110, v137
 ds_read_u16 v107, v138
 ds_read_u16 v111, v139
 v_subrev_f32 v120, 0x44c00000, v66
 v_subrev_f32 v121, 0x44c02000, v66
 v_cvt_pk_bf16_f32 v122, v120, v121
 v_and_b32 v120, 0xffff, v122
 v_lshrrev_b32 v121, 16, v122
 v_subrev_u32 v122, 1536, v65
 v_min_u32 v122, 128, v122
 v_add_u32 v122, 17024, v122
 v_max_u32 v120, v120, v122
 v_subrev_u32 v122, 1537, v65
 v_min_u32 v122, 128, v122
 v_add_u32 v122, 17024, v122
 v_max_u32 v121, v121, v122
 v_lshl_add_u32 v132, v120, 1, s92
 v_lshl_add_u32 v133, v121, 1, s92
 v_subrev_f32 v120, 0x44c04000, v66
 v_subrev_f32 v121, 0x44c06000, v66
 v_cvt_pk_bf16_f32 v122, v120, v121
 v_and_b32 v120, 0xffff, v122
 v_lshrrev_b32 v121, 16, v122
 v_subrev_u32 v122, 1538, v65
 v_min_u32 v122, 128, v122
 v_add_u32 v122, 17024, v122
 v_max_u32 v120, v120, v122
 v_subrev_u32 v122, 1539, v65
 v_min_u32 v122, 128, v122
 v_add_u32 v122, 17024, v122
 v_max_u32 v121, v121, v122
 v_lshl_add_u32 v134, v120, 1, s92
 v_lshl_add_u32 v135, v121, 1, s92
 v_subrev_f32 v120, 0x44c08000, v66
 v_subrev_f32 v121, 0x44c0a000, v66
 v_cvt_pk_bf16_f32 v122, v120, v121
 v_and_b32 v120, 0xffff, v122
 v_lshrrev_b32 v121, 16, v122
 v_subrev_u32 v122, 1540, v65
 v_min_u32 v122, 128, v122
 v_add_u32 v122, 17024, v122
 v_max_u32 v120, v120, v122
 v_subrev_u32 v122, 1541, v65
 v_min_u32 v122, 128, v122
 v_add_u32 v122, 17024, v122
 v_max_u32 v121, v121, v122
 v_lshl_add_u32 v136, v120, 1, s92
 v_lshl_add_u32 v137, v121, 1, s92
 v_subrev_f32 v120, 0x44c0c000, v66
 v_subrev_f32 v121, 0x44c0e000, v66
 v_cvt_pk_bf16_f32 v122, v120, v121
 v_and_b32 v120, 0xffff, v122
 v_lshrrev_b32 v121, 16, v122
 v_subrev_u32 v122, 1542, v65
 v_min_u32 v122, 128, v122
 v_add_u32 v122, 17024, v122
 v_max_u32 v120, v120, v122
 v_subrev_u32 v122, 1543, v65
 v_min_u32 v122, 128, v122
 v_add_u32 v122, 17024, v122
 v_max_u32 v121, v121, v122
 v_lshl_add_u32 v138, v120, 1, s92
 v_lshl_add_u32 v139, v121, 1, s92
 s_waitcnt lgkmcnt(0)
 ds_read_u16 v112, v132
 ds_read_u16 v116, v133
 ds_read_u16 v113, v134
 ds_read_u16 v117, v135
 ds_read_u16 v114, v136
 ds_read_u16 v118, v137
 ds_read_u16 v115, v138
 ds_read_u16 v119, v139
 v_lshl_add_u32 v65, v64, 4, s94
 v_mov_b32 v120, 0
 v_mov_b32 v121, 0
 v_mov_b32 v122, 0
 v_mov_b32 v123, 0
 v_lshrrev_b32 v66, 2, v64
 v_mul_u32_u24 v66, 4096, v66
 v_add_u32 v66, 4096, v66
 v_cmp_gt_u32 vcc, 16, v64
 v_mov_b32 v67, 16384
 s_nop 0
 v_cndmask_b32 v66, v67, v66, vcc
 v_add_u32 v66, v66, v65
 s_waitcnt lgkmcnt(0)
 s_mov_b64 exec, 0x1fffff
 ds_write_b128 v66, v[120:123]
 s_mov_b64 exec, -1
 v_lshl_or_b32 v88, v92, 16, v88
 v_lshl_or_b32 v89, v93, 16, v89
 v_lshl_or_b32 v90, v94, 16, v90
 v_lshl_or_b32 v91, v95, 16, v91
 ds_write_b128 v65, v[88:91] offset:12480
 v_lshl_or_b32 v96, v100, 16, v96
 v_lshl_or_b32 v97, v101, 16, v97
 v_lshl_or_b32 v98, v102, 16, v98
 v_lshl_or_b32 v99, v103, 16, v99
 ds_write_b128 v65, v[96:99] offset:13504
 v_lshl_or_b32 v104, v108, 16, v104
 v_lshl_or_b32 v105, v109, 16, v105
 v_lshl_or_b32 v106, v110, 16, v106
 v_lshl_or_b32 v107, v111, 16, v107
 ds_write_b128 v65, v[104:107] offset:14528
 v_lshl_or_b32 v112, v116, 16, v112
 v_lshl_or_b32 v113, v117, 16, v113
 v_lshl_or_b32 v114, v118, 16, v114
 v_lshl_or_b32 v115, v119, 16, v115
 ds_write_b128 v65, v[112:115] offset:15552
 s_waitcnt lgkmcnt(0)
 ds_read_b64 v[92:93], v65 offset:12496
 ds_read_b64 v[100:101], v65 offset:13520
 ds_read_b64 v[108:109], v65 offset:14544
 ds_read_b64 v[116:117], v65 offset:15568
 s_waitcnt lgkmcnt(0)
 v_alignbit_b32 v132, v89, v88, 16
 v_mov_b32 v136, v89
 v_alignbit_b32 v140, v90, v89, 16
 v_alignbit_b32 v133, v90, v89, 16
 v_mov_b32 v137, v90
 v_alignbit_b32 v141, v91, v90, 16
 v_alignbit_b32 v134, v91, v90, 16
 v_mov_b32 v138, v91
 v_alignbit_b32 v142, v92, v91, 16
 v_alignbit_b32 v135, v92, v91, 16
 v_mov_b32 v139, v92
 v_alignbit_b32 v143, v93, v92, 16
 ds_write_b128 v65, v[132:135] offset:8320
 ds_write_b128 v65, v[136:139] offset:4160
 ds_write_b128 v65, v[140:143] offset:0
 v_alignbit_b32 v144, v97, v96, 16
 v_mov_b32 v148, v97
 v_alignbit_b32 v152, v98, v97, 16
 v_alignbit_b32 v145, v98, v97, 16
 v_mov_b32 v149, v98
 v_alignbit_b32 v153, v99, v98, 16
 v_alignbit_b32 v146, v99, v98, 16
 v_mov_b32 v150, v99
 v_alignbit_b32 v154, v100, v99, 16
 v_alignbit_b32 v147, v100, v99, 16
 v_mov_b32 v151, v100
 v_alignbit_b32 v155, v101, v100, 16
 ds_write_b128 v65, v[144:147] offset:9344
 ds_write_b128 v65, v[148:151] offset:5184
 ds_write_b128 v65, v[152:155] offset:1024
 v_alignbit_b32 v132, v105, v104, 16
 v_mov_b32 v136, v105
 v_alignbit_b32 v140, v106, v105, 16
 v_alignbit_b32 v133, v106, v105, 16
 v_mov_b32 v137, v106
 v_alignbit_b32 v141, v107, v106, 16
 v_alignbit_b32 v134, v107, v106, 16
 v_mov_b32 v138, v107
 v_alignbit_b32 v142, v108, v107, 16
 v_alignbit_b32 v135, v108, v107, 16
 v_mov_b32 v139, v108
 v_alignbit_b32 v143, v109, v108, 16
 ds_write_b128 v65, v[132:135] offset:10368
 ds_write_b128 v65, v[136:139] offset:6208
 ds_write_b128 v65, v[140:143] offset:2048
 v_alignbit_b32 v144, v113, v112, 16
 v_mov_b32 v148, v113
 v_alignbit_b32 v152, v114, v113, 16
 v_alignbit_b32 v145, v114, v113, 16
 v_mov_b32 v149, v114
 v_alignbit_b32 v153, v115, v114, 16
 v_alignbit_b32 v146, v115, v114, 16
 v_mov_b32 v150, v115
 v_alignbit_b32 v154, v116, v115, 16
 v_alignbit_b32 v147, v116, v115, 16
 v_mov_b32 v151, v116
 v_alignbit_b32 v155, v117, v116, 16
 ds_write_b128 v65, v[144:147] offset:11392
 ds_write_b128 v65, v[148:151] offset:7232
 ds_write_b128 v65, v[152:155] offset:3072
 v_and_b32 v66, 3, v64
 v_mul_u32_u24 v65, 4160, v66
 v_bfe_u32 v66, v64, 3, 1
 v_bfe_u32 v67, v64, 2, 1
 v_lshl_add_u32 v66, v67, 1, v66
 v_bfe_u32 v67, v64, 4, 1
 v_lshl_add_u32 v66, v67, 2, v66
 v_lshlrev_b32 v66, 3, v66
 v_sub_u32 v65, v65, v66
 v_lshrrev_b32 v67, 5, v64
 v_lshl_add_u32 v65, v67, 4, v65
 s_add_u32 s92, s94, 2040
 v_add_u32 v65, s92, v65
 v_and_b32 v66, 31, v64
 v_mul_u32_u24 v66, 80, v66
 v_lshl_add_u32 v67, v67, 4, v66
 s_add_u32 s92, s94, 16720
 v_add_u32 v67, s92, v67
 v_mov_b32 v214, v67
 v_mov_b32 v68, v67
 s_sub_u32 s93, s92, 80
 v_mov_b32 v88, 0
 v_mov_b32 v89, 0
 v_mov_b32 v90, 0
 v_mov_b32 v91, 0
 v_mov_b32 v92, 0
 v_mov_b32 v93, 0
 v_mov_b32 v94, 0
 v_mov_b32 v95, 0
 v_mov_b32 v96, 0
 v_mov_b32 v97, 0
 v_mov_b32 v98, 0
 v_mov_b32 v99, 0
 v_mov_b32 v100, 0
 v_mov_b32 v101, 0
 v_mov_b32 v102, 0
 v_mov_b32 v103, 0
 v_mov_b32 v104, 0
 v_mov_b32 v105, 0
 v_mov_b32 v106, 0
 v_mov_b32 v107, 0
 v_mov_b32 v108, 0
 v_mov_b32 v109, 0
 v_mov_b32 v110, 0
 v_mov_b32 v111, 0
 v_mov_b32 v112, 0
 v_mov_b32 v113, 0
 v_mov_b32 v114, 0
 v_mov_b32 v115, 0
 v_mov_b32 v116, 0
 v_mov_b32 v117, 0
 v_mov_b32 v118, 0
 v_mov_b32 v119, 0
 s_waitcnt lgkmcnt(0)
 s_barrier
 s_waitcnt vmcnt(10)
 s_barrier
 ds_read_b64_tr_b16 a[96:97], v13 offset:32768
 ds_read_b64_tr_b16 a[98:99], v13 offset:33792
 ds_read_b64_tr_b16 a[100:101], v13 offset:36864
 ds_read_b64_tr_b16 a[102:103], v13 offset:37888
 ds_read_b64_tr_b16 a[104:105], v13 offset:40960
 ds_read_b64_tr_b16 a[106:107], v13 offset:41984
 ds_read_b64_tr_b16 a[108:109], v13 offset:45056
 ds_read_b64_tr_b16 a[110:111], v13 offset:46080
 s_waitcnt lgkmcnt(0)
 ds_read_b64_tr_b16 a[112:113], v13 offset:49152
 ds_read_b64_tr_b16 a[114:115], v13 offset:50176
 ds_read_b64_tr_b16 a[116:117], v13 offset:53248
 ds_read_b64_tr_b16 a[118:119], v13 offset:54272
 ds_read_b64_tr_b16 a[120:121], v13 offset:57344
 ds_read_b64_tr_b16 a[122:123], v13 offset:58368
 ds_read_b64_tr_b16 a[124:125], v13 offset:61440
 ds_read_b64_tr_b16 a[126:127], v13 offset:62464
 s_waitcnt lgkmcnt(0)
 s_barrier
 s_add_u32 m0, s45, 32768
 s_add_u32 s43, s44, 1310720
 buffer_load_dwordx4 v12, s[8:11], s43 offen  lds
 s_add_u32 m0, s45, 33792
 s_add_u32 s43, s44, 1318912
 buffer_load_dwordx4 v12, s[8:11], s43 offen  lds
 s_add_u32 m0, s45, 34816
 s_add_u32 s43, s44, 1327104
 buffer_load_dwordx4 v12, s[8:11], s43 offen  lds
 s_add_u32 m0, s45, 35840
 s_add_u32 s43, s44, 1335296
 buffer_load_dwordx4 v12, s[8:11], s43 offen  lds
 s_add_u32 m0, s45, 36864
 s_add_u32 s43, s44, 1343488
 buffer_load_dwordx4 v12, s[8:11], s43 offen  lds
 s_add_u32 m0, s45, 37888
 s_add_u32 s43, s44, 1351680
 buffer_load_dwordx4 v12, s[8:11], s43 offen  lds
 s_add_u32 m0, s45, 38912
 s_add_u32 s43, s44, 1359872
 buffer_load_dwordx4 v12, s[8:11], s43 offen  lds
 s_add_u32 m0, s45, 39936
 s_add_u32 s43, s44, 1368064
 buffer_load_dwordx4 v12, s[8:11], s43 offen  lds
 ds_read_b64 v[120:121], v65 offset:2080
 ds_read_b64 v[122:123], v65 offset:2088
 ds_read_b128 v[128:131], v67 offset:2592
 ds_read_b128 v[132:135], v68 offset:32
 ds_read_b64 v[124:125], v65 offset:32
 ds_read_b64 v[126:127], v65 offset:40
 s_mov_b32 s95, 0
L_rOb_cv0:
 ds_read_b64 v[136:137], v65 offset:2048
 ds_read_b64 v[138:139], v65 offset:2056
 ds_read_b128 v[144:147], v67 offset:2560
 ds_read_b128 v[148:151], v68 offset:0
 ds_read_b64 v[140:141], v65 offset:0
 ds_read_b64 v[142:143], v65 offset:8
 s_waitcnt lgkmcnt(6)
 v_mfma_f32_32x32x16_bf16 v[104:119], v[120:123], v[128:131], v[104:119]
 v_subrev_u32 v65, 64, v65
 v_subrev_u32 v67, 80, v67
 v_max_i32 v68, s93, v67
 v_mfma_f32_32x32x16_bf16 v[88:103], v[120:123], v[132:135], v[88:103]
 v_mfma_f32_32x32x16_bf16 v[104:119], v[124:127], v[132:135], v[104:119]
 ds_read_b64 v[120:121], v65 offset:2080
 ds_read_b64 v[122:123], v65 offset:2088
 ds_read_b128 v[128:131], v67 offset:2592
 ds_read_b128 v[132:135], v68 offset:32
 ds_read_b64 v[124:125], v65 offset:32
 ds_read_b64 v[126:127], v65 offset:40
 s_waitcnt lgkmcnt(6)
 v_mfma_f32_32x32x16_bf16 v[104:119], v[136:139], v[144:147], v[104:119]
 s_add_u32 s95, s95, 1
 s_cmp_lt_u32 s95, 8
 v_mfma_f32_32x32x16_bf16 v[88:103], v[136:139], v[148:151], v[88:103]
 v_mfma_f32_32x32x16_bf16 v[104:119], v[140:143], v[148:151], v[104:119]
 s_cbranch_scc1 L_rOb_cv0
 s_waitcnt vmcnt(10)
 s_barrier
 ds_read_b64_tr_b16 a[128:129], v13 offset:0
 ds_read_b64_tr_b16 a[130:131], v13 offset:1024
 ds_read_b64_tr_b16 a[132:133], v13 offset:4096
 ds_read_b64_tr_b16 a[134:135], v13 offset:5120
 ds_read_b64_tr_b16 a[136:137], v13 offset:8192
 ds_read_b64_tr_b16 a[138:139], v13 offset:9216
 ds_read_b64_tr_b16 a[140:141], v13 offset:12288
 ds_read_b64_tr_b16 a[142:143], v13 offset:13312
 s_waitcnt lgkmcnt(0)
 ds_read_b64_tr_b16 a[144:145], v13 offset:16384
 ds_read_b64_tr_b16 a[146:147], v13 offset:17408
 ds_read_b64_tr_b16 a[148:149], v13 offset:20480
 ds_read_b64_tr_b16 a[150:151], v13 offset:21504
 ds_read_b64_tr_b16 a[152:153], v13 offset:24576
 ds_read_b64_tr_b16 a[154:155], v13 offset:25600
 ds_read_b64_tr_b16 a[156:157], v13 offset:28672
 ds_read_b64_tr_b16 a[158:159], v13 offset:29696
 s_waitcnt lgkmcnt(0)
 s_barrier
 s_add_u32 m0, s45, 0
 s_add_u32 s43, s44, 1572864
 buffer_load_dwordx4 v12, s[8:11], s43 offen  lds
 s_add_u32 m0, s45, 1024
 s_add_u32 s43, s44, 1581056
 buffer_load_dwordx4 v12, s[8:11], s43 offen  lds
 s_add_u32 m0, s45, 2048
 s_add_u32 s43, s44, 1589248
 buffer_load_dwordx4 v12, s[8:11], s43 offen  lds
 s_add_u32 m0, s45, 3072
 s_add_u32 s43, s44, 1597440
 buffer_load_dwordx4 v12, s[8:11], s43 offen  lds
 s_add_u32 m0, s45, 4096
 s_add_u32 s43, s44, 1605632
 buffer_load_dwordx4 v12, s[8:11], s43 offen  lds
 s_add_u32 m0, s45, 5120
 s_add_u32 s43, s44, 1613824
 buffer_load_dwordx4 v12, s[8:11], s43 offen  lds
 s_add_u32 m0, s45, 6144
 s_add_u32 s43, s44, 1622016
 buffer_load_dwordx4 v12, s[8:11], s43 offen  lds
 s_add_u32 m0, s45, 7168
 s_add_u32 s43, s44, 1630208
 buffer_load_dwordx4 v12, s[8:11], s43 offen  lds
 buffer_load_dword v14, v4, s[36:39], s46 offen
 s_add_u32 s46, s46, 1048576
 s_mov_b32 s95, 0
L_rOb_cv1:
 ds_read_b64 v[136:137], v65 offset:2048
 ds_read_b64 v[138:139], v65 offset:2056
 ds_read_b128 v[144:147], v67 offset:2560
 ds_read_b128 v[148:151], v68 offset:0
 ds_read_b64 v[140:141], v65 offset:0
 ds_read_b64 v[142:143], v65 offset:8
 s_waitcnt lgkmcnt(6)
 v_mfma_f32_32x32x16_bf16 v[104:119], v[120:123], v[128:131], v[104:119]
 v_subrev_u32 v65, 64, v65
 v_subrev_u32 v67, 80, v67
 v_max_i32 v68, s93, v67
 v_mfma_f32_32x32x16_bf16 v[88:103], v[120:123], v[132:135], v[88:103]
 v_mfma_f32_32x32x16_bf16 v[104:119], v[124:127], v[132:135], v[104:119]
 ds_read_b64 v[120:121], v65 offset:2080
 ds_read_b64 v[122:123], v65 offset:2088
 ds_read_b128 v[128:131], v67 offset:2592
 ds_read_b128 v[132:135], v68 offset:32
 ds_read_b64 v[124:125], v65 offset:32
 ds_read_b64 v[126:127], v65 offset:40
 s_waitcnt lgkmcnt(6)
 v_mfma_f32_32x32x16_bf16 v[104:119], v[136:139], v[144:147], v[104:119]
 s_add_u32 s95, s95, 1
 s_cmp_lt_u32 s95, 8
 v_mfma_f32_32x32x16_bf16 v[88:103], v[136:139], v[148:151], v[88:103]
 v_mfma_f32_32x32x16_bf16 v[104:119], v[140:143], v[148:151], v[104:119]
 s_cbranch_scc1 L_rOb_cv1
 s_waitcnt vmcnt(9)
 s_barrier
 ds_read_b64_tr_b16 a[160:161], v13 offset:32768
 ds_read_b64_tr_b16 a[162:163], v13 offset:33792
 ds_read_b64_tr_b16 a[164:165], v13 offset:36864
 ds_read_b64_tr_b16 a[166:167], v13 offset:37888
 ds_read_b64_tr_b16 a[168:169], v13 offset:40960
 ds_read_b64_tr_b16 a[170:171], v13 offset:41984
 ds_read_b64_tr_b16 a[172:173], v13 offset:45056
 ds_read_b64_tr_b16 a[174:175], v13 offset:46080
 s_waitcnt lgkmcnt(0)
 ds_read_b64_tr_b16 a[176:177], v13 offset:49152
 ds_read_b64_tr_b16 a[178:179], v13 offset:50176
 ds_read_b64_tr_b16 a[180:181], v13 offset:53248
 ds_read_b64_tr_b16 a[182:183], v13 offset:54272
 ds_read_b64_tr_b16 a[184:185], v13 offset:57344
 ds_read_b64_tr_b16 a[186:187], v13 offset:58368
 ds_read_b64_tr_b16 a[188:189], v13 offset:61440
 ds_read_b64_tr_b16 a[190:191], v13 offset:62464
 s_waitcnt lgkmcnt(0)
 s_barrier
 s_add_u32 m0, s45, 32768
 s_add_u32 s43, s44, 1835008
 buffer_load_dwordx4 v12, s[8:11], s43 offen  lds
 s_add_u32 m0, s45, 33792
 s_add_u32 s43, s44, 1843200
 buffer_load_dwordx4 v12, s[8:11], s43 offen  lds
 s_add_u32 m0, s45, 34816
 s_add_u32 s43, s44, 1851392
 buffer_load_dwordx4 v12, s[8:11], s43 offen  lds
 s_add_u32 m0, s45, 35840
 s_add_u32 s43, s44, 1859584
 buffer_load_dwordx4 v12, s[8:11], s43 offen  lds
 s_add_u32 m0, s45, 36864
 s_add_u32 s43, s44, 1867776
 buffer_load_dwordx4 v12, s[8:11], s43 offen  lds
 s_add_u32 m0, s45, 37888
 s_add_u32 s43, s44, 1875968
 buffer_load_dwordx4 v12, s[8:11], s43 offen  lds
 s_add_u32 m0, s45, 38912
 s_add_u32 s43, s44, 1884160
 buffer_load_dwordx4 v12, s[8:11], s43 offen  lds
 s_add_u32 m0, s45, 39936
 s_add_u32 s43, s44, 1892352
 buffer_load_dwordx4 v12, s[8:11], s43 offen  lds
 s_mov_b32 s95, 0
L_rOb_cv2:
 ds_read_b64 v[136:137], v65 offset:2048
 ds_read_b64 v[138:139], v65 offset:2056
 ds_read_b128 v[144:147], v67 offset:2560
 ds_read_b128 v[148:151], v68 offset:0
 ds_read_b64 v[140:141], v65 offset:0
 ds_read_b64 v[142:143], v65 offset:8
 s_waitcnt lgkmcnt(6)
 v_mfma_f32_32x32x16_bf16 v[104:119], v[120:123], v[128:131], v[104:119]
 v_subrev_u32 v65, 64, v65
 v_subrev_u32 v67, 80, v67
 v_max_i32 v68, s93, v67
 v_mfma_f32_32x32x16_bf16 v[88:103], v[120:123], v[132:135], v[88:103]
 v_mfma_f32_32x32x16_bf16 v[104:119], v[124:127], v[132:135], v[104:119]
 ds_read_b64 v[120:121], v65 offset:2080
 ds_read_b64 v[122:123], v65 offset:2088
 ds_read_b128 v[128:131], v67 offset:2592
 ds_read_b128 v[132:135], v68 offset:32
 ds_read_b64 v[124:125], v65 offset:32
 ds_read_b64 v[126:127], v65 offset:40
 s_waitcnt lgkmcnt(6)
 v_mfma_f32_32x32x16_bf16 v[104:119], v[136:139], v[144:147], v[104:119]
 s_add_u32 s95, s95, 1
 s_cmp_lt_u32 s95, 8
 v_mfma_f32_32x32x16_bf16 v[88:103], v[136:139], v[148:151], v[88:103]
 v_mfma_f32_32x32x16_bf16 v[104:119], v[140:143], v[148:151], v[104:119]
 s_cbranch_scc1 L_rOb_cv2
 s_waitcnt vmcnt(9)
 s_barrier
 ds_read_b64_tr_b16 a[192:193], v13 offset:0
 ds_read_b64_tr_b16 a[194:195], v13 offset:1024
 ds_read_b64_tr_b16 a[196:197], v13 offset:4096
 ds_read_b64_tr_b16 a[198:199], v13 offset:5120
 ds_read_b64_tr_b16 a[200:201], v13 offset:8192
 ds_read_b64_tr_b16 a[202:203], v13 offset:9216
 ds_read_b64_tr_b16 a[204:205], v13 offset:12288
 ds_read_b64_tr_b16 a[206:207], v13 offset:13312
 s_waitcnt lgkmcnt(0)
 ds_read_b64_tr_b16 a[208:209], v13 offset:16384
 ds_read_b64_tr_b16 a[210:211], v13 offset:17408
 ds_read_b64_tr_b16 a[212:213], v13 offset:20480
 ds_read_b64_tr_b16 a[214:215], v13 offset:21504
 ds_read_b64_tr_b16 a[216:217], v13 offset:24576
 ds_read_b64_tr_b16 a[218:219], v13 offset:25600
 ds_read_b64_tr_b16 a[220:221], v13 offset:28672
 ds_read_b64_tr_b16 a[222:223], v13 offset:29696
 s_waitcnt lgkmcnt(0)
 buffer_load_dword v14, v4, s[36:39], s46 offen
 s_add_u32 s46, s46, 1048576
 s_mov_b32 s95, 0
L_rOb_cv3:
 ds_read_b64 v[136:137], v65 offset:2048
 ds_read_b64 v[138:139], v65 offset:2056
 ds_read_b128 v[144:147], v67 offset:2560
 ds_read_b128 v[148:151], v68 offset:0
 ds_read_b64 v[140:141], v65 offset:0
 ds_read_b64 v[142:143], v65 offset:8
 s_waitcnt lgkmcnt(6)
 v_mfma_f32_32x32x16_bf16 v[104:119], v[120:123], v[128:131], v[104:119]
 v_subrev_u32 v65, 64, v65
 v_subrev_u32 v67, 80, v67
 v_max_i32 v68, s93, v67
 v_mfma_f32_32x32x16_bf16 v[88:103], v[120:123], v[132:135], v[88:103]
 v_mfma_f32_32x32x16_bf16 v[104:119], v[124:127], v[132:135], v[104:119]
 ds_read_b64 v[120:121], v65 offset:2080
 ds_read_b64 v[122:123], v65 offset:2088
 ds_read_b128 v[128:131], v67 offset:2592
 ds_read_b128 v[132:135], v68 offset:32
 ds_read_b64 v[124:125], v65 offset:32
 ds_read_b64 v[126:127], v65 offset:40
 s_waitcnt lgkmcnt(6)
 v_mfma_f32_32x32x16_bf16 v[104:119], v[136:139], v[144:147], v[104:119]
 s_add_u32 s95, s95, 1
 s_cmp_lt_u32 s95, 8
 v_mfma_f32_32x32x16_bf16 v[88:103], v[136:139], v[148:151], v[88:103]
 v_mfma_f32_32x32x16_bf16 v[104:119], v[140:143], v[148:151], v[104:119]
 s_cbranch_scc1 L_rOb_cv3
 s_waitcnt vmcnt(1)
 s_barrier
 ds_read_b64_tr_b16 a[224:225], v13 offset:32768
 ds_read_b64_tr_b16 a[226:227], v13 offset:33792
 ds_read_b64_tr_b16 a[228:229], v13 offset:36864
 ds_read_b64_tr_b16 a[230:231], v13 offset:37888
 ds_read_b64_tr_b16 a[232:233], v13 offset:40960
 ds_read_b64_tr_b16 a[234:235], v13 offset:41984
 ds_read_b64_tr_b16 a[236:237], v13 offset:45056
 ds_read_b64_tr_b16 a[238:239], v13 offset:46080
 s_waitcnt lgkmcnt(0)
 ds_read_b64_tr_b16 a[240:241], v13 offset:49152
 ds_read_b64_tr_b16 a[242:243], v13 offset:50176
 ds_read_b64_tr_b16 a[244:245], v13 offset:53248
 ds_read_b64_tr_b16 a[246:247], v13 offset:54272
 ds_read_b64_tr_b16 a[248:249], v13 offset:57344
 ds_read_b64_tr_b16 a[250:251], v13 offset:58368
 ds_read_b64_tr_b16 a[252:253], v13 offset:61440
 ds_read_b64_tr_b16 a[254:255], v13 offset:62464
 s_waitcnt lgkmcnt(0)
 s_load_dwordx2 s[84:85], s[0:1], 128
 s_mov_b32 s86, 8388608
 s_mov_b32 s87, 0x20000
 s_lshl_b32 s90, s89, 16
 s_and_b32 s91, s89, s98
 s_and_b32 s89, s88, s98
 s_lshl_b32 s88, s88, 16
 v_lshlrev_b32 v70, 1, v70
 s_lshl_b32 s93, s28, 3
 s_add_u32 s93, s93, 2048
 s_waitcnt lgkmcnt(0)
 s_nop 1
 v_cvt_pk_bf16_f32 v152, v88, v89
 v_cvt_pk_bf16_f32 v153, v90, v91
 v_cvt_pk_bf16_f32 v154, v92, v93
 v_cvt_pk_bf16_f32 v155, v94, v95
 v_cvt_pk_bf16_f32 v156, v96, v97
 v_cvt_pk_bf16_f32 v157, v98, v99
 v_cvt_pk_bf16_f32 v158, v100, v101
 v_cvt_pk_bf16_f32 v159, v102, v103
 ds_write_b128 v214, v[152:155] offset:0
 ds_write_b128 v214, v[156:159] offset:32
 v_cvt_pk_bf16_f32 v160, v104, v105
 v_cvt_pk_bf16_f32 v161, v106, v107
 v_cvt_pk_bf16_f32 v162, v108, v109
 v_cvt_pk_bf16_f32 v163, v110, v111
 v_cvt_pk_bf16_f32 v164, v112, v113
 v_cvt_pk_bf16_f32 v165, v114, v115
 v_cvt_pk_bf16_f32 v166, v116, v117
 v_cvt_pk_bf16_f32 v167, v118, v119
 ds_write_b128 v214, v[160:163] offset:2560
 ds_write_b128 v214, v[164:167] offset:2592
 s_waitcnt lgkmcnt(0)
 s_barrier
 ds_read_b128 v[88:91], v69 offset:0
 ds_read_b128 v[92:95], v69 offset:21888
 ds_read_b128 v[96:99], v215 offset:0
 ds_read_b128 v[100:103], v215 offset:21888
 v_lshlrev_b32 v104, 16, v72
 v_and_b32 v105, s98, v72
 v_pk_mul_f32 v[104:105], v[104:105], s[88:89]
 v_cvt_pk_bf16_f32 v72, v104, v105
 v_lshlrev_b32 v104, 16, v72
 v_and_b32 v105, s98, v72
 v_lshlrev_b32 v106, 16, v73
 v_and_b32 v107, s98, v73
 v_pk_mul_f32 v[106:107], v[106:107], s[90:91]
 v_cvt_pk_bf16_f32 v73, v106, v107
 v_lshlrev_b32 v106, 16, v73
 v_and_b32 v107, s98, v73
 v_lshlrev_b32 v108, 16, v74
 v_and_b32 v109, s98, v74
 v_pk_mul_f32 v[108:109], v[108:109], s[88:89]
 v_cvt_pk_bf16_f32 v74, v108, v109
 v_lshlrev_b32 v108, 16, v74
 v_and_b32 v109, s98, v74
 v_lshlrev_b32 v110, 16, v75
 v_and_b32 v111, s98, v75
 v_pk_mul_f32 v[110:111], v[110:111], s[90:91]
 v_cvt_pk_bf16_f32 v75, v110, v111
 v_lshlrev_b32 v110, 16, v75
 v_and_b32 v111, s98, v75
 v_lshlrev_b32 v112, 16, v76
 v_and_b32 v113, s98, v76
 v_pk_mul_f32 v[112:113], v[112:113], s[88:89]
 v_cvt_pk_bf16_f32 v76, v112, v113
 v_lshlrev_b32 v112, 16, v76
 v_and_b32 v113, s98, v76
 v_lshlrev_b32 v114, 16, v77
 v_and_b32 v115, s98, v77
 v_pk_mul_f32 v[114:115], v[114:115], s[90:91]
 v_cvt_pk_bf16_f32 v77, v114, v115
 v_lshlrev_b32 v114, 16, v77
 v_and_b32 v115, s98, v77
 v_lshlrev_b32 v116, 16, v78
 v_and_b32 v117, s98, v78
 v_pk_mul_f32 v[116:117], v[116:117], s[88:89]
 v_cvt_pk_bf16_f32 v78, v116, v117
 v_lshlrev_b32 v116, 16, v78
 v_and_b32 v117, s98, v78
 v_lshlrev_b32 v118, 16, v79
 v_and_b32 v119, s98, v79
 v_pk_mul_f32 v[118:119], v[118:119], s[90:91]
 v_cvt_pk_bf16_f32 v79, v118, v119
 v_lshlrev_b32 v118, 16, v79
 v_and_b32 v119, s98, v79
 v_lshlrev_b32 v120, 16, v80
 v_and_b32 v121, s98, v80
 v_pk_mul_f32 v[120:121], v[120:121], s[88:89]
 v_cvt_pk_bf16_f32 v80, v120, v121
 v_lshlrev_b32 v120, 16, v80
 v_and_b32 v121, s98, v80
 v_lshlrev_b32 v122, 16, v81
 v_and_b32 v123, s98, v81
 v_pk_mul_f32 v[122:123], v[122:123], s[90:91]
 v_cvt_pk_bf16_f32 v81, v122, v123
 v_lshlrev_b32 v122, 16, v81
 v_and_b32 v123, s98, v81
 v_lshlrev_b32 v124, 16, v82
 v_and_b32 v125, s98, v82
 v_pk_mul_f32 v[124:125], v[124:125], s[88:89]
 v_cvt_pk_bf16_f32 v82, v124, v125
 v_lshlrev_b32 v124, 16, v82
 v_and_b32 v125, s98, v82
 v_lshlrev_b32 v126, 16, v83
 v_and_b32 v127, s98, v83
 v_pk_mul_f32 v[126:127], v[126:127], s[90:91]
 v_cvt_pk_bf16_f32 v83, v126, v127
 v_lshlrev_b32 v126, 16, v83
 v_and_b32 v127, s98, v83
 v_lshlrev_b32 v128, 16, v84
 v_and_b32 v129, s98, v84
 v_pk_mul_f32 v[128:129], v[128:129], s[88:89]
 v_cvt_pk_bf16_f32 v84, v128, v129
 v_lshlrev_b32 v128, 16, v84
 v_and_b32 v129, s98, v84
 v_lshlrev_b32 v130, 16, v85
 v_and_b32 v131, s98, v85
 v_pk_mul_f32 v[130:131], v[130:131], s[90:91]
 v_cvt_pk_bf16_f32 v85, v130, v131
 v_lshlrev_b32 v130, 16, v85
 v_and_b32 v131, s98, v85
 v_lshlrev_b32 v132, 16, v86
 v_and_b32 v133, s98, v86
 v_pk_mul_f32 v[132:133], v[132:133], s[88:89]
 v_cvt_pk_bf16_f32 v86, v132, v133
 v_lshlrev_b32 v132, 16, v86
 v_and_b32 v133, s98, v86
 v_lshlrev_b32 v134, 16, v87
 v_and_b32 v135, s98, v87
 v_pk_mul_f32 v[134:135], v[134:135], s[90:91]
 v_cvt_pk_bf16_f32 v87, v134, v135
 v_lshlrev_b32 v134, 16, v87
 v_and_b32 v135, s98, v87
 s_waitcnt lgkmcnt(0)
 v_lshlrev_b32 v136, 16, v88
 v_lshlrev_b32 v137, 16, v92
 v_lshlrev_b32 v138, 16, v96
 v_lshlrev_b32 v139, 16, v100
 v_pk_add_f32 v[104:105], v[104:105], v[136:137]
 v_cvt_pk_bf16_f32 v72, v104, v105
 v_pk_add_f32 v[106:107], v[106:107], v[138:139]
 v_cvt_pk_bf16_f32 v73, v106, v107
 buffer_store_dwordx2 v[72:73], v70, s[84:87], s93 offen
 s_add_u32 s93, s93, 4096
 v_and_b32 v136, s98, v88
 v_and_b32 v137, s98, v92
 v_and_b32 v138, s98, v96
 v_and_b32 v139, s98, v100
 v_pk_add_f32 v[108:109], v[108:109], v[136:137]
 v_cvt_pk_bf16_f32 v74, v108, v109
 v_pk_add_f32 v[110:111], v[110:111], v[138:139]
 v_cvt_pk_bf16_f32 v75, v110, v111
 buffer_store_dwordx2 v[74:75], v70, s[84:87], s93 offen
 s_add_u32 s93, s93, 4096
 v_lshlrev_b32 v136, 16, v89
 v_lshlrev_b32 v137, 16, v93
 v_lshlrev_b32 v138, 16, v97
 v_lshlrev_b32 v139, 16, v101
 v_pk_add_f32 v[112:113], v[112:113], v[136:137]
 v_cvt_pk_bf16_f32 v76, v112, v113
 v_pk_add_f32 v[114:115], v[114:115], v[138:139]
 v_cvt_pk_bf16_f32 v77, v114, v115
 buffer_store_dwordx2 v[76:77], v70, s[84:87], s93 offen
 s_add_u32 s93, s93, 4096
 v_and_b32 v136, s98, v89
 v_and_b32 v137, s98, v93
 v_and_b32 v138, s98, v97
 v_and_b32 v139, s98, v101
 v_pk_add_f32 v[116:117], v[116:117], v[136:137]
 v_cvt_pk_bf16_f32 v78, v116, v117
 v_pk_add_f32 v[118:119], v[118:119], v[138:139]
 v_cvt_pk_bf16_f32 v79, v118, v119
 buffer_store_dwordx2 v[78:79], v70, s[84:87], s93 offen
 s_add_u32 s93, s93, 4096
 v_lshlrev_b32 v136, 16, v90
 v_lshlrev_b32 v137, 16, v94
 v_lshlrev_b32 v138, 16, v98
 v_lshlrev_b32 v139, 16, v102
 v_pk_add_f32 v[120:121], v[120:121], v[136:137]
 v_cvt_pk_bf16_f32 v80, v120, v121
 v_pk_add_f32 v[122:123], v[122:123], v[138:139]
 v_cvt_pk_bf16_f32 v81, v122, v123
 buffer_store_dwordx2 v[80:81], v70, s[84:87], s93 offen
 s_add_u32 s93, s93, 4096
 v_and_b32 v136, s98, v90
 v_and_b32 v137, s98, v94
 v_and_b32 v138, s98, v98
 v_and_b32 v139, s98, v102
 v_pk_add_f32 v[124:125], v[124:125], v[136:137]
 v_cvt_pk_bf16_f32 v82, v124, v125
 v_pk_add_f32 v[126:127], v[126:127], v[138:139]
 v_cvt_pk_bf16_f32 v83, v126, v127
 buffer_store_dwordx2 v[82:83], v70, s[84:87], s93 offen
 s_add_u32 s93, s93, 4096
 v_lshlrev_b32 v136, 16, v91
 v_lshlrev_b32 v137, 16, v95
 v_lshlrev_b32 v138, 16, v99
 v_lshlrev_b32 v139, 16, v103
 v_pk_add_f32 v[128:129], v[128:129], v[136:137]
 v_cvt_pk_bf16_f32 v84, v128, v129
 v_pk_add_f32 v[130:131], v[130:131], v[138:139]
 v_cvt_pk_bf16_f32 v85, v130, v131
 buffer_store_dwordx2 v[84:85], v70, s[84:87], s93 offen
 s_add_u32 s93, s93, 4096
 v_and_b32 v136, s98, v91
 v_and_b32 v137, s98, v95
 v_and_b32 v138, s98, v99
 v_and_b32 v139, s98, v103
 v_pk_add_f32 v[132:133], v[132:133], v[136:137]
 v_cvt_pk_bf16_f32 v86, v132, v133
 v_pk_add_f32 v[134:135], v[134:135], v[138:139]
 v_cvt_pk_bf16_f32 v87, v134, v135
 buffer_store_dwordx2 v[86:87], v70, s[84:87], s93 offen
 s_add_u32 s93, s93, 4096
 s_barrier
 s_mov_b32 s3, 0
L_rdy_11:
 buffer_load_dwordx4 v[84:87], off, s[12:15], s30 sc1
 s_add_u32 s3, s3, 1
 s_cmp_gt_u32 s3, 400000
 s_cbranch_scc1 L_exit
 s_waitcnt vmcnt(0)
 v_readfirstlane_b32 s32, v84
 v_readfirstlane_b32 s33, v85
 v_readfirstlane_b32 vcc_hi, v86
 s_and_b32 vcc_lo, s32, 0xffff
 s_cmp_lt_u32 vcc_lo, 256
 s_cbranch_scc1 L_rdy_11
 s_cmp_lg_u32 vcc_hi, 0
 s_cbranch_scc1 L_general
 s_load_dwordx2 s[8:9], s[0:1], 128
 s_mov_b32 s10, 8388608
 s_mov_b32 s11, 0x20000
 s_mov_b32 s36, s4
 s_mov_b32 s37, s5
 s_mov_b32 s38, s6
 s_mov_b32 s39, s7
 s_lshr_b32 s41, s25, 3
 s_lshl_b32 s41, s41, 2
 s_add_u32 s41, s41, s26
 s_lshl_b32 s44, s41, 14
 s_add_u32 s44, s44, 67108864
 s_lshl_b32 s47, s41, 3
 s_add_u32 s47, s47, 3760128
 s_lshl_b32 s45, s26, 14
 s_waitcnt lgkmcnt(0)
 v_mov_b32 v15, 0
 v_and_b32 v255, 1, v1
 v_lshlrev_b32 v255, 2, v255
 s_mov_b32 s56, 0
 s_mov_b32 s57, 0
 s_mov_b32 s58, 0
 s_mov_b32 s59, 0
 s_mov_b32 s60, 0
 s_mov_b32 s61, 0
 s_mov_b32 s62, 0
 s_mov_b32 s63, 0
 s_mov_b32 s64, 0
 s_mov_b32 s65, 0
 s_mov_b32 s66, 0
 s_mov_b32 s67, 0
 s_mov_b32 s68, 0
 s_mov_b32 s69, 0
 s_mov_b32 s70, 0
 s_mov_b32 s71, 0
 s_mov_b32 s40, 0
 s_and_b32 s41, s25, 7
 s_lshl_b32 s41, s41, 2
 s_add_u32 s41, s41, s26
 s_lshl_b32 s46, s41, 14
 s_lshl_b32 s54, s41, 6
 s_lshr_b32 s41, s25, 3
 s_xor_b32 s42, s41, 1
 s_lshl_b32 s42, s42, 12
 s_add_u32 s42, s42, s46
 s_add_u32 s64, s42, 1159201792
 s_xor_b32 s42, s41, 2
 s_lshl_b32 s42, s42, 12
 s_add_u32 s42, s42, s46
 s_add_u32 s65, s42, 1159202816
 s_xor_b32 s42, s41, 3
 s_lshl_b32 s42, s42, 12
 s_add_u32 s42, s42, s46
 s_add_u32 s66, s42, 1159203840
 s_lshl_b32 s42, s41, 12
 s_add_u32 s42, s42, s46
 s_add_u32 s53, s42, 84934656
 s_lshl_b32 s42, s41, 4
 s_add_u32 s54, s54, s42
 s_add_u32 s54, s54, 1073348608
 v_and_b32 v3, 31, v1
 v_lshrrev_b32 v4, 5, v1
 v_lshlrev_b32 v14, 12, v3
 v_lshl_add_u32 v14, v4, 3, v14
L_rO_first:
 v_cmp_ge_u32 vcc, 0, v15
 s_and_b32 vcc_lo, vcc_lo, 0x3
 s_cbranch_scc0 L_rO_firstok
 buffer_load_dword v15, v255, s[4:7], s47 offen sc1
 s_add_u32 s48, s48, 1
 s_cmp_gt_u32 s48, 400000
 s_cbranch_scc1 L_done
 s_waitcnt vmcnt(0)
 s_branch L_rO_first
L_rO_firstok:
 s_add_u32 s47, s47, 128
 buffer_load_dword v15, v255, s[4:7], s47 offen sc1
 s_add_u32 m0, s45, 0
 s_add_u32 s43, s44, 0
 buffer_load_dwordx4 v2, s[36:39], s43 offen offset:0 sc1 lds
 buffer_load_dwordx4 v2, s[36:39], s43 offen offset:1024 sc1 lds
 buffer_load_dwordx4 v2, s[36:39], s43 offen offset:2048 sc1 lds
 buffer_load_dwordx4 v2, s[36:39], s43 offen offset:3072 sc1 lds
 s_add_u32 m0, s45, 4096
 s_add_u32 s43, s44, 4096
 buffer_load_dwordx4 v2, s[36:39], s43 offen offset:0 sc1 lds
 buffer_load_dwordx4 v2, s[36:39], s43 offen offset:1024 sc1 lds
 buffer_load_dwordx4 v2, s[36:39], s43 offen offset:2048 sc1 lds
 buffer_load_dwordx4 v2, s[36:39], s43 offen offset:3072 sc1 lds
 s_add_u32 m0, s45, 8192
 s_add_u32 s43, s44, 8192
 buffer_load_dwordx4 v2, s[36:39], s43 offen offset:0 sc1 lds
 buffer_load_dwordx4 v2, s[36:39], s43 offen offset:1024 sc1 lds
 buffer_load_dwordx4 v2, s[36:39], s43 offen offset:2048 sc1 lds
 buffer_load_dwordx4 v2, s[36:39], s43 offen offset:3072 sc1 lds
 s_add_u32 m0, s45, 12288
 s_add_u32 s43, s44, 12288
 buffer_load_dwordx4 v2, s[36:39], s43 offen offset:0 sc1 lds
 buffer_load_dwordx4 v2, s[36:39], s43 offen offset:1024 sc1 lds
 buffer_load_dwordx4 v2, s[36:39], s43 offen offset:2048 sc1 lds
 buffer_load_dwordx4 v2, s[36:39], s43 offen offset:3072 sc1 lds
 s_waitcnt vmcnt(0)
 s_barrier
 ds_read_b128 v[16:19], v10 offset:0
 ds_read_b128 v[20:23], v10 offset:1024
 ds_read_b128 v[24:27], v10 offset:2048
 ds_read_b128 v[28:31], v10 offset:3072
 ds_read_b128 v[32:35], v10 offset:4096
 ds_read_b128 v[36:39], v10 offset:5120
L_rO_loop:
 s_waitcnt lgkmcnt(5)
 v_mfma_f32_32x32x16_bf16 v[48:63], a[0:3], v[16:19], 0
 ds_read_b128 v[40:43], v10 offset:6144
 s_add_u32 s44, s44, 0x40000
 s_add_u32 s42, s40, 1
 v_cmp_ge_u32 vcc, s42, v15
 s_waitcnt lgkmcnt(5)
 v_mfma_f32_32x32x16_bf16 v[48:63], a[4:7], v[20:23], v[48:63]
 ds_read_b128 v[44:47], v10 offset:7168
 s_and_b32 vcc_lo, vcc_lo, 0x3
 s_cselect_b32 s50, 0, 1
 s_cselect_b32 s51, 1073741824, s44
 s_waitcnt lgkmcnt(5)
 v_mfma_f32_32x32x16_bf16 v[48:63], a[8:11], v[24:27], v[48:63]
 ds_read_b128 v[16:19], v10 offset:8192
 s_add_u32 m0, s45, 65536
 s_add_u32 s43, s51, 0
 buffer_load_dwordx4 v2, s[36:39], s43 offen offset:0 sc1 lds
 s_waitcnt lgkmcnt(5)
 v_mfma_f32_32x32x16_bf16 v[48:63], a[12:15], v[28:31], v[48:63]
 ds_read_b128 v[20:23], v10 offset:9216
 s_waitcnt lgkmcnt(5)
 v_mfma_f32_32x32x16_bf16 v[48:63], a[16:19], v[32:35], v[48:63]
 ds_read_b128 v[24:27], v10 offset:10240
 buffer_load_dwordx4 v2, s[36:39], s43 offen offset:1024 sc1 lds
 s_waitcnt lgkmcnt(5)
 v_mfma_f32_32x32x16_bf16 v[48:63], a[20:23], v[36:39], v[48:63]
 ds_read_b128 v[28:31], v10 offset:11264
 s_waitcnt lgkmcnt(5)
 v_mfma_f32_32x32x16_bf16 v[48:63], a[24:27], v[40:43], v[48:63]
 ds_read_b128 v[32:35], v10 offset:12288
 buffer_store_dwordx4 v[68:71], v2, s[4:7], s64 offen sc1
 s_add_u32 s64, s64, 524288
 s_bitset0_b32 s64, 30
 s_waitcnt lgkmcnt(5)
 v_mfma_f32_32x32x16_bf16 v[48:63], a[28:31], v[44:47], v[48:63]
 ds_read_b128 v[36:39], v10 offset:13312
 buffer_load_dwordx4 v2, s[36:39], s43 offen offset:2048 sc1 lds
 s_waitcnt lgkmcnt(5)
 v_mfma_f32_32x32x16_bf16 v[48:63], a[32:35], v[16:19], v[48:63]
 ds_read_b128 v[40:43], v10 offset:14336
 s_waitcnt lgkmcnt(5)
 v_mfma_f32_32x32x16_bf16 v[48:63], a[36:39], v[20:23], v[48:63]
 ds_read_b128 v[44:47], v10 offset:15360
 buffer_load_dwordx4 v2, s[36:39], s43 offen offset:3072 sc1 lds
 s_waitcnt lgkmcnt(5)
 v_mfma_f32_32x32x16_bf16 v[48:63], a[40:43], v[24:27], v[48:63]
 ds_read_b128 v[16:19], v10 offset:16384
 s_waitcnt lgkmcnt(5)
 v_mfma_f32_32x32x16_bf16 v[48:63], a[44:47], v[28:31], v[48:63]
 ds_read_b128 v[20:23], v10 offset:17408
 buffer_store_dwordx4 v[72:75], v2, s[4:7], s65 offen sc1
 s_add_u32 s65, s65, 524288
 s_bitset0_b32 s65, 30
 s_waitcnt lgkmcnt(5)
 v_mfma_f32_32x32x16_bf16 v[48:63], a[48:51], v[32:35], v[48:63]
 ds_read_b128 v[24:27], v10 offset:18432
 s_add_u32 m0, s45, 69632
 s_add_u32 s43, s51, 4096
 buffer_load_dwordx4 v2, s[36:39], s43 offen offset:0 sc1 lds
 s_waitcnt lgkmcnt(5)
 v_mfma_f32_32x32x16_bf16 v[48:63], a[52:55], v[36:39], v[48:63]
 ds_read_b128 v[28:31], v10 offset:19456
 s_waitcnt lgkmcnt(5)
 v_mfma_f32_32x32x16_bf16 v[48:63], a[56:59], v[40:43], v[48:63]
 ds_read_b128 v[32:35], v10 offset:20480
 buffer_load_dwordx4 v2, s[36:39], s43 offen offset:1024 sc1 lds
 s_waitcnt lgkmcnt(5)
 v_mfma_f32_32x32x16_bf16 v[48:63], a[60:63], v[44:47], v[48:63]
 ds_read_b128 v[36:39], v10 offset:21504
 s_waitcnt lgkmcnt(5)
 v_mfma_f32_32x32x16_bf16 v[48:63], a[64:67], v[16:19], v[48:63]
 ds_read_b128 v[40:43], v10 offset:22528
 buffer_store_dwordx4 v[76:79], v2, s[4:7], s66 offen sc1
 s_add_u32 s66, s66, 524288
 s_bitset0_b32 s66, 30
 s_waitcnt lgkmcnt(5)
 v_mfma_f32_32x32x16_bf16 v[48:63], a[68:71], v[20:23], v[48:63]
 ds_read_b128 v[44:47], v10 offset:23552
 buffer_load_dwordx4 v2, s[36:39], s43 offen offset:2048 sc1 lds
 s_waitcnt lgkmcnt(5)
 v_mfma_f32_32x32x16_bf16 v[48:63], a[72:75], v[24:27], v[48:63]
 ds_read_b128 v[16:19], v10 offset:24576
 s_waitcnt vmcnt(10)
 v_pk_add_f32 v[92:93], v[92:93], v[96:97]
 v_pk_add_f32 v[94:95], v[94:95], v[98:99]
 v_pk_add_f32 v[92:93], v[92:93], v[100:101]
 s_waitcnt lgkmcnt(5)
 v_mfma_f32_32x32x16_bf16 v[48:63], a[76:79], v[28:31], v[48:63]
 ds_read_b128 v[20:23], v10 offset:25600
 buffer_load_dwordx4 v2, s[36:39], s43 offen offset:3072 sc1 lds
 s_waitcnt lgkmcnt(5)
 v_mfma_f32_32x32x16_bf16 v[48:63], a[80:83], v[32:35], v[48:63]
 ds_read_b128 v[24:27], v10 offset:26624
 v_pk_add_f32 v[94:95], v[94:95], v[102:103]
 v_pk_add_f32 v[92:93], v[92:93], v[104:105]
 v_pk_add_f32 v[94:95], v[94:95], v[106:107]
 s_waitcnt lgkmcnt(5)
 v_mfma_f32_32x32x16_bf16 v[48:63], a[84:87], v[36:39], v[48:63]
 ds_read_b128 v[28:31], v10 offset:27648
 v_cvt_pk_bf16_f32 v80, v92, v93
 v_cvt_pk_bf16_f32 v81, v94, v95
 s_waitcnt lgkmcnt(5)
 v_mfma_f32_32x32x16_bf16 v[48:63], a[88:91], v[40:43], v[48:63]
 ds_read_b128 v[32:35], v10 offset:28672
 s_add_u32 m0, s45, 73728
 s_add_u32 s43, s51, 8192
 buffer_load_dwordx4 v2, s[36:39], s43 offen offset:0 sc1 lds
 s_waitcnt lgkmcnt(5)
 v_mfma_f32_32x32x16_bf16 v[48:63], a[92:95], v[44:47], v[48:63]
 ds_read_b128 v[36:39], v10 offset:29696
 buffer_store_dwordx2 v[80:81], v14, s[8:11], s54 offen
 s_add_u32 s54, s54, 131072
 s_bitset0_b32 s54, 30
 s_waitcnt lgkmcnt(5)
 v_mfma_f32_32x32x16_bf16 v[48:63], a[96:99], v[16:19], v[48:63]
 ds_read_b128 v[40:43], v10 offset:30720
 buffer_load_dwordx4 v2, s[36:39], s43 offen offset:1024 sc1 lds
 s_waitcnt lgkmcnt(5)
 v_mfma_f32_32x32x16_bf16 v[48:63], a[100:103], v[20:23], v[48:63]
 ds_read_b128 v[44:47], v10 offset:31744
 v_mov_b32 v92, v64
 v_mov_b32 v93, v65
 v_mov_b32 v94, v66
 v_mov_b32 v95, v67
 s_waitcnt lgkmcnt(5)
 v_mfma_f32_32x32x16_bf16 v[48:63], a[104:107], v[24:27], v[48:63]
 ds_read_b128 v[16:19], v10 offset:32768
 s_load_dwordx4 s[60:63], s[4:5], s49 glc
 s_waitcnt lgkmcnt(5)
 v_mfma_f32_32x32x16_bf16 v[48:63], a[108:111], v[28:31], v[48:63]
 ds_read_b128 v[20:23], v10 offset:33792
 buffer_load_dwordx4 v2, s[36:39], s43 offen offset:2048 sc1 lds
 s_waitcnt lgkmcnt(5)
 v_mfma_f32_32x32x16_bf16 v[48:63], a[112:115], v[32:35], v[48:63]
 ds_read_b128 v[24:27], v10 offset:34816
 s_waitcnt lgkmcnt(5)
 v_mfma_f32_32x32x16_bf16 v[48:63], a[116:119], v[36:39], v[48:63]
 ds_read_b128 v[28:31], v10 offset:35840
 buffer_load_dwordx4 v2, s[36:39], s43 offen offset:3072 sc1 lds
 s_waitcnt lgkmcnt(5)
 v_mfma_f32_32x32x16_bf16 v[48:63], a[120:123], v[40:43], v[48:63]
 ds_read_b128 v[32:35], v10 offset:36864
 s_waitcnt lgkmcnt(5)
 v_mfma_f32_32x32x16_bf16 v[48:63], a[124:127], v[44:47], v[48:63]
 ds_read_b128 v[36:39], v10 offset:37888
 s_waitcnt lgkmcnt(5)
 v_mfma_f32_32x32x16_bf16 v[48:63], a[128:131], v[16:19], v[48:63]
 ds_read_b128 v[40:43], v10 offset:38912
 s_add_u32 m0, s45, 77824
 s_add_u32 s43, s51, 12288
 buffer_load_dwordx4 v2, s[36:39], s43 offen offset:0 sc1 lds
 s_waitcnt lgkmcnt(5)
 v_mfma_f32_32x32x16_bf16 v[48:63], a[132:135], v[20:23], v[48:63]
 ds_read_b128 v[44:47], v10 offset:39936
 s_waitcnt lgkmcnt(5)
 v_mfma_f32_32x32x16_bf16 v[48:63], a[136:139], v[24:27], v[48:63]
 ds_read_b128 v[16:19], v10 offset:40960
 buffer_load_dwordx4 v2, s[36:39], s43 offen offset:1024 sc1 lds
 s_waitcnt lgkmcnt(5)
 v_mfma_f32_32x32x16_bf16 v[48:63], a[140:143], v[28:31], v[48:63]
 ds_read_b128 v[20:23], v10 offset:41984
 s_waitcnt lgkmcnt(5)
 v_mfma_f32_32x32x16_bf16 v[48:63], a[144:147], v[32:35], v[48:63]
 ds_read_b128 v[24:27], v10 offset:43008
 s_waitcnt lgkmcnt(5)
 v_mfma_f32_32x32x16_bf16 v[48:63], a[148:151], v[36:39], v[48:63]
 ds_read_b128 v[28:31], v10 offset:44032
 buffer_load_dwordx4 v2, s[36:39], s43 offen offset:2048 sc1 lds
 s_waitcnt lgkmcnt(5)
 v_mfma_f32_32x32x16_bf16 v[48:63], a[152:155], v[40:43], v[48:63]
 ds_read_b128 v[32:35], v10 offset:45056
 s_waitcnt lgkmcnt(5)
 v_mfma_f32_32x32x16_bf16 v[48:63], a[156:159], v[44:47], v[48:63]
 ds_read_b128 v[36:39], v10 offset:46080
 buffer_load_dwordx4 v2, s[36:39], s43 offen offset:3072 sc1 lds
 s_waitcnt lgkmcnt(5)
 v_mfma_f32_32x32x16_bf16 v[48:63], a[160:163], v[16:19], v[48:63]
 ds_read_b128 v[40:43], v10 offset:47104
 s_lshl_b32 s41, s50, 7
 s_add_u32 s47, s47, s41
 buffer_load_dword v15, v255, s[4:7], s47 offen sc1
 s_waitcnt lgkmcnt(5)
 v_mfma_f32_32x32x16_bf16 v[48:63], a[164:167], v[20:23], v[48:63]
 ds_read_b128 v[44:47], v10 offset:48128
 s_waitcnt lgkmcnt(5)
 v_mfma_f32_32x32x16_bf16 v[48:63], a[168:171], v[24:27], v[48:63]
 ds_read_b128 v[16:19], v10 offset:49152
 s_add_u32 s41, s40, 2
 v_mov_b32 v9, s41
 s_waitcnt vmcnt(12)
 buffer_store_dword v9, v8, s[4:7], 0 offen sc1
 s_waitcnt lgkmcnt(5)
 v_mfma_f32_32x32x16_bf16 v[48:63], a[172:175], v[28:31], v[48:63]
 ds_read_b128 v[20:23], v10 offset:50176
 s_waitcnt lgkmcnt(5)
 v_mfma_f32_32x32x16_bf16 v[48:63], a[176:179], v[32:35], v[48:63]
 ds_read_b128 v[24:27], v10 offset:51200
 s_waitcnt lgkmcnt(5)
 v_mfma_f32_32x32x16_bf16 v[48:63], a[180:183], v[36:39], v[48:63]
 ds_read_b128 v[28:31], v10 offset:52224
 s_waitcnt lgkmcnt(5)
 v_mfma_f32_32x32x16_bf16 v[48:63], a[184:187], v[40:43], v[48:63]
 ds_read_b128 v[32:35], v10 offset:53248
 s_waitcnt lgkmcnt(5)
 v_mfma_f32_32x32x16_bf16 v[48:63], a[188:191], v[44:47], v[48:63]
 ds_read_b128 v[36:39], v10 offset:54272
 s_waitcnt lgkmcnt(5)
 v_mfma_f32_32x32x16_bf16 v[48:63], a[192:195], v[16:19], v[48:63]
 ds_read_b128 v[40:43], v10 offset:55296
 s_waitcnt lgkmcnt(5)
 v_mfma_f32_32x32x16_bf16 v[48:63], a[196:199], v[20:23], v[48:63]
 ds_read_b128 v[44:47], v10 offset:56320
 s_waitcnt lgkmcnt(5)
 v_mfma_f32_32x32x16_bf16 v[48:63], a[200:203], v[24:27], v[48:63]
 ds_read_b128 v[16:19], v10 offset:57344
 s_sub_u32 s52, s40, 0
L_rO_p0:
 s_min_u32 s41, s60, s61
 s_min_u32 s41, s41, s62
 s_min_u32 s41, s41, s63
 s_cmp_gt_u32 s41, s52
 s_cbranch_scc1 L_rO_p0ok
 s_load_dwordx4 s[60:63], s[4:5], s49 glc
 s_add_u32 s48, s48, 1
 s_cmp_gt_u32 s48, 400000
 s_cbranch_scc1 L_done
 s_waitcnt lgkmcnt(0)
 s_branch L_rO_p0
L_rO_p0ok:
 buffer_load_dwordx4 v[96:99], v2, s[4:7], s53 offen offset:1024 sc1
 buffer_load_dwordx4 v[100:103], v2, s[4:7], s53 offen offset:2048 sc1
 buffer_load_dwordx4 v[104:107], v2, s[4:7], s53 offen offset:3072 sc1
 s_add_u32 s53, s53, 524288
 s_waitcnt lgkmcnt(5)
 v_mfma_f32_32x32x16_bf16 v[48:63], a[204:207], v[28:31], v[48:63]
 ds_read_b128 v[20:23], v10 offset:58368
 s_waitcnt lgkmcnt(5)
 v_mfma_f32_32x32x16_bf16 v[48:63], a[208:211], v[32:35], v[48:63]
 ds_read_b128 v[24:27], v10 offset:59392
 s_waitcnt lgkmcnt(5)
 v_mfma_f32_32x32x16_bf16 v[48:63], a[212:215], v[36:39], v[48:63]
 ds_read_b128 v[28:31], v10 offset:60416
 s_waitcnt lgkmcnt(5)
 v_mfma_f32_32x32x16_bf16 v[48:63], a[216:219], v[40:43], v[48:63]
 ds_read_b128 v[32:35], v10 offset:61440
 s_waitcnt lgkmcnt(5)
 v_mfma_f32_32x32x16_bf16 v[48:63], a[220:223], v[44:47], v[48:63]
 ds_read_b128 v[36:39], v10 offset:62464
 s_waitcnt lgkmcnt(5)
 v_mfma_f32_32x32x16_bf16 v[48:63], a[224:227], v[16:19], v[48:63]
 ds_read_b128 v[40:43], v10 offset:63488
 s_waitcnt lgkmcnt(5)
 v_mfma_f32_32x32x16_bf16 v[48:63], a[228:231], v[20:23], v[48:63]
 ds_read_b128 v[44:47], v10 offset:64512
 s_waitcnt lgkmcnt(5)
 v_mfma_f32_32x32x16_bf16 v[48:63], a[232:235], v[24:27], v[48:63]
 s_waitcnt lgkmcnt(4)
 v_mfma_f32_32x32x16_bf16 v[48:63], a[236:239], v[28:31], v[48:63]
 s_waitcnt lgkmcnt(0)
 s_add_u32 s40, s40, 1
 s_cmp_eq_u32 s40, 64
 s_cselect_b32 s50, 1, s50
 s_cmp_eq_u32 s50, 1
 s_cbranch_scc1 L_rO_pre0
L_rO_o0:
 v_cmp_ge_u32 vcc, s40, v15
 s_and_b32 vcc_lo, vcc_lo, 0x3
 s_cbranch_scc0 L_rO_o0ok
 buffer_load_dword v15, v255, s[4:7], s47 offen sc1
 s_add_u32 s48, s48, 1
 s_cmp_gt_u32 s48, 400000
 s_cbranch_scc1 L_done
 s_waitcnt vmcnt(0)
 s_branch L_rO_o0
L_rO_o0ok:
 s_add_u32 m0, s45, 65536
 s_add_u32 s43, s44, 0
 buffer_load_dwordx4 v2, s[36:39], s43 offen offset:0 sc1 lds
 buffer_load_dwordx4 v2, s[36:39], s43 offen offset:1024 sc1 lds
 buffer_load_dwordx4 v2, s[36:39], s43 offen offset:2048 sc1 lds
 buffer_load_dwordx4 v2, s[36:39], s43 offen offset:3072 sc1 lds
 s_add_u32 m0, s45, 69632
 s_add_u32 s43, s44, 4096
 buffer_load_dwordx4 v2, s[36:39], s43 offen offset:0 sc1 lds
 buffer_load_dwordx4 v2, s[36:39], s43 offen offset:1024 sc1 lds
 buffer_load_dwordx4 v2, s[36:39], s43 offen offset:2048 sc1 lds
 buffer_load_dwordx4 v2, s[36:39], s43 offen offset:3072 sc1 lds
 s_add_u32 m0, s45, 73728
 s_add_u32 s43, s44, 8192
 buffer_load_dwordx4 v2, s[36:39], s43 offen offset:0 sc1 lds
 buffer_load_dwordx4 v2, s[36:39], s43 offen offset:1024 sc1 lds
 buffer_load_dwordx4 v2, s[36:39], s43 offen offset:2048 sc1 lds
 buffer_load_dwordx4 v2, s[36:39], s43 offen offset:3072 sc1 lds
 s_add_u32 m0, s45, 77824
 s_add_u32 s43, s44, 12288
 buffer_load_dwordx4 v2, s[36:39], s43 offen offset:0 sc1 lds
 buffer_load_dwordx4 v2, s[36:39], s43 offen offset:1024 sc1 lds
 buffer_load_dwordx4 v2, s[36:39], s43 offen offset:2048 sc1 lds
 buffer_load_dwordx4 v2, s[36:39], s43 offen offset:3072 sc1 lds
 s_add_u32 s47, s47, 128
 buffer_load_dword v15, v255, s[4:7], s47 offen sc1
 s_waitcnt vmcnt(0)
L_rO_pre0:
 s_waitcnt vmcnt(5)
 s_barrier
 ds_read_b128 v[16:19], v11 offset:0
 ds_read_b128 v[20:23], v11 offset:1024
 v_mfma_f32_32x32x16_bf16 v[48:63], a[240:243], v[32:35], v[48:63]
 ds_read_b128 v[24:27], v11 offset:2048
 ds_read_b128 v[28:31], v11 offset:3072
 v_mfma_f32_32x32x16_bf16 v[48:63], a[244:247], v[36:39], v[48:63]
 ds_read_b128 v[32:35], v11 offset:4096
 ds_read_b128 v[36:39], v11 offset:5120
 v_mfma_f32_32x32x16_bf16 v[48:63], a[248:251], v[40:43], v[48:63]
 v_mfma_f32_32x32x16_bf16 v[48:63], a[252:255], v[44:47], v[48:63]
 s_waitcnt lgkmcnt(5)
 v_mfma_f32_32x32x16_bf16 v[64:79], a[0:3], v[16:19], 0
 ds_read_b128 v[40:43], v11 offset:6144
 s_add_u32 s44, s44, 0x40000
 s_add_u32 s42, s40, 1
 v_cmp_ge_u32 vcc, s42, v15
 s_waitcnt lgkmcnt(5)
 v_mfma_f32_32x32x16_bf16 v[64:79], a[4:7], v[20:23], v[64:79]
 ds_read_b128 v[44:47], v11 offset:7168
 s_and_b32 vcc_lo, vcc_lo, 0x3
 s_cselect_b32 s50, 0, 1
 s_cselect_b32 s51, 1073741824, s44
 s_waitcnt lgkmcnt(5)
 v_mfma_f32_32x32x16_bf16 v[64:79], a[8:11], v[24:27], v[64:79]
 ds_read_b128 v[16:19], v11 offset:8192
 s_add_u32 m0, s45, 0
 s_add_u32 s43, s51, 0
 buffer_load_dwordx4 v2, s[36:39], s43 offen offset:0 sc1 lds
 s_waitcnt lgkmcnt(5)
 v_mfma_f32_32x32x16_bf16 v[64:79], a[12:15], v[28:31], v[64:79]
 ds_read_b128 v[20:23], v11 offset:9216
 s_waitcnt lgkmcnt(5)
 v_mfma_f32_32x32x16_bf16 v[64:79], a[16:19], v[32:35], v[64:79]
 ds_read_b128 v[24:27], v11 offset:10240
 buffer_load_dwordx4 v2, s[36:39], s43 offen offset:1024 sc1 lds
 s_waitcnt lgkmcnt(5)
 v_mfma_f32_32x32x16_bf16 v[64:79], a[20:23], v[36:39], v[64:79]
 ds_read_b128 v[28:31], v11 offset:11264
 s_waitcnt lgkmcnt(5)
 v_mfma_f32_32x32x16_bf16 v[64:79], a[24:27], v[40:43], v[64:79]
 ds_read_b128 v[32:35], v11 offset:12288
 buffer_store_dwordx4 v[52:55], v2, s[4:7], s64 offen sc1
 s_add_u32 s64, s64, 524288
 s_bitset0_b32 s64, 30
 s_waitcnt lgkmcnt(5)
 v_mfma_f32_32x32x16_bf16 v[64:79], a[28:31], v[44:47], v[64:79]
 ds_read_b128 v[36:39], v11 offset:13312
 buffer_load_dwordx4 v2, s[36:39], s43 offen offset:2048 sc1 lds
 s_waitcnt lgkmcnt(5)
 v_mfma_f32_32x32x16_bf16 v[64:79], a[32:35], v[16:19], v[64:79]
 ds_read_b128 v[40:43], v11 offset:14336
 s_waitcnt lgkmcnt(5)
 v_mfma_f32_32x32x16_bf16 v[64:79], a[36:39], v[20:23], v[64:79]
 ds_read_b128 v[44:47], v11 offset:15360
 buffer_load_dwordx4 v2, s[36:39], s43 offen offset:3072 sc1 lds
 s_waitcnt lgkmcnt(5)
 v_mfma_f32_32x32x16_bf16 v[64:79], a[40:43], v[24:27], v[64:79]
 ds_read_b128 v[16:19], v11 offset:16384
 s_waitcnt lgkmcnt(5)
 v_mfma_f32_32x32x16_bf16 v[64:79], a[44:47], v[28:31], v[64:79]
 ds_read_b128 v[20:23], v11 offset:17408
 buffer_store_dwordx4 v[56:59], v2, s[4:7], s65 offen sc1
 s_add_u32 s65, s65, 524288
 s_bitset0_b32 s65, 30
 s_waitcnt lgkmcnt(5)
 v_mfma_f32_32x32x16_bf16 v[64:79], a[48:51], v[32:35], v[64:79]
 ds_read_b128 v[24:27], v11 offset:18432
 s_add_u32 m0, s45, 4096
 s_add_u32 s43, s51, 4096
 buffer_load_dwordx4 v2, s[36:39], s43 offen offset:0 sc1 lds
 s_waitcnt lgkmcnt(5)
 v_mfma_f32_32x32x16_bf16 v[64:79], a[52:55], v[36:39], v[64:79]
 ds_read_b128 v[28:31], v11 offset:19456
 s_waitcnt lgkmcnt(5)
 v_mfma_f32_32x32x16_bf16 v[64:79], a[56:59], v[40:43], v[64:79]
 ds_read_b128 v[32:35], v11 offset:20480
 buffer_load_dwordx4 v2, s[36:39], s43 offen offset:1024 sc1 lds
 s_waitcnt lgkmcnt(5)
 v_mfma_f32_32x32x16_bf16 v[64:79], a[60:63], v[44:47], v[64:79]
 ds_read_b128 v[36:39], v11 offset:21504
 s_waitcnt lgkmcnt(5)
 v_mfma_f32_32x32x16_bf16 v[64:79], a[64:67], v[16:19], v[64:79]
 ds_read_b128 v[40:43], v11 offset:22528
 buffer_store_dwordx4 v[60:63], v2, s[4:7], s66 offen sc1
 s_add_u32 s66, s66, 524288
 s_bitset0_b32 s66, 30
 s_waitcnt lgkmcnt(5)
 v_mfma_f32_32x32x16_bf16 v[64:79], a[68:71], v[20:23], v[64:79]
 ds_read_b128 v[44:47], v11 offset:23552
 buffer_load_dwordx4 v2, s[36:39], s43 offen offset:2048 sc1 lds
 s_waitcnt lgkmcnt(5)
 v_mfma_f32_32x32x16_bf16 v[64:79], a[72:75], v[24:27], v[64:79]
 ds_read_b128 v[16:19], v11 offset:24576
 s_waitcnt vmcnt(10)
 v_pk_add_f32 v[88:89], v[88:89], v[96:97]
 v_pk_add_f32 v[90:91], v[90:91], v[98:99]
 v_pk_add_f32 v[88:89], v[88:89], v[100:101]
 s_waitcnt lgkmcnt(5)
 v_mfma_f32_32x32x16_bf16 v[64:79], a[76:79], v[28:31], v[64:79]
 ds_read_b128 v[20:23], v11 offset:25600
 buffer_load_dwordx4 v2, s[36:39], s43 offen offset:3072 sc1 lds
 s_waitcnt lgkmcnt(5)
 v_mfma_f32_32x32x16_bf16 v[64:79], a[80:83], v[32:35], v[64:79]
 ds_read_b128 v[24:27], v11 offset:26624
 v_pk_add_f32 v[90:91], v[90:91], v[102:103]
 v_pk_add_f32 v[88:89], v[88:89], v[104:105]
 v_pk_add_f32 v[90:91], v[90:91], v[106:107]
 s_waitcnt lgkmcnt(5)
 v_mfma_f32_32x32x16_bf16 v[64:79], a[84:87], v[36:39], v[64:79]
 ds_read_b128 v[28:31], v11 offset:27648
 v_cvt_pk_bf16_f32 v80, v88, v89
 v_cvt_pk_bf16_f32 v81, v90, v91
 s_waitcnt lgkmcnt(5)
 v_mfma_f32_32x32x16_bf16 v[64:79], a[88:91], v[40:43], v[64:79]
 ds_read_b128 v[32:35], v11 offset:28672
 s_add_u32 m0, s45, 8192
 s_add_u32 s43, s51, 8192
 buffer_load_dwordx4 v2, s[36:39], s43 offen offset:0 sc1 lds
 s_waitcnt lgkmcnt(5)
 v_mfma_f32_32x32x16_bf16 v[64:79], a[92:95], v[44:47], v[64:79]
 ds_read_b128 v[36:39], v11 offset:29696
 buffer_store_dwordx2 v[80:81], v14, s[8:11], s54 offen
 s_add_u32 s54, s54, 131072
 s_bitset0_b32 s54, 30
 s_waitcnt lgkmcnt(5)
 v_mfma_f32_32x32x16_bf16 v[64:79], a[96:99], v[16:19], v[64:79]
 ds_read_b128 v[40:43], v11 offset:30720
 buffer_load_dwordx4 v2, s[36:39], s43 offen offset:1024 sc1 lds
 s_waitcnt lgkmcnt(5)
 v_mfma_f32_32x32x16_bf16 v[64:79], a[100:103], v[20:23], v[64:79]
 ds_read_b128 v[44:47], v11 offset:31744
 v_mov_b32 v88, v48
 v_mov_b32 v89, v49
 v_mov_b32 v90, v50
 v_mov_b32 v91, v51
 s_waitcnt lgkmcnt(5)
 v_mfma_f32_32x32x16_bf16 v[64:79], a[104:107], v[24:27], v[64:79]
 ds_read_b128 v[16:19], v11 offset:32768
 s_load_dwordx4 s[60:63], s[4:5], s49 glc
 s_waitcnt lgkmcnt(5)
 v_mfma_f32_32x32x16_bf16 v[64:79], a[108:111], v[28:31], v[64:79]
 ds_read_b128 v[20:23], v11 offset:33792
 buffer_load_dwordx4 v2, s[36:39], s43 offen offset:2048 sc1 lds
 s_waitcnt lgkmcnt(5)
 v_mfma_f32_32x32x16_bf16 v[64:79], a[112:115], v[32:35], v[64:79]
 ds_read_b128 v[24:27], v11 offset:34816
 s_waitcnt lgkmcnt(5)
 v_mfma_f32_32x32x16_bf16 v[64:79], a[116:119], v[36:39], v[64:79]
 ds_read_b128 v[28:31], v11 offset:35840
 buffer_load_dwordx4 v2, s[36:39], s43 offen offset:3072 sc1 lds
 s_waitcnt lgkmcnt(5)
 v_mfma_f32_32x32x16_bf16 v[64:79], a[120:123], v[40:43], v[64:79]
 ds_read_b128 v[32:35], v11 offset:36864
 s_waitcnt lgkmcnt(5)
 v_mfma_f32_32x32x16_bf16 v[64:79], a[124:127], v[44:47], v[64:79]
 ds_read_b128 v[36:39], v11 offset:37888
 s_waitcnt lgkmcnt(5)
 v_mfma_f32_32x32x16_bf16 v[64:79], a[128:131], v[16:19], v[64:79]
 ds_read_b128 v[40:43], v11 offset:38912
 s_add_u32 m0, s45, 12288
 s_add_u32 s43, s51, 12288
 buffer_load_dwordx4 v2, s[36:39], s43 offen offset:0 sc1 lds
 s_waitcnt lgkmcnt(5)
 v_mfma_f32_32x32x16_bf16 v[64:79], a[132:135], v[20:23], v[64:79]
 ds_read_b128 v[44:47], v11 offset:39936
 s_waitcnt lgkmcnt(5)
 v_mfma_f32_32x32x16_bf16 v[64:79], a[136:139], v[24:27], v[64:79]
 ds_read_b128 v[16:19], v11 offset:40960
 buffer_load_dwordx4 v2, s[36:39], s43 offen offset:1024 sc1 lds
 s_waitcnt lgkmcnt(5)
 v_mfma_f32_32x32x16_bf16 v[64:79], a[140:143], v[28:31], v[64:79]
 ds_read_b128 v[20:23], v11 offset:41984
 s_waitcnt lgkmcnt(5)
 v_mfma_f32_32x32x16_bf16 v[64:79], a[144:147], v[32:35], v[64:79]
 ds_read_b128 v[24:27], v11 offset:43008
 s_waitcnt lgkmcnt(5)
 v_mfma_f32_32x32x16_bf16 v[64:79], a[148:151], v[36:39], v[64:79]
 ds_read_b128 v[28:31], v11 offset:44032
 buffer_load_dwordx4 v2, s[36:39], s43 offen offset:2048 sc1 lds
 s_waitcnt lgkmcnt(5)
 v_mfma_f32_32x32x16_bf16 v[64:79], a[152:155], v[40:43], v[64:79]
 ds_read_b128 v[32:35], v11 offset:45056
 s_waitcnt lgkmcnt(5)
 v_mfma_f32_32x32x16_bf16 v[64:79], a[156:159], v[44:47], v[64:79]
 ds_read_b128 v[36:39], v11 offset:46080
 buffer_load_dwordx4 v2, s[36:39], s43 offen offset:3072 sc1 lds
 s_waitcnt lgkmcnt(5)
 v_mfma_f32_32x32x16_bf16 v[64:79], a[160:163], v[16:19], v[64:79]
 ds_read_b128 v[40:43], v11 offset:47104
 s_lshl_b32 s41, s50, 7
 s_add_u32 s47, s47, s41
 buffer_load_dword v15, v255, s[4:7], s47 offen sc1
 s_waitcnt lgkmcnt(5)
 v_mfma_f32_32x32x16_bf16 v[64:79], a[164:167], v[20:23], v[64:79]
 ds_read_b128 v[44:47], v11 offset:48128
 s_waitcnt lgkmcnt(5)
 v_mfma_f32_32x32x16_bf16 v[64:79], a[168:171], v[24:27], v[64:79]
 ds_read_b128 v[16:19], v11 offset:49152
 s_add_u32 s41, s40, 2
 v_mov_b32 v9, s41
 s_waitcnt vmcnt(12)
 buffer_store_dword v9, v8, s[4:7], 0 offen sc1
 s_waitcnt lgkmcnt(5)
 v_mfma_f32_32x32x16_bf16 v[64:79], a[172:175], v[28:31], v[64:79]
 ds_read_b128 v[20:23], v11 offset:50176
 s_waitcnt lgkmcnt(5)
 v_mfma_f32_32x32x16_bf16 v[64:79], a[176:179], v[32:35], v[64:79]
 ds_read_b128 v[24:27], v11 offset:51200
 s_waitcnt lgkmcnt(5)
 v_mfma_f32_32x32x16_bf16 v[64:79], a[180:183], v[36:39], v[64:79]
 ds_read_b128 v[28:31], v11 offset:52224
 s_waitcnt lgkmcnt(5)
 v_mfma_f32_32x32x16_bf16 v[64:79], a[184:187], v[40:43], v[64:79]
 ds_read_b128 v[32:35], v11 offset:53248
 s_waitcnt lgkmcnt(5)
 v_mfma_f32_32x32x16_bf16 v[64:79], a[188:191], v[44:47], v[64:79]
 ds_read_b128 v[36:39], v11 offset:54272
 s_waitcnt lgkmcnt(5)
 v_mfma_f32_32x32x16_bf16 v[64:79], a[192:195], v[16:19], v[64:79]
 ds_read_b128 v[40:43], v11 offset:55296
 s_waitcnt lgkmcnt(5)
 v_mfma_f32_32x32x16_bf16 v[64:79], a[196:199], v[20:23], v[64:79]
 ds_read_b128 v[44:47], v11 offset:56320
 s_waitcnt lgkmcnt(5)
 v_mfma_f32_32x32x16_bf16 v[64:79], a[200:203], v[24:27], v[64:79]
 ds_read_b128 v[16:19], v11 offset:57344
 s_sub_u32 s52, s40, 0
L_rO_p1:
 s_min_u32 s41, s60, s61
 s_min_u32 s41, s41, s62
 s_min_u32 s41, s41, s63
 s_cmp_gt_u32 s41, s52
 s_cbranch_scc1 L_rO_p1ok
 s_load_dwordx4 s[60:63], s[4:5], s49 glc
 s_add_u32 s48, s48, 1
 s_cmp_gt_u32 s48, 400000
 s_cbranch_scc1 L_done
 s_waitcnt lgkmcnt(0)
 s_branch L_rO_p1
L_rO_p1ok:
 buffer_load_dwordx4 v[96:99], v2, s[4:7], s53 offen offset:1024 sc1
 buffer_load_dwordx4 v[100:103], v2, s[4:7], s53 offen offset:2048 sc1
 buffer_load_dwordx4 v[104:107], v2, s[4:7], s53 offen offset:3072 sc1
 s_add_u32 s53, s53, 524288
 s_waitcnt lgkmcnt(5)
 v_mfma_f32_32x32x16_bf16 v[64:79], a[204:207], v[28:31], v[64:79]
 ds_read_b128 v[20:23], v11 offset:58368
 s_waitcnt lgkmcnt(5)
 v_mfma_f32_32x32x16_bf16 v[64:79], a[208:211], v[32:35], v[64:79]
 ds_read_b128 v[24:27], v11 offset:59392
 s_waitcnt lgkmcnt(5)
 v_mfma_f32_32x32x16_bf16 v[64:79], a[212:215], v[36:39], v[64:79]
 ds_read_b128 v[28:31], v11 offset:60416
 s_waitcnt lgkmcnt(5)
 v_mfma_f32_32x32x16_bf16 v[64:79], a[216:219], v[40:43], v[64:79]
 ds_read_b128 v[32:35], v11 offset:61440
 s_waitcnt lgkmcnt(5)
 v_mfma_f32_32x32x16_bf16 v[64:79], a[220:223], v[44:47], v[64:79]
 ds_read_b128 v[36:39], v11 offset:62464
 s_waitcnt lgkmcnt(5)
 v_mfma_f32_32x32x16_bf16 v[64:79], a[224:227], v[16:19], v[64:79]
 ds_read_b128 v[40:43], v11 offset:63488
 s_waitcnt lgkmcnt(5)
 v_mfma_f32_32x32x16_bf16 v[64:79], a[228:231], v[20:23], v[64:79]
 ds_read_b128 v[44:47], v11 offset:64512
 s_waitcnt lgkmcnt(5)
 v_mfma_f32_32x32x16_bf16 v[64:79], a[232:235], v[24:27], v[64:79]
 s_waitcnt lgkmcnt(4)
 v_mfma_f32_32x32x16_bf16 v[64:79], a[236:239], v[28:31], v[64:79]
 s_waitcnt lgkmcnt(0)
 s_add_u32 s40, s40, 1
 s_cmp_eq_u32 s40, 64
 s_cselect_b32 s50, 1, s50
 s_cmp_eq_u32 s50, 1
 s_cbranch_scc1 L_rO_pre1
L_rO_o1:
 v_cmp_ge_u32 vcc, s40, v15
 s_and_b32 vcc_lo, vcc_lo, 0x3
 s_cbranch_scc0 L_rO_o1ok
 buffer_load_dword v15, v255, s[4:7], s47 offen sc1
 s_add_u32 s48, s48, 1
 s_cmp_gt_u32 s48, 400000
 s_cbranch_scc1 L_done
 s_waitcnt vmcnt(0)
 s_branch L_rO_o1
L_rO_o1ok:
 s_add_u32 m0, s45, 0
 s_add_u32 s43, s44, 0
 buffer_load_dwordx4 v2, s[36:39], s43 offen offset:0 sc1 lds
 buffer_load_dwordx4 v2, s[36:39], s43 offen offset:1024 sc1 lds
 buffer_load_dwordx4 v2, s[36:39], s43 offen offset:2048 sc1 lds
 buffer_load_dwordx4 v2, s[36:39], s43 offen offset:3072 sc1 lds
 s_add_u32 m0, s45, 4096
 s_add_u32 s43, s44, 4096
 buffer_load_dwordx4 v2, s[36:39], s43 offen offset:0 sc1 lds
 buffer_load_dwordx4 v2, s[36:39], s43 offen offset:1024 sc1 lds
 buffer_load_dwordx4 v2, s[36:39], s43 offen offset:2048 sc1 lds
 buffer_load_dwordx4 v2, s[36:39], s43 offen offset:3072 sc1 lds
 s_add_u32 m0, s45, 8192
 s_add_u32 s43, s44, 8192
 buffer_load_dwordx4 v2, s[36:39], s43 offen offset:0 sc1 lds
 buffer_load_dwordx4 v2, s[36:39], s43 offen offset:1024 sc1 lds
 buffer_load_dwordx4 v2, s[36:39], s43 offen offset:2048 sc1 lds
 buffer_load_dwordx4 v2, s[36:39], s43 offen offset:3072 sc1 lds
 s_add_u32 m0, s45, 12288
 s_add_u32 s43, s44, 12288
 buffer_load_dwordx4 v2, s[36:39], s43 offen offset:0 sc1 lds
 buffer_load_dwordx4 v2, s[36:39], s43 offen offset:1024 sc1 lds
 buffer_load_dwordx4 v2, s[36:39], s43 offen offset:2048 sc1 lds
 buffer_load_dwordx4 v2, s[36:39], s43 offen offset:3072 sc1 lds
 s_add_u32 s47, s47, 128
 buffer_load_dword v15, v255, s[4:7], s47 offen sc1
 s_waitcnt vmcnt(0)
L_rO_pre1:
 s_waitcnt vmcnt(5)
 s_barrier
 ds_read_b128 v[16:19], v10 offset:0
 ds_read_b128 v[20:23], v10 offset:1024
 v_mfma_f32_32x32x16_bf16 v[64:79], a[240:243], v[32:35], v[64:79]
 ds_read_b128 v[24:27], v10 offset:2048
 ds_read_b128 v[28:31], v10 offset:3072
 v_mfma_f32_32x32x16_bf16 v[64:79], a[244:247], v[36:39], v[64:79]
 ds_read_b128 v[32:35], v10 offset:4096
 ds_read_b128 v[36:39], v10 offset:5120
 v_mfma_f32_32x32x16_bf16 v[64:79], a[248:251], v[40:43], v[64:79]
 v_mfma_f32_32x32x16_bf16 v[64:79], a[252:255], v[44:47], v[64:79]
 s_cmp_lt_u32 s40, 64
 s_cbranch_scc1 L_rO_loop
 s_nop 9
 buffer_store_dwordx4 v[68:71], v2, s[4:7], s64 offen sc1
 s_add_u32 s64, s64, 524288
 s_bitset0_b32 s64, 30
 buffer_store_dwordx4 v[72:75], v2, s[4:7], s65 offen sc1
 s_add_u32 s65, s65, 524288
 s_bitset0_b32 s65, 30
 buffer_store_dwordx4 v[76:79], v2, s[4:7], s66 offen sc1
 s_add_u32 s66, s66, 524288
 s_bitset0_b32 s66, 30
 s_waitcnt vmcnt(3)
 v_pk_add_f32 v[92:93], v[92:93], v[96:97]
 v_pk_add_f32 v[94:95], v[94:95], v[98:99]
 v_pk_add_f32 v[92:93], v[92:93], v[100:101]
 v_pk_add_f32 v[94:95], v[94:95], v[102:103]
 v_pk_add_f32 v[92:93], v[92:93], v[104:105]
 v_pk_add_f32 v[94:95], v[94:95], v[106:107]
 v_cvt_pk_bf16_f32 v80, v92, v93
 v_cvt_pk_bf16_f32 v81, v94, v95
 buffer_store_dwordx2 v[80:81], v14, s[8:11], s54 offen
 s_add_u32 s54, s54, 131072
 s_bitset0_b32 s54, 30
 v_mov_b32 v92, v64
 v_mov_b32 v93, v65
 v_mov_b32 v94, v66
 v_mov_b32 v95, v67
 s_waitcnt lgkmcnt(0)
 s_sub_u32 s52, s40, 0
L_rO_t2:
 s_min_u32 s41, s60, s61
 s_min_u32 s41, s41, s62
 s_min_u32 s41, s41, s63
 s_cmp_gt_u32 s41, s52
 s_cbranch_scc1 L_rO_t2ok
 s_load_dwordx4 s[60:63], s[4:5], s49 glc
 s_add_u32 s48, s48, 1
 s_cmp_gt_u32 s48, 400000
 s_cbranch_scc1 L_done
 s_waitcnt lgkmcnt(0)
 s_branch L_rO_t2
L_rO_t2ok:
 buffer_load_dwordx4 v[96:99], v2, s[4:7], s53 offen offset:1024 sc1
 buffer_load_dwordx4 v[100:103], v2, s[4:7], s53 offen offset:2048 sc1
 buffer_load_dwordx4 v[104:107], v2, s[4:7], s53 offen offset:3072 sc1
 s_add_u32 s53, s53, 524288
 v_mov_b32 v9, 66
 s_waitcnt vmcnt(4)
 buffer_store_dword v9, v8, s[4:7], 0 offen sc1
 s_waitcnt vmcnt(1)
 v_pk_add_f32 v[88:89], v[88:89], v[96:97]
 v_pk_add_f32 v[90:91], v[90:91], v[98:99]
 v_pk_add_f32 v[88:89], v[88:89], v[100:101]
 v_pk_add_f32 v[90:91], v[90:91], v[102:103]
 v_pk_add_f32 v[88:89], v[88:89], v[104:105]
 v_pk_add_f32 v[90:91], v[90:91], v[106:107]
 v_cvt_pk_bf16_f32 v80, v88, v89
 v_cvt_pk_bf16_f32 v81, v90, v91
 buffer_store_dwordx2 v[80:81], v14, s[8:11], s54 offen
 s_add_u32 s54, s54, 131072
 s_bitset0_b32 s54, 30
 s_add_u32 s40, s40, 1
 s_sub_u32 s52, s40, 0
L_rO_t1:
 s_min_u32 s41, s60, s61
 s_min_u32 s41, s41, s62
 s_min_u32 s41, s41, s63
 s_cmp_gt_u32 s41, s52
 s_cbranch_scc1 L_rO_t1ok
 s_load_dwordx4 s[60:63], s[4:5], s49 glc
 s_add_u32 s48, s48, 1
 s_cmp_gt_u32 s48, 400000
 s_cbranch_scc1 L_done
 s_waitcnt lgkmcnt(0)
 s_branch L_rO_t1
L_rO_t1ok:
 buffer_load_dwordx4 v[96:99], v2, s[4:7], s53 offen offset:1024 sc1
 buffer_load_dwordx4 v[100:103], v2, s[4:7], s53 offen offset:2048 sc1
 buffer_load_dwordx4 v[104:107], v2, s[4:7], s53 offen offset:3072 sc1
 s_add_u32 s53, s53, 524288
 s_waitcnt vmcnt(0)
 v_pk_add_f32 v[92:93], v[92:93], v[96:97]
 v_pk_add_f32 v[94:95], v[94:95], v[98:99]
 v_pk_add_f32 v[92:93], v[92:93], v[100:101]
 v_pk_add_f32 v[94:95], v[94:95], v[102:103]
 v_pk_add_f32 v[92:93], v[92:93], v[104:105]
 v_pk_add_f32 v[94:95], v[94:95], v[106:107]
 v_cvt_pk_bf16_f32 v80, v92, v93
 v_cvt_pk_bf16_f32 v81, v94, v95
 buffer_store_dwordx2 v[80:81], v14, s[8:11], s54 offen
 s_add_u32 s54, s54, 131072
 s_bitset0_b32 s54, 30
 s_waitcnt vmcnt(0) lgkmcnt(0)
 s_barrier
 s_branch L_done
L_role_G:
 s_mov_b32 s10, 8388608
 s_mov_b32 s11, 0x20000
 v_and_b32 v1, 63, v0
 v_lshrrev_b32 v32, 2, v1
 v_and_b32 v33, 3, v1
 v_lshlrev_b32 v33, 4, v33
 v_lshl_add_u32 v39, v32, 13, v33
 v_lshl_add_u32 v40, v32, 11, v33
 s_lshl_b32 s59, s24, 5
 s_add_u32 s59, s59, s25
 s_lshl_b32 s59, s59, 6
 s_lshl_b32 s60, s26, 21
 s_add_u32 s44, s59, s60
 s_lshl_b32 s59, s24, 21
 s_lshl_b32 s60, s25, 6
 s_add_u32 s59, s59, s60
 s_lshl_b32 s60, s26, 19
 s_add_u32 s46, s59, s60
 s_lshl_b32 s48, s26, 13
 s_and_b32 s59, s25, 1
 s_mul_i32 s59, s59, 2
 s_lshl_b32 s60, s59, 17
 s_sub_u32 s45, s44, s60
 s_add_u32 s44, s44, s60
 s_lshl_b32 s60, s59, 15
 s_sub_u32 s47, s46, s60
 s_add_u32 s46, s46, s60
 s_lshl_b32 s60, s59, 10
 s_sub_u32 s49, s48, s60
 s_add_u32 s48, s48, s60
 s_mov_b64 s[8:9], s[16:17]
 s_add_u32 m0, s48, 0
 s_add_u32 s59, s44, 0
 buffer_load_dwordx4 v39, s[8:11], s59 offen  lds
 s_add_u32 m0, s48, 1024
 s_add_u32 s59, s44, 131072
 buffer_load_dwordx4 v39, s[8:11], s59 offen  lds
 s_add_u32 m0, s49, 2048
 s_add_u32 s59, s45, 262144
 buffer_load_dwordx4 v39, s[8:11], s59 offen  lds
 s_add_u32 m0, s49, 3072
 s_add_u32 s59, s45, 393216
 buffer_load_dwordx4 v39, s[8:11], s59 offen  lds
 s_add_u32 m0, s48, 4096
 s_add_u32 s59, s44, 524288
 buffer_load_dwordx4 v39, s[8:11], s59 offen  lds
 s_add_u32 m0, s48, 5120
 s_add_u32 s59, s44, 655360
 buffer_load_dwordx4 v39, s[8:11], s59 offen  lds
 s_add_u32 m0, s49, 6144
 s_add_u32 s59, s45, 786432
 buffer_load_dwordx4 v39, s[8:11], s59 offen  lds
 s_add_u32 m0, s49, 7168
 s_add_u32 s59, s45, 917504
 buffer_load_dwordx4 v39, s[8:11], s59 offen  lds
 v_and_b32 v1, 63, v0
 v_lshlrev_b32 v2, 4, v1
 v_lshlrev_b32 v3, 3, v1
 v_lshlrev_b32 v4, 2, v1
 v_mov_b32 v50, -1
 v_mov_b32 v51, -1
 v_mov_b32 v52, -1
 v_mov_b32 v53, -1
 v_bfrev_b32 v31, 1
 v_mov_b32 v37, 0
 v_mov_b32 v30, 0
 v_bfe_u32 v32, v1, 1, 1
 v_mul_u32_u24 v32, 0xaaaa, v32
 v_add_u32 v5, 0x4444, v32
 s_lshl_b32 s59, s26, 12
 v_add_u32 v6, s59, v2
 v_and_b32 v34, 15, v1
 v_lshrrev_b32 v35, 4, v1
 s_mul_i32 s59, s26, 2304
 s_add_u32 s59, s59, 4096
 v_mul_u32_u24 v32, 288, v35
 v_lshl_add_u32 v32, v34, 2, v32
 v_add_u32 v7, s59, v32
 v_add_u32 v8, 1152, v7
 v_mul_u32_u24 v32, 144, v34
 v_lshl_add_u32 v9, v35, 5, v32
 s_lshl_b32 s59, s26, 10
 v_add_u32 v10, s59, v2
 v_mov_b32 v32, 0x3e0293ee
 v_cmp_gt_u32 vcc, 8, v34
 s_nop 1
 v_cndmask_b32 v54, 1.0, v32, vcc
 s_mul_i32 s59, s25, 1280
 v_add_u32 v22, s59, v2
 v_cmp_gt_u32 vcc, 8, v34
 s_nop 1
 v_cndmask_b32 v11, v31, v22, vcc
 v_cmp_gt_u32 vcc, 16, v1
 s_nop 1
 v_cndmask_b32 v23, v31, v22, vcc
 v_lshlrev_b32 v32, 5, v34
 v_lshl_add_u32 v32, v35, 4, v32
 s_add_u32 s60, s59, 768
 v_add_u32 v32, s60, v32
 v_cmp_le_u32 vcc, 8, v34
 s_nop 1
 v_cndmask_b32 v32, v31, v32, vcc
 v_cmp_gt_u32 vcc, 2, v35
 s_nop 1
 v_cndmask_b32 v12, v31, v32, vcc
 s_xor_b32 s59, s25, 1
 s_mul_i32 s59, s59, 1280
 v_add_u32 v47, s59, v2
 s_xor_b32 s59, s25, 2
 s_mul_i32 s59, s59, 1280
 v_add_u32 v48, s59, v2
 s_xor_b32 s59, s25, 3
 s_mul_i32 s59, s59, 1280
 v_add_u32 v49, s59, v2
 s_and_b32 s59, s25, 28
 s_mul_i32 s59, s59, 1280
 s_add_u32 s59, s59, 1024
 v_add_u32 v13, s59, v4
 s_lshl_b32 s59, s25, 9
 v_lshlrev_b32 v32, 4, v34
 v_lshl_add_u32 v32, v35, 7, v32
 v_add_u32 v32, s59, v32
 v_cmp_gt_u32 vcc, 8, v34
 s_nop 1
 v_cndmask_b32 v14, v31, v32, vcc
 v_lshrrev_b32 v32, 2, v34
 v_and_b32 v36, 1, v34
 v_lshl_add_u32 v32, v32, 1, v36
 v_bfe_u32 v36, v34, 1, 1
 v_lshl_add_u32 v32, v36, 3, v32
 v_lshl_add_u32 v32, v35, 4, v32
 v_lshlrev_b32 v20, 4, v32
 v_add_u32 v32, s59, v2
 v_cmp_gt_u32 vcc, 32, v1
 s_nop 1
 v_cndmask_b32 v21, v31, v32, vcc
 v_lshrrev_b32 v32, 5, v1
 v_lshlrev_b32 v32, 8, v32
 v_bfe_u32 v36, v1, 1, 3
 v_lshl_add_u32 v32, v36, 5, v32
 v_bfe_u32 v36, v1, 4, 1
 v_lshl_add_u32 v32, v36, 4, v32
 v_and_b32 v36, 1, v1
 v_lshl_add_u32 v32, v36, 3, v32
 v_add_u32 v16, s59, v32
 s_lshr_b32 s59, s25, 1
 s_lshl_b32 s59, s59, 14
 s_and_b32 s60, s25, 1
 s_lshl_b32 s60, s60, 12
 s_add_u32 s59, s59, s60
 v_mov_b32 v29, v31
 s_add_u32 s60, s24, 1
 s_and_b32 s60, s60, 3
 s_lshl_b32 s60, s60, 10
 s_add_u32 s60, s60, s59
 v_add_u32 v44, s60, v2
 s_add_u32 s60, s60, 0
 v_writelane_b32 v29, s60, 0
 s_mov_b32 s74, s60
 s_add_u32 s60, s24, 2
 s_and_b32 s60, s60, 3
 s_lshl_b32 s60, s60, 10
 s_add_u32 s60, s60, s59
 v_add_u32 v45, s60, v2
 s_add_u32 s60, s60, 4
 v_writelane_b32 v29, s60, 1
 s_mov_b32 s75, s60
 s_add_u32 s60, s24, 3
 s_and_b32 s60, s60, 3
 s_lshl_b32 s60, s60, 10
 s_add_u32 s60, s60, s59
 v_add_u32 v46, s60, v2
 s_add_u32 s60, s60, 8
 v_writelane_b32 v29, s60, 2
 s_mov_b32 s76, s60
 s_lshl_b32 s60, s24, 10
 s_add_u32 s59, s59, s60
 v_add_u32 v24, s59, v2
 s_mov_b32 s73, s59
 s_and_b32 s60, s26, 1
 s_lshl_b32 s60, s60, 9
 s_add_u32 s59, s59, s60
 v_add_u32 v15, s59, v4
 v_lshrrev_b32 v32, 2, v34
 v_and_b32 v36, 3, v34
 v_lshl_add_u32 v32, v32, 3, v36
 v_lshlrev_b32 v32, 4, v32
 v_lshl_add_u32 v17, v35, 9, v32
 v_lshlrev_b32 v32, 4, v34
 v_lshl_add_u32 v18, v35, 9, v32
 v_lshl_add_u32 v32, v35, 7, v32
 v_subrev_u32 v32, 128, v32
 v_cmp_le_u32 vcc, 8, v34
 s_nop 1
 v_cndmask_b32 v19, v31, v32, vcc
 s_lshl_b32 s59, s24, 3
 s_lshr_b32 s60, s25, 2
 s_add_u32 s59, s59, s60
 s_lshl_b32 s59, s59, 7
 s_and_b32 s60, s25, 3
 s_lshl_b32 s60, s60, 2
 s_add_u32 s59, s59, s60
 s_add_u32 s77, s59, 3735552
 s_add_u32 s78, s59, 3735568
 s_add_u32 s59, s59, 3735584
 v_mov_b32 v32, s59
 v_cmp_eq_u32 vcc, 0, v1
 s_nop 1
 v_cndmask_b32 v42, v31, v32, vcc
 s_lshr_b32 s59, s25, 3
 s_lshl_b32 s60, s25, 2
 v_lshl_add_u32 v32, v1, 8, s60
 v_cmp_gt_u32 vcc, 4, v1
 s_nop 1
 v_cndmask_b32 v25, v31, v32, vcc
 v_cmp_ne_u32 vcc, s59, v1
 s_nop 1
 v_cndmask_b32 v25, v31, v25, vcc
 v_lshrrev_b32 v36, 3, v1
 s_and_b32 s60, s60, 28
 s_sub_u32 s60, s60, 3072
 v_lshl_add_u32 v32, v1, 7, s60
 s_add_u32 s60, s59, 4
 v_cmp_eq_u32 vcc, s60, v36
 s_nop 1
 v_cndmask_b32 v25, v25, v32, vcc
 s_add_u32 s60, s25, 32
 v_cmp_ne_u32 vcc, s60, v1
 s_nop 1
 v_cndmask_b32 v25, v31, v25, vcc
 s_lshl_b32 s60, s59, 8
 v_add_u32 v26, s60, v4
 s_lshl_b32 s60, s25, 7
 s_add_u32 s60, s60, 1024
 v_and_b32 v32, 28, v4
 v_add_u32 v32, s60, v32
 v_cmp_eq_u32 vcc, s59, v36
 s_nop 1
 v_cndmask_b32 v26, v26, v32, vcc
 s_lshl_b32 s71, 1, s25
 s_not_b32 s71, s71
 s_lshr_b32 s59, s25, 2
 s_lshl_b32 s59, s59, 8
 s_add_u32 s59, s59, 6144
 v_add_u32 v28, s59, v4
 s_and_b32 s60, s25, 3
 v_cmp_eq_u32 vcc, s60, v1
 s_nop 1
 v_cndmask_b32 v27, v31, v28, vcc
 s_mov_b32 s66, 0x42200000
 s_lshl_b32 s67, s24, 16
 s_lshl_b32 s68, s24, 18
 s_add_u32 s68, s68, 2621440
 s_add_u32 s67, s67, 2097152
 s_lshl_b32 s69, s24, 14
 s_add_u32 s69, s69, 3670016
 s_add_u32 s70, s69, 8192
 s_lshl_b32 s59, s26, 14
 s_add_u32 s53, s67, s59
 s_add_u32 s54, s53, 262144
 s_lshl_b32 s59, s26, 16
 s_add_u32 s55, s68, s59
 s_lshl_b32 s56, s26, 18
 s_add_u32 s56, s56, 134217728
 s_add_u32 s65, s56, 8192
 s_mov_b32 s72, 150732800
 s_mov_b32 s63, 150740992
 buffer_load_dwordx4 v[216:219], v21, s[4:7], s53 offen sc1
 buffer_load_dwordx4 v[220:223], v21, s[4:7], s54 offen sc1
 buffer_load_dwordx4 v[224:227], v22, s[4:7], s55 offen sc1
 buffer_load_dwordx4 v[228:231], v23, s[4:7], s55 offen offset:1024 sc1
 buffer_load_dword v236, v25, s[4:7], s69 offen sc1
 buffer_load_dword v237, v27, s[4:7], s69 offen sc1
 buffer_load_dword v238, v25, s[4:7], s70 offen sc1
 s_load_dwordx2 s[40:41], s[0:1], 8
 v_lshrrev_b32 v36, 2, v34
 v_lshlrev_b32 v36, 1, v36
 v_and_b32 v32, 1, v34
 v_add_u32 v36, v36, v32
 v_lshlrev_b32 v36, 11, v36
 v_lshl_add_u32 v36, v35, 5, v36
 v_bfe_u32 v32, v34, 1, 1
 v_lshl_add_u32 v36, v32, 4, v36
 s_lshl_b32 s59, s25, 6
 s_mov_b32 s42, 16384
 s_mov_b32 s43, 0x20000
 s_waitcnt lgkmcnt(0)
 buffer_load_dwordx4 v[232:235], v36, s[40:43], s59 offen
 v_bfe_u32 v41, v1, 2, 1
 v_bfe_u32 v32, v1, 3, 1
 v_lshl_add_u32 v41, v32, 3, v41
 v_bfe_u32 v32, v1, 4, 1
 v_lshl_add_u32 v41, v32, 2, v41
 v_bfe_u32 v32, v1, 5, 1
 v_lshl_add_u32 v41, v32, 4, v41
 v_lshlrev_b32 v41, 6, v41
 v_and_b32 v32, 3, v1
 v_lshl_add_u32 v41, v32, 3, v41
 v_bfe_u32 v38, v1, 2, 1
 v_bfe_u32 v32, v1, 3, 1
 v_lshl_add_u32 v38, v32, 2, v38
 v_bfe_u32 v32, v1, 4, 1
 v_lshl_add_u32 v38, v32, 4, v38
 v_bfe_u32 v32, v1, 5, 1
 v_lshl_add_u32 v38, v32, 3, v38
 v_lshlrev_b32 v38, 6, v38
 v_and_b32 v32, 3, v1
 v_lshl_add_u32 v38, v32, 3, v38
 s_lshl_b32 s60, s26, 13
 v_add_u32 v41, s60, v41
 s_and_b32 s60, s26, 1
 s_lshl_b32 s60, s60, 5
 v_add_u32 v38, s60, v38
 s_add_u32 m0, s48, 32768
 s_add_u32 s59, s44, 1048576
 buffer_load_dwordx4 v39, s[8:11], s59 offen  lds
 s_add_u32 m0, s48, 33792
 s_add_u32 s59, s44, 1179648
 buffer_load_dwordx4 v39, s[8:11], s59 offen  lds
 s_add_u32 m0, s49, 34816
 s_add_u32 s59, s45, 1310720
 buffer_load_dwordx4 v39, s[8:11], s59 offen  lds
 s_add_u32 m0, s49, 35840
 s_add_u32 s59, s45, 1441792
 buffer_load_dwordx4 v39, s[8:11], s59 offen  lds
 s_add_u32 m0, s48, 36864
 s_add_u32 s59, s44, 1572864
 buffer_load_dwordx4 v39, s[8:11], s59 offen  lds
 s_add_u32 m0, s48, 37888
 s_add_u32 s59, s44, 1703936
 buffer_load_dwordx4 v39, s[8:11], s59 offen  lds
 s_add_u32 m0, s49, 38912
 s_add_u32 s59, s45, 1835008
 buffer_load_dwordx4 v39, s[8:11], s59 offen  lds
 s_add_u32 m0, s49, 39936
 s_add_u32 s59, s45, 1966080
 buffer_load_dwordx4 v39, s[8:11], s59 offen  lds
 v_and_b32 v67, 15, v64
 v_lshrrev_b32 v68, 4, v64
 v_cvt_f32_u32 v200, v67
 v_mul_f32 v206, 0x41800000, v200
 v_lshl_add_u32 v65, v67, 1, 0
 v_add_u32 v65, 256, v65
 v_and_b32 v66, 3, v67
 v_lshlrev_b32 v66, 2, v66
 v_lshrrev_b32 v69, 2, v67
 v_lshl_add_u32 v66, v69, 8, v66
 v_cmp_gt_u32 vcc, 8, v67
 s_nop 1
 v_cndmask_b32 v65, v66, v65, vcc
 v_cvt_f32_u32 v202, v65
 v_and_b32 v65, 1, v67
 v_lshlrev_b32 v65, 3, v65
 v_lshrrev_b32 v66, 1, v67
 v_min_u32 v66, 4, v66
 v_lshl_add_u32 v65, v66, 8, v65
 v_add_u32 v65, 1024, v65
 v_cvt_f32_u32 v204, v65
 s_waitcnt vmcnt(25)
 v_lshlrev_b32 v95, 16, v94
 v_mul_f32 v95, 0x3fb8aa3b, v95
 v_exp_f32 v95, v95
 s_nop 0
 v_cvt_pk_bf16_f32 v95, v95, v95
 v_and_b32 v95, s98, v95
 v_lshl_add_u32 v65, v64, 5, s94
 v_lshlrev_b32 v96, 16, v88
 v_lshlrev_b32 v97, 16, v89
 v_lshlrev_b32 v98, 16, v90
 v_lshlrev_b32 v99, 16, v91
 v_lshlrev_b32 v100, 16, v92
 v_lshlrev_b32 v101, 16, v93
 v_mul_f32 v96, v95, v96
 v_mul_f32 v97, v95, v97
 v_mul_f32 v98, v95, v98
 v_mul_f32 v99, v95, v99
 v_mul_f32 v104, 0x3fb8aa3b, v96
 v_mul_f32 v105, 0x3e22f983, v97
 v_mul_f32 v106, v100, v98
 v_fma_f32 v106, -v101, v99, v106
 v_mul_f32 v107, v100, v99
 v_fma_f32 v107, v101, v98, v107
 ds_write_b128 v65, v[104:107] offset:4160
 v_and_b32 v96, s98, v88
 v_and_b32 v97, s98, v89
 v_and_b32 v98, s98, v90
 v_and_b32 v99, s98, v91
 v_and_b32 v100, s98, v92
 v_and_b32 v101, s98, v93
 v_mul_f32 v96, v95, v96
 v_mul_f32 v97, v95, v97
 v_mul_f32 v98, v95, v98
 v_mul_f32 v99, v95, v99
 v_mul_f32 v108, 0x3fb8aa3b, v96
 v_mul_f32 v109, 0x3e22f983, v97
 v_mul_f32 v110, v100, v98
 v_fma_f32 v110, -v101, v99, v110
 v_mul_f32 v111, v100, v99
 v_fma_f32 v111, v101, v98, v111
 ds_write_b128 v65, v[108:111] offset:4176
 v_mov_b32 v120, 0
 v_mov_b32 v121, 0
 v_mov_b32 v122, 0
 v_mov_b32 v123, 0
 v_mov_b32 v124, 0
 v_mov_b32 v125, 0
 v_mov_b32 v126, 0
 v_mov_b32 v127, 0
 v_mov_b32 v128, 0
 v_mov_b32 v129, 0
 v_mov_b32 v130, 0
 v_mov_b32 v131, 0
 v_lshl_add_u32 v69, v68, 6, s94
 s_mov_b32 s95, 0
 s_waitcnt lgkmcnt(0)
L_cgb_kg0:
 ds_read_b128 v[88:91], v69 offset:4160
 ds_read_b128 v[92:95], v69 offset:4176
 ds_read_b128 v[96:99], v69 offset:4192
 ds_read_b128 v[100:103], v69 offset:4208
 v_add_u32 v69, 256, v69
 s_waitcnt lgkmcnt(3)
 v_pk_mul_f32 v[132:133], v[88:89], v[200:201] op_sel_hi:[1,0]
 v_pk_mul_f32 v[136:137], v[88:89], v[202:203] op_sel_hi:[1,0]
 v_pk_mul_f32 v[140:141], v[88:89], v[204:205] op_sel_hi:[1,0]
 v_pk_mul_f32 v[144:145], v[88:89], v[206:207] op_sel_hi:[1,0]
 v_fract_f32 v133, v133
 v_fract_f32 v137, v137
 v_fract_f32 v141, v141
 v_fract_f32 v145, v145
 v_exp_f32 v132, v132
 v_cos_f32 v134, v133
 v_sin_f32 v135, v133
 v_exp_f32 v136, v136
 v_cos_f32 v138, v137
 v_sin_f32 v139, v137
 v_exp_f32 v140, v140
 v_cos_f32 v142, v141
 v_sin_f32 v143, v141
 v_exp_f32 v144, v144
 v_cos_f32 v146, v145
 v_sin_f32 v147, v145
 v_pk_mul_f32 v[134:135], v[134:135], v[132:133] op_sel_hi:[1,0]
 v_pk_mul_f32 v[138:139], v[138:139], v[136:137] op_sel_hi:[1,0]
 v_pk_mul_f32 v[142:143], v[142:143], v[140:141] op_sel_hi:[1,0]
 v_pk_mul_f32 v[146:147], v[146:147], v[144:145] op_sel_hi:[1,0]
 v_pk_mul_f32 v[144:145], v[146:147], v[90:91] op_sel_hi:[0,1] neg_hi:[0,1]
 v_cvt_pk_bf16_f32 v104, v134, v135
 v_cvt_pk_bf16_f32 v108, v138, v139
 v_cvt_pk_bf16_f32 v112, v142, v143
 v_pk_fma_f32 v[144:145], v[146:147], v[90:91], v[144:145] op_sel:[1,1,0] op_sel_hi:[1,0,1] neg_lo:[0,1,0] neg_hi:[0,1,0]
 v_cvt_pk_bf16_f32 v116, v144, v145
 s_waitcnt lgkmcnt(2)
 v_pk_mul_f32 v[132:133], v[92:93], v[200:201] op_sel_hi:[1,0]
 v_pk_mul_f32 v[136:137], v[92:93], v[202:203] op_sel_hi:[1,0]
 v_pk_mul_f32 v[140:141], v[92:93], v[204:205] op_sel_hi:[1,0]
 v_pk_mul_f32 v[144:145], v[92:93], v[206:207] op_sel_hi:[1,0]
 v_fract_f32 v133, v133
 v_fract_f32 v137, v137
 v_fract_f32 v141, v141
 v_fract_f32 v145, v145
 v_exp_f32 v132, v132
 v_cos_f32 v134, v133
 v_sin_f32 v135, v133
 v_exp_f32 v136, v136
 v_cos_f32 v138, v137
 v_sin_f32 v139, v137
 v_exp_f32 v140, v140
 v_cos_f32 v142, v141
 v_sin_f32 v143, v141
 v_exp_f32 v144, v144
 v_cos_f32 v146, v145
 v_sin_f32 v147, v145
 v_pk_mul_f32 v[134:135], v[134:135], v[132:133] op_sel_hi:[1,0]
 v_pk_mul_f32 v[138:139], v[138:139], v[136:137] op_sel_hi:[1,0]
 v_pk_mul_f32 v[142:143], v[142:143], v[140:141] op_sel_hi:[1,0]
 v_pk_mul_f32 v[146:147], v[146:147], v[144:145] op_sel_hi:[1,0]
 v_pk_mul_f32 v[144:145], v[146:147], v[94:95] op_sel_hi:[0,1] neg_hi:[0,1]
 v_cvt_pk_bf16_f32 v105, v134, v135
 v_cvt_pk_bf16_f32 v109, v138, v139
 v_cvt_pk_bf16_f32 v113, v142, v143
 v_pk_fma_f32 v[144:145], v[146:147], v[94:95], v[144:145] op_sel:[1,1,0] op_sel_hi:[1,0,1] neg_lo:[0,1,0] neg_hi:[0,1,0]
 v_cvt_pk_bf16_f32 v117, v144, v145
 s_waitcnt lgkmcnt(1)
 v_pk_mul_f32 v[132:133], v[96:97], v[200:201] op_sel_hi:[1,0]
 v_pk_mul_f32 v[136:137], v[96:97], v[202:203] op_sel_hi:[1,0]
 v_pk_mul_f32 v[140:141], v[96:97], v[204:205] op_sel_hi:[1,0]
 v_pk_mul_f32 v[144:145], v[96:97], v[206:207] op_sel_hi:[1,0]
 v_fract_f32 v133, v133
 v_fract_f32 v137, v137
 v_fract_f32 v141, v141
 v_fract_f32 v145, v145
 v_exp_f32 v132, v132
 v_cos_f32 v134, v133
 v_sin_f32 v135, v133
 v_exp_f32 v136, v136
 v_cos_f32 v138, v137
 v_sin_f32 v139, v137
 v_exp_f32 v140, v140
 v_cos_f32 v142, v141
 v_sin_f32 v143, v141
 v_exp_f32 v144, v144
 v_cos_f32 v146, v145
 v_sin_f32 v147, v145
 v_pk_mul_f32 v[134:135], v[134:135], v[132:133] op_sel_hi:[1,0]
 v_pk_mul_f32 v[138:139], v[138:139], v[136:137] op_sel_hi:[1,0]
 v_pk_mul_f32 v[142:143], v[142:143], v[140:141] op_sel_hi:[1,0]
 v_pk_mul_f32 v[146:147], v[146:147], v[144:145] op_sel_hi:[1,0]
 v_pk_mul_f32 v[144:145], v[146:147], v[98:99] op_sel_hi:[0,1] neg_hi:[0,1]
 v_cvt_pk_bf16_f32 v106, v134, v135
 v_cvt_pk_bf16_f32 v110, v138, v139
 v_cvt_pk_bf16_f32 v114, v142, v143
 v_pk_fma_f32 v[144:145], v[146:147], v[98:99], v[144:145] op_sel:[1,1,0] op_sel_hi:[1,0,1] neg_lo:[0,1,0] neg_hi:[0,1,0]
 v_cvt_pk_bf16_f32 v118, v144, v145
 s_waitcnt lgkmcnt(0)
 v_pk_mul_f32 v[132:133], v[100:101], v[200:201] op_sel_hi:[1,0]
 v_pk_mul_f32 v[136:137], v[100:101], v[202:203] op_sel_hi:[1,0]
 v_pk_mul_f32 v[140:141], v[100:101], v[204:205] op_sel_hi:[1,0]
 v_pk_mul_f32 v[144:145], v[100:101], v[206:207] op_sel_hi:[1,0]
 v_fract_f32 v133, v133
 v_fract_f32 v137, v137
 v_fract_f32 v141, v141
 v_fract_f32 v145, v145
 v_exp_f32 v132, v132
 v_cos_f32 v134, v133
 v_sin_f32 v135, v133
 v_exp_f32 v136, v136
 v_cos_f32 v138, v137
 v_sin_f32 v139, v137
 v_exp_f32 v140, v140
 v_cos_f32 v142, v141
 v_sin_f32 v143, v141
 v_exp_f32 v144, v144
 v_cos_f32 v146, v145
 v_sin_f32 v147, v145
 v_pk_mul_f32 v[134:135], v[134:135], v[132:133] op_sel_hi:[1,0]
 v_pk_mul_f32 v[138:139], v[138:139], v[136:137] op_sel_hi:[1,0]
 v_pk_mul_f32 v[142:143], v[142:143], v[140:141] op_sel_hi:[1,0]
 v_pk_mul_f32 v[146:147], v[146:147], v[144:145] op_sel_hi:[1,0]
 v_pk_mul_f32 v[144:145], v[146:147], v[102:103] op_sel_hi:[0,1] neg_hi:[0,1]
 v_cvt_pk_bf16_f32 v107, v134, v135
 v_cvt_pk_bf16_f32 v111, v138, v139
 v_cvt_pk_bf16_f32 v115, v142, v143
 v_pk_fma_f32 v[144:145], v[146:147], v[102:103], v[144:145] op_sel:[1,1,0] op_sel_hi:[1,0,1] neg_lo:[0,1,0] neg_hi:[0,1,0]
 v_cvt_pk_bf16_f32 v119, v144, v145
 s_add_u32 s95, s95, 1
 s_cmp_lt_u32 s95, 2
 v_mfma_f32_16x16x32_bf16 v[120:123], v[104:107], v[116:119], v[120:123]
 v_mfma_f32_16x16x32_bf16 v[124:127], v[108:111], v[116:119], v[124:127]
 v_mfma_f32_16x16x32_bf16 v[128:131], v[112:115], v[116:119], v[128:131]
 s_cbranch_scc1 L_cgb_kg0
 s_waitcnt vmcnt(8)
 s_cmp_eq_u32 s26, 0
 s_cselect_b64 vcc, -1, 0
 v_min_u32 v232, -2, v232
 v_cndmask_b32 v232, -1, v232, vcc
 v_min_u32 v233, -2, v233
 v_cndmask_b32 v233, -1, v233, vcc
 v_min_u32 v234, -2, v234
 v_cndmask_b32 v234, -1, v234, vcc
 v_min_u32 v235, -2, v235
 v_cndmask_b32 v235, -1, v235, vcc
 buffer_store_dwordx4 v[232:235], v21, s[4:7], s53 offen sc1
 buffer_store_dwordx4 v[50:53], v21, s[4:7], s54 offen sc1
 buffer_store_dwordx4 v[50:53], v22, s[4:7], s55 offen sc1
 buffer_store_dwordx4 v[50:53], v23, s[4:7], s55 offen offset:1024 sc1
 buffer_store_dwordx4 v[50:53], v24, s[4:7], s56 offen sc1
 buffer_store_dwordx4 v[50:53], v24, s[4:7], s65 offen sc1
 buffer_store_dword v37, v29, s[4:7], s63 offen sc1
 buffer_store_dword v37, v25, s[4:7], s69 offen sc1
 buffer_store_dword v37, v27, s[4:7], s69 offen sc1
 buffer_store_dword v37, v25, s[4:7], s70 offen sc1
 buffer_store_dword v37, v29, s[4:7], s72 offen sc1
 buffer_store_dword v37, v42, s[4:7], 0 offen sc1
 s_waitcnt vmcnt(28)
 ds_read_b64_tr_b16 a[0:1], v41 offset:0
 ds_read_b64_tr_b16 a[2:3], v41 offset:128
 ds_read_b64_tr_b16 a[4:5], v41 offset:2048
 ds_read_b64_tr_b16 a[6:7], v41 offset:2176
 ds_read_b64_tr_b16 a[8:9], v41 offset:32
 ds_read_b64_tr_b16 a[10:11], v41 offset:160
 ds_read_b64_tr_b16 a[12:13], v41 offset:2080
 ds_read_b64_tr_b16 a[14:15], v41 offset:2208
 s_waitcnt lgkmcnt(0)
 ds_read_b64_tr_b16 a[48:49], v41 offset:4096
 ds_read_b64_tr_b16 a[50:51], v41 offset:4224
 ds_read_b64_tr_b16 a[52:53], v41 offset:6144
 ds_read_b64_tr_b16 a[54:55], v41 offset:6272
 ds_read_b64_tr_b16 a[56:57], v41 offset:4128
 ds_read_b64_tr_b16 a[58:59], v41 offset:4256
 ds_read_b64_tr_b16 a[60:61], v41 offset:6176
 ds_read_b64_tr_b16 a[62:63], v41 offset:6304
 s_waitcnt lgkmcnt(0)
 s_mov_b64 s[8:9], s[18:19]
 s_add_u32 m0, s48, 0
 s_add_u32 s59, s44, 0
 buffer_load_dwordx4 v39, s[8:11], s59 offen  lds
 s_add_u32 m0, s48, 1024
 s_add_u32 s59, s44, 131072
 buffer_load_dwordx4 v39, s[8:11], s59 offen  lds
 s_add_u32 m0, s49, 2048
 s_add_u32 s59, s45, 262144
 buffer_load_dwordx4 v39, s[8:11], s59 offen  lds
 s_add_u32 m0, s49, 3072
 s_add_u32 s59, s45, 393216
 buffer_load_dwordx4 v39, s[8:11], s59 offen  lds
 s_add_u32 m0, s48, 4096
 s_add_u32 s59, s44, 524288
 buffer_load_dwordx4 v39, s[8:11], s59 offen  lds
 s_add_u32 m0, s48, 5120
 s_add_u32 s59, s44, 655360
 buffer_load_dwordx4 v39, s[8:11], s59 offen  lds
 s_add_u32 m0, s49, 6144
 s_add_u32 s59, s45, 786432
 buffer_load_dwordx4 v39, s[8:11], s59 offen  lds
 s_add_u32 m0, s49, 7168
 s_add_u32 s59, s45, 917504
 buffer_load_dwordx4 v39, s[8:11], s59 offen  lds
L_cgb_kg1:
 ds_read_b128 v[88:91], v69 offset:4160
 ds_read_b128 v[92:95], v69 offset:4176
 ds_read_b128 v[96:99], v69 offset:4192
 ds_read_b128 v[100:103], v69 offset:4208
 v_add_u32 v69, 256, v69
 s_waitcnt lgkmcnt(3)
 v_pk_mul_f32 v[132:133], v[88:89], v[200:201] op_sel_hi:[1,0]
 v_pk_mul_f32 v[136:137], v[88:89], v[202:203] op_sel_hi:[1,0]
 v_pk_mul_f32 v[140:141], v[88:89], v[204:205] op_sel_hi:[1,0]
 v_pk_mul_f32 v[144:145], v[88:89], v[206:207] op_sel_hi:[1,0]
 v_fract_f32 v133, v133
 v_fract_f32 v137, v137
 v_fract_f32 v141, v141
 v_fract_f32 v145, v145
 v_exp_f32 v132, v132
 v_cos_f32 v134, v133
 v_sin_f32 v135, v133
 v_exp_f32 v136, v136
 v_cos_f32 v138, v137
 v_sin_f32 v139, v137
 v_exp_f32 v140, v140
 v_cos_f32 v142, v141
 v_sin_f32 v143, v141
 v_exp_f32 v144, v144
 v_cos_f32 v146, v145
 v_sin_f32 v147, v145
 v_pk_mul_f32 v[134:135], v[134:135], v[132:133] op_sel_hi:[1,0]
 v_pk_mul_f32 v[138:139], v[138:139], v[136:137] op_sel_hi:[1,0]
 v_pk_mul_f32 v[142:143], v[142:143], v[140:141] op_sel_hi:[1,0]
 v_pk_mul_f32 v[146:147], v[146:147], v[144:145] op_sel_hi:[1,0]
 v_pk_mul_f32 v[144:145], v[146:147], v[90:91] op_sel_hi:[0,1] neg_hi:[0,1]
 v_cvt_pk_bf16_f32 v104, v134, v135
 v_cvt_pk_bf16_f32 v108, v138, v139
 v_cvt_pk_bf16_f32 v112, v142, v143
 v_pk_fma_f32 v[144:145], v[146:147], v[90:91], v[144:145] op_sel:[1,1,0] op_sel_hi:[1,0,1] neg_lo:[0,1,0] neg_hi:[0,1,0]
 v_cvt_pk_bf16_f32 v116, v144, v145
 s_waitcnt lgkmcnt(2)
 v_pk_mul_f32 v[132:133], v[92:93], v[200:201] op_sel_hi:[1,0]
 v_pk_mul_f32 v[136:137], v[92:93], v[202:203] op_sel_hi:[1,0]
 v_pk_mul_f32 v[140:141], v[92:93], v[204:205] op_sel_hi:[1,0]
 v_pk_mul_f32 v[144:145], v[92:93], v[206:207] op_sel_hi:[1,0]
 v_fract_f32 v133, v133
 v_fract_f32 v137, v137
 v_fract_f32 v141, v141
 v_fract_f32 v145, v145
 v_exp_f32 v132, v132
 v_cos_f32 v134, v133
 v_sin_f32 v135, v133
 v_exp_f32 v136, v136
 v_cos_f32 v138, v137
 v_sin_f32 v139, v137
 v_exp_f32 v140, v140
 v_cos_f32 v142, v141
 v_sin_f32 v143, v141
 v_exp_f32 v144, v144
 v_cos_f32 v146, v145
 v_sin_f32 v147, v145
 v_pk_mul_f32 v[134:135], v[134:135], v[132:133] op_sel_hi:[1,0]
 v_pk_mul_f32 v[138:139], v[138:139], v[136:137] op_sel_hi:[1,0]
 v_pk_mul_f32 v[142:143], v[142:143], v[140:141] op_sel_hi:[1,0]
 v_pk_mul_f32 v[146:147], v[146:147], v[144:145] op_sel_hi:[1,0]
 v_pk_mul_f32 v[144:145], v[146:147], v[94:95] op_sel_hi:[0,1] neg_hi:[0,1]
 v_cvt_pk_bf16_f32 v105, v134, v135
 v_cvt_pk_bf16_f32 v109, v138, v139
 v_cvt_pk_bf16_f32 v113, v142, v143
 v_pk_fma_f32 v[144:145], v[146:147], v[94:95], v[144:145] op_sel:[1,1,0] op_sel_hi:[1,0,1] neg_lo:[0,1,0] neg_hi:[0,1,0]
 v_cvt_pk_bf16_f32 v117, v144, v145
 s_waitcnt lgkmcnt(1)
 v_pk_mul_f32 v[132:133], v[96:97], v[200:201] op_sel_hi:[1,0]
 v_pk_mul_f32 v[136:137], v[96:97], v[202:203] op_sel_hi:[1,0]
 v_pk_mul_f32 v[140:141], v[96:97], v[204:205] op_sel_hi:[1,0]
 v_pk_mul_f32 v[144:145], v[96:97], v[206:207] op_sel_hi:[1,0]
 v_fract_f32 v133, v133
 v_fract_f32 v137, v137
 v_fract_f32 v141, v141
 v_fract_f32 v145, v145
 v_exp_f32 v132, v132
 v_cos_f32 v134, v133
 v_sin_f32 v135, v133
 v_exp_f32 v136, v136
 v_cos_f32 v138, v137
 v_sin_f32 v139, v137
 v_exp_f32 v140, v140
 v_cos_f32 v142, v141
 v_sin_f32 v143, v141
 v_exp_f32 v144, v144
 v_cos_f32 v146, v145
 v_sin_f32 v147, v145
 v_pk_mul_f32 v[134:135], v[134:135], v[132:133] op_sel_hi:[1,0]
 v_pk_mul_f32 v[138:139], v[138:139], v[136:137] op_sel_hi:[1,0]
 v_pk_mul_f32 v[142:143], v[142:143], v[140:141] op_sel_hi:[1,0]
 v_pk_mul_f32 v[146:147], v[146:147], v[144:145] op_sel_hi:[1,0]
 v_pk_mul_f32 v[144:145], v[146:147], v[98:99] op_sel_hi:[0,1] neg_hi:[0,1]
 v_cvt_pk_bf16_f32 v106, v134, v135
 v_cvt_pk_bf16_f32 v110, v138, v139
 v_cvt_pk_bf16_f32 v114, v142, v143
 v_pk_fma_f32 v[144:145], v[146:147], v[98:99], v[144:145] op_sel:[1,1,0] op_sel_hi:[1,0,1] neg_lo:[0,1,0] neg_hi:[0,1,0]
 v_cvt_pk_bf16_f32 v118, v144, v145
 s_waitcnt lgkmcnt(0)
 v_pk_mul_f32 v[132:133], v[100:101], v[200:201] op_sel_hi:[1,0]
 v_pk_mul_f32 v[136:137], v[100:101], v[202:203] op_sel_hi:[1,0]
 v_pk_mul_f32 v[140:141], v[100:101], v[204:205] op_sel_hi:[1,0]
 v_pk_mul_f32 v[144:145], v[100:101], v[206:207] op_sel_hi:[1,0]
 v_fract_f32 v133, v133
 v_fract_f32 v137, v137
 v_fract_f32 v141, v141
 v_fract_f32 v145, v145
 v_exp_f32 v132, v132
 v_cos_f32 v134, v133
 v_sin_f32 v135, v133
 v_exp_f32 v136, v136
 v_cos_f32 v138, v137
 v_sin_f32 v139, v137
 v_exp_f32 v140, v140
 v_cos_f32 v142, v141
 v_sin_f32 v143, v141
 v_exp_f32 v144, v144
 v_cos_f32 v146, v145
 v_sin_f32 v147, v145
 v_pk_mul_f32 v[134:135], v[134:135], v[132:133] op_sel_hi:[1,0]
 v_pk_mul_f32 v[138:139], v[138:139], v[136:137] op_sel_hi:[1,0]
 v_pk_mul_f32 v[142:143], v[142:143], v[140:141] op_sel_hi:[1,0]
 v_pk_mul_f32 v[146:147], v[146:147], v[144:145] op_sel_hi:[1,0]
 v_pk_mul_f32 v[144:145], v[146:147], v[102:103] op_sel_hi:[0,1] neg_hi:[0,1]
 v_cvt_pk_bf16_f32 v107, v134, v135
 v_cvt_pk_bf16_f32 v111, v138, v139
 v_cvt_pk_bf16_f32 v115, v142, v143
 v_pk_fma_f32 v[144:145], v[146:147], v[102:103], v[144:145] op_sel:[1,1,0] op_sel_hi:[1,0,1] neg_lo:[0,1,0] neg_hi:[0,1,0]
 v_cvt_pk_bf16_f32 v119, v144, v145
 s_add_u32 s95, s95, 1
 s_cmp_lt_u32 s95, 5
 v_mfma_f32_16x16x32_bf16 v[120:123], v[104:107], v[116:119], v[120:123]
 v_mfma_f32_16x16x32_bf16 v[124:127], v[108:111], v[116:119], v[124:127]
 v_mfma_f32_16x16x32_bf16 v[128:131], v[112:115], v[116:119], v[128:131]
 s_cbranch_scc1 L_cgb_kg1
 s_lshl_b32 s93, s28, 3
 buffer_load_dwordx2 v[72:73], v70, s[84:87], s93 offen offset:0
 buffer_load_dwordx2 v[74:75], v70, s[84:87], s93 offen offset:2048
 s_add_u32 s93, s93, 4096
 buffer_load_dwordx2 v[76:77], v70, s[84:87], s93 offen offset:0
 buffer_load_dwordx2 v[78:79], v70, s[84:87], s93 offen offset:2048
 s_add_u32 s93, s93, 4096
 buffer_load_dwordx2 v[80:81], v70, s[84:87], s93 offen offset:0
 buffer_load_dwordx2 v[82:83], v70, s[84:87], s93 offen offset:2048
 s_add_u32 s93, s93, 4096
 buffer_load_dwordx2 v[84:85], v70, s[84:87], s93 offen offset:0
 buffer_load_dwordx2 v[86:87], v70, s[84:87], s93 offen offset:2048
 s_waitcnt vmcnt(28)
 ds_read_b64_tr_b16 a[96:97], v41 offset:32768
 ds_read_b64_tr_b16 a[98:99], v41 offset:32896
 ds_read_b64_tr_b16 a[100:101], v41 offset:34816
 ds_read_b64_tr_b16 a[102:103], v41 offset:34944
 ds_read_b64_tr_b16 a[104:105], v41 offset:32800
 ds_read_b64_tr_b16 a[106:107], v41 offset:32928
 ds_read_b64_tr_b16 a[108:109], v41 offset:34848
 ds_read_b64_tr_b16 a[110:111], v41 offset:34976
 s_waitcnt lgkmcnt(0)
 ds_read_b64_tr_b16 a[144:145], v41 offset:36864
 ds_read_b64_tr_b16 a[146:147], v41 offset:36992
 ds_read_b64_tr_b16 a[148:149], v41 offset:38912
 ds_read_b64_tr_b16 a[150:151], v41 offset:39040
 ds_read_b64_tr_b16 a[152:153], v41 offset:36896
 ds_read_b64_tr_b16 a[154:155], v41 offset:37024
 ds_read_b64_tr_b16 a[156:157], v41 offset:38944
 ds_read_b64_tr_b16 a[158:159], v41 offset:39072
 s_waitcnt lgkmcnt(0)
 s_add_u32 m0, s48, 32768
 s_add_u32 s59, s44, 1048576
 buffer_load_dwordx4 v39, s[8:11], s59 offen  lds
 s_add_u32 m0, s48, 33792
 s_add_u32 s59, s44, 1179648
 buffer_load_dwordx4 v39, s[8:11], s59 offen  lds
 s_add_u32 m0, s49, 34816
 s_add_u32 s59, s45, 1310720
 buffer_load_dwordx4 v39, s[8:11], s59 offen  lds
 s_add_u32 m0, s49, 35840
 s_add_u32 s59, s45, 1441792
 buffer_load_dwordx4 v39, s[8:11], s59 offen  lds
 s_add_u32 m0, s48, 36864
 s_add_u32 s59, s44, 1572864
 buffer_load_dwordx4 v39, s[8:11], s59 offen  lds
 s_add_u32 m0, s48, 37888
 s_add_u32 s59, s44, 1703936
 buffer_load_dwordx4 v39, s[8:11], s59 offen  lds
 s_add_u32 m0, s49, 38912
 s_add_u32 s59, s45, 1835008
 buffer_load_dwordx4 v39, s[8:11], s59 offen  lds
 s_add_u32 m0, s49, 39936
 s_add_u32 s59, s45, 1966080
 buffer_load_dwordx4 v39, s[8:11], s59 offen  lds
L_cgb_kg2:
 ds_read_b128 v[88:91], v69 offset:4160
 ds_read_b128 v[92:95], v69 offset:4176
 ds_read_b128 v[96:99], v69 offset:4192
 ds_read_b128 v[100:103], v69 offset:4208
 v_add_u32 v69, 256, v69
 s_waitcnt lgkmcnt(3)
 v_pk_mul_f32 v[132:133], v[88:89], v[200:201] op_sel_hi:[1,0]
 v_pk_mul_f32 v[136:137], v[88:89], v[202:203] op_sel_hi:[1,0]
 v_pk_mul_f32 v[140:141], v[88:89], v[204:205] op_sel_hi:[1,0]
 v_pk_mul_f32 v[144:145], v[88:89], v[206:207] op_sel_hi:[1,0]
 v_fract_f32 v133, v133
 v_fract_f32 v137, v137
 v_fract_f32 v141, v141
 v_fract_f32 v145, v145
 v_exp_f32 v132, v132
 v_cos_f32 v134, v133
 v_sin_f32 v135, v133
 v_exp_f32 v136, v136
 v_cos_f32 v138, v137
 v_sin_f32 v139, v137
 v_exp_f32 v140, v140
 v_cos_f32 v142, v141
 v_sin_f32 v143, v141
 v_exp_f32 v144, v144
 v_cos_f32 v146, v145
 v_sin_f32 v147, v145
 v_pk_mul_f32 v[134:135], v[134:135], v[132:133] op_sel_hi:[1,0]
 v_pk_mul_f32 v[138:139], v[138:139], v[136:137] op_sel_hi:[1,0]
 v_pk_mul_f32 v[142:143], v[142:143], v[140:141] op_sel_hi:[1,0]
 v_pk_mul_f32 v[146:147], v[146:147], v[144:145] op_sel_hi:[1,0]
 v_pk_mul_f32 v[144:145], v[146:147], v[90:91] op_sel_hi:[0,1] neg_hi:[0,1]
 v_cvt_pk_bf16_f32 v104, v134, v135
 v_cvt_pk_bf16_f32 v108, v138, v139
 v_cvt_pk_bf16_f32 v112, v142, v143
 v_pk_fma_f32 v[144:145], v[146:147], v[90:91], v[144:145] op_sel:[1,1,0] op_sel_hi:[1,0,1] neg_lo:[0,1,0] neg_hi:[0,1,0]
 v_cvt_pk_bf16_f32 v116, v144, v145
 s_waitcnt lgkmcnt(2)
 v_pk_mul_f32 v[132:133], v[92:93], v[200:201] op_sel_hi:[1,0]
 v_pk_mul_f32 v[136:137], v[92:93], v[202:203] op_sel_hi:[1,0]
 v_pk_mul_f32 v[140:141], v[92:93], v[204:205] op_sel_hi:[1,0]
 v_pk_mul_f32 v[144:145], v[92:93], v[206:207] op_sel_hi:[1,0]
 v_fract_f32 v133, v133
 v_fract_f32 v137, v137
 v_fract_f32 v141, v141
 v_fract_f32 v145, v145
 v_exp_f32 v132, v132
 v_cos_f32 v134, v133
 v_sin_f32 v135, v133
 v_exp_f32 v136, v136
 v_cos_f32 v138, v137
 v_sin_f32 v139, v137
 v_exp_f32 v140, v140
 v_cos_f32 v142, v141
 v_sin_f32 v143, v141
 v_exp_f32 v144, v144
 v_cos_f32 v146, v145
 v_sin_f32 v147, v145
 v_pk_mul_f32 v[134:135], v[134:135], v[132:133] op_sel_hi:[1,0]
 v_pk_mul_f32 v[138:139], v[138:139], v[136:137] op_sel_hi:[1,0]
 v_pk_mul_f32 v[142:143], v[142:143], v[140:141] op_sel_hi:[1,0]
 v_pk_mul_f32 v[146:147], v[146:147], v[144:145] op_sel_hi:[1,0]
 v_pk_mul_f32 v[144:145], v[146:147], v[94:95] op_sel_hi:[0,1] neg_hi:[0,1]
 v_cvt_pk_bf16_f32 v105, v134, v135
 v_cvt_pk_bf16_f32 v109, v138, v139
 v_cvt_pk_bf16_f32 v113, v142, v143
 v_pk_fma_f32 v[144:145], v[146:147], v[94:95], v[144:145] op_sel:[1,1,0] op_sel_hi:[1,0,1] neg_lo:[0,1,0] neg_hi:[0,1,0]
 v_cvt_pk_bf16_f32 v117, v144, v145
 s_waitcnt lgkmcnt(1)
 v_pk_mul_f32 v[132:133], v[96:97], v[200:201] op_sel_hi:[1,0]
 v_pk_mul_f32 v[136:137], v[96:97], v[202:203] op_sel_hi:[1,0]
 v_pk_mul_f32 v[140:141], v[96:97], v[204:205] op_sel_hi:[1,0]
 v_pk_mul_f32 v[144:145], v[96:97], v[206:207] op_sel_hi:[1,0]
 v_fract_f32 v133, v133
 v_fract_f32 v137, v137
 v_fract_f32 v141, v141
 v_fract_f32 v145, v145
 v_exp_f32 v132, v132
 v_cos_f32 v134, v133
 v_sin_f32 v135, v133
 v_exp_f32 v136, v136
 v_cos_f32 v138, v137
 v_sin_f32 v139, v137
 v_exp_f32 v140, v140
 v_cos_f32 v142, v141
 v_sin_f32 v143, v141
 v_exp_f32 v144, v144
 v_cos_f32 v146, v145
 v_sin_f32 v147, v145
 v_pk_mul_f32 v[134:135], v[134:135], v[132:133] op_sel_hi:[1,0]
 v_pk_mul_f32 v[138:139], v[138:139], v[136:137] op_sel_hi:[1,0]
 v_pk_mul_f32 v[142:143], v[142:143], v[140:141] op_sel_hi:[1,0]
 v_pk_mul_f32 v[146:147], v[146:147], v[144:145] op_sel_hi:[1,0]
 v_pk_mul_f32 v[144:145], v[146:147], v[98:99] op_sel_hi:[0,1] neg_hi:[0,1]
 v_cvt_pk_bf16_f32 v106, v134, v135
 v_cvt_pk_bf16_f32 v110, v138, v139
 v_cvt_pk_bf16_f32 v114, v142, v143
 v_pk_fma_f32 v[144:145], v[146:147], v[98:99], v[144:145] op_sel:[1,1,0] op_sel_hi:[1,0,1] neg_lo:[0,1,0] neg_hi:[0,1,0]
 v_cvt_pk_bf16_f32 v118, v144, v145
 s_waitcnt lgkmcnt(0)
 v_pk_mul_f32 v[132:133], v[100:101], v[200:201] op_sel_hi:[1,0]
 v_pk_mul_f32 v[136:137], v[100:101], v[202:203] op_sel_hi:[1,0]
 v_pk_mul_f32 v[140:141], v[100:101], v[204:205] op_sel_hi:[1,0]
 v_pk_mul_f32 v[144:145], v[100:101], v[206:207] op_sel_hi:[1,0]
 v_fract_f32 v133, v133
 v_fract_f32 v137, v137
 v_fract_f32 v141, v141
 v_fract_f32 v145, v145
 v_exp_f32 v132, v132
 v_cos_f32 v134, v133
 v_sin_f32 v135, v133
 v_exp_f32 v136, v136
 v_cos_f32 v138, v137
 v_sin_f32 v139, v137
 v_exp_f32 v140, v140
 v_cos_f32 v142, v141
 v_sin_f32 v143, v141
 v_exp_f32 v144, v144
 v_cos_f32 v146, v145
 v_sin_f32 v147, v145
 v_pk_mul_f32 v[134:135], v[134:135], v[132:133] op_sel_hi:[1,0]
 v_pk_mul_f32 v[138:139], v[138:139], v[136:137] op_sel_hi:[1,0]
 v_pk_mul_f32 v[142:143], v[142:143], v[140:141] op_sel_hi:[1,0]
 v_pk_mul_f32 v[146:147], v[146:147], v[144:145] op_sel_hi:[1,0]
 v_pk_mul_f32 v[144:145], v[146:147], v[102:103] op_sel_hi:[0,1] neg_hi:[0,1]
 v_cvt_pk_bf16_f32 v107, v134, v135
 v_cvt_pk_bf16_f32 v111, v138, v139
 v_cvt_pk_bf16_f32 v115, v142, v143
 v_pk_fma_f32 v[144:145], v[146:147], v[102:103], v[144:145] op_sel:[1,1,0] op_sel_hi:[1,0,1] neg_lo:[0,1,0] neg_hi:[0,1,0]
 v_cvt_pk_bf16_f32 v119, v144, v145
 s_add_u32 s95, s95, 1
 s_cmp_lt_u32 s95, 8
 v_mfma_f32_16x16x32_bf16 v[120:123], v[104:107], v[116:119], v[120:123]
 v_mfma_f32_16x16x32_bf16 v[124:127], v[108:111], v[116:119], v[124:127]
 v_mfma_f32_16x16x32_bf16 v[128:131], v[112:115], v[116:119], v[128:131]
 s_cbranch_scc1 L_cgb_kg2
 s_waitcnt vmcnt(16)
 ds_read_b64_tr_b16 a[16:17], v41 offset:0
 ds_read_b64_tr_b16 a[18:19], v41 offset:128
 ds_read_b64_tr_b16 a[20:21], v41 offset:2048
 ds_read_b64_tr_b16 a[22:23], v41 offset:2176
 ds_read_b64_tr_b16 a[24:25], v41 offset:32
 ds_read_b64_tr_b16 a[26:27], v41 offset:160
 ds_read_b64_tr_b16 a[28:29], v41 offset:2080
 ds_read_b64_tr_b16 a[30:31], v41 offset:2208
 s_waitcnt lgkmcnt(0)
 ds_read_b64_tr_b16 a[64:65], v41 offset:4096
 ds_read_b64_tr_b16 a[66:67], v41 offset:4224
 ds_read_b64_tr_b16 a[68:69], v41 offset:6144
 ds_read_b64_tr_b16 a[70:71], v41 offset:6272
 ds_read_b64_tr_b16 a[72:73], v41 offset:4128
 ds_read_b64_tr_b16 a[74:75], v41 offset:4256
 ds_read_b64_tr_b16 a[76:77], v41 offset:6176
 ds_read_b64_tr_b16 a[78:79], v41 offset:6304
 s_waitcnt lgkmcnt(0)
 s_mov_b64 s[8:9], s[20:21]
 s_add_u32 m0, s48, 0
 s_add_u32 s59, s44, 0
 buffer_load_dwordx4 v39, s[8:11], s59 offen  lds
 s_add_u32 m0, s48, 1024
 s_add_u32 s59, s44, 131072
 buffer_load_dwordx4 v39, s[8:11], s59 offen  lds
 s_add_u32 m0, s49, 2048
 s_add_u32 s59, s45, 262144
 buffer_load_dwordx4 v39, s[8:11], s59 offen  lds
 s_add_u32 m0, s49, 3072
 s_add_u32 s59, s45, 393216
 buffer_load_dwordx4 v39, s[8:11], s59 offen  lds
 s_add_u32 m0, s48, 4096
 s_add_u32 s59, s44, 524288
 buffer_load_dwordx4 v39, s[8:11], s59 offen  lds
 s_add_u32 m0, s48, 5120
 s_add_u32 s59, s44, 655360
 buffer_load_dwordx4 v39, s[8:11], s59 offen  lds
 s_add_u32 m0, s49, 6144
 s_add_u32 s59, s45, 786432
 buffer_load_dwordx4 v39, s[8:11], s59 offen  lds
 s_add_u32 m0, s49, 7168
 s_add_u32 s59, s45, 917504
 buffer_load_dwordx4 v39, s[8:11], s59 offen  lds
 v_lshlrev_b32 v65, 5, v67
 v_lshl_add_u32 v65, v68, 3, v65
 v_add_u32 v65, s94, v65
 v_lshlrev_b32 v66, 4, v67
 v_lshl_add_u32 v66, v68, 3, v66
 v_lshlrev_b32 v69, 3, v67
 v_lshl_add_u32 v69, v68, 7, v69
 v_cmp_gt_u32 vcc, 2, v68
 s_nop 1
 v_cndmask_b32 v66, v69, v66, vcc
 v_add_u32 v66, s94, v66
 v_lshlrev_b32 v69, 2, v67
 v_lshl_add_u32 v69, v68, 7, v69
 v_add_u32 v69, s94, v69
 v_cvt_pk_bf16_f32 v132, v120, v121
 v_cvt_pk_bf16_f32 v133, v122, v123
 v_cvt_pk_bf16_f32 v134, v124, v125
 v_cvt_pk_bf16_f32 v135, v126, v127
 v_cvt_pk_bf16_f32 v136, v128, v129
 v_cvt_pk_bf16_f32 v137, v130, v131
 ds_write_b64 v65, v[132:133]
 ds_write_b64 v66, v[134:135] offset:512
 ds_write_b32 v69, v136 offset:1024
 ds_write_b32 v69, v137 offset:1088
 v_lshrrev_b32 v65, 2, v0
 v_mul_u32_u24 v65, 80, v65
 v_and_b32 v66, 3, v0
 v_lshl_add_u32 v69, v66, 4, v65
 v_add_u32 v69, 82256, v69
 v_add_u32 v215, 43776, v69
 s_waitcnt vmcnt(16)
 v_perm_b32 v140, v74, v72, s96
 v_perm_b32 v141, v78, v76, s96
 v_perm_b32 v142, v82, v80, s96
 v_perm_b32 v143, v86, v84, s96
 ds_write_b128 v69, v[140:143] offset:0
 v_perm_b32 v144, v74, v72, s97
 v_perm_b32 v145, v78, v76, s97
 v_perm_b32 v146, v82, v80, s97
 v_perm_b32 v147, v86, v84, s97
 ds_write_b128 v69, v[144:147] offset:21888
 v_perm_b32 v148, v75, v73, s96
 v_perm_b32 v149, v79, v77, s96
 v_perm_b32 v150, v83, v81, s96
 v_perm_b32 v151, v87, v85, s96
 ds_write_b128 v215, v[148:151] offset:0
 v_perm_b32 v152, v75, v73, s97
 v_perm_b32 v153, v79, v77, s97
 v_perm_b32 v154, v83, v81, s97
 v_perm_b32 v155, v87, v85, s97
 ds_write_b128 v215, v[152:155] offset:21888
 v_lshlrev_b32 v65, 3, v64
 v_sub_u32 v65, 2047, v65
 v_cvt_f32_u32 v66, v65
 s_sub_u32 s92, s94, 34048
 s_waitcnt lgkmcnt(0)
 v_subrev_f32 v120, 0x0, v66
 v_subrev_f32 v121, 0x3f800000, v66
 v_cvt_pk_bf16_f32 v122, v120, v121
 v_and_b32 v120, 0xffff, v122
 v_lshrrev_b32 v121, 16, v122
 v_lshl_add_u32 v132, v120, 1, s92
 v_lshl_add_u32 v133, v121, 1, s92
 v_subrev_f32 v120, 0x40000000, v66
 v_subrev_f32 v121, 0x40400000, v66
 v_cvt_pk_bf16_f32 v122, v120, v121
 v_and_b32 v120, 0xffff, v122
 v_lshrrev_b32 v121, 16, v122
 v_lshl_add_u32 v134, v120, 1, s92
 v_lshl_add_u32 v135, v121, 1, s92
 v_subrev_f32 v120, 0x40800000, v66
 v_subrev_f32 v121, 0x40a00000, v66
 v_cvt_pk_bf16_f32 v122, v120, v121
 v_and_b32 v120, 0xffff, v122
 v_lshrrev_b32 v121, 16, v122
 v_lshl_add_u32 v136, v120, 1, s92
 v_lshl_add_u32 v137, v121, 1, s92
 v_subrev_f32 v120, 0x40c00000, v66
 v_subrev_f32 v121, 0x40e00000, v66
 v_cvt_pk_bf16_f32 v122, v120, v121
 v_and_b32 v120, 0xffff, v122
 v_lshrrev_b32 v121, 16, v122
 v_lshl_add_u32 v138, v120, 1, s92
 v_lshl_add_u32 v139, v121, 1, s92
 s_waitcnt lgkmcnt(0)
 ds_read_u16 v88, v132
 ds_read_u16 v92, v133
 ds_read_u16 v89, v134
 ds_read_u16 v93, v135
 ds_read_u16 v90, v136
 ds_read_u16 v94, v137
 ds_read_u16 v91, v138
 ds_read_u16 v95, v139
 v_subrev_f32 v120, 0x44000000, v66
 v_subrev_f32 v121, 0x44004000, v66
 v_cvt_pk_bf16_f32 v122, v120, v121
 v_and_b32 v120, 0xffff, v122
 v_lshrrev_b32 v121, 16, v122
 v_lshl_add_u32 v132, v120, 1, s92
 v_lshl_add_u32 v133, v121, 1, s92
 v_subrev_f32 v120, 0x44008000, v66
 v_subrev_f32 v121, 0x4400c000, v66
 v_cvt_pk_bf16_f32 v122, v120, v121
 v_and_b32 v120, 0xffff, v122
 v_lshrrev_b32 v121, 16, v122
 v_lshl_add_u32 v134, v120, 1, s92
 v_lshl_add_u32 v135, v121, 1, s92
 v_subrev_f32 v120, 0x44010000, v66
 v_subrev_f32 v121, 0x44014000, v66
 v_cvt_pk_bf16_f32 v122, v120, v121
 v_and_b32 v120, 0xffff, v122
 v_lshrrev_b32 v121, 16, v122
 v_lshl_add_u32 v136, v120, 1, s92
 v_lshl_add_u32 v137, v121, 1, s92
 v_subrev_f32 v120, 0x44018000, v66
 v_subrev_f32 v121, 0x4401c000, v66
 v_cvt_pk_bf16_f32 v122, v120, v121
 v_and_b32 v120, 0xffff, v122
 v_lshrrev_b32 v121, 16, v122
 v_lshl_add_u32 v138, v120, 1, s92
 v_lshl_add_u32 v139, v121, 1, s92
 s_waitcnt lgkmcnt(0)
 ds_read_u16 v96, v132
 ds_read_u16 v100, v133
 ds_read_u16 v97, v134
 ds_read_u16 v101, v135
 ds_read_u16 v98, v136
 ds_read_u16 v102, v137
 ds_read_u16 v99, v138
 ds_read_u16 v103, v139
 v_subrev_f32 v120, 0x44800000, v66
 v_subrev_f32 v121, 0x44802000, v66
 v_cvt_pk_bf16_f32 v122, v120, v121
 v_and_b32 v120, 0xffff, v122
 v_lshrrev_b32 v121, 16, v122
 v_lshl_add_u32 v132, v120, 1, s92
 v_lshl_add_u32 v133, v121, 1, s92
 v_subrev_f32 v120, 0x44804000, v66
 v_subrev_f32 v121, 0x44806000, v66
 v_cvt_pk_bf16_f32 v122, v120, v121
 v_and_b32 v120, 0xffff, v122
 v_lshrrev_b32 v121, 16, v122
 v_lshl_add_u32 v134, v120, 1, s92
 v_lshl_add_u32 v135, v121, 1, s92
 v_subrev_f32 v120, 0x44808000, v66
 v_subrev_f32 v121, 0x4480a000, v66
 v_cvt_pk_bf16_f32 v122, v120, v121
 v_and_b32 v120, 0xffff, v122
 v_lshrrev_b32 v121, 16, v122
 v_lshl_add_u32 v136, v120, 1, s92
 v_lshl_add_u32 v137, v121, 1, s92
 v_subrev_f32 v120, 0x4480c000, v66
 v_subrev_f32 v121, 0x4480e000, v66
 v_cvt_pk_bf16_f32 v122, v120, v121
 v_and_b32 v120, 0xffff, v122
 v_lshrrev_b32 v121, 16, v122
 v_lshl_add_u32 v138, v120, 1, s92
 v_lshl_add_u32 v139, v121, 1, s92
 s_waitcnt lgkmcnt(0)
 ds_read_u16 v104, v132
 ds_read_u16 v108, v133
 ds_read_u16 v105, v134
 ds_read_u16 v109, v135
 ds_read_u16 v106, v136
 ds_read_u16 v110, v137
 ds_read_u16 v107, v138
 ds_read_u16 v111, v139
 v_subrev_f32 v120, 0x44c00000, v66
 v_subrev_f32 v121, 0x44c02000, v66
 v_cvt_pk_bf16_f32 v122, v120, v121
 v_and_b32 v120, 0xffff, v122
 v_lshrrev_b32 v121, 16, v122
 v_subrev_u32 v122, 1536, v65
 v_min_u32 v122, 128, v122
 v_add_u32 v122, 17024, v122
 v_max_u32 v120, v120, v122
 v_subrev_u32 v122, 1537, v65
 v_min_u32 v122, 128, v122
 v_add_u32 v122, 17024, v122
 v_max_u32 v121, v121, v122
 v_lshl_add_u32 v132, v120, 1, s92
 v_lshl_add_u32 v133, v121, 1, s92
 v_subrev_f32 v120, 0x44c04000, v66
 v_subrev_f32 v121, 0x44c06000, v66
 v_cvt_pk_bf16_f32 v122, v120, v121
 v_and_b32 v120, 0xffff, v122
 v_lshrrev_b32 v121, 16, v122
 v_subrev_u32 v122, 1538, v65
 v_min_u32 v122, 128, v122
 v_add_u32 v122, 17024, v122
 v_max_u32 v120, v120, v122
 v_subrev_u32 v122, 1539, v65
 v_min_u32 v122, 128, v122
 v_add_u32 v122, 17024, v122
 v_max_u32 v121, v121, v122
 v_lshl_add_u32 v134, v120, 1, s92
 v_lshl_add_u32 v135, v121, 1, s92
 v_subrev_f32 v120, 0x44c08000, v66
 v_subrev_f32 v121, 0x44c0a000, v66
 v_cvt_pk_bf16_f32 v122, v120, v121
 v_and_b32 v120, 0xffff, v122
 v_lshrrev_b32 v121, 16, v122
 v_subrev_u32 v122, 1540, v65
 v_min_u32 v122, 128, v122
 v_add_u32 v122, 17024, v122
 v_max_u32 v120, v120, v122
 v_subrev_u32 v122, 1541, v65
 v_min_u32 v122, 128, v122
 v_add_u32 v122, 17024, v122
 v_max_u32 v121, v121, v122
 v_lshl_add_u32 v136, v120, 1, s92
 v_lshl_add_u32 v137, v121, 1, s92
 v_subrev_f32 v120, 0x44c0c000, v66
 v_subrev_f32 v121, 0x44c0e000, v66
 v_cvt_pk_bf16_f32 v122, v120, v121
 v_and_b32 v120, 0xffff, v122
 v_lshrrev_b32 v121, 16, v122
 v_subrev_u32 v122, 1542, v65
 v_min_u32 v122, 128, v122
 v_add_u32 v122, 17024, v122
 v_max_u32 v120, v120, v122
 v_subrev_u32 v122, 1543, v65
 v_min_u32 v122, 128, v122
 v_add_u32 v122, 17024, v122
 v_max_u32 v121, v121, v122
 v_lshl_add_u32 v138, v120, 1, s92
 v_lshl_add_u32 v139, v121, 1, s92
 s_waitcnt lgkmcnt(0)
 ds_read_u16 v112, v132
 ds_read_u16 v116, v133
 ds_read_u16 v113, v134
 ds_read_u16 v117, v135
 ds_read_u16 v114, v136
 ds_read_u16 v118, v137
 ds_read_u16 v115, v138
 ds_read_u16 v119, v139
 v_lshl_add_u32 v65, v64, 4, s94
 v_mov_b32 v120, 0
 v_mov_b32 v121, 0
 v_mov_b32 v122, 0
 v_mov_b32 v123, 0
 v_lshrrev_b32 v66, 2, v64
 v_mul_u32_u24 v66, 4096, v66
 v_add_u32 v66, 4096, v66
 v_cmp_gt_u32 vcc, 16, v64
 v_mov_b32 v67, 16384
 s_nop 0
 v_cndmask_b32 v66, v67, v66, vcc
 v_add_u32 v66, v66, v65
 s_waitcnt lgkmcnt(0)
 s_mov_b64 exec, 0x1fffff
 ds_write_b128 v66, v[120:123]
 s_mov_b64 exec, -1
 v_lshl_or_b32 v88, v92, 16, v88
 v_lshl_or_b32 v89, v93, 16, v89
 v_lshl_or_b32 v90, v94, 16, v90
 v_lshl_or_b32 v91, v95, 16, v91
 ds_write_b128 v65, v[88:91] offset:12480
 v_lshl_or_b32 v96, v100, 16, v96
 v_lshl_or_b32 v97, v101, 16, v97
 v_lshl_or_b32 v98, v102, 16, v98
 v_lshl_or_b32 v99, v103, 16, v99
 ds_write_b128 v65, v[96:99] offset:13504
 v_lshl_or_b32 v104, v108, 16, v104
 v_lshl_or_b32 v105, v109, 16, v105
 v_lshl_or_b32 v106, v110, 16, v106
 v_lshl_or_b32 v107, v111, 16, v107
 ds_write_b128 v65, v[104:107] offset:14528
 v_lshl_or_b32 v112, v116, 16, v112
 v_lshl_or_b32 v113, v117, 16, v113
 v_lshl_or_b32 v114, v118, 16, v114
 v_lshl_or_b32 v115, v119, 16, v115
 ds_write_b128 v65, v[112:115] offset:15552
 s_waitcnt lgkmcnt(0)
 ds_read_b64 v[92:93], v65 offset:12496
 ds_read_b64 v[100:101], v65 offset:13520
 ds_read_b64 v[108:109], v65 offset:14544
 ds_read_b64 v[116:117], v65 offset:15568
 s_waitcnt lgkmcnt(0)
 v_alignbit_b32 v132, v89, v88, 16
 v_mov_b32 v136, v89
 v_alignbit_b32 v140, v90, v89, 16
 v_alignbit_b32 v133, v90, v89, 16
 v_mov_b32 v137, v90
 v_alignbit_b32 v141, v91, v90, 16
 v_alignbit_b32 v134, v91, v90, 16
 v_mov_b32 v138, v91
 v_alignbit_b32 v142, v92, v91, 16
 v_alignbit_b32 v135, v92, v91, 16
 v_mov_b32 v139, v92
 v_alignbit_b32 v143, v93, v92, 16
 ds_write_b128 v65, v[132:135] offset:8320
 ds_write_b128 v65, v[136:139] offset:4160
 ds_write_b128 v65, v[140:143] offset:0
 v_alignbit_b32 v144, v97, v96, 16
 v_mov_b32 v148, v97
 v_alignbit_b32 v152, v98, v97, 16
 v_alignbit_b32 v145, v98, v97, 16
 v_mov_b32 v149, v98
 v_alignbit_b32 v153, v99, v98, 16
 v_alignbit_b32 v146, v99, v98, 16
 v_mov_b32 v150, v99
 v_alignbit_b32 v154, v100, v99, 16
 v_alignbit_b32 v147, v100, v99, 16
 v_mov_b32 v151, v100
 v_alignbit_b32 v155, v101, v100, 16
 ds_write_b128 v65, v[144:147] offset:9344
 ds_write_b128 v65, v[148:151] offset:5184
 ds_write_b128 v65, v[152:155] offset:1024
 v_alignbit_b32 v132, v105, v104, 16
 v_mov_b32 v136, v105
 v_alignbit_b32 v140, v106, v105, 16
 v_alignbit_b32 v133, v106, v105, 16
 v_mov_b32 v137, v106
 v_alignbit_b32 v141, v107, v106, 16
 v_alignbit_b32 v134, v107, v106, 16
 v_mov_b32 v138, v107
 v_alignbit_b32 v142, v108, v107, 16
 v_alignbit_b32 v135, v108, v107, 16
 v_mov_b32 v139, v108
 v_alignbit_b32 v143, v109, v108, 16
 ds_write_b128 v65, v[132:135] offset:10368
 ds_write_b128 v65, v[136:139] offset:6208
 ds_write_b128 v65, v[140:143] offset:2048
 v_alignbit_b32 v144, v113, v112, 16
 v_mov_b32 v148, v113
 v_alignbit_b32 v152, v114, v113, 16
 v_alignbit_b32 v145, v114, v113, 16
 v_mov_b32 v149, v114
 v_alignbit_b32 v153, v115, v114, 16
 v_alignbit_b32 v146, v115, v114, 16
 v_mov_b32 v150, v115
 v_alignbit_b32 v154, v116, v115, 16
 v_alignbit_b32 v147, v116, v115, 16
 v_mov_b32 v151, v116
 v_alignbit_b32 v155, v117, v116, 16
 ds_write_b128 v65, v[144:147] offset:11392
 ds_write_b128 v65, v[148:151] offset:7232
 ds_write_b128 v65, v[152:155] offset:3072
 v_and_b32 v66, 3, v64
 v_mul_u32_u24 v65, 4160, v66
 v_bfe_u32 v66, v64, 3, 1
 v_bfe_u32 v67, v64, 2, 1
 v_lshl_add_u32 v66, v67, 1, v66
 v_bfe_u32 v67, v64, 4, 1
 v_lshl_add_u32 v66, v67, 2, v66
 v_lshlrev_b32 v66, 3, v66
 v_sub_u32 v65, v65, v66
 v_lshrrev_b32 v67, 5, v64
 v_lshl_add_u32 v65, v67, 4, v65
 s_add_u32 s92, s94, 2040
 v_add_u32 v65, s92, v65
 v_and_b32 v66, 31, v64
 v_mul_u32_u24 v66, 80, v66
 v_lshl_add_u32 v67, v67, 4, v66
 s_add_u32 s92, s94, 16720
 v_add_u32 v67, s92, v67
 v_mov_b32 v214, v67
 v_mov_b32 v68, v67
 s_sub_u32 s93, s92, 80
 v_mov_b32 v88, 0
 v_mov_b32 v89, 0
 v_mov_b32 v90, 0
 v_mov_b32 v91, 0
 v_mov_b32 v92, 0
 v_mov_b32 v93, 0
 v_mov_b32 v94, 0
 v_mov_b32 v95, 0
 v_mov_b32 v96, 0
 v_mov_b32 v97, 0
 v_mov_b32 v98, 0
 v_mov_b32 v99, 0
 v_mov_b32 v100, 0
 v_mov_b32 v101, 0
 v_mov_b32 v102, 0
 v_mov_b32 v103, 0
 v_mov_b32 v104, 0
 v_mov_b32 v105, 0
 v_mov_b32 v106, 0
 v_mov_b32 v107, 0
 v_mov_b32 v108, 0
 v_mov_b32 v109, 0
 v_mov_b32 v110, 0
 v_mov_b32 v111, 0
 v_mov_b32 v112, 0
 v_mov_b32 v113, 0
 v_mov_b32 v114, 0
 v_mov_b32 v115, 0
 v_mov_b32 v116, 0
 v_mov_b32 v117, 0
 v_mov_b32 v118, 0
 v_mov_b32 v119, 0
 s_waitcnt lgkmcnt(0)
 s_barrier
 s_waitcnt vmcnt(8)
 ds_read_b64_tr_b16 a[112:113], v41 offset:32768
 ds_read_b64_tr_b16 a[114:115], v41 offset:32896
 ds_read_b64_tr_b16 a[116:117], v41 offset:34816
 ds_read_b64_tr_b16 a[118:119], v41 offset:34944
 ds_read_b64_tr_b16 a[120:121], v41 offset:32800
 ds_read_b64_tr_b16 a[122:123], v41 offset:32928
 ds_read_b64_tr_b16 a[124:125], v41 offset:34848
 ds_read_b64_tr_b16 a[126:127], v41 offset:34976
 s_waitcnt lgkmcnt(0)
 ds_read_b64_tr_b16 a[160:161], v41 offset:36864
 ds_read_b64_tr_b16 a[162:163], v41 offset:36992
 ds_read_b64_tr_b16 a[164:165], v41 offset:38912
 ds_read_b64_tr_b16 a[166:167], v41 offset:39040
 ds_read_b64_tr_b16 a[168:169], v41 offset:36896
 ds_read_b64_tr_b16 a[170:171], v41 offset:37024
 ds_read_b64_tr_b16 a[172:173], v41 offset:38944
 ds_read_b64_tr_b16 a[174:175], v41 offset:39072
 s_waitcnt lgkmcnt(0)
 s_add_u32 m0, s48, 32768
 s_add_u32 s59, s44, 1048576
 buffer_load_dwordx4 v39, s[8:11], s59 offen  lds
 s_add_u32 m0, s48, 33792
 s_add_u32 s59, s44, 1179648
 buffer_load_dwordx4 v39, s[8:11], s59 offen  lds
 s_add_u32 m0, s49, 34816
 s_add_u32 s59, s45, 1310720
 buffer_load_dwordx4 v39, s[8:11], s59 offen  lds
 s_add_u32 m0, s49, 35840
 s_add_u32 s59, s45, 1441792
 buffer_load_dwordx4 v39, s[8:11], s59 offen  lds
 s_add_u32 m0, s48, 36864
 s_add_u32 s59, s44, 1572864
 buffer_load_dwordx4 v39, s[8:11], s59 offen  lds
 s_add_u32 m0, s48, 37888
 s_add_u32 s59, s44, 1703936
 buffer_load_dwordx4 v39, s[8:11], s59 offen  lds
 s_add_u32 m0, s49, 38912
 s_add_u32 s59, s45, 1835008
 buffer_load_dwordx4 v39, s[8:11], s59 offen  lds
 s_add_u32 m0, s49, 39936
 s_add_u32 s59, s45, 1966080
 buffer_load_dwordx4 v39, s[8:11], s59 offen  lds
 v_mov_b32 v216, s34
 v_mov_b32 v217, s35
 v_bfrev_b32 v218, 1
 v_cmp_eq_u32 vcc, 64, v0
 s_nop 1
 v_cndmask_b32 v218, v218, 0, vcc
 buffer_atomic_add_x2 v[216:217], v218, s[12:15], s30 offen sc1
 ds_read_b64 v[120:121], v65 offset:2080
 ds_read_b64 v[122:123], v65 offset:2088
 ds_read_b128 v[128:131], v67 offset:2592
 ds_read_b128 v[132:135], v68 offset:32
 ds_read_b64 v[124:125], v65 offset:32
 ds_read_b64 v[126:127], v65 offset:40
 s_mov_b32 s95, 0
L_cgb_cv0:
 ds_read_b64 v[136:137], v65 offset:2048
 ds_read_b64 v[138:139], v65 offset:2056
 ds_read_b128 v[144:147], v67 offset:2560
 ds_read_b128 v[148:151], v68 offset:0
 ds_read_b64 v[140:141], v65 offset:0
 ds_read_b64 v[142:143], v65 offset:8
 s_waitcnt lgkmcnt(6)
 v_mfma_f32_32x32x16_bf16 v[104:119], v[120:123], v[128:131], v[104:119]
 v_subrev_u32 v65, 64, v65
 v_subrev_u32 v67, 80, v67
 v_max_i32 v68, s93, v67
 v_mfma_f32_32x32x16_bf16 v[88:103], v[120:123], v[132:135], v[88:103]
 v_mfma_f32_32x32x16_bf16 v[104:119], v[124:127], v[132:135], v[104:119]
 ds_read_b64 v[120:121], v65 offset:2080
 ds_read_b64 v[122:123], v65 offset:2088
 ds_read_b128 v[128:131], v67 offset:2592
 ds_read_b128 v[132:135], v68 offset:32
 ds_read_b64 v[124:125], v65 offset:32
 ds_read_b64 v[126:127], v65 offset:40
 s_waitcnt lgkmcnt(6)
 v_mfma_f32_32x32x16_bf16 v[104:119], v[136:139], v[144:147], v[104:119]
 s_add_u32 s95, s95, 1
 s_cmp_lt_u32 s95, 8
 v_mfma_f32_32x32x16_bf16 v[88:103], v[136:139], v[148:151], v[88:103]
 v_mfma_f32_32x32x16_bf16 v[104:119], v[140:143], v[148:151], v[104:119]
 s_cbranch_scc1 L_cgb_cv0
 s_waitcnt vmcnt(9)
 ds_read_b64_tr_b16 a[32:33], v41 offset:0
 ds_read_b64_tr_b16 a[34:35], v41 offset:128
 ds_read_b64_tr_b16 a[36:37], v41 offset:2048
 ds_read_b64_tr_b16 a[38:39], v41 offset:2176
 ds_read_b64_tr_b16 a[40:41], v41 offset:32
 ds_read_b64_tr_b16 a[42:43], v41 offset:160
 ds_read_b64_tr_b16 a[44:45], v41 offset:2080
 ds_read_b64_tr_b16 a[46:47], v41 offset:2208
 s_waitcnt lgkmcnt(0)
 ds_read_b64_tr_b16 a[80:81], v41 offset:4096
 ds_read_b64_tr_b16 a[82:83], v41 offset:4224
 ds_read_b64_tr_b16 a[84:85], v41 offset:6144
 ds_read_b64_tr_b16 a[86:87], v41 offset:6272
 ds_read_b64_tr_b16 a[88:89], v41 offset:4128
 ds_read_b64_tr_b16 a[90:91], v41 offset:4256
 ds_read_b64_tr_b16 a[92:93], v41 offset:6176
 ds_read_b64_tr_b16 a[94:95], v41 offset:6304
 s_waitcnt lgkmcnt(0)
 s_mov_b64 s[8:9], s[22:23]
 s_add_u32 m0, s48, 0
 s_add_u32 s59, s46, 0
 buffer_load_dwordx4 v40, s[8:11], s59 offen  lds
 s_add_u32 m0, s48, 1024
 s_add_u32 s59, s46, 32768
 buffer_load_dwordx4 v40, s[8:11], s59 offen  lds
 s_add_u32 m0, s49, 2048
 s_add_u32 s59, s47, 65536
 buffer_load_dwordx4 v40, s[8:11], s59 offen  lds
 s_add_u32 m0, s49, 3072
 s_add_u32 s59, s47, 98304
 buffer_load_dwordx4 v40, s[8:11], s59 offen  lds
 s_add_u32 m0, s48, 4096
 s_add_u32 s59, s46, 131072
 buffer_load_dwordx4 v40, s[8:11], s59 offen  lds
 s_add_u32 m0, s48, 5120
 s_add_u32 s59, s46, 163840
 buffer_load_dwordx4 v40, s[8:11], s59 offen  lds
 s_add_u32 m0, s49, 6144
 s_add_u32 s59, s47, 196608
 buffer_load_dwordx4 v40, s[8:11], s59 offen  lds
 s_add_u32 m0, s49, 7168
 s_add_u32 s59, s47, 229376
 buffer_load_dwordx4 v40, s[8:11], s59 offen  lds
 s_mov_b32 s95, 0
L_cgb_cv1:
 ds_read_b64 v[136:137], v65 offset:2048
 ds_read_b64 v[138:139], v65 offset:2056
 ds_read_b128 v[144:147], v67 offset:2560
 ds_read_b128 v[148:151], v68 offset:0
 ds_read_b64 v[140:141], v65 offset:0
 ds_read_b64 v[142:143], v65 offset:8
 s_waitcnt lgkmcnt(6)
 v_mfma_f32_32x32x16_bf16 v[104:119], v[120:123], v[128:131], v[104:119]
 v_subrev_u32 v65, 64, v65
 v_subrev_u32 v67, 80, v67
 v_max_i32 v68, s93, v67
 v_mfma_f32_32x32x16_bf16 v[88:103], v[120:123], v[132:135], v[88:103]
 v_mfma_f32_32x32x16_bf16 v[104:119], v[124:127], v[132:135], v[104:119]
 ds_read_b64 v[120:121], v65 offset:2080
 ds_read_b64 v[122:123], v65 offset:2088
 ds_read_b128 v[128:131], v67 offset:2592
 ds_read_b128 v[132:135], v68 offset:32
 ds_read_b64 v[124:125], v65 offset:32
 ds_read_b64 v[126:127], v65 offset:40
 s_waitcnt lgkmcnt(6)
 v_mfma_f32_32x32x16_bf16 v[104:119], v[136:139], v[144:147], v[104:119]
 s_add_u32 s95, s95, 1
 s_cmp_lt_u32 s95, 8
 v_mfma_f32_32x32x16_bf16 v[88:103], v[136:139], v[148:151], v[88:103]
 v_mfma_f32_32x32x16_bf16 v[104:119], v[140:143], v[148:151], v[104:119]
 s_cbranch_scc1 L_cgb_cv1
 s_waitcnt vmcnt(9)
 ds_read_b64_tr_b16 a[128:129], v41 offset:32768
 ds_read_b64_tr_b16 a[130:131], v41 offset:32896
 ds_read_b64_tr_b16 a[132:133], v41 offset:34816
 ds_read_b64_tr_b16 a[134:135], v41 offset:34944
 ds_read_b64_tr_b16 a[136:137], v41 offset:32800
 ds_read_b64_tr_b16 a[138:139], v41 offset:32928
 ds_read_b64_tr_b16 a[140:141], v41 offset:34848
 ds_read_b64_tr_b16 a[142:143], v41 offset:34976
 s_waitcnt lgkmcnt(0)
 ds_read_b64_tr_b16 a[176:177], v41 offset:36864
 ds_read_b64_tr_b16 a[178:179], v41 offset:36992
 ds_read_b64_tr_b16 a[180:181], v41 offset:38912
 ds_read_b64_tr_b16 a[182:183], v41 offset:39040
 ds_read_b64_tr_b16 a[184:185], v41 offset:36896
 ds_read_b64_tr_b16 a[186:187], v41 offset:37024
 ds_read_b64_tr_b16 a[188:189], v41 offset:38944
 ds_read_b64_tr_b16 a[190:191], v41 offset:39072
 s_waitcnt lgkmcnt(0)
 s_add_u32 m0, s48, 32768
 s_add_u32 s59, s46, 262144
 buffer_load_dwordx4 v40, s[8:11], s59 offen  lds
 s_add_u32 m0, s48, 33792
 s_add_u32 s59, s46, 294912
 buffer_load_dwordx4 v40, s[8:11], s59 offen  lds
 s_add_u32 m0, s49, 34816
 s_add_u32 s59, s47, 327680
 buffer_load_dwordx4 v40, s[8:11], s59 offen  lds
 s_add_u32 m0, s49, 35840
 s_add_u32 s59, s47, 360448
 buffer_load_dwordx4 v40, s[8:11], s59 offen  lds
 s_add_u32 m0, s48, 36864
 s_add_u32 s59, s46, 393216
 buffer_load_dwordx4 v40, s[8:11], s59 offen  lds
 s_add_u32 m0, s48, 37888
 s_add_u32 s59, s46, 425984
 buffer_load_dwordx4 v40, s[8:11], s59 offen  lds
 s_add_u32 m0, s49, 38912
 s_add_u32 s59, s47, 458752
 buffer_load_dwordx4 v40, s[8:11], s59 offen  lds
 s_add_u32 m0, s49, 39936
 s_add_u32 s59, s47, 491520
 buffer_load_dwordx4 v40, s[8:11], s59 offen  lds
 s_mov_b32 s95, 0
L_cgb_cv2:
 ds_read_b64 v[136:137], v65 offset:2048
 ds_read_b64 v[138:139], v65 offset:2056
 ds_read_b128 v[144:147], v67 offset:2560
 ds_read_b128 v[148:151], v68 offset:0
 ds_read_b64 v[140:141], v65 offset:0
 ds_read_b64 v[142:143], v65 offset:8
 s_waitcnt lgkmcnt(6)
 v_mfma_f32_32x32x16_bf16 v[104:119], v[120:123], v[128:131], v[104:119]
 v_subrev_u32 v65, 64, v65
 v_subrev_u32 v67, 80, v67
 v_max_i32 v68, s93, v67
 v_mfma_f32_32x32x16_bf16 v[88:103], v[120:123], v[132:135], v[88:103]
 v_mfma_f32_32x32x16_bf16 v[104:119], v[124:127], v[132:135], v[104:119]
 ds_read_b64 v[120:121], v65 offset:2080
 ds_read_b64 v[122:123], v65 offset:2088
 ds_read_b128 v[128:131], v67 offset:2592
 ds_read_b128 v[132:135], v68 offset:32
 ds_read_b64 v[124:125], v65 offset:32
 ds_read_b64 v[126:127], v65 offset:40
 s_waitcnt lgkmcnt(6)
 v_mfma_f32_32x32x16_bf16 v[104:119], v[136:139], v[144:147], v[104:119]
 s_add_u32 s95, s95, 1
 s_cmp_lt_u32 s95, 8
 v_mfma_f32_32x32x16_bf16 v[88:103], v[136:139], v[148:151], v[88:103]
 v_mfma_f32_32x32x16_bf16 v[104:119], v[140:143], v[148:151], v[104:119]
 s_cbranch_scc1 L_cgb_cv2
 s_waitcnt vmcnt(8)
 s_barrier
 ds_read_b64_tr_b16 a[192:193], v38 offset:0
 ds_read_b64_tr_b16 a[194:195], v38 offset:128
 ds_read_b64_tr_b16 a[196:197], v38 offset:2048
 ds_read_b64_tr_b16 a[198:199], v38 offset:2176
 ds_read_b64_tr_b16 a[200:201], v38 offset:4096
 ds_read_b64_tr_b16 a[202:203], v38 offset:4224
 ds_read_b64_tr_b16 a[204:205], v38 offset:6144
 ds_read_b64_tr_b16 a[206:207], v38 offset:6272
 s_waitcnt lgkmcnt(0)
 ds_read_b64_tr_b16 a[208:209], v38 offset:8192
 ds_read_b64_tr_b16 a[210:211], v38 offset:8320
 ds_read_b64_tr_b16 a[212:213], v38 offset:10240
 ds_read_b64_tr_b16 a[214:215], v38 offset:10368
 ds_read_b64_tr_b16 a[216:217], v38 offset:12288
 ds_read_b64_tr_b16 a[218:219], v38 offset:12416
 ds_read_b64_tr_b16 a[220:221], v38 offset:14336
 ds_read_b64_tr_b16 a[222:223], v38 offset:14464
 s_waitcnt lgkmcnt(0)
 ds_read_b64_tr_b16 a[224:225], v38 offset:16384
 ds_read_b64_tr_b16 a[226:227], v38 offset:16512
 ds_read_b64_tr_b16 a[228:229], v38 offset:18432
 ds_read_b64_tr_b16 a[230:231], v38 offset:18560
 ds_read_b64_tr_b16 a[232:233], v38 offset:20480
 ds_read_b64_tr_b16 a[234:235], v38 offset:20608
 ds_read_b64_tr_b16 a[236:237], v38 offset:22528
 ds_read_b64_tr_b16 a[238:239], v38 offset:22656
 s_waitcnt lgkmcnt(0)
 ds_read_b64_tr_b16 a[240:241], v38 offset:24576
 ds_read_b64_tr_b16 a[242:243], v38 offset:24704
 ds_read_b64_tr_b16 a[244:245], v38 offset:26624
 ds_read_b64_tr_b16 a[246:247], v38 offset:26752
 ds_read_b64_tr_b16 a[248:249], v38 offset:28672
 ds_read_b64_tr_b16 a[250:251], v38 offset:28800
 ds_read_b64_tr_b16 a[252:253], v38 offset:30720
 ds_read_b64_tr_b16 a[254:255], v38 offset:30848
 s_waitcnt lgkmcnt(0)
 s_mov_b32 s95, 0
L_cgb_cv3:
 ds_read_b64 v[136:137], v65 offset:2048
 ds_read_b64 v[138:139], v65 offset:2056
 ds_read_b128 v[144:147], v67 offset:2560
 ds_read_b128 v[148:151], v68 offset:0
 ds_read_b64 v[140:141], v65 offset:0
 ds_read_b64 v[142:143], v65 offset:8
 s_waitcnt lgkmcnt(6)
 v_mfma_f32_32x32x16_bf16 v[104:119], v[120:123], v[128:131], v[104:119]
 v_subrev_u32 v65, 64, v65
 v_subrev_u32 v67, 80, v67
 v_max_i32 v68, s93, v67
 v_mfma_f32_32x32x16_bf16 v[88:103], v[120:123], v[132:135], v[88:103]
 v_mfma_f32_32x32x16_bf16 v[104:119], v[124:127], v[132:135], v[104:119]
 ds_read_b64 v[120:121], v65 offset:2080
 ds_read_b64 v[122:123], v65 offset:2088
 ds_read_b128 v[128:131], v67 offset:2592
 ds_read_b128 v[132:135], v68 offset:32
 ds_read_b64 v[124:125], v65 offset:32
 ds_read_b64 v[126:127], v65 offset:40
 s_waitcnt lgkmcnt(6)
 v_mfma_f32_32x32x16_bf16 v[104:119], v[136:139], v[144:147], v[104:119]
 s_add_u32 s95, s95, 1
 s_cmp_lt_u32 s95, 8
 v_mfma_f32_32x32x16_bf16 v[88:103], v[136:139], v[148:151], v[88:103]
 v_mfma_f32_32x32x16_bf16 v[104:119], v[140:143], v[148:151], v[104:119]
 s_cbranch_scc1 L_cgb_cv3
 s_load_dwordx2 s[84:85], s[0:1], 128
 s_mov_b32 s86, 8388608
 s_mov_b32 s87, 0x20000
 s_lshl_b32 s90, s89, 16
 s_and_b32 s91, s89, s98
 s_and_b32 s89, s88, s98
 s_lshl_b32 s88, s88, 16
 v_lshlrev_b32 v70, 1, v70
 s_lshl_b32 s93, s28, 3
 s_add_u32 s93, s93, 2048
 s_waitcnt lgkmcnt(0)
 s_nop 1
 v_cvt_pk_bf16_f32 v152, v88, v89
 v_cvt_pk_bf16_f32 v153, v90, v91
 v_cvt_pk_bf16_f32 v154, v92, v93
 v_cvt_pk_bf16_f32 v155, v94, v95
 v_cvt_pk_bf16_f32 v156, v96, v97
 v_cvt_pk_bf16_f32 v157, v98, v99
 v_cvt_pk_bf16_f32 v158, v100, v101
 v_cvt_pk_bf16_f32 v159, v102, v103
 ds_write_b128 v214, v[152:155] offset:0
 ds_write_b128 v214, v[156:159] offset:32
 v_cvt_pk_bf16_f32 v160, v104, v105
 v_cvt_pk_bf16_f32 v161, v106, v107
 v_cvt_pk_bf16_f32 v162, v108, v109
 v_cvt_pk_bf16_f32 v163, v110, v111
 v_cvt_pk_bf16_f32 v164, v112, v113
 v_cvt_pk_bf16_f32 v165, v114, v115
 v_cvt_pk_bf16_f32 v166, v116, v117
 v_cvt_pk_bf16_f32 v167, v118, v119
 ds_write_b128 v214, v[160:163] offset:2560
 ds_write_b128 v214, v[164:167] offset:2592
 s_waitcnt lgkmcnt(0)
 s_barrier
 ds_read_b128 v[88:91], v69 offset:0
 ds_read_b128 v[92:95], v69 offset:21888
 ds_read_b128 v[96:99], v215 offset:0
 ds_read_b128 v[100:103], v215 offset:21888
 v_lshlrev_b32 v104, 16, v72
 v_and_b32 v105, s98, v72
 v_pk_mul_f32 v[104:105], v[104:105], s[88:89]
 v_cvt_pk_bf16_f32 v72, v104, v105
 v_lshlrev_b32 v104, 16, v72
 v_and_b32 v105, s98, v72
 v_lshlrev_b32 v106, 16, v73
 v_and_b32 v107, s98, v73
 v_pk_mul_f32 v[106:107], v[106:107], s[90:91]
 v_cvt_pk_bf16_f32 v73, v106, v107
 v_lshlrev_b32 v106, 16, v73
 v_and_b32 v107, s98, v73
 v_lshlrev_b32 v108, 16, v74
 v_and_b32 v109, s98, v74
 v_pk_mul_f32 v[108:109], v[108:109], s[88:89]
 v_cvt_pk_bf16_f32 v74, v108, v109
 v_lshlrev_b32 v108, 16, v74
 v_and_b32 v109, s98, v74
 v_lshlrev_b32 v110, 16, v75
 v_and_b32 v111, s98, v75
 v_pk_mul_f32 v[110:111], v[110:111], s[90:91]
 v_cvt_pk_bf16_f32 v75, v110, v111
 v_lshlrev_b32 v110, 16, v75
 v_and_b32 v111, s98, v75
 v_lshlrev_b32 v112, 16, v76
 v_and_b32 v113, s98, v76
 v_pk_mul_f32 v[112:113], v[112:113], s[88:89]
 v_cvt_pk_bf16_f32 v76, v112, v113
 v_lshlrev_b32 v112, 16, v76
 v_and_b32 v113, s98, v76
 v_lshlrev_b32 v114, 16, v77
 v_and_b32 v115, s98, v77
 v_pk_mul_f32 v[114:115], v[114:115], s[90:91]
 v_cvt_pk_bf16_f32 v77, v114, v115
 v_lshlrev_b32 v114, 16, v77
 v_and_b32 v115, s98, v77
 v_lshlrev_b32 v116, 16, v78
 v_and_b32 v117, s98, v78
 v_pk_mul_f32 v[116:117], v[116:117], s[88:89]
 v_cvt_pk_bf16_f32 v78, v116, v117
 v_lshlrev_b32 v116, 16, v78
 v_and_b32 v117, s98, v78
 v_lshlrev_b32 v118, 16, v79
 v_and_b32 v119, s98, v79
 v_pk_mul_f32 v[118:119], v[118:119], s[90:91]
 v_cvt_pk_bf16_f32 v79, v118, v119
 v_lshlrev_b32 v118, 16, v79
 v_and_b32 v119, s98, v79
 v_lshlrev_b32 v120, 16, v80
 v_and_b32 v121, s98, v80
 v_pk_mul_f32 v[120:121], v[120:121], s[88:89]
 v_cvt_pk_bf16_f32 v80, v120, v121
 v_lshlrev_b32 v120, 16, v80
 v_and_b32 v121, s98, v80
 v_lshlrev_b32 v122, 16, v81
 v_and_b32 v123, s98, v81
 v_pk_mul_f32 v[122:123], v[122:123], s[90:91]
 v_cvt_pk_bf16_f32 v81, v122, v123
 v_lshlrev_b32 v122, 16, v81
 v_and_b32 v123, s98, v81
 v_lshlrev_b32 v124, 16, v82
 v_and_b32 v125, s98, v82
 v_pk_mul_f32 v[124:125], v[124:125], s[88:89]
 v_cvt_pk_bf16_f32 v82, v124, v125
 v_lshlrev_b32 v124, 16, v82
 v_and_b32 v125, s98, v82
 v_lshlrev_b32 v126, 16, v83
 v_and_b32 v127, s98, v83
 v_pk_mul_f32 v[126:127], v[126:127], s[90:91]
 v_cvt_pk_bf16_f32 v83, v126, v127
 v_lshlrev_b32 v126, 16, v83
 v_and_b32 v127, s98, v83
 v_lshlrev_b32 v128, 16, v84
 v_and_b32 v129, s98, v84
 v_pk_mul_f32 v[128:129], v[128:129], s[88:89]
 v_cvt_pk_bf16_f32 v84, v128, v129
 v_lshlrev_b32 v128, 16, v84
 v_and_b32 v129, s98, v84
 v_lshlrev_b32 v130, 16, v85
 v_and_b32 v131, s98, v85
 v_pk_mul_f32 v[130:131], v[130:131], s[90:91]
 v_cvt_pk_bf16_f32 v85, v130, v131
 v_lshlrev_b32 v130, 16, v85
 v_and_b32 v131, s98, v85
 v_lshlrev_b32 v132, 16, v86
 v_and_b32 v133, s98, v86
 v_pk_mul_f32 v[132:133], v[132:133], s[88:89]
 v_cvt_pk_bf16_f32 v86, v132, v133
 v_lshlrev_b32 v132, 16, v86
 v_and_b32 v133, s98, v86
 v_lshlrev_b32 v134, 16, v87
 v_and_b32 v135, s98, v87
 v_pk_mul_f32 v[134:135], v[134:135], s[90:91]
 v_cvt_pk_bf16_f32 v87, v134, v135
 v_lshlrev_b32 v134, 16, v87
 v_and_b32 v135, s98, v87
 s_waitcnt lgkmcnt(0)
 v_lshlrev_b32 v136, 16, v88
 v_lshlrev_b32 v137, 16, v92
 v_lshlrev_b32 v138, 16, v96
 v_lshlrev_b32 v139, 16, v100
 v_pk_add_f32 v[104:105], v[104:105], v[136:137]
 v_cvt_pk_bf16_f32 v72, v104, v105
 v_pk_add_f32 v[106:107], v[106:107], v[138:139]
 v_cvt_pk_bf16_f32 v73, v106, v107
 buffer_store_dwordx2 v[72:73], v70, s[84:87], s93 offen
 s_add_u32 s93, s93, 4096
 v_and_b32 v136, s98, v88
 v_and_b32 v137, s98, v92
 v_and_b32 v138, s98, v96
 v_and_b32 v139, s98, v100
 v_pk_add_f32 v[108:109], v[108:109], v[136:137]
 v_cvt_pk_bf16_f32 v74, v108, v109
 v_pk_add_f32 v[110:111], v[110:111], v[138:139]
 v_cvt_pk_bf16_f32 v75, v110, v111
 buffer_store_dwordx2 v[74:75], v70, s[84:87], s93 offen
 s_add_u32 s93, s93, 4096
 v_lshlrev_b32 v136, 16, v89
 v_lshlrev_b32 v137, 16, v93
 v_lshlrev_b32 v138, 16, v97
 v_lshlrev_b32 v139, 16, v101
 v_pk_add_f32 v[112:113], v[112:113], v[136:137]
 v_cvt_pk_bf16_f32 v76, v112, v113
 v_pk_add_f32 v[114:115], v[114:115], v[138:139]
 v_cvt_pk_bf16_f32 v77, v114, v115
 buffer_store_dwordx2 v[76:77], v70, s[84:87], s93 offen
 s_add_u32 s93, s93, 4096
 v_and_b32 v136, s98, v89
 v_and_b32 v137, s98, v93
 v_and_b32 v138, s98, v97
 v_and_b32 v139, s98, v101
 v_pk_add_f32 v[116:117], v[116:117], v[136:137]
 v_cvt_pk_bf16_f32 v78, v116, v117
 v_pk_add_f32 v[118:119], v[118:119], v[138:139]
 v_cvt_pk_bf16_f32 v79, v118, v119
 buffer_store_dwordx2 v[78:79], v70, s[84:87], s93 offen
 s_add_u32 s93, s93, 4096
 v_lshlrev_b32 v136, 16, v90
 v_lshlrev_b32 v137, 16, v94
 v_lshlrev_b32 v138, 16, v98
 v_lshlrev_b32 v139, 16, v102
 v_pk_add_f32 v[120:121], v[120:121], v[136:137]
 v_cvt_pk_bf16_f32 v80, v120, v121
 v_pk_add_f32 v[122:123], v[122:123], v[138:139]
 v_cvt_pk_bf16_f32 v81, v122, v123
 buffer_store_dwordx2 v[80:81], v70, s[84:87], s93 offen
 s_add_u32 s93, s93, 4096
 v_and_b32 v136, s98, v90
 v_and_b32 v137, s98, v94
 v_and_b32 v138, s98, v98
 v_and_b32 v139, s98, v102
 v_pk_add_f32 v[124:125], v[124:125], v[136:137]
 v_cvt_pk_bf16_f32 v82, v124, v125
 v_pk_add_f32 v[126:127], v[126:127], v[138:139]
 v_cvt_pk_bf16_f32 v83, v126, v127
 buffer_store_dwordx2 v[82:83], v70, s[84:87], s93 offen
 s_add_u32 s93, s93, 4096
 v_lshlrev_b32 v136, 16, v91
 v_lshlrev_b32 v137, 16, v95
 v_lshlrev_b32 v138, 16, v99
 v_lshlrev_b32 v139, 16, v103
 v_pk_add_f32 v[128:129], v[128:129], v[136:137]
 v_cvt_pk_bf16_f32 v84, v128, v129
 v_pk_add_f32 v[130:131], v[130:131], v[138:139]
 v_cvt_pk_bf16_f32 v85, v130, v131
 buffer_store_dwordx2 v[84:85], v70, s[84:87], s93 offen
 s_add_u32 s93, s93, 4096
 v_and_b32 v136, s98, v91
 v_and_b32 v137, s98, v95
 v_and_b32 v138, s98, v99
 v_and_b32 v139, s98, v103
 v_pk_add_f32 v[132:133], v[132:133], v[136:137]
 v_cvt_pk_bf16_f32 v86, v132, v133
 v_pk_add_f32 v[134:135], v[134:135], v[138:139]
 v_cvt_pk_bf16_f32 v87, v134, v135
 buffer_store_dwordx2 v[86:87], v70, s[84:87], s93 offen
 s_add_u32 s93, s93, 4096
 s_waitcnt vmcnt(8)
 s_barrier
 ds_read_b64_tr_b16 v[172:173], v38 offset:32768
 ds_read_b64_tr_b16 v[174:175], v38 offset:32896
 ds_read_b64_tr_b16 v[176:177], v38 offset:34816
 ds_read_b64_tr_b16 v[178:179], v38 offset:34944
 ds_read_b64_tr_b16 v[180:181], v38 offset:36864
 ds_read_b64_tr_b16 v[182:183], v38 offset:36992
 ds_read_b64_tr_b16 v[184:185], v38 offset:38912
 ds_read_b64_tr_b16 v[186:187], v38 offset:39040
 s_waitcnt lgkmcnt(0)
 ds_read_b64_tr_b16 v[188:189], v38 offset:40960
 ds_read_b64_tr_b16 v[190:191], v38 offset:41088
 ds_read_b64_tr_b16 v[192:193], v38 offset:43008
 ds_read_b64_tr_b16 v[194:195], v38 offset:43136
 ds_read_b64_tr_b16 v[196:197], v38 offset:45056
 ds_read_b64_tr_b16 v[198:199], v38 offset:45184
 ds_read_b64_tr_b16 v[200:201], v38 offset:47104
 ds_read_b64_tr_b16 v[202:203], v38 offset:47232
 s_waitcnt lgkmcnt(0)
 ds_read_b64_tr_b16 v[204:205], v38 offset:49152
 ds_read_b64_tr_b16 v[206:207], v38 offset:49280
 ds_read_b64_tr_b16 v[208:209], v38 offset:51200
 ds_read_b64_tr_b16 v[210:211], v38 offset:51328
 ds_read_b64_tr_b16 v[212:213], v38 offset:53248
 ds_read_b64_tr_b16 v[214:215], v38 offset:53376
 ds_read_b64_tr_b16 v[216:217], v38 offset:55296
 ds_read_b64_tr_b16 v[218:219], v38 offset:55424
 s_waitcnt lgkmcnt(0)
 ds_read_b64_tr_b16 v[220:221], v38 offset:57344
 ds_read_b64_tr_b16 v[222:223], v38 offset:57472
 ds_read_b64_tr_b16 v[224:225], v38 offset:59392
 ds_read_b64_tr_b16 v[226:227], v38 offset:59520
 ds_read_b64_tr_b16 v[228:229], v38 offset:61440
 ds_read_b64_tr_b16 v[230:231], v38 offset:61568
 ds_read_b64_tr_b16 v[232:233], v38 offset:63488
 ds_read_b64_tr_b16 v[234:235], v38 offset:63616
 s_waitcnt lgkmcnt(0)
 s_barrier
 v_mov_b32 v39, 0
 v_mov_b32 v40, 0
 v_mov_b32 v41, 0
 s_mov_b32 s3, 0
L_rdy_12:
 buffer_load_dwordx4 v[88:91], off, s[12:15], s30 sc1
 s_add_u32 s3, s3, 1
 s_cmp_gt_u32 s3, 400000
 s_cbranch_scc1 L_exit
 s_waitcnt vmcnt(0)
 v_readfirstlane_b32 s32, v88
 v_readfirstlane_b32 s33, v89
 v_readfirstlane_b32 vcc_hi, v90
 s_and_b32 vcc_lo, s32, 0xffff
 s_cmp_lt_u32 vcc_lo, 256
 s_cbranch_scc1 L_rdy_12
 s_cmp_lg_u32 vcc_hi, 0
 s_cbranch_scc1 L_general
 s_mov_b32 s59, 63
 s_lshr_b32 s60, s59, 3
 s_lshr_b32 s60, s27, s60
 s_and_b32 s60, s60, 1
 s_lshl_b32 s60, s60, 13
 s_lshl_b32 s72, s59, 18
 s_add_u32 s72, s72, s60
 s_add_u32 s72, s72, 134217728
 s_add_u32 s73, s73, s72
 s_add_u32 s74, s74, s72
 s_add_u32 s75, s75, s72
 s_add_u32 s76, s76, s72
 s_mov_b32 s52, 0
 s_mov_b32 s53, s67
 s_lshl_b32 s59, s24, 5
 s_add_u32 s59, s59, s25
 s_lshl_b32 s57, s59, 11
 s_add_u32 s57, s57, 16777216
 s_lshl_b32 s58, s59, 9
 s_add_u32 s58, s58, 4194304
 s_mov_b32 s62, 0
 s_mov_b32 s40, 0
 s_mov_b32 s41, 0
 s_mov_b32 s42, 0
 s_mov_b32 s43, 0
 s_cmp_eq_u32 s26, 1
 s_cbranch_scc1 L_cg_w1
 s_cmp_eq_u32 s26, 2
 s_cbranch_scc1 L_cg_w2
 s_cmp_eq_u32 s26, 3
 s_cbranch_scc1 L_cg_w3
L_cg_w0:
 v_mov_b32 v205, 0
 v_mov_b32 v207, 0
 v_mov_b32 v209, 0
 v_mov_b32 v56, 0
 v_mov_b32 v57, 0
 v_mov_b32 v58, 0
 v_mov_b32 v59, 0
 v_mov_b32 v60, 0
 v_mov_b32 v61, 0
 v_mov_b32 v62, 0
 v_mov_b32 v63, 0
 v_mov_b32 v64, 0
 v_mov_b32 v65, 0
 v_mov_b32 v66, 0
 v_mov_b32 v67, 0
 v_mov_b32 v68, 0
 v_mov_b32 v69, 0
 v_mov_b32 v70, 0
 v_mov_b32 v71, 0
 v_mov_b32 v72, 0
 v_mov_b32 v73, 0
 v_mov_b32 v74, 0
 v_mov_b32 v75, 0
 v_mov_b32 v76, 0
 v_mov_b32 v77, 0
 v_mov_b32 v78, 0
 v_mov_b32 v79, 0
 s_waitcnt vmcnt(0)
 s_barrier
 buffer_load_dwordx4 v[92:95], v6, s[4:7], s53 offen offset:0 sc1
 s_nop 3
 buffer_load_dwordx4 v[96:99], v6, s[4:7], s53 offen offset:1024 sc1
 s_nop 3
 buffer_load_dwordx4 v[100:103], v6, s[4:7], s53 offen offset:2048 sc1
 s_nop 3
 buffer_load_dwordx4 v[104:107], v6, s[4:7], s53 offen offset:3072 sc1
L_cg_w0_loop:
 s_and_b32 s59, s52, 3
 s_add_u32 s54, s53, 262144
 s_lshl_b32 s60, s59, 16
 s_add_u32 s55, s68, s60
 v_add_u32 v30, 1, v30
 ds_read_b128 v[172:175], v17 offset:49152
 ds_read_b128 v[176:179], v17 offset:49216
 ds_read_b128 v[180:183], v18 offset:51200
 ds_read_b128 v[184:187], v18 offset:51456
L_cg_w0_dtry:
 s_waitcnt vmcnt(3)
 v_smfmac_f32_16x16x64_bf16 v[56:59], v[92:95], a[0:7], v5
 v_smfmac_f32_16x16x64_bf16 v[60:63], v[92:95], a[8:15], v5
 v_smfmac_f32_16x16x64_bf16 v[64:67], v[92:95], a[16:23], v5
 v_smfmac_f32_16x16x64_bf16 v[68:71], v[92:95], a[24:31], v5
 s_waitcnt vmcnt(2)
 v_smfmac_f32_16x16x64_bf16 v[56:59], v[96:99], a[48:55], v5
 v_smfmac_f32_16x16x64_bf16 v[60:63], v[96:99], a[56:63], v5
 v_smfmac_f32_16x16x64_bf16 v[64:67], v[96:99], a[64:71], v5
 v_smfmac_f32_16x16x64_bf16 v[68:71], v[96:99], a[72:79], v5
 s_waitcnt vmcnt(1)
 v_smfmac_f32_16x16x64_bf16 v[56:59], v[100:103], a[96:103], v5
 v_smfmac_f32_16x16x64_bf16 v[60:63], v[100:103], a[104:111], v5
 v_smfmac_f32_16x16x64_bf16 v[64:67], v[100:103], a[112:119], v5
 v_smfmac_f32_16x16x64_bf16 v[68:71], v[100:103], a[120:127], v5
 s_waitcnt vmcnt(0)
 v_smfmac_f32_16x16x64_bf16 v[56:59], v[104:107], a[144:151], v5
 v_smfmac_f32_16x16x64_bf16 v[60:63], v[104:107], a[152:159], v5
 v_smfmac_f32_16x16x64_bf16 v[64:67], v[104:107], a[160:167], v5
 v_smfmac_f32_16x16x64_bf16 v[68:71], v[104:107], a[168:175], v5
 s_nop 4
 v_pk_add_f32 v[84:85], v[56:57], v[58:59]
 ds_write2_b32 v7, v84, v85 offset0:0 offset1:36
 v_cmp_u_f32 vcc, v84, v85
 v_pk_add_f32 v[86:87], v[60:61], v[62:63]
 ds_write2_b32 v7, v86, v87 offset0:16 offset1:52
 v_pk_add_f32 v[88:89], v[64:65], v[66:67]
 ds_write2_b32 v8, v88, v89 offset0:0 offset1:36
 v_pk_add_f32 v[90:91], v[68:69], v[70:71]
 ds_write2_b32 v8, v90, v91 offset0:16 offset1:52
 s_cbranch_vccnz L_cg_w0_dslow
L_cg_w0_dgood:
 v_smfmac_f32_16x16x64_bf16 v[72:75], v[92:95], a[32:39], v5
 v_smfmac_f32_16x16x64_bf16 v[76:79], v[92:95], a[40:47], v5
 v_smfmac_f32_16x16x64_bf16 v[72:75], v[96:99], a[80:87], v5
 v_smfmac_f32_16x16x64_bf16 v[76:79], v[96:99], a[88:95], v5
 s_waitcnt lgkmcnt(0)
 s_barrier
 ds_read_b128 v[108:111], v9 offset:4096
 ds_read_b128 v[112:115], v9 offset:4112
 ds_read_b128 v[116:119], v9 offset:6400
 ds_read_b128 v[120:123], v9 offset:6416
 ds_read_b128 v[124:127], v9 offset:8704
 ds_read_b128 v[128:131], v9 offset:8720
 ds_read_b128 v[132:135], v9 offset:11008
 ds_read_b128 v[136:139], v9 offset:11024
 v_smfmac_f32_16x16x64_bf16 v[72:75], v[100:103], a[128:135], v5
 s_waitcnt lgkmcnt(6)
 v_pk_mul_f32 v[108:109], v[108:109], v[54:55] op_sel_hi:[1,0]
 v_pk_mul_f32 v[110:111], v[110:111], v[54:55] op_sel_hi:[1,0]
 v_pk_mul_f32 v[112:113], v[112:113], v[54:55] op_sel_hi:[1,0]
 v_pk_mul_f32 v[114:115], v[114:115], v[54:55] op_sel_hi:[1,0]
 s_waitcnt lgkmcnt(4)
 v_pk_fma_f32 v[108:109], v[116:117], v[54:55], v[108:109] op_sel_hi:[1,0,1]
 v_pk_fma_f32 v[110:111], v[118:119], v[54:55], v[110:111] op_sel_hi:[1,0,1]
 v_pk_fma_f32 v[112:113], v[120:121], v[54:55], v[112:113] op_sel_hi:[1,0,1]
 v_pk_fma_f32 v[114:115], v[122:123], v[54:55], v[114:115] op_sel_hi:[1,0,1]
 s_waitcnt lgkmcnt(2)
 v_pk_fma_f32 v[108:109], v[124:125], v[54:55], v[108:109] op_sel_hi:[1,0,1]
 v_pk_fma_f32 v[110:111], v[126:127], v[54:55], v[110:111] op_sel_hi:[1,0,1]
 v_pk_fma_f32 v[112:113], v[128:129], v[54:55], v[112:113] op_sel_hi:[1,0,1]
 v_pk_fma_f32 v[114:115], v[130:131], v[54:55], v[114:115] op_sel_hi:[1,0,1]
 s_waitcnt lgkmcnt(0)
 v_pk_fma_f32 v[108:109], v[132:133], v[54:55], v[108:109] op_sel_hi:[1,0,1]
 v_pk_fma_f32 v[110:111], v[134:135], v[54:55], v[110:111] op_sel_hi:[1,0,1]
 v_pk_fma_f32 v[112:113], v[136:137], v[54:55], v[112:113] op_sel_hi:[1,0,1]
 v_pk_fma_f32 v[114:115], v[138:139], v[54:55], v[114:115] op_sel_hi:[1,0,1]
 v_cvt_pk_bf16_f32 v188, v108, v109
 v_cvt_pk_bf16_f32 v189, v110, v111
 v_cvt_pk_bf16_f32 v190, v112, v113
 v_cvt_pk_bf16_f32 v191, v114, v115
 s_nop 1
 v_mfma_f32_16x16x32_bf16 v[192:195], v[172:175], v[188:191], 0
 v_mfma_f32_16x16x32_bf16 v[196:199], v[176:179], v[188:191], 0
 v_mfma_f32_16x16x32_bf16 v[200:203], v[188:191], v[188:191], 0
 s_nop 5
 buffer_store_dwordx4 v[192:195], v11, s[4:7], s55 offen sc1
 buffer_store_dwordx4 v[196:199], v11, s[4:7], s55 offen offset:128 sc1
 buffer_store_dwordx4 v[200:203], v12, s[4:7], s55 offen sc1
 v_smfmac_f32_16x16x64_bf16 v[76:79], v[100:103], a[136:143], v5
 v_smfmac_f32_16x16x64_bf16 v[72:75], v[104:107], a[176:183], v5
 v_smfmac_f32_16x16x64_bf16 v[76:79], v[104:107], a[184:191], v5
 s_barrier
 buffer_load_dwordx4 v[108:111], v47, s[4:7], s55 offen sc1
 buffer_load_dwordx4 v[112:115], v48, s[4:7], s55 offen sc1
 buffer_load_dwordx4 v[116:119], v49, s[4:7], s55 offen sc1
 buffer_load_dword v120, v13, s[4:7], s55 offen offset:0 sc1
 buffer_load_dword v121, v13, s[4:7], s55 offen offset:1280 sc1
 buffer_load_dword v122, v13, s[4:7], s55 offen offset:2560 sc1
 buffer_load_dword v123, v13, s[4:7], s55 offen offset:3840 sc1
 ds_read_b128 v[124:127], v2 offset:15360
 ds_read_b128 v[128:131], v2 offset:16384
 ds_read_b128 v[132:135], v2 offset:17408
 v_pk_add_f32 v[84:85], v[72:73], v[74:75]
 v_pk_add_f32 v[86:87], v[76:77], v[78:79]
 v_mov_b32_dpp v192, v196 row_ror:8 row_mask:0xf bank_mask:0xc
 v_mov_b32_dpp v193, v197 row_ror:8 row_mask:0xf bank_mask:0xc
 v_mov_b32_dpp v194, v198 row_ror:8 row_mask:0xf bank_mask:0xc
 v_mov_b32_dpp v195, v199 row_ror:8 row_mask:0xf bank_mask:0xc
 s_waitcnt lgkmcnt(2)
 v_pk_add_f32 v[84:85], v[84:85], v[124:125]
 v_pk_add_f32 v[86:87], v[86:87], v[126:127]
 s_waitcnt lgkmcnt(1)
 v_pk_add_f32 v[84:85], v[84:85], v[128:129]
 v_pk_add_f32 v[86:87], v[86:87], v[130:131]
 s_waitcnt lgkmcnt(0)
 v_pk_add_f32 v[84:85], v[84:85], v[132:133]
 v_pk_add_f32 v[86:87], v[86:87], v[134:135]
 v_cvt_pk_bf16_f32 v206, v84, v85
 v_cvt_pk_bf16_f32 v208, v86, v87
 s_cmp_eq_u32 s52, 63
 s_cbranch_scc1 L_cg_w0_done
L_cg_w0_atry:
 s_waitcnt vmcnt(6)
 v_pk_add_f32 v[230:231], v[192:193], v[108:109]
 v_pk_add_f32 v[232:233], v[194:195], v[110:111]
 s_waitcnt vmcnt(5)
 v_pk_add_f32 v[230:231], v[230:231], v[112:113]
 v_pk_add_f32 v[232:233], v[232:233], v[114:115]
 s_waitcnt vmcnt(4)
 v_pk_add_f32 v[230:231], v[230:231], v[116:117]
 v_pk_add_f32 v[232:233], v[232:233], v[118:119]
 v_maximum3_f32 v36, |v230|, |v231|, |v232|
 s_waitcnt vmcnt(0)
 v_pk_add_f32 v[234:235], v[120:121], v[122:123]
 v_add_f32 v234, v234, v235
 v_maximum3_f32 v36, v36, |v233|, |v234|
 v_cmp_ngt_f32 vcc, s66, v36
 v_exp_f32 v214, v230
 v_exp_f32 v215, v231
 v_exp_f32 v216, v232
 v_exp_f32 v217, v233
 v_exp_f32 v136, v234
 s_cbranch_vccnz L_cg_w0_abad
L_cg_w0_agood:
 buffer_store_dword v30, v25, s[4:7], s69 offen sc1
 v_cvt_pk_bf16_f32 v210, v214, v215
 v_cvt_pk_bf16_f32 v211, v216, v217
 v_mov_b32_dpp v138, v136 row_ror:8 row_mask:0xf bank_mask:0xf
 v_mov_b32_dpp v212, v210 row_ror:8 row_mask:0xf bank_mask:0xf
 v_mov_b32_dpp v213, v211 row_ror:8 row_mask:0xf bank_mask:0xf
 v_cvt_pk_bf16_f32 v204, v136, v138
 v_pk_add_f32 v[214:215], v[214:215], v[216:217]
 v_mfma_f32_16x16x32_bf16 v[218:221], v[180:183], v[210:213], 0
 v_add_f32 v137, v214, v215
 v_add_f32 v137, v137, v136
 v_mfma_f32_16x16x32_bf16 v[222:225], v[184:187], v[210:213], 0
 s_nop 0
 v_add_f32_dpp v138, v137, v137 row_ror:8 row_mask:0xf bank_mask:0xf
 v_add_f32_dpp v139, v137, v137 row_ror:8 row_mask:0xf bank_mask:0xf
 v_mfma_f32_16x16x16_bf16 v[218:221], v[206:207], v[204:205], v[218:221]
 s_nop 0
 v_permlane16_swap_b32 v138, v139
 v_mfma_f32_16x16x16_bf16 v[222:225], v[208:209], v[204:205], v[222:225]
 v_add_f32 v137, v138, v139
 v_add_f32 v138, v138, v139
 s_nop 1
 v_permlane32_swap_b32 v137, v138
 s_nop 0
 v_add_f32 v137, v137, v138
 v_rcp_f32 v214, v137
 s_mov_b32 m0, 20480
 v_pk_mul_f32 v[218:219], v[218:219], v[214:215] op_sel_hi:[1,0]
 v_pk_mul_f32 v[220:221], v[220:221], v[214:215] op_sel_hi:[1,0]
 v_pk_mul_f32 v[222:223], v[222:223], v[214:215] op_sel_hi:[1,0]
 v_pk_mul_f32 v[224:225], v[224:225], v[214:215] op_sel_hi:[1,0]
 v_cvt_pk_bf16_f32 v226, v218, v219
 v_cvt_pk_bf16_f32 v227, v220, v221
 v_cvt_pk_bf16_f32 v228, v222, v223
 v_cvt_pk_bf16_f32 v229, v224, v225
 buffer_store_dwordx4 v[226:229], v14, s[4:7], s54 offen sc1
 s_barrier
 buffer_load_dwordx4 v6, s[4:7], s54 offen offset:0 sc1 lds
 s_nop 3
 buffer_load_dwordx4 v6, s[4:7], s54 offen offset:1024 sc1 lds
 s_nop 3
 buffer_load_dwordx4 v6, s[4:7], s54 offen offset:2048 sc1 lds
 s_nop 3
 buffer_load_dwordx4 v6, s[4:7], s54 offen offset:3072 sc1 lds
 s_add_u32 s52, s52, 1
 s_and_b32 s61, s52, 3
 s_lshl_b32 s61, s61, 14
 s_add_u32 s53, s67, s61
 v_mov_b32 v56, 0
 v_mov_b32 v57, 0
 v_mov_b32 v58, 0
 v_mov_b32 v59, 0
 v_mov_b32 v60, 0
 v_mov_b32 v61, 0
 v_mov_b32 v62, 0
 v_mov_b32 v63, 0
 v_mov_b32 v64, 0
 v_mov_b32 v65, 0
 v_mov_b32 v66, 0
 v_mov_b32 v67, 0
 v_mov_b32 v68, 0
 v_mov_b32 v69, 0
 v_mov_b32 v70, 0
 v_mov_b32 v71, 0
 v_mov_b32 v72, 0
 v_mov_b32 v73, 0
 v_mov_b32 v74, 0
 v_mov_b32 v75, 0
 v_mov_b32 v76, 0
 v_mov_b32 v77, 0
 v_mov_b32 v78, 0
 v_mov_b32 v79, 0
 s_add_u32 s61, s58, 4194304
 s_waitcnt vmcnt(3)
 s_barrier
 s_waitcnt vmcnt(2)
 s_barrier
 buffer_store_dwordx4 v[188:191], v19, s[4:7], s58 offen sc1
 s_waitcnt vmcnt(2)
 s_barrier
 buffer_store_dword v206, v4, s[4:7], s61 offen sc1
 buffer_store_dword v208, v4, s[4:7], s61 offen offset:256 sc1
 s_load_dwordx4 s[40:43], s[4:5], s73 glc
 s_waitcnt vmcnt(3)
 s_barrier
 s_add_u32 s58, s58, 0x10000
L_cg_w0_cpoll:
 s_load_dwordx4 s[40:43], s[4:5], s73 glc
 s_min_u32 s59, s40, s41
 s_min_u32 s59, s59, s42
 s_cmp_ge_u32 s59, s52
 s_cbranch_scc1 L_cg_w0_cgo
 s_min_u32 s59, s40, s41
 s_min_u32 s59, s59, s42
 s_cmp_ge_u32 s59, s52
 s_cbranch_scc1 L_cg_w0_cgo
 s_min_u32 s59, s40, s41
 s_min_u32 s59, s59, s42
 s_cmp_ge_u32 s59, s52
 s_cbranch_scc1 L_cg_w0_cgo
 s_waitcnt lgkmcnt(8)
 s_add_u32 s62, s62, 1
 s_cmp_lt_u32 s62, 400000
 s_cbranch_scc1 L_cg_w0_cpoll
 s_branch L_done
L_cg_w0_cgo:
L_cg_w0_bjoin:
 s_barrier
 v_mov_b32 v32, 1
 ds_read_b32 v32, v37 offset:19456
L_cg_w0_fspin:
 v_cmp_eq_u32 vcc, 1, v32
 s_cbranch_vccnz L_cg_w0_fspin
 v_cmp_ne_u32 vcc, 0, v32
 s_cbranch_vccnz L_cg_w0_bretry
 s_add_u32 s60, s77, 32
 s_waitcnt vmcnt(0)
 s_atomic_umax s52, s[4:5], s60
 s_barrier
 buffer_load_dwordx4 v[92:95], v6, s[4:7], s53 offen offset:0 sc1
 s_nop 3
 buffer_load_dwordx4 v[96:99], v6, s[4:7], s53 offen offset:1024 sc1
 s_nop 3
 buffer_load_dwordx4 v[100:103], v6, s[4:7], s53 offen offset:2048 sc1
 s_nop 3
 buffer_load_dwordx4 v[104:107], v6, s[4:7], s53 offen offset:3072 sc1
 s_branch L_cg_w0_loop
L_cg_w0_dslow:
 v_max_u32 v36, v92, v93
 v_max3_u32 v36, v36, v94, v95
 v_max3_u32 v36, v36, v96, v97
 v_max3_u32 v36, v36, v98, v99
 v_max3_u32 v36, v36, v100, v101
 v_max3_u32 v36, v36, v102, v103
 v_max3_u32 v36, v36, v104, v105
 v_max3_u32 v36, v36, v106, v107
 v_cmp_eq_u32 vcc, -1, v36
 s_cbranch_vccz L_cg_w0_dgood
L_cg_w0_dagain:
 buffer_load_dwordx4 v[92:95], v6, s[4:7], s53 offen offset:0 sc1
 buffer_load_dwordx4 v[96:99], v6, s[4:7], s53 offen offset:1024 sc1
 buffer_load_dwordx4 v[100:103], v6, s[4:7], s53 offen offset:2048 sc1
 buffer_load_dwordx4 v[104:107], v6, s[4:7], s53 offen offset:3072 sc1
 v_mov_b32 v56, 0
 v_mov_b32 v57, 0
 v_mov_b32 v58, 0
 v_mov_b32 v59, 0
 v_mov_b32 v60, 0
 v_mov_b32 v61, 0
 v_mov_b32 v62, 0
 v_mov_b32 v63, 0
 v_mov_b32 v64, 0
 v_mov_b32 v65, 0
 v_mov_b32 v66, 0
 v_mov_b32 v67, 0
 v_mov_b32 v68, 0
 v_mov_b32 v69, 0
 v_mov_b32 v70, 0
 v_mov_b32 v71, 0
 s_add_u32 s62, s62, 1
 s_cmp_gt_u32 s62, 400000
 s_cbranch_scc1 L_done
 s_waitcnt vmcnt(0)
 v_max_u32 v36, v92, v93
 v_max3_u32 v36, v36, v94, v95
 v_max3_u32 v36, v36, v96, v97
 v_max3_u32 v36, v36, v98, v99
 v_max3_u32 v36, v36, v100, v101
 v_max3_u32 v36, v36, v102, v103
 v_max3_u32 v36, v36, v104, v105
 v_max3_u32 v36, v36, v106, v107
 v_cmp_eq_u32 vcc, -1, v36
 s_cbranch_vccnz L_cg_w0_dagain
 s_branch L_cg_w0_dtry
L_cg_w0_bretry:
 s_add_u32 s62, s62, 1
 s_cmp_gt_u32 s62, 400000
 s_cbranch_scc1 L_done
 s_mov_b32 m0, 20480
 s_nop 0
 buffer_load_dwordx4 v6, s[4:7], s54 offen offset:0 sc1 lds
 s_nop 3
 buffer_load_dwordx4 v6, s[4:7], s54 offen offset:1024 sc1 lds
 s_nop 3
 buffer_load_dwordx4 v6, s[4:7], s54 offen offset:2048 sc1 lds
 s_nop 3
 buffer_load_dwordx4 v6, s[4:7], s54 offen offset:3072 sc1 lds
 s_waitcnt vmcnt(3)
 s_barrier
 s_waitcnt vmcnt(2)
 s_barrier
 s_waitcnt vmcnt(1)
 s_barrier
 s_waitcnt vmcnt(0)
 s_barrier
 s_branch L_cg_w0_bjoin
L_cg_w0_abad:
 v_max3_u32 v36, v120, v121, v122
 v_max_u32 v36, v36, v123
 v_max3_u32 v36, v36, v108, v109
 v_max3_u32 v36, v36, v110, v111
 v_max3_u32 v36, v36, v112, v113
 v_max3_u32 v36, v36, v114, v115
 v_max3_u32 v36, v36, v116, v117
 v_max3_u32 v36, v36, v118, v119
 v_cmp_eq_u32 vcc, -1, v36
 buffer_load_dwordx4 v[108:111], v47, s[4:7], s55 offen sc1
 buffer_load_dwordx4 v[112:115], v48, s[4:7], s55 offen sc1
 buffer_load_dwordx4 v[116:119], v49, s[4:7], s55 offen sc1
 buffer_load_dword v120, v13, s[4:7], s55 offen offset:0 sc1
 buffer_load_dword v121, v13, s[4:7], s55 offen offset:1280 sc1
 buffer_load_dword v122, v13, s[4:7], s55 offen offset:2560 sc1
 buffer_load_dword v123, v13, s[4:7], s55 offen offset:3840 sc1
 s_add_u32 s62, s62, 1
 s_cmp_gt_u32 s62, 400000
 s_cbranch_scc1 L_done
 s_cbranch_vccnz L_cg_w0_atry
 v_max3_f32 v36, v230, v231, v232
 v_max3_f32 v36, v36, v233, v234
 s_nop 1
 v_max_f32_dpp v138, v36, v36 row_ror:8 row_mask:0xf bank_mask:0xf
 v_max_f32_dpp v139, v36, v36 row_ror:8 row_mask:0xf bank_mask:0xf
 s_nop 1
 v_permlane16_swap_b32 v138, v139
 s_nop 1
 v_max_f32 v36, v138, v139
 v_max_f32 v138, v138, v139
 s_nop 1
 v_permlane32_swap_b32 v36, v138
 s_nop 1
 v_max_f32 v36, v36, v138
 v_sub_f32 v230, v230, v36
 v_sub_f32 v231, v231, v36
 v_sub_f32 v232, v232, v36
 v_sub_f32 v233, v233, v36
 v_sub_f32 v234, v234, v36
 v_exp_f32 v214, v230
 v_exp_f32 v215, v231
 v_exp_f32 v216, v232
 v_exp_f32 v217, v233
 v_exp_f32 v136, v234
 s_branch L_cg_w0_agood
L_cg_w0_done:
 s_add_u32 s59, s58, 4194304
 buffer_store_dwordx4 v[188:191], v19, s[4:7], s58 offen sc1
 buffer_store_dword v206, v4, s[4:7], s59 offen sc1
 buffer_store_dword v208, v4, s[4:7], s59 offen offset:256 sc1
 s_waitcnt vmcnt(0)
 buffer_store_dword v30, v42, s[4:7], 0 offen sc1
 s_branch L_done
L_cg_w1:
 s_mov_b32 s79, 0
 s_mov_b32 s80, 0
L_cg_w1_kv0:
 s_min_u32 s59, s79, s80
 s_cmp_gt_u32 s59, 0
 s_cbranch_scc1 L_cg_w1_kv0_ok
 s_load_dword s79, s[4:5], s77 glc
 s_load_dword s80, s[4:5], s78 glc
 s_add_u32 s62, s62, 1
 s_cmp_gt_u32 s62, 400000
 s_cbranch_scc1 L_done
 s_waitcnt lgkmcnt(0)
 s_branch L_cg_w1_kv0
L_cg_w1_kv0_ok:
 s_mov_b32 m0, 49152
 s_add_u32 s59, s57, 16775168
 buffer_load_dwordx4 v2, s[4:7], s57 offen sc1 lds
 buffer_load_dwordx4 v2, s[4:7], s57 offen offset:1024 sc1 lds
 buffer_load_dwordx4 v2, s[4:7], s59 offen offset:2048 sc1 lds
 buffer_load_dwordx4 v2, s[4:7], s59 offen offset:3072 sc1 lds
 v_mov_b32 v56, 0
 v_mov_b32 v57, 0
 v_mov_b32 v58, 0
 v_mov_b32 v59, 0
 v_mov_b32 v60, 0
 v_mov_b32 v61, 0
 v_mov_b32 v62, 0
 v_mov_b32 v63, 0
 v_mov_b32 v64, 0
 v_mov_b32 v65, 0
 v_mov_b32 v66, 0
 v_mov_b32 v67, 0
 v_mov_b32 v68, 0
 v_mov_b32 v69, 0
 v_mov_b32 v70, 0
 v_mov_b32 v71, 0
 v_mov_b32 v72, 0
 v_mov_b32 v73, 0
 v_mov_b32 v74, 0
 v_mov_b32 v75, 0
 v_mov_b32 v76, 0
 v_mov_b32 v77, 0
 v_mov_b32 v78, 0
 v_mov_b32 v79, 0
 s_waitcnt vmcnt(0)
 s_barrier
 buffer_load_dwordx4 v[96:99], v6, s[4:7], s53 offen offset:1024 sc1
 s_nop 3
 buffer_load_dwordx4 v[92:95], v6, s[4:7], s53 offen offset:0 sc1
 s_nop 3
 buffer_load_dwordx4 v[104:107], v6, s[4:7], s53 offen offset:3072 sc1
 s_nop 3
 buffer_load_dwordx4 v[100:103], v6, s[4:7], s53 offen offset:2048 sc1
L_cg_w1_loop:
 s_and_b32 s59, s52, 3
 s_add_u32 s54, s53, 262144
 s_lshl_b32 s60, s59, 16
 s_add_u32 s55, s68, s60
 v_add_u32 v30, 1, v30
L_cg_w1_dtry:
 s_waitcnt vmcnt(3)
 v_smfmac_f32_16x16x64_bf16 v[56:59], v[96:99], a[48:55], v5
 v_smfmac_f32_16x16x64_bf16 v[60:63], v[96:99], a[56:63], v5
 v_smfmac_f32_16x16x64_bf16 v[64:67], v[96:99], a[64:71], v5
 v_smfmac_f32_16x16x64_bf16 v[68:71], v[96:99], a[72:79], v5
 s_waitcnt vmcnt(2)
 v_smfmac_f32_16x16x64_bf16 v[56:59], v[92:95], a[0:7], v5
 v_smfmac_f32_16x16x64_bf16 v[60:63], v[92:95], a[8:15], v5
 v_smfmac_f32_16x16x64_bf16 v[64:67], v[92:95], a[16:23], v5
 v_smfmac_f32_16x16x64_bf16 v[68:71], v[92:95], a[24:31], v5
 s_waitcnt vmcnt(1)
 v_smfmac_f32_16x16x64_bf16 v[56:59], v[104:107], a[144:151], v5
 v_smfmac_f32_16x16x64_bf16 v[60:63], v[104:107], a[152:159], v5
 v_smfmac_f32_16x16x64_bf16 v[64:67], v[104:107], a[160:167], v5
 v_smfmac_f32_16x16x64_bf16 v[68:71], v[104:107], a[168:175], v5
 s_waitcnt vmcnt(0)
 v_smfmac_f32_16x16x64_bf16 v[56:59], v[100:103], a[96:103], v5
 v_smfmac_f32_16x16x64_bf16 v[60:63], v[100:103], a[104:111], v5
 v_smfmac_f32_16x16x64_bf16 v[64:67], v[100:103], a[112:119], v5
 v_smfmac_f32_16x16x64_bf16 v[68:71], v[100:103], a[120:127], v5
 s_nop 4
 v_pk_add_f32 v[84:85], v[56:57], v[58:59]
 ds_write2_b32 v7, v84, v85 offset0:0 offset1:36
 v_cmp_u_f32 vcc, v84, v85
 v_pk_add_f32 v[86:87], v[60:61], v[62:63]
 ds_write2_b32 v7, v86, v87 offset0:16 offset1:52
 v_pk_add_f32 v[88:89], v[64:65], v[66:67]
 ds_write2_b32 v8, v88, v89 offset0:0 offset1:36
 v_pk_add_f32 v[90:91], v[68:69], v[70:71]
 ds_write2_b32 v8, v90, v91 offset0:16 offset1:52
 s_cbranch_vccnz L_cg_w1_dslow
L_cg_w1_dgood:
 v_smfmac_f32_16x16x64_bf16 v[72:75], v[92:95], a[32:39], v5
 v_smfmac_f32_16x16x64_bf16 v[76:79], v[92:95], a[40:47], v5
 v_smfmac_f32_16x16x64_bf16 v[72:75], v[96:99], a[80:87], v5
 v_smfmac_f32_16x16x64_bf16 v[76:79], v[96:99], a[88:95], v5
 s_waitcnt lgkmcnt(0)
 s_barrier
 v_smfmac_f32_16x16x64_bf16 v[72:75], v[100:103], a[128:135], v5
 v_smfmac_f32_16x16x64_bf16 v[76:79], v[100:103], a[136:143], v5
 v_smfmac_f32_16x16x64_bf16 v[72:75], v[104:107], a[176:183], v5
 v_smfmac_f32_16x16x64_bf16 v[76:79], v[104:107], a[184:191], v5
 buffer_store_dword v30, v27, s[4:7], s69 offen sc1
 s_nop 7
 v_pk_add_f32 v[84:85], v[72:73], v[74:75]
 v_pk_add_f32 v[86:87], v[76:77], v[78:79]
 ds_write_b128 v10, v[84:87] offset:14336
 s_mov_b32 exec_lo, 15
 s_mov_b32 exec_hi, 0
L_cg_w1_apoll:
 v_cmp_gt_u32 vcc, v30, v39
 buffer_load_dword v39, v28, s[4:7], s69 offen sc1
 s_nop 2
 buffer_load_dword v39, v28, s[4:7], s69 offen sc1
 s_cbranch_vccz L_cg_w1_ago
 v_cmp_gt_u32 vcc, v30, v39
 buffer_load_dword v39, v28, s[4:7], s69 offen sc1
 s_nop 2
 buffer_load_dword v39, v28, s[4:7], s69 offen sc1
 s_cbranch_vccz L_cg_w1_ago
 v_cmp_gt_u32 vcc, v30, v39
 buffer_load_dword v39, v28, s[4:7], s69 offen sc1
 s_nop 2
 buffer_load_dword v39, v28, s[4:7], s69 offen sc1
 s_cbranch_vccz L_cg_w1_ago
 v_cmp_gt_u32 vcc, v30, v39
 buffer_load_dword v39, v28, s[4:7], s69 offen sc1
 s_nop 2
 buffer_load_dword v39, v28, s[4:7], s69 offen sc1
 s_cbranch_vccz L_cg_w1_ago
 v_cmp_gt_u32 vcc, v30, v39
 buffer_load_dword v39, v28, s[4:7], s69 offen sc1
 s_nop 2
 buffer_load_dword v39, v28, s[4:7], s69 offen sc1
 s_cbranch_vccz L_cg_w1_ago
 v_cmp_gt_u32 vcc, v30, v39
 buffer_load_dword v39, v28, s[4:7], s69 offen sc1
 s_nop 2
 buffer_load_dword v39, v28, s[4:7], s69 offen sc1
 s_cbranch_vccz L_cg_w1_ago
 v_cmp_gt_u32 vcc, v30, v39
 buffer_load_dword v39, v28, s[4:7], s69 offen sc1
 s_nop 2
 buffer_load_dword v39, v28, s[4:7], s69 offen sc1
 s_cbranch_vccz L_cg_w1_ago
 v_cmp_gt_u32 vcc, v30, v39
 buffer_load_dword v39, v28, s[4:7], s69 offen sc1
 s_nop 2
 buffer_load_dword v39, v28, s[4:7], s69 offen sc1
 s_cbranch_vccz L_cg_w1_ago
 v_cmp_gt_u32 vcc, v30, v39
 buffer_load_dword v39, v28, s[4:7], s69 offen sc1
 s_nop 2
 buffer_load_dword v39, v28, s[4:7], s69 offen sc1
 s_cbranch_vccz L_cg_w1_ago
 v_cmp_gt_u32 vcc, v30, v39
 buffer_load_dword v39, v28, s[4:7], s69 offen sc1
 s_nop 2
 buffer_load_dword v39, v28, s[4:7], s69 offen sc1
 s_cbranch_vccz L_cg_w1_ago
 s_waitcnt vmcnt(36)
 s_add_u32 s62, s62, 1
 s_cmp_lt_u32 s62, 400000
 s_cbranch_scc1 L_cg_w1_apoll
 s_branch L_done
L_cg_w1_ago:
 s_mov_b64 exec, -1
 s_waitcnt lgkmcnt(0)
 s_barrier
 s_cmp_eq_u32 s52, 63
 s_cbranch_scc1 L_cg_w1_done
 s_lshr_b32 s60, s52, 3
 s_lshr_b32 s60, s27, s60
 s_and_b32 s60, s60, 1
 s_lshl_b32 s60, s60, 13
 s_lshl_b32 s56, s52, 18
 s_add_u32 s56, s56, s60
 s_add_u32 s56, s56, 134217728
 s_mov_b32 m0, 24576
 s_add_u32 s61, s52, 4
 s_lshr_b32 s60, s61, 3
 s_lshr_b32 s60, s27, s60
 s_and_b32 s60, s60, 1
 s_lshl_b32 s60, s60, 13
 s_lshl_b32 s65, s61, 18
 s_add_u32 s65, s65, s60
 s_add_u32 s65, s65, 134217728
 s_cmp_gt_u32 s61, 62
 s_cselect_b32 s65, 1073741824, s65
 s_add_u32 s57, s57, 0x40000
 s_add_u32 s61, s52, 1
L_cg_w1_kv:
 s_min_u32 s59, s79, s80
 s_cmp_gt_u32 s59, s61
 s_cbranch_scc1 L_cg_w1_kv_ok
 s_load_dword s79, s[4:5], s77 glc
 s_load_dword s80, s[4:5], s78 glc
 s_add_u32 s62, s62, 1
 s_cmp_gt_u32 s62, 400000
 s_cbranch_scc1 L_done
 s_waitcnt lgkmcnt(0)
 s_branch L_cg_w1_kv
L_cg_w1_kv_ok:
 s_add_u32 s60, s52, 3
 s_min_u32 s60, s60, 63
 s_cmp_gt_u32 s59, s60
 s_cbranch_scc1 L_cg_w1_kvfresh
 s_load_dword s79, s[4:5], s77 glc
 s_load_dword s80, s[4:5], s78 glc
L_cg_w1_kvfresh:
 s_mov_b32 exec_lo, s71
 s_mov_b32 exec_hi, 0
L_cg_w1_bpoll:
 v_cmp_gt_u32 vcc, v30, v40
 buffer_load_dword v40, v26, s[4:7], s69 offen sc1
 s_nop 2
 buffer_load_dword v40, v26, s[4:7], s69 offen sc1
 s_cbranch_vccz L_cg_w1_bgo
 v_cmp_gt_u32 vcc, v30, v40
 buffer_load_dword v40, v26, s[4:7], s69 offen sc1
 s_nop 2
 buffer_load_dword v40, v26, s[4:7], s69 offen sc1
 s_cbranch_vccz L_cg_w1_bgo
 v_cmp_gt_u32 vcc, v30, v40
 buffer_load_dword v40, v26, s[4:7], s69 offen sc1
 s_nop 2
 buffer_load_dword v40, v26, s[4:7], s69 offen sc1
 s_cbranch_vccz L_cg_w1_bgo
 v_cmp_gt_u32 vcc, v30, v40
 buffer_load_dword v40, v26, s[4:7], s69 offen sc1
 s_nop 2
 buffer_load_dword v40, v26, s[4:7], s69 offen sc1
 s_cbranch_vccz L_cg_w1_bgo
 v_cmp_gt_u32 vcc, v30, v40
 buffer_load_dword v40, v26, s[4:7], s69 offen sc1
 s_nop 2
 buffer_load_dword v40, v26, s[4:7], s69 offen sc1
 s_cbranch_vccz L_cg_w1_bgo
 v_cmp_gt_u32 vcc, v30, v40
 buffer_load_dword v40, v26, s[4:7], s69 offen sc1
 s_nop 2
 buffer_load_dword v40, v26, s[4:7], s69 offen sc1
 s_cbranch_vccz L_cg_w1_bgo
 v_cmp_gt_u32 vcc, v30, v40
 buffer_load_dword v40, v26, s[4:7], s69 offen sc1
 s_nop 2
 buffer_load_dword v40, v26, s[4:7], s69 offen sc1
 s_cbranch_vccz L_cg_w1_bgo
 v_cmp_gt_u32 vcc, v30, v40
 buffer_load_dword v40, v26, s[4:7], s69 offen sc1
 s_nop 2
 buffer_load_dword v40, v26, s[4:7], s69 offen sc1
 s_cbranch_vccz L_cg_w1_bgo
 v_cmp_gt_u32 vcc, v30, v40
 buffer_load_dword v40, v26, s[4:7], s69 offen sc1
 s_nop 2
 buffer_load_dword v40, v26, s[4:7], s69 offen sc1
 s_cbranch_vccz L_cg_w1_bgo
 v_cmp_gt_u32 vcc, v30, v40
 buffer_load_dword v40, v26, s[4:7], s69 offen sc1
 s_nop 2
 buffer_load_dword v40, v26, s[4:7], s69 offen sc1
 s_cbranch_vccz L_cg_w1_bgo
 s_waitcnt vmcnt(36)
 s_add_u32 s62, s62, 1
 s_cmp_lt_u32 s62, 400000
 s_cbranch_scc1 L_cg_w1_bpoll
 s_branch L_done
L_cg_w1_bgo:
 s_mov_b64 exec, -1
 s_barrier
 buffer_load_dwordx4 v6, s[4:7], s54 offen offset:1024 sc1 lds
 s_nop 3
 buffer_load_dwordx4 v6, s[4:7], s54 offen offset:0 sc1 lds
 s_nop 3
 buffer_load_dwordx4 v6, s[4:7], s54 offen offset:3072 sc1 lds
 s_nop 3
 buffer_load_dwordx4 v6, s[4:7], s54 offen offset:2048 sc1 lds
 s_add_u32 s52, s52, 1
 s_and_b32 s61, s52, 3
 s_lshl_b32 s61, s61, 14
 s_add_u32 s53, s67, s61
 v_mov_b32 v56, 0
 v_mov_b32 v57, 0
 v_mov_b32 v58, 0
 v_mov_b32 v59, 0
 v_mov_b32 v60, 0
 v_mov_b32 v61, 0
 v_mov_b32 v62, 0
 v_mov_b32 v63, 0
 v_mov_b32 v64, 0
 v_mov_b32 v65, 0
 v_mov_b32 v66, 0
 v_mov_b32 v67, 0
 v_mov_b32 v68, 0
 v_mov_b32 v69, 0
 v_mov_b32 v70, 0
 v_mov_b32 v71, 0
 v_mov_b32 v72, 0
 v_mov_b32 v73, 0
 v_mov_b32 v74, 0
 v_mov_b32 v75, 0
 v_mov_b32 v76, 0
 v_mov_b32 v77, 0
 v_mov_b32 v78, 0
 v_mov_b32 v79, 0
 s_waitcnt vmcnt(3)
 s_barrier
 s_nop 5
 s_atomic_umax s52, s[4:5], s74
 s_atomic_umax s52, s[4:5], s75
 s_atomic_umax s52, s[4:5], s76
 s_waitcnt vmcnt(2)
 s_barrier
 s_nop 1
 s_mov_b32 m0, 49152
 s_add_u32 s59, s57, 16775168
 buffer_load_dwordx4 v2, s[4:7], s57 offen sc1 lds
 buffer_load_dwordx4 v2, s[4:7], s57 offen offset:1024 sc1 lds
 buffer_load_dwordx4 v2, s[4:7], s59 offen offset:2048 sc1 lds
 buffer_load_dwordx4 v2, s[4:7], s59 offen offset:3072 sc1 lds
 s_waitcnt vmcnt(5)
 s_barrier
 buffer_store_dwordx4 v[50:53], v24, s[4:7], s65 offen sc1
 s_waitcnt vmcnt(5)
 s_barrier
L_cg_w1_bjoin:
 s_barrier
 buffer_load_dwordx4 v[108:111], v44, s[4:7], s56 offen sc1
 buffer_load_dwordx4 v[112:115], v45, s[4:7], s56 offen sc1
 buffer_load_dwordx4 v[116:119], v46, s[4:7], s56 offen sc1
 ds_read_b32 v32, v37 offset:19456
 ds_read_b128 v[120:123], v2 offset:18432
 s_waitcnt lgkmcnt(0)
 v_cmp_ne_u32 vcc, 0, v32
 s_cbranch_vccnz L_cg_w1_bretry
 s_waitcnt vmcnt(2)
 buffer_store_dword v30, v25, s[4:7], s70 offen sc1
 v_pk_add_f32 v[124:125], v[120:121], v[108:109]
 v_pk_add_f32 v[126:127], v[122:123], v[110:111]
 s_waitcnt vmcnt(2)
 v_pk_add_f32 v[124:125], v[124:125], v[112:113]
 v_pk_add_f32 v[126:127], v[126:127], v[114:115]
 s_waitcnt vmcnt(1)
 v_pk_add_f32 v[124:125], v[124:125], v[116:117]
 v_pk_add_f32 v[126:127], v[126:127], v[118:119]
 v_cmpx_o_f32 vcc, v124, v125
 v_cmpx_o_f32 vcc, v126, v127
 v_cvt_pk_bf16_f32 v128, v124, v125
 v_cvt_pk_bf16_f32 v129, v126, v127
 buffer_store_dwordx2 v[128:129], v16, s[4:7], s53 offen sc1
 s_cmp_eq_u64 exec, -1
 s_cbranch_scc0 L_cg_w1_cslow
L_cg_w1_cgood:
 s_barrier
 buffer_load_dwordx4 v[96:99], v6, s[4:7], s53 offen offset:1024 sc1
 s_nop 3
 buffer_load_dwordx4 v[92:95], v6, s[4:7], s53 offen offset:0 sc1
 s_nop 3
 buffer_load_dwordx4 v[104:107], v6, s[4:7], s53 offen offset:3072 sc1
 s_nop 3
 buffer_load_dwordx4 v[100:103], v6, s[4:7], s53 offen offset:2048 sc1
 s_branch L_cg_w1_loop
L_cg_w1_dslow:
 v_max_u32 v36, v92, v93
 v_max3_u32 v36, v36, v94, v95
 v_max3_u32 v36, v36, v96, v97
 v_max3_u32 v36, v36, v98, v99
 v_max3_u32 v36, v36, v100, v101
 v_max3_u32 v36, v36, v102, v103
 v_max3_u32 v36, v36, v104, v105
 v_max3_u32 v36, v36, v106, v107
 v_cmp_eq_u32 vcc, -1, v36
 s_cbranch_vccz L_cg_w1_dgood
L_cg_w1_dagain:
 buffer_load_dwordx4 v[96:99], v6, s[4:7], s53 offen offset:1024 sc1
 buffer_load_dwordx4 v[92:95], v6, s[4:7], s53 offen offset:0 sc1
 buffer_load_dwordx4 v[104:107], v6, s[4:7], s53 offen offset:3072 sc1
 buffer_load_dwordx4 v[100:103], v6, s[4:7], s53 offen offset:2048 sc1
 v_mov_b32 v56, 0
 v_mov_b32 v57, 0
 v_mov_b32 v58, 0
 v_mov_b32 v59, 0
 v_mov_b32 v60, 0
 v_mov_b32 v61, 0
 v_mov_b32 v62, 0
 v_mov_b32 v63, 0
 v_mov_b32 v64, 0
 v_mov_b32 v65, 0
 v_mov_b32 v66, 0
 v_mov_b32 v67, 0
 v_mov_b32 v68, 0
 v_mov_b32 v69, 0
 v_mov_b32 v70, 0
 v_mov_b32 v71, 0
 s_add_u32 s62, s62, 1
 s_cmp_gt_u32 s62, 400000
 s_cbranch_scc1 L_done
 s_waitcnt vmcnt(0)
 v_max_u32 v36, v92, v93
 v_max3_u32 v36, v36, v94, v95
 v_max3_u32 v36, v36, v96, v97
 v_max3_u32 v36, v36, v98, v99
 v_max3_u32 v36, v36, v100, v101
 v_max3_u32 v36, v36, v102, v103
 v_max3_u32 v36, v36, v104, v105
 v_max3_u32 v36, v36, v106, v107
 v_cmp_eq_u32 vcc, -1, v36
 s_cbranch_vccnz L_cg_w1_dagain
 s_branch L_cg_w1_dtry
L_cg_w1_bretry:
 s_add_u32 s62, s62, 1
 s_cmp_gt_u32 s62, 400000
 s_cbranch_scc1 L_done
 s_mov_b32 m0, 24576
 s_nop 0
 buffer_load_dwordx4 v6, s[4:7], s54 offen offset:1024 sc1 lds
 s_nop 3
 buffer_load_dwordx4 v6, s[4:7], s54 offen offset:0 sc1 lds
 s_nop 3
 buffer_load_dwordx4 v6, s[4:7], s54 offen offset:3072 sc1 lds
 s_nop 3
 buffer_load_dwordx4 v6, s[4:7], s54 offen offset:2048 sc1 lds
 s_waitcnt vmcnt(3)
 s_barrier
 s_waitcnt vmcnt(2)
 s_barrier
 s_waitcnt vmcnt(1)
 s_barrier
 s_waitcnt vmcnt(0)
 s_barrier
 s_branch L_cg_w1_bjoin
L_cg_w1_cslow:
 s_mov_b64 exec, -1
 v_max_u32 v36, v108, v109
 v_max3_u32 v36, v36, v110, v111
 v_max3_u32 v36, v36, v112, v113
 v_max3_u32 v36, v36, v114, v115
 v_max3_u32 v36, v36, v116, v117
 v_max3_u32 v36, v36, v118, v119
 v_cmp_eq_u32 vcc, -1, v36
 s_cbranch_vccz L_cg_w1_cfull
 buffer_load_dwordx4 v[108:111], v44, s[4:7], s56 offen sc1
 buffer_load_dwordx4 v[112:115], v45, s[4:7], s56 offen sc1
 buffer_load_dwordx4 v[116:119], v46, s[4:7], s56 offen sc1
 s_add_u32 s62, s62, 1
 s_cmp_gt_u32 s62, 400000
 s_cbranch_scc1 L_done
 s_waitcnt vmcnt(2)
 v_pk_add_f32 v[124:125], v[120:121], v[108:109]
 v_pk_add_f32 v[126:127], v[122:123], v[110:111]
 s_waitcnt vmcnt(1)
 v_pk_add_f32 v[124:125], v[124:125], v[112:113]
 v_pk_add_f32 v[126:127], v[126:127], v[114:115]
 s_waitcnt vmcnt(0)
 v_pk_add_f32 v[124:125], v[124:125], v[116:117]
 v_pk_add_f32 v[126:127], v[126:127], v[118:119]
 s_branch L_cg_w1_cslow
L_cg_w1_cfull:
 v_cvt_pk_bf16_f32 v128, v124, v125
 v_cvt_pk_bf16_f32 v129, v126, v127
 buffer_store_dwordx2 v[128:129], v16, s[4:7], s53 offen sc1
 s_branch L_cg_w1_cgood
L_cg_w1_done:
 s_branch L_done
L_cg_w2:
 v_mov_b32 v56, 0
 v_mov_b32 v57, 0
 v_mov_b32 v58, 0
 v_mov_b32 v59, 0
 v_mov_b32 v60, 0
 v_mov_b32 v61, 0
 v_mov_b32 v62, 0
 v_mov_b32 v63, 0
 v_mov_b32 v64, 0
 v_mov_b32 v65, 0
 v_mov_b32 v66, 0
 v_mov_b32 v67, 0
 v_mov_b32 v68, 0
 v_mov_b32 v69, 0
 v_mov_b32 v70, 0
 v_mov_b32 v71, 0
 v_mov_b32 v72, 0
 v_mov_b32 v73, 0
 v_mov_b32 v74, 0
 v_mov_b32 v75, 0
 v_mov_b32 v76, 0
 v_mov_b32 v77, 0
 v_mov_b32 v78, 0
 v_mov_b32 v79, 0
 s_waitcnt vmcnt(0)
 s_barrier
 buffer_load_dwordx4 v[100:103], v6, s[4:7], s53 offen offset:2048 sc1
 s_nop 3
 buffer_load_dwordx4 v[104:107], v6, s[4:7], s53 offen offset:3072 sc1
 s_nop 3
 buffer_load_dwordx4 v[92:95], v6, s[4:7], s53 offen offset:0 sc1
 s_nop 3
 buffer_load_dwordx4 v[96:99], v6, s[4:7], s53 offen offset:1024 sc1
L_cg_w2_loop:
 s_and_b32 s59, s52, 3
 s_add_u32 s54, s53, 262144
 s_lshl_b32 s60, s59, 16
 s_add_u32 s55, s68, s60
 v_add_u32 v30, 1, v30
L_cg_w2_dtry:
 s_waitcnt vmcnt(3)
 v_smfmac_f32_16x16x64_bf16 v[56:59], v[100:103], a[96:103], v5
 v_smfmac_f32_16x16x64_bf16 v[60:63], v[100:103], a[104:111], v5
 v_smfmac_f32_16x16x64_bf16 v[64:67], v[100:103], a[112:119], v5
 v_smfmac_f32_16x16x64_bf16 v[68:71], v[100:103], a[120:127], v5
 s_waitcnt vmcnt(2)
 v_smfmac_f32_16x16x64_bf16 v[56:59], v[104:107], a[144:151], v5
 v_smfmac_f32_16x16x64_bf16 v[60:63], v[104:107], a[152:159], v5
 v_smfmac_f32_16x16x64_bf16 v[64:67], v[104:107], a[160:167], v5
 v_smfmac_f32_16x16x64_bf16 v[68:71], v[104:107], a[168:175], v5
 s_waitcnt vmcnt(1)
 v_smfmac_f32_16x16x64_bf16 v[56:59], v[92:95], a[0:7], v5
 v_smfmac_f32_16x16x64_bf16 v[60:63], v[92:95], a[8:15], v5
 v_smfmac_f32_16x16x64_bf16 v[64:67], v[92:95], a[16:23], v5
 v_smfmac_f32_16x16x64_bf16 v[68:71], v[92:95], a[24:31], v5
 s_waitcnt vmcnt(0)
 v_smfmac_f32_16x16x64_bf16 v[56:59], v[96:99], a[48:55], v5
 v_smfmac_f32_16x16x64_bf16 v[60:63], v[96:99], a[56:63], v5
 v_smfmac_f32_16x16x64_bf16 v[64:67], v[96:99], a[64:71], v5
 v_smfmac_f32_16x16x64_bf16 v[68:71], v[96:99], a[72:79], v5
 s_nop 4
 v_pk_add_f32 v[84:85], v[56:57], v[58:59]
 ds_write2_b32 v7, v84, v85 offset0:0 offset1:36
 v_cmp_u_f32 vcc, v84, v85
 v_pk_add_f32 v[86:87], v[60:61], v[62:63]
 ds_write2_b32 v7, v86, v87 offset0:16 offset1:52
 v_pk_add_f32 v[88:89], v[64:65], v[66:67]
 ds_write2_b32 v8, v88, v89 offset0:0 offset1:36
 v_pk_add_f32 v[90:91], v[68:69], v[70:71]
 ds_write2_b32 v8, v90, v91 offset0:16 offset1:52
 s_cbranch_vccnz L_cg_w2_dslow
L_cg_w2_dgood:
 v_smfmac_f32_16x16x64_bf16 v[72:75], v[92:95], a[32:39], v5
 v_smfmac_f32_16x16x64_bf16 v[76:79], v[92:95], a[40:47], v5
 v_smfmac_f32_16x16x64_bf16 v[72:75], v[96:99], a[80:87], v5
 v_smfmac_f32_16x16x64_bf16 v[76:79], v[96:99], a[88:95], v5
 s_waitcnt lgkmcnt(0)
 s_barrier
 v_smfmac_f32_16x16x64_bf16 v[72:75], v[100:103], a[128:135], v5
 v_smfmac_f32_16x16x64_bf16 v[76:79], v[100:103], a[136:143], v5
 v_smfmac_f32_16x16x64_bf16 v[72:75], v[104:107], a[176:183], v5
 v_smfmac_f32_16x16x64_bf16 v[76:79], v[104:107], a[184:191], v5
 s_nop 7
 v_pk_add_f32 v[84:85], v[72:73], v[74:75]
 v_pk_add_f32 v[86:87], v[76:77], v[78:79]
 ds_write_b128 v10, v[84:87] offset:14336
 s_waitcnt lgkmcnt(0)
 s_barrier
 s_cmp_eq_u32 s52, 63
 s_cbranch_scc1 L_cg_w2_done
 s_lshr_b32 s60, s52, 3
 s_lshr_b32 s60, s27, s60
 s_and_b32 s60, s60, 1
 s_lshl_b32 s60, s60, 13
 s_lshl_b32 s56, s52, 18
 s_add_u32 s56, s56, s60
 s_add_u32 s56, s56, 134217728
 s_mov_b32 m0, 28672
 v_mov_b32 v80, 0
 v_mov_b32 v81, 0
 v_mov_b32 v82, 0
 v_mov_b32 v83, 0
 s_barrier
 buffer_load_dwordx4 v6, s[4:7], s54 offen offset:2048 sc1 lds
 s_nop 3
 buffer_load_dwordx4 v6, s[4:7], s54 offen offset:3072 sc1 lds
 s_nop 3
 buffer_load_dwordx4 v6, s[4:7], s54 offen offset:0 sc1 lds
 s_nop 3
 buffer_load_dwordx4 v6, s[4:7], s54 offen offset:1024 sc1 lds
 s_add_u32 s52, s52, 1
 s_and_b32 s61, s52, 3
 s_lshl_b32 s61, s61, 14
 s_add_u32 s53, s67, s61
 v_mov_b32 v56, 0
 v_mov_b32 v57, 0
 v_mov_b32 v58, 0
 v_mov_b32 v59, 0
 v_mov_b32 v60, 0
 v_mov_b32 v61, 0
 v_mov_b32 v62, 0
 v_mov_b32 v63, 0
 v_mov_b32 v64, 0
 v_mov_b32 v65, 0
 v_mov_b32 v66, 0
 v_mov_b32 v67, 0
 v_mov_b32 v68, 0
 v_mov_b32 v69, 0
 v_mov_b32 v70, 0
 v_mov_b32 v71, 0
 v_mov_b32 v72, 0
 v_mov_b32 v73, 0
 v_mov_b32 v74, 0
 v_mov_b32 v75, 0
 v_mov_b32 v76, 0
 v_mov_b32 v77, 0
 v_mov_b32 v78, 0
 v_mov_b32 v79, 0
L_cg_w2_bwait:
 s_waitcnt vmcnt(3)
 s_barrier
 ds_read_b128 v[108:111], v20 offset:20480
 ds_read_b128 v[128:131], v20 offset:25600
 ds_read_b128 v[148:151], v20 offset:30720
 ds_read_b128 v[168:171], v20 offset:35840
 s_waitcnt lgkmcnt(3)
 v_smfmac_f32_16x16x64_bf16 v[80:83], v[108:111], a[192:199], v5
 s_waitcnt vmcnt(2)
 s_barrier
 ds_read_b128 v[112:115], v20 offset:21504
 ds_read_b128 v[124:127], v20 offset:24576
 ds_read_b128 v[152:155], v20 offset:31744
 ds_read_b128 v[164:167], v20 offset:34816
 s_waitcnt lgkmcnt(6)
 v_smfmac_f32_16x16x64_bf16 v[80:83], v[128:131], a[216:223], v5
 s_waitcnt lgkmcnt(5)
 v_smfmac_f32_16x16x64_bf16 v[80:83], v[148:151], v[204:211], v5
 s_waitcnt lgkmcnt(4)
 v_smfmac_f32_16x16x64_bf16 v[80:83], v[168:171], v[228:235], v5
 s_waitcnt lgkmcnt(3)
 v_smfmac_f32_16x16x64_bf16 v[80:83], v[112:115], a[200:207], v5
 s_waitcnt vmcnt(1)
 s_barrier
 ds_read_b128 v[116:119], v20 offset:22528
 ds_read_b128 v[136:139], v20 offset:27648
 ds_read_b128 v[140:143], v20 offset:28672
 ds_read_b128 v[160:163], v20 offset:33792
 s_waitcnt lgkmcnt(6)
 v_smfmac_f32_16x16x64_bf16 v[80:83], v[124:127], a[208:215], v5
 s_waitcnt lgkmcnt(5)
 v_smfmac_f32_16x16x64_bf16 v[80:83], v[152:155], v[212:219], v5
 s_waitcnt lgkmcnt(4)
 v_smfmac_f32_16x16x64_bf16 v[80:83], v[164:167], v[220:227], v5
 s_waitcnt lgkmcnt(3)
 v_smfmac_f32_16x16x64_bf16 v[80:83], v[116:119], v[172:179], v5
 s_waitcnt vmcnt(0)
 s_barrier
 ds_read_b128 v[120:123], v20 offset:23552
 ds_read_b128 v[132:135], v20 offset:26624
 ds_read_b128 v[144:147], v20 offset:29696
 ds_read_b128 v[156:159], v20 offset:32768
 s_waitcnt lgkmcnt(6)
 v_smfmac_f32_16x16x64_bf16 v[80:83], v[136:139], v[196:203], v5
 s_waitcnt lgkmcnt(5)
 v_smfmac_f32_16x16x64_bf16 v[80:83], v[140:143], a[224:231], v5
 s_waitcnt lgkmcnt(4)
 v_smfmac_f32_16x16x64_bf16 v[80:83], v[160:163], a[248:255], v5
 s_waitcnt lgkmcnt(3)
 v_smfmac_f32_16x16x64_bf16 v[80:83], v[120:123], v[180:187], v5
 s_waitcnt lgkmcnt(2)
 v_smfmac_f32_16x16x64_bf16 v[80:83], v[132:135], v[188:195], v5
 s_waitcnt lgkmcnt(1)
 v_smfmac_f32_16x16x64_bf16 v[80:83], v[144:147], a[232:239], v5
 s_waitcnt lgkmcnt(0)
 v_smfmac_f32_16x16x64_bf16 v[80:83], v[156:159], a[240:247], v5
 s_nop 7
 v_pk_add_f32 v[84:85], v[80:81], v[82:83]
 v_cmpx_o_f32 vcc, v84, v85
 buffer_store_dword v84, v15, s[4:7], s56 offen sc1
 buffer_store_dword v85, v15, s[4:7], s56 offen offset:256 sc1
 s_cmp_eq_u64 exec, -1
 s_cbranch_scc0 L_cg_w2_bslow
L_cg_w2_bgood:
 ds_write2st64_b32 v4, v84, v85 offset0:72 offset1:73
 ds_write_b32 v37, v37 offset:19456
 s_nop 15
 s_nop 15
 s_nop 15
 s_nop 15
 s_nop 5
 s_waitcnt lgkmcnt(0)
 s_barrier
 s_nop 15
 s_nop 15
 s_nop 15
 s_nop 11
 s_mov_b32 exec_lo, s71
 s_mov_b32 exec_hi, 0
L_cg_w2_spoll:
 v_cmp_gt_u32 vcc, v30, v41
 buffer_load_dword v41, v26, s[4:7], s70 offen sc1
 s_nop 2
 buffer_load_dword v41, v26, s[4:7], s70 offen sc1
 s_cbranch_vccz L_cg_w2_sgo
 v_cmp_gt_u32 vcc, v30, v41
 buffer_load_dword v41, v26, s[4:7], s70 offen sc1
 s_nop 2
 buffer_load_dword v41, v26, s[4:7], s70 offen sc1
 s_cbranch_vccz L_cg_w2_sgo
 v_cmp_gt_u32 vcc, v30, v41
 buffer_load_dword v41, v26, s[4:7], s70 offen sc1
 s_nop 2
 buffer_load_dword v41, v26, s[4:7], s70 offen sc1
 s_cbranch_vccz L_cg_w2_sgo
 v_cmp_gt_u32 vcc, v30, v41
 buffer_load_dword v41, v26, s[4:7], s70 offen sc1
 s_nop 2
 buffer_load_dword v41, v26, s[4:7], s70 offen sc1
 s_cbranch_vccz L_cg_w2_sgo
 v_cmp_gt_u32 vcc, v30, v41
 buffer_load_dword v41, v26, s[4:7], s70 offen sc1
 s_nop 2
 buffer_load_dword v41, v26, s[4:7], s70 offen sc1
 s_cbranch_vccz L_cg_w2_sgo
 v_cmp_gt_u32 vcc, v30, v41
 buffer_load_dword v41, v26, s[4:7], s70 offen sc1
 s_nop 2
 buffer_load_dword v41, v26, s[4:7], s70 offen sc1
 s_cbranch_vccz L_cg_w2_sgo
 v_cmp_gt_u32 vcc, v30, v41
 buffer_load_dword v41, v26, s[4:7], s70 offen sc1
 s_nop 2
 buffer_load_dword v41, v26, s[4:7], s70 offen sc1
 s_cbranch_vccz L_cg_w2_sgo
 v_cmp_gt_u32 vcc, v30, v41
 buffer_load_dword v41, v26, s[4:7], s70 offen sc1
 s_nop 2
 buffer_load_dword v41, v26, s[4:7], s70 offen sc1
 s_cbranch_vccz L_cg_w2_sgo
 v_cmp_gt_u32 vcc, v30, v41
 buffer_load_dword v41, v26, s[4:7], s70 offen sc1
 s_nop 2
 buffer_load_dword v41, v26, s[4:7], s70 offen sc1
 s_cbranch_vccz L_cg_w2_sgo
 v_cmp_gt_u32 vcc, v30, v41
 buffer_load_dword v41, v26, s[4:7], s70 offen sc1
 s_nop 2
 buffer_load_dword v41, v26, s[4:7], s70 offen sc1
 s_cbranch_vccz L_cg_w2_sgo
 s_waitcnt vmcnt(36)
 s_add_u32 s62, s62, 1
 s_cmp_lt_u32 s62, 400000
 s_cbranch_scc1 L_cg_w2_spoll
 s_branch L_done
L_cg_w2_sgo:
 s_mov_b64 exec, -1
 s_barrier
 buffer_load_dwordx4 v[100:103], v6, s[4:7], s53 offen offset:2048 sc1
 s_nop 3
 buffer_load_dwordx4 v[104:107], v6, s[4:7], s53 offen offset:3072 sc1
 s_nop 3
 buffer_load_dwordx4 v[92:95], v6, s[4:7], s53 offen offset:0 sc1
 s_nop 3
 buffer_load_dwordx4 v[96:99], v6, s[4:7], s53 offen offset:1024 sc1
 s_branch L_cg_w2_loop
L_cg_w2_dslow:
 v_max_u32 v36, v92, v93
 v_max3_u32 v36, v36, v94, v95
 v_max3_u32 v36, v36, v96, v97
 v_max3_u32 v36, v36, v98, v99
 v_max3_u32 v36, v36, v100, v101
 v_max3_u32 v36, v36, v102, v103
 v_max3_u32 v36, v36, v104, v105
 v_max3_u32 v36, v36, v106, v107
 v_cmp_eq_u32 vcc, -1, v36
 s_cbranch_vccz L_cg_w2_dgood
L_cg_w2_dagain:
 buffer_load_dwordx4 v[100:103], v6, s[4:7], s53 offen offset:2048 sc1
 buffer_load_dwordx4 v[104:107], v6, s[4:7], s53 offen offset:3072 sc1
 buffer_load_dwordx4 v[92:95], v6, s[4:7], s53 offen offset:0 sc1
 buffer_load_dwordx4 v[96:99], v6, s[4:7], s53 offen offset:1024 sc1
 v_mov_b32 v56, 0
 v_mov_b32 v57, 0
 v_mov_b32 v58, 0
 v_mov_b32 v59, 0
 v_mov_b32 v60, 0
 v_mov_b32 v61, 0
 v_mov_b32 v62, 0
 v_mov_b32 v63, 0
 v_mov_b32 v64, 0
 v_mov_b32 v65, 0
 v_mov_b32 v66, 0
 v_mov_b32 v67, 0
 v_mov_b32 v68, 0
 v_mov_b32 v69, 0
 v_mov_b32 v70, 0
 v_mov_b32 v71, 0
 s_add_u32 s62, s62, 1
 s_cmp_gt_u32 s62, 400000
 s_cbranch_scc1 L_done
 s_waitcnt vmcnt(0)
 v_max_u32 v36, v92, v93
 v_max3_u32 v36, v36, v94, v95
 v_max3_u32 v36, v36, v96, v97
 v_max3_u32 v36, v36, v98, v99
 v_max3_u32 v36, v36, v100, v101
 v_max3_u32 v36, v36, v102, v103
 v_max3_u32 v36, v36, v104, v105
 v_max3_u32 v36, v36, v106, v107
 v_cmp_eq_u32 vcc, -1, v36
 s_cbranch_vccnz L_cg_w2_dagain
 s_branch L_cg_w2_dtry
L_cg_w2_bslow:
 s_mov_b64 exec, -1
 v_max_u32 v36, v108, v109
 v_max3_u32 v36, v36, v110, v111
 v_max3_u32 v36, v36, v112, v113
 v_max3_u32 v36, v36, v114, v115
 v_max3_u32 v36, v36, v116, v117
 v_max3_u32 v36, v36, v118, v119
 v_max3_u32 v36, v36, v120, v121
 v_max3_u32 v36, v36, v122, v123
 v_max3_u32 v36, v36, v124, v125
 v_max3_u32 v36, v36, v126, v127
 v_max3_u32 v36, v36, v128, v129
 v_max3_u32 v36, v36, v130, v131
 v_max3_u32 v36, v36, v132, v133
 v_max3_u32 v36, v36, v134, v135
 v_max3_u32 v36, v36, v136, v137
 v_max3_u32 v36, v36, v138, v139
 v_max3_u32 v36, v36, v140, v141
 v_max3_u32 v36, v36, v142, v143
 v_max3_u32 v36, v36, v144, v145
 v_max3_u32 v36, v36, v146, v147
 v_max3_u32 v36, v36, v148, v149
 v_max3_u32 v36, v36, v150, v151
 v_max3_u32 v36, v36, v152, v153
 v_max3_u32 v36, v36, v154, v155
 v_max3_u32 v36, v36, v156, v157
 v_max3_u32 v36, v36, v158, v159
 v_max3_u32 v36, v36, v160, v161
 v_max3_u32 v36, v36, v162, v163
 v_max3_u32 v36, v36, v164, v165
 v_max3_u32 v36, v36, v166, v167
 v_max3_u32 v36, v36, v168, v169
 v_max3_u32 v36, v36, v170, v171
 v_cmp_eq_u32 vcc, -1, v36
 s_cbranch_vccnz L_cg_w2_bagain
 buffer_store_dword v84, v15, s[4:7], s56 offen sc1
 buffer_store_dword v85, v15, s[4:7], s56 offen offset:256 sc1
 s_branch L_cg_w2_bgood
L_cg_w2_bagain:
 ds_write_b32 v37, v50 offset:19456
 v_mov_b32 v80, 0
 v_mov_b32 v81, 0
 v_mov_b32 v82, 0
 v_mov_b32 v83, 0
 s_add_u32 s62, s62, 1
 s_cmp_gt_u32 s62, 400000
 s_cbranch_scc1 L_done
 s_waitcnt lgkmcnt(0)
 s_barrier
 buffer_load_dwordx4 v6, s[4:7], s54 offen offset:2048 sc1 lds
 s_nop 3
 buffer_load_dwordx4 v6, s[4:7], s54 offen offset:3072 sc1 lds
 s_nop 3
 buffer_load_dwordx4 v6, s[4:7], s54 offen offset:0 sc1 lds
 s_nop 3
 buffer_load_dwordx4 v6, s[4:7], s54 offen offset:1024 sc1 lds
 s_branch L_cg_w2_bwait
L_cg_w2_done:
 s_branch L_done
L_cg_w3:
 v_mov_b32 v56, 0
 v_mov_b32 v57, 0
 v_mov_b32 v58, 0
 v_mov_b32 v59, 0
 v_mov_b32 v60, 0
 v_mov_b32 v61, 0
 v_mov_b32 v62, 0
 v_mov_b32 v63, 0
 v_mov_b32 v64, 0
 v_mov_b32 v65, 0
 v_mov_b32 v66, 0
 v_mov_b32 v67, 0
 v_mov_b32 v68, 0
 v_mov_b32 v69, 0
 v_mov_b32 v70, 0
 v_mov_b32 v71, 0
 v_mov_b32 v72, 0
 v_mov_b32 v73, 0
 v_mov_b32 v74, 0
 v_mov_b32 v75, 0
 v_mov_b32 v76, 0
 v_mov_b32 v77, 0
 v_mov_b32 v78, 0
 v_mov_b32 v79, 0
 s_waitcnt vmcnt(0)
 s_barrier
 buffer_load_dwordx4 v[104:107], v6, s[4:7], s53 offen offset:3072 sc1
 s_nop 3
 buffer_load_dwordx4 v[100:103], v6, s[4:7], s53 offen offset:2048 sc1
 s_nop 3
 buffer_load_dwordx4 v[96:99], v6, s[4:7], s53 offen offset:1024 sc1
 s_nop 3
 buffer_load_dwordx4 v[92:95], v6, s[4:7], s53 offen offset:0 sc1
L_cg_w3_loop:
 s_and_b32 s59, s52, 3
 s_add_u32 s54, s53, 262144
 s_lshl_b32 s60, s59, 16
 s_add_u32 s55, s68, s60
 v_add_u32 v30, 1, v30
L_cg_w3_dtry:
 s_waitcnt vmcnt(3)
 v_smfmac_f32_16x16x64_bf16 v[56:59], v[104:107], a[144:151], v5
 v_smfmac_f32_16x16x64_bf16 v[60:63], v[104:107], a[152:159], v5
 v_smfmac_f32_16x16x64_bf16 v[64:67], v[104:107], a[160:167], v5
 v_smfmac_f32_16x16x64_bf16 v[68:71], v[104:107], a[168:175], v5
 s_waitcnt vmcnt(2)
 v_smfmac_f32_16x16x64_bf16 v[56:59], v[100:103], a[96:103], v5
 v_smfmac_f32_16x16x64_bf16 v[60:63], v[100:103], a[104:111], v5
 v_smfmac_f32_16x16x64_bf16 v[64:67], v[100:103], a[112:119], v5
 v_smfmac_f32_16x16x64_bf16 v[68:71], v[100:103], a[120:127], v5
 s_waitcnt vmcnt(1)
 v_smfmac_f32_16x16x64_bf16 v[56:59], v[96:99], a[48:55], v5
 v_smfmac_f32_16x16x64_bf16 v[60:63], v[96:99], a[56:63], v5
 v_smfmac_f32_16x16x64_bf16 v[64:67], v[96:99], a[64:71], v5
 v_smfmac_f32_16x16x64_bf16 v[68:71], v[96:99], a[72:79], v5
 s_waitcnt vmcnt(0)
 v_smfmac_f32_16x16x64_bf16 v[56:59], v[92:95], a[0:7], v5
 v_smfmac_f32_16x16x64_bf16 v[60:63], v[92:95], a[8:15], v5
 v_smfmac_f32_16x16x64_bf16 v[64:67], v[92:95], a[16:23], v5
 v_smfmac_f32_16x16x64_bf16 v[68:71], v[92:95], a[24:31], v5
 s_nop 4
 v_pk_add_f32 v[84:85], v[56:57], v[58:59]
 ds_write2_b32 v7, v84, v85 offset0:0 offset1:36
 v_cmp_u_f32 vcc, v84, v85
 v_pk_add_f32 v[86:87], v[60:61], v[62:63]
 ds_write2_b32 v7, v86, v87 offset0:16 offset1:52
 v_pk_add_f32 v[88:89], v[64:65], v[66:67]
 ds_write2_b32 v8, v88, v89 offset0:0 offset1:36
 v_pk_add_f32 v[90:91], v[68:69], v[70:71]
 ds_write2_b32 v8, v90, v91 offset0:16 offset1:52
 s_cbranch_vccnz L_cg_w3_dslow
L_cg_w3_dgood:
 v_smfmac_f32_16x16x64_bf16 v[72:75], v[92:95], a[32:39], v5
 v_smfmac_f32_16x16x64_bf16 v[76:79], v[92:95], a[40:47], v5
 v_smfmac_f32_16x16x64_bf16 v[72:75], v[96:99], a[80:87], v5
 v_smfmac_f32_16x16x64_bf16 v[76:79], v[96:99], a[88:95], v5
 s_waitcnt lgkmcnt(0)
 s_barrier
 v_smfmac_f32_16x16x64_bf16 v[72:75], v[100:103], a[128:135], v5
 v_smfmac_f32_16x16x64_bf16 v[76:79], v[100:103], a[136:143], v5
 v_smfmac_f32_16x16x64_bf16 v[72:75], v[104:107], a[176:183], v5
 v_smfmac_f32_16x16x64_bf16 v[76:79], v[104:107], a[184:191], v5
 s_nop 7
 v_pk_add_f32 v[84:85], v[72:73], v[74:75]
 v_pk_add_f32 v[86:87], v[76:77], v[78:79]
 ds_write_b128 v10, v[84:87] offset:14336
 s_waitcnt lgkmcnt(0)
 s_barrier
 s_cmp_eq_u32 s52, 63
 s_cbranch_scc1 L_cg_w3_done
 s_lshr_b32 s60, s52, 3
 s_lshr_b32 s60, s27, s60
 s_and_b32 s60, s60, 1
 s_lshl_b32 s60, s60, 13
 s_lshl_b32 s56, s52, 18
 s_add_u32 s56, s56, s60
 s_add_u32 s56, s56, 134217728
 s_mov_b32 m0, 32768
 v_mov_b32 v80, 0
 v_mov_b32 v81, 0
 v_mov_b32 v82, 0
 v_mov_b32 v83, 0
 s_xor_b32 s63, s53, 0x8000
 s_xor_b32 s64, s55, 0x20000
 s_barrier
 buffer_load_dwordx4 v6, s[4:7], s54 offen offset:3072 sc1 lds
 s_nop 3
 buffer_load_dwordx4 v6, s[4:7], s54 offen offset:2048 sc1 lds
 s_nop 3
 buffer_load_dwordx4 v6, s[4:7], s54 offen offset:1024 sc1 lds
 s_nop 3
 buffer_load_dwordx4 v6, s[4:7], s54 offen offset:0 sc1 lds
 s_add_u32 s52, s52, 1
 s_and_b32 s61, s52, 3
 s_lshl_b32 s61, s61, 14
 s_add_u32 s53, s67, s61
 v_mov_b32 v56, 0
 v_mov_b32 v57, 0
 v_mov_b32 v58, 0
 v_mov_b32 v59, 0
 v_mov_b32 v60, 0
 v_mov_b32 v61, 0
 v_mov_b32 v62, 0
 v_mov_b32 v63, 0
 v_mov_b32 v64, 0
 v_mov_b32 v65, 0
 v_mov_b32 v66, 0
 v_mov_b32 v67, 0
 v_mov_b32 v68, 0
 v_mov_b32 v69, 0
 v_mov_b32 v70, 0
 v_mov_b32 v71, 0
 v_mov_b32 v72, 0
 v_mov_b32 v73, 0
 v_mov_b32 v74, 0
 v_mov_b32 v75, 0
 v_mov_b32 v76, 0
 v_mov_b32 v77, 0
 v_mov_b32 v78, 0
 v_mov_b32 v79, 0
L_cg_w3_bwait:
 s_waitcnt vmcnt(3)
 s_barrier
 ds_read_b128 v[108:111], v20 offset:20480
 ds_read_b128 v[128:131], v20 offset:25600
 ds_read_b128 v[148:151], v20 offset:30720
 ds_read_b128 v[168:171], v20 offset:35840
 s_waitcnt lgkmcnt(3)
 v_smfmac_f32_16x16x64_bf16 v[80:83], v[108:111], a[192:199], v5
 s_waitcnt vmcnt(2)
 s_barrier
 ds_read_b128 v[112:115], v20 offset:21504
 ds_read_b128 v[124:127], v20 offset:24576
 ds_read_b128 v[152:155], v20 offset:31744
 ds_read_b128 v[164:167], v20 offset:34816
 s_waitcnt lgkmcnt(6)
 v_smfmac_f32_16x16x64_bf16 v[80:83], v[128:131], a[216:223], v5
 s_waitcnt lgkmcnt(5)
 v_smfmac_f32_16x16x64_bf16 v[80:83], v[148:151], v[204:211], v5
 s_waitcnt lgkmcnt(4)
 v_smfmac_f32_16x16x64_bf16 v[80:83], v[168:171], v[228:235], v5
 s_waitcnt lgkmcnt(3)
 v_smfmac_f32_16x16x64_bf16 v[80:83], v[112:115], a[200:207], v5
 s_waitcnt vmcnt(1)
 s_barrier
 ds_read_b128 v[116:119], v20 offset:22528
 ds_read_b128 v[136:139], v20 offset:27648
 ds_read_b128 v[140:143], v20 offset:28672
 ds_read_b128 v[160:163], v20 offset:33792
 s_waitcnt lgkmcnt(6)
 v_smfmac_f32_16x16x64_bf16 v[80:83], v[124:127], a[208:215], v5
 s_waitcnt lgkmcnt(5)
 v_smfmac_f32_16x16x64_bf16 v[80:83], v[152:155], v[212:219], v5
 s_waitcnt lgkmcnt(4)
 v_smfmac_f32_16x16x64_bf16 v[80:83], v[164:167], v[220:227], v5
 s_waitcnt lgkmcnt(3)
 v_smfmac_f32_16x16x64_bf16 v[80:83], v[116:119], v[172:179], v5
 s_waitcnt vmcnt(0)
 s_barrier
 ds_read_b128 v[120:123], v20 offset:23552
 ds_read_b128 v[132:135], v20 offset:26624
 ds_read_b128 v[144:147], v20 offset:29696
 ds_read_b128 v[156:159], v20 offset:32768
 s_waitcnt lgkmcnt(6)
 v_smfmac_f32_16x16x64_bf16 v[80:83], v[136:139], v[196:203], v5
 s_waitcnt lgkmcnt(5)
 v_smfmac_f32_16x16x64_bf16 v[80:83], v[140:143], a[224:231], v5
 s_waitcnt lgkmcnt(4)
 v_smfmac_f32_16x16x64_bf16 v[80:83], v[160:163], a[248:255], v5
 s_waitcnt lgkmcnt(3)
 v_smfmac_f32_16x16x64_bf16 v[80:83], v[120:123], v[180:187], v5
 s_waitcnt lgkmcnt(2)
 v_smfmac_f32_16x16x64_bf16 v[80:83], v[132:135], v[188:195], v5
 s_waitcnt lgkmcnt(1)
 v_smfmac_f32_16x16x64_bf16 v[80:83], v[144:147], a[232:239], v5
 s_waitcnt lgkmcnt(0)
 v_smfmac_f32_16x16x64_bf16 v[80:83], v[156:159], a[240:247], v5
 s_nop 7
 v_pk_add_f32 v[84:85], v[80:81], v[82:83]
 v_cmpx_o_f32 vcc, v84, v85
 buffer_store_dword v84, v15, s[4:7], s56 offen sc1
 buffer_store_dword v85, v15, s[4:7], s56 offen offset:256 sc1
 s_cmp_eq_u64 exec, -1
 s_cbranch_scc0 L_cg_w3_bslow
L_cg_w3_bgood:
 ds_write2st64_b32 v4, v84, v85 offset0:74 offset1:75
 s_add_u32 s60, s63, 262144
 buffer_store_dwordx4 v[50:53], v21, s[4:7], s63 offen sc1
 buffer_store_dwordx4 v[50:53], v21, s[4:7], s60 offen sc1
 buffer_store_dwordx4 v[50:53], v22, s[4:7], s64 offen sc1
 buffer_store_dwordx4 v[50:53], v23, s[4:7], s64 offen offset:1024 sc1
 s_waitcnt lgkmcnt(0)
 s_barrier
 s_barrier
 buffer_load_dwordx4 v[104:107], v6, s[4:7], s53 offen offset:3072 sc1
 s_nop 3
 buffer_load_dwordx4 v[100:103], v6, s[4:7], s53 offen offset:2048 sc1
 s_nop 3
 buffer_load_dwordx4 v[96:99], v6, s[4:7], s53 offen offset:1024 sc1
 s_nop 3
 buffer_load_dwordx4 v[92:95], v6, s[4:7], s53 offen offset:0 sc1
 s_branch L_cg_w3_loop
L_cg_w3_dslow:
 v_max_u32 v36, v92, v93
 v_max3_u32 v36, v36, v94, v95
 v_max3_u32 v36, v36, v96, v97
 v_max3_u32 v36, v36, v98, v99
 v_max3_u32 v36, v36, v100, v101
 v_max3_u32 v36, v36, v102, v103
 v_max3_u32 v36, v36, v104, v105
 v_max3_u32 v36, v36, v106, v107
 v_cmp_eq_u32 vcc, -1, v36
 s_cbranch_vccz L_cg_w3_dgood
L_cg_w3_dagain:
 buffer_load_dwordx4 v[104:107], v6, s[4:7], s53 offen offset:3072 sc1
 buffer_load_dwordx4 v[100:103], v6, s[4:7], s53 offen offset:2048 sc1
 buffer_load_dwordx4 v[96:99], v6, s[4:7], s53 offen offset:1024 sc1
 buffer_load_dwordx4 v[92:95], v6, s[4:7], s53 offen offset:0 sc1
 v_mov_b32 v56, 0
 v_mov_b32 v57, 0
 v_mov_b32 v58, 0
 v_mov_b32 v59, 0
 v_mov_b32 v60, 0
 v_mov_b32 v61, 0
 v_mov_b32 v62, 0
 v_mov_b32 v63, 0
 v_mov_b32 v64, 0
 v_mov_b32 v65, 0
 v_mov_b32 v66, 0
 v_mov_b32 v67, 0
 v_mov_b32 v68, 0
 v_mov_b32 v69, 0
 v_mov_b32 v70, 0
 v_mov_b32 v71, 0
 s_add_u32 s62, s62, 1
 s_cmp_gt_u32 s62, 400000
 s_cbranch_scc1 L_done
 s_waitcnt vmcnt(0)
 v_max_u32 v36, v92, v93
 v_max3_u32 v36, v36, v94, v95
 v_max3_u32 v36, v36, v96, v97
 v_max3_u32 v36, v36, v98, v99
 v_max3_u32 v36, v36, v100, v101
 v_max3_u32 v36, v36, v102, v103
 v_max3_u32 v36, v36, v104, v105
 v_max3_u32 v36, v36, v106, v107
 v_cmp_eq_u32 vcc, -1, v36
 s_cbranch_vccnz L_cg_w3_dagain
 s_branch L_cg_w3_dtry
L_cg_w3_bslow:
 s_mov_b64 exec, -1
 v_max_u32 v36, v108, v109
 v_max3_u32 v36, v36, v110, v111
 v_max3_u32 v36, v36, v112, v113
 v_max3_u32 v36, v36, v114, v115
 v_max3_u32 v36, v36, v116, v117
 v_max3_u32 v36, v36, v118, v119
 v_max3_u32 v36, v36, v120, v121
 v_max3_u32 v36, v36, v122, v123
 v_max3_u32 v36, v36, v124, v125
 v_max3_u32 v36, v36, v126, v127
 v_max3_u32 v36, v36, v128, v129
 v_max3_u32 v36, v36, v130, v131
 v_max3_u32 v36, v36, v132, v133
 v_max3_u32 v36, v36, v134, v135
 v_max3_u32 v36, v36, v136, v137
 v_max3_u32 v36, v36, v138, v139
 v_max3_u32 v36, v36, v140, v141
 v_max3_u32 v36, v36, v142, v143
 v_max3_u32 v36, v36, v144, v145
 v_max3_u32 v36, v36, v146, v147
 v_max3_u32 v36, v36, v148, v149
 v_max3_u32 v36, v36, v150, v151
 v_max3_u32 v36, v36, v152, v153
 v_max3_u32 v36, v36, v154, v155
 v_max3_u32 v36, v36, v156, v157
 v_max3_u32 v36, v36, v158, v159
 v_max3_u32 v36, v36, v160, v161
 v_max3_u32 v36, v36, v162, v163
 v_max3_u32 v36, v36, v164, v165
 v_max3_u32 v36, v36, v166, v167
 v_max3_u32 v36, v36, v168, v169
 v_max3_u32 v36, v36, v170, v171
 v_cmp_eq_u32 vcc, -1, v36
 s_cbranch_vccnz L_cg_w3_bagain
 buffer_store_dword v84, v15, s[4:7], s56 offen sc1
 buffer_store_dword v85, v15, s[4:7], s56 offen offset:256 sc1
 s_branch L_cg_w3_bgood
L_cg_w3_bagain:
 v_mov_b32 v80, 0
 v_mov_b32 v81, 0
 v_mov_b32 v82, 0
 v_mov_b32 v83, 0
 s_add_u32 s62, s62, 1
 s_cmp_gt_u32 s62, 400000
 s_cbranch_scc1 L_done
 s_waitcnt lgkmcnt(0)
 s_barrier
 buffer_load_dwordx4 v6, s[4:7], s54 offen offset:3072 sc1 lds
 s_nop 3
 buffer_load_dwordx4 v6, s[4:7], s54 offen offset:2048 sc1 lds
 s_nop 3
 buffer_load_dwordx4 v6, s[4:7], s54 offen offset:1024 sc1 lds
 s_nop 3
 buffer_load_dwordx4 v6, s[4:7], s54 offen offset:0 sc1 lds
 s_branch L_cg_w3_bwait
L_cg_w3_done:
 s_branch L_done
.section .rodata,"a"
.p2align 6
.amdhsa_kernel concat_heads__memory_aug_recurrent_mem_tr__ssm_conv_s4__prompt_kernel
  .amdhsa_next_free_vgpr 512
  .amdhsa_next_free_sgpr 102
  .amdhsa_accum_offset 256
  .amdhsa_group_segment_fixed_size 0
  .amdhsa_kernarg_size 152
  .amdhsa_user_sgpr_count 2
  .amdhsa_user_sgpr_kernarg_segment_ptr 1
  .amdhsa_system_sgpr_workgroup_id_x 1
  .amdhsa_float_denorm_mode_32 3
.end_amdhsa_kernel
```

```asm
; @launch grid=(256,1,1) block=(256,1,1) lds=153600
.amdgcn_target "amdgcn-amd-amdhsa--gfx950"
.text
.globl concat_heads__memory_aug_recurrent_mem_tr__ssm_conv_s4__prompt_kernel
.p2align 8
.type concat_heads__memory_aug_recurrent_mem_tr__ssm_conv_s4__prompt_kernel,@function
concat_heads__memory_aug_recurrent_mem_tr__ssm_conv_s4__prompt_kernel:
 s_cmp_ge_u32 s2, 256
 s_cbranch_scc1 L_exit
 s_load_dwordx2 s[4:5], s[0:1], 144
 s_load_dwordx2 s[12:13], s[0:1], 136
 s_load_dwordx8 s[16:23], s[0:1], 16
 s_load_dwordx16 s[68:83], s[0:1], 64
 s_load_dwordx2 s[84:85], s[0:1], 56
 s_getreg_b32 s24, hwreg(HW_REG_XCC_ID, 0, 4)
 v_lshrrev_b32 v1, 6, v0
 s_mov_b32 s6, 0xf000000
 s_mov_b32 s7, 0x20000
 v_readfirstlane_b32 s26, v1
 s_mov_b32 s14, 256
 s_mov_b32 s15, 0x20000
 s_mov_b32 s27, 0
 s_mov_b32 s29, 0
 s_mov_b32 s30, 32
 s_and_b32 s32, s2, 7
 s_lshl_b32 s32, s32, 5
 s_lshr_b32 s28, s2, 3
 s_add_u32 s28, s28, s32
 s_waitcnt lgkmcnt(0)
 s_add_u32 s4, s4, 0x1fffff
 s_addc_u32 s5, s5, 0
 s_and_b32 s4, s4, 0xffe00000
 v_mov_b32 v2, 153536
 s_mov_b64 s[34:35], 1
 s_cmp_lg_u32 s26, 0
 s_cbranch_scc1 L_start
 s_and_b32 s32, s24, 3
 s_lshl_b32 s32, s32, 6
 s_and_b32 s33, s24, 12
 s_add_u32 s32, s32, s33
 v_mov_b32 v3, s32
 v_mov_b32 v4, 1
 s_mov_b64 exec, 1
 buffer_atomic_add v4, v3, s[12:15], 0 offen sc0 sc1
 s_mov_b64 exec, -1
L_start:
 s_mov_b32 s31, 0
 s_mul_i32 s94, s26, 21888
 s_add_u32 s94, s94, 65536
 v_and_b32 v64, 63, v0
 s_lshl_b32 s92, s28, 2
 s_add_u32 s92, s92, s26
 s_lshl_b32 s93, s92, 8
 v_lshl_add_u32 v65, v64, 2, s93
 s_lshl_b32 s93, s92, 1
 v_mov_b32 v66, s93
 s_mov_b32 s86, 4194304
 s_mov_b32 s87, 0x20000
 s_mov_b32 s96, 0x05040100
 s_mov_b32 s97, 0x07060302
 s_mov_b32 s98, 0xffff0000
 s_lshl_b32 s93, s28, 3
 global_load_dword v88, v65, s[68:69]
 global_load_dword v89, v65, s[70:71]
 global_load_dword v90, v65, s[72:73]
 global_load_dword v91, v65, s[74:75]
 global_load_dword v92, v65, s[76:77]
 global_load_dword v93, v65, s[78:79]
 global_load_ushort v94, v66, s[80:81]
 s_and_b32 s92, s28, 15
 s_lshl_b32 s92, s92, 18
 s_add_u32 s92, s92, s93
 v_lshrrev_b32 v65, 1, v0
 v_lshlrev_b32 v65, 11, v65
 buffer_load_dword v72, v65, s[84:87], s92 offen sc1
 s_cmp_eq_u32 s29, 1
 s_cbranch_scc1 L_dispatch
 s_cmp_lg_u32 s26, 0
 s_cbranch_scc1 L_notfirst
 s_waitcnt vmcnt(8)
 s_mov_b64 exec, 1
 ds_write_b32 v2, v4
 s_mov_b64 exec, -1
L_notfirst:
 s_waitcnt lgkmcnt(0)
 s_barrier
 ds_read_b32 v4, v2
 s_waitcnt lgkmcnt(0)
 v_readfirstlane_b32 s25, v4
 s_cmp_ge_u32 s25, 32
 s_cbranch_scc1 L_odd
 s_cmp_lt_u32 s24, 8
 s_cbranch_scc1 L_dispatch
L_odd:
 v_mov_b32 v4, 1
 buffer_store_dword v4, off, s[12:15], s30 offset:8 sc1
 s_waitcnt vmcnt(0)
 v_mov_b32 v4, s34
 v_mov_b32 v5, s35
 v_bfrev_b32 v6, 1
 v_cmp_eq_u32 vcc, 64, v0
 s_nop 1
 v_cndmask_b32 v6, v6, 0, vcc
 buffer_atomic_add_x2 v[4:5], v6, s[12:15], s30 offen sc1
 s_mov_b32 s3, 0
L_rdy_1:
 buffer_load_dwordx4 v[8:11], off, s[12:15], s30 sc1
 s_add_u32 s3, s3, 1
 s_cmp_gt_u32 s3, 400000
 s_cbranch_scc1 L_exit
 s_waitcnt vmcnt(0)
 v_readfirstlane_b32 s32, v8
 v_readfirstlane_b32 s33, v9
 v_readfirstlane_b32 vcc_hi, v10
 s_and_b32 vcc_lo, s32, 0xffff
 s_cmp_lt_u32 vcc_lo, 256
 s_cbranch_scc1 L_rdy_1
 s_cmp_lg_u32 vcc_hi, 0
 s_cbranch_scc1 L_general
L_general:
 s_waitcnt vmcnt(0) lgkmcnt(0)
 s_barrier
 s_mov_b32 s29, 1
 s_mov_b32 s30, 48
 s_mov_b32 s27, 0
 s_lshr_b32 s24, s2, 5
 s_and_b32 s25, s2, 31
 s_add_u32 s4, s4, 0x200000
 s_addc_u32 s5, s5, 0
 s_load_dwordx16 s[68:83], s[0:1], 64
 s_load_dwordx2 s[84:85], s[0:1], 56
 s_waitcnt lgkmcnt(0)
 s_branch L_start
L_dispatch:
 s_cmp_eq_u32 s24, 4
 s_cbranch_scc1 L_role_K
 s_cmp_eq_u32 s24, 5
 s_cbranch_scc1 L_role_Q
 s_cmp_eq_u32 s24, 6
 s_cbranch_scc1 L_role_V
 s_cmp_eq_u32 s24, 7
 s_cbranch_scc1 L_role_O
 s_cmp_eq_u32 s29, 1
 s_cbranch_scc1 L_role_G
 s_mov_b32 s10, 8388608
 s_mov_b32 s11, 0x20000
 v_and_b32 v1, 63, v0
 v_lshrrev_b32 v32, 2, v1
 v_and_b32 v33, 3, v1
 v_lshlrev_b32 v33, 4, v33
 v_lshl_add_u32 v39, v32, 13, v33
 v_lshl_add_u32 v40, v32, 11, v33
 s_lshl_b32 s55, s24, 5
 s_add_u32 s55, s55, s25
 s_lshl_b32 s55, s55, 6
 s_lshl_b32 s56, s26, 21
 s_add_u32 s42, s55, s56
 s_lshl_b32 s55, s24, 21
 s_lshl_b32 s56, s25, 6
 s_add_u32 s55, s55, s56
 s_lshl_b32 s56, s26, 19
 s_add_u32 s44, s55, s56
 s_lshl_b32 s46, s26, 13
 s_and_b32 s55, s25, 1
 s_mul_i32 s55, s55, 2
 s_lshl_b32 s56, s55, 17
 s_sub_u32 s43, s42, s56
 s_add_u32 s42, s42, s56
 s_lshl_b32 s56, s55, 15
 s_sub_u32 s45, s44, s56
 s_add_u32 s44, s44, s56
 s_lshl_b32 s56, s55, 10
 s_sub_u32 s47, s46, s56
 s_add_u32 s46, s46, s56
 s_mov_b64 s[8:9], s[16:17]
 s_add_u32 m0, s46, 0
 s_add_u32 s55, s42, 0
 buffer_load_dwordx4 v39, s[8:11], s55 offen  lds
 s_add_u32 m0, s46, 1024
 s_add_u32 s55, s42, 131072
 buffer_load_dwordx4 v39, s[8:11], s55 offen  lds
 s_add_u32 m0, s47, 2048
 s_add_u32 s55, s43, 262144
 buffer_load_dwordx4 v39, s[8:11], s55 offen  lds
 s_add_u32 m0, s47, 3072
 s_add_u32 s55, s43, 393216
 buffer_load_dwordx4 v39, s[8:11], s55 offen  lds
 s_add_u32 m0, s46, 4096
 s_add_u32 s55, s42, 524288
 buffer_load_dwordx4 v39, s[8:11], s55 offen  lds
 s_add_u32 m0, s46, 5120
 s_add_u32 s55, s42, 655360
 buffer_load_dwordx4 v39, s[8:11], s55 offen  lds
 s_add_u32 m0, s47, 6144
 s_add_u32 s55, s43, 786432
 buffer_load_dwordx4 v39, s[8:11], s55 offen  lds
 s_add_u32 m0, s47, 7168
 s_add_u32 s55, s43, 917504
 buffer_load_dwordx4 v39, s[8:11], s55 offen  lds
 v_and_b32 v1, 63, v0
 v_lshlrev_b32 v2, 4, v1
 v_lshlrev_b32 v3, 3, v1
 v_lshlrev_b32 v4, 2, v1
 v_mov_b32 v50, -1
 v_mov_b32 v51, -1
 v_mov_b32 v52, -1
 v_mov_b32 v53, -1
 v_bfrev_b32 v31, 1
 v_mov_b32 v37, 0
 v_mov_b32 v30, 0
 v_bfe_u32 v32, v1, 1, 1
 v_mul_u32_u24 v32, 0xaaaa, v32
 v_add_u32 v5, 0x4444, v32
 s_lshl_b32 s55, s26, 12
 v_add_u32 v6, s55, v2
 v_and_b32 v34, 15, v1
 v_lshrrev_b32 v35, 4, v1
 s_mul_i32 s55, s26, 2304
 s_add_u32 s55, s55, 4096
 v_mul_u32_u24 v32, 288, v35
 v_lshl_add_u32 v32, v34, 2, v32
 v_add_u32 v7, s55, v32
 v_add_u32 v8, 1152, v7
 v_mul_u32_u24 v32, 144, v34
 v_lshl_add_u32 v9, v35, 5, v32
 s_lshl_b32 s55, s26, 10
 v_add_u32 v10, s55, v2
 v_mov_b32 v32, 0x3e0293ee
 v_cmp_gt_u32 vcc, 8, v34
 s_nop 1
 v_cndmask_b32 v54, 1.0, v32, vcc
 s_mul_i32 s55, s25, 1280
 v_add_u32 v22, s55, v2
 v_cmp_gt_u32 vcc, 8, v34
 s_nop 1
 v_cndmask_b32 v11, v31, v22, vcc
 v_cmp_gt_u32 vcc, 16, v1
 s_nop 1
 v_cndmask_b32 v23, v31, v22, vcc
 v_lshlrev_b32 v32, 5, v34
 v_lshl_add_u32 v32, v35, 4, v32
 s_add_u32 s56, s55, 768
 v_add_u32 v32, s56, v32
 v_cmp_le_u32 vcc, 8, v34
 s_nop 1
 v_cndmask_b32 v32, v31, v32, vcc
 v_cmp_gt_u32 vcc, 2, v35
 s_nop 1
 v_cndmask_b32 v12, v31, v32, vcc
 s_xor_b32 s55, s25, 1
 s_mul_i32 s55, s55, 1280
 v_add_u32 v47, s55, v2
 s_xor_b32 s55, s25, 2
 s_mul_i32 s55, s55, 1280
 v_add_u32 v48, s55, v2
 s_xor_b32 s55, s25, 3
 s_mul_i32 s55, s55, 1280
 v_add_u32 v49, s55, v2
 s_and_b32 s55, s25, 28
 s_mul_i32 s55, s55, 1280
 s_add_u32 s55, s55, 1024
 v_add_u32 v13, s55, v4
 s_lshl_b32 s55, s25, 9
 v_lshlrev_b32 v32, 4, v34
 v_lshl_add_u32 v32, v35, 7, v32
 v_add_u32 v32, s55, v32
 v_cmp_gt_u32 vcc, 8, v34
 s_nop 1
 v_cndmask_b32 v14, v31, v32, vcc
 v_lshrrev_b32 v32, 2, v34
 v_and_b32 v36, 1, v34
 v_lshl_add_u32 v32, v32, 1, v36
 v_bfe_u32 v36, v34, 1, 1
 v_lshl_add_u32 v32, v36, 3, v32
 v_lshl_add_u32 v32, v35, 4, v32
 v_lshlrev_b32 v20, 4, v32
 v_add_u32 v32, s55, v2
 v_cmp_gt_u32 vcc, 32, v1
 s_nop 1
 v_cndmask_b32 v21, v31, v32, vcc
 v_lshrrev_b32 v32, 5, v1
 v_lshlrev_b32 v32, 8, v32
 v_bfe_u32 v36, v1, 1, 3
 v_lshl_add_u32 v32, v36, 5, v32
 v_bfe_u32 v36, v1, 4, 1
 v_lshl_add_u32 v32, v36, 4, v32
 v_and_b32 v36, 1, v1
 v_lshl_add_u32 v32, v36, 3, v32
 v_add_u32 v16, s55, v32
 s_lshr_b32 s55, s25, 1
 s_lshl_b32 s55, s55, 14
 s_and_b32 s56, s25, 1
 s_lshl_b32 s56, s56, 12
 s_add_u32 s55, s55, s56
 v_mov_b32 v29, v31
 s_add_u32 s56, s24, 1
 s_and_b32 s56, s56, 3
 s_lshl_b32 s56, s56, 10
 s_add_u32 s56, s56, s55
 v_add_u32 v44, s56, v2
 s_add_u32 s56, s56, 0
 v_writelane_b32 v29, s56, 0
 s_mov_b32 s70, s56
 s_add_u32 s56, s24, 2
 s_and_b32 s56, s56, 3
 s_lshl_b32 s56, s56, 10
 s_add_u32 s56, s56, s55
 v_add_u32 v45, s56, v2
 s_add_u32 s56, s56, 4
 v_writelane_b32 v29, s56, 1
 s_mov_b32 s71, s56
 s_add_u32 s56, s24, 3
 s_and_b32 s56, s56, 3
 s_lshl_b32 s56, s56, 10
 s_add_u32 s56, s56, s55
 v_add_u32 v46, s56, v2
 s_add_u32 s56, s56, 8
 v_writelane_b32 v29, s56, 2
 s_mov_b32 s72, s56
 s_lshl_b32 s56, s24, 10
 s_add_u32 s55, s55, s56
 v_add_u32 v24, s55, v2
 s_mov_b32 s69, s55
 s_and_b32 s56, s26, 1
 s_lshl_b32 s56, s56, 9
 s_add_u32 s55, s55, s56
 v_add_u32 v15, s55, v4
 v_lshrrev_b32 v32, 2, v34
 v_and_b32 v36, 3, v34
 v_lshl_add_u32 v32, v32, 3, v36
 v_lshlrev_b32 v32, 4, v32
 v_lshl_add_u32 v17, v35, 9, v32
 v_lshlrev_b32 v32, 4, v34
 v_lshl_add_u32 v18, v35, 9, v32
 v_lshl_add_u32 v32, v35, 7, v32
 v_subrev_u32 v32, 128, v32
 v_cmp_le_u32 vcc, 8, v34
 s_nop 1
 v_cndmask_b32 v19, v31, v32, vcc
 s_lshl_b32 s55, s24, 3
 s_lshr_b32 s56, s25, 2
 s_add_u32 s55, s55, s56
 s_lshl_b32 s55, s55, 7
 s_and_b32 s56, s25, 3
 s_lshl_b32 s56, s56, 2
 s_add_u32 s55, s55, s56
 s_add_u32 s73, s55, 3735552
 s_add_u32 s74, s55, 3735568
 s_add_u32 s55, s55, 3739648
 v_mov_b32 v32, s55
 v_cmp_eq_u32 vcc, 0, v1
 s_nop 1
 v_cndmask_b32 v42, v31, v32, vcc
 s_lshr_b32 s55, s25, 3
 s_lshl_b32 s56, s25, 2
 v_lshl_add_u32 v32, v1, 8, s56
 v_cmp_gt_u32 vcc, 4, v1
 s_nop 1
 v_cndmask_b32 v25, v31, v32, vcc
 v_cmp_ne_u32 vcc, s55, v1
 s_nop 1
 v_cndmask_b32 v25, v31, v25, vcc
 v_lshrrev_b32 v36, 3, v1
 s_and_b32 s56, s56, 28
 s_sub_u32 s56, s56, 3072
 v_lshl_add_u32 v32, v1, 7, s56
 s_add_u32 s56, s55, 4
 v_cmp_eq_u32 vcc, s56, v36
 s_nop 1
 v_cndmask_b32 v25, v25, v32, vcc
 s_add_u32 s56, s25, 32
 v_cmp_ne_u32 vcc, s56, v1
 s_nop 1
 v_cndmask_b32 v25, v31, v25, vcc
 s_lshl_b32 s56, s55, 8
 v_add_u32 v26, s56, v4
 s_lshl_b32 s56, s25, 7
 s_add_u32 s56, s56, 1024
 v_and_b32 v32, 28, v4
 v_add_u32 v32, s56, v32
 v_cmp_eq_u32 vcc, s55, v36
 s_nop 1
 v_cndmask_b32 v26, v26, v32, vcc
 s_lshl_b32 s67, 1, s25
 s_not_b32 s67, s67
 s_lshr_b32 s55, s25, 2
 s_lshl_b32 s55, s55, 8
 s_add_u32 s55, s55, 6144
 v_add_u32 v28, s55, v4
 s_and_b32 s56, s25, 3
 v_cmp_eq_u32 vcc, s56, v1
 s_nop 1
 v_cndmask_b32 v27, v31, v28, vcc
 s_mov_b32 s62, 0x42200000
 s_lshl_b32 s63, s24, 16
 s_lshl_b32 s64, s24, 18
 s_add_u32 s64, s64, 2621440
 s_add_u32 s63, s63, 2097152
 s_lshl_b32 s65, s24, 14
 s_add_u32 s65, s65, 3670016
 s_add_u32 s66, s65, 8192
 s_lshl_b32 s55, s26, 14
 s_add_u32 s49, s63, s55
 s_add_u32 s50, s49, 262144
 s_lshl_b32 s55, s26, 16
 s_add_u32 s51, s64, s55
 s_lshl_b32 s52, s26, 18
 s_add_u32 s52, s52, 134217728
 s_add_u32 s61, s52, 8192
 s_mov_b32 s68, 150732800
 s_mov_b32 s59, 150740992
 s_load_dwordx2 s[36:37], s[0:1], 8
 v_lshrrev_b32 v36, 2, v34
 v_lshlrev_b32 v36, 1, v36
 v_and_b32 v32, 1, v34
 v_add_u32 v36, v36, v32
 v_lshlrev_b32 v36, 11, v36
 v_lshl_add_u32 v36, v35, 5, v36
 v_bfe_u32 v32, v34, 1, 1
 v_lshl_add_u32 v36, v32, 4, v36
 s_lshl_b32 s55, s25, 6
 s_mov_b32 s38, 16384
 s_mov_b32 s39, 0x20000
 buffer_store_dwordx4 v[50:53], v21, s[4:7], s49 offen
 buffer_store_dwordx4 v[50:53], v21, s[4:7], s50 offen
 buffer_store_dwordx4 v[50:53], v22, s[4:7], s51 offen
 buffer_store_dwordx4 v[50:53], v23, s[4:7], s51 offen offset:1024
 buffer_store_dwordx4 v[50:53], v24, s[4:7], s52 offen sc1
 buffer_store_dwordx4 v[50:53], v24, s[4:7], s61 offen sc1
 buffer_store_dword v37, v29, s[4:7], s59 offen sc1
 buffer_store_dword v37, v25, s[4:7], s65 offen
 buffer_store_dword v37, v27, s[4:7], s65 offen
 buffer_store_dword v37, v25, s[4:7], s66 offen
 buffer_store_dword v37, v29, s[4:7], s68 offen sc1
 buffer_store_dword v37, v42, s[4:7], 0 offen sc1
 s_waitcnt lgkmcnt(0)
 buffer_load_dwordx4 v[232:235], v36, s[36:39], s55 offen
 v_bfe_u32 v41, v1, 2, 1
 v_bfe_u32 v32, v1, 3, 1
 v_lshl_add_u32 v41, v32, 3, v41
 v_bfe_u32 v32, v1, 4, 1
 v_lshl_add_u32 v41, v32, 2, v41
 v_bfe_u32 v32, v1, 5, 1
 v_lshl_add_u32 v41, v32, 4, v41
 v_lshlrev_b32 v41, 6, v41
 v_and_b32 v32, 3, v1
 v_lshl_add_u32 v41, v32, 3, v41
 v_bfe_u32 v38, v1, 2, 1
 v_bfe_u32 v32, v1, 3, 1
 v_lshl_add_u32 v38, v32, 2, v38
 v_bfe_u32 v32, v1, 4, 1
 v_lshl_add_u32 v38, v32, 4, v38
 v_bfe_u32 v32, v1, 5, 1
 v_lshl_add_u32 v38, v32, 3, v38
 v_lshlrev_b32 v38, 6, v38
 v_and_b32 v32, 3, v1
 v_lshl_add_u32 v38, v32, 3, v38
 s_lshl_b32 s56, s26, 13
 v_add_u32 v41, s56, v41
 s_and_b32 s56, s26, 1
 s_lshl_b32 s56, s56, 5
 v_add_u32 v38, s56, v38
 s_add_u32 m0, s46, 32768
 s_add_u32 s55, s42, 1048576
 buffer_load_dwordx4 v39, s[8:11], s55 offen  lds
 s_add_u32 m0, s46, 33792
 s_add_u32 s55, s42, 1179648
 buffer_load_dwordx4 v39, s[8:11], s55 offen  lds
 s_add_u32 m0, s47, 34816
 s_add_u32 s55, s43, 1310720
 buffer_load_dwordx4 v39, s[8:11], s55 offen  lds
 s_add_u32 m0, s47, 35840
 s_add_u32 s55, s43, 1441792
 buffer_load_dwordx4 v39, s[8:11], s55 offen  lds
 s_add_u32 m0, s46, 36864
 s_add_u32 s55, s42, 1572864
 buffer_load_dwordx4 v39, s[8:11], s55 offen  lds
 s_add_u32 m0, s46, 37888
 s_add_u32 s55, s42, 1703936
 buffer_load_dwordx4 v39, s[8:11], s55 offen  lds
 s_add_u32 m0, s47, 38912
 s_add_u32 s55, s43, 1835008
 buffer_load_dwordx4 v39, s[8:11], s55 offen  lds
 s_add_u32 m0, s47, 39936
 s_add_u32 s55, s43, 1966080
 buffer_load_dwordx4 v39, s[8:11], s55 offen  lds
 v_and_b32 v67, 15, v64
 v_lshrrev_b32 v68, 4, v64
 v_cvt_f32_u32 v200, v67
 v_mul_f32 v206, 0x41800000, v200
 v_lshl_add_u32 v65, v67, 1, 0
 v_add_u32 v65, 256, v65
 v_and_b32 v66, 3, v67
 v_lshlrev_b32 v66, 2, v66
 v_lshrrev_b32 v69, 2, v67
 v_lshl_add_u32 v66, v69, 8, v66
 v_cmp_gt_u32 vcc, 8, v67
 s_nop 1
 v_cndmask_b32 v65, v66, v65, vcc
 v_cvt_f32_u32 v202, v65
 v_and_b32 v65, 1, v67
 v_lshlrev_b32 v65, 3, v65
 v_lshrrev_b32 v66, 1, v67
 v_min_u32 v66, 4, v66
 v_lshl_add_u32 v65, v66, 8, v65
 v_add_u32 v65, 1024, v65
 v_cvt_f32_u32 v204, v65
 s_waitcnt vmcnt(30)
 v_lshlrev_b32 v95, 16, v94
 v_mul_f32 v95, 0x3fb8aa3b, v95
 v_exp_f32 v95, v95
 s_nop 0
 v_cvt_pk_bf16_f32 v95, v95, v95
 v_and_b32 v95, s98, v95
 v_lshl_add_u32 v65, v64, 5, s94
 v_lshlrev_b32 v96, 16, v88
 v_lshlrev_b32 v97, 16, v89
 v_lshlrev_b32 v98, 16, v90
 v_lshlrev_b32 v99, 16, v91
 v_lshlrev_b32 v100, 16, v92
 v_lshlrev_b32 v101, 16, v93
 v_mul_f32 v96, v95, v96
 v_mul_f32 v97, v95, v97
 v_mul_f32 v98, v95, v98
 v_mul_f32 v99, v95, v99
 v_mul_f32 v104, 0x3fb8aa3b, v96
 v_mul_f32 v105, 0x3e22f983, v97
 v_mul_f32 v106, v100, v98
 v_fma_f32 v106, -v101, v99, v106
 v_mul_f32 v107, v100, v99
 v_fma_f32 v107, v101, v98, v107
 ds_write_b128 v65, v[104:107] offset:4160
 v_and_b32 v96, s98, v88
 v_and_b32 v97, s98, v89
 v_and_b32 v98, s98, v90
 v_and_b32 v99, s98, v91
 v_and_b32 v100, s98, v92
 v_and_b32 v101, s98, v93
 v_mul_f32 v96, v95, v96
 v_mul_f32 v97, v95, v97
 v_mul_f32 v98, v95, v98
 v_mul_f32 v99, v95, v99
 v_mul_f32 v108, 0x3fb8aa3b, v96
 v_mul_f32 v109, 0x3e22f983, v97
 v_mul_f32 v110, v100, v98
 v_fma_f32 v110, -v101, v99, v110
 v_mul_f32 v111, v100, v99
 v_fma_f32 v111, v101, v98, v111
 ds_write_b128 v65, v[108:111] offset:4176
 v_mov_b32 v120, 0
 v_mov_b32 v121, 0
 v_mov_b32 v122, 0
 v_mov_b32 v123, 0
 v_mov_b32 v124, 0
 v_mov_b32 v125, 0
 v_mov_b32 v126, 0
 v_mov_b32 v127, 0
 v_mov_b32 v128, 0
 v_mov_b32 v129, 0
 v_mov_b32 v130, 0
 v_mov_b32 v131, 0
 v_lshl_add_u32 v69, v68, 6, s94
 s_mov_b32 s95, 0
 s_waitcnt lgkmcnt(0)
L_cfb_kg0:
 ds_read_b128 v[88:91], v69 offset:4160
 ds_read_b128 v[92:95], v69 offset:4176
 ds_read_b128 v[96:99], v69 offset:4192
 ds_read_b128 v[100:103], v69 offset:4208
 v_add_u32 v69, 256, v69
 s_waitcnt lgkmcnt(3)
 v_pk_mul_f32 v[132:133], v[88:89], v[200:201] op_sel_hi:[1,0]
 v_pk_mul_f32 v[136:137], v[88:89], v[202:203] op_sel_hi:[1,0]
 v_pk_mul_f32 v[140:141], v[88:89], v[204:205] op_sel_hi:[1,0]
 v_pk_mul_f32 v[144:145], v[88:89], v[206:207] op_sel_hi:[1,0]
 v_fract_f32 v133, v133
 v_fract_f32 v137, v137
 v_fract_f32 v141, v141
 v_fract_f32 v145, v145
 v_exp_f32 v132, v132
 v_cos_f32 v134, v133
 v_sin_f32 v135, v133
 v_exp_f32 v136, v136
 v_cos_f32 v138, v137
 v_sin_f32 v139, v137
 v_exp_f32 v140, v140
 v_cos_f32 v142, v141
 v_sin_f32 v143, v141
 v_exp_f32 v144, v144
 v_cos_f32 v146, v145
 v_sin_f32 v147, v145
 v_pk_mul_f32 v[134:135], v[134:135], v[132:133] op_sel_hi:[1,0]
 v_pk_mul_f32 v[138:139], v[138:139], v[136:137] op_sel_hi:[1,0]
 v_pk_mul_f32 v[142:143], v[142:143], v[140:141] op_sel_hi:[1,0]
 v_pk_mul_f32 v[146:147], v[146:147], v[144:145] op_sel_hi:[1,0]
 v_pk_mul_f32 v[144:145], v[146:147], v[90:91] op_sel_hi:[0,1] neg_hi:[0,1]
 v_cvt_pk_bf16_f32 v104, v134, v135
 v_cvt_pk_bf16_f32 v108, v138, v139
 v_cvt_pk_bf16_f32 v112, v142, v143
 v_pk_fma_f32 v[144:145], v[146:147], v[90:91], v[144:145] op_sel:[1,1,0] op_sel_hi:[1,0,1] neg_lo:[0,1,0] neg_hi:[0,1,0]
 v_cvt_pk_bf16_f32 v116, v144, v145
 s_waitcnt lgkmcnt(2)
 v_pk_mul_f32 v[132:133], v[92:93], v[200:201] op_sel_hi:[1,0]
 v_pk_mul_f32 v[136:137], v[92:93], v[202:203] op_sel_hi:[1,0]
 v_pk_mul_f32 v[140:141], v[92:93], v[204:205] op_sel_hi:[1,0]
 v_pk_mul_f32 v[144:145], v[92:93], v[206:207] op_sel_hi:[1,0]
 v_fract_f32 v133, v133
 v_fract_f32 v137, v137
 v_fract_f32 v141, v141
 v_fract_f32 v145, v145
 v_exp_f32 v132, v132
 v_cos_f32 v134, v133
 v_sin_f32 v135, v133
 v_exp_f32 v136, v136
 v_cos_f32 v138, v137
 v_sin_f32 v139, v137
 v_exp_f32 v140, v140
 v_cos_f32 v142, v141
 v_sin_f32 v143, v141
 v_exp_f32 v144, v144
 v_cos_f32 v146, v145
 v_sin_f32 v147, v145
 v_pk_mul_f32 v[134:135], v[134:135], v[132:133] op_sel_hi:[1,0]
 v_pk_mul_f32 v[138:139], v[138:139], v[136:137] op_sel_hi:[1,0]
 v_pk_mul_f32 v[142:143], v[142:143], v[140:141] op_sel_hi:[1,0]
 v_pk_mul_f32 v[146:147], v[146:147], v[144:145] op_sel_hi:[1,0]
 v_pk_mul_f32 v[144:145], v[146:147], v[94:95] op_sel_hi:[0,1] neg_hi:[0,1]
 v_cvt_pk_bf16_f32 v105, v134, v135
 v_cvt_pk_bf16_f32 v109, v138, v139
 v_cvt_pk_bf16_f32 v113, v142, v143
 v_pk_fma_f32 v[144:145], v[146:147], v[94:95], v[144:145] op_sel:[1,1,0] op_sel_hi:[1,0,1] neg_lo:[0,1,0] neg_hi:[0,1,0]
 v_cvt_pk_bf16_f32 v117, v144, v145
 s_waitcnt lgkmcnt(1)
 v_pk_mul_f32 v[132:133], v[96:97], v[200:201] op_sel_hi:[1,0]
 v_pk_mul_f32 v[136:137], v[96:97], v[202:203] op_sel_hi:[1,0]
 v_pk_mul_f32 v[140:141], v[96:97], v[204:205] op_sel_hi:[1,0]
 v_pk_mul_f32 v[144:145], v[96:97], v[206:207] op_sel_hi:[1,0]
 v_fract_f32 v133, v133
 v_fract_f32 v137, v137
 v_fract_f32 v141, v141
 v_fract_f32 v145, v145
 v_exp_f32 v132, v132
 v_cos_f32 v134, v133
 v_sin_f32 v135, v133
 v_exp_f32 v136, v136
 v_cos_f32 v138, v137
 v_sin_f32 v139, v137
 v_exp_f32 v140, v140
 v_cos_f32 v142, v141
 v_sin_f32 v143, v141
 v_exp_f32 v144, v144
 v_cos_f32 v146, v145
 v_sin_f32 v147, v145
 v_pk_mul_f32 v[134:135], v[134:135], v[132:133] op_sel_hi:[1,0]
 v_pk_mul_f32 v[138:139], v[138:139], v[136:137] op_sel_hi:[1,0]
 v_pk_mul_f32 v[142:143], v[142:143], v[140:141] op_sel_hi:[1,0]
 v_pk_mul_f32 v[146:147], v[146:147], v[144:145] op_sel_hi:[1,0]
 v_pk_mul_f32 v[144:145], v[146:147], v[98:99] op_sel_hi:[0,1] neg_hi:[0,1]
 v_cvt_pk_bf16_f32 v106, v134, v135
 v_cvt_pk_bf16_f32 v110, v138, v139
 v_cvt_pk_bf16_f32 v114, v142, v143
 v_pk_fma_f32 v[144:145], v[146:147], v[98:99], v[144:145] op_sel:[1,1,0] op_sel_hi:[1,0,1] neg_lo:[0,1,0] neg_hi:[0,1,0]
 v_cvt_pk_bf16_f32 v118, v144, v145
 s_waitcnt lgkmcnt(0)
 v_pk_mul_f32 v[132:133], v[100:101], v[200:201] op_sel_hi:[1,0]
 v_pk_mul_f32 v[136:137], v[100:101], v[202:203] op_sel_hi:[1,0]
 v_pk_mul_f32 v[140:141], v[100:101], v[204:205] op_sel_hi:[1,0]
 v_pk_mul_f32 v[144:145], v[100:101], v[206:207] op_sel_hi:[1,0]
 v_fract_f32 v133, v133
 v_fract_f32 v137, v137
 v_fract_f32 v141, v141
 v_fract_f32 v145, v145
 v_exp_f32 v132, v132
 v_cos_f32 v134, v133
 v_sin_f32 v135, v133
 v_exp_f32 v136, v136
 v_cos_f32 v138, v137
 v_sin_f32 v139, v137
 v_exp_f32 v140, v140
 v_cos_f32 v142, v141
 v_sin_f32 v143, v141
 v_exp_f32 v144, v144
 v_cos_f32 v146, v145
 v_sin_f32 v147, v145
 v_pk_mul_f32 v[134:135], v[134:135], v[132:133] op_sel_hi:[1,0]
 v_pk_mul_f32 v[138:139], v[138:139], v[136:137] op_sel_hi:[1,0]
 v_pk_mul_f32 v[142:143], v[142:143], v[140:141] op_sel_hi:[1,0]
 v_pk_mul_f32 v[146:147], v[146:147], v[144:145] op_sel_hi:[1,0]
 v_pk_mul_f32 v[144:145], v[146:147], v[102:103] op_sel_hi:[0,1] neg_hi:[0,1]
 v_cvt_pk_bf16_f32 v107, v134, v135
 v_cvt_pk_bf16_f32 v111, v138, v139
 v_cvt_pk_bf16_f32 v115, v142, v143
 v_pk_fma_f32 v[144:145], v[146:147], v[102:103], v[144:145] op_sel:[1,1,0] op_sel_hi:[1,0,1] neg_lo:[0,1,0] neg_hi:[0,1,0]
 v_cvt_pk_bf16_f32 v119, v144, v145
 s_add_u32 s95, s95, 1
 s_cmp_lt_u32 s95, 2
 v_mfma_f32_16x16x32_bf16 v[120:123], v[104:107], v[116:119], v[120:123]
 v_mfma_f32_16x16x32_bf16 v[124:127], v[108:111], v[116:119], v[124:127]
 v_mfma_f32_16x16x32_bf16 v[128:131], v[112:115], v[116:119], v[128:131]
 s_cbranch_scc1 L_cfb_kg0
 s_waitcnt vmcnt(21)
 ds_read_b64_tr_b16 a[0:1], v41 offset:0
 ds_read_b64_tr_b16 a[2:3], v41 offset:128
 ds_read_b64_tr_b16 a[4:5], v41 offset:2048
 ds_read_b64_tr_b16 a[6:7], v41 offset:2176
 ds_read_b64_tr_b16 a[8:9], v41 offset:32
 ds_read_b64_tr_b16 a[10:11], v41 offset:160
 ds_read_b64_tr_b16 a[12:13], v41 offset:2080
 ds_read_b64_tr_b16 a[14:15], v41 offset:2208
 s_waitcnt lgkmcnt(0)
 ds_read_b64_tr_b16 a[48:49], v41 offset:4096
 ds_read_b64_tr_b16 a[50:51], v41 offset:4224
 ds_read_b64_tr_b16 a[52:53], v41 offset:6144
 ds_read_b64_tr_b16 a[54:55], v41 offset:6272
 ds_read_b64_tr_b16 a[56:57], v41 offset:4128
 ds_read_b64_tr_b16 a[58:59], v41 offset:4256
 ds_read_b64_tr_b16 a[60:61], v41 offset:6176
 ds_read_b64_tr_b16 a[62:63], v41 offset:6304
 s_waitcnt lgkmcnt(0)
 s_mov_b64 s[8:9], s[18:19]
 s_add_u32 m0, s46, 0
 s_add_u32 s55, s42, 0
 buffer_load_dwordx4 v39, s[8:11], s55 offen  lds
 s_add_u32 m0, s46, 1024
 s_add_u32 s55, s42, 131072
 buffer_load_dwordx4 v39, s[8:11], s55 offen  lds
 s_add_u32 m0, s47, 2048
 s_add_u32 s55, s43, 262144
 buffer_load_dwordx4 v39, s[8:11], s55 offen  lds
 s_add_u32 m0, s47, 3072
 s_add_u32 s55, s43, 393216
 buffer_load_dwordx4 v39, s[8:11], s55 offen  lds
 s_add_u32 m0, s46, 4096
 s_add_u32 s55, s42, 524288
 buffer_load_dwordx4 v39, s[8:11], s55 offen  lds
 s_add_u32 m0, s46, 5120
 s_add_u32 s55, s42, 655360
 buffer_load_dwordx4 v39, s[8:11], s55 offen  lds
 s_add_u32 m0, s47, 6144
 s_add_u32 s55, s43, 786432
 buffer_load_dwordx4 v39, s[8:11], s55 offen  lds
 s_add_u32 m0, s47, 7168
 s_add_u32 s55, s43, 917504
 buffer_load_dwordx4 v39, s[8:11], s55 offen  lds
 s_waitcnt vmcnt(16)
 s_cmp_eq_u32 s26, 0
 s_cselect_b32 s55, s49, 1073741824
 v_min_u32 v232, -2, v232
 v_min_u32 v233, -2, v233
 v_min_u32 v234, -2, v234
 v_min_u32 v235, -2, v235
 buffer_store_dwordx4 v[232:235], v21, s[4:7], s55 offen
L_cfb_kg1:
 ds_read_b128 v[88:91], v69 offset:4160
 ds_read_b128 v[92:95], v69 offset:4176
 ds_read_b128 v[96:99], v69 offset:4192
 ds_read_b128 v[100:103], v69 offset:4208
 v_add_u32 v69, 256, v69
 s_waitcnt lgkmcnt(3)
 v_pk_mul_f32 v[132:133], v[88:89], v[200:201] op_sel_hi:[1,0]
 v_pk_mul_f32 v[136:137], v[88:89], v[202:203] op_sel_hi:[1,0]
 v_pk_mul_f32 v[140:141], v[88:89], v[204:205] op_sel_hi:[1,0]
 v_pk_mul_f32 v[144:145], v[88:89], v[206:207] op_sel_hi:[1,0]
 v_fract_f32 v133, v133
 v_fract_f32 v137, v137
 v_fract_f32 v141, v141
 v_fract_f32 v145, v145
 v_exp_f32 v132, v132
 v_cos_f32 v134, v133
 v_sin_f32 v135, v133
 v_exp_f32 v136, v136
 v_cos_f32 v138, v137
 v_sin_f32 v139, v137
 v_exp_f32 v140, v140
 v_cos_f32 v142, v141
 v_sin_f32 v143, v141
 v_exp_f32 v144, v144
 v_cos_f32 v146, v145
 v_sin_f32 v147, v145
 v_pk_mul_f32 v[134:135], v[134:135], v[132:133] op_sel_hi:[1,0]
 v_pk_mul_f32 v[138:139], v[138:139], v[136:137] op_sel_hi:[1,0]
 v_pk_mul_f32 v[142:143], v[142:143], v[140:141] op_sel_hi:[1,0]
 v_pk_mul_f32 v[146:147], v[146:147], v[144:145] op_sel_hi:[1,0]
 v_pk_mul_f32 v[144:145], v[146:147], v[90:91] op_sel_hi:[0,1] neg_hi:[0,1]
 v_cvt_pk_bf16_f32 v104, v134, v135
 v_cvt_pk_bf16_f32 v108, v138, v139
 v_cvt_pk_bf16_f32 v112, v142, v143
 v_pk_fma_f32 v[144:145], v[146:147], v[90:91], v[144:145] op_sel:[1,1,0] op_sel_hi:[1,0,1] neg_lo:[0,1,0] neg_hi:[0,1,0]
 v_cvt_pk_bf16_f32 v116, v144, v145
 s_waitcnt lgkmcnt(2)
 v_pk_mul_f32 v[132:133], v[92:93], v[200:201] op_sel_hi:[1,0]
 v_pk_mul_f32 v[136:137], v[92:93], v[202:203] op_sel_hi:[1,0]
 v_pk_mul_f32 v[140:141], v[92:93], v[204:205] op_sel_hi:[1,0]
 v_pk_mul_f32 v[144:145], v[92:93], v[206:207] op_sel_hi:[1,0]
 v_fract_f32 v133, v133
 v_fract_f32 v137, v137
 v_fract_f32 v141, v141
 v_fract_f32 v145, v145
 v_exp_f32 v132, v132
 v_cos_f32 v134, v133
 v_sin_f32 v135, v133
 v_exp_f32 v136, v136
 v_cos_f32 v138, v137
 v_sin_f32 v139, v137
 v_exp_f32 v140, v140
 v_cos_f32 v142, v141
 v_sin_f32 v143, v141
 v_exp_f32 v144, v144
 v_cos_f32 v146, v145
 v_sin_f32 v147, v145
 v_pk_mul_f32 v[134:135], v[134:135], v[132:133] op_sel_hi:[1,0]
 v_pk_mul_f32 v[138:139], v[138:139], v[136:137] op_sel_hi:[1,0]
 v_pk_mul_f32 v[142:143], v[142:143], v[140:141] op_sel_hi:[1,0]
 v_pk_mul_f32 v[146:147], v[146:147], v[144:145] op_sel_hi:[1,0]
 v_pk_mul_f32 v[144:145], v[146:147], v[94:95] op_sel_hi:[0,1] neg_hi:[0,1]
 v_cvt_pk_bf16_f32 v105, v134, v135
 v_cvt_pk_bf16_f32 v109, v138, v139
 v_cvt_pk_bf16_f32 v113, v142, v143
 v_pk_fma_f32 v[144:145], v[146:147], v[94:95], v[144:145] op_sel:[1,1,0] op_sel_hi:[1,0,1] neg_lo:[0,1,0] neg_hi:[0,1,0]
 v_cvt_pk_bf16_f32 v117, v144, v145
 s_waitcnt lgkmcnt(1)
 v_pk_mul_f32 v[132:133], v[96:97], v[200:201] op_sel_hi:[1,0]
 v_pk_mul_f32 v[136:137], v[96:97], v[202:203] op_sel_hi:[1,0]
 v_pk_mul_f32 v[140:141], v[96:97], v[204:205] op_sel_hi:[1,0]
 v_pk_mul_f32 v[144:145], v[96:97], v[206:207] op_sel_hi:[1,0]
 v_fract_f32 v133, v133
 v_fract_f32 v137, v137
 v_fract_f32 v141, v141
 v_fract_f32 v145, v145
 v_exp_f32 v132, v132
 v_cos_f32 v134, v133
 v_sin_f32 v135, v133
 v_exp_f32 v136, v136
 v_cos_f32 v138, v137
 v_sin_f32 v139, v137
 v_exp_f32 v140, v140
 v_cos_f32 v142, v141
 v_sin_f32 v143, v141
 v_exp_f32 v144, v144
 v_cos_f32 v146, v145
 v_sin_f32 v147, v145
 v_pk_mul_f32 v[134:135], v[134:135], v[132:133] op_sel_hi:[1,0]
 v_pk_mul_f32 v[138:139], v[138:139], v[136:137] op_sel_hi:[1,0]
 v_pk_mul_f32 v[142:143], v[142:143], v[140:141] op_sel_hi:[1,0]
 v_pk_mul_f32 v[146:147], v[146:147], v[144:145] op_sel_hi:[1,0]
 v_pk_mul_f32 v[144:145], v[146:147], v[98:99] op_sel_hi:[0,1] neg_hi:[0,1]
 v_cvt_pk_bf16_f32 v106, v134, v135
 v_cvt_pk_bf16_f32 v110, v138, v139
 v_cvt_pk_bf16_f32 v114, v142, v143
 v_pk_fma_f32 v[144:145], v[146:147], v[98:99], v[144:145] op_sel:[1,1,0] op_sel_hi:[1,0,1] neg_lo:[0,1,0] neg_hi:[0,1,0]
 v_cvt_pk_bf16_f32 v118, v144, v145
 s_waitcnt lgkmcnt(0)
 v_pk_mul_f32 v[132:133], v[100:101], v[200:201] op_sel_hi:[1,0]
 v_pk_mul_f32 v[136:137], v[100:101], v[202:203] op_sel_hi:[1,0]
 v_pk_mul_f32 v[140:141], v[100:101], v[204:205] op_sel_hi:[1,0]
 v_pk_mul_f32 v[144:145], v[100:101], v[206:207] op_sel_hi:[1,0]
 v_fract_f32 v133, v133
 v_fract_f32 v137, v137
 v_fract_f32 v141, v141
 v_fract_f32 v145, v145
 v_exp_f32 v132, v132
 v_cos_f32 v134, v133
 v_sin_f32 v135, v133
 v_exp_f32 v136, v136
 v_cos_f32 v138, v137
 v_sin_f32 v139, v137
 v_exp_f32 v140, v140
 v_cos_f32 v142, v141
 v_sin_f32 v143, v141
 v_exp_f32 v144, v144
 v_cos_f32 v146, v145
 v_sin_f32 v147, v145
 v_pk_mul_f32 v[134:135], v[134:135], v[132:133] op_sel_hi:[1,0]
 v_pk_mul_f32 v[138:139], v[138:139], v[136:137] op_sel_hi:[1,0]
 v_pk_mul_f32 v[142:143], v[142:143], v[140:141] op_sel_hi:[1,0]
 v_pk_mul_f32 v[146:147], v[146:147], v[144:145] op_sel_hi:[1,0]
 v_pk_mul_f32 v[144:145], v[146:147], v[102:103] op_sel_hi:[0,1] neg_hi:[0,1]
 v_cvt_pk_bf16_f32 v107, v134, v135
 v_cvt_pk_bf16_f32 v111, v138, v139
 v_cvt_pk_bf16_f32 v115, v142, v143
 v_pk_fma_f32 v[144:145], v[146:147], v[102:103], v[144:145] op_sel:[1,1,0] op_sel_hi:[1,0,1] neg_lo:[0,1,0] neg_hi:[0,1,0]
 v_cvt_pk_bf16_f32 v119, v144, v145
 s_add_u32 s95, s95, 1
 s_cmp_lt_u32 s95, 5
 v_mfma_f32_16x16x32_bf16 v[120:123], v[104:107], v[116:119], v[120:123]
 v_mfma_f32_16x16x32_bf16 v[124:127], v[108:111], v[116:119], v[124:127]
 v_mfma_f32_16x16x32_bf16 v[128:131], v[112:115], v[116:119], v[128:131]
 s_cbranch_scc1 L_cfb_kg1
 s_waitcnt vmcnt(9)
 ds_read_b64_tr_b16 a[96:97], v41 offset:32768
 ds_read_b64_tr_b16 a[98:99], v41 offset:32896
 ds_read_b64_tr_b16 a[100:101], v41 offset:34816
 ds_read_b64_tr_b16 a[102:103], v41 offset:34944
 ds_read_b64_tr_b16 a[104:105], v41 offset:32800
 ds_read_b64_tr_b16 a[106:107], v41 offset:32928
 ds_read_b64_tr_b16 a[108:109], v41 offset:34848
 ds_read_b64_tr_b16 a[110:111], v41 offset:34976
 s_waitcnt lgkmcnt(0)
 ds_read_b64_tr_b16 a[144:145], v41 offset:36864
 ds_read_b64_tr_b16 a[146:147], v41 offset:36992
 ds_read_b64_tr_b16 a[148:149], v41 offset:38912
 ds_read_b64_tr_b16 a[150:151], v41 offset:39040
 ds_read_b64_tr_b16 a[152:153], v41 offset:36896
 ds_read_b64_tr_b16 a[154:155], v41 offset:37024
 ds_read_b64_tr_b16 a[156:157], v41 offset:38944
 ds_read_b64_tr_b16 a[158:159], v41 offset:39072
 s_waitcnt lgkmcnt(0)
 s_add_u32 m0, s46, 32768
 s_add_u32 s55, s42, 1048576
 buffer_load_dwordx4 v39, s[8:11], s55 offen  lds
 s_add_u32 m0, s46, 33792
 s_add_u32 s55, s42, 1179648
 buffer_load_dwordx4 v39, s[8:11], s55 offen  lds
 s_add_u32 m0, s47, 34816
 s_add_u32 s55, s43, 1310720
 buffer_load_dwordx4 v39, s[8:11], s55 offen  lds
 s_add_u32 m0, s47, 35840
 s_add_u32 s55, s43, 1441792
 buffer_load_dwordx4 v39, s[8:11], s55 offen  lds
 s_add_u32 m0, s46, 36864
 s_add_u32 s55, s42, 1572864
 buffer_load_dwordx4 v39, s[8:11], s55 offen  lds
 s_add_u32 m0, s46, 37888
 s_add_u32 s55, s42, 1703936
 buffer_load_dwordx4 v39, s[8:11], s55 offen  lds
 s_add_u32 m0, s47, 38912
 s_add_u32 s55, s43, 1835008
 buffer_load_dwordx4 v39, s[8:11], s55 offen  lds
 s_add_u32 m0, s47, 39936
 s_add_u32 s55, s43, 1966080
 buffer_load_dwordx4 v39, s[8:11], s55 offen  lds
 s_barrier
 v_mov_b32 v216, s34
 v_mov_b32 v217, s35
 v_bfrev_b32 v218, 1
 v_cmp_eq_u32 vcc, 64, v0
 s_nop 1
 v_cndmask_b32 v218, v218, 0, vcc
 buffer_atomic_add_x2 v[216:217], v218, s[12:15], s30 offen sc1
L_cfb_kg2:
 ds_read_b128 v[88:91], v69 offset:4160
 ds_read_b128 v[92:95], v69 offset:4176
 ds_read_b128 v[96:99], v69 offset:4192
 ds_read_b128 v[100:103], v69 offset:4208
 v_add_u32 v69, 256, v69
 s_waitcnt lgkmcnt(3)
 v_pk_mul_f32 v[132:133], v[88:89], v[200:201] op_sel_hi:[1,0]
 v_pk_mul_f32 v[136:137], v[88:89], v[202:203] op_sel_hi:[1,0]
 v_pk_mul_f32 v[140:141], v[88:89], v[204:205] op_sel_hi:[1,0]
 v_pk_mul_f32 v[144:145], v[88:89], v[206:207] op_sel_hi:[1,0]
 v_fract_f32 v133, v133
 v_fract_f32 v137, v137
 v_fract_f32 v141, v141
 v_fract_f32 v145, v145
 v_exp_f32 v132, v132
 v_cos_f32 v134, v133
 v_sin_f32 v135, v133
 v_exp_f32 v136, v136
 v_cos_f32 v138, v137
 v_sin_f32 v139, v137
 v_exp_f32 v140, v140
 v_cos_f32 v142, v141
 v_sin_f32 v143, v141
 v_exp_f32 v144, v144
 v_cos_f32 v146, v145
 v_sin_f32 v147, v145
 v_pk_mul_f32 v[134:135], v[134:135], v[132:133] op_sel_hi:[1,0]
 v_pk_mul_f32 v[138:139], v[138:139], v[136:137] op_sel_hi:[1,0]
 v_pk_mul_f32 v[142:143], v[142:143], v[140:141] op_sel_hi:[1,0]
 v_pk_mul_f32 v[146:147], v[146:147], v[144:145] op_sel_hi:[1,0]
 v_pk_mul_f32 v[144:145], v[146:147], v[90:91] op_sel_hi:[0,1] neg_hi:[0,1]
 v_cvt_pk_bf16_f32 v104, v134, v135
 v_cvt_pk_bf16_f32 v108, v138, v139
 v_cvt_pk_bf16_f32 v112, v142, v143
 v_pk_fma_f32 v[144:145], v[146:147], v[90:91], v[144:145] op_sel:[1,1,0] op_sel_hi:[1,0,1] neg_lo:[0,1,0] neg_hi:[0,1,0]
 v_cvt_pk_bf16_f32 v116, v144, v145
 s_waitcnt lgkmcnt(2)
 v_pk_mul_f32 v[132:133], v[92:93], v[200:201] op_sel_hi:[1,0]
 v_pk_mul_f32 v[136:137], v[92:93], v[202:203] op_sel_hi:[1,0]
 v_pk_mul_f32 v[140:141], v[92:93], v[204:205] op_sel_hi:[1,0]
 v_pk_mul_f32 v[144:145], v[92:93], v[206:207] op_sel_hi:[1,0]
 v_fract_f32 v133, v133
 v_fract_f32 v137, v137
 v_fract_f32 v141, v141
 v_fract_f32 v145, v145
 v_exp_f32 v132, v132
 v_cos_f32 v134, v133
 v_sin_f32 v135, v133
 v_exp_f32 v136, v136
 v_cos_f32 v138, v137
 v_sin_f32 v139, v137
 v_exp_f32 v140, v140
 v_cos_f32 v142, v141
 v_sin_f32 v143, v141
 v_exp_f32 v144, v144
 v_cos_f32 v146, v145
 v_sin_f32 v147, v145
 v_pk_mul_f32 v[134:135], v[134:135], v[132:133] op_sel_hi:[1,0]
 v_pk_mul_f32 v[138:139], v[138:139], v[136:137] op_sel_hi:[1,0]
 v_pk_mul_f32 v[142:143], v[142:143], v[140:141] op_sel_hi:[1,0]
 v_pk_mul_f32 v[146:147], v[146:147], v[144:145] op_sel_hi:[1,0]
 v_pk_mul_f32 v[144:145], v[146:147], v[94:95] op_sel_hi:[0,1] neg_hi:[0,1]
 v_cvt_pk_bf16_f32 v105, v134, v135
 v_cvt_pk_bf16_f32 v109, v138, v139
 v_cvt_pk_bf16_f32 v113, v142, v143
 v_pk_fma_f32 v[144:145], v[146:147], v[94:95], v[144:145] op_sel:[1,1,0] op_sel_hi:[1,0,1] neg_lo:[0,1,0] neg_hi:[0,1,0]
 v_cvt_pk_bf16_f32 v117, v144, v145
 s_waitcnt lgkmcnt(1)
 v_pk_mul_f32 v[132:133], v[96:97], v[200:201] op_sel_hi:[1,0]
 v_pk_mul_f32 v[136:137], v[96:97], v[202:203] op_sel_hi:[1,0]
 v_pk_mul_f32 v[140:141], v[96:97], v[204:205] op_sel_hi:[1,0]
 v_pk_mul_f32 v[144:145], v[96:97], v[206:207] op_sel_hi:[1,0]
 v_fract_f32 v133, v133
 v_fract_f32 v137, v137
 v_fract_f32 v141, v141
 v_fract_f32 v145, v145
 v_exp_f32 v132, v132
 v_cos_f32 v134, v133
 v_sin_f32 v135, v133
 v_exp_f32 v136, v136
 v_cos_f32 v138, v137
 v_sin_f32 v139, v137
 v_exp_f32 v140, v140
 v_cos_f32 v142, v141
 v_sin_f32 v143, v141
 v_exp_f32 v144, v144
 v_cos_f32 v146, v145
 v_sin_f32 v147, v145
 v_pk_mul_f32 v[134:135], v[134:135], v[132:133] op_sel_hi:[1,0]
 v_pk_mul_f32 v[138:139], v[138:139], v[136:137] op_sel_hi:[1,0]
 v_pk_mul_f32 v[142:143], v[142:143], v[140:141] op_sel_hi:[1,0]
 v_pk_mul_f32 v[146:147], v[146:147], v[144:145] op_sel_hi:[1,0]
 v_pk_mul_f32 v[144:145], v[146:147], v[98:99] op_sel_hi:[0,1] neg_hi:[0,1]
 v_cvt_pk_bf16_f32 v106, v134, v135
 v_cvt_pk_bf16_f32 v110, v138, v139
 v_cvt_pk_bf16_f32 v114, v142, v143
 v_pk_fma_f32 v[144:145], v[146:147], v[98:99], v[144:145] op_sel:[1,1,0] op_sel_hi:[1,0,1] neg_lo:[0,1,0] neg_hi:[0,1,0]
 v_cvt_pk_bf16_f32 v118, v144, v145
 s_waitcnt lgkmcnt(0)
 v_pk_mul_f32 v[132:133], v[100:101], v[200:201] op_sel_hi:[1,0]
 v_pk_mul_f32 v[136:137], v[100:101], v[202:203] op_sel_hi:[1,0]
 v_pk_mul_f32 v[140:141], v[100:101], v[204:205] op_sel_hi:[1,0]
 v_pk_mul_f32 v[144:145], v[100:101], v[206:207] op_sel_hi:[1,0]
 v_fract_f32 v133, v133
 v_fract_f32 v137, v137
 v_fract_f32 v141, v141
 v_fract_f32 v145, v145
 v_exp_f32 v132, v132
 v_cos_f32 v134, v133
 v_sin_f32 v135, v133
 v_exp_f32 v136, v136
 v_cos_f32 v138, v137
 v_sin_f32 v139, v137
 v_exp_f32 v140, v140
 v_cos_f32 v142, v141
 v_sin_f32 v143, v141
 v_exp_f32 v144, v144
 v_cos_f32 v146, v145
 v_sin_f32 v147, v145
 v_pk_mul_f32 v[134:135], v[134:135], v[132:133] op_sel_hi:[1,0]
 v_pk_mul_f32 v[138:139], v[138:139], v[136:137] op_sel_hi:[1,0]
 v_pk_mul_f32 v[142:143], v[142:143], v[140:141] op_sel_hi:[1,0]
 v_pk_mul_f32 v[146:147], v[146:147], v[144:145] op_sel_hi:[1,0]
 v_pk_mul_f32 v[144:145], v[146:147], v[102:103] op_sel_hi:[0,1] neg_hi:[0,1]
 v_cvt_pk_bf16_f32 v107, v134, v135
 v_cvt_pk_bf16_f32 v111, v138, v139
 v_cvt_pk_bf16_f32 v115, v142, v143
 v_pk_fma_f32 v[144:145], v[146:147], v[102:103], v[144:145] op_sel:[1,1,0] op_sel_hi:[1,0,1] neg_lo:[0,1,0] neg_hi:[0,1,0]
 v_cvt_pk_bf16_f32 v119, v144, v145
 s_add_u32 s95, s95, 1
 s_cmp_lt_u32 s95, 8
 v_mfma_f32_16x16x32_bf16 v[120:123], v[104:107], v[116:119], v[120:123]
 v_mfma_f32_16x16x32_bf16 v[124:127], v[108:111], v[116:119], v[124:127]
 v_mfma_f32_16x16x32_bf16 v[128:131], v[112:115], v[116:119], v[128:131]
 s_cbranch_scc1 L_cfb_kg2
 s_waitcnt vmcnt(10)
 ds_read_b64_tr_b16 a[16:17], v41 offset:0
 ds_read_b64_tr_b16 a[18:19], v41 offset:128
 ds_read_b64_tr_b16 a[20:21], v41 offset:2048
 ds_read_b64_tr_b16 a[22:23], v41 offset:2176
 ds_read_b64_tr_b16 a[24:25], v41 offset:32
 ds_read_b64_tr_b16 a[26:27], v41 offset:160
 ds_read_b64_tr_b16 a[28:29], v41 offset:2080
 ds_read_b64_tr_b16 a[30:31], v41 offset:2208
 s_waitcnt lgkmcnt(0)
 ds_read_b64_tr_b16 a[64:65], v41 offset:4096
 ds_read_b64_tr_b16 a[66:67], v41 offset:4224
 ds_read_b64_tr_b16 a[68:69], v41 offset:6144
 ds_read_b64_tr_b16 a[70:71], v41 offset:6272
 ds_read_b64_tr_b16 a[72:73], v41 offset:4128
 ds_read_b64_tr_b16 a[74:75], v41 offset:4256
 ds_read_b64_tr_b16 a[76:77], v41 offset:6176
 ds_read_b64_tr_b16 a[78:79], v41 offset:6304
 s_waitcnt lgkmcnt(0)
 s_mov_b64 s[8:9], s[20:21]
 s_add_u32 m0, s46, 0
 s_add_u32 s55, s42, 0
 buffer_load_dwordx4 v39, s[8:11], s55 offen  lds
 s_add_u32 m0, s46, 1024
 s_add_u32 s55, s42, 131072
 buffer_load_dwordx4 v39, s[8:11], s55 offen  lds
 s_add_u32 m0, s47, 2048
 s_add_u32 s55, s43, 262144
 buffer_load_dwordx4 v39, s[8:11], s55 offen  lds
 s_add_u32 m0, s47, 3072
 s_add_u32 s55, s43, 393216
 buffer_load_dwordx4 v39, s[8:11], s55 offen  lds
 s_add_u32 m0, s46, 4096
 s_add_u32 s55, s42, 524288
 buffer_load_dwordx4 v39, s[8:11], s55 offen  lds
 s_add_u32 m0, s46, 5120
 s_add_u32 s55, s42, 655360
 buffer_load_dwordx4 v39, s[8:11], s55 offen  lds
 s_add_u32 m0, s47, 6144
 s_add_u32 s55, s43, 786432
 buffer_load_dwordx4 v39, s[8:11], s55 offen  lds
 s_add_u32 m0, s47, 7168
 s_add_u32 s55, s43, 917504
 buffer_load_dwordx4 v39, s[8:11], s55 offen  lds
 v_lshlrev_b32 v65, 5, v67
 v_lshl_add_u32 v65, v68, 3, v65
 v_add_u32 v65, s94, v65
 v_lshlrev_b32 v66, 4, v67
 v_lshl_add_u32 v66, v68, 3, v66
 v_lshlrev_b32 v69, 3, v67
 v_lshl_add_u32 v69, v68, 7, v69
 v_cmp_gt_u32 vcc, 2, v68
 s_nop 1
 v_cndmask_b32 v66, v69, v66, vcc
 v_add_u32 v66, s94, v66
 v_lshlrev_b32 v69, 2, v67
 v_lshl_add_u32 v69, v68, 7, v69
 v_add_u32 v69, s94, v69
 v_cvt_pk_bf16_f32 v132, v120, v121
 v_cvt_pk_bf16_f32 v133, v122, v123
 v_cvt_pk_bf16_f32 v134, v124, v125
 v_cvt_pk_bf16_f32 v135, v126, v127
 v_cvt_pk_bf16_f32 v136, v128, v129
 v_cvt_pk_bf16_f32 v137, v130, v131
 ds_write_b64 v65, v[132:133]
 ds_write_b64 v66, v[134:135] offset:512
 ds_write_b32 v69, v136 offset:1024
 ds_write_b32 v69, v137 offset:1088
 s_waitcnt vmcnt(9)
 ds_read_b64_tr_b16 a[112:113], v41 offset:32768
 ds_read_b64_tr_b16 a[114:115], v41 offset:32896
 ds_read_b64_tr_b16 a[116:117], v41 offset:34816
 ds_read_b64_tr_b16 a[118:119], v41 offset:34944
 ds_read_b64_tr_b16 a[120:121], v41 offset:32800
 ds_read_b64_tr_b16 a[122:123], v41 offset:32928
 ds_read_b64_tr_b16 a[124:125], v41 offset:34848
 ds_read_b64_tr_b16 a[126:127], v41 offset:34976
 s_waitcnt lgkmcnt(0)
 ds_read_b64_tr_b16 a[160:161], v41 offset:36864
 ds_read_b64_tr_b16 a[162:163], v41 offset:36992
 ds_read_b64_tr_b16 a[164:165], v41 offset:38912
 ds_read_b64_tr_b16 a[166:167], v41 offset:39040
 ds_read_b64_tr_b16 a[168:169], v41 offset:36896
 ds_read_b64_tr_b16 a[170:171], v41 offset:37024
 ds_read_b64_tr_b16 a[172:173], v41 offset:38944
 ds_read_b64_tr_b16 a[174:175], v41 offset:39072
 s_waitcnt lgkmcnt(0)
 s_add_u32 m0, s46, 32768
 s_add_u32 s55, s42, 1048576
 buffer_load_dwordx4 v39, s[8:11], s55 offen  lds
 s_add_u32 m0, s46, 33792
 s_add_u32 s55, s42, 1179648
 buffer_load_dwordx4 v39, s[8:11], s55 offen  lds
 s_add_u32 m0, s47, 34816
 s_add_u32 s55, s43, 1310720
 buffer_load_dwordx4 v39, s[8:11], s55 offen  lds
 s_add_u32 m0, s47, 35840
 s_add_u32 s55, s43, 1441792
 buffer_load_dwordx4 v39, s[8:11], s55 offen  lds
 s_add_u32 m0, s46, 36864
 s_add_u32 s55, s42, 1572864
 buffer_load_dwordx4 v39, s[8:11], s55 offen  lds
 s_add_u32 m0, s46, 37888
 s_add_u32 s55, s42, 1703936
 buffer_load_dwordx4 v39, s[8:11], s55 offen  lds
 s_add_u32 m0, s47, 38912
 s_add_u32 s55, s43, 1835008
 buffer_load_dwordx4 v39, s[8:11], s55 offen  lds
 s_add_u32 m0, s47, 39936
 s_add_u32 s55, s43, 1966080
 buffer_load_dwordx4 v39, s[8:11], s55 offen  lds
 s_waitcnt vmcnt(8)
 ds_read_b64_tr_b16 a[32:33], v41 offset:0
 ds_read_b64_tr_b16 a[34:35], v41 offset:128
 ds_read_b64_tr_b16 a[36:37], v41 offset:2048
 ds_read_b64_tr_b16 a[38:39], v41 offset:2176
 ds_read_b64_tr_b16 a[40:41], v41 offset:32
 ds_read_b64_tr_b16 a[42:43], v41 offset:160
 ds_read_b64_tr_b16 a[44:45], v41 offset:2080
 ds_read_b64_tr_b16 a[46:47], v41 offset:2208
 s_waitcnt lgkmcnt(0)
 ds_read_b64_tr_b16 a[80:81], v41 offset:4096
 ds_read_b64_tr_b16 a[82:83], v41 offset:4224
 ds_read_b64_tr_b16 a[84:85], v41 offset:6144
 ds_read_b64_tr_b16 a[86:87], v41 offset:6272
 ds_read_b64_tr_b16 a[88:89], v41 offset:4128
 ds_read_b64_tr_b16 a[90:91], v41 offset:4256
 ds_read_b64_tr_b16 a[92:93], v41 offset:6176
 ds_read_b64_tr_b16 a[94:95], v41 offset:6304
 s_waitcnt lgkmcnt(0)
 s_mov_b64 s[8:9], s[22:23]
 s_add_u32 m0, s46, 0
 s_add_u32 s55, s44, 0
 buffer_load_dwordx4 v40, s[8:11], s55 offen  lds
 s_add_u32 m0, s46, 1024
 s_add_u32 s55, s44, 32768
 buffer_load_dwordx4 v40, s[8:11], s55 offen  lds
 s_add_u32 m0, s47, 2048
 s_add_u32 s55, s45, 65536
 buffer_load_dwordx4 v40, s[8:11], s55 offen  lds
 s_add_u32 m0, s47, 3072
 s_add_u32 s55, s45, 98304
 buffer_load_dwordx4 v40, s[8:11], s55 offen  lds
 s_add_u32 m0, s46, 4096
 s_add_u32 s55, s44, 131072
 buffer_load_dwordx4 v40, s[8:11], s55 offen  lds
 s_add_u32 m0, s46, 5120
 s_add_u32 s55, s44, 163840
 buffer_load_dwordx4 v40, s[8:11], s55 offen  lds
 s_add_u32 m0, s47, 6144
 s_add_u32 s55, s45, 196608
 buffer_load_dwordx4 v40, s[8:11], s55 offen  lds
 s_add_u32 m0, s47, 7168
 s_add_u32 s55, s45, 229376
 buffer_load_dwordx4 v40, s[8:11], s55 offen  lds
 s_waitcnt vmcnt(8)
 ds_read_b64_tr_b16 a[128:129], v41 offset:32768
 ds_read_b64_tr_b16 a[130:131], v41 offset:32896
 ds_read_b64_tr_b16 a[132:133], v41 offset:34816
 ds_read_b64_tr_b16 a[134:135], v41 offset:34944
 ds_read_b64_tr_b16 a[136:137], v41 offset:32800
 ds_read_b64_tr_b16 a[138:139], v41 offset:32928
 ds_read_b64_tr_b16 a[140:141], v41 offset:34848
 ds_read_b64_tr_b16 a[142:143], v41 offset:34976
 s_waitcnt lgkmcnt(0)
 ds_read_b64_tr_b16 a[176:177], v41 offset:36864
 ds_read_b64_tr_b16 a[178:179], v41 offset:36992
 ds_read_b64_tr_b16 a[180:181], v41 offset:38912
 ds_read_b64_tr_b16 a[182:183], v41 offset:39040
 ds_read_b64_tr_b16 a[184:185], v41 offset:36896
 ds_read_b64_tr_b16 a[186:187], v41 offset:37024
 ds_read_b64_tr_b16 a[188:189], v41 offset:38944
 ds_read_b64_tr_b16 a[190:191], v41 offset:39072
 s_waitcnt lgkmcnt(0)
 s_add_u32 m0, s46, 32768
 s_add_u32 s55, s44, 262144
 buffer_load_dwordx4 v40, s[8:11], s55 offen  lds
 s_add_u32 m0, s46, 33792
 s_add_u32 s55, s44, 294912
 buffer_load_dwordx4 v40, s[8:11], s55 offen  lds
 s_add_u32 m0, s47, 34816
 s_add_u32 s55, s45, 327680
 buffer_load_dwordx4 v40, s[8:11], s55 offen  lds
 s_add_u32 m0, s47, 35840
 s_add_u32 s55, s45, 360448
 buffer_load_dwordx4 v40, s[8:11], s55 offen  lds
 s_add_u32 m0, s46, 36864
 s_add_u32 s55, s44, 393216
 buffer_load_dwordx4 v40, s[8:11], s55 offen  lds
 s_add_u32 m0, s46, 37888
 s_add_u32 s55, s44, 425984
 buffer_load_dwordx4 v40, s[8:11], s55 offen  lds
 s_add_u32 m0, s47, 38912
 s_add_u32 s55, s45, 458752
 buffer_load_dwordx4 v40, s[8:11], s55 offen  lds
 s_add_u32 m0, s47, 39936
 s_add_u32 s55, s45, 491520
 buffer_load_dwordx4 v40, s[8:11], s55 offen  lds
 buffer_load_dwordx4 v[216:219], v21, s[4:7], s49 offen sc1
 buffer_load_dwordx4 v[220:223], v21, s[4:7], s50 offen sc1
 buffer_load_dwordx4 v[224:227], v22, s[4:7], s51 offen sc1
 buffer_load_dwordx4 v[228:231], v23, s[4:7], s51 offen offset:1024 sc1
 buffer_load_dword v236, v25, s[4:7], s65 offen sc1
 buffer_load_dword v237, v27, s[4:7], s65 offen sc1
 buffer_load_dword v238, v25, s[4:7], s66 offen sc1
 s_getpc_b64 s[40:41]
 s_lshl_b32 s55, s25, 9
 v_lshrrev_b32 v32, 1, v0
 v_lshl_add_u32 v32, v32, 2, s55
 global_load_dword v239, v32, s[40:41]
 s_waitcnt vmcnt(16)
 s_barrier
 ds_read_b64_tr_b16 a[192:193], v38 offset:0
 ds_read_b64_tr_b16 a[194:195], v38 offset:128
 ds_read_b64_tr_b16 a[196:197], v38 offset:2048
 ds_read_b64_tr_b16 a[198:199], v38 offset:2176
 ds_read_b64_tr_b16 a[200:201], v38 offset:4096
 ds_read_b64_tr_b16 a[202:203], v38 offset:4224
 ds_read_b64_tr_b16 a[204:205], v38 offset:6144
 ds_read_b64_tr_b16 a[206:207], v38 offset:6272
 s_waitcnt lgkmcnt(0)
 ds_read_b64_tr_b16 a[208:209], v38 offset:8192
 ds_read_b64_tr_b16 a[210:211], v38 offset:8320
 ds_read_b64_tr_b16 a[212:213], v38 offset:10240
 ds_read_b64_tr_b16 a[214:215], v38 offset:10368
 ds_read_b64_tr_b16 a[216:217], v38 offset:12288
 ds_read_b64_tr_b16 a[218:219], v38 offset:12416
 ds_read_b64_tr_b16 a[220:221], v38 offset:14336
 ds_read_b64_tr_b16 a[222:223], v38 offset:14464
 s_waitcnt lgkmcnt(0)
 ds_read_b64_tr_b16 a[224:225], v38 offset:16384
 ds_read_b64_tr_b16 a[226:227], v38 offset:16512
 ds_read_b64_tr_b16 a[228:229], v38 offset:18432
 ds_read_b64_tr_b16 a[230:231], v38 offset:18560
 ds_read_b64_tr_b16 a[232:233], v38 offset:20480
 ds_read_b64_tr_b16 a[234:235], v38 offset:20608
 ds_read_b64_tr_b16 a[236:237], v38 offset:22528
 ds_read_b64_tr_b16 a[238:239], v38 offset:22656
 s_waitcnt lgkmcnt(0)
 ds_read_b64_tr_b16 a[240:241], v38 offset:24576
 ds_read_b64_tr_b16 a[242:243], v38 offset:24704
 ds_read_b64_tr_b16 a[244:245], v38 offset:26624
 ds_read_b64_tr_b16 a[246:247], v38 offset:26752
 ds_read_b64_tr_b16 a[248:249], v38 offset:28672
 ds_read_b64_tr_b16 a[250:251], v38 offset:28800
 ds_read_b64_tr_b16 a[252:253], v38 offset:30720
 ds_read_b64_tr_b16 a[254:255], v38 offset:30848
 s_waitcnt lgkmcnt(0)
 s_waitcnt vmcnt(0)
 s_waitcnt vmcnt(8)
 s_barrier
 ds_read_b64_tr_b16 v[172:173], v38 offset:32768
 ds_read_b64_tr_b16 v[174:175], v38 offset:32896
 ds_read_b64_tr_b16 v[176:177], v38 offset:34816
 ds_read_b64_tr_b16 v[178:179], v38 offset:34944
 ds_read_b64_tr_b16 v[180:181], v38 offset:36864
 ds_read_b64_tr_b16 v[182:183], v38 offset:36992
 ds_read_b64_tr_b16 v[184:185], v38 offset:38912
 ds_read_b64_tr_b16 v[186:187], v38 offset:39040
 s_waitcnt lgkmcnt(0)
 ds_read_b64_tr_b16 v[188:189], v38 offset:40960
 ds_read_b64_tr_b16 v[190:191], v38 offset:41088
 ds_read_b64_tr_b16 v[192:193], v38 offset:43008
 ds_read_b64_tr_b16 v[194:195], v38 offset:43136
 ds_read_b64_tr_b16 v[196:197], v38 offset:45056
 ds_read_b64_tr_b16 v[198:199], v38 offset:45184
 ds_read_b64_tr_b16 v[200:201], v38 offset:47104
 ds_read_b64_tr_b16 v[202:203], v38 offset:47232
 s_waitcnt lgkmcnt(0)
 ds_read_b64_tr_b16 v[204:205], v38 offset:49152
 ds_read_b64_tr_b16 v[206:207], v38 offset:49280
 ds_read_b64_tr_b16 v[208:209], v38 offset:51200
 ds_read_b64_tr_b16 v[210:211], v38 offset:51328
 ds_read_b64_tr_b16 v[212:213], v38 offset:53248
 ds_read_b64_tr_b16 v[214:215], v38 offset:53376
 ds_read_b64_tr_b16 v[216:217], v38 offset:55296
 ds_read_b64_tr_b16 v[218:219], v38 offset:55424
 s_waitcnt lgkmcnt(0)
 ds_read_b64_tr_b16 v[220:221], v38 offset:57344
 ds_read_b64_tr_b16 v[222:223], v38 offset:57472
 ds_read_b64_tr_b16 v[224:225], v38 offset:59392
 ds_read_b64_tr_b16 v[226:227], v38 offset:59520
 ds_read_b64_tr_b16 v[228:229], v38 offset:61440
 ds_read_b64_tr_b16 v[230:231], v38 offset:61568
 ds_read_b64_tr_b16 v[232:233], v38 offset:63488
 ds_read_b64_tr_b16 v[234:235], v38 offset:63616
 s_waitcnt lgkmcnt(0)
 s_barrier
 v_mov_b32 v39, 0
 v_mov_b32 v40, 0
 v_mov_b32 v41, 0
 s_mov_b32 s3, 0
L_rdy_2:
 buffer_load_dwordx4 v[88:91], off, s[12:15], s30 sc1
 s_add_u32 s3, s3, 1
 s_cmp_gt_u32 s3, 400000
 s_cbranch_scc1 L_exit
 s_waitcnt vmcnt(0)
 v_readfirstlane_b32 s32, v88
 v_readfirstlane_b32 s33, v89
 v_readfirstlane_b32 vcc_hi, v90
 s_and_b32 vcc_lo, s32, 0xffff
 s_cmp_lt_u32 vcc_lo, 256
 s_cbranch_scc1 L_rdy_2
 s_cmp_lg_u32 vcc_hi, 0
 s_cbranch_scc1 L_general
 s_lshr_b32 vcc_lo, s33, 16
 s_and_b32 vcc_hi, s33, 0xffff
 s_cmp_gt_u32 vcc_lo, vcc_hi
 s_cselect_b32 s27, 0, 1
 s_lshl_b32 s27, 0x55, s27
 s_mov_b32 s55, 63
 s_lshr_b32 s56, s55, 3
 s_lshr_b32 s56, s27, s56
 s_and_b32 s56, s56, 1
 s_lshl_b32 s56, s56, 13
 s_lshl_b32 s68, s55, 18
 s_add_u32 s68, s68, s56
 s_add_u32 s68, s68, 134217728
 s_add_u32 s69, s69, s68
 s_add_u32 s70, s70, s68
 s_add_u32 s71, s71, s68
 s_add_u32 s72, s72, s68
 s_mov_b32 s48, 0
 s_mov_b32 s49, s63
 s_lshl_b32 s55, s24, 5
 s_add_u32 s55, s55, s25
 s_lshl_b32 s53, s55, 11
 s_add_u32 s53, s53, 16777216
 s_lshl_b32 s54, s55, 9
 s_add_u32 s54, s54, 4194304
 s_mov_b32 s58, 0
 s_mov_b32 s36, 0
 s_mov_b32 s37, 0
 s_mov_b32 s38, 0
 s_mov_b32 s39, 0
 s_cmp_eq_u32 s26, 1
 s_cbranch_scc1 L_cf_w1
 s_cmp_eq_u32 s26, 2
 s_cbranch_scc1 L_cf_w2
 s_cmp_eq_u32 s26, 3
 s_cbranch_scc1 L_cf_w3
L_cf_w0:
 v_mov_b32 v205, 0
 v_mov_b32 v207, 0
 v_mov_b32 v209, 0
 v_mov_b32 v56, 0
 v_mov_b32 v57, 0
 v_mov_b32 v58, 0
 v_mov_b32 v59, 0
 v_mov_b32 v60, 0
 v_mov_b32 v61, 0
 v_mov_b32 v62, 0
 v_mov_b32 v63, 0
 v_mov_b32 v64, 0
 v_mov_b32 v65, 0
 v_mov_b32 v66, 0
 v_mov_b32 v67, 0
 v_mov_b32 v68, 0
 v_mov_b32 v69, 0
 v_mov_b32 v70, 0
 v_mov_b32 v71, 0
 v_mov_b32 v72, 0
 v_mov_b32 v73, 0
 v_mov_b32 v74, 0
 v_mov_b32 v75, 0
 v_mov_b32 v76, 0
 v_mov_b32 v77, 0
 v_mov_b32 v78, 0
 v_mov_b32 v79, 0
 s_waitcnt vmcnt(0)
 s_barrier
 buffer_load_dwordx4 v[92:95], v6, s[4:7], s49 offen offset:0 sc1
 s_nop 3
 buffer_load_dwordx4 v[96:99], v6, s[4:7], s49 offen offset:1024 sc1
 s_nop 3
 buffer_load_dwordx4 v[100:103], v6, s[4:7], s49 offen offset:2048 sc1
 s_nop 3
 buffer_load_dwordx4 v[104:107], v6, s[4:7], s49 offen offset:3072 sc1
L_cf_w0_loop:
 s_and_b32 s55, s48, 3
 s_add_u32 s50, s49, 262144
 s_lshl_b32 s56, s55, 16
 s_add_u32 s51, s64, s56
 v_add_u32 v30, 1, v30
 ds_read_b128 v[172:175], v17 offset:36864
 ds_read_b128 v[176:179], v17 offset:36928
 ds_read_b128 v[180:183], v18 offset:38912
 ds_read_b128 v[184:187], v18 offset:39168
L_cf_w0_dtry:
 s_waitcnt vmcnt(3)
 v_smfmac_f32_16x16x64_bf16 v[56:59], v[92:95], a[0:7], v5
 v_smfmac_f32_16x16x64_bf16 v[60:63], v[92:95], a[8:15], v5
 v_smfmac_f32_16x16x64_bf16 v[64:67], v[92:95], a[16:23], v5
 v_smfmac_f32_16x16x64_bf16 v[68:71], v[92:95], a[24:31], v5
 s_waitcnt vmcnt(2)
 v_smfmac_f32_16x16x64_bf16 v[56:59], v[96:99], a[48:55], v5
 v_smfmac_f32_16x16x64_bf16 v[60:63], v[96:99], a[56:63], v5
 v_smfmac_f32_16x16x64_bf16 v[64:67], v[96:99], a[64:71], v5
 v_smfmac_f32_16x16x64_bf16 v[68:71], v[96:99], a[72:79], v5
 s_waitcnt vmcnt(1)
 v_smfmac_f32_16x16x64_bf16 v[56:59], v[100:103], a[96:103], v5
 v_smfmac_f32_16x16x64_bf16 v[60:63], v[100:103], a[104:111], v5
 v_smfmac_f32_16x16x64_bf16 v[64:67], v[100:103], a[112:119], v5
 v_smfmac_f32_16x16x64_bf16 v[68:71], v[100:103], a[120:127], v5
 s_waitcnt vmcnt(0)
 v_smfmac_f32_16x16x64_bf16 v[56:59], v[104:107], a[144:151], v5
 v_smfmac_f32_16x16x64_bf16 v[60:63], v[104:107], a[152:159], v5
 v_smfmac_f32_16x16x64_bf16 v[64:67], v[104:107], a[160:167], v5
 v_smfmac_f32_16x16x64_bf16 v[68:71], v[104:107], a[168:175], v5
 s_nop 4
 v_pk_add_f32 v[84:85], v[56:57], v[58:59]
 ds_write2_b32 v7, v84, v85 offset0:0 offset1:36
 v_cmp_u_f32 vcc, v84, v85
 v_pk_add_f32 v[86:87], v[60:61], v[62:63]
 ds_write2_b32 v7, v86, v87 offset0:16 offset1:52
 v_pk_add_f32 v[88:89], v[64:65], v[66:67]
 ds_write2_b32 v8, v88, v89 offset0:0 offset1:36
 v_pk_add_f32 v[90:91], v[68:69], v[70:71]
 ds_write2_b32 v8, v90, v91 offset0:16 offset1:52
 s_cbranch_vccnz L_cf_w0_dslow
L_cf_w0_dgood:
 v_smfmac_f32_16x16x64_bf16 v[72:75], v[92:95], a[32:39], v5
 v_smfmac_f32_16x16x64_bf16 v[76:79], v[92:95], a[40:47], v5
 v_smfmac_f32_16x16x64_bf16 v[72:75], v[96:99], a[80:87], v5
 v_smfmac_f32_16x16x64_bf16 v[76:79], v[96:99], a[88:95], v5
 s_waitcnt lgkmcnt(0)
 s_barrier
 ds_read_b128 v[108:111], v9 offset:4096
 ds_read_b128 v[112:115], v9 offset:4112
 ds_read_b128 v[116:119], v9 offset:6400
 ds_read_b128 v[120:123], v9 offset:6416
 ds_read_b128 v[124:127], v9 offset:8704
 ds_read_b128 v[128:131], v9 offset:8720
 ds_read_b128 v[132:135], v9 offset:11008
 ds_read_b128 v[136:139], v9 offset:11024
 v_smfmac_f32_16x16x64_bf16 v[72:75], v[100:103], a[128:135], v5
 s_waitcnt lgkmcnt(6)
 v_pk_mul_f32 v[108:109], v[108:109], v[54:55] op_sel_hi:[1,0]
 v_pk_mul_f32 v[110:111], v[110:111], v[54:55] op_sel_hi:[1,0]
 v_pk_mul_f32 v[112:113], v[112:113], v[54:55] op_sel_hi:[1,0]
 v_pk_mul_f32 v[114:115], v[114:115], v[54:55] op_sel_hi:[1,0]
 s_waitcnt lgkmcnt(4)
 v_pk_fma_f32 v[108:109], v[116:117], v[54:55], v[108:109] op_sel_hi:[1,0,1]
 v_pk_fma_f32 v[110:111], v[118:119], v[54:55], v[110:111] op_sel_hi:[1,0,1]
 v_pk_fma_f32 v[112:113], v[120:121], v[54:55], v[112:113] op_sel_hi:[1,0,1]
 v_pk_fma_f32 v[114:115], v[122:123], v[54:55], v[114:115] op_sel_hi:[1,0,1]
 s_waitcnt lgkmcnt(2)
 v_pk_fma_f32 v[108:109], v[124:125], v[54:55], v[108:109] op_sel_hi:[1,0,1]
 v_pk_fma_f32 v[110:111], v[126:127], v[54:55], v[110:111] op_sel_hi:[1,0,1]
 v_pk_fma_f32 v[112:113], v[128:129], v[54:55], v[112:113] op_sel_hi:[1,0,1]
 v_pk_fma_f32 v[114:115], v[130:131], v[54:55], v[114:115] op_sel_hi:[1,0,1]
 s_waitcnt lgkmcnt(0)
 v_pk_fma_f32 v[108:109], v[132:133], v[54:55], v[108:109] op_sel_hi:[1,0,1]
 v_pk_fma_f32 v[110:111], v[134:135], v[54:55], v[110:111] op_sel_hi:[1,0,1]
 v_pk_fma_f32 v[112:113], v[136:137], v[54:55], v[112:113] op_sel_hi:[1,0,1]
 v_pk_fma_f32 v[114:115], v[138:139], v[54:55], v[114:115] op_sel_hi:[1,0,1]
 v_cvt_pk_bf16_f32 v188, v108, v109
 v_cvt_pk_bf16_f32 v189, v110, v111
 v_cvt_pk_bf16_f32 v190, v112, v113
 v_cvt_pk_bf16_f32 v191, v114, v115
 s_nop 1
 v_mfma_f32_16x16x32_bf16 v[192:195], v[172:175], v[188:191], 0
 v_mfma_f32_16x16x32_bf16 v[196:199], v[176:179], v[188:191], 0
 v_mfma_f32_16x16x32_bf16 v[200:203], v[188:191], v[188:191], 0
 s_nop 5
 buffer_store_dwordx4 v[192:195], v11, s[4:7], s51 offen
 buffer_store_dwordx4 v[196:199], v11, s[4:7], s51 offen offset:128
 buffer_store_dwordx4 v[200:203], v12, s[4:7], s51 offen
 v_smfmac_f32_16x16x64_bf16 v[76:79], v[100:103], a[136:143], v5
 v_smfmac_f32_16x16x64_bf16 v[72:75], v[104:107], a[176:183], v5
 v_smfmac_f32_16x16x64_bf16 v[76:79], v[104:107], a[184:191], v5
 s_barrier
 buffer_load_dwordx4 v[108:111], v47, s[4:7], s51 offen sc1
 buffer_load_dwordx4 v[112:115], v48, s[4:7], s51 offen sc1
 buffer_load_dwordx4 v[116:119], v49, s[4:7], s51 offen sc1
 buffer_load_dword v120, v13, s[4:7], s51 offen offset:0 sc1
 buffer_load_dword v121, v13, s[4:7], s51 offen offset:1280 sc1
 buffer_load_dword v122, v13, s[4:7], s51 offen offset:2560 sc1
 buffer_load_dword v123, v13, s[4:7], s51 offen offset:3840 sc1
 ds_read_b128 v[124:127], v2 offset:15360
 ds_read_b128 v[128:131], v2 offset:16384
 ds_read_b128 v[132:135], v2 offset:17408
 v_pk_add_f32 v[84:85], v[72:73], v[74:75]
 v_pk_add_f32 v[86:87], v[76:77], v[78:79]
 v_mov_b32_dpp v192, v196 row_ror:8 row_mask:0xf bank_mask:0xc
 v_mov_b32_dpp v193, v197 row_ror:8 row_mask:0xf bank_mask:0xc
 v_mov_b32_dpp v194, v198 row_ror:8 row_mask:0xf bank_mask:0xc
 v_mov_b32_dpp v195, v199 row_ror:8 row_mask:0xf bank_mask:0xc
 s_waitcnt lgkmcnt(2)
 v_pk_add_f32 v[84:85], v[84:85], v[124:125]
 v_pk_add_f32 v[86:87], v[86:87], v[126:127]
 s_waitcnt lgkmcnt(1)
 v_pk_add_f32 v[84:85], v[84:85], v[128:129]
 v_pk_add_f32 v[86:87], v[86:87], v[130:131]
 s_waitcnt lgkmcnt(0)
 v_pk_add_f32 v[84:85], v[84:85], v[132:133]
 v_pk_add_f32 v[86:87], v[86:87], v[134:135]
 v_cvt_pk_bf16_f32 v206, v84, v85
 v_cvt_pk_bf16_f32 v208, v86, v87
 s_cmp_eq_u32 s48, 63
 s_cbranch_scc1 L_cf_w0_done
L_cf_w0_atry:
 s_waitcnt vmcnt(6)
 v_pk_add_f32 v[230:231], v[192:193], v[108:109]
 v_pk_add_f32 v[232:233], v[194:195], v[110:111]
 s_waitcnt vmcnt(5)
 v_pk_add_f32 v[230:231], v[230:231], v[112:113]
 v_pk_add_f32 v[232:233], v[232:233], v[114:115]
 s_waitcnt vmcnt(4)
 v_pk_add_f32 v[230:231], v[230:231], v[116:117]
 v_pk_add_f32 v[232:233], v[232:233], v[118:119]
 v_maximum3_f32 v36, |v230|, |v231|, |v232|
 s_waitcnt vmcnt(0)
 v_pk_add_f32 v[234:235], v[120:121], v[122:123]
 v_add_f32 v234, v234, v235
 v_maximum3_f32 v36, v36, |v233|, |v234|
 v_cmp_ngt_f32 vcc, s62, v36
 v_exp_f32 v214, v230
 v_exp_f32 v215, v231
 v_exp_f32 v216, v232
 v_exp_f32 v217, v233
 v_exp_f32 v136, v234
 s_cbranch_vccnz L_cf_w0_abad
L_cf_w0_agood:
 buffer_store_dword v30, v25, s[4:7], s65 offen
 v_cvt_pk_bf16_f32 v210, v214, v215
 v_cvt_pk_bf16_f32 v211, v216, v217
 v_mov_b32_dpp v138, v136 row_ror:8 row_mask:0xf bank_mask:0xf
 v_mov_b32_dpp v212, v210 row_ror:8 row_mask:0xf bank_mask:0xf
 v_mov_b32_dpp v213, v211 row_ror:8 row_mask:0xf bank_mask:0xf
 v_cvt_pk_bf16_f32 v204, v136, v138
 v_pk_add_f32 v[214:215], v[214:215], v[216:217]
 v_mfma_f32_16x16x32_bf16 v[218:221], v[180:183], v[210:213], 0
 v_add_f32 v137, v214, v215
 v_add_f32 v137, v137, v136
 v_mfma_f32_16x16x32_bf16 v[222:225], v[184:187], v[210:213], 0
 s_nop 0
 v_add_f32_dpp v138, v137, v137 row_ror:8 row_mask:0xf bank_mask:0xf
 v_add_f32_dpp v139, v137, v137 row_ror:8 row_mask:0xf bank_mask:0xf
 v_mfma_f32_16x16x16_bf16 v[218:221], v[206:207], v[204:205], v[218:221]
 s_nop 0
 v_permlane16_swap_b32 v138, v139
 v_mfma_f32_16x16x16_bf16 v[222:225], v[208:209], v[204:205], v[222:225]
 v_add_f32 v137, v138, v139
 v_add_f32 v138, v138, v139
 s_nop 1
 v_permlane32_swap_b32 v137, v138
 s_nop 0
 v_add_f32 v137, v137, v138
 v_rcp_f32 v214, v137
 s_mov_b32 m0, 20480
 v_pk_mul_f32 v[218:219], v[218:219], v[214:215] op_sel_hi:[1,0]
 v_pk_mul_f32 v[220:221], v[220:221], v[214:215] op_sel_hi:[1,0]
 v_pk_mul_f32 v[222:223], v[222:223], v[214:215] op_sel_hi:[1,0]
 v_pk_mul_f32 v[224:225], v[224:225], v[214:215] op_sel_hi:[1,0]
 v_cvt_pk_bf16_f32 v226, v218, v219
 v_cvt_pk_bf16_f32 v227, v220, v221
 v_cvt_pk_bf16_f32 v228, v222, v223
 v_cvt_pk_bf16_f32 v229, v224, v225
 buffer_store_dwordx4 v[226:229], v14, s[4:7], s50 offen
 s_barrier
 buffer_load_dwordx4 v6, s[4:7], s50 offen offset:0 sc1 lds
 s_nop 3
 buffer_load_dwordx4 v6, s[4:7], s50 offen offset:1024 sc1 lds
 s_nop 3
 buffer_load_dwordx4 v6, s[4:7], s50 offen offset:2048 sc1 lds
 s_nop 3
 buffer_load_dwordx4 v6, s[4:7], s50 offen offset:3072 sc1 lds
 s_add_u32 s48, s48, 1
 s_and_b32 s57, s48, 3
 s_lshl_b32 s57, s57, 14
 s_add_u32 s49, s63, s57
 v_mov_b32 v56, 0
 v_mov_b32 v57, 0
 v_mov_b32 v58, 0
 v_mov_b32 v59, 0
 v_mov_b32 v60, 0
 v_mov_b32 v61, 0
 v_mov_b32 v62, 0
 v_mov_b32 v63, 0
 v_mov_b32 v64, 0
 v_mov_b32 v65, 0
 v_mov_b32 v66, 0
 v_mov_b32 v67, 0
 v_mov_b32 v68, 0
 v_mov_b32 v69, 0
 v_mov_b32 v70, 0
 v_mov_b32 v71, 0
 v_mov_b32 v72, 0
 v_mov_b32 v73, 0
 v_mov_b32 v74, 0
 v_mov_b32 v75, 0
 v_mov_b32 v76, 0
 v_mov_b32 v77, 0
 v_mov_b32 v78, 0
 v_mov_b32 v79, 0
 s_add_u32 s57, s54, 4194304
 s_waitcnt vmcnt(3)
 s_barrier
 s_waitcnt vmcnt(2)
 s_barrier
 buffer_store_dwordx4 v[188:191], v19, s[4:7], s54 offen sc1
 s_waitcnt vmcnt(2)
 s_barrier
 buffer_store_dword v206, v4, s[4:7], s57 offen sc1
 buffer_store_dword v208, v4, s[4:7], s57 offen offset:256 sc1
 s_load_dwordx4 s[36:39], s[4:5], s69 glc
 s_waitcnt vmcnt(3)
 s_barrier
 s_add_u32 s54, s54, 0x10000
L_cf_w0_cpoll:
 s_load_dwordx4 s[36:39], s[4:5], s69 glc
 s_min_u32 s55, s36, s37
 s_min_u32 s55, s55, s38
 s_cmp_ge_u32 s55, s48
 s_cbranch_scc1 L_cf_w0_cgo
 s_min_u32 s55, s36, s37
 s_min_u32 s55, s55, s38
 s_cmp_ge_u32 s55, s48
 s_cbranch_scc1 L_cf_w0_cgo
 s_min_u32 s55, s36, s37
 s_min_u32 s55, s55, s38
 s_cmp_ge_u32 s55, s48
 s_cbranch_scc1 L_cf_w0_cgo
 s_waitcnt lgkmcnt(8)
 s_add_u32 s58, s58, 1
 s_cmp_lt_u32 s58, 400000
 s_cbranch_scc1 L_cf_w0_cpoll
 s_branch L_done
L_cf_w0_cgo:
L_cf_w0_bjoin:
 s_barrier
 v_mov_b32 v32, 1
 ds_read_b32 v32, v37 offset:19456
L_cf_w0_fspin:
 v_cmp_eq_u32 vcc, 1, v32
 s_cbranch_vccnz L_cf_w0_fspin
 v_cmp_ne_u32 vcc, 0, v32
 s_cbranch_vccnz L_cf_w0_bretry
 s_add_u32 s56, s73, 4096
 s_waitcnt vmcnt(0)
 s_atomic_umax s48, s[4:5], s56
 s_barrier
 buffer_load_dwordx4 v[92:95], v6, s[4:7], s49 offen offset:0 sc1
 s_nop 3
 buffer_load_dwordx4 v[96:99], v6, s[4:7], s49 offen offset:1024 sc1
 s_nop 3
 buffer_load_dwordx4 v[100:103], v6, s[4:7], s49 offen offset:2048 sc1
 s_nop 3
 buffer_load_dwordx4 v[104:107], v6, s[4:7], s49 offen offset:3072 sc1
 s_branch L_cf_w0_loop
L_cf_w0_dslow:
 v_max_u32 v36, v92, v93
 v_max3_u32 v36, v36, v94, v95
 v_max3_u32 v36, v36, v96, v97
 v_max3_u32 v36, v36, v98, v99
 v_max3_u32 v36, v36, v100, v101
 v_max3_u32 v36, v36, v102, v103
 v_max3_u32 v36, v36, v104, v105
 v_max3_u32 v36, v36, v106, v107
 v_cmp_eq_u32 vcc, -1, v36
 s_cbranch_vccz L_cf_w0_dgood
L_cf_w0_dagain:
 buffer_load_dwordx4 v[92:95], v6, s[4:7], s49 offen offset:0 sc1
 buffer_load_dwordx4 v[96:99], v6, s[4:7], s49 offen offset:1024 sc1
 buffer_load_dwordx4 v[100:103], v6, s[4:7], s49 offen offset:2048 sc1
 buffer_load_dwordx4 v[104:107], v6, s[4:7], s49 offen offset:3072 sc1
 v_mov_b32 v56, 0
 v_mov_b32 v57, 0
 v_mov_b32 v58, 0
 v_mov_b32 v59, 0
 v_mov_b32 v60, 0
 v_mov_b32 v61, 0
 v_mov_b32 v62, 0
 v_mov_b32 v63, 0
 v_mov_b32 v64, 0
 v_mov_b32 v65, 0
 v_mov_b32 v66, 0
 v_mov_b32 v67, 0
 v_mov_b32 v68, 0
 v_mov_b32 v69, 0
 v_mov_b32 v70, 0
 v_mov_b32 v71, 0
 s_add_u32 s58, s58, 1
 s_cmp_gt_u32 s58, 400000
 s_cbranch_scc1 L_done
 s_waitcnt vmcnt(0)
 v_max_u32 v36, v92, v93
 v_max3_u32 v36, v36, v94, v95
 v_max3_u32 v36, v36, v96, v97
 v_max3_u32 v36, v36, v98, v99
 v_max3_u32 v36, v36, v100, v101
 v_max3_u32 v36, v36, v102, v103
 v_max3_u32 v36, v36, v104, v105
 v_max3_u32 v36, v36, v106, v107
 v_cmp_eq_u32 vcc, -1, v36
 s_cbranch_vccnz L_cf_w0_dagain
 s_branch L_cf_w0_dtry
L_cf_w0_bretry:
 s_add_u32 s58, s58, 1
 s_cmp_gt_u32 s58, 400000
 s_cbranch_scc1 L_done
 s_mov_b32 m0, 20480
 s_nop 0
 buffer_load_dwordx4 v6, s[4:7], s50 offen offset:0 sc1 lds
 s_nop 3
 buffer_load_dwordx4 v6, s[4:7], s50 offen offset:1024 sc1 lds
 s_nop 3
 buffer_load_dwordx4 v6, s[4:7], s50 offen offset:2048 sc1 lds
 s_nop 3
 buffer_load_dwordx4 v6, s[4:7], s50 offen offset:3072 sc1 lds
 s_waitcnt vmcnt(3)
 s_barrier
 s_waitcnt vmcnt(2)
 s_barrier
 s_waitcnt vmcnt(1)
 s_barrier
 s_waitcnt vmcnt(0)
 s_barrier
 s_branch L_cf_w0_bjoin
L_cf_w0_abad:
 v_max3_u32 v36, v120, v121, v122
 v_max_u32 v36, v36, v123
 v_max3_u32 v36, v36, v108, v109
 v_max3_u32 v36, v36, v110, v111
 v_max3_u32 v36, v36, v112, v113
 v_max3_u32 v36, v36, v114, v115
 v_max3_u32 v36, v36, v116, v117
 v_max3_u32 v36, v36, v118, v119
 v_cmp_eq_u32 vcc, -1, v36
 buffer_load_dwordx4 v[108:111], v47, s[4:7], s51 offen sc1
 buffer_load_dwordx4 v[112:115], v48, s[4:7], s51 offen sc1
 buffer_load_dwordx4 v[116:119], v49, s[4:7], s51 offen sc1
 buffer_load_dword v120, v13, s[4:7], s51 offen offset:0 sc1
 buffer_load_dword v121, v13, s[4:7], s51 offen offset:1280 sc1
 buffer_load_dword v122, v13, s[4:7], s51 offen offset:2560 sc1
 buffer_load_dword v123, v13, s[4:7], s51 offen offset:3840 sc1
 s_add_u32 s58, s58, 1
 s_cmp_gt_u32 s58, 400000
 s_cbranch_scc1 L_done
 s_cbranch_vccnz L_cf_w0_atry
 v_max3_f32 v36, v230, v231, v232
 v_max3_f32 v36, v36, v233, v234
 s_nop 1
 v_max_f32_dpp v138, v36, v36 row_ror:8 row_mask:0xf bank_mask:0xf
 v_max_f32_dpp v139, v36, v36 row_ror:8 row_mask:0xf bank_mask:0xf
 s_nop 1
 v_permlane16_swap_b32 v138, v139
 s_nop 1
 v_max_f32 v36, v138, v139
 v_max_f32 v138, v138, v139
 s_nop 1
 v_permlane32_swap_b32 v36, v138
 s_nop 1
 v_max_f32 v36, v36, v138
 v_sub_f32 v230, v230, v36
 v_sub_f32 v231, v231, v36
 v_sub_f32 v232, v232, v36
 v_sub_f32 v233, v233, v36
 v_sub_f32 v234, v234, v36
 v_exp_f32 v214, v230
 v_exp_f32 v215, v231
 v_exp_f32 v216, v232
 v_exp_f32 v217, v233
 v_exp_f32 v136, v234
 s_branch L_cf_w0_agood
L_cf_w0_done:
 s_add_u32 s55, s54, 4194304
 buffer_store_dwordx4 v[188:191], v19, s[4:7], s54 offen sc1
 buffer_store_dword v206, v4, s[4:7], s55 offen sc1
 buffer_store_dword v208, v4, s[4:7], s55 offen offset:256 sc1
 s_waitcnt vmcnt(0)
 buffer_store_dword v30, v42, s[4:7], 0 offen sc1
 s_waitcnt vmcnt(0) lgkmcnt(0)
 s_branch L_conv_back
L_cf_w1:
 s_mov_b32 s75, 0
 s_mov_b32 s76, 0
L_cf_w1_kv0:
 s_min_u32 s55, s75, s76
 s_cmp_gt_u32 s55, 0
 s_cbranch_scc1 L_cf_w1_kv0_ok
 s_load_dword s75, s[4:5], s73 glc
 s_load_dword s76, s[4:5], s74 glc
 s_add_u32 s58, s58, 1
 s_cmp_gt_u32 s58, 400000
 s_cbranch_scc1 L_done
 s_waitcnt lgkmcnt(0)
 s_branch L_cf_w1_kv0
L_cf_w1_kv0_ok:
 s_mov_b32 m0, 36864
 s_add_u32 s55, s53, 16775168
 buffer_load_dwordx4 v2, s[4:7], s53 offen sc1 lds
 buffer_load_dwordx4 v2, s[4:7], s53 offen offset:1024 sc1 lds
 buffer_load_dwordx4 v2, s[4:7], s55 offen offset:2048 sc1 lds
 buffer_load_dwordx4 v2, s[4:7], s55 offen offset:3072 sc1 lds
 v_mov_b32 v56, 0
 v_mov_b32 v57, 0
 v_mov_b32 v58, 0
 v_mov_b32 v59, 0
 v_mov_b32 v60, 0
 v_mov_b32 v61, 0
 v_mov_b32 v62, 0
 v_mov_b32 v63, 0
 v_mov_b32 v64, 0
 v_mov_b32 v65, 0
 v_mov_b32 v66, 0
 v_mov_b32 v67, 0
 v_mov_b32 v68, 0
 v_mov_b32 v69, 0
 v_mov_b32 v70, 0
 v_mov_b32 v71, 0
 v_mov_b32 v72, 0
 v_mov_b32 v73, 0
 v_mov_b32 v74, 0
 v_mov_b32 v75, 0
 v_mov_b32 v76, 0
 v_mov_b32 v77, 0
 v_mov_b32 v78, 0
 v_mov_b32 v79, 0
 s_waitcnt vmcnt(0)
 s_barrier
 buffer_load_dwordx4 v[96:99], v6, s[4:7], s49 offen offset:1024 sc1
 s_nop 3
 buffer_load_dwordx4 v[92:95], v6, s[4:7], s49 offen offset:0 sc1
 s_nop 3
 buffer_load_dwordx4 v[104:107], v6, s[4:7], s49 offen offset:3072 sc1
 s_nop 3
 buffer_load_dwordx4 v[100:103], v6, s[4:7], s49 offen offset:2048 sc1
L_cf_w1_loop:
 s_and_b32 s55, s48, 3
 s_add_u32 s50, s49, 262144
 s_lshl_b32 s56, s55, 16
 s_add_u32 s51, s64, s56
 v_add_u32 v30, 1, v30
L_cf_w1_dtry:
 s_waitcnt vmcnt(3)
 v_smfmac_f32_16x16x64_bf16 v[56:59], v[96:99], a[48:55], v5
 v_smfmac_f32_16x16x64_bf16 v[60:63], v[96:99], a[56:63], v5
 v_smfmac_f32_16x16x64_bf16 v[64:67], v[96:99], a[64:71], v5
 v_smfmac_f32_16x16x64_bf16 v[68:71], v[96:99], a[72:79], v5
 s_waitcnt vmcnt(2)
 v_smfmac_f32_16x16x64_bf16 v[56:59], v[92:95], a[0:7], v5
 v_smfmac_f32_16x16x64_bf16 v[60:63], v[92:95], a[8:15], v5
 v_smfmac_f32_16x16x64_bf16 v[64:67], v[92:95], a[16:23], v5
 v_smfmac_f32_16x16x64_bf16 v[68:71], v[92:95], a[24:31], v5
 s_waitcnt vmcnt(1)
 v_smfmac_f32_16x16x64_bf16 v[56:59], v[104:107], a[144:151], v5
 v_smfmac_f32_16x16x64_bf16 v[60:63], v[104:107], a[152:159], v5
 v_smfmac_f32_16x16x64_bf16 v[64:67], v[104:107], a[160:167], v5
 v_smfmac_f32_16x16x64_bf16 v[68:71], v[104:107], a[168:175], v5
 s_waitcnt vmcnt(0)
 v_smfmac_f32_16x16x64_bf16 v[56:59], v[100:103], a[96:103], v5
 v_smfmac_f32_16x16x64_bf16 v[60:63], v[100:103], a[104:111], v5
 v_smfmac_f32_16x16x64_bf16 v[64:67], v[100:103], a[112:119], v5
 v_smfmac_f32_16x16x64_bf16 v[68:71], v[100:103], a[120:127], v5
 s_nop 4
 v_pk_add_f32 v[84:85], v[56:57], v[58:59]
 ds_write2_b32 v7, v84, v85 offset0:0 offset1:36
 v_cmp_u_f32 vcc, v84, v85
 v_pk_add_f32 v[86:87], v[60:61], v[62:63]
 ds_write2_b32 v7, v86, v87 offset0:16 offset1:52
 v_pk_add_f32 v[88:89], v[64:65], v[66:67]
 ds_write2_b32 v8, v88, v89 offset0:0 offset1:36
 v_pk_add_f32 v[90:91], v[68:69], v[70:71]
 ds_write2_b32 v8, v90, v91 offset0:16 offset1:52
 s_cbranch_vccnz L_cf_w1_dslow
L_cf_w1_dgood:
 v_smfmac_f32_16x16x64_bf16 v[72:75], v[92:95], a[32:39], v5
 v_smfmac_f32_16x16x64_bf16 v[76:79], v[92:95], a[40:47], v5
 v_smfmac_f32_16x16x64_bf16 v[72:75], v[96:99], a[80:87], v5
 v_smfmac_f32_16x16x64_bf16 v[76:79], v[96:99], a[88:95], v5
 s_waitcnt lgkmcnt(0)
 s_barrier
 v_smfmac_f32_16x16x64_bf16 v[72:75], v[100:103], a[128:135], v5
 v_smfmac_f32_16x16x64_bf16 v[76:79], v[100:103], a[136:143], v5
 v_smfmac_f32_16x16x64_bf16 v[72:75], v[104:107], a[176:183], v5
 v_smfmac_f32_16x16x64_bf16 v[76:79], v[104:107], a[184:191], v5
 buffer_store_dword v30, v27, s[4:7], s65 offen
 s_nop 7
 v_pk_add_f32 v[84:85], v[72:73], v[74:75]
 v_pk_add_f32 v[86:87], v[76:77], v[78:79]
 ds_write_b128 v10, v[84:87] offset:14336
 s_mov_b32 exec_lo, 15
 s_mov_b32 exec_hi, 0
L_cf_w1_apoll:
 v_cmp_gt_u32 vcc, v30, v39
 buffer_load_dword v39, v28, s[4:7], s65 offen sc1
 s_nop 2
 buffer_load_dword v39, v28, s[4:7], s65 offen sc1
 s_cbranch_vccz L_cf_w1_ago
 v_cmp_gt_u32 vcc, v30, v39
 buffer_load_dword v39, v28, s[4:7], s65 offen sc1
 s_nop 2
 buffer_load_dword v39, v28, s[4:7], s65 offen sc1
 s_cbranch_vccz L_cf_w1_ago
 v_cmp_gt_u32 vcc, v30, v39
 buffer_load_dword v39, v28, s[4:7], s65 offen sc1
 s_nop 2
 buffer_load_dword v39, v28, s[4:7], s65 offen sc1
 s_cbranch_vccz L_cf_w1_ago
 v_cmp_gt_u32 vcc, v30, v39
 buffer_load_dword v39, v28, s[4:7], s65 offen sc1
 s_nop 2
 buffer_load_dword v39, v28, s[4:7], s65 offen sc1
 s_cbranch_vccz L_cf_w1_ago
 v_cmp_gt_u32 vcc, v30, v39
 buffer_load_dword v39, v28, s[4:7], s65 offen sc1
 s_nop 2
 buffer_load_dword v39, v28, s[4:7], s65 offen sc1
 s_cbranch_vccz L_cf_w1_ago
 v_cmp_gt_u32 vcc, v30, v39
 buffer_load_dword v39, v28, s[4:7], s65 offen sc1
 s_nop 2
 buffer_load_dword v39, v28, s[4:7], s65 offen sc1
 s_cbranch_vccz L_cf_w1_ago
 v_cmp_gt_u32 vcc, v30, v39
 buffer_load_dword v39, v28, s[4:7], s65 offen sc1
 s_nop 2
 buffer_load_dword v39, v28, s[4:7], s65 offen sc1
 s_cbranch_vccz L_cf_w1_ago
 v_cmp_gt_u32 vcc, v30, v39
 buffer_load_dword v39, v28, s[4:7], s65 offen sc1
 s_nop 2
 buffer_load_dword v39, v28, s[4:7], s65 offen sc1
 s_cbranch_vccz L_cf_w1_ago
 v_cmp_gt_u32 vcc, v30, v39
 buffer_load_dword v39, v28, s[4:7], s65 offen sc1
 s_nop 2
 buffer_load_dword v39, v28, s[4:7], s65 offen sc1
 s_cbranch_vccz L_cf_w1_ago
 v_cmp_gt_u32 vcc, v30, v39
 buffer_load_dword v39, v28, s[4:7], s65 offen sc1
 s_nop 2
 buffer_load_dword v39, v28, s[4:7], s65 offen sc1
 s_cbranch_vccz L_cf_w1_ago
 s_waitcnt vmcnt(36)
 s_add_u32 s58, s58, 1
 s_cmp_lt_u32 s58, 400000
 s_cbranch_scc1 L_cf_w1_apoll
 s_branch L_done
L_cf_w1_ago:
 s_mov_b64 exec, -1
 s_waitcnt lgkmcnt(0)
 s_barrier
 s_cmp_eq_u32 s48, 63
 s_cbranch_scc1 L_cf_w1_done
 s_lshr_b32 s56, s48, 3
 s_lshr_b32 s56, s27, s56
 s_and_b32 s56, s56, 1
 s_lshl_b32 s56, s56, 13
 s_lshl_b32 s52, s48, 18
 s_add_u32 s52, s52, s56
 s_add_u32 s52, s52, 134217728
 s_mov_b32 m0, 24576
 s_add_u32 s57, s48, 4
 s_lshr_b32 s56, s57, 3
 s_lshr_b32 s56, s27, s56
 s_and_b32 s56, s56, 1
 s_lshl_b32 s56, s56, 13
 s_lshl_b32 s61, s57, 18
 s_add_u32 s61, s61, s56
 s_add_u32 s61, s61, 134217728
 s_cmp_gt_u32 s57, 62
 s_cselect_b32 s61, 1073741824, s61
 s_add_u32 s53, s53, 0x40000
 s_add_u32 s57, s48, 1
L_cf_w1_kv:
 s_min_u32 s55, s75, s76
 s_cmp_gt_u32 s55, s57
 s_cbranch_scc1 L_cf_w1_kv_ok
 s_load_dword s75, s[4:5], s73 glc
 s_load_dword s76, s[4:5], s74 glc
 s_add_u32 s58, s58, 1
 s_cmp_gt_u32 s58, 400000
 s_cbranch_scc1 L_done
 s_waitcnt lgkmcnt(0)
 s_branch L_cf_w1_kv
L_cf_w1_kv_ok:
 s_add_u32 s56, s48, 3
 s_min_u32 s56, s56, 63
 s_cmp_gt_u32 s55, s56
 s_cbranch_scc1 L_cf_w1_kvfresh
 s_load_dword s75, s[4:5], s73 glc
 s_load_dword s76, s[4:5], s74 glc
L_cf_w1_kvfresh:
 s_mov_b32 exec_lo, s67
 s_mov_b32 exec_hi, 0
L_cf_w1_bpoll:
 v_cmp_gt_u32 vcc, v30, v40
 buffer_load_dword v40, v26, s[4:7], s65 offen sc1
 s_nop 2
 buffer_load_dword v40, v26, s[4:7], s65 offen sc1
 s_cbranch_vccz L_cf_w1_bgo
 v_cmp_gt_u32 vcc, v30, v40
 buffer_load_dword v40, v26, s[4:7], s65 offen sc1
 s_nop 2
 buffer_load_dword v40, v26, s[4:7], s65 offen sc1
 s_cbranch_vccz L_cf_w1_bgo
 v_cmp_gt_u32 vcc, v30, v40
 buffer_load_dword v40, v26, s[4:7], s65 offen sc1
 s_nop 2
 buffer_load_dword v40, v26, s[4:7], s65 offen sc1
 s_cbranch_vccz L_cf_w1_bgo
 v_cmp_gt_u32 vcc, v30, v40
 buffer_load_dword v40, v26, s[4:7], s65 offen sc1
 s_nop 2
 buffer_load_dword v40, v26, s[4:7], s65 offen sc1
 s_cbranch_vccz L_cf_w1_bgo
 v_cmp_gt_u32 vcc, v30, v40
 buffer_load_dword v40, v26, s[4:7], s65 offen sc1
 s_nop 2
 buffer_load_dword v40, v26, s[4:7], s65 offen sc1
 s_cbranch_vccz L_cf_w1_bgo
 v_cmp_gt_u32 vcc, v30, v40
 buffer_load_dword v40, v26, s[4:7], s65 offen sc1
 s_nop 2
 buffer_load_dword v40, v26, s[4:7], s65 offen sc1
 s_cbranch_vccz L_cf_w1_bgo
 v_cmp_gt_u32 vcc, v30, v40
 buffer_load_dword v40, v26, s[4:7], s65 offen sc1
 s_nop 2
 buffer_load_dword v40, v26, s[4:7], s65 offen sc1
 s_cbranch_vccz L_cf_w1_bgo
 v_cmp_gt_u32 vcc, v30, v40
 buffer_load_dword v40, v26, s[4:7], s65 offen sc1
 s_nop 2
 buffer_load_dword v40, v26, s[4:7], s65 offen sc1
 s_cbranch_vccz L_cf_w1_bgo
 v_cmp_gt_u32 vcc, v30, v40
 buffer_load_dword v40, v26, s[4:7], s65 offen sc1
 s_nop 2
 buffer_load_dword v40, v26, s[4:7], s65 offen sc1
 s_cbranch_vccz L_cf_w1_bgo
 v_cmp_gt_u32 vcc, v30, v40
 buffer_load_dword v40, v26, s[4:7], s65 offen sc1
 s_nop 2
 buffer_load_dword v40, v26, s[4:7], s65 offen sc1
 s_cbranch_vccz L_cf_w1_bgo
 s_waitcnt vmcnt(36)
 s_add_u32 s58, s58, 1
 s_cmp_lt_u32 s58, 400000
 s_cbranch_scc1 L_cf_w1_bpoll
 s_branch L_done
L_cf_w1_bgo:
 s_mov_b64 exec, -1
 s_barrier
 buffer_load_dwordx4 v6, s[4:7], s50 offen offset:1024 sc1 lds
 s_nop 3
 buffer_load_dwordx4 v6, s[4:7], s50 offen offset:0 sc1 lds
 s_nop 3
 buffer_load_dwordx4 v6, s[4:7], s50 offen offset:3072 sc1 lds
 s_nop 3
 buffer_load_dwordx4 v6, s[4:7], s50 offen offset:2048 sc1 lds
 s_add_u32 s48, s48, 1
 s_and_b32 s57, s48, 3
 s_lshl_b32 s57, s57, 14
 s_add_u32 s49, s63, s57
 v_mov_b32 v56, 0
 v_mov_b32 v57, 0
 v_mov_b32 v58, 0
 v_mov_b32 v59, 0
 v_mov_b32 v60, 0
 v_mov_b32 v61, 0
 v_mov_b32 v62, 0
 v_mov_b32 v63, 0
 v_mov_b32 v64, 0
 v_mov_b32 v65, 0
 v_mov_b32 v66, 0
 v_mov_b32 v67, 0
 v_mov_b32 v68, 0
 v_mov_b32 v69, 0
 v_mov_b32 v70, 0
 v_mov_b32 v71, 0
 v_mov_b32 v72, 0
 v_mov_b32 v73, 0
 v_mov_b32 v74, 0
 v_mov_b32 v75, 0
 v_mov_b32 v76, 0
 v_mov_b32 v77, 0
 v_mov_b32 v78, 0
 v_mov_b32 v79, 0
 s_waitcnt vmcnt(3)
 s_barrier
 s_nop 5
 s_atomic_umax s48, s[4:5], s70
 s_atomic_umax s48, s[4:5], s71
 s_atomic_umax s48, s[4:5], s72
 s_waitcnt vmcnt(2)
 s_barrier
 s_nop 1
 s_mov_b32 m0, 36864
 s_add_u32 s55, s53, 16775168
 buffer_load_dwordx4 v2, s[4:7], s53 offen sc1 lds
 buffer_load_dwordx4 v2, s[4:7], s53 offen offset:1024 sc1 lds
 buffer_load_dwordx4 v2, s[4:7], s55 offen offset:2048 sc1 lds
 buffer_load_dwordx4 v2, s[4:7], s55 offen offset:3072 sc1 lds
 s_waitcnt vmcnt(5)
 s_barrier
 buffer_store_dwordx4 v[50:53], v24, s[4:7], s61 offen sc1
 s_waitcnt vmcnt(5)
 s_barrier
L_cf_w1_bjoin:
 s_barrier
 buffer_load_dwordx4 v[108:111], v44, s[4:7], s52 offen sc1
 buffer_load_dwordx4 v[112:115], v45, s[4:7], s52 offen sc1
 buffer_load_dwordx4 v[116:119], v46, s[4:7], s52 offen sc1
 ds_read_b32 v32, v37 offset:19456
 ds_read_b128 v[120:123], v2 offset:18432
 s_waitcnt lgkmcnt(0)
 v_cmp_ne_u32 vcc, 0, v32
 s_cbranch_vccnz L_cf_w1_bretry
 s_waitcnt vmcnt(2)
 buffer_store_dword v30, v25, s[4:7], s66 offen
 v_pk_add_f32 v[124:125], v[120:121], v[108:109]
 v_pk_add_f32 v[126:127], v[122:123], v[110:111]
 s_waitcnt vmcnt(2)
 v_pk_add_f32 v[124:125], v[124:125], v[112:113]
 v_pk_add_f32 v[126:127], v[126:127], v[114:115]
 s_waitcnt vmcnt(1)
 v_pk_add_f32 v[124:125], v[124:125], v[116:117]
 v_pk_add_f32 v[126:127], v[126:127], v[118:119]
 v_cmpx_o_f32 vcc, v124, v125
 v_cmpx_o_f32 vcc, v126, v127
 v_cvt_pk_bf16_f32 v128, v124, v125
 v_cvt_pk_bf16_f32 v129, v126, v127
 buffer_store_dwordx2 v[128:129], v16, s[4:7], s49 offen
 s_cmp_eq_u64 exec, -1
 s_cbranch_scc0 L_cf_w1_cslow
L_cf_w1_cgood:
 s_barrier
 buffer_load_dwordx4 v[96:99], v6, s[4:7], s49 offen offset:1024 sc1
 s_nop 3
 buffer_load_dwordx4 v[92:95], v6, s[4:7], s49 offen offset:0 sc1
 s_nop 3
 buffer_load_dwordx4 v[104:107], v6, s[4:7], s49 offen offset:3072 sc1
 s_nop 3
 buffer_load_dwordx4 v[100:103], v6, s[4:7], s49 offen offset:2048 sc1
 s_branch L_cf_w1_loop
L_cf_w1_dslow:
 v_max_u32 v36, v92, v93
 v_max3_u32 v36, v36, v94, v95
 v_max3_u32 v36, v36, v96, v97
 v_max3_u32 v36, v36, v98, v99
 v_max3_u32 v36, v36, v100, v101
 v_max3_u32 v36, v36, v102, v103
 v_max3_u32 v36, v36, v104, v105
 v_max3_u32 v36, v36, v106, v107
 v_cmp_eq_u32 vcc, -1, v36
 s_cbranch_vccz L_cf_w1_dgood
L_cf_w1_dagain:
 buffer_load_dwordx4 v[96:99], v6, s[4:7], s49 offen offset:1024 sc1
 buffer_load_dwordx4 v[92:95], v6, s[4:7], s49 offen offset:0 sc1
 buffer_load_dwordx4 v[104:107], v6, s[4:7], s49 offen offset:3072 sc1
 buffer_load_dwordx4 v[100:103], v6, s[4:7], s49 offen offset:2048 sc1
 v_mov_b32 v56, 0
 v_mov_b32 v57, 0
 v_mov_b32 v58, 0
 v_mov_b32 v59, 0
 v_mov_b32 v60, 0
 v_mov_b32 v61, 0
 v_mov_b32 v62, 0
 v_mov_b32 v63, 0
 v_mov_b32 v64, 0
 v_mov_b32 v65, 0
 v_mov_b32 v66, 0
 v_mov_b32 v67, 0
 v_mov_b32 v68, 0
 v_mov_b32 v69, 0
 v_mov_b32 v70, 0
 v_mov_b32 v71, 0
 s_add_u32 s58, s58, 1
 s_cmp_gt_u32 s58, 400000
 s_cbranch_scc1 L_done
 s_waitcnt vmcnt(0)
 v_max_u32 v36, v92, v93
 v_max3_u32 v36, v36, v94, v95
 v_max3_u32 v36, v36, v96, v97
 v_max3_u32 v36, v36, v98, v99
 v_max3_u32 v36, v36, v100, v101
 v_max3_u32 v36, v36, v102, v103
 v_max3_u32 v36, v36, v104, v105
 v_max3_u32 v36, v36, v106, v107
 v_cmp_eq_u32 vcc, -1, v36
 s_cbranch_vccnz L_cf_w1_dagain
 s_branch L_cf_w1_dtry
L_cf_w1_bretry:
 s_add_u32 s58, s58, 1
 s_cmp_gt_u32 s58, 400000
 s_cbranch_scc1 L_done
 s_mov_b32 m0, 24576
 s_nop 0
 buffer_load_dwordx4 v6, s[4:7], s50 offen offset:1024 sc1 lds
 s_nop 3
 buffer_load_dwordx4 v6, s[4:7], s50 offen offset:0 sc1 lds
 s_nop 3
 buffer_load_dwordx4 v6, s[4:7], s50 offen offset:3072 sc1 lds
 s_nop 3
 buffer_load_dwordx4 v6, s[4:7], s50 offen offset:2048 sc1 lds
 s_waitcnt vmcnt(3)
 s_barrier
 s_waitcnt vmcnt(2)
 s_barrier
 s_waitcnt vmcnt(1)
 s_barrier
 s_waitcnt vmcnt(0)
 s_barrier
 s_branch L_cf_w1_bjoin
L_cf_w1_cslow:
 s_mov_b64 exec, -1
 v_max_u32 v36, v108, v109
 v_max3_u32 v36, v36, v110, v111
 v_max3_u32 v36, v36, v112, v113
 v_max3_u32 v36, v36, v114, v115
 v_max3_u32 v36, v36, v116, v117
 v_max3_u32 v36, v36, v118, v119
 v_cmp_eq_u32 vcc, -1, v36
 s_cbranch_vccz L_cf_w1_cfull
 buffer_load_dwordx4 v[108:111], v44, s[4:7], s52 offen sc1
 buffer_load_dwordx4 v[112:115], v45, s[4:7], s52 offen sc1
 buffer_load_dwordx4 v[116:119], v46, s[4:7], s52 offen sc1
 s_add_u32 s58, s58, 1
 s_cmp_gt_u32 s58, 400000
 s_cbranch_scc1 L_done
 s_waitcnt vmcnt(2)
 v_pk_add_f32 v[124:125], v[120:121], v[108:109]
 v_pk_add_f32 v[126:127], v[122:123], v[110:111]
 s_waitcnt vmcnt(1)
 v_pk_add_f32 v[124:125], v[124:125], v[112:113]
 v_pk_add_f32 v[126:127], v[126:127], v[114:115]
 s_waitcnt vmcnt(0)
 v_pk_add_f32 v[124:125], v[124:125], v[116:117]
 v_pk_add_f32 v[126:127], v[126:127], v[118:119]
 s_branch L_cf_w1_cslow
L_cf_w1_cfull:
 v_cvt_pk_bf16_f32 v128, v124, v125
 v_cvt_pk_bf16_f32 v129, v126, v127
 buffer_store_dwordx2 v[128:129], v16, s[4:7], s49 offen
 s_branch L_cf_w1_cgood
L_cf_w1_done:
 s_waitcnt vmcnt(0) lgkmcnt(0)
 s_branch L_conv_back
L_cf_w2:
 v_mov_b32 v56, 0
 v_mov_b32 v57, 0
 v_mov_b32 v58, 0
 v_mov_b32 v59, 0
 v_mov_b32 v60, 0
 v_mov_b32 v61, 0
 v_mov_b32 v62, 0
 v_mov_b32 v63, 0
 v_mov_b32 v64, 0
 v_mov_b32 v65, 0
 v_mov_b32 v66, 0
 v_mov_b32 v67, 0
 v_mov_b32 v68, 0
 v_mov_b32 v69, 0
 v_mov_b32 v70, 0
 v_mov_b32 v71, 0
 v_mov_b32 v72, 0
 v_mov_b32 v73, 0
 v_mov_b32 v74, 0
 v_mov_b32 v75, 0
 v_mov_b32 v76, 0
 v_mov_b32 v77, 0
 v_mov_b32 v78, 0
 v_mov_b32 v79, 0
 s_waitcnt vmcnt(0)
 s_barrier
 buffer_load_dwordx4 v[100:103], v6, s[4:7], s49 offen offset:2048 sc1
 s_nop 3
 buffer_load_dwordx4 v[104:107], v6, s[4:7], s49 offen offset:3072 sc1
 s_nop 3
 buffer_load_dwordx4 v[92:95], v6, s[4:7], s49 offen offset:0 sc1
 s_nop 3
 buffer_load_dwordx4 v[96:99], v6, s[4:7], s49 offen offset:1024 sc1
L_cf_w2_loop:
 s_and_b32 s55, s48, 3
 s_add_u32 s50, s49, 262144
 s_lshl_b32 s56, s55, 16
 s_add_u32 s51, s64, s56
 v_add_u32 v30, 1, v30
L_cf_w2_dtry:
 s_waitcnt vmcnt(3)
 v_smfmac_f32_16x16x64_bf16 v[56:59], v[100:103], a[96:103], v5
 v_smfmac_f32_16x16x64_bf16 v[60:63], v[100:103], a[104:111], v5
 v_smfmac_f32_16x16x64_bf16 v[64:67], v[100:103], a[112:119], v5
 v_smfmac_f32_16x16x64_bf16 v[68:71], v[100:103], a[120:127], v5
 s_waitcnt vmcnt(2)
 v_smfmac_f32_16x16x64_bf16 v[56:59], v[104:107], a[144:151], v5
 v_smfmac_f32_16x16x64_bf16 v[60:63], v[104:107], a[152:159], v5
 v_smfmac_f32_16x16x64_bf16 v[64:67], v[104:107], a[160:167], v5
 v_smfmac_f32_16x16x64_bf16 v[68:71], v[104:107], a[168:175], v5
 s_waitcnt vmcnt(1)
 v_smfmac_f32_16x16x64_bf16 v[56:59], v[92:95], a[0:7], v5
 v_smfmac_f32_16x16x64_bf16 v[60:63], v[92:95], a[8:15], v5
 v_smfmac_f32_16x16x64_bf16 v[64:67], v[92:95], a[16:23], v5
 v_smfmac_f32_16x16x64_bf16 v[68:71], v[92:95], a[24:31], v5
 s_waitcnt vmcnt(0)
 v_smfmac_f32_16x16x64_bf16 v[56:59], v[96:99], a[48:55], v5
 v_smfmac_f32_16x16x64_bf16 v[60:63], v[96:99], a[56:63], v5
 v_smfmac_f32_16x16x64_bf16 v[64:67], v[96:99], a[64:71], v5
 v_smfmac_f32_16x16x64_bf16 v[68:71], v[96:99], a[72:79], v5
 s_nop 4
 v_pk_add_f32 v[84:85], v[56:57], v[58:59]
 ds_write2_b32 v7, v84, v85 offset0:0 offset1:36
 v_cmp_u_f32 vcc, v84, v85
 v_pk_add_f32 v[86:87], v[60:61], v[62:63]
 ds_write2_b32 v7, v86, v87 offset0:16 offset1:52
 v_pk_add_f32 v[88:89], v[64:65], v[66:67]
 ds_write2_b32 v8, v88, v89 offset0:0 offset1:36
 v_pk_add_f32 v[90:91], v[68:69], v[70:71]
 ds_write2_b32 v8, v90, v91 offset0:16 offset1:52
 s_cbranch_vccnz L_cf_w2_dslow
L_cf_w2_dgood:
 v_smfmac_f32_16x16x64_bf16 v[72:75], v[92:95], a[32:39], v5
 v_smfmac_f32_16x16x64_bf16 v[76:79], v[92:95], a[40:47], v5
 v_smfmac_f32_16x16x64_bf16 v[72:75], v[96:99], a[80:87], v5
 v_smfmac_f32_16x16x64_bf16 v[76:79], v[96:99], a[88:95], v5
 s_waitcnt lgkmcnt(0)
 s_barrier
 v_smfmac_f32_16x16x64_bf16 v[72:75], v[100:103], a[128:135], v5
 v_smfmac_f32_16x16x64_bf16 v[76:79], v[100:103], a[136:143], v5
 v_smfmac_f32_16x16x64_bf16 v[72:75], v[104:107], a[176:183], v5
 v_smfmac_f32_16x16x64_bf16 v[76:79], v[104:107], a[184:191], v5
 s_nop 7
 v_pk_add_f32 v[84:85], v[72:73], v[74:75]
 v_pk_add_f32 v[86:87], v[76:77], v[78:79]
 ds_write_b128 v10, v[84:87] offset:14336
 s_waitcnt lgkmcnt(0)
 s_barrier
 s_cmp_eq_u32 s48, 63
 s_cbranch_scc1 L_cf_w2_done
 s_lshr_b32 s56, s48, 3
 s_lshr_b32 s56, s27, s56
 s_and_b32 s56, s56, 1
 s_lshl_b32 s56, s56, 13
 s_lshl_b32 s52, s48, 18
 s_add_u32 s52, s52, s56
 s_add_u32 s52, s52, 134217728
 s_mov_b32 m0, 28672
 v_mov_b32 v80, 0
 v_mov_b32 v81, 0
 v_mov_b32 v82, 0
 v_mov_b32 v83, 0
 s_barrier
 buffer_load_dwordx4 v6, s[4:7], s50 offen offset:2048 sc1 lds
 s_nop 3
 buffer_load_dwordx4 v6, s[4:7], s50 offen offset:3072 sc1 lds
 s_nop 3
 buffer_load_dwordx4 v6, s[4:7], s50 offen offset:0 sc1 lds
 s_nop 3
 buffer_load_dwordx4 v6, s[4:7], s50 offen offset:1024 sc1 lds
 s_add_u32 s48, s48, 1
 s_and_b32 s57, s48, 3
 s_lshl_b32 s57, s57, 14
 s_add_u32 s49, s63, s57
 v_mov_b32 v56, 0
 v_mov_b32 v57, 0
 v_mov_b32 v58, 0
 v_mov_b32 v59, 0
 v_mov_b32 v60, 0
 v_mov_b32 v61, 0
 v_mov_b32 v62, 0
 v_mov_b32 v63, 0
 v_mov_b32 v64, 0
 v_mov_b32 v65, 0
 v_mov_b32 v66, 0
 v_mov_b32 v67, 0
 v_mov_b32 v68, 0
 v_mov_b32 v69, 0
 v_mov_b32 v70, 0
 v_mov_b32 v71, 0
 v_mov_b32 v72, 0
 v_mov_b32 v73, 0
 v_mov_b32 v74, 0
 v_mov_b32 v75, 0
 v_mov_b32 v76, 0
 v_mov_b32 v77, 0
 v_mov_b32 v78, 0
 v_mov_b32 v79, 0
L_cf_w2_bwait:
 s_waitcnt vmcnt(3)
 s_barrier
 ds_read_b128 v[108:111], v20 offset:20480
 ds_read_b128 v[128:131], v20 offset:25600
 ds_read_b128 v[148:151], v20 offset:30720
 ds_read_b128 v[168:171], v20 offset:35840
 s_waitcnt lgkmcnt(3)
 v_smfmac_f32_16x16x64_bf16 v[80:83], v[108:111], a[192:199], v5
 s_waitcnt vmcnt(2)
 s_barrier
 ds_read_b128 v[112:115], v20 offset:21504
 ds_read_b128 v[124:127], v20 offset:24576
 ds_read_b128 v[152:155], v20 offset:31744
 ds_read_b128 v[164:167], v20 offset:34816
 s_waitcnt lgkmcnt(6)
 v_smfmac_f32_16x16x64_bf16 v[80:83], v[128:131], a[216:223], v5
 s_waitcnt lgkmcnt(5)
 v_smfmac_f32_16x16x64_bf16 v[80:83], v[148:151], v[204:211], v5
 s_waitcnt lgkmcnt(4)
 v_smfmac_f32_16x16x64_bf16 v[80:83], v[168:171], v[228:235], v5
 s_waitcnt lgkmcnt(3)
 v_smfmac_f32_16x16x64_bf16 v[80:83], v[112:115], a[200:207], v5
 s_waitcnt vmcnt(1)
 s_barrier
 ds_read_b128 v[116:119], v20 offset:22528
 ds_read_b128 v[136:139], v20 offset:27648
 ds_read_b128 v[140:143], v20 offset:28672
 ds_read_b128 v[160:163], v20 offset:33792
 s_waitcnt lgkmcnt(6)
 v_smfmac_f32_16x16x64_bf16 v[80:83], v[124:127], a[208:215], v5
 s_waitcnt lgkmcnt(5)
 v_smfmac_f32_16x16x64_bf16 v[80:83], v[152:155], v[212:219], v5
 s_waitcnt lgkmcnt(4)
 v_smfmac_f32_16x16x64_bf16 v[80:83], v[164:167], v[220:227], v5
 s_waitcnt lgkmcnt(3)
 v_smfmac_f32_16x16x64_bf16 v[80:83], v[116:119], v[172:179], v5
 s_waitcnt vmcnt(0)
 s_barrier
 ds_read_b128 v[120:123], v20 offset:23552
 ds_read_b128 v[132:135], v20 offset:26624
 ds_read_b128 v[144:147], v20 offset:29696
 ds_read_b128 v[156:159], v20 offset:32768
 s_waitcnt lgkmcnt(6)
 v_smfmac_f32_16x16x64_bf16 v[80:83], v[136:139], v[196:203], v5
 s_waitcnt lgkmcnt(5)
 v_smfmac_f32_16x16x64_bf16 v[80:83], v[140:143], a[224:231], v5
 s_waitcnt lgkmcnt(4)
 v_smfmac_f32_16x16x64_bf16 v[80:83], v[160:163], a[248:255], v5
 s_waitcnt lgkmcnt(3)
 v_smfmac_f32_16x16x64_bf16 v[80:83], v[120:123], v[180:187], v5
 s_waitcnt lgkmcnt(2)
 v_smfmac_f32_16x16x64_bf16 v[80:83], v[132:135], v[188:195], v5
 s_waitcnt lgkmcnt(1)
 v_smfmac_f32_16x16x64_bf16 v[80:83], v[144:147], a[232:239], v5
 s_waitcnt lgkmcnt(0)
 v_smfmac_f32_16x16x64_bf16 v[80:83], v[156:159], a[240:247], v5
 s_nop 7
 v_pk_add_f32 v[84:85], v[80:81], v[82:83]
 v_cmpx_o_f32 vcc, v84, v85
 buffer_store_dword v84, v15, s[4:7], s52 offen sc1
 buffer_store_dword v85, v15, s[4:7], s52 offen offset:256 sc1
 s_cmp_eq_u64 exec, -1
 s_cbranch_scc0 L_cf_w2_bslow
L_cf_w2_bgood:
 ds_write2st64_b32 v4, v84, v85 offset0:72 offset1:73
 ds_write_b32 v37, v37 offset:19456
 s_nop 15
 s_nop 15
 s_nop 15
 s_nop 15
 s_nop 5
 s_waitcnt lgkmcnt(0)
 s_barrier
 s_nop 15
 s_nop 15
 s_nop 15
 s_nop 11
 s_mov_b32 exec_lo, s67
 s_mov_b32 exec_hi, 0
L_cf_w2_spoll:
 v_cmp_gt_u32 vcc, v30, v41
 buffer_load_dword v41, v26, s[4:7], s66 offen sc1
 s_nop 2
 buffer_load_dword v41, v26, s[4:7], s66 offen sc1
 s_cbranch_vccz L_cf_w2_sgo
 v_cmp_gt_u32 vcc, v30, v41
 buffer_load_dword v41, v26, s[4:7], s66 offen sc1
 s_nop 2
 buffer_load_dword v41, v26, s[4:7], s66 offen sc1
 s_cbranch_vccz L_cf_w2_sgo
 v_cmp_gt_u32 vcc, v30, v41
 buffer_load_dword v41, v26, s[4:7], s66 offen sc1
 s_nop 2
 buffer_load_dword v41, v26, s[4:7], s66 offen sc1
 s_cbranch_vccz L_cf_w2_sgo
 v_cmp_gt_u32 vcc, v30, v41
 buffer_load_dword v41, v26, s[4:7], s66 offen sc1
 s_nop 2
 buffer_load_dword v41, v26, s[4:7], s66 offen sc1
 s_cbranch_vccz L_cf_w2_sgo
 v_cmp_gt_u32 vcc, v30, v41
 buffer_load_dword v41, v26, s[4:7], s66 offen sc1
 s_nop 2
 buffer_load_dword v41, v26, s[4:7], s66 offen sc1
 s_cbranch_vccz L_cf_w2_sgo
 v_cmp_gt_u32 vcc, v30, v41
 buffer_load_dword v41, v26, s[4:7], s66 offen sc1
 s_nop 2
 buffer_load_dword v41, v26, s[4:7], s66 offen sc1
 s_cbranch_vccz L_cf_w2_sgo
 v_cmp_gt_u32 vcc, v30, v41
 buffer_load_dword v41, v26, s[4:7], s66 offen sc1
 s_nop 2
 buffer_load_dword v41, v26, s[4:7], s66 offen sc1
 s_cbranch_vccz L_cf_w2_sgo
 v_cmp_gt_u32 vcc, v30, v41
 buffer_load_dword v41, v26, s[4:7], s66 offen sc1
 s_nop 2
 buffer_load_dword v41, v26, s[4:7], s66 offen sc1
 s_cbranch_vccz L_cf_w2_sgo
 v_cmp_gt_u32 vcc, v30, v41
 buffer_load_dword v41, v26, s[4:7], s66 offen sc1
 s_nop 2
 buffer_load_dword v41, v26, s[4:7], s66 offen sc1
 s_cbranch_vccz L_cf_w2_sgo
 v_cmp_gt_u32 vcc, v30, v41
 buffer_load_dword v41, v26, s[4:7], s66 offen sc1
 s_nop 2
 buffer_load_dword v41, v26, s[4:7], s66 offen sc1
 s_cbranch_vccz L_cf_w2_sgo
 s_waitcnt vmcnt(36)
 s_add_u32 s58, s58, 1
 s_cmp_lt_u32 s58, 400000
 s_cbranch_scc1 L_cf_w2_spoll
 s_branch L_done
L_cf_w2_sgo:
 s_mov_b64 exec, -1
 s_barrier
 buffer_load_dwordx4 v[100:103], v6, s[4:7], s49 offen offset:2048 sc1
 s_nop 3
 buffer_load_dwordx4 v[104:107], v6, s[4:7], s49 offen offset:3072 sc1
 s_nop 3
 buffer_load_dwordx4 v[92:95], v6, s[4:7], s49 offen offset:0 sc1
 s_nop 3
 buffer_load_dwordx4 v[96:99], v6, s[4:7], s49 offen offset:1024 sc1
 s_branch L_cf_w2_loop
L_cf_w2_dslow:
 v_max_u32 v36, v92, v93
 v_max3_u32 v36, v36, v94, v95
 v_max3_u32 v36, v36, v96, v97
 v_max3_u32 v36, v36, v98, v99
 v_max3_u32 v36, v36, v100, v101
 v_max3_u32 v36, v36, v102, v103
 v_max3_u32 v36, v36, v104, v105
 v_max3_u32 v36, v36, v106, v107
 v_cmp_eq_u32 vcc, -1, v36
 s_cbranch_vccz L_cf_w2_dgood
L_cf_w2_dagain:
 buffer_load_dwordx4 v[100:103], v6, s[4:7], s49 offen offset:2048 sc1
 buffer_load_dwordx4 v[104:107], v6, s[4:7], s49 offen offset:3072 sc1
 buffer_load_dwordx4 v[92:95], v6, s[4:7], s49 offen offset:0 sc1
 buffer_load_dwordx4 v[96:99], v6, s[4:7], s49 offen offset:1024 sc1
 v_mov_b32 v56, 0
 v_mov_b32 v57, 0
 v_mov_b32 v58, 0
 v_mov_b32 v59, 0
 v_mov_b32 v60, 0
 v_mov_b32 v61, 0
 v_mov_b32 v62, 0
 v_mov_b32 v63, 0
 v_mov_b32 v64, 0
 v_mov_b32 v65, 0
 v_mov_b32 v66, 0
 v_mov_b32 v67, 0
 v_mov_b32 v68, 0
 v_mov_b32 v69, 0
 v_mov_b32 v70, 0
 v_mov_b32 v71, 0
 s_add_u32 s58, s58, 1
 s_cmp_gt_u32 s58, 400000
 s_cbranch_scc1 L_done
 s_waitcnt vmcnt(0)
 v_max_u32 v36, v92, v93
 v_max3_u32 v36, v36, v94, v95
 v_max3_u32 v36, v36, v96, v97
 v_max3_u32 v36, v36, v98, v99
 v_max3_u32 v36, v36, v100, v101
 v_max3_u32 v36, v36, v102, v103
 v_max3_u32 v36, v36, v104, v105
 v_max3_u32 v36, v36, v106, v107
 v_cmp_eq_u32 vcc, -1, v36
 s_cbranch_vccnz L_cf_w2_dagain
 s_branch L_cf_w2_dtry
L_cf_w2_bslow:
 s_mov_b64 exec, -1
 v_max_u32 v36, v108, v109
 v_max3_u32 v36, v36, v110, v111
 v_max3_u32 v36, v36, v112, v113
 v_max3_u32 v36, v36, v114, v115
 v_max3_u32 v36, v36, v116, v117
 v_max3_u32 v36, v36, v118, v119
 v_max3_u32 v36, v36, v120, v121
 v_max3_u32 v36, v36, v122, v123
 v_max3_u32 v36, v36, v124, v125
 v_max3_u32 v36, v36, v126, v127
 v_max3_u32 v36, v36, v128, v129
 v_max3_u32 v36, v36, v130, v131
 v_max3_u32 v36, v36, v132, v133
 v_max3_u32 v36, v36, v134, v135
 v_max3_u32 v36, v36, v136, v137
 v_max3_u32 v36, v36, v138, v139
 v_max3_u32 v36, v36, v140, v141
 v_max3_u32 v36, v36, v142, v143
 v_max3_u32 v36, v36, v144, v145
 v_max3_u32 v36, v36, v146, v147
 v_max3_u32 v36, v36, v148, v149
 v_max3_u32 v36, v36, v150, v151
 v_max3_u32 v36, v36, v152, v153
 v_max3_u32 v36, v36, v154, v155
 v_max3_u32 v36, v36, v156, v157
 v_max3_u32 v36, v36, v158, v159
 v_max3_u32 v36, v36, v160, v161
 v_max3_u32 v36, v36, v162, v163
 v_max3_u32 v36, v36, v164, v165
 v_max3_u32 v36, v36, v166, v167
 v_max3_u32 v36, v36, v168, v169
 v_max3_u32 v36, v36, v170, v171
 v_cmp_eq_u32 vcc, -1, v36
 s_cbranch_vccnz L_cf_w2_bagain
 buffer_store_dword v84, v15, s[4:7], s52 offen sc1
 buffer_store_dword v85, v15, s[4:7], s52 offen offset:256 sc1
 s_branch L_cf_w2_bgood
L_cf_w2_bagain:
 ds_write_b32 v37, v50 offset:19456
 v_mov_b32 v80, 0
 v_mov_b32 v81, 0
 v_mov_b32 v82, 0
 v_mov_b32 v83, 0
 s_add_u32 s58, s58, 1
 s_cmp_gt_u32 s58, 400000
 s_cbranch_scc1 L_done
 s_waitcnt lgkmcnt(0)
 s_barrier
 buffer_load_dwordx4 v6, s[4:7], s50 offen offset:2048 sc1 lds
 s_nop 3
 buffer_load_dwordx4 v6, s[4:7], s50 offen offset:3072 sc1 lds
 s_nop 3
 buffer_load_dwordx4 v6, s[4:7], s50 offen offset:0 sc1 lds
 s_nop 3
 buffer_load_dwordx4 v6, s[4:7], s50 offen offset:1024 sc1 lds
 s_branch L_cf_w2_bwait
L_cf_w2_done:
 s_waitcnt vmcnt(0) lgkmcnt(0)
 s_branch L_conv_back
L_cf_w3:
 v_mov_b32 v56, 0
 v_mov_b32 v57, 0
 v_mov_b32 v58, 0
 v_mov_b32 v59, 0
 v_mov_b32 v60, 0
 v_mov_b32 v61, 0
 v_mov_b32 v62, 0
 v_mov_b32 v63, 0
 v_mov_b32 v64, 0
 v_mov_b32 v65, 0
 v_mov_b32 v66, 0
 v_mov_b32 v67, 0
 v_mov_b32 v68, 0
 v_mov_b32 v69, 0
 v_mov_b32 v70, 0
 v_mov_b32 v71, 0
 v_mov_b32 v72, 0
 v_mov_b32 v73, 0
 v_mov_b32 v74, 0
 v_mov_b32 v75, 0
 v_mov_b32 v76, 0
 v_mov_b32 v77, 0
 v_mov_b32 v78, 0
 v_mov_b32 v79, 0
 s_waitcnt vmcnt(0)
 s_barrier
 buffer_load_dwordx4 v[104:107], v6, s[4:7], s49 offen offset:3072 sc1
 s_nop 3
 buffer_load_dwordx4 v[100:103], v6, s[4:7], s49 offen offset:2048 sc1
 s_nop 3
 buffer_load_dwordx4 v[96:99], v6, s[4:7], s49 offen offset:1024 sc1
 s_nop 3
 buffer_load_dwordx4 v[92:95], v6, s[4:7], s49 offen offset:0 sc1
L_cf_w3_loop:
 s_and_b32 s55, s48, 3
 s_add_u32 s50, s49, 262144
 s_lshl_b32 s56, s55, 16
 s_add_u32 s51, s64, s56
 v_add_u32 v30, 1, v30
L_cf_w3_dtry:
 s_waitcnt vmcnt(3)
 v_smfmac_f32_16x16x64_bf16 v[56:59], v[104:107], a[144:151], v5
 v_smfmac_f32_16x16x64_bf16 v[60:63], v[104:107], a[152:159], v5
 v_smfmac_f32_16x16x64_bf16 v[64:67], v[104:107], a[160:167], v5
 v_smfmac_f32_16x16x64_bf16 v[68:71], v[104:107], a[168:175], v5
 s_waitcnt vmcnt(2)
 v_smfmac_f32_16x16x64_bf16 v[56:59], v[100:103], a[96:103], v5
 v_smfmac_f32_16x16x64_bf16 v[60:63], v[100:103], a[104:111], v5
 v_smfmac_f32_16x16x64_bf16 v[64:67], v[100:103], a[112:119], v5
 v_smfmac_f32_16x16x64_bf16 v[68:71], v[100:103], a[120:127], v5
 s_waitcnt vmcnt(1)
 v_smfmac_f32_16x16x64_bf16 v[56:59], v[96:99], a[48:55], v5
 v_smfmac_f32_16x16x64_bf16 v[60:63], v[96:99], a[56:63], v5
 v_smfmac_f32_16x16x64_bf16 v[64:67], v[96:99], a[64:71], v5
 v_smfmac_f32_16x16x64_bf16 v[68:71], v[96:99], a[72:79], v5
 s_waitcnt vmcnt(0)
 v_smfmac_f32_16x16x64_bf16 v[56:59], v[92:95], a[0:7], v5
 v_smfmac_f32_16x16x64_bf16 v[60:63], v[92:95], a[8:15], v5
 v_smfmac_f32_16x16x64_bf16 v[64:67], v[92:95], a[16:23], v5
 v_smfmac_f32_16x16x64_bf16 v[68:71], v[92:95], a[24:31], v5
 s_nop 4
 v_pk_add_f32 v[84:85], v[56:57], v[58:59]
 ds_write2_b32 v7, v84, v85 offset0:0 offset1:36
 v_cmp_u_f32 vcc, v84, v85
 v_pk_add_f32 v[86:87], v[60:61], v[62:63]
 ds_write2_b32 v7, v86, v87 offset0:16 offset1:52
 v_pk_add_f32 v[88:89], v[64:65], v[66:67]
 ds_write2_b32 v8, v88, v89 offset0:0 offset1:36
 v_pk_add_f32 v[90:91], v[68:69], v[70:71]
 ds_write2_b32 v8, v90, v91 offset0:16 offset1:52
 s_cbranch_vccnz L_cf_w3_dslow
L_cf_w3_dgood:
 v_smfmac_f32_16x16x64_bf16 v[72:75], v[92:95], a[32:39], v5
 v_smfmac_f32_16x16x64_bf16 v[76:79], v[92:95], a[40:47], v5
 v_smfmac_f32_16x16x64_bf16 v[72:75], v[96:99], a[80:87], v5
 v_smfmac_f32_16x16x64_bf16 v[76:79], v[96:99], a[88:95], v5
 s_waitcnt lgkmcnt(0)
 s_barrier
 v_smfmac_f32_16x16x64_bf16 v[72:75], v[100:103], a[128:135], v5
 v_smfmac_f32_16x16x64_bf16 v[76:79], v[100:103], a[136:143], v5
 v_smfmac_f32_16x16x64_bf16 v[72:75], v[104:107], a[176:183], v5
 v_smfmac_f32_16x16x64_bf16 v[76:79], v[104:107], a[184:191], v5
 s_nop 7
 v_pk_add_f32 v[84:85], v[72:73], v[74:75]
 v_pk_add_f32 v[86:87], v[76:77], v[78:79]
 ds_write_b128 v10, v[84:87] offset:14336
 s_waitcnt lgkmcnt(0)
 s_barrier
 s_cmp_eq_u32 s48, 63
 s_cbranch_scc1 L_cf_w3_done
 s_lshr_b32 s56, s48, 3
 s_lshr_b32 s56, s27, s56
 s_and_b32 s56, s56, 1
 s_lshl_b32 s56, s56, 13
 s_lshl_b32 s52, s48, 18
 s_add_u32 s52, s52, s56
 s_add_u32 s52, s52, 134217728
 s_mov_b32 m0, 32768
 v_mov_b32 v80, 0
 v_mov_b32 v81, 0
 v_mov_b32 v82, 0
 v_mov_b32 v83, 0
 s_xor_b32 s59, s49, 0x8000
 s_xor_b32 s60, s51, 0x20000
 s_barrier
 buffer_load_dwordx4 v6, s[4:7], s50 offen offset:3072 sc1 lds
 s_nop 3
 buffer_load_dwordx4 v6, s[4:7], s50 offen offset:2048 sc1 lds
 s_nop 3
 buffer_load_dwordx4 v6, s[4:7], s50 offen offset:1024 sc1 lds
 s_nop 3
 buffer_load_dwordx4 v6, s[4:7], s50 offen offset:0 sc1 lds
 s_add_u32 s48, s48, 1
 s_and_b32 s57, s48, 3
 s_lshl_b32 s57, s57, 14
 s_add_u32 s49, s63, s57
 v_mov_b32 v56, 0
 v_mov_b32 v57, 0
 v_mov_b32 v58, 0
 v_mov_b32 v59, 0
 v_mov_b32 v60, 0
 v_mov_b32 v61, 0
 v_mov_b32 v62, 0
 v_mov_b32 v63, 0
 v_mov_b32 v64, 0
 v_mov_b32 v65, 0
 v_mov_b32 v66, 0
 v_mov_b32 v67, 0
 v_mov_b32 v68, 0
 v_mov_b32 v69, 0
 v_mov_b32 v70, 0
 v_mov_b32 v71, 0
 v_mov_b32 v72, 0
 v_mov_b32 v73, 0
 v_mov_b32 v74, 0
 v_mov_b32 v75, 0
 v_mov_b32 v76, 0
 v_mov_b32 v77, 0
 v_mov_b32 v78, 0
 v_mov_b32 v79, 0
L_cf_w3_bwait:
 s_waitcnt vmcnt(3)
 s_barrier
 ds_read_b128 v[108:111], v20 offset:20480
 ds_read_b128 v[128:131], v20 offset:25600
 ds_read_b128 v[148:151], v20 offset:30720
 ds_read_b128 v[168:171], v20 offset:35840
 s_waitcnt lgkmcnt(3)
 v_smfmac_f32_16x16x64_bf16 v[80:83], v[108:111], a[192:199], v5
 s_waitcnt vmcnt(2)
 s_barrier
 ds_read_b128 v[112:115], v20 offset:21504
 ds_read_b128 v[124:127], v20 offset:24576
 ds_read_b128 v[152:155], v20 offset:31744
 ds_read_b128 v[164:167], v20 offset:34816
 s_waitcnt lgkmcnt(6)
 v_smfmac_f32_16x16x64_bf16 v[80:83], v[128:131], a[216:223], v5
 s_waitcnt lgkmcnt(5)
 v_smfmac_f32_16x16x64_bf16 v[80:83], v[148:151], v[204:211], v5
 s_waitcnt lgkmcnt(4)
 v_smfmac_f32_16x16x64_bf16 v[80:83], v[168:171], v[228:235], v5
 s_waitcnt lgkmcnt(3)
 v_smfmac_f32_16x16x64_bf16 v[80:83], v[112:115], a[200:207], v5
 s_waitcnt vmcnt(1)
 s_barrier
 ds_read_b128 v[116:119], v20 offset:22528
 ds_read_b128 v[136:139], v20 offset:27648
 ds_read_b128 v[140:143], v20 offset:28672
 ds_read_b128 v[160:163], v20 offset:33792
 s_waitcnt lgkmcnt(6)
 v_smfmac_f32_16x16x64_bf16 v[80:83], v[124:127], a[208:215], v5
 s_waitcnt lgkmcnt(5)
 v_smfmac_f32_16x16x64_bf16 v[80:83], v[152:155], v[212:219], v5
 s_waitcnt lgkmcnt(4)
 v_smfmac_f32_16x16x64_bf16 v[80:83], v[164:167], v[220:227], v5
 s_waitcnt lgkmcnt(3)
 v_smfmac_f32_16x16x64_bf16 v[80:83], v[116:119], v[172:179], v5
 s_waitcnt vmcnt(0)
 s_barrier
 ds_read_b128 v[120:123], v20 offset:23552
 ds_read_b128 v[132:135], v20 offset:26624
 ds_read_b128 v[144:147], v20 offset:29696
 ds_read_b128 v[156:159], v20 offset:32768
 s_waitcnt lgkmcnt(6)
 v_smfmac_f32_16x16x64_bf16 v[80:83], v[136:139], v[196:203], v5
 s_waitcnt lgkmcnt(5)
 v_smfmac_f32_16x16x64_bf16 v[80:83], v[140:143], a[224:231], v5
 s_waitcnt lgkmcnt(4)
 v_smfmac_f32_16x16x64_bf16 v[80:83], v[160:163], a[248:255], v5
 s_waitcnt lgkmcnt(3)
 v_smfmac_f32_16x16x64_bf16 v[80:83], v[120:123], v[180:187], v5
 s_waitcnt lgkmcnt(2)
 v_smfmac_f32_16x16x64_bf16 v[80:83], v[132:135], v[188:195], v5
 s_waitcnt lgkmcnt(1)
 v_smfmac_f32_16x16x64_bf16 v[80:83], v[144:147], a[232:239], v5
 s_waitcnt lgkmcnt(0)
 v_smfmac_f32_16x16x64_bf16 v[80:83], v[156:159], a[240:247], v5
 s_nop 7
 v_pk_add_f32 v[84:85], v[80:81], v[82:83]
 v_cmpx_o_f32 vcc, v84, v85
 buffer_store_dword v84, v15, s[4:7], s52 offen sc1
 buffer_store_dword v85, v15, s[4:7], s52 offen offset:256 sc1
 s_cmp_eq_u64 exec, -1
 s_cbranch_scc0 L_cf_w3_bslow
L_cf_w3_bgood:
 ds_write2st64_b32 v4, v84, v85 offset0:74 offset1:75
 s_add_u32 s56, s59, 262144
 buffer_store_dwordx4 v[50:53], v21, s[4:7], s59 offen
 buffer_store_dwordx4 v[50:53], v21, s[4:7], s56 offen
 buffer_store_dwordx4 v[50:53], v22, s[4:7], s60 offen
 buffer_store_dwordx4 v[50:53], v23, s[4:7], s60 offen offset:1024
 s_waitcnt lgkmcnt(0)
 s_barrier
 s_barrier
 buffer_load_dwordx4 v[104:107], v6, s[4:7], s49 offen offset:3072 sc1
 s_nop 3
 buffer_load_dwordx4 v[100:103], v6, s[4:7], s49 offen offset:2048 sc1
 s_nop 3
 buffer_load_dwordx4 v[96:99], v6, s[4:7], s49 offen offset:1024 sc1
 s_nop 3
 buffer_load_dwordx4 v[92:95], v6, s[4:7], s49 offen offset:0 sc1
 s_branch L_cf_w3_loop
L_cf_w3_dslow:
 v_max_u32 v36, v92, v93
 v_max3_u32 v36, v36, v94, v95
 v_max3_u32 v36, v36, v96, v97
 v_max3_u32 v36, v36, v98, v99
 v_max3_u32 v36, v36, v100, v101
 v_max3_u32 v36, v36, v102, v103
 v_max3_u32 v36, v36, v104, v105
 v_max3_u32 v36, v36, v106, v107
 v_cmp_eq_u32 vcc, -1, v36
 s_cbranch_vccz L_cf_w3_dgood
L_cf_w3_dagain:
 buffer_load_dwordx4 v[104:107], v6, s[4:7], s49 offen offset:3072 sc1
 buffer_load_dwordx4 v[100:103], v6, s[4:7], s49 offen offset:2048 sc1
 buffer_load_dwordx4 v[96:99], v6, s[4:7], s49 offen offset:1024 sc1
 buffer_load_dwordx4 v[92:95], v6, s[4:7], s49 offen offset:0 sc1
 v_mov_b32 v56, 0
 v_mov_b32 v57, 0
 v_mov_b32 v58, 0
 v_mov_b32 v59, 0
 v_mov_b32 v60, 0
 v_mov_b32 v61, 0
 v_mov_b32 v62, 0
 v_mov_b32 v63, 0
 v_mov_b32 v64, 0
 v_mov_b32 v65, 0
 v_mov_b32 v66, 0
 v_mov_b32 v67, 0
 v_mov_b32 v68, 0
 v_mov_b32 v69, 0
 v_mov_b32 v70, 0
 v_mov_b32 v71, 0
 s_add_u32 s58, s58, 1
 s_cmp_gt_u32 s58, 400000
 s_cbranch_scc1 L_done
 s_waitcnt vmcnt(0)
 v_max_u32 v36, v92, v93
 v_max3_u32 v36, v36, v94, v95
 v_max3_u32 v36, v36, v96, v97
 v_max3_u32 v36, v36, v98, v99
 v_max3_u32 v36, v36, v100, v101
 v_max3_u32 v36, v36, v102, v103
 v_max3_u32 v36, v36, v104, v105
 v_max3_u32 v36, v36, v106, v107
 v_cmp_eq_u32 vcc, -1, v36
 s_cbranch_vccnz L_cf_w3_dagain
 s_branch L_cf_w3_dtry
L_cf_w3_bslow:
 s_mov_b64 exec, -1
 v_max_u32 v36, v108, v109
 v_max3_u32 v36, v36, v110, v111
 v_max3_u32 v36, v36, v112, v113
 v_max3_u32 v36, v36, v114, v115
 v_max3_u32 v36, v36, v116, v117
 v_max3_u32 v36, v36, v118, v119
 v_max3_u32 v36, v36, v120, v121
 v_max3_u32 v36, v36, v122, v123
 v_max3_u32 v36, v36, v124, v125
 v_max3_u32 v36, v36, v126, v127
 v_max3_u32 v36, v36, v128, v129
 v_max3_u32 v36, v36, v130, v131
 v_max3_u32 v36, v36, v132, v133
 v_max3_u32 v36, v36, v134, v135
 v_max3_u32 v36, v36, v136, v137
 v_max3_u32 v36, v36, v138, v139
 v_max3_u32 v36, v36, v140, v141
 v_max3_u32 v36, v36, v142, v143
 v_max3_u32 v36, v36, v144, v145
 v_max3_u32 v36, v36, v146, v147
 v_max3_u32 v36, v36, v148, v149
 v_max3_u32 v36, v36, v150, v151
 v_max3_u32 v36, v36, v152, v153
 v_max3_u32 v36, v36, v154, v155
 v_max3_u32 v36, v36, v156, v157
 v_max3_u32 v36, v36, v158, v159
 v_max3_u32 v36, v36, v160, v161
 v_max3_u32 v36, v36, v162, v163
 v_max3_u32 v36, v36, v164, v165
 v_max3_u32 v36, v36, v166, v167
 v_max3_u32 v36, v36, v168, v169
 v_max3_u32 v36, v36, v170, v171
 v_cmp_eq_u32 vcc, -1, v36
 s_cbranch_vccnz L_cf_w3_bagain
 buffer_store_dword v84, v15, s[4:7], s52 offen sc1
 buffer_store_dword v85, v15, s[4:7], s52 offen offset:256 sc1
 s_branch L_cf_w3_bgood
L_cf_w3_bagain:
 v_mov_b32 v80, 0
 v_mov_b32 v81, 0
 v_mov_b32 v82, 0
 v_mov_b32 v83, 0
 s_add_u32 s58, s58, 1
 s_cmp_gt_u32 s58, 400000
 s_cbranch_scc1 L_done
 s_waitcnt lgkmcnt(0)
 s_barrier
 buffer_load_dwordx4 v6, s[4:7], s50 offen offset:3072 sc1 lds
 s_nop 3
 buffer_load_dwordx4 v6, s[4:7], s50 offen offset:2048 sc1 lds
 s_nop 3
 buffer_load_dwordx4 v6, s[4:7], s50 offen offset:1024 sc1 lds
 s_nop 3
 buffer_load_dwordx4 v6, s[4:7], s50 offen offset:0 sc1 lds
 s_branch L_cf_w3_bwait
L_cf_w3_done:
 s_waitcnt vmcnt(0) lgkmcnt(0)
 s_branch L_conv_back
L_conv_full:
 s_load_dwordx16 s[68:83], s[0:1], 64
 s_load_dwordx2 s[84:85], s[0:1], 56
 s_waitcnt lgkmcnt(0)
 s_mul_i32 s94, s26, 21888
 s_add_u32 s94, s94, 65536
 v_and_b32 v64, 63, v0
 s_lshl_b32 s92, s28, 2
 s_add_u32 s92, s92, s26
 s_lshl_b32 s93, s92, 8
 v_lshl_add_u32 v65, v64, 2, s93
 s_lshl_b32 s93, s92, 1
 v_mov_b32 v66, s93
 s_mov_b32 s86, 4194304
 s_mov_b32 s87, 0x20000
 s_mov_b32 s96, 0x05040100
 s_mov_b32 s97, 0x07060302
 s_mov_b32 s98, 0xffff0000
 s_lshl_b32 s93, s28, 3
 global_load_dword v88, v65, s[68:69]
 global_load_dword v89, v65, s[70:71]
 global_load_dword v90, v65, s[72:73]
 global_load_dword v91, v65, s[74:75]
 global_load_dword v92, v65, s[76:77]
 global_load_dword v93, v65, s[78:79]
 global_load_ushort v94, v66, s[80:81]
 s_and_b32 s92, s28, 15
 s_lshl_b32 s92, s92, 18
 s_add_u32 s92, s92, s93
 v_lshrrev_b32 v65, 1, v0
 v_lshlrev_b32 v65, 11, v65
 buffer_load_dword v72, v65, s[84:87], s92 offen sc1
L_conv_front:
 v_and_b32 v67, 15, v64
 v_lshrrev_b32 v68, 4, v64
 v_cvt_f32_u32 v200, v67
 v_mul_f32 v206, 0x41800000, v200
 v_lshl_add_u32 v65, v67, 1, 0
 v_add_u32 v65, 256, v65
 v_and_b32 v66, 3, v67
 v_lshlrev_b32 v66, 2, v66
 v_lshrrev_b32 v69, 2, v67
 v_lshl_add_u32 v66, v69, 8, v66
 v_cmp_gt_u32 vcc, 8, v67
 s_nop 1
 v_cndmask_b32 v65, v66, v65, vcc
 v_cvt_f32_u32 v202, v65
 v_and_b32 v65, 1, v67
 v_lshlrev_b32 v65, 3, v65
 v_lshrrev_b32 v66, 1, v67
 v_min_u32 v66, 4, v66
 v_lshl_add_u32 v65, v66, 8, v65
 v_add_u32 v65, 1024, v65
 v_cvt_f32_u32 v204, v65
 s_waitcnt vmcnt(1)
 v_lshlrev_b32 v95, 16, v94
 v_mul_f32 v95, 0x3fb8aa3b, v95
 v_exp_f32 v95, v95
 s_nop 0
 v_cvt_pk_bf16_f32 v95, v95, v95
 v_and_b32 v95, s98, v95
 v_lshl_add_u32 v65, v64, 5, s94
 v_lshlrev_b32 v96, 16, v88
 v_lshlrev_b32 v97, 16, v89
 v_lshlrev_b32 v98, 16, v90
 v_lshlrev_b32 v99, 16, v91
 v_lshlrev_b32 v100, 16, v92
 v_lshlrev_b32 v101, 16, v93
 v_mul_f32 v96, v95, v96
 v_mul_f32 v97, v95, v97
 v_mul_f32 v98, v95, v98
 v_mul_f32 v99, v95, v99
 v_mul_f32 v104, 0x3fb8aa3b, v96
 v_mul_f32 v105, 0x3e22f983, v97
 v_mul_f32 v106, v100, v98
 v_fma_f32 v106, -v101, v99, v106
 v_mul_f32 v107, v100, v99
 v_fma_f32 v107, v101, v98, v107
 ds_write_b128 v65, v[104:107] offset:4160
 v_and_b32 v96, s98, v88
 v_and_b32 v97, s98, v89
 v_and_b32 v98, s98, v90
 v_and_b32 v99, s98, v91
 v_and_b32 v100, s98, v92
 v_and_b32 v101, s98, v93
 v_mul_f32 v96, v95, v96
 v_mul_f32 v97, v95, v97
 v_mul_f32 v98, v95, v98
 v_mul_f32 v99, v95, v99
 v_mul_f32 v108, 0x3fb8aa3b, v96
 v_mul_f32 v109, 0x3e22f983, v97
 v_mul_f32 v110, v100, v98
 v_fma_f32 v110, -v101, v99, v110
 v_mul_f32 v111, v100, v99
 v_fma_f32 v111, v101, v98, v111
 ds_write_b128 v65, v[108:111] offset:4176
 v_mov_b32 v120, 0
 v_mov_b32 v121, 0
 v_mov_b32 v122, 0
 v_mov_b32 v123, 0
 v_mov_b32 v124, 0
 v_mov_b32 v125, 0
 v_mov_b32 v126, 0
 v_mov_b32 v127, 0
 v_mov_b32 v128, 0
 v_mov_b32 v129, 0
 v_mov_b32 v130, 0
 v_mov_b32 v131, 0
 v_lshl_add_u32 v69, v68, 6, s94
 s_mov_b32 s95, 0
 s_waitcnt lgkmcnt(0)
L_cva_kg0:
 ds_read_b128 v[88:91], v69 offset:4160
 ds_read_b128 v[92:95], v69 offset:4176
 ds_read_b128 v[96:99], v69 offset:4192
 ds_read_b128 v[100:103], v69 offset:4208
 v_add_u32 v69, 256, v69
 s_waitcnt lgkmcnt(3)
 v_pk_mul_f32 v[132:133], v[88:89], v[200:201] op_sel_hi:[1,0]
 v_pk_mul_f32 v[136:137], v[88:89], v[202:203] op_sel_hi:[1,0]
 v_pk_mul_f32 v[140:141], v[88:89], v[204:205] op_sel_hi:[1,0]
 v_pk_mul_f32 v[144:145], v[88:89], v[206:207] op_sel_hi:[1,0]
 v_fract_f32 v133, v133
 v_fract_f32 v137, v137
 v_fract_f32 v141, v141
 v_fract_f32 v145, v145
 v_exp_f32 v132, v132
 v_cos_f32 v134, v133
 v_sin_f32 v135, v133
 v_exp_f32 v136, v136
 v_cos_f32 v138, v137
 v_sin_f32 v139, v137
 v_exp_f32 v140, v140
 v_cos_f32 v142, v141
 v_sin_f32 v143, v141
 v_exp_f32 v144, v144
 v_cos_f32 v146, v145
 v_sin_f32 v147, v145
 v_pk_mul_f32 v[134:135], v[134:135], v[132:133] op_sel_hi:[1,0]
 v_pk_mul_f32 v[138:139], v[138:139], v[136:137] op_sel_hi:[1,0]
 v_pk_mul_f32 v[142:143], v[142:143], v[140:141] op_sel_hi:[1,0]
 v_pk_mul_f32 v[146:147], v[146:147], v[144:145] op_sel_hi:[1,0]
 v_pk_mul_f32 v[144:145], v[146:147], v[90:91] op_sel_hi:[0,1] neg_hi:[0,1]
 v_cvt_pk_bf16_f32 v104, v134, v135
 v_cvt_pk_bf16_f32 v108, v138, v139
 v_cvt_pk_bf16_f32 v112, v142, v143
 v_pk_fma_f32 v[144:145], v[146:147], v[90:91], v[144:145] op_sel:[1,1,0] op_sel_hi:[1,0,1] neg_lo:[0,1,0] neg_hi:[0,1,0]
 v_cvt_pk_bf16_f32 v116, v144, v145
 s_waitcnt lgkmcnt(2)
 v_pk_mul_f32 v[132:133], v[92:93], v[200:201] op_sel_hi:[1,0]
 v_pk_mul_f32 v[136:137], v[92:93], v[202:203] op_sel_hi:[1,0]
 v_pk_mul_f32 v[140:141], v[92:93], v[204:205] op_sel_hi:[1,0]
 v_pk_mul_f32 v[144:145], v[92:93], v[206:207] op_sel_hi:[1,0]
 v_fract_f32 v133, v133
 v_fract_f32 v137, v137
 v_fract_f32 v141, v141
 v_fract_f32 v145, v145
 v_exp_f32 v132, v132
 v_cos_f32 v134, v133
 v_sin_f32 v135, v133
 v_exp_f32 v136, v136
 v_cos_f32 v138, v137
 v_sin_f32 v139, v137
 v_exp_f32 v140, v140
 v_cos_f32 v142, v141
 v_sin_f32 v143, v141
 v_exp_f32 v144, v144
 v_cos_f32 v146, v145
 v_sin_f32 v147, v145
 v_pk_mul_f32 v[134:135], v[134:135], v[132:133] op_sel_hi:[1,0]
 v_pk_mul_f32 v[138:139], v[138:139], v[136:137] op_sel_hi:[1,0]
 v_pk_mul_f32 v[142:143], v[142:143], v[140:141] op_sel_hi:[1,0]
 v_pk_mul_f32 v[146:147], v[146:147], v[144:145] op_sel_hi:[1,0]
 v_pk_mul_f32 v[144:145], v[146:147], v[94:95] op_sel_hi:[0,1] neg_hi:[0,1]
 v_cvt_pk_bf16_f32 v105, v134, v135
 v_cvt_pk_bf16_f32 v109, v138, v139
 v_cvt_pk_bf16_f32 v113, v142, v143
 v_pk_fma_f32 v[144:145], v[146:147], v[94:95], v[144:145] op_sel:[1,1,0] op_sel_hi:[1,0,1] neg_lo:[0,1,0] neg_hi:[0,1,0]
 v_cvt_pk_bf16_f32 v117, v144, v145
 s_waitcnt lgkmcnt(1)
 v_pk_mul_f32 v[132:133], v[96:97], v[200:201] op_sel_hi:[1,0]
 v_pk_mul_f32 v[136:137], v[96:97], v[202:203] op_sel_hi:[1,0]
 v_pk_mul_f32 v[140:141], v[96:97], v[204:205] op_sel_hi:[1,0]
 v_pk_mul_f32 v[144:145], v[96:97], v[206:207] op_sel_hi:[1,0]
 v_fract_f32 v133, v133
 v_fract_f32 v137, v137
 v_fract_f32 v141, v141
 v_fract_f32 v145, v145
 v_exp_f32 v132, v132
 v_cos_f32 v134, v133
 v_sin_f32 v135, v133
 v_exp_f32 v136, v136
 v_cos_f32 v138, v137
 v_sin_f32 v139, v137
 v_exp_f32 v140, v140
 v_cos_f32 v142, v141
 v_sin_f32 v143, v141
 v_exp_f32 v144, v144
 v_cos_f32 v146, v145
 v_sin_f32 v147, v145
 v_pk_mul_f32 v[134:135], v[134:135], v[132:133] op_sel_hi:[1,0]
 v_pk_mul_f32 v[138:139], v[138:139], v[136:137] op_sel_hi:[1,0]
 v_pk_mul_f32 v[142:143], v[142:143], v[140:141] op_sel_hi:[1,0]
 v_pk_mul_f32 v[146:147], v[146:147], v[144:145] op_sel_hi:[1,0]
 v_pk_mul_f32 v[144:145], v[146:147], v[98:99] op_sel_hi:[0,1] neg_hi:[0,1]
 v_cvt_pk_bf16_f32 v106, v134, v135
 v_cvt_pk_bf16_f32 v110, v138, v139
 v_cvt_pk_bf16_f32 v114, v142, v143
 v_pk_fma_f32 v[144:145], v[146:147], v[98:99], v[144:145] op_sel:[1,1,0] op_sel_hi:[1,0,1] neg_lo:[0,1,0] neg_hi:[0,1,0]
 v_cvt_pk_bf16_f32 v118, v144, v145
 s_waitcnt lgkmcnt(0)
 v_pk_mul_f32 v[132:133], v[100:101], v[200:201] op_sel_hi:[1,0]
 v_pk_mul_f32 v[136:137], v[100:101], v[202:203] op_sel_hi:[1,0]
 v_pk_mul_f32 v[140:141], v[100:101], v[204:205] op_sel_hi:[1,0]
 v_pk_mul_f32 v[144:145], v[100:101], v[206:207] op_sel_hi:[1,0]
 v_fract_f32 v133, v133
 v_fract_f32 v137, v137
 v_fract_f32 v141, v141
 v_fract_f32 v145, v145
 v_exp_f32 v132, v132
 v_cos_f32 v134, v133
 v_sin_f32 v135, v133
 v_exp_f32 v136, v136
 v_cos_f32 v138, v137
 v_sin_f32 v139, v137
 v_exp_f32 v140, v140
 v_cos_f32 v142, v141
 v_sin_f32 v143, v141
 v_exp_f32 v144, v144
 v_cos_f32 v146, v145
 v_sin_f32 v147, v145
 v_pk_mul_f32 v[134:135], v[134:135], v[132:133] op_sel_hi:[1,0]
 v_pk_mul_f32 v[138:139], v[138:139], v[136:137] op_sel_hi:[1,0]
 v_pk_mul_f32 v[142:143], v[142:143], v[140:141] op_sel_hi:[1,0]
 v_pk_mul_f32 v[146:147], v[146:147], v[144:145] op_sel_hi:[1,0]
 v_pk_mul_f32 v[144:145], v[146:147], v[102:103] op_sel_hi:[0,1] neg_hi:[0,1]
 v_cvt_pk_bf16_f32 v107, v134, v135
 v_cvt_pk_bf16_f32 v111, v138, v139
 v_cvt_pk_bf16_f32 v115, v142, v143
 v_pk_fma_f32 v[144:145], v[146:147], v[102:103], v[144:145] op_sel:[1,1,0] op_sel_hi:[1,0,1] neg_lo:[0,1,0] neg_hi:[0,1,0]
 v_cvt_pk_bf16_f32 v119, v144, v145
 s_add_u32 s95, s95, 1
 s_cmp_lt_u32 s95, 2
 v_mfma_f32_16x16x32_bf16 v[120:123], v[104:107], v[116:119], v[120:123]
 v_mfma_f32_16x16x32_bf16 v[124:127], v[108:111], v[116:119], v[124:127]
 v_mfma_f32_16x16x32_bf16 v[128:131], v[112:115], v[116:119], v[128:131]
 s_cbranch_scc1 L_cva_kg0
L_cva_kg1:
 ds_read_b128 v[88:91], v69 offset:4160
 ds_read_b128 v[92:95], v69 offset:4176
 ds_read_b128 v[96:99], v69 offset:4192
 ds_read_b128 v[100:103], v69 offset:4208
 v_add_u32 v69, 256, v69
 s_waitcnt lgkmcnt(3)
 v_pk_mul_f32 v[132:133], v[88:89], v[200:201] op_sel_hi:[1,0]
 v_pk_mul_f32 v[136:137], v[88:89], v[202:203] op_sel_hi:[1,0]
 v_pk_mul_f32 v[140:141], v[88:89], v[204:205] op_sel_hi:[1,0]
 v_pk_mul_f32 v[144:145], v[88:89], v[206:207] op_sel_hi:[1,0]
 v_fract_f32 v133, v133
 v_fract_f32 v137, v137
 v_fract_f32 v141, v141
 v_fract_f32 v145, v145
 v_exp_f32 v132, v132
 v_cos_f32 v134, v133
 v_sin_f32 v135, v133
 v_exp_f32 v136, v136
 v_cos_f32 v138, v137
 v_sin_f32 v139, v137
 v_exp_f32 v140, v140
 v_cos_f32 v142, v141
 v_sin_f32 v143, v141
 v_exp_f32 v144, v144
 v_cos_f32 v146, v145
 v_sin_f32 v147, v145
 v_pk_mul_f32 v[134:135], v[134:135], v[132:133] op_sel_hi:[1,0]
 v_pk_mul_f32 v[138:139], v[138:139], v[136:137] op_sel_hi:[1,0]
 v_pk_mul_f32 v[142:143], v[142:143], v[140:141] op_sel_hi:[1,0]
 v_pk_mul_f32 v[146:147], v[146:147], v[144:145] op_sel_hi:[1,0]
 v_pk_mul_f32 v[144:145], v[146:147], v[90:91] op_sel_hi:[0,1] neg_hi:[0,1]
 v_cvt_pk_bf16_f32 v104, v134, v135
 v_cvt_pk_bf16_f32 v108, v138, v139
 v_cvt_pk_bf16_f32 v112, v142, v143
 v_pk_fma_f32 v[144:145], v[146:147], v[90:91], v[144:145] op_sel:[1,1,0] op_sel_hi:[1,0,1] neg_lo:[0,1,0] neg_hi:[0,1,0]
 v_cvt_pk_bf16_f32 v116, v144, v145
 s_waitcnt lgkmcnt(2)
 v_pk_mul_f32 v[132:133], v[92:93], v[200:201] op_sel_hi:[1,0]
 v_pk_mul_f32 v[136:137], v[92:93], v[202:203] op_sel_hi:[1,0]
 v_pk_mul_f32 v[140:141], v[92:93], v[204:205] op_sel_hi:[1,0]
 v_pk_mul_f32 v[144:145], v[92:93], v[206:207] op_sel_hi:[1,0]
 v_fract_f32 v133, v133
 v_fract_f32 v137, v137
 v_fract_f32 v141, v141
 v_fract_f32 v145, v145
 v_exp_f32 v132, v132
 v_cos_f32 v134, v133
 v_sin_f32 v135, v133
 v_exp_f32 v136, v136
 v_cos_f32 v138, v137
 v_sin_f32 v139, v137
 v_exp_f32 v140, v140
 v_cos_f32 v142, v141
 v_sin_f32 v143, v141
 v_exp_f32 v144, v144
 v_cos_f32 v146, v145
 v_sin_f32 v147, v145
 v_pk_mul_f32 v[134:135], v[134:135], v[132:133] op_sel_hi:[1,0]
 v_pk_mul_f32 v[138:139], v[138:139], v[136:137] op_sel_hi:[1,0]
 v_pk_mul_f32 v[142:143], v[142:143], v[140:141] op_sel_hi:[1,0]
 v_pk_mul_f32 v[146:147], v[146:147], v[144:145] op_sel_hi:[1,0]
 v_pk_mul_f32 v[144:145], v[146:147], v[94:95] op_sel_hi:[0,1] neg_hi:[0,1]
 v_cvt_pk_bf16_f32 v105, v134, v135
 v_cvt_pk_bf16_f32 v109, v138, v139
 v_cvt_pk_bf16_f32 v113, v142, v143
 v_pk_fma_f32 v[144:145], v[146:147], v[94:95], v[144:145] op_sel:[1,1,0] op_sel_hi:[1,0,1] neg_lo:[0,1,0] neg_hi:[0,1,0]
 v_cvt_pk_bf16_f32 v117, v144, v145
 s_waitcnt lgkmcnt(1)
 v_pk_mul_f32 v[132:133], v[96:97], v[200:201] op_sel_hi:[1,0]
 v_pk_mul_f32 v[136:137], v[96:97], v[202:203] op_sel_hi:[1,0]
 v_pk_mul_f32 v[140:141], v[96:97], v[204:205] op_sel_hi:[1,0]
 v_pk_mul_f32 v[144:145], v[96:97], v[206:207] op_sel_hi:[1,0]
 v_fract_f32 v133, v133
 v_fract_f32 v137, v137
 v_fract_f32 v141, v141
 v_fract_f32 v145, v145
 v_exp_f32 v132, v132
 v_cos_f32 v134, v133
 v_sin_f32 v135, v133
 v_exp_f32 v136, v136
 v_cos_f32 v138, v137
 v_sin_f32 v139, v137
 v_exp_f32 v140, v140
 v_cos_f32 v142, v141
 v_sin_f32 v143, v141
 v_exp_f32 v144, v144
 v_cos_f32 v146, v145
 v_sin_f32 v147, v145
 v_pk_mul_f32 v[134:135], v[134:135], v[132:133] op_sel_hi:[1,0]
 v_pk_mul_f32 v[138:139], v[138:139], v[136:137] op_sel_hi:[1,0]
 v_pk_mul_f32 v[142:143], v[142:143], v[140:141] op_sel_hi:[1,0]
 v_pk_mul_f32 v[146:147], v[146:147], v[144:145] op_sel_hi:[1,0]
 v_pk_mul_f32 v[144:145], v[146:147], v[98:99] op_sel_hi:[0,1] neg_hi:[0,1]
 v_cvt_pk_bf16_f32 v106, v134, v135
 v_cvt_pk_bf16_f32 v110, v138, v139
 v_cvt_pk_bf16_f32 v114, v142, v143
 v_pk_fma_f32 v[144:145], v[146:147], v[98:99], v[144:145] op_sel:[1,1,0] op_sel_hi:[1,0,1] neg_lo:[0,1,0] neg_hi:[0,1,0]
 v_cvt_pk_bf16_f32 v118, v144, v145
 s_waitcnt lgkmcnt(0)
 v_pk_mul_f32 v[132:133], v[100:101], v[200:201] op_sel_hi:[1,0]
 v_pk_mul_f32 v[136:137], v[100:101], v[202:203] op_sel_hi:[1,0]
 v_pk_mul_f32 v[140:141], v[100:101], v[204:205] op_sel_hi:[1,0]
 v_pk_mul_f32 v[144:145], v[100:101], v[206:207] op_sel_hi:[1,0]
 v_fract_f32 v133, v133
 v_fract_f32 v137, v137
 v_fract_f32 v141, v141
 v_fract_f32 v145, v145
 v_exp_f32 v132, v132
 v_cos_f32 v134, v133
 v_sin_f32 v135, v133
 v_exp_f32 v136, v136
 v_cos_f32 v138, v137
 v_sin_f32 v139, v137
 v_exp_f32 v140, v140
 v_cos_f32 v142, v141
 v_sin_f32 v143, v141
 v_exp_f32 v144, v144
 v_cos_f32 v146, v145
 v_sin_f32 v147, v145
 v_pk_mul_f32 v[134:135], v[134:135], v[132:133] op_sel_hi:[1,0]
 v_pk_mul_f32 v[138:139], v[138:139], v[136:137] op_sel_hi:[1,0]
 v_pk_mul_f32 v[142:143], v[142:143], v[140:141] op_sel_hi:[1,0]
 v_pk_mul_f32 v[146:147], v[146:147], v[144:145] op_sel_hi:[1,0]
 v_pk_mul_f32 v[144:145], v[146:147], v[102:103] op_sel_hi:[0,1] neg_hi:[0,1]
 v_cvt_pk_bf16_f32 v107, v134, v135
 v_cvt_pk_bf16_f32 v111, v138, v139
 v_cvt_pk_bf16_f32 v115, v142, v143
 v_pk_fma_f32 v[144:145], v[146:147], v[102:103], v[144:145] op_sel:[1,1,0] op_sel_hi:[1,0,1] neg_lo:[0,1,0] neg_hi:[0,1,0]
 v_cvt_pk_bf16_f32 v119, v144, v145
 s_add_u32 s95, s95, 1
 s_cmp_lt_u32 s95, 5
 v_mfma_f32_16x16x32_bf16 v[120:123], v[104:107], v[116:119], v[120:123]
 v_mfma_f32_16x16x32_bf16 v[124:127], v[108:111], v[116:119], v[124:127]
 v_mfma_f32_16x16x32_bf16 v[128:131], v[112:115], v[116:119], v[128:131]
 s_cbranch_scc1 L_cva_kg1
L_cva_kg2:
 ds_read_b128 v[88:91], v69 offset:4160
 ds_read_b128 v[92:95], v69 offset:4176
 ds_read_b128 v[96:99], v69 offset:4192
 ds_read_b128 v[100:103], v69 offset:4208
 v_add_u32 v69, 256, v69
 s_waitcnt lgkmcnt(3)
 v_pk_mul_f32 v[132:133], v[88:89], v[200:201] op_sel_hi:[1,0]
 v_pk_mul_f32 v[136:137], v[88:89], v[202:203] op_sel_hi:[1,0]
 v_pk_mul_f32 v[140:141], v[88:89], v[204:205] op_sel_hi:[1,0]
 v_pk_mul_f32 v[144:145], v[88:89], v[206:207] op_sel_hi:[1,0]
 v_fract_f32 v133, v133
 v_fract_f32 v137, v137
 v_fract_f32 v141, v141
 v_fract_f32 v145, v145
 v_exp_f32 v132, v132
 v_cos_f32 v134, v133
 v_sin_f32 v135, v133
 v_exp_f32 v136, v136
 v_cos_f32 v138, v137
 v_sin_f32 v139, v137
 v_exp_f32 v140, v140
 v_cos_f32 v142, v141
 v_sin_f32 v143, v141
 v_exp_f32 v144, v144
 v_cos_f32 v146, v145
 v_sin_f32 v147, v145
 v_pk_mul_f32 v[134:135], v[134:135], v[132:133] op_sel_hi:[1,0]
 v_pk_mul_f32 v[138:139], v[138:139], v[136:137] op_sel_hi:[1,0]
 v_pk_mul_f32 v[142:143], v[142:143], v[140:141] op_sel_hi:[1,0]
 v_pk_mul_f32 v[146:147], v[146:147], v[144:145] op_sel_hi:[1,0]
 v_pk_mul_f32 v[144:145], v[146:147], v[90:91] op_sel_hi:[0,1] neg_hi:[0,1]
 v_cvt_pk_bf16_f32 v104, v134, v135
 v_cvt_pk_bf16_f32 v108, v138, v139
 v_cvt_pk_bf16_f32 v112, v142, v143
 v_pk_fma_f32 v[144:145], v[146:147], v[90:91], v[144:145] op_sel:[1,1,0] op_sel_hi:[1,0,1] neg_lo:[0,1,0] neg_hi:[0,1,0]
 v_cvt_pk_bf16_f32 v116, v144, v145
 s_waitcnt lgkmcnt(2)
 v_pk_mul_f32 v[132:133], v[92:93], v[200:201] op_sel_hi:[1,0]
 v_pk_mul_f32 v[136:137], v[92:93], v[202:203] op_sel_hi:[1,0]
 v_pk_mul_f32 v[140:141], v[92:93], v[204:205] op_sel_hi:[1,0]
 v_pk_mul_f32 v[144:145], v[92:93], v[206:207] op_sel_hi:[1,0]
 v_fract_f32 v133, v133
 v_fract_f32 v137, v137
 v_fract_f32 v141, v141
 v_fract_f32 v145, v145
 v_exp_f32 v132, v132
 v_cos_f32 v134, v133
 v_sin_f32 v135, v133
 v_exp_f32 v136, v136
 v_cos_f32 v138, v137
 v_sin_f32 v139, v137
 v_exp_f32 v140, v140
 v_cos_f32 v142, v141
 v_sin_f32 v143, v141
 v_exp_f32 v144, v144
 v_cos_f32 v146, v145
 v_sin_f32 v147, v145
 v_pk_mul_f32 v[134:135], v[134:135], v[132:133] op_sel_hi:[1,0]
 v_pk_mul_f32 v[138:139], v[138:139], v[136:137] op_sel_hi:[1,0]
 v_pk_mul_f32 v[142:143], v[142:143], v[140:141] op_sel_hi:[1,0]
 v_pk_mul_f32 v[146:147], v[146:147], v[144:145] op_sel_hi:[1,0]
 v_pk_mul_f32 v[144:145], v[146:147], v[94:95] op_sel_hi:[0,1] neg_hi:[0,1]
 v_cvt_pk_bf16_f32 v105, v134, v135
 v_cvt_pk_bf16_f32 v109, v138, v139
 v_cvt_pk_bf16_f32 v113, v142, v143
 v_pk_fma_f32 v[144:145], v[146:147], v[94:95], v[144:145] op_sel:[1,1,0] op_sel_hi:[1,0,1] neg_lo:[0,1,0] neg_hi:[0,1,0]
 v_cvt_pk_bf16_f32 v117, v144, v145
 s_waitcnt lgkmcnt(1)
 v_pk_mul_f32 v[132:133], v[96:97], v[200:201] op_sel_hi:[1,0]
 v_pk_mul_f32 v[136:137], v[96:97], v[202:203] op_sel_hi:[1,0]
 v_pk_mul_f32 v[140:141], v[96:97], v[204:205] op_sel_hi:[1,0]
 v_pk_mul_f32 v[144:145], v[96:97], v[206:207] op_sel_hi:[1,0]
 v_fract_f32 v133, v133
 v_fract_f32 v137, v137
 v_fract_f32 v141, v141
 v_fract_f32 v145, v145
 v_exp_f32 v132, v132
 v_cos_f32 v134, v133
 v_sin_f32 v135, v133
 v_exp_f32 v136, v136
 v_cos_f32 v138, v137
 v_sin_f32 v139, v137
 v_exp_f32 v140, v140
 v_cos_f32 v142, v141
 v_sin_f32 v143, v141
 v_exp_f32 v144, v144
 v_cos_f32 v146, v145
 v_sin_f32 v147, v145
 v_pk_mul_f32 v[134:135], v[134:135], v[132:133] op_sel_hi:[1,0]
 v_pk_mul_f32 v[138:139], v[138:139], v[136:137] op_sel_hi:[1,0]
 v_pk_mul_f32 v[142:143], v[142:143], v[140:141] op_sel_hi:[1,0]
 v_pk_mul_f32 v[146:147], v[146:147], v[144:145] op_sel_hi:[1,0]
 v_pk_mul_f32 v[144:145], v[146:147], v[98:99] op_sel_hi:[0,1] neg_hi:[0,1]
 v_cvt_pk_bf16_f32 v106, v134, v135
 v_cvt_pk_bf16_f32 v110, v138, v139
 v_cvt_pk_bf16_f32 v114, v142, v143
 v_pk_fma_f32 v[144:145], v[146:147], v[98:99], v[144:145] op_sel:[1,1,0] op_sel_hi:[1,0,1] neg_lo:[0,1,0] neg_hi:[0,1,0]
 v_cvt_pk_bf16_f32 v118, v144, v145
 s_waitcnt lgkmcnt(0)
 v_pk_mul_f32 v[132:133], v[100:101], v[200:201] op_sel_hi:[1,0]
 v_pk_mul_f32 v[136:137], v[100:101], v[202:203] op_sel_hi:[1,0]
 v_pk_mul_f32 v[140:141], v[100:101], v[204:205] op_sel_hi:[1,0]
 v_pk_mul_f32 v[144:145], v[100:101], v[206:207] op_sel_hi:[1,0]
 v_fract_f32 v133, v133
 v_fract_f32 v137, v137
 v_fract_f32 v141, v141
 v_fract_f32 v145, v145
 v_exp_f32 v132, v132
 v_cos_f32 v134, v133
 v_sin_f32 v135, v133
 v_exp_f32 v136, v136
 v_cos_f32 v138, v137
 v_sin_f32 v139, v137
 v_exp_f32 v140, v140
 v_cos_f32 v142, v141
 v_sin_f32 v143, v141
 v_exp_f32 v144, v144
 v_cos_f32 v146, v145
 v_sin_f32 v147, v145
 v_pk_mul_f32 v[134:135], v[134:135], v[132:133] op_sel_hi:[1,0]
 v_pk_mul_f32 v[138:139], v[138:139], v[136:137] op_sel_hi:[1,0]
 v_pk_mul_f32 v[142:143], v[142:143], v[140:141] op_sel_hi:[1,0]
 v_pk_mul_f32 v[146:147], v[146:147], v[144:145] op_sel_hi:[1,0]
 v_pk_mul_f32 v[144:145], v[146:147], v[102:103] op_sel_hi:[0,1] neg_hi:[0,1]
 v_cvt_pk_bf16_f32 v107, v134, v135
 v_cvt_pk_bf16_f32 v111, v138, v139
 v_cvt_pk_bf16_f32 v115, v142, v143
 v_pk_fma_f32 v[144:145], v[146:147], v[102:103], v[144:145] op_sel:[1,1,0] op_sel_hi:[1,0,1] neg_lo:[0,1,0] neg_hi:[0,1,0]
 v_cvt_pk_bf16_f32 v119, v144, v145
 s_add_u32 s95, s95, 1
 s_cmp_lt_u32 s95, 8
 v_mfma_f32_16x16x32_bf16 v[120:123], v[104:107], v[116:119], v[120:123]
 v_mfma_f32_16x16x32_bf16 v[124:127], v[108:111], v[116:119], v[124:127]
 v_mfma_f32_16x16x32_bf16 v[128:131], v[112:115], v[116:119], v[128:131]
 s_cbranch_scc1 L_cva_kg2
 v_lshlrev_b32 v65, 5, v67
 v_lshl_add_u32 v65, v68, 3, v65
 v_add_u32 v65, s94, v65
 v_lshlrev_b32 v66, 4, v67
 v_lshl_add_u32 v66, v68, 3, v66
 v_lshlrev_b32 v69, 3, v67
 v_lshl_add_u32 v69, v68, 7, v69
 v_cmp_gt_u32 vcc, 2, v68
 s_nop 1
 v_cndmask_b32 v66, v69, v66, vcc
 v_add_u32 v66, s94, v66
 v_lshlrev_b32 v69, 2, v67
 v_lshl_add_u32 v69, v68, 7, v69
 v_add_u32 v69, s94, v69
 v_cvt_pk_bf16_f32 v132, v120, v121
 v_cvt_pk_bf16_f32 v133, v122, v123
 v_cvt_pk_bf16_f32 v134, v124, v125
 v_cvt_pk_bf16_f32 v135, v126, v127
 v_cvt_pk_bf16_f32 v136, v128, v129
 v_cvt_pk_bf16_f32 v137, v130, v131
 ds_write_b64 v65, v[132:133]
 ds_write_b64 v66, v[134:135] offset:512
 ds_write_b32 v69, v136 offset:1024
 ds_write_b32 v69, v137 offset:1088
L_conv_back:
 s_load_dwordx2 s[90:91], s[0:1], 120
 s_load_dwordx2 s[84:85], s[0:1], 56
 s_mov_b32 s86, 4194304
 s_mov_b32 s87, 0x20000
 v_lshlrev_b32 v70, 14, v0
 s_mul_i32 s94, s26, 21888
 s_add_u32 s94, s94, 65536
 s_mov_b32 s96, 0x05040100
 s_mov_b32 s97, 0x07060302
 s_mov_b32 s98, 0xffff0000
 v_and_b32 v64, 63, v0
 v_lshrrev_b32 v65, 2, v0
 v_mul_u32_u24 v65, 80, v65
 v_and_b32 v66, 3, v0
 v_lshl_add_u32 v69, v66, 4, v65
 v_add_u32 v69, 82256, v69
 v_add_u32 v215, 43776, v69
 s_lshl_b32 s93, s28, 3
 s_waitcnt lgkmcnt(0)
 s_load_dwordx2 s[88:89], s[90:91], s93
 v_lshlrev_b32 v65, 3, v64
 v_sub_u32 v65, 2047, v65
 v_cvt_f32_u32 v66, v65
 s_sub_u32 s92, s94, 34048
 s_waitcnt lgkmcnt(0)
 buffer_load_dwordx2 v[72:73], v70, s[84:87], s93 offen offset:0 sc1
 buffer_load_dwordx2 v[74:75], v70, s[84:87], s93 offen offset:2048 sc1
 v_subrev_f32 v120, 0x0, v66
 v_subrev_f32 v121, 0x3f800000, v66
 v_cvt_pk_bf16_f32 v122, v120, v121
 v_and_b32 v120, 0xffff, v122
 v_lshrrev_b32 v121, 16, v122
 v_lshl_add_u32 v132, v120, 1, s92
 v_lshl_add_u32 v133, v121, 1, s92
 v_subrev_f32 v120, 0x40000000, v66
 v_subrev_f32 v121, 0x40400000, v66
 v_cvt_pk_bf16_f32 v122, v120, v121
 v_and_b32 v120, 0xffff, v122
 v_lshrrev_b32 v121, 16, v122
 v_lshl_add_u32 v134, v120, 1, s92
 v_lshl_add_u32 v135, v121, 1, s92
 v_subrev_f32 v120, 0x40800000, v66
 v_subrev_f32 v121, 0x40a00000, v66
 v_cvt_pk_bf16_f32 v122, v120, v121
 v_and_b32 v120, 0xffff, v122
 v_lshrrev_b32 v121, 16, v122
 v_lshl_add_u32 v136, v120, 1, s92
 v_lshl_add_u32 v137, v121, 1, s92
 v_subrev_f32 v120, 0x40c00000, v66
 v_subrev_f32 v121, 0x40e00000, v66
 v_cvt_pk_bf16_f32 v122, v120, v121
 v_and_b32 v120, 0xffff, v122
 v_lshrrev_b32 v121, 16, v122
 v_lshl_add_u32 v138, v120, 1, s92
 v_lshl_add_u32 v139, v121, 1, s92
 s_waitcnt lgkmcnt(0)
 ds_read_u16 v88, v132
 ds_read_u16 v92, v133
 ds_read_u16 v89, v134
 ds_read_u16 v93, v135
 ds_read_u16 v90, v136
 ds_read_u16 v94, v137
 ds_read_u16 v91, v138
 ds_read_u16 v95, v139
 s_add_u32 s93, s93, 4096
 buffer_load_dwordx2 v[76:77], v70, s[84:87], s93 offen offset:0 sc1
 buffer_load_dwordx2 v[78:79], v70, s[84:87], s93 offen offset:2048 sc1
 v_subrev_f32 v120, 0x44000000, v66
 v_subrev_f32 v121, 0x44004000, v66
 v_cvt_pk_bf16_f32 v122, v120, v121
 v_and_b32 v120, 0xffff, v122
 v_lshrrev_b32 v121, 16, v122
 v_lshl_add_u32 v132, v120, 1, s92
 v_lshl_add_u32 v133, v121, 1, s92
 v_subrev_f32 v120, 0x44008000, v66
 v_subrev_f32 v121, 0x4400c000, v66
 v_cvt_pk_bf16_f32 v122, v120, v121
 v_and_b32 v120, 0xffff, v122
 v_lshrrev_b32 v121, 16, v122
 v_lshl_add_u32 v134, v120, 1, s92
 v_lshl_add_u32 v135, v121, 1, s92
 v_subrev_f32 v120, 0x44010000, v66
 v_subrev_f32 v121, 0x44014000, v66
 v_cvt_pk_bf16_f32 v122, v120, v121
 v_and_b32 v120, 0xffff, v122
 v_lshrrev_b32 v121, 16, v122
 v_lshl_add_u32 v136, v120, 1, s92
 v_lshl_add_u32 v137, v121, 1, s92
 v_subrev_f32 v120, 0x44018000, v66
 v_subrev_f32 v121, 0x4401c000, v66
 v_cvt_pk_bf16_f32 v122, v120, v121
 v_and_b32 v120, 0xffff, v122
 v_lshrrev_b32 v121, 16, v122
 v_lshl_add_u32 v138, v120, 1, s92
 v_lshl_add_u32 v139, v121, 1, s92
 s_waitcnt lgkmcnt(0)
 ds_read_u16 v96, v132
 ds_read_u16 v100, v133
 ds_read_u16 v97, v134
 ds_read_u16 v101, v135
 ds_read_u16 v98, v136
 ds_read_u16 v102, v137
 ds_read_u16 v99, v138
 ds_read_u16 v103, v139
 s_add_u32 s93, s93, 4096
 buffer_load_dwordx2 v[80:81], v70, s[84:87], s93 offen offset:0 sc1
 buffer_load_dwordx2 v[82:83], v70, s[84:87], s93 offen offset:2048 sc1
 v_subrev_f32 v120, 0x44800000, v66
 v_subrev_f32 v121, 0x44802000, v66
 v_cvt_pk_bf16_f32 v122, v120, v121
 v_and_b32 v120, 0xffff, v122
 v_lshrrev_b32 v121, 16, v122
 v_lshl_add_u32 v132, v120, 1, s92
 v_lshl_add_u32 v133, v121, 1, s92
 v_subrev_f32 v120, 0x44804000, v66
 v_subrev_f32 v121, 0x44806000, v66
 v_cvt_pk_bf16_f32 v122, v120, v121
 v_and_b32 v120, 0xffff, v122
 v_lshrrev_b32 v121, 16, v122
 v_lshl_add_u32 v134, v120, 1, s92
 v_lshl_add_u32 v135, v121, 1, s92
 v_subrev_f32 v120, 0x44808000, v66
 v_subrev_f32 v121, 0x4480a000, v66
 v_cvt_pk_bf16_f32 v122, v120, v121
 v_and_b32 v120, 0xffff, v122
 v_lshrrev_b32 v121, 16, v122
 v_lshl_add_u32 v136, v120, 1, s92
 v_lshl_add_u32 v137, v121, 1, s92
 v_subrev_f32 v120, 0x4480c000, v66
 v_subrev_f32 v121, 0x4480e000, v66
 v_cvt_pk_bf16_f32 v122, v120, v121
 v_and_b32 v120, 0xffff, v122
 v_lshrrev_b32 v121, 16, v122
 v_lshl_add_u32 v138, v120, 1, s92
 v_lshl_add_u32 v139, v121, 1, s92
 s_waitcnt lgkmcnt(0)
 ds_read_u16 v104, v132
 ds_read_u16 v108, v133
 ds_read_u16 v105, v134
 ds_read_u16 v109, v135
 ds_read_u16 v106, v136
 ds_read_u16 v110, v137
 ds_read_u16 v107, v138
 ds_read_u16 v111, v139
 s_add_u32 s93, s93, 4096
 buffer_load_dwordx2 v[84:85], v70, s[84:87], s93 offen offset:0 sc1
 buffer_load_dwordx2 v[86:87], v70, s[84:87], s93 offen offset:2048 sc1
 v_subrev_f32 v120, 0x44c00000, v66
 v_subrev_f32 v121, 0x44c02000, v66
 v_cvt_pk_bf16_f32 v122, v120, v121
 v_and_b32 v120, 0xffff, v122
 v_lshrrev_b32 v121, 16, v122
 v_subrev_u32 v122, 1536, v65
 v_min_u32 v122, 128, v122
 v_add_u32 v122, 17024, v122
 v_max_u32 v120, v120, v122
 v_subrev_u32 v122, 1537, v65
 v_min_u32 v122, 128, v122
 v_add_u32 v122, 17024, v122
 v_max_u32 v121, v121, v122
 v_lshl_add_u32 v132, v120, 1, s92
 v_lshl_add_u32 v133, v121, 1, s92
 v_subrev_f32 v120, 0x44c04000, v66
 v_subrev_f32 v121, 0x44c06000, v66
 v_cvt_pk_bf16_f32 v122, v120, v121
 v_and_b32 v120, 0xffff, v122
 v_lshrrev_b32 v121, 16, v122
 v_subrev_u32 v122, 1538, v65
 v_min_u32 v122, 128, v122
 v_add_u32 v122, 17024, v122
 v_max_u32 v120, v120, v122
 v_subrev_u32 v122, 1539, v65
 v_min_u32 v122, 128, v122
 v_add_u32 v122, 17024, v122
 v_max_u32 v121, v121, v122
 v_lshl_add_u32 v134, v120, 1, s92
 v_lshl_add_u32 v135, v121, 1, s92
 v_subrev_f32 v120, 0x44c08000, v66
 v_subrev_f32 v121, 0x44c0a000, v66
 v_cvt_pk_bf16_f32 v122, v120, v121
 v_and_b32 v120, 0xffff, v122
 v_lshrrev_b32 v121, 16, v122
 v_subrev_u32 v122, 1540, v65
 v_min_u32 v122, 128, v122
 v_add_u32 v122, 17024, v122
 v_max_u32 v120, v120, v122
 v_subrev_u32 v122, 1541, v65
 v_min_u32 v122, 128, v122
 v_add_u32 v122, 17024, v122
 v_max_u32 v121, v121, v122
 v_lshl_add_u32 v136, v120, 1, s92
 v_lshl_add_u32 v137, v121, 1, s92
 v_subrev_f32 v120, 0x44c0c000, v66
 v_subrev_f32 v121, 0x44c0e000, v66
 v_cvt_pk_bf16_f32 v122, v120, v121
 v_and_b32 v120, 0xffff, v122
 v_lshrrev_b32 v121, 16, v122
 v_subrev_u32 v122, 1542, v65
 v_min_u32 v122, 128, v122
 v_add_u32 v122, 17024, v122
 v_max_u32 v120, v120, v122
 v_subrev_u32 v122, 1543, v65
 v_min_u32 v122, 128, v122
 v_add_u32 v122, 17024, v122
 v_max_u32 v121, v121, v122
 v_lshl_add_u32 v138, v120, 1, s92
 v_lshl_add_u32 v139, v121, 1, s92
 s_waitcnt lgkmcnt(0)
 ds_read_u16 v112, v132
 ds_read_u16 v116, v133
 ds_read_u16 v113, v134
 ds_read_u16 v117, v135
 ds_read_u16 v114, v136
 ds_read_u16 v118, v137
 ds_read_u16 v115, v138
 ds_read_u16 v119, v139
 v_lshl_add_u32 v65, v64, 4, s94
 v_mov_b32 v120, 0
 v_mov_b32 v121, 0
 v_mov_b32 v122, 0
 v_mov_b32 v123, 0
 v_lshrrev_b32 v66, 2, v64
 v_mul_u32_u24 v66, 4096, v66
 v_add_u32 v66, 4096, v66
 v_cmp_gt_u32 vcc, 16, v64
 v_mov_b32 v67, 16384
 s_nop 0
 v_cndmask_b32 v66, v67, v66, vcc
 v_add_u32 v66, v66, v65
 s_waitcnt lgkmcnt(0)
 s_mov_b64 exec, 0x1fffff
 ds_write_b128 v66, v[120:123]
 s_mov_b64 exec, -1
 v_lshl_or_b32 v88, v92, 16, v88
 v_lshl_or_b32 v89, v93, 16, v89
 v_lshl_or_b32 v90, v94, 16, v90
 v_lshl_or_b32 v91, v95, 16, v91
 ds_write_b128 v65, v[88:91] offset:12480
 v_lshl_or_b32 v96, v100, 16, v96
 v_lshl_or_b32 v97, v101, 16, v97
 v_lshl_or_b32 v98, v102, 16, v98
 v_lshl_or_b32 v99, v103, 16, v99
 ds_write_b128 v65, v[96:99] offset:13504
 v_lshl_or_b32 v104, v108, 16, v104
 v_lshl_or_b32 v105, v109, 16, v105
 v_lshl_or_b32 v106, v110, 16, v106
 v_lshl_or_b32 v107, v111, 16, v107
 ds_write_b128 v65, v[104:107] offset:14528
 v_lshl_or_b32 v112, v116, 16, v112
 v_lshl_or_b32 v113, v117, 16, v113
 v_lshl_or_b32 v114, v118, 16, v114
 v_lshl_or_b32 v115, v119, 16, v115
 ds_write_b128 v65, v[112:115] offset:15552
 s_waitcnt lgkmcnt(0)
 ds_read_b64 v[92:93], v65 offset:12496
 ds_read_b64 v[100:101], v65 offset:13520
 ds_read_b64 v[108:109], v65 offset:14544
 ds_read_b64 v[116:117], v65 offset:15568
 s_waitcnt lgkmcnt(0)
 v_alignbit_b32 v132, v89, v88, 16
 v_mov_b32 v136, v89
 v_alignbit_b32 v140, v90, v89, 16
 v_alignbit_b32 v133, v90, v89, 16
 v_mov_b32 v137, v90
 v_alignbit_b32 v141, v91, v90, 16
 v_alignbit_b32 v134, v91, v90, 16
 v_mov_b32 v138, v91
 v_alignbit_b32 v142, v92, v91, 16
 v_alignbit_b32 v135, v92, v91, 16
 v_mov_b32 v139, v92
 v_alignbit_b32 v143, v93, v92, 16
 ds_write_b128 v65, v[132:135] offset:8320
 ds_write_b128 v65, v[136:139] offset:4160
 ds_write_b128 v65, v[140:143] offset:0
 v_alignbit_b32 v144, v97, v96, 16
 v_mov_b32 v148, v97
 v_alignbit_b32 v152, v98, v97, 16
 v_alignbit_b32 v145, v98, v97, 16
 v_mov_b32 v149, v98
 v_alignbit_b32 v153, v99, v98, 16
 v_alignbit_b32 v146, v99, v98, 16
 v_mov_b32 v150, v99
 v_alignbit_b32 v154, v100, v99, 16
 v_alignbit_b32 v147, v100, v99, 16
 v_mov_b32 v151, v100
 v_alignbit_b32 v155, v101, v100, 16
 ds_write_b128 v65, v[144:147] offset:9344
 ds_write_b128 v65, v[148:151] offset:5184
 ds_write_b128 v65, v[152:155] offset:1024
 v_alignbit_b32 v132, v105, v104, 16
 v_mov_b32 v136, v105
 v_alignbit_b32 v140, v106, v105, 16
 v_alignbit_b32 v133, v106, v105, 16
 v_mov_b32 v137, v106
 v_alignbit_b32 v141, v107, v106, 16
 v_alignbit_b32 v134, v107, v106, 16
 v_mov_b32 v138, v107
 v_alignbit_b32 v142, v108, v107, 16
 v_alignbit_b32 v135, v108, v107, 16
 v_mov_b32 v139, v108
 v_alignbit_b32 v143, v109, v108, 16
 ds_write_b128 v65, v[132:135] offset:10368
 ds_write_b128 v65, v[136:139] offset:6208
 ds_write_b128 v65, v[140:143] offset:2048
 v_alignbit_b32 v144, v113, v112, 16
 v_mov_b32 v148, v113
 v_alignbit_b32 v152, v114, v113, 16
 v_alignbit_b32 v145, v114, v113, 16
 v_mov_b32 v149, v114
 v_alignbit_b32 v153, v115, v114, 16
 v_alignbit_b32 v146, v115, v114, 16
 v_mov_b32 v150, v115
 v_alignbit_b32 v154, v116, v115, 16
 v_alignbit_b32 v147, v116, v115, 16
 v_mov_b32 v151, v116
 v_alignbit_b32 v155, v117, v116, 16
 ds_write_b128 v65, v[144:147] offset:11392
 ds_write_b128 v65, v[148:151] offset:7232
 ds_write_b128 v65, v[152:155] offset:3072
 s_waitcnt lgkmcnt(0)
 s_waitcnt vmcnt(0)
 v_perm_b32 v140, v74, v72, s96
 v_perm_b32 v141, v78, v76, s96
 v_perm_b32 v142, v82, v80, s96
 v_perm_b32 v143, v86, v84, s96
 ds_write_b128 v69, v[140:143] offset:0
 v_perm_b32 v144, v74, v72, s97
 v_perm_b32 v145, v78, v76, s97
 v_perm_b32 v146, v82, v80, s97
 v_perm_b32 v147, v86, v84, s97
 ds_write_b128 v69, v[144:147] offset:21888
 v_perm_b32 v148, v75, v73, s96
 v_perm_b32 v149, v79, v77, s96
 v_perm_b32 v150, v83, v81, s96
 v_perm_b32 v151, v87, v85, s96
 ds_write_b128 v215, v[148:151] offset:0
 v_perm_b32 v152, v75, v73, s97
 v_perm_b32 v153, v79, v77, s97
 v_perm_b32 v154, v83, v81, s97
 v_perm_b32 v155, v87, v85, s97
 ds_write_b128 v215, v[152:155] offset:21888
 s_load_dwordx2 s[84:85], s[0:1], 128
 s_mov_b32 s86, 8388608
 s_waitcnt lgkmcnt(0)
 s_barrier
 v_and_b32 v66, 3, v64
 v_mul_u32_u24 v65, 4160, v66
 v_bfe_u32 v66, v64, 3, 1
 v_bfe_u32 v67, v64, 2, 1
 v_lshl_add_u32 v66, v67, 1, v66
 v_bfe_u32 v67, v64, 4, 1
 v_lshl_add_u32 v66, v67, 2, v66
 v_lshlrev_b32 v66, 3, v66
 v_sub_u32 v65, v65, v66
 v_lshrrev_b32 v67, 5, v64
 v_lshl_add_u32 v65, v67, 4, v65
 s_add_u32 s92, s94, 2040
 v_add_u32 v65, s92, v65
 v_and_b32 v66, 31, v64
 v_mul_u32_u24 v66, 80, v66
 v_lshl_add_u32 v67, v67, 4, v66
 s_add_u32 s92, s94, 16720
 v_add_u32 v67, s92, v67
 v_mov_b32 v214, v67
 v_mov_b32 v68, v67
 s_sub_u32 s93, s92, 80
 v_mov_b32 v88, 0
 v_mov_b32 v89, 0
 v_mov_b32 v90, 0
 v_mov_b32 v91, 0
 v_mov_b32 v92, 0
 v_mov_b32 v93, 0
 v_mov_b32 v94, 0
 v_mov_b32 v95, 0
 v_mov_b32 v96, 0
 v_mov_b32 v97, 0
 v_mov_b32 v98, 0
 v_mov_b32 v99, 0
 v_mov_b32 v100, 0
 v_mov_b32 v101, 0
 v_mov_b32 v102, 0
 v_mov_b32 v103, 0
 v_mov_b32 v104, 0
 v_mov_b32 v105, 0
 v_mov_b32 v106, 0
 v_mov_b32 v107, 0
 v_mov_b32 v108, 0
 v_mov_b32 v109, 0
 v_mov_b32 v110, 0
 v_mov_b32 v111, 0
 v_mov_b32 v112, 0
 v_mov_b32 v113, 0
 v_mov_b32 v114, 0
 v_mov_b32 v115, 0
 v_mov_b32 v116, 0
 v_mov_b32 v117, 0
 v_mov_b32 v118, 0
 v_mov_b32 v119, 0
 ds_read_b64 v[120:121], v65 offset:2080
 ds_read_b64 v[122:123], v65 offset:2088
 ds_read_b128 v[128:131], v67 offset:2592
 ds_read_b128 v[132:135], v68 offset:32
 ds_read_b64 v[124:125], v65 offset:32
 ds_read_b64 v[126:127], v65 offset:40
 s_mov_b32 s95, 0
L_cvb_cv0:
 ds_read_b64 v[136:137], v65 offset:2048
 ds_read_b64 v[138:139], v65 offset:2056
 ds_read_b128 v[144:147], v67 offset:2560
 ds_read_b128 v[148:151], v68 offset:0
 ds_read_b64 v[140:141], v65 offset:0
 ds_read_b64 v[142:143], v65 offset:8
 s_waitcnt lgkmcnt(6)
 v_mfma_f32_32x32x16_bf16 v[104:119], v[120:123], v[128:131], v[104:119]
 v_subrev_u32 v65, 64, v65
 v_subrev_u32 v67, 80, v67
 v_max_i32 v68, s93, v67
 v_mfma_f32_32x32x16_bf16 v[88:103], v[120:123], v[132:135], v[88:103]
 v_mfma_f32_32x32x16_bf16 v[104:119], v[124:127], v[132:135], v[104:119]
 ds_read_b64 v[120:121], v65 offset:2080
 ds_read_b64 v[122:123], v65 offset:2088
 ds_read_b128 v[128:131], v67 offset:2592
 ds_read_b128 v[132:135], v68 offset:32
 ds_read_b64 v[124:125], v65 offset:32
 ds_read_b64 v[126:127], v65 offset:40
 s_waitcnt lgkmcnt(6)
 v_mfma_f32_32x32x16_bf16 v[104:119], v[136:139], v[144:147], v[104:119]
 s_add_u32 s95, s95, 1
 s_cmp_lt_u32 s95, 8
 v_mfma_f32_32x32x16_bf16 v[88:103], v[136:139], v[148:151], v[88:103]
 v_mfma_f32_32x32x16_bf16 v[104:119], v[140:143], v[148:151], v[104:119]
 s_cbranch_scc1 L_cvb_cv0
 s_mov_b32 s95, 0
L_cvb_cv1:
 ds_read_b64 v[136:137], v65 offset:2048
 ds_read_b64 v[138:139], v65 offset:2056
 ds_read_b128 v[144:147], v67 offset:2560
 ds_read_b128 v[148:151], v68 offset:0
 ds_read_b64 v[140:141], v65 offset:0
 ds_read_b64 v[142:143], v65 offset:8
 s_waitcnt lgkmcnt(6)
 v_mfma_f32_32x32x16_bf16 v[104:119], v[120:123], v[128:131], v[104:119]
 v_subrev_u32 v65, 64, v65
 v_subrev_u32 v67, 80, v67
 v_max_i32 v68, s93, v67
 v_mfma_f32_32x32x16_bf16 v[88:103], v[120:123], v[132:135], v[88:103]
 v_mfma_f32_32x32x16_bf16 v[104:119], v[124:127], v[132:135], v[104:119]
 ds_read_b64 v[120:121], v65 offset:2080
 ds_read_b64 v[122:123], v65 offset:2088
 ds_read_b128 v[128:131], v67 offset:2592
 ds_read_b128 v[132:135], v68 offset:32
 ds_read_b64 v[124:125], v65 offset:32
 ds_read_b64 v[126:127], v65 offset:40
 s_waitcnt lgkmcnt(6)
 v_mfma_f32_32x32x16_bf16 v[104:119], v[136:139], v[144:147], v[104:119]
 s_add_u32 s95, s95, 1
 s_cmp_lt_u32 s95, 8
 v_mfma_f32_32x32x16_bf16 v[88:103], v[136:139], v[148:151], v[88:103]
 v_mfma_f32_32x32x16_bf16 v[104:119], v[140:143], v[148:151], v[104:119]
 s_cbranch_scc1 L_cvb_cv1
 s_mov_b32 s95, 0
L_cvb_cv2:
 ds_read_b64 v[136:137], v65 offset:2048
 ds_read_b64 v[138:139], v65 offset:2056
 ds_read_b128 v[144:147], v67 offset:2560
 ds_read_b128 v[148:151], v68 offset:0
 ds_read_b64 v[140:141], v65 offset:0
 ds_read_b64 v[142:143], v65 offset:8
 s_waitcnt lgkmcnt(6)
 v_mfma_f32_32x32x16_bf16 v[104:119], v[120:123], v[128:131], v[104:119]
 v_subrev_u32 v65, 64, v65
 v_subrev_u32 v67, 80, v67
 v_max_i32 v68, s93, v67
 v_mfma_f32_32x32x16_bf16 v[88:103], v[120:123], v[132:135], v[88:103]
 v_mfma_f32_32x32x16_bf16 v[104:119], v[124:127], v[132:135], v[104:119]
 ds_read_b64 v[120:121], v65 offset:2080
 ds_read_b64 v[122:123], v65 offset:2088
 ds_read_b128 v[128:131], v67 offset:2592
 ds_read_b128 v[132:135], v68 offset:32
 ds_read_b64 v[124:125], v65 offset:32
 ds_read_b64 v[126:127], v65 offset:40
 s_waitcnt lgkmcnt(6)
 v_mfma_f32_32x32x16_bf16 v[104:119], v[136:139], v[144:147], v[104:119]
 s_add_u32 s95, s95, 1
 s_cmp_lt_u32 s95, 8
 v_mfma_f32_32x32x16_bf16 v[88:103], v[136:139], v[148:151], v[88:103]
 v_mfma_f32_32x32x16_bf16 v[104:119], v[140:143], v[148:151], v[104:119]
 s_cbranch_scc1 L_cvb_cv2
 s_mov_b32 s95, 0
L_cvb_cv3:
 ds_read_b64 v[136:137], v65 offset:2048
 ds_read_b64 v[138:139], v65 offset:2056
 ds_read_b128 v[144:147], v67 offset:2560
 ds_read_b128 v[148:151], v68 offset:0
 ds_read_b64 v[140:141], v65 offset:0
 ds_read_b64 v[142:143], v65 offset:8
 s_waitcnt lgkmcnt(6)
 v_mfma_f32_32x32x16_bf16 v[104:119], v[120:123], v[128:131], v[104:119]
 v_subrev_u32 v65, 64, v65
 v_subrev_u32 v67, 80, v67
 v_max_i32 v68, s93, v67
 v_mfma_f32_32x32x16_bf16 v[88:103], v[120:123], v[132:135], v[88:103]
 v_mfma_f32_32x32x16_bf16 v[104:119], v[124:127], v[132:135], v[104:119]
 ds_read_b64 v[120:121], v65 offset:2080
 ds_read_b64 v[122:123], v65 offset:2088
 ds_read_b128 v[128:131], v67 offset:2592
 ds_read_b128 v[132:135], v68 offset:32
 ds_read_b64 v[124:125], v65 offset:32
 ds_read_b64 v[126:127], v65 offset:40
 s_waitcnt lgkmcnt(6)
 v_mfma_f32_32x32x16_bf16 v[104:119], v[136:139], v[144:147], v[104:119]
 s_add_u32 s95, s95, 1
 s_cmp_lt_u32 s95, 8
 v_mfma_f32_32x32x16_bf16 v[88:103], v[136:139], v[148:151], v[88:103]
 v_mfma_f32_32x32x16_bf16 v[104:119], v[140:143], v[148:151], v[104:119]
 s_cbranch_scc1 L_cvb_cv3
 s_waitcnt lgkmcnt(0)
 ds_read_b128 v[120:123], v214 offset:0
 ds_read_b128 v[124:127], v214 offset:32
 ds_read_b128 v[128:131], v214 offset:2560
 ds_read_b128 v[132:135], v214 offset:2592
 s_lshl_b32 s92, s26, 4
 s_lshr_b64 s[88:89], s[88:89], s92
 s_lshl_b32 s88, s88, 16
 s_mov_b32 s89, s88
 v_lshlrev_b32 v70, 15, v0
 s_lshl_b32 s93, s28, 3
 s_add_u32 s93, s93, 2048
 s_waitcnt lgkmcnt(0)
 v_lshlrev_b32 v136, 16, v120
 v_and_b32 v137, s98, v120
 v_cvt_pk_bf16_f32 v89, v88, v89
 v_pk_mul_f32 v[136:137], v[136:137], s[88:89]
 v_lshlrev_b32 v88, 16, v89
 v_cvt_pk_bf16_f32 v120, v136, v137
 v_and_b32 v89, s98, v89
 v_lshlrev_b32 v136, 16, v120
 v_and_b32 v137, s98, v120
 v_pk_add_f32 v[88:89], v[88:89], v[136:137]
 v_cvt_pk_bf16_f32 v120, v88, v89
 v_lshlrev_b32 v136, 16, v121
 v_and_b32 v137, s98, v121
 v_cvt_pk_bf16_f32 v91, v90, v91
 v_pk_mul_f32 v[136:137], v[136:137], s[88:89]
 v_lshlrev_b32 v90, 16, v91
 v_cvt_pk_bf16_f32 v121, v136, v137
 v_and_b32 v91, s98, v91
 v_lshlrev_b32 v136, 16, v121
 v_and_b32 v137, s98, v121
 v_pk_add_f32 v[90:91], v[90:91], v[136:137]
 v_cvt_pk_bf16_f32 v121, v90, v91
 v_lshlrev_b32 v136, 16, v122
 v_and_b32 v137, s98, v122
 v_cvt_pk_bf16_f32 v93, v92, v93
 v_pk_mul_f32 v[136:137], v[136:137], s[88:89]
 v_lshlrev_b32 v92, 16, v93
 v_cvt_pk_bf16_f32 v122, v136, v137
 v_and_b32 v93, s98, v93
 v_lshlrev_b32 v136, 16, v122
 v_and_b32 v137, s98, v122
 v_pk_add_f32 v[92:93], v[92:93], v[136:137]
 v_cvt_pk_bf16_f32 v122, v92, v93
 v_lshlrev_b32 v136, 16, v123
 v_and_b32 v137, s98, v123
 v_cvt_pk_bf16_f32 v95, v94, v95
 v_pk_mul_f32 v[136:137], v[136:137], s[88:89]
 v_lshlrev_b32 v94, 16, v95
 v_cvt_pk_bf16_f32 v123, v136, v137
 v_and_b32 v95, s98, v95
 v_lshlrev_b32 v136, 16, v123
 v_and_b32 v137, s98, v123
 v_pk_add_f32 v[94:95], v[94:95], v[136:137]
 v_cvt_pk_bf16_f32 v123, v94, v95
 ds_write_b128 v214, v[120:123] offset:0
 v_lshlrev_b32 v136, 16, v124
 v_and_b32 v137, s98, v124
 v_cvt_pk_bf16_f32 v97, v96, v97
 v_pk_mul_f32 v[136:137], v[136:137], s[88:89]
 v_lshlrev_b32 v96, 16, v97
 v_cvt_pk_bf16_f32 v124, v136, v137
 v_and_b32 v97, s98, v97
 v_lshlrev_b32 v136, 16, v124
 v_and_b32 v137, s98, v124
 v_pk_add_f32 v[96:97], v[96:97], v[136:137]
 v_cvt_pk_bf16_f32 v124, v96, v97
 v_lshlrev_b32 v136, 16, v125
 v_and_b32 v137, s98, v125
 v_cvt_pk_bf16_f32 v99, v98, v99
 v_pk_mul_f32 v[136:137], v[136:137], s[88:89]
 v_lshlrev_b32 v98, 16, v99
 v_cvt_pk_bf16_f32 v125, v136, v137
 v_and_b32 v99, s98, v99
 v_lshlrev_b32 v136, 16, v125
 v_and_b32 v137, s98, v125
 v_pk_add_f32 v[98:99], v[98:99], v[136:137]
 v_cvt_pk_bf16_f32 v125, v98, v99
 v_lshlrev_b32 v136, 16, v126
 v_and_b32 v137, s98, v126
 v_cvt_pk_bf16_f32 v101, v100, v101
 v_pk_mul_f32 v[136:137], v[136:137], s[88:89]
 v_lshlrev_b32 v100, 16, v101
 v_cvt_pk_bf16_f32 v126, v136, v137
 v_and_b32 v101, s98, v101
 v_lshlrev_b32 v136, 16, v126
 v_and_b32 v137, s98, v126
 v_pk_add_f32 v[100:101], v[100:101], v[136:137]
 v_cvt_pk_bf16_f32 v126, v100, v101
 v_lshlrev_b32 v136, 16, v127
 v_and_b32 v137, s98, v127
 v_cvt_pk_bf16_f32 v103, v102, v103
 v_pk_mul_f32 v[136:137], v[136:137], s[88:89]
 v_lshlrev_b32 v102, 16, v103
 v_cvt_pk_bf16_f32 v127, v136, v137
 v_and_b32 v103, s98, v103
 v_lshlrev_b32 v136, 16, v127
 v_and_b32 v137, s98, v127
 v_pk_add_f32 v[102:103], v[102:103], v[136:137]
 v_cvt_pk_bf16_f32 v127, v102, v103
 ds_write_b128 v214, v[124:127] offset:32
 v_lshlrev_b32 v136, 16, v128
 v_and_b32 v137, s98, v128
 v_cvt_pk_bf16_f32 v105, v104, v105
 v_pk_mul_f32 v[136:137], v[136:137], s[88:89]
 v_lshlrev_b32 v104, 16, v105
 v_cvt_pk_bf16_f32 v128, v136, v137
 v_and_b32 v105, s98, v105
 v_lshlrev_b32 v136, 16, v128
 v_and_b32 v137, s98, v128
 v_pk_add_f32 v[104:105], v[104:105], v[136:137]
 v_cvt_pk_bf16_f32 v128, v104, v105
 v_lshlrev_b32 v136, 16, v129
 v_and_b32 v137, s98, v129
 v_cvt_pk_bf16_f32 v107, v106, v107
 v_pk_mul_f32 v[136:137], v[136:137], s[88:89]
 v_lshlrev_b32 v106, 16, v107
 v_cvt_pk_bf16_f32 v129, v136, v137
 v_and_b32 v107, s98, v107
 v_lshlrev_b32 v136, 16, v129
 v_and_b32 v137, s98, v129
 v_pk_add_f32 v[106:107], v[106:107], v[136:137]
 v_cvt_pk_bf16_f32 v129, v106, v107
 v_lshlrev_b32 v136, 16, v130
 v_and_b32 v137, s98, v130
 v_cvt_pk_bf16_f32 v109, v108, v109
 v_pk_mul_f32 v[136:137], v[136:137], s[88:89]
 v_lshlrev_b32 v108, 16, v109
 v_cvt_pk_bf16_f32 v130, v136, v137
 v_and_b32 v109, s98, v109
 v_lshlrev_b32 v136, 16, v130
 v_and_b32 v137, s98, v130
 v_pk_add_f32 v[108:109], v[108:109], v[136:137]
 v_cvt_pk_bf16_f32 v130, v108, v109
 v_lshlrev_b32 v136, 16, v131
 v_and_b32 v137, s98, v131
 v_cvt_pk_bf16_f32 v111, v110, v111
 v_pk_mul_f32 v[136:137], v[136:137], s[88:89]
 v_lshlrev_b32 v110, 16, v111
 v_cvt_pk_bf16_f32 v131, v136, v137
 v_and_b32 v111, s98, v111
 v_lshlrev_b32 v136, 16, v131
 v_and_b32 v137, s98, v131
 v_pk_add_f32 v[110:111], v[110:111], v[136:137]
 v_cvt_pk_bf16_f32 v131, v110, v111
 ds_write_b128 v214, v[128:131] offset:2560
 v_lshlrev_b32 v136, 16, v132
 v_and_b32 v137, s98, v132
 v_cvt_pk_bf16_f32 v113, v112, v113
 v_pk_mul_f32 v[136:137], v[136:137], s[88:89]
 v_lshlrev_b32 v112, 16, v113
 v_cvt_pk_bf16_f32 v132, v136, v137
 v_and_b32 v113, s98, v113
 v_lshlrev_b32 v136, 16, v132
 v_and_b32 v137, s98, v132
 v_pk_add_f32 v[112:113], v[112:113], v[136:137]
 v_cvt_pk_bf16_f32 v132, v112, v113
 v_lshlrev_b32 v136, 16, v133
 v_and_b32 v137, s98, v133
 v_cvt_pk_bf16_f32 v115, v114, v115
 v_pk_mul_f32 v[136:137], v[136:137], s[88:89]
 v_lshlrev_b32 v114, 16, v115
 v_cvt_pk_bf16_f32 v133, v136, v137
 v_and_b32 v115, s98, v115
 v_lshlrev_b32 v136, 16, v133
 v_and_b32 v137, s98, v133
 v_pk_add_f32 v[114:115], v[114:115], v[136:137]
 v_cvt_pk_bf16_f32 v133, v114, v115
 v_lshlrev_b32 v136, 16, v134
 v_and_b32 v137, s98, v134
 v_cvt_pk_bf16_f32 v117, v116, v117
 v_pk_mul_f32 v[136:137], v[136:137], s[88:89]
 v_lshlrev_b32 v116, 16, v117
 v_cvt_pk_bf16_f32 v134, v136, v137
 v_and_b32 v117, s98, v117
 v_lshlrev_b32 v136, 16, v134
 v_and_b32 v137, s98, v134
 v_pk_add_f32 v[116:117], v[116:117], v[136:137]
 v_cvt_pk_bf16_f32 v134, v116, v117
 v_lshlrev_b32 v136, 16, v135
 v_and_b32 v137, s98, v135
 v_cvt_pk_bf16_f32 v119, v118, v119
 v_pk_mul_f32 v[136:137], v[136:137], s[88:89]
 v_lshlrev_b32 v118, 16, v119
 v_cvt_pk_bf16_f32 v135, v136, v137
 v_and_b32 v119, s98, v119
 v_lshlrev_b32 v136, 16, v135
 v_and_b32 v137, s98, v135
 v_pk_add_f32 v[118:119], v[118:119], v[136:137]
 v_cvt_pk_bf16_f32 v135, v118, v119
 ds_write_b128 v214, v[132:135] offset:2592
 s_waitcnt lgkmcnt(0)
 s_barrier
 ds_read_b128 v[88:91], v69 offset:0
 ds_read_b128 v[92:95], v69 offset:21888
 ds_read_b128 v[96:99], v215 offset:0
 ds_read_b128 v[100:103], v215 offset:21888
 s_waitcnt lgkmcnt(0)
 v_perm_b32 v72, v92, v88, s96
 v_perm_b32 v73, v100, v96, s96
 buffer_store_dwordx2 v[72:73], v70, s[84:87], s93 offen
 s_add_u32 s93, s93, 4096
 v_perm_b32 v74, v92, v88, s97
 v_perm_b32 v75, v100, v96, s97
 buffer_store_dwordx2 v[74:75], v70, s[84:87], s93 offen
 s_add_u32 s93, s93, 4096
 v_perm_b32 v76, v93, v89, s96
 v_perm_b32 v77, v101, v97, s96
 buffer_store_dwordx2 v[76:77], v70, s[84:87], s93 offen
 s_add_u32 s93, s93, 4096
 v_perm_b32 v78, v93, v89, s97
 v_perm_b32 v79, v101, v97, s97
 buffer_store_dwordx2 v[78:79], v70, s[84:87], s93 offen
 s_add_u32 s93, s93, 4096
 v_perm_b32 v80, v94, v90, s96
 v_perm_b32 v81, v102, v98, s96
 buffer_store_dwordx2 v[80:81], v70, s[84:87], s93 offen
 s_add_u32 s93, s93, 4096
 v_perm_b32 v82, v94, v90, s97
 v_perm_b32 v83, v102, v98, s97
 buffer_store_dwordx2 v[82:83], v70, s[84:87], s93 offen
 s_add_u32 s93, s93, 4096
 v_perm_b32 v84, v95, v91, s96
 v_perm_b32 v85, v103, v99, s96
 buffer_store_dwordx2 v[84:85], v70, s[84:87], s93 offen
 s_add_u32 s93, s93, 4096
 v_perm_b32 v86, v95, v91, s97
 v_perm_b32 v87, v103, v99, s97
 buffer_store_dwordx2 v[86:87], v70, s[84:87], s93 offen
 s_add_u32 s93, s93, 4096
 s_cmp_eq_u32 s31, 1
 s_cbranch_scc1 L_conv_ret_Q
 s_cmp_eq_u32 s31, 2
 s_cbranch_scc1 L_conv_ret_O
L_done:
L_exit:
 s_endpgm
L_role_K:
 s_mov_b64 s[8:9], s[18:19]
 s_mov_b32 s10, 8388608
 s_mov_b32 s11, 0x20000
 v_and_b32 v1, 63, v0
 v_lshrrev_b32 v12, 4, v1
 v_lshlrev_b32 v12, 13, v12
 v_and_b32 v3, 15, v1
 v_lshl_add_u32 v12, v3, 4, v12
 s_lshl_b32 s44, s25, 8
 s_lshl_b32 s42, s26, 18
 s_add_u32 s44, s44, s42
 s_lshl_b32 s45, s26, 13
 s_add_u32 s45, s45, 67584
 s_add_u32 m0, s45, 0
 s_add_u32 s43, s44, 0
 buffer_load_dwordx4 v12, s[8:11], s43 offen  lds
 s_add_u32 m0, s45, 1024
 s_add_u32 s43, s44, 32768
 buffer_load_dwordx4 v12, s[8:11], s43 offen  lds
 s_add_u32 m0, s45, 2048
 s_add_u32 s43, s44, 65536
 buffer_load_dwordx4 v12, s[8:11], s43 offen  lds
 s_add_u32 m0, s45, 3072
 s_add_u32 s43, s44, 98304
 buffer_load_dwordx4 v12, s[8:11], s43 offen  lds
 s_add_u32 m0, s45, 4096
 s_add_u32 s43, s44, 131072
 buffer_load_dwordx4 v12, s[8:11], s43 offen  lds
 s_add_u32 m0, s45, 5120
 s_add_u32 s43, s44, 163840
 buffer_load_dwordx4 v12, s[8:11], s43 offen  lds
 s_add_u32 m0, s45, 6144
 s_add_u32 s43, s44, 196608
 buffer_load_dwordx4 v12, s[8:11], s43 offen  lds
 s_add_u32 m0, s45, 7168
 s_add_u32 s43, s44, 229376
 buffer_load_dwordx4 v12, s[8:11], s43 offen  lds
 v_and_b32 v1, 63, v0
 v_lshlrev_b32 v2, 4, v1
 v_bfrev_b32 v7, 1
 s_mov_b32 s48, 0
 v_and_b32 v5, 0x13, v1
 v_bfe_u32 v3, v1, 2, 1
 v_lshl_add_u32 v5, v3, 3, v5
 v_bfe_u32 v3, v1, 3, 1
 v_lshl_add_u32 v5, v3, 2, v5
 v_lshrrev_b32 v4, 5, v1
 v_lshlrev_b32 v3, 9, v4
 v_lshl_add_u32 v6, v5, 4, v3
 v_and_b32 v3, 31, v1
 v_mul_u32_u24 v3, 2064, v3
 v_lshl_add_u32 v10, v4, 4, v3
 v_add_u32 v11, 66048, v10
 s_lshr_b32 s50, s25, 3
 s_add_u32 s50, s50, 4
 s_and_b32 s51, s25, 7
 s_lshl_b32 s51, s51, 2
 s_add_u32 s51, s51, s26
 v_lshl_add_u32 v3, v1, 3, s50
 v_cmp_gt_u32 vcc, 48, v3
 s_lshr_b32 s41, s51, 1
 s_lshl_b32 s41, s41, 5
 s_and_b32 s42, s51, 1
 s_add_u32 s41, s41, s42
 s_lshl_b32 s41, s41, 2
 s_add_u32 s55, s41, 3932160
 v_lshl_add_u32 v3, v3, 11, s55
 v_cndmask_b32 v14, v7, v3, vcc
 s_lshl_b32 s41, s25, 7
 s_add_u32 s41, s41, 3735552
 s_lshl_b32 s42, s26, 2
 s_add_u32 s41, s41, s42
 v_mov_b32 v3, s41
 v_cmp_eq_u32 vcc, 0, v1
 v_mov_b32 v9, 0
 s_nop 0
 v_cndmask_b32 v8, v7, v3, vcc
 v_bfe_u32 v13, v1, 2, 2
 v_lshrrev_b32 v3, 5, v1
 v_lshl_add_u32 v13, v3, 3, v13
 v_lshlrev_b32 v13, 8, v13
 v_bfe_u32 v3, v1, 4, 1
 v_lshl_add_u32 v13, v3, 5, v13
 v_and_b32 v3, 1, v1
 v_lshl_add_u32 v13, v3, 4, v13
 v_bfe_u32 v3, v1, 1, 1
 v_lshl_add_u32 v13, v3, 3, v13
 s_lshl_b32 s43, s26, 6
 s_add_u32 s43, s43, 67584
 v_add_u32 v13, s43, v13
 buffer_store_dword v9, v8, s[4:7], 0 offen sc1
 buffer_store_dword v9, v14, s[4:7], 0 offen sc1
 s_add_u32 m0, s45, 32768
 s_add_u32 s43, s44, 1048576
 buffer_load_dwordx4 v12, s[8:11], s43 offen  lds
 s_add_u32 m0, s45, 33792
 s_add_u32 s43, s44, 1081344
 buffer_load_dwordx4 v12, s[8:11], s43 offen  lds
 s_add_u32 m0, s45, 34816
 s_add_u32 s43, s44, 1114112
 buffer_load_dwordx4 v12, s[8:11], s43 offen  lds
 s_add_u32 m0, s45, 35840
 s_add_u32 s43, s44, 1146880
 buffer_load_dwordx4 v12, s[8:11], s43 offen  lds
 s_add_u32 m0, s45, 36864
 s_add_u32 s43, s44, 1179648
 buffer_load_dwordx4 v12, s[8:11], s43 offen  lds
 s_add_u32 m0, s45, 37888
 s_add_u32 s43, s44, 1212416
 buffer_load_dwordx4 v12, s[8:11], s43 offen  lds
 s_add_u32 m0, s45, 38912
 s_add_u32 s43, s44, 1245184
 buffer_load_dwordx4 v12, s[8:11], s43 offen  lds
 s_add_u32 m0, s45, 39936
 s_add_u32 s43, s44, 1277952
 buffer_load_dwordx4 v12, s[8:11], s43 offen  lds
 s_waitcnt vmcnt(10)
 s_barrier
 ds_read_b64_tr_b16 a[0:1], v13 offset:0
 ds_read_b64_tr_b16 a[2:3], v13 offset:1024
 ds_read_b64_tr_b16 a[4:5], v13 offset:4096
 ds_read_b64_tr_b16 a[6:7], v13 offset:5120
 ds_read_b64_tr_b16 a[8:9], v13 offset:8192
 ds_read_b64_tr_b16 a[10:11], v13 offset:9216
 ds_read_b64_tr_b16 a[12:13], v13 offset:12288
 ds_read_b64_tr_b16 a[14:15], v13 offset:13312
 s_waitcnt lgkmcnt(0)
 ds_read_b64_tr_b16 a[16:17], v13 offset:16384
 ds_read_b64_tr_b16 a[18:19], v13 offset:17408
 ds_read_b64_tr_b16 a[20:21], v13 offset:20480
 ds_read_b64_tr_b16 a[22:23], v13 offset:21504
 ds_read_b64_tr_b16 a[24:25], v13 offset:24576
 ds_read_b64_tr_b16 a[26:27], v13 offset:25600
 ds_read_b64_tr_b16 a[28:29], v13 offset:28672
 ds_read_b64_tr_b16 a[30:31], v13 offset:29696
 s_waitcnt lgkmcnt(0)
 s_barrier
 s_add_u32 m0, s45, 0
 s_add_u32 s43, s44, 2097152
 buffer_load_dwordx4 v12, s[8:11], s43 offen  lds
 s_add_u32 m0, s45, 1024
 s_add_u32 s43, s44, 2129920
 buffer_load_dwordx4 v12, s[8:11], s43 offen  lds
 s_add_u32 m0, s45, 2048
 s_add_u32 s43, s44, 2162688
 buffer_load_dwordx4 v12, s[8:11], s43 offen  lds
 s_add_u32 m0, s45, 3072
 s_add_u32 s43, s44, 2195456
 buffer_load_dwordx4 v12, s[8:11], s43 offen  lds
 s_add_u32 m0, s45, 4096
 s_add_u32 s43, s44, 2228224
 buffer_load_dwordx4 v12, s[8:11], s43 offen  lds
 s_add_u32 m0, s45, 5120
 s_add_u32 s43, s44, 2260992
 buffer_load_dwordx4 v12, s[8:11], s43 offen  lds
 s_add_u32 m0, s45, 6144
 s_add_u32 s43, s44, 2293760
 buffer_load_dwordx4 v12, s[8:11], s43 offen  lds
 s_add_u32 m0, s45, 7168
 s_add_u32 s43, s44, 2326528
 buffer_load_dwordx4 v12, s[8:11], s43 offen  lds
 s_waitcnt vmcnt(8)
 s_barrier
 ds_read_b64_tr_b16 a[32:33], v13 offset:32768
 ds_read_b64_tr_b16 a[34:35], v13 offset:33792
 ds_read_b64_tr_b16 a[36:37], v13 offset:36864
 ds_read_b64_tr_b16 a[38:39], v13 offset:37888
 ds_read_b64_tr_b16 a[40:41], v13 offset:40960
 ds_read_b64_tr_b16 a[42:43], v13 offset:41984
 ds_read_b64_tr_b16 a[44:45], v13 offset:45056
 ds_read_b64_tr_b16 a[46:47], v13 offset:46080
 s_waitcnt lgkmcnt(0)
 ds_read_b64_tr_b16 a[48:49], v13 offset:49152
 ds_read_b64_tr_b16 a[50:51], v13 offset:50176
 ds_read_b64_tr_b16 a[52:53], v13 offset:53248
 ds_read_b64_tr_b16 a[54:55], v13 offset:54272
 ds_read_b64_tr_b16 a[56:57], v13 offset:57344
 ds_read_b64_tr_b16 a[58:59], v13 offset:58368
 ds_read_b64_tr_b16 a[60:61], v13 offset:61440
 ds_read_b64_tr_b16 a[62:63], v13 offset:62464
 s_waitcnt lgkmcnt(0)
 s_barrier
 s_add_u32 m0, s45, 32768
 s_add_u32 s43, s44, 3145728
 buffer_load_dwordx4 v12, s[8:11], s43 offen  lds
 s_add_u32 m0, s45, 33792
 s_add_u32 s43, s44, 3178496
 buffer_load_dwordx4 v12, s[8:11], s43 offen  lds
 s_add_u32 m0, s45, 34816
 s_add_u32 s43, s44, 3211264
 buffer_load_dwordx4 v12, s[8:11], s43 offen  lds
 s_add_u32 m0, s45, 35840
 s_add_u32 s43, s44, 3244032
 buffer_load_dwordx4 v12, s[8:11], s43 offen  lds
 s_add_u32 m0, s45, 36864
 s_add_u32 s43, s44, 3276800
 buffer_load_dwordx4 v12, s[8:11], s43 offen  lds
 s_add_u32 m0, s45, 37888
 s_add_u32 s43, s44, 3309568
 buffer_load_dwordx4 v12, s[8:11], s43 offen  lds
 s_add_u32 m0, s45, 38912
 s_add_u32 s43, s44, 3342336
 buffer_load_dwordx4 v12, s[8:11], s43 offen  lds
 s_add_u32 m0, s45, 39936
 s_add_u32 s43, s44, 3375104
 buffer_load_dwordx4 v12, s[8:11], s43 offen  lds
 v_mov_b32 v250, s34
 v_mov_b32 v251, s35
 v_bfrev_b32 v252, 1
 v_cmp_eq_u32 vcc, 64, v0
 s_nop 1
 v_cndmask_b32 v252, v252, 0, vcc
 buffer_atomic_add_x2 v[250:251], v252, s[12:15], s30 offen sc1
 s_waitcnt vmcnt(9)
 s_barrier
 ds_read_b64_tr_b16 a[64:65], v13 offset:0
 ds_read_b64_tr_b16 a[66:67], v13 offset:1024
 ds_read_b64_tr_b16 a[68:69], v13 offset:4096
 ds_read_b64_tr_b16 a[70:71], v13 offset:5120
 ds_read_b64_tr_b16 a[72:73], v13 offset:8192
 ds_read_b64_tr_b16 a[74:75], v13 offset:9216
 ds_read_b64_tr_b16 a[76:77], v13 offset:12288
 ds_read_b64_tr_b16 a[78:79], v13 offset:13312
 s_waitcnt lgkmcnt(0)
 ds_read_b64_tr_b16 a[80:81], v13 offset:16384
 ds_read_b64_tr_b16 a[82:83], v13 offset:17408
 ds_read_b64_tr_b16 a[84:85], v13 offset:20480
 ds_read_b64_tr_b16 a[86:87], v13 offset:21504
 ds_read_b64_tr_b16 a[88:89], v13 offset:24576
 ds_read_b64_tr_b16 a[90:91], v13 offset:25600
 ds_read_b64_tr_b16 a[92:93], v13 offset:28672
 ds_read_b64_tr_b16 a[94:95], v13 offset:29696
 s_waitcnt lgkmcnt(0)
 s_barrier
 s_add_u32 m0, s45, 0
 s_add_u32 s43, s44, 4194304
 buffer_load_dwordx4 v12, s[8:11], s43 offen  lds
 s_add_u32 m0, s45, 1024
 s_add_u32 s43, s44, 4227072
 buffer_load_dwordx4 v12, s[8:11], s43 offen  lds
 s_add_u32 m0, s45, 2048
 s_add_u32 s43, s44, 4259840
 buffer_load_dwordx4 v12, s[8:11], s43 offen  lds
 s_add_u32 m0, s45, 3072
 s_add_u32 s43, s44, 4292608
 buffer_load_dwordx4 v12, s[8:11], s43 offen  lds
 s_add_u32 m0, s45, 4096
 s_add_u32 s43, s44, 4325376
 buffer_load_dwordx4 v12, s[8:11], s43 offen  lds
 s_add_u32 m0, s45, 5120
 s_add_u32 s43, s44, 4358144
 buffer_load_dwordx4 v12, s[8:11], s43 offen  lds
 s_add_u32 m0, s45, 6144
 s_add_u32 s43, s44, 4390912
 buffer_load_dwordx4 v12, s[8:11], s43 offen  lds
 s_add_u32 m0, s45, 7168
 s_add_u32 s43, s44, 4423680
 buffer_load_dwordx4 v12, s[8:11], s43 offen  lds
 s_waitcnt vmcnt(9)
 s_barrier
 ds_read_b64_tr_b16 a[96:97], v13 offset:32768
 ds_read_b64_tr_b16 a[98:99], v13 offset:33792
 ds_read_b64_tr_b16 a[100:101], v13 offset:36864
 ds_read_b64_tr_b16 a[102:103], v13 offset:37888
 ds_read_b64_tr_b16 a[104:105], v13 offset:40960
 ds_read_b64_tr_b16 a[106:107], v13 offset:41984
 ds_read_b64_tr_b16 a[108:109], v13 offset:45056
 ds_read_b64_tr_b16 a[110:111], v13 offset:46080
 s_waitcnt lgkmcnt(0)
 ds_read_b64_tr_b16 a[112:113], v13 offset:49152
 ds_read_b64_tr_b16 a[114:115], v13 offset:50176
 ds_read_b64_tr_b16 a[116:117], v13 offset:53248
 ds_read_b64_tr_b16 a[118:119], v13 offset:54272
 ds_read_b64_tr_b16 a[120:121], v13 offset:57344
 ds_read_b64_tr_b16 a[122:123], v13 offset:58368
 ds_read_b64_tr_b16 a[124:125], v13 offset:61440
 ds_read_b64_tr_b16 a[126:127], v13 offset:62464
 s_waitcnt lgkmcnt(0)
 s_barrier
 s_add_u32 m0, s45, 32768
 s_add_u32 s43, s44, 5242880
 buffer_load_dwordx4 v12, s[8:11], s43 offen  lds
 s_add_u32 m0, s45, 33792
 s_add_u32 s43, s44, 5275648
 buffer_load_dwordx4 v12, s[8:11], s43 offen  lds
 s_add_u32 m0, s45, 34816
 s_add_u32 s43, s44, 5308416
 buffer_load_dwordx4 v12, s[8:11], s43 offen  lds
 s_add_u32 m0, s45, 35840
 s_add_u32 s43, s44, 5341184
 buffer_load_dwordx4 v12, s[8:11], s43 offen  lds
 s_add_u32 m0, s45, 36864
 s_add_u32 s43, s44, 5373952
 buffer_load_dwordx4 v12, s[8:11], s43 offen  lds
 s_add_u32 m0, s45, 37888
 s_add_u32 s43, s44, 5406720
 buffer_load_dwordx4 v12, s[8:11], s43 offen  lds
 s_add_u32 m0, s45, 38912
 s_add_u32 s43, s44, 5439488
 buffer_load_dwordx4 v12, s[8:11], s43 offen  lds
 s_add_u32 m0, s45, 39936
 s_add_u32 s43, s44, 5472256
 buffer_load_dwordx4 v12, s[8:11], s43 offen  lds
 s_waitcnt vmcnt(8)
 s_barrier
 ds_read_b64_tr_b16 a[128:129], v13 offset:0
 ds_read_b64_tr_b16 a[130:131], v13 offset:1024
 ds_read_b64_tr_b16 a[132:133], v13 offset:4096
 ds_read_b64_tr_b16 a[134:135], v13 offset:5120
 ds_read_b64_tr_b16 a[136:137], v13 offset:8192
 ds_read_b64_tr_b16 a[138:139], v13 offset:9216
 ds_read_b64_tr_b16 a[140:141], v13 offset:12288
 ds_read_b64_tr_b16 a[142:143], v13 offset:13312
 s_waitcnt lgkmcnt(0)
 ds_read_b64_tr_b16 a[144:145], v13 offset:16384
 ds_read_b64_tr_b16 a[146:147], v13 offset:17408
 ds_read_b64_tr_b16 a[148:149], v13 offset:20480
 ds_read_b64_tr_b16 a[150:151], v13 offset:21504
 ds_read_b64_tr_b16 a[152:153], v13 offset:24576
 ds_read_b64_tr_b16 a[154:155], v13 offset:25600
 ds_read_b64_tr_b16 a[156:157], v13 offset:28672
 ds_read_b64_tr_b16 a[158:159], v13 offset:29696
 s_waitcnt lgkmcnt(0)
 s_barrier
 s_add_u32 m0, s45, 0
 s_add_u32 s43, s44, 6291456
 buffer_load_dwordx4 v12, s[8:11], s43 offen  lds
 s_add_u32 m0, s45, 1024
 s_add_u32 s43, s44, 6324224
 buffer_load_dwordx4 v12, s[8:11], s43 offen  lds
 s_add_u32 m0, s45, 2048
 s_add_u32 s43, s44, 6356992
 buffer_load_dwordx4 v12, s[8:11], s43 offen  lds
 s_add_u32 m0, s45, 3072
 s_add_u32 s43, s44, 6389760
 buffer_load_dwordx4 v12, s[8:11], s43 offen  lds
 s_add_u32 m0, s45, 4096
 s_add_u32 s43, s44, 6422528
 buffer_load_dwordx4 v12, s[8:11], s43 offen  lds
 s_add_u32 m0, s45, 5120
 s_add_u32 s43, s44, 6455296
 buffer_load_dwordx4 v12, s[8:11], s43 offen  lds
 s_add_u32 m0, s45, 6144
 s_add_u32 s43, s44, 6488064
 buffer_load_dwordx4 v12, s[8:11], s43 offen  lds
 s_add_u32 m0, s45, 7168
 s_add_u32 s43, s44, 6520832
 buffer_load_dwordx4 v12, s[8:11], s43 offen  lds
 s_load_dwordx2 s[36:37], s[0:1], 0
 s_mov_b32 s38, 4194304
 s_mov_b32 s39, 0x20000
 s_lshl_b32 s41, s26, 14
 s_mul_i32 s42, s26, 16512
 s_waitcnt lgkmcnt(0)
 s_add_u32 m0, s42, 0
 s_add_u32 s43, s41, 0
 buffer_load_dwordx4 v2, s[36:39], s43 offen offset:0 lds
 buffer_load_dwordx4 v2, s[36:39], s43 offen offset:1024 lds
 s_add_u32 m0, s42, 2064
 s_add_u32 s43, s41, 2048
 buffer_load_dwordx4 v2, s[36:39], s43 offen offset:0 lds
 buffer_load_dwordx4 v2, s[36:39], s43 offen offset:1024 lds
 s_add_u32 m0, s42, 4128
 s_add_u32 s43, s41, 4096
 buffer_load_dwordx4 v2, s[36:39], s43 offen offset:0 lds
 buffer_load_dwordx4 v2, s[36:39], s43 offen offset:1024 lds
 s_add_u32 m0, s42, 6192
 s_add_u32 s43, s41, 6144
 buffer_load_dwordx4 v2, s[36:39], s43 offen offset:0 lds
 buffer_load_dwordx4 v2, s[36:39], s43 offen offset:1024 lds
 s_add_u32 m0, s42, 8256
 s_add_u32 s43, s41, 8192
 buffer_load_dwordx4 v2, s[36:39], s43 offen offset:0 lds
 buffer_load_dwordx4 v2, s[36:39], s43 offen offset:1024 lds
 s_add_u32 m0, s42, 10320
 s_add_u32 s43, s41, 10240
 buffer_load_dwordx4 v2, s[36:39], s43 offen offset:0 lds
 buffer_load_dwordx4 v2, s[36:39], s43 offen offset:1024 lds
 s_add_u32 m0, s42, 12384
 s_add_u32 s43, s41, 12288
 buffer_load_dwordx4 v2, s[36:39], s43 offen offset:0 lds
 buffer_load_dwordx4 v2, s[36:39], s43 offen offset:1024 lds
 s_add_u32 m0, s42, 14448
 s_add_u32 s43, s41, 14336
 buffer_load_dwordx4 v2, s[36:39], s43 offen offset:0 lds
 buffer_load_dwordx4 v2, s[36:39], s43 offen offset:1024 lds
 s_waitcnt vmcnt(24)
 s_barrier
 ds_read_b64_tr_b16 a[160:161], v13 offset:32768
 ds_read_b64_tr_b16 a[162:163], v13 offset:33792
 ds_read_b64_tr_b16 a[164:165], v13 offset:36864
 ds_read_b64_tr_b16 a[166:167], v13 offset:37888
 ds_read_b64_tr_b16 a[168:169], v13 offset:40960
 ds_read_b64_tr_b16 a[170:171], v13 offset:41984
 ds_read_b64_tr_b16 a[172:173], v13 offset:45056
 ds_read_b64_tr_b16 a[174:175], v13 offset:46080
 s_waitcnt lgkmcnt(0)
 ds_read_b64_tr_b16 a[176:177], v13 offset:49152
 ds_read_b64_tr_b16 a[178:179], v13 offset:50176
 ds_read_b64_tr_b16 a[180:181], v13 offset:53248
 ds_read_b64_tr_b16 a[182:183], v13 offset:54272
 ds_read_b64_tr_b16 a[184:185], v13 offset:57344
 ds_read_b64_tr_b16 a[186:187], v13 offset:58368
 ds_read_b64_tr_b16 a[188:189], v13 offset:61440
 ds_read_b64_tr_b16 a[190:191], v13 offset:62464
 s_waitcnt lgkmcnt(0)
 s_barrier
 s_add_u32 m0, s45, 32768
 s_add_u32 s43, s44, 7340032
 buffer_load_dwordx4 v12, s[8:11], s43 offen  lds
 s_add_u32 m0, s45, 33792
 s_add_u32 s43, s44, 7372800
 buffer_load_dwordx4 v12, s[8:11], s43 offen  lds
 s_add_u32 m0, s45, 34816
 s_add_u32 s43, s44, 7405568
 buffer_load_dwordx4 v12, s[8:11], s43 offen  lds
 s_add_u32 m0, s45, 35840
 s_add_u32 s43, s44, 7438336
 buffer_load_dwordx4 v12, s[8:11], s43 offen  lds
 s_add_u32 m0, s45, 36864
 s_add_u32 s43, s44, 7471104
 buffer_load_dwordx4 v12, s[8:11], s43 offen  lds
 s_add_u32 m0, s45, 37888
 s_add_u32 s43, s44, 7503872
 buffer_load_dwordx4 v12, s[8:11], s43 offen  lds
 s_add_u32 m0, s45, 38912
 s_add_u32 s43, s44, 7536640
 buffer_load_dwordx4 v12, s[8:11], s43 offen  lds
 s_add_u32 m0, s45, 39936
 s_add_u32 s43, s44, 7569408
 buffer_load_dwordx4 v12, s[8:11], s43 offen  lds
 s_waitcnt vmcnt(24)
 s_barrier
 ds_read_b64_tr_b16 a[192:193], v13 offset:0
 ds_read_b64_tr_b16 a[194:195], v13 offset:1024
 ds_read_b64_tr_b16 a[196:197], v13 offset:4096
 ds_read_b64_tr_b16 a[198:199], v13 offset:5120
 ds_read_b64_tr_b16 a[200:201], v13 offset:8192
 ds_read_b64_tr_b16 a[202:203], v13 offset:9216
 ds_read_b64_tr_b16 a[204:205], v13 offset:12288
 ds_read_b64_tr_b16 a[206:207], v13 offset:13312
 s_waitcnt lgkmcnt(0)
 ds_read_b64_tr_b16 a[208:209], v13 offset:16384
 ds_read_b64_tr_b16 a[210:211], v13 offset:17408
 ds_read_b64_tr_b16 a[212:213], v13 offset:20480
 ds_read_b64_tr_b16 a[214:215], v13 offset:21504
 ds_read_b64_tr_b16 a[216:217], v13 offset:24576
 ds_read_b64_tr_b16 a[218:219], v13 offset:25600
 ds_read_b64_tr_b16 a[220:221], v13 offset:28672
 ds_read_b64_tr_b16 a[222:223], v13 offset:29696
 s_waitcnt lgkmcnt(0)
 s_waitcnt vmcnt(0)
 s_barrier
 ds_read_b64_tr_b16 a[224:225], v13 offset:32768
 ds_read_b64_tr_b16 a[226:227], v13 offset:33792
 ds_read_b64_tr_b16 a[228:229], v13 offset:36864
 ds_read_b64_tr_b16 a[230:231], v13 offset:37888
 ds_read_b64_tr_b16 a[232:233], v13 offset:40960
 ds_read_b64_tr_b16 a[234:235], v13 offset:41984
 ds_read_b64_tr_b16 a[236:237], v13 offset:45056
 ds_read_b64_tr_b16 a[238:239], v13 offset:46080
 s_waitcnt lgkmcnt(0)
 ds_read_b64_tr_b16 a[240:241], v13 offset:49152
 ds_read_b64_tr_b16 a[242:243], v13 offset:50176
 ds_read_b64_tr_b16 a[244:245], v13 offset:53248
 ds_read_b64_tr_b16 a[246:247], v13 offset:54272
 ds_read_b64_tr_b16 a[248:249], v13 offset:57344
 ds_read_b64_tr_b16 a[250:251], v13 offset:58368
 ds_read_b64_tr_b16 a[252:253], v13 offset:61440
 ds_read_b64_tr_b16 a[254:255], v13 offset:62464
 s_waitcnt lgkmcnt(0)
 s_barrier
 s_mov_b32 s3, 0
L_rdy_3:
 buffer_load_dwordx4 v[84:87], off, s[12:15], s30 sc1
 s_add_u32 s3, s3, 1
 s_cmp_gt_u32 s3, 400000
 s_cbranch_scc1 L_exit
 s_waitcnt vmcnt(0)
 v_readfirstlane_b32 s32, v84
 v_readfirstlane_b32 s33, v85
 v_readfirstlane_b32 vcc_hi, v86
 s_and_b32 vcc_lo, s32, 0xffff
 s_cmp_lt_u32 vcc_lo, 256
 s_cbranch_scc1 L_rdy_3
 s_cmp_lg_u32 vcc_hi, 0
 s_cbranch_scc1 L_general
 s_load_dwordx2 s[36:37], s[0:1], 0
 s_mov_b32 s38, 4194304
 s_mov_b32 s39, 0x20000
 s_lshl_b32 s44, s26, 14
 s_mul_i32 s45, s26, 16512
 s_lshl_b32 s41, s25, 2
 s_add_u32 s41, s41, s26
 s_lshl_b32 s46, s41, 11
 s_add_u32 s46, s46, 16777216
 s_waitcnt lgkmcnt(0)
 v_mov_b32 v15, 0
 v_and_b32 v255, 1, v1
 v_lshlrev_b32 v255, 2, v255
 s_mov_b32 s56, 0
 s_mov_b32 s57, 0
 s_mov_b32 s58, 0
 s_mov_b32 s59, 0
 s_mov_b32 s60, 0
 s_mov_b32 s61, 0
 s_mov_b32 s62, 0
 s_mov_b32 s63, 0
 s_mov_b32 s64, 0
 s_mov_b32 s65, 0
 s_mov_b32 s66, 0
 s_mov_b32 s67, 0
 s_mov_b32 s68, 0
 s_mov_b32 s69, 0
 s_mov_b32 s70, 0
 s_mov_b32 s71, 0
 s_mov_b32 s40, 0
 s_waitcnt vmcnt(0)
 s_barrier
 ds_read_b128 v[16:19], v10 offset:0
 ds_read_b128 v[20:23], v10 offset:32
 ds_read_b128 v[24:27], v10 offset:64
 ds_read_b128 v[28:31], v10 offset:96
 ds_read_b128 v[32:35], v10 offset:128
 ds_read_b128 v[36:39], v10 offset:160
 s_add_u32 s46, s46, 1073479680
 v_and_b32 v3, 31, v1
 v_lshrrev_b32 v4, 5, v1
 v_lshlrev_b32 v12, 4, v3
 v_lshl_add_u32 v12, v4, 7, v12
 v_cmp_gt_u32 vcc, 8, v3
 v_and_b32 v13, 15, v5
 v_lshlrev_b32 v13, 2, v13
 v_lshl_add_u32 v13, v4, 7, v13
 v_lshrrev_b32 v5, 4, v5
 v_lshl_add_u32 v13, v5, 8, v13
 v_cndmask_b32 v12, v7, v12, vcc
 v_lshlrev_b32 v4, 3, v4
 v_sub_u32 v3, v3, v4
 v_mov_b32 v4, 0xf149f2ca
 v_cmp_gt_i32 vcc, 0, v3
 s_nop 1
 v_cndmask_b32 v232, 0, v4, vcc
 v_cmp_gt_i32 vcc, 1, v3
 s_nop 1
 v_cndmask_b32 v233, 0, v4, vcc
 v_cmp_gt_i32 vcc, 2, v3
 s_nop 1
 v_cndmask_b32 v234, 0, v4, vcc
 v_cmp_gt_i32 vcc, 3, v3
 s_nop 1
 v_cndmask_b32 v235, 0, v4, vcc
 v_cmp_gt_i32 vcc, 4, v3
 s_nop 1
 v_cndmask_b32 v236, 0, v4, vcc
 v_cmp_gt_i32 vcc, 5, v3
 s_nop 1
 v_cndmask_b32 v237, 0, v4, vcc
 v_cmp_gt_i32 vcc, 6, v3
 s_nop 1
 v_cndmask_b32 v238, 0, v4, vcc
 v_cmp_gt_i32 vcc, 7, v3
 s_nop 1
 v_cndmask_b32 v239, 0, v4, vcc
 v_cmp_gt_i32 vcc, 16, v3
 s_nop 1
 v_cndmask_b32 v240, 0, v4, vcc
 v_cmp_gt_i32 vcc, 17, v3
 s_nop 1
 v_cndmask_b32 v241, 0, v4, vcc
 v_cmp_gt_i32 vcc, 18, v3
 s_nop 1
 v_cndmask_b32 v242, 0, v4, vcc
 v_cmp_gt_i32 vcc, 19, v3
 s_nop 1
 v_cndmask_b32 v243, 0, v4, vcc
 v_cmp_gt_i32 vcc, 20, v3
 s_nop 1
 v_cndmask_b32 v244, 0, v4, vcc
 v_cmp_gt_i32 vcc, 21, v3
 s_nop 1
 v_cndmask_b32 v245, 0, v4, vcc
 v_cmp_gt_i32 vcc, 22, v3
 s_nop 1
 v_cndmask_b32 v246, 0, v4, vcc
 v_cmp_gt_i32 vcc, 23, v3
 s_nop 1
 v_cndmask_b32 v247, 0, v4, vcc
 v_mov_b32 v248, 0x3e0293ee
 s_lshl_b32 s47, s51, 7
 s_add_u32 s47, s47, 3739648
 s_mov_b32 s53, 0x40000000
 v_cmp_eq_u32 vcc, 0, v1
 v_mov_b32 v252, 0
 s_nop 0
 v_cndmask_b32 v14, v7, 0, vcc
L_rK_loop:
 s_waitcnt lgkmcnt(5)
 v_mfma_f32_32x32x16_bf16 v[48:63], a[0:3], v[16:19], 0
 ds_read_b128 v[40:43], v10 offset:192
 s_add_u32 s44, s44, 65536
 s_add_u32 m0, s45, 66048
 s_add_u32 s43, s44, 0
 buffer_load_dwordx4 v2, s[36:39], s43 offen offset:0 lds
 s_waitcnt lgkmcnt(5)
 v_mfma_f32_32x32x16_bf16 v[48:63], a[4:7], v[20:23], v[48:63]
 ds_read_b128 v[44:47], v10 offset:224
 s_waitcnt lgkmcnt(5)
 v_mfma_f32_32x32x16_bf16 v[48:63], a[8:11], v[24:27], v[48:63]
 ds_read_b128 v[16:19], v10 offset:256
 buffer_load_dwordx4 v2, s[36:39], s43 offen offset:1024 lds
 s_waitcnt lgkmcnt(5)
 v_mfma_f32_32x32x16_bf16 v[48:63], a[12:15], v[28:31], v[48:63]
 ds_read_b128 v[20:23], v10 offset:288
 s_waitcnt lgkmcnt(5)
 v_mfma_f32_32x32x16_bf16 v[48:63], a[16:19], v[32:35], v[48:63]
 ds_read_b128 v[24:27], v10 offset:320
 s_add_u32 m0, s45, 68112
 s_add_u32 s43, s44, 2048
 buffer_load_dwordx4 v2, s[36:39], s43 offen offset:0 lds
 v_cvt_pk_bf16_f32 v80, v64, v65
 v_cvt_pk_bf16_f32 v81, v66, v67
 s_waitcnt lgkmcnt(5)
 v_mfma_f32_32x32x16_bf16 v[48:63], a[20:23], v[36:39], v[48:63]
 ds_read_b128 v[28:31], v10 offset:352
 v_cvt_pk_bf16_f32 v82, v68, v69
 v_cvt_pk_bf16_f32 v83, v70, v71
 s_waitcnt lgkmcnt(5)
 v_mfma_f32_32x32x16_bf16 v[48:63], a[24:27], v[40:43], v[48:63]
 ds_read_b128 v[32:35], v10 offset:384
 buffer_load_dwordx4 v2, s[36:39], s43 offen offset:1024 lds
 v_cvt_pk_bf16_f32 v84, v72, v73
 v_cvt_pk_bf16_f32 v85, v74, v75
 s_waitcnt lgkmcnt(5)
 v_mfma_f32_32x32x16_bf16 v[48:63], a[28:31], v[44:47], v[48:63]
 ds_read_b128 v[36:39], v10 offset:416
 v_cvt_pk_bf16_f32 v86, v76, v77
 v_cvt_pk_bf16_f32 v87, v78, v79
 s_waitcnt lgkmcnt(5)
 v_mfma_f32_32x32x16_bf16 v[48:63], a[32:35], v[16:19], v[48:63]
 ds_read_b128 v[40:43], v10 offset:448
 s_add_u32 m0, s45, 70176
 s_add_u32 s43, s44, 4096
 buffer_load_dwordx4 v2, s[36:39], s43 offen offset:0 lds
 s_waitcnt lgkmcnt(5)
 v_mfma_f32_32x32x16_bf16 v[48:63], a[36:39], v[20:23], v[48:63]
 ds_read_b128 v[44:47], v10 offset:480
 buffer_store_dwordx4 v[80:83], v2, s[4:7], s46 offen sc1
 s_waitcnt lgkmcnt(5)
 v_mfma_f32_32x32x16_bf16 v[48:63], a[40:43], v[24:27], v[48:63]
 ds_read_b128 v[16:19], v10 offset:512
 buffer_load_dwordx4 v2, s[36:39], s43 offen offset:1024 lds
 s_waitcnt lgkmcnt(5)
 v_mfma_f32_32x32x16_bf16 v[48:63], a[44:47], v[28:31], v[48:63]
 ds_read_b128 v[20:23], v10 offset:544
 buffer_store_dwordx4 v[84:87], v2, s[4:7], s46 offen offset:1024 sc1
 s_add_u32 s46, s46, 0x40000
 s_bitset0_b32 s46, 30
 s_waitcnt lgkmcnt(5)
 v_mfma_f32_32x32x16_bf16 v[48:63], a[48:51], v[32:35], v[48:63]
 ds_read_b128 v[24:27], v10 offset:576
 s_add_u32 m0, s45, 72240
 s_add_u32 s43, s44, 6144
 buffer_load_dwordx4 v2, s[36:39], s43 offen offset:0 lds
 s_waitcnt lgkmcnt(5)
 v_mfma_f32_32x32x16_bf16 v[48:63], a[52:55], v[36:39], v[48:63]
 ds_read_b128 v[28:31], v10 offset:608
 s_load_dwordx4 s[60:63], s[4:5], s47 offset:4096 glc
 s_waitcnt lgkmcnt(5)
 v_mfma_f32_32x32x16_bf16 v[48:63], a[56:59], v[40:43], v[48:63]
 ds_read_b128 v[32:35], v10 offset:640
 buffer_load_dwordx4 v2, s[36:39], s43 offen offset:1024 lds
 s_waitcnt lgkmcnt(5)
 v_mfma_f32_32x32x16_bf16 v[48:63], a[60:63], v[44:47], v[48:63]
 ds_read_b128 v[36:39], v10 offset:672
 s_waitcnt lgkmcnt(5)
 v_mfma_f32_32x32x16_bf16 v[48:63], a[64:67], v[16:19], v[48:63]
 ds_read_b128 v[40:43], v10 offset:704
 s_add_u32 m0, s45, 74304
 s_add_u32 s43, s44, 8192
 buffer_load_dwordx4 v2, s[36:39], s43 offen offset:0 lds
 s_waitcnt lgkmcnt(5)
 v_mfma_f32_32x32x16_bf16 v[48:63], a[68:71], v[20:23], v[48:63]
 ds_read_b128 v[44:47], v10 offset:736
 s_waitcnt lgkmcnt(5)
 v_mfma_f32_32x32x16_bf16 v[48:63], a[72:75], v[24:27], v[48:63]
 ds_read_b128 v[16:19], v10 offset:768
 buffer_load_dwordx4 v2, s[36:39], s43 offen offset:1024 lds
 s_waitcnt lgkmcnt(5)
 v_mfma_f32_32x32x16_bf16 v[48:63], a[76:79], v[28:31], v[48:63]
 ds_read_b128 v[20:23], v10 offset:800
 s_waitcnt lgkmcnt(5)
 v_mfma_f32_32x32x16_bf16 v[48:63], a[80:83], v[32:35], v[48:63]
 ds_read_b128 v[24:27], v10 offset:832
 s_add_u32 m0, s45, 76368
 s_add_u32 s43, s44, 10240
 buffer_load_dwordx4 v2, s[36:39], s43 offen offset:0 lds
 s_waitcnt lgkmcnt(5)
 v_mfma_f32_32x32x16_bf16 v[48:63], a[84:87], v[36:39], v[48:63]
 ds_read_b128 v[28:31], v10 offset:864
 s_waitcnt lgkmcnt(5)
 v_mfma_f32_32x32x16_bf16 v[48:63], a[88:91], v[40:43], v[48:63]
 ds_read_b128 v[32:35], v10 offset:896
 buffer_load_dwordx4 v2, s[36:39], s43 offen offset:1024 lds
 s_waitcnt lgkmcnt(5)
 v_mfma_f32_32x32x16_bf16 v[48:63], a[92:95], v[44:47], v[48:63]
 ds_read_b128 v[36:39], v10 offset:928
 s_waitcnt lgkmcnt(5)
 v_mfma_f32_32x32x16_bf16 v[48:63], a[96:99], v[16:19], v[48:63]
 ds_read_b128 v[40:43], v10 offset:960
 s_add_u32 m0, s45, 78432
 s_add_u32 s43, s44, 12288
 buffer_load_dwordx4 v2, s[36:39], s43 offen offset:0 lds
 s_waitcnt lgkmcnt(5)
 v_mfma_f32_32x32x16_bf16 v[48:63], a[100:103], v[20:23], v[48:63]
 ds_read_b128 v[44:47], v10 offset:992
 s_waitcnt vmcnt(15)
 buffer_store_dword v252, v14, s[4:7], s53 offen sc1
 s_mov_b32 s53, 0x40000000
 s_waitcnt lgkmcnt(5)
 v_mfma_f32_32x32x16_bf16 v[48:63], a[104:107], v[24:27], v[48:63]
 ds_read_b128 v[16:19], v10 offset:1024
 buffer_load_dwordx4 v2, s[36:39], s43 offen offset:1024 lds
 s_waitcnt lgkmcnt(5)
 v_mfma_f32_32x32x16_bf16 v[48:63], a[108:111], v[28:31], v[48:63]
 ds_read_b128 v[20:23], v10 offset:1056
 s_waitcnt lgkmcnt(5)
 v_mfma_f32_32x32x16_bf16 v[48:63], a[112:115], v[32:35], v[48:63]
 ds_read_b128 v[24:27], v10 offset:1088
 s_add_u32 m0, s45, 80496
 s_add_u32 s43, s44, 14336
 buffer_load_dwordx4 v2, s[36:39], s43 offen offset:0 lds
 s_waitcnt lgkmcnt(5)
 v_mfma_f32_32x32x16_bf16 v[48:63], a[116:119], v[36:39], v[48:63]
 ds_read_b128 v[28:31], v10 offset:1120
 s_waitcnt lgkmcnt(5)
 v_mfma_f32_32x32x16_bf16 v[48:63], a[120:123], v[40:43], v[48:63]
 ds_read_b128 v[32:35], v10 offset:1152
 buffer_load_dwordx4 v2, s[36:39], s43 offen offset:1024 lds
 s_waitcnt lgkmcnt(5)
 v_mfma_f32_32x32x16_bf16 v[48:63], a[124:127], v[44:47], v[48:63]
 ds_read_b128 v[36:39], v10 offset:1184
 s_waitcnt lgkmcnt(5)
 v_mfma_f32_32x32x16_bf16 v[48:63], a[128:131], v[16:19], v[48:63]
 ds_read_b128 v[40:43], v10 offset:1216
 s_waitcnt lgkmcnt(5)
 v_mfma_f32_32x32x16_bf16 v[48:63], a[132:135], v[20:23], v[48:63]
 ds_read_b128 v[44:47], v10 offset:1248
 s_waitcnt lgkmcnt(5)
 v_mfma_f32_32x32x16_bf16 v[48:63], a[136:139], v[24:27], v[48:63]
 ds_read_b128 v[16:19], v10 offset:1280
 s_waitcnt lgkmcnt(5)
 v_mfma_f32_32x32x16_bf16 v[48:63], a[140:143], v[28:31], v[48:63]
 ds_read_b128 v[20:23], v10 offset:1312
 s_load_dwordx4 s[56:59], s[4:5], s47 glc
 s_waitcnt lgkmcnt(5)
 v_mfma_f32_32x32x16_bf16 v[48:63], a[144:147], v[32:35], v[48:63]
 ds_read_b128 v[24:27], v10 offset:1344
 s_waitcnt lgkmcnt(5)
 v_mfma_f32_32x32x16_bf16 v[48:63], a[148:151], v[36:39], v[48:63]
 ds_read_b128 v[28:31], v10 offset:1376
 v_mov_b32 v9, s40
 s_waitcnt vmcnt(11)
 buffer_store_dword v9, v8, s[4:7], 0 offen sc1
 s_waitcnt lgkmcnt(5)
 v_mfma_f32_32x32x16_bf16 v[48:63], a[152:155], v[40:43], v[48:63]
 ds_read_b128 v[32:35], v10 offset:1408
 s_waitcnt lgkmcnt(5)
 v_mfma_f32_32x32x16_bf16 v[48:63], a[156:159], v[44:47], v[48:63]
 ds_read_b128 v[36:39], v10 offset:1440
 s_waitcnt lgkmcnt(5)
 v_mfma_f32_32x32x16_bf16 v[48:63], a[160:163], v[16:19], v[48:63]
 ds_read_b128 v[40:43], v10 offset:1472
 s_waitcnt lgkmcnt(5)
 v_mfma_f32_32x32x16_bf16 v[48:63], a[164:167], v[20:23], v[48:63]
 ds_read_b128 v[44:47], v10 offset:1504
 s_waitcnt lgkmcnt(5)
 v_mfma_f32_32x32x16_bf16 v[48:63], a[168:171], v[24:27], v[48:63]
 ds_read_b128 v[16:19], v10 offset:1536
 s_waitcnt lgkmcnt(5)
 v_mfma_f32_32x32x16_bf16 v[48:63], a[172:175], v[28:31], v[48:63]
 ds_read_b128 v[20:23], v10 offset:1568
 s_waitcnt lgkmcnt(5)
 v_mfma_f32_32x32x16_bf16 v[48:63], a[176:179], v[32:35], v[48:63]
 ds_read_b128 v[24:27], v10 offset:1600
 s_waitcnt lgkmcnt(5)
 v_mfma_f32_32x32x16_bf16 v[48:63], a[180:183], v[36:39], v[48:63]
 ds_read_b128 v[28:31], v10 offset:1632
 s_waitcnt lgkmcnt(5)
 v_mfma_f32_32x32x16_bf16 v[48:63], a[184:187], v[40:43], v[48:63]
 ds_read_b128 v[32:35], v10 offset:1664
 s_waitcnt lgkmcnt(5)
 v_mfma_f32_32x32x16_bf16 v[48:63], a[188:191], v[44:47], v[48:63]
 ds_read_b128 v[36:39], v10 offset:1696
 s_waitcnt lgkmcnt(5)
 v_mfma_f32_32x32x16_bf16 v[48:63], a[192:195], v[16:19], v[48:63]
 ds_read_b128 v[40:43], v10 offset:1728
 s_waitcnt lgkmcnt(5)
 v_mfma_f32_32x32x16_bf16 v[48:63], a[196:199], v[20:23], v[48:63]
 ds_read_b128 v[44:47], v10 offset:1760
 s_waitcnt lgkmcnt(5)
 v_mfma_f32_32x32x16_bf16 v[48:63], a[200:203], v[24:27], v[48:63]
 ds_read_b128 v[16:19], v10 offset:1792
 s_waitcnt lgkmcnt(5)
 v_mfma_f32_32x32x16_bf16 v[48:63], a[204:207], v[28:31], v[48:63]
 ds_read_b128 v[20:23], v10 offset:1824
 s_waitcnt lgkmcnt(5)
 v_mfma_f32_32x32x16_bf16 v[48:63], a[208:211], v[32:35], v[48:63]
 ds_read_b128 v[24:27], v10 offset:1856
 s_waitcnt lgkmcnt(5)
 v_mfma_f32_32x32x16_bf16 v[48:63], a[212:215], v[36:39], v[48:63]
 ds_read_b128 v[28:31], v10 offset:1888
 s_waitcnt lgkmcnt(5)
 v_mfma_f32_32x32x16_bf16 v[48:63], a[216:219], v[40:43], v[48:63]
 ds_read_b128 v[32:35], v10 offset:1920
 s_waitcnt lgkmcnt(5)
 v_mfma_f32_32x32x16_bf16 v[48:63], a[220:223], v[44:47], v[48:63]
 ds_read_b128 v[36:39], v10 offset:1952
 s_waitcnt lgkmcnt(5)
 v_mfma_f32_32x32x16_bf16 v[48:63], a[224:227], v[16:19], v[48:63]
 ds_read_b128 v[40:43], v10 offset:1984
 s_waitcnt lgkmcnt(5)
 v_mfma_f32_32x32x16_bf16 v[48:63], a[228:231], v[20:23], v[48:63]
 ds_read_b128 v[44:47], v10 offset:2016
 s_add_u32 s40, s40, 1
 s_mov_b32 s54, 0
 s_waitcnt lgkmcnt(5)
 v_mfma_f32_32x32x16_bf16 v[48:63], a[232:235], v[24:27], v[48:63]
 s_waitcnt lgkmcnt(4)
 v_mfma_f32_32x32x16_bf16 v[48:63], a[236:239], v[28:31], v[48:63]
 s_waitcnt lgkmcnt(0)
 s_waitcnt vmcnt(1)
 s_barrier
 ds_read_b128 v[16:19], v11 offset:0
 ds_read_b128 v[20:23], v11 offset:32
 v_mfma_f32_32x32x16_bf16 v[48:63], a[240:243], v[32:35], v[48:63]
 ds_read_b128 v[24:27], v11 offset:64
 ds_read_b128 v[28:31], v11 offset:96
 v_mfma_f32_32x32x16_bf16 v[48:63], a[244:247], v[36:39], v[48:63]
 ds_read_b128 v[32:35], v11 offset:128
 ds_read_b128 v[36:39], v11 offset:160
 v_mfma_f32_32x32x16_bf16 v[48:63], a[248:251], v[40:43], v[48:63]
 s_min_u32 s52, s56, s57
 s_min_u32 s52, s52, s58
 s_min_u32 s52, s52, s59
 s_min_u32 s52, s52, s60
 v_mfma_f32_32x32x16_bf16 v[48:63], a[252:255], v[44:47], v[48:63]
 s_min_u32 s52, s52, s61
 s_min_u32 s52, s52, s62
 s_min_u32 s52, s52, s63
 s_cmp_gt_u32 s52, s50
 s_cbranch_scc1 L_rK_att
L_rK_ret0:
 s_waitcnt lgkmcnt(5)
 v_mfma_f32_32x32x16_bf16 v[64:79], a[0:3], v[16:19], 0
 ds_read_b128 v[40:43], v11 offset:192
 s_add_u32 s44, s44, 65536
 s_add_u32 m0, s45, 0
 s_add_u32 s43, s44, 0
 buffer_load_dwordx4 v2, s[36:39], s43 offen offset:0 lds
 s_waitcnt lgkmcnt(5)
 v_mfma_f32_32x32x16_bf16 v[64:79], a[4:7], v[20:23], v[64:79]
 ds_read_b128 v[44:47], v11 offset:224
 s_waitcnt lgkmcnt(5)
 v_mfma_f32_32x32x16_bf16 v[64:79], a[8:11], v[24:27], v[64:79]
 ds_read_b128 v[16:19], v11 offset:256
 buffer_load_dwordx4 v2, s[36:39], s43 offen offset:1024 lds
 s_waitcnt lgkmcnt(5)
 v_mfma_f32_32x32x16_bf16 v[64:79], a[12:15], v[28:31], v[64:79]
 ds_read_b128 v[20:23], v11 offset:288
 s_waitcnt lgkmcnt(5)
 v_mfma_f32_32x32x16_bf16 v[64:79], a[16:19], v[32:35], v[64:79]
 ds_read_b128 v[24:27], v11 offset:320
 s_add_u32 m0, s45, 2064
 s_add_u32 s43, s44, 2048
 buffer_load_dwordx4 v2, s[36:39], s43 offen offset:0 lds
 v_cvt_pk_bf16_f32 v80, v48, v49
 v_cvt_pk_bf16_f32 v81, v50, v51
 s_waitcnt lgkmcnt(5)
 v_mfma_f32_32x32x16_bf16 v[64:79], a[20:23], v[36:39], v[64:79]
 ds_read_b128 v[28:31], v11 offset:352
 v_cvt_pk_bf16_f32 v82, v52, v53
 v_cvt_pk_bf16_f32 v83, v54, v55
 s_waitcnt lgkmcnt(5)
 v_mfma_f32_32x32x16_bf16 v[64:79], a[24:27], v[40:43], v[64:79]
 ds_read_b128 v[32:35], v11 offset:384
 buffer_load_dwordx4 v2, s[36:39], s43 offen offset:1024 lds
 v_cvt_pk_bf16_f32 v84, v56, v57
 v_cvt_pk_bf16_f32 v85, v58, v59
 s_waitcnt lgkmcnt(5)
 v_mfma_f32_32x32x16_bf16 v[64:79], a[28:31], v[44:47], v[64:79]
 ds_read_b128 v[36:39], v11 offset:416
 v_cvt_pk_bf16_f32 v86, v60, v61
 v_cvt_pk_bf16_f32 v87, v62, v63
 s_waitcnt lgkmcnt(5)
 v_mfma_f32_32x32x16_bf16 v[64:79], a[32:35], v[16:19], v[64:79]
 ds_read_b128 v[40:43], v11 offset:448
 s_add_u32 m0, s45, 4128
 s_add_u32 s43, s44, 4096
 buffer_load_dwordx4 v2, s[36:39], s43 offen offset:0 lds
 s_waitcnt lgkmcnt(5)
 v_mfma_f32_32x32x16_bf16 v[64:79], a[36:39], v[20:23], v[64:79]
 ds_read_b128 v[44:47], v11 offset:480
 buffer_store_dwordx4 v[80:83], v2, s[4:7], s46 offen sc1
 s_waitcnt lgkmcnt(5)
 v_mfma_f32_32x32x16_bf16 v[64:79], a[40:43], v[24:27], v[64:79]
 ds_read_b128 v[16:19], v11 offset:512
 buffer_load_dwordx4 v2, s[36:39], s43 offen offset:1024 lds
 s_waitcnt lgkmcnt(5)
 v_mfma_f32_32x32x16_bf16 v[64:79], a[44:47], v[28:31], v[64:79]
 ds_read_b128 v[20:23], v11 offset:544
 buffer_store_dwordx4 v[84:87], v2, s[4:7], s46 offen offset:1024 sc1
 s_add_u32 s46, s46, 0x40000
 s_bitset0_b32 s46, 30
 s_waitcnt lgkmcnt(5)
 v_mfma_f32_32x32x16_bf16 v[64:79], a[48:51], v[32:35], v[64:79]
 ds_read_b128 v[24:27], v11 offset:576
 s_add_u32 m0, s45, 6192
 s_add_u32 s43, s44, 6144
 buffer_load_dwordx4 v2, s[36:39], s43 offen offset:0 lds
 s_waitcnt lgkmcnt(5)
 v_mfma_f32_32x32x16_bf16 v[64:79], a[52:55], v[36:39], v[64:79]
 ds_read_b128 v[28:31], v11 offset:608
 s_load_dwordx4 s[60:63], s[4:5], s47 offset:4096 glc
 s_waitcnt lgkmcnt(5)
 v_mfma_f32_32x32x16_bf16 v[64:79], a[56:59], v[40:43], v[64:79]
 ds_read_b128 v[32:35], v11 offset:640
 buffer_load_dwordx4 v2, s[36:39], s43 offen offset:1024 lds
 s_waitcnt lgkmcnt(5)
 v_mfma_f32_32x32x16_bf16 v[64:79], a[60:63], v[44:47], v[64:79]
 ds_read_b128 v[36:39], v11 offset:672
 s_waitcnt lgkmcnt(5)
 v_mfma_f32_32x32x16_bf16 v[64:79], a[64:67], v[16:19], v[64:79]
 ds_read_b128 v[40:43], v11 offset:704
 s_add_u32 m0, s45, 8256
 s_add_u32 s43, s44, 8192
 buffer_load_dwordx4 v2, s[36:39], s43 offen offset:0 lds
 s_waitcnt lgkmcnt(5)
 v_mfma_f32_32x32x16_bf16 v[64:79], a[68:71], v[20:23], v[64:79]
 ds_read_b128 v[44:47], v11 offset:736
 s_waitcnt lgkmcnt(5)
 v_mfma_f32_32x32x16_bf16 v[64:79], a[72:75], v[24:27], v[64:79]
 ds_read_b128 v[16:19], v11 offset:768
 buffer_load_dwordx4 v2, s[36:39], s43 offen offset:1024 lds
 s_waitcnt lgkmcnt(5)
 v_mfma_f32_32x32x16_bf16 v[64:79], a[76:79], v[28:31], v[64:79]
 ds_read_b128 v[20:23], v11 offset:800
 s_waitcnt lgkmcnt(5)
 v_mfma_f32_32x32x16_bf16 v[64:79], a[80:83], v[32:35], v[64:79]
 ds_read_b128 v[24:27], v11 offset:832
 s_add_u32 m0, s45, 10320
 s_add_u32 s43, s44, 10240
 buffer_load_dwordx4 v2, s[36:39], s43 offen offset:0 lds
 s_waitcnt lgkmcnt(5)
 v_mfma_f32_32x32x16_bf16 v[64:79], a[84:87], v[36:39], v[64:79]
 ds_read_b128 v[28:31], v11 offset:864
 s_waitcnt lgkmcnt(5)
 v_mfma_f32_32x32x16_bf16 v[64:79], a[88:91], v[40:43], v[64:79]
 ds_read_b128 v[32:35], v11 offset:896
 buffer_load_dwordx4 v2, s[36:39], s43 offen offset:1024 lds
 s_waitcnt lgkmcnt(5)
 v_mfma_f32_32x32x16_bf16 v[64:79], a[92:95], v[44:47], v[64:79]
 ds_read_b128 v[36:39], v11 offset:928
 s_waitcnt lgkmcnt(5)
 v_mfma_f32_32x32x16_bf16 v[64:79], a[96:99], v[16:19], v[64:79]
 ds_read_b128 v[40:43], v11 offset:960
 s_add_u32 m0, s45, 12384
 s_add_u32 s43, s44, 12288
 buffer_load_dwordx4 v2, s[36:39], s43 offen offset:0 lds
 s_waitcnt lgkmcnt(5)
 v_mfma_f32_32x32x16_bf16 v[64:79], a[100:103], v[20:23], v[64:79]
 ds_read_b128 v[44:47], v11 offset:992
 s_waitcnt vmcnt(15)
 buffer_store_dword v252, v14, s[4:7], s53 offen sc1
 s_mov_b32 s53, 0x40000000
 s_waitcnt lgkmcnt(5)
 v_mfma_f32_32x32x16_bf16 v[64:79], a[104:107], v[24:27], v[64:79]
 ds_read_b128 v[16:19], v11 offset:1024
 buffer_load_dwordx4 v2, s[36:39], s43 offen offset:1024 lds
 s_waitcnt lgkmcnt(5)
 v_mfma_f32_32x32x16_bf16 v[64:79], a[108:111], v[28:31], v[64:79]
 ds_read_b128 v[20:23], v11 offset:1056
 s_waitcnt lgkmcnt(5)
 v_mfma_f32_32x32x16_bf16 v[64:79], a[112:115], v[32:35], v[64:79]
 ds_read_b128 v[24:27], v11 offset:1088
 s_add_u32 m0, s45, 14448
 s_add_u32 s43, s44, 14336
 buffer_load_dwordx4 v2, s[36:39], s43 offen offset:0 lds
 s_waitcnt lgkmcnt(5)
 v_mfma_f32_32x32x16_bf16 v[64:79], a[116:119], v[36:39], v[64:79]
 ds_read_b128 v[28:31], v11 offset:1120
 s_waitcnt lgkmcnt(5)
 v_mfma_f32_32x32x16_bf16 v[64:79], a[120:123], v[40:43], v[64:79]
 ds_read_b128 v[32:35], v11 offset:1152
 buffer_load_dwordx4 v2, s[36:39], s43 offen offset:1024 lds
 s_waitcnt lgkmcnt(5)
 v_mfma_f32_32x32x16_bf16 v[64:79], a[124:127], v[44:47], v[64:79]
 ds_read_b128 v[36:39], v11 offset:1184
 s_waitcnt lgkmcnt(5)
 v_mfma_f32_32x32x16_bf16 v[64:79], a[128:131], v[16:19], v[64:79]
 ds_read_b128 v[40:43], v11 offset:1216
 s_waitcnt lgkmcnt(5)
 v_mfma_f32_32x32x16_bf16 v[64:79], a[132:135], v[20:23], v[64:79]
 ds_read_b128 v[44:47], v11 offset:1248
 s_waitcnt lgkmcnt(5)
 v_mfma_f32_32x32x16_bf16 v[64:79], a[136:139], v[24:27], v[64:79]
 ds_read_b128 v[16:19], v11 offset:1280
 s_waitcnt lgkmcnt(5)
 v_mfma_f32_32x32x16_bf16 v[64:79], a[140:143], v[28:31], v[64:79]
 ds_read_b128 v[20:23], v11 offset:1312
 s_load_dwordx4 s[56:59], s[4:5], s47 glc
 s_waitcnt lgkmcnt(5)
 v_mfma_f32_32x32x16_bf16 v[64:79], a[144:147], v[32:35], v[64:79]
 ds_read_b128 v[24:27], v11 offset:1344
 s_waitcnt lgkmcnt(5)
 v_mfma_f32_32x32x16_bf16 v[64:79], a[148:151], v[36:39], v[64:79]
 ds_read_b128 v[28:31], v11 offset:1376
 v_mov_b32 v9, s40
 s_waitcnt vmcnt(11)
 buffer_store_dword v9, v8, s[4:7], 0 offen sc1
 s_waitcnt lgkmcnt(5)
 v_mfma_f32_32x32x16_bf16 v[64:79], a[152:155], v[40:43], v[64:79]
 ds_read_b128 v[32:35], v11 offset:1408
 s_waitcnt lgkmcnt(5)
 v_mfma_f32_32x32x16_bf16 v[64:79], a[156:159], v[44:47], v[64:79]
 ds_read_b128 v[36:39], v11 offset:1440
 s_waitcnt lgkmcnt(5)
 v_mfma_f32_32x32x16_bf16 v[64:79], a[160:163], v[16:19], v[64:79]
 ds_read_b128 v[40:43], v11 offset:1472
 s_waitcnt lgkmcnt(5)
 v_mfma_f32_32x32x16_bf16 v[64:79], a[164:167], v[20:23], v[64:79]
 ds_read_b128 v[44:47], v11 offset:1504
 s_waitcnt lgkmcnt(5)
 v_mfma_f32_32x32x16_bf16 v[64:79], a[168:171], v[24:27], v[64:79]
 ds_read_b128 v[16:19], v11 offset:1536
 s_waitcnt lgkmcnt(5)
 v_mfma_f32_32x32x16_bf16 v[64:79], a[172:175], v[28:31], v[64:79]
 ds_read_b128 v[20:23], v11 offset:1568
 s_waitcnt lgkmcnt(5)
 v_mfma_f32_32x32x16_bf16 v[64:79], a[176:179], v[32:35], v[64:79]
 ds_read_b128 v[24:27], v11 offset:1600
 s_waitcnt lgkmcnt(5)
 v_mfma_f32_32x32x16_bf16 v[64:79], a[180:183], v[36:39], v[64:79]
 ds_read_b128 v[28:31], v11 offset:1632
 s_waitcnt lgkmcnt(5)
 v_mfma_f32_32x32x16_bf16 v[64:79], a[184:187], v[40:43], v[64:79]
 ds_read_b128 v[32:35], v11 offset:1664
 s_waitcnt lgkmcnt(5)
 v_mfma_f32_32x32x16_bf16 v[64:79], a[188:191], v[44:47], v[64:79]
 ds_read_b128 v[36:39], v11 offset:1696
 s_waitcnt lgkmcnt(5)
 v_mfma_f32_32x32x16_bf16 v[64:79], a[192:195], v[16:19], v[64:79]
 ds_read_b128 v[40:43], v11 offset:1728
 s_waitcnt lgkmcnt(5)
 v_mfma_f32_32x32x16_bf16 v[64:79], a[196:199], v[20:23], v[64:79]
 ds_read_b128 v[44:47], v11 offset:1760
 s_waitcnt lgkmcnt(5)
 v_mfma_f32_32x32x16_bf16 v[64:79], a[200:203], v[24:27], v[64:79]
 ds_read_b128 v[16:19], v11 offset:1792
 s_waitcnt lgkmcnt(5)
 v_mfma_f32_32x32x16_bf16 v[64:79], a[204:207], v[28:31], v[64:79]
 ds_read_b128 v[20:23], v11 offset:1824
 s_waitcnt lgkmcnt(5)
 v_mfma_f32_32x32x16_bf16 v[64:79], a[208:211], v[32:35], v[64:79]
 ds_read_b128 v[24:27], v11 offset:1856
 s_waitcnt lgkmcnt(5)
 v_mfma_f32_32x32x16_bf16 v[64:79], a[212:215], v[36:39], v[64:79]
 ds_read_b128 v[28:31], v11 offset:1888
 s_waitcnt lgkmcnt(5)
 v_mfma_f32_32x32x16_bf16 v[64:79], a[216:219], v[40:43], v[64:79]
 ds_read_b128 v[32:35], v11 offset:1920
 s_waitcnt lgkmcnt(5)
 v_mfma_f32_32x32x16_bf16 v[64:79], a[220:223], v[44:47], v[64:79]
 ds_read_b128 v[36:39], v11 offset:1952
 s_waitcnt lgkmcnt(5)
 v_mfma_f32_32x32x16_bf16 v[64:79], a[224:227], v[16:19], v[64:79]
 ds_read_b128 v[40:43], v11 offset:1984
 s_waitcnt lgkmcnt(5)
 v_mfma_f32_32x32x16_bf16 v[64:79], a[228:231], v[20:23], v[64:79]
 ds_read_b128 v[44:47], v11 offset:2016
 s_add_u32 s40, s40, 1
 s_mov_b32 s54, 1
 s_waitcnt lgkmcnt(5)
 v_mfma_f32_32x32x16_bf16 v[64:79], a[232:235], v[24:27], v[64:79]
 s_waitcnt lgkmcnt(4)
 v_mfma_f32_32x32x16_bf16 v[64:79], a[236:239], v[28:31], v[64:79]
 s_waitcnt lgkmcnt(0)
 s_waitcnt vmcnt(1)
 s_barrier
 ds_read_b128 v[16:19], v10 offset:0
 ds_read_b128 v[20:23], v10 offset:32
 v_mfma_f32_32x32x16_bf16 v[64:79], a[240:243], v[32:35], v[64:79]
 ds_read_b128 v[24:27], v10 offset:64
 ds_read_b128 v[28:31], v10 offset:96
 v_mfma_f32_32x32x16_bf16 v[64:79], a[244:247], v[36:39], v[64:79]
 ds_read_b128 v[32:35], v10 offset:128
 ds_read_b128 v[36:39], v10 offset:160
 v_mfma_f32_32x32x16_bf16 v[64:79], a[248:251], v[40:43], v[64:79]
 s_min_u32 s52, s56, s57
 s_min_u32 s52, s52, s58
 s_min_u32 s52, s52, s59
 s_min_u32 s52, s52, s60
 v_mfma_f32_32x32x16_bf16 v[64:79], a[252:255], v[44:47], v[64:79]
 s_min_u32 s52, s52, s61
 s_min_u32 s52, s52, s62
 s_min_u32 s52, s52, s63
 s_cmp_gt_u32 s52, s50
 s_cbranch_scc1 L_rK_att
L_rK_ret1:
 s_cmp_lt_u32 s40, 64
 s_cbranch_scc1 L_rK_loop
 s_nop 11
 v_cvt_pk_bf16_f32 v80, v64, v65
 v_cvt_pk_bf16_f32 v81, v66, v67
 v_cvt_pk_bf16_f32 v82, v68, v69
 v_cvt_pk_bf16_f32 v83, v70, v71
 v_cvt_pk_bf16_f32 v84, v72, v73
 v_cvt_pk_bf16_f32 v85, v74, v75
 v_cvt_pk_bf16_f32 v86, v76, v77
 v_cvt_pk_bf16_f32 v87, v78, v79
 buffer_store_dwordx4 v[80:83], v2, s[4:7], s46 offen sc1
 buffer_store_dwordx4 v[84:87], v2, s[4:7], s46 offen offset:1024 sc1
 s_add_u32 s46, s46, 0x40000
 v_mov_b32 v9, 64
 s_mov_b32 s54, 2
L_rK_ret2:
 s_waitcnt vmcnt(0) lgkmcnt(0)
 buffer_store_dword v9, v8, s[4:7], 0 offen sc1
 buffer_store_dword v252, v14, s[4:7], s53 offen sc1
 s_mov_b32 s53, 0x40000000
 s_cmp_ge_u32 s50, 64
 s_cbranch_scc1 L_rK_end
L_rK_att:
L_rK_wm1:
 s_min_u32 s52, s56, s57
 s_min_u32 s52, s52, s58
 s_min_u32 s52, s52, s59
 s_max_u32 s41, s50, 1
 s_cmp_ge_u32 s52, s41
 s_cbranch_scc1 L_rK_wm1ok
 s_sleep 12
 s_load_dwordx4 s[56:59], s[4:5], s47 glc
 s_add_u32 s48, s48, 1
 s_cmp_gt_u32 s48, 400000
 s_cbranch_scc1 L_done
 s_waitcnt lgkmcnt(0)
 s_branch L_rK_wm1
L_rK_wm1ok:
 s_lshl_b32 s42, s50, 5
 s_add_u32 s42, s42, s51
 s_lshl_b32 s49, s42, 13
 s_add_u32 s43, s49, 16777216
 buffer_load_dwordx4 v[80:83], v6, s[4:7], s43 offen offset:0 sc1
 buffer_load_dwordx4 v[84:87], v6, s[4:7], s43 offen offset:1024 sc1
 buffer_load_dwordx4 v[88:91], v6, s[4:7], s43 offen offset:2048 sc1
 buffer_load_dwordx4 v[92:95], v6, s[4:7], s43 offen offset:3072 sc1
 s_add_u32 s43, s49, 16781312
 buffer_load_dwordx4 v[96:99], v6, s[4:7], s43 offen offset:0 sc1
 buffer_load_dwordx4 v[100:103], v6, s[4:7], s43 offen offset:1024 sc1
 buffer_load_dwordx4 v[104:107], v6, s[4:7], s43 offen offset:2048 sc1
 buffer_load_dwordx4 v[108:111], v6, s[4:7], s43 offen offset:3072 sc1
L_rK_wq:
 s_min_u32 s41, s60, s61
 s_min_u32 s41, s41, s62
 s_min_u32 s41, s41, s63
 s_cmp_gt_u32 s41, s50
 s_cbranch_scc1 L_rK_wqok
 s_load_dwordx4 s[60:63], s[4:5], s47 offset:4096 glc
 s_add_u32 s48, s48, 1
 s_cmp_gt_u32 s48, 400000
 s_cbranch_scc1 L_done
 s_waitcnt lgkmcnt(0)
 s_branch L_rK_wq
L_rK_wqok:
 s_add_u32 s43, s49, 50331648
 buffer_load_dwordx4 v[144:147], v2, s[4:7], s43 offen offset:0 sc1
 buffer_load_dwordx4 v[148:151], v2, s[4:7], s43 offen offset:1024 sc1
 buffer_load_dwordx4 v[152:155], v2, s[4:7], s43 offen offset:2048 sc1
 buffer_load_dwordx4 v[156:159], v2, s[4:7], s43 offen offset:3072 sc1
 s_add_u32 s43, s49, 50335744
 buffer_load_dwordx4 v[160:163], v2, s[4:7], s43 offen offset:0 sc1
 buffer_load_dwordx4 v[164:167], v2, s[4:7], s43 offen offset:1024 sc1
 buffer_load_dwordx4 v[168:171], v2, s[4:7], s43 offen offset:2048 sc1
 buffer_load_dwordx4 v[172:175], v2, s[4:7], s43 offen offset:3072 sc1
 s_add_u32 s43, s49, 33554432
 buffer_load_dwordx4 v[176:179], v6, s[4:7], s43 offen offset:0 sc1
 buffer_load_dwordx4 v[180:183], v6, s[4:7], s43 offen offset:1024 sc1
 buffer_load_dwordx4 v[184:187], v6, s[4:7], s43 offen offset:2048 sc1
 buffer_load_dwordx4 v[188:191], v6, s[4:7], s43 offen offset:3072 sc1
 s_add_u32 s43, s49, 33558528
 buffer_load_dwordx4 v[192:195], v6, s[4:7], s43 offen offset:0 sc1
 buffer_load_dwordx4 v[196:199], v6, s[4:7], s43 offen offset:1024 sc1
 buffer_load_dwordx4 v[200:203], v6, s[4:7], s43 offen offset:2048 sc1
 buffer_load_dwordx4 v[204:207], v6, s[4:7], s43 offen offset:3072 sc1
L_rK_wm2:
 s_min_u32 s41, s56, s57
 s_min_u32 s41, s41, s58
 s_min_u32 s41, s41, s59
 s_cmp_gt_u32 s41, s50
 s_cbranch_scc1 L_rK_wm2ok
 s_load_dwordx4 s[56:59], s[4:5], s47 glc
 s_add_u32 s48, s48, 1
 s_cmp_gt_u32 s48, 400000
 s_cbranch_scc1 L_done
 s_waitcnt lgkmcnt(0)
 s_branch L_rK_wm2
L_rK_wm2ok:
 s_lshr_b32 s42, s49, 2
 s_add_u32 s43, s42, 4194304
 buffer_load_dwordx4 v[112:115], v12, s[4:7], s43 offen offset:0 sc1
 buffer_load_dwordx4 v[116:119], v12, s[4:7], s43 offen offset:256 sc1
 buffer_load_dwordx4 v[120:123], v12, s[4:7], s43 offen offset:512 sc1
 buffer_load_dwordx4 v[124:127], v12, s[4:7], s43 offen offset:768 sc1
 buffer_load_dwordx4 v[128:131], v12, s[4:7], s43 offen offset:1024 sc1
 buffer_load_dwordx4 v[132:135], v12, s[4:7], s43 offen offset:1280 sc1
 buffer_load_dwordx4 v[136:139], v12, s[4:7], s43 offen offset:1536 sc1
 buffer_load_dwordx4 v[140:143], v12, s[4:7], s43 offen offset:1792 sc1
 s_add_u32 s43, s42, 8388608
 buffer_load_dword v208, v13, s[4:7], s43 offen offset:0 sc1
 buffer_load_dword v209, v13, s[4:7], s43 offen offset:64 sc1
 buffer_load_dword v210, v13, s[4:7], s43 offen offset:512 sc1
 buffer_load_dword v211, v13, s[4:7], s43 offen offset:576 sc1
 buffer_load_dword v212, v13, s[4:7], s43 offen offset:1024 sc1
 buffer_load_dword v213, v13, s[4:7], s43 offen offset:1088 sc1
 buffer_load_dword v214, v13, s[4:7], s43 offen offset:1536 sc1
 buffer_load_dword v215, v13, s[4:7], s43 offen offset:1600 sc1
 s_lshl_b32 s53, s50, 11
 s_add_u32 s53, s53, s55
 s_waitcnt vmcnt(24)
 v_mfma_f32_32x32x16_bf16 v[216:231], v[80:83], v[144:147], v[232:247]
 v_mfma_f32_32x32x16_bf16 v[216:231], v[84:87], v[148:151], v[216:231]
 v_mfma_f32_32x32x16_bf16 v[216:231], v[88:91], v[152:155], v[216:231]
 v_mfma_f32_32x32x16_bf16 v[216:231], v[92:95], v[156:159], v[216:231]
 v_mfma_f32_32x32x16_bf16 v[216:231], v[96:99], v[160:163], v[216:231]
 v_mfma_f32_32x32x16_bf16 v[216:231], v[100:103], v[164:167], v[216:231]
 v_mfma_f32_32x32x16_bf16 v[216:231], v[104:107], v[168:171], v[216:231]
 v_mfma_f32_32x32x16_bf16 v[216:231], v[108:111], v[172:175], v[216:231]
 s_waitcnt vmcnt(8)
 v_mfma_f32_32x32x16_bf16 v[80:95], v[112:115], v[144:147], 0
 v_mfma_f32_32x32x16_bf16 v[80:95], v[116:119], v[148:151], v[80:95]
 v_mfma_f32_32x32x16_bf16 v[80:95], v[120:123], v[152:155], v[80:95]
 v_mfma_f32_32x32x16_bf16 v[80:95], v[124:127], v[156:159], v[80:95]
 v_mfma_f32_32x32x16_bf16 v[80:95], v[128:131], v[160:163], v[80:95]
 v_mfma_f32_32x32x16_bf16 v[80:95], v[132:135], v[164:167], v[80:95]
 v_mfma_f32_32x32x16_bf16 v[80:95], v[136:139], v[168:171], v[80:95]
 v_mfma_f32_32x32x16_bf16 v[80:95], v[140:143], v[172:175], v[80:95]
 s_nop 3
 v_max3_f32 v3, v216, v217, v218
 v_max3_f32 v3, v3, v219, v220
 v_max3_f32 v3, v3, v221, v222
 v_max3_f32 v3, v3, v223, v224
 v_max3_f32 v3, v3, v225, v226
 v_max3_f32 v3, v3, v227, v228
 v_max3_f32 v3, v3, v229, v230
 v_max_f32 v3, v3, v231
 v_max3_f32 v3, v3, v80, v81
 v_max3_f32 v3, v3, v82, v83
 v_mov_b32 v4, v3
 s_nop 1
 v_permlane32_swap_b32 v3, v4
 s_nop 0
 v_max_f32 v3, v3, v4
 v_mul_f32 v3, v248, v3
 v_fma_f32 v216, v216, v248, -v3
 v_fma_f32 v217, v217, v248, -v3
 v_fma_f32 v218, v218, v248, -v3
 v_fma_f32 v219, v219, v248, -v3
 v_fma_f32 v220, v220, v248, -v3
 v_fma_f32 v221, v221, v248, -v3
 v_fma_f32 v222, v222, v248, -v3
 v_fma_f32 v223, v223, v248, -v3
 v_fma_f32 v224, v224, v248, -v3
 v_fma_f32 v225, v225, v248, -v3
 v_fma_f32 v226, v226, v248, -v3
 v_fma_f32 v227, v227, v248, -v3
 v_fma_f32 v228, v228, v248, -v3
 v_fma_f32 v229, v229, v248, -v3
 v_fma_f32 v230, v230, v248, -v3
 v_fma_f32 v231, v231, v248, -v3
 v_fma_f32 v80, v80, v248, -v3
 v_fma_f32 v81, v81, v248, -v3
 v_fma_f32 v82, v82, v248, -v3
 v_fma_f32 v83, v83, v248, -v3
 v_exp_f32 v216, v216
 v_exp_f32 v217, v217
 v_exp_f32 v218, v218
 v_exp_f32 v219, v219
 v_exp_f32 v220, v220
 v_exp_f32 v221, v221
 v_exp_f32 v222, v222
 v_exp_f32 v223, v223
 v_exp_f32 v224, v224
 v_exp_f32 v225, v225
 v_exp_f32 v226, v226
 v_exp_f32 v227, v227
 v_exp_f32 v228, v228
 v_exp_f32 v229, v229
 v_exp_f32 v230, v230
 v_exp_f32 v231, v231
 v_exp_f32 v80, v80
 v_exp_f32 v81, v81
 v_exp_f32 v82, v82
 v_exp_f32 v83, v83
 v_pk_add_f32 v[250:251], v[216:217], v[218:219]
 v_pk_add_f32 v[250:251], v[250:251], v[220:221]
 v_pk_add_f32 v[250:251], v[250:251], v[222:223]
 v_pk_add_f32 v[250:251], v[250:251], v[224:225]
 v_pk_add_f32 v[250:251], v[250:251], v[226:227]
 v_pk_add_f32 v[250:251], v[250:251], v[228:229]
 v_pk_add_f32 v[250:251], v[250:251], v[230:231]
 v_pk_add_f32 v[250:251], v[250:251], v[80:81]
 v_pk_add_f32 v[250:251], v[250:251], v[82:83]
 v_add_f32 v3, v250, v251
 v_add_f32 v4, v250, v251
 s_nop 1
 v_permlane32_swap_b32 v3, v4
 s_nop 0
 v_add_f32 v3, v3, v4
 v_rcp_f32 v250, v3
 s_nop 0
 v_pk_mul_f32 v[216:217], v[216:217], v[250:251] op_sel_hi:[1,0]
 v_pk_mul_f32 v[218:219], v[218:219], v[250:251] op_sel_hi:[1,0]
 v_pk_mul_f32 v[220:221], v[220:221], v[250:251] op_sel_hi:[1,0]
 v_pk_mul_f32 v[222:223], v[222:223], v[250:251] op_sel_hi:[1,0]
 v_pk_mul_f32 v[224:225], v[224:225], v[250:251] op_sel_hi:[1,0]
 v_pk_mul_f32 v[226:227], v[226:227], v[250:251] op_sel_hi:[1,0]
 v_pk_mul_f32 v[228:229], v[228:229], v[250:251] op_sel_hi:[1,0]
 v_pk_mul_f32 v[230:231], v[230:231], v[250:251] op_sel_hi:[1,0]
 v_pk_mul_f32 v[80:81], v[80:81], v[250:251] op_sel_hi:[1,0]
 v_pk_mul_f32 v[82:83], v[82:83], v[250:251] op_sel_hi:[1,0]
 v_cvt_pk_bf16_f32 v144, v216, v217
 v_cvt_pk_bf16_f32 v145, v218, v219
 v_cvt_pk_bf16_f32 v146, v220, v221
 v_cvt_pk_bf16_f32 v147, v222, v223
 v_cvt_pk_bf16_f32 v148, v224, v225
 v_cvt_pk_bf16_f32 v149, v226, v227
 v_cvt_pk_bf16_f32 v150, v228, v229
 v_cvt_pk_bf16_f32 v151, v230, v231
 v_cvt_pk_bf16_f32 v152, v80, v81
 v_cvt_pk_bf16_f32 v153, v82, v83
 s_waitcnt vmcnt(0)
 s_add_u32 s43, s49, 67108864
 s_add_u32 s42, s43, 4096
 v_mfma_f32_32x32x16_bf16 v[80:95], v[176:179], v[144:147], 0
 v_mfma_f32_32x32x16_bf16 v[80:95], v[180:183], v[148:151], v[80:95]
 v_mfma_f32_32x32x8_bf16 v[80:95], v[208:209], v[152:153], v[80:95]
 v_mfma_f32_32x32x16_bf16 v[96:111], v[184:187], v[144:147], 0
 v_mfma_f32_32x32x16_bf16 v[96:111], v[188:191], v[148:151], v[96:111]
 v_mfma_f32_32x32x8_bf16 v[96:111], v[210:211], v[152:153], v[96:111]
 v_mfma_f32_32x32x16_bf16 v[112:127], v[192:195], v[144:147], 0
 v_mfma_f32_32x32x16_bf16 v[112:127], v[196:199], v[148:151], v[112:127]
 v_mfma_f32_32x32x8_bf16 v[112:127], v[212:213], v[152:153], v[112:127]
 v_mfma_f32_32x32x16_bf16 v[128:143], v[200:203], v[144:147], 0
 v_mfma_f32_32x32x16_bf16 v[128:143], v[204:207], v[148:151], v[128:143]
 v_mfma_f32_32x32x8_bf16 v[128:143], v[214:215], v[152:153], v[128:143]
 s_nop 2
 v_cvt_pk_bf16_f32 v176, v80, v81
 v_cvt_pk_bf16_f32 v177, v82, v83
 v_cvt_pk_bf16_f32 v178, v84, v85
 v_cvt_pk_bf16_f32 v179, v86, v87
 v_cvt_pk_bf16_f32 v180, v88, v89
 v_cvt_pk_bf16_f32 v181, v90, v91
 v_cvt_pk_bf16_f32 v182, v92, v93
 v_cvt_pk_bf16_f32 v183, v94, v95
 buffer_store_dwordx4 v[176:179], v2, s[4:7], s43 offen offset:0 sc1
 buffer_store_dwordx4 v[180:183], v2, s[4:7], s43 offen offset:1024 sc1
 v_cvt_pk_bf16_f32 v184, v96, v97
 v_cvt_pk_bf16_f32 v185, v98, v99
 v_cvt_pk_bf16_f32 v186, v100, v101
 v_cvt_pk_bf16_f32 v187, v102, v103
 v_cvt_pk_bf16_f32 v188, v104, v105
 v_cvt_pk_bf16_f32 v189, v106, v107
 v_cvt_pk_bf16_f32 v190, v108, v109
 v_cvt_pk_bf16_f32 v191, v110, v111
 buffer_store_dwordx4 v[184:187], v2, s[4:7], s43 offen offset:2048 sc1
 buffer_store_dwordx4 v[188:191], v2, s[4:7], s43 offen offset:3072 sc1
 v_cvt_pk_bf16_f32 v192, v112, v113
 v_cvt_pk_bf16_f32 v193, v114, v115
 v_cvt_pk_bf16_f32 v194, v116, v117
 v_cvt_pk_bf16_f32 v195, v118, v119
 v_cvt_pk_bf16_f32 v196, v120, v121
 v_cvt_pk_bf16_f32 v197, v122, v123
 v_cvt_pk_bf16_f32 v198, v124, v125
 v_cvt_pk_bf16_f32 v199, v126, v127
 buffer_store_dwordx4 v[192:195], v2, s[4:7], s42 offen offset:0 sc1
 buffer_store_dwordx4 v[196:199], v2, s[4:7], s42 offen offset:1024 sc1
 v_cvt_pk_bf16_f32 v200, v128, v129
 v_cvt_pk_bf16_f32 v201, v130, v131
 v_cvt_pk_bf16_f32 v202, v132, v133
 v_cvt_pk_bf16_f32 v203, v134, v135
 v_cvt_pk_bf16_f32 v204, v136, v137
 v_cvt_pk_bf16_f32 v205, v138, v139
 v_cvt_pk_bf16_f32 v206, v140, v141
 v_cvt_pk_bf16_f32 v207, v142, v143
 buffer_store_dwordx4 v[200:203], v2, s[4:7], s42 offen offset:2048 sc1
 buffer_store_dwordx4 v[204:207], v2, s[4:7], s42 offen offset:3072 sc1
 s_add_u32 s41, s50, 1
 v_mov_b32 v252, s41
 s_add_u32 s50, s50, 8
 s_cmp_lt_u32 s50, 48
 s_cselect_b32 s50, s50, 64
L_rK_back:
 s_cmp_eq_u32 s54, 0
 s_cbranch_scc1 L_rK_ret0
 s_cmp_eq_u32 s54, 1
 s_cbranch_scc1 L_rK_ret1
 s_branch L_rK_ret2
L_rK_end:
 s_waitcnt vmcnt(0) lgkmcnt(0)
 s_barrier
 s_branch L_conv_full
L_role_V:
 s_mov_b64 s[8:9], s[20:21]
 s_mov_b32 s10, 8388608
 s_mov_b32 s11, 0x20000
 v_and_b32 v1, 63, v0
 v_lshrrev_b32 v12, 4, v1
 v_lshlrev_b32 v12, 13, v12
 v_and_b32 v3, 15, v1
 v_lshl_add_u32 v12, v3, 4, v12
 s_lshl_b32 s44, s25, 8
 s_lshl_b32 s42, s26, 18
 s_add_u32 s44, s44, s42
 s_lshl_b32 s45, s26, 13
 s_add_u32 s45, s45, 67584
 s_add_u32 m0, s45, 0
 s_add_u32 s43, s44, 0
 buffer_load_dwordx4 v12, s[8:11], s43 offen  lds
 s_add_u32 m0, s45, 1024
 s_add_u32 s43, s44, 32768
 buffer_load_dwordx4 v12, s[8:11], s43 offen  lds
 s_add_u32 m0, s45, 2048
 s_add_u32 s43, s44, 65536
 buffer_load_dwordx4 v12, s[8:11], s43 offen  lds
 s_add_u32 m0, s45, 3072
 s_add_u32 s43, s44, 98304
 buffer_load_dwordx4 v12, s[8:11], s43 offen  lds
 s_add_u32 m0, s45, 4096
 s_add_u32 s43, s44, 131072
 buffer_load_dwordx4 v12, s[8:11], s43 offen  lds
 s_add_u32 m0, s45, 5120
 s_add_u32 s43, s44, 163840
 buffer_load_dwordx4 v12, s[8:11], s43 offen  lds
 s_add_u32 m0, s45, 6144
 s_add_u32 s43, s44, 196608
 buffer_load_dwordx4 v12, s[8:11], s43 offen  lds
 s_add_u32 m0, s45, 7168
 s_add_u32 s43, s44, 229376
 buffer_load_dwordx4 v12, s[8:11], s43 offen  lds
 v_and_b32 v1, 63, v0
 v_lshlrev_b32 v2, 4, v1
 v_bfrev_b32 v7, 1
 s_mov_b32 s48, 0
 v_and_b32 v5, 0x13, v1
 v_bfe_u32 v3, v1, 2, 1
 v_lshl_add_u32 v5, v3, 3, v5
 v_bfe_u32 v3, v1, 3, 1
 v_lshl_add_u32 v5, v3, 2, v5
 v_lshrrev_b32 v4, 5, v1
 v_lshlrev_b32 v3, 9, v4
 v_lshl_add_u32 v6, v5, 4, v3
 v_mul_u32_u24 v3, 2064, v5
 v_lshl_add_u32 v10, v4, 4, v3
 v_add_u32 v11, 66048, v10
 s_lshr_b32 s50, s25, 3
 s_add_u32 s50, s50, 0
 s_and_b32 s51, s25, 7
 s_lshl_b32 s51, s51, 2
 s_add_u32 s51, s51, s26
 v_lshl_add_u32 v3, v1, 3, s50
 v_cmp_gt_u32 vcc, 48, v3
 s_lshr_b32 s41, s51, 1
 s_lshl_b32 s41, s41, 5
 s_and_b32 s42, s51, 1
 s_add_u32 s41, s41, s42
 s_lshl_b32 s41, s41, 2
 s_add_u32 s55, s41, 3932160
 v_lshl_add_u32 v3, v3, 11, s55
 v_cndmask_b32 v14, v7, v3, vcc
 s_lshl_b32 s41, s25, 7
 s_add_u32 s41, s41, 3735568
 s_lshl_b32 s42, s26, 2
 s_add_u32 s41, s41, s42
 v_mov_b32 v3, s41
 v_cmp_eq_u32 vcc, 0, v1
 v_mov_b32 v9, 0
 s_nop 0
 v_cndmask_b32 v8, v7, v3, vcc
 v_bfe_u32 v13, v1, 2, 2
 v_lshrrev_b32 v3, 5, v1
 v_lshl_add_u32 v13, v3, 3, v13
 v_lshlrev_b32 v13, 8, v13
 v_bfe_u32 v3, v1, 4, 1
 v_lshl_add_u32 v13, v3, 5, v13
 v_and_b32 v3, 1, v1
 v_lshl_add_u32 v13, v3, 3, v13
 v_bfe_u32 v3, v1, 1, 1
 v_lshl_add_u32 v13, v3, 4, v13
 s_lshl_b32 s43, s26, 6
 s_add_u32 s43, s43, 67584
 v_add_u32 v13, s43, v13
 buffer_store_dword v9, v8, s[4:7], 0 offen sc1
 buffer_store_dword v9, v14, s[4:7], 0 offen sc1
 s_add_u32 m0, s45, 32768
 s_add_u32 s43, s44, 1048576
 buffer_load_dwordx4 v12, s[8:11], s43 offen  lds
 s_add_u32 m0, s45, 33792
 s_add_u32 s43, s44, 1081344
 buffer_load_dwordx4 v12, s[8:11], s43 offen  lds
 s_add_u32 m0, s45, 34816
 s_add_u32 s43, s44, 1114112
 buffer_load_dwordx4 v12, s[8:11], s43 offen  lds
 s_add_u32 m0, s45, 35840
 s_add_u32 s43, s44, 1146880
 buffer_load_dwordx4 v12, s[8:11], s43 offen  lds
 s_add_u32 m0, s45, 36864
 s_add_u32 s43, s44, 1179648
 buffer_load_dwordx4 v12, s[8:11], s43 offen  lds
 s_add_u32 m0, s45, 37888
 s_add_u32 s43, s44, 1212416
 buffer_load_dwordx4 v12, s[8:11], s43 offen  lds
 s_add_u32 m0, s45, 38912
 s_add_u32 s43, s44, 1245184
 buffer_load_dwordx4 v12, s[8:11], s43 offen  lds
 s_add_u32 m0, s45, 39936
 s_add_u32 s43, s44, 1277952
 buffer_load_dwordx4 v12, s[8:11], s43 offen  lds
 s_waitcnt vmcnt(10)
 s_barrier
 ds_read_b64_tr_b16 a[0:1], v13 offset:0
 ds_read_b64_tr_b16 a[2:3], v13 offset:1024
 ds_read_b64_tr_b16 a[4:5], v13 offset:4096
 ds_read_b64_tr_b16 a[6:7], v13 offset:5120
 ds_read_b64_tr_b16 a[8:9], v13 offset:8192
 ds_read_b64_tr_b16 a[10:11], v13 offset:9216
 ds_read_b64_tr_b16 a[12:13], v13 offset:12288
 ds_read_b64_tr_b16 a[14:15], v13 offset:13312
 s_waitcnt lgkmcnt(0)
 ds_read_b64_tr_b16 a[16:17], v13 offset:16384
 ds_read_b64_tr_b16 a[18:19], v13 offset:17408
 ds_read_b64_tr_b16 a[20:21], v13 offset:20480
 ds_read_b64_tr_b16 a[22:23], v13 offset:21504
 ds_read_b64_tr_b16 a[24:25], v13 offset:24576
 ds_read_b64_tr_b16 a[26:27], v13 offset:25600
 ds_read_b64_tr_b16 a[28:29], v13 offset:28672
 ds_read_b64_tr_b16 a[30:31], v13 offset:29696
 s_waitcnt lgkmcnt(0)
 s_barrier
 s_add_u32 m0, s45, 0
 s_add_u32 s43, s44, 2097152
 buffer_load_dwordx4 v12, s[8:11], s43 offen  lds
 s_add_u32 m0, s45, 1024
 s_add_u32 s43, s44, 2129920
 buffer_load_dwordx4 v12, s[8:11], s43 offen  lds
 s_add_u32 m0, s45, 2048
 s_add_u32 s43, s44, 2162688
 buffer_load_dwordx4 v12, s[8:11], s43 offen  lds
 s_add_u32 m0, s45, 3072
 s_add_u32 s43, s44, 2195456
 buffer_load_dwordx4 v12, s[8:11], s43 offen  lds
 s_add_u32 m0, s45, 4096
 s_add_u32 s43, s44, 2228224
 buffer_load_dwordx4 v12, s[8:11], s43 offen  lds
 s_add_u32 m0, s45, 5120
 s_add_u32 s43, s44, 2260992
 buffer_load_dwordx4 v12, s[8:11], s43 offen  lds
 s_add_u32 m0, s45, 6144
 s_add_u32 s43, s44, 2293760
 buffer_load_dwordx4 v12, s[8:11], s43 offen  lds
 s_add_u32 m0, s45, 7168
 s_add_u32 s43, s44, 2326528
 buffer_load_dwordx4 v12, s[8:11], s43 offen  lds
 s_waitcnt vmcnt(8)
 s_barrier
 ds_read_b64_tr_b16 a[32:33], v13 offset:32768
 ds_read_b64_tr_b16 a[34:35], v13 offset:33792
 ds_read_b64_tr_b16 a[36:37], v13 offset:36864
 ds_read_b64_tr_b16 a[38:39], v13 offset:37888
 ds_read_b64_tr_b16 a[40:41], v13 offset:40960
 ds_read_b64_tr_b16 a[42:43], v13 offset:41984
 ds_read_b64_tr_b16 a[44:45], v13 offset:45056
 ds_read_b64_tr_b16 a[46:47], v13 offset:46080
 s_waitcnt lgkmcnt(0)
 ds_read_b64_tr_b16 a[48:49], v13 offset:49152
 ds_read_b64_tr_b16 a[50:51], v13 offset:50176
 ds_read_b64_tr_b16 a[52:53], v13 offset:53248
 ds_read_b64_tr_b16 a[54:55], v13 offset:54272
 ds_read_b64_tr_b16 a[56:57], v13 offset:57344
 ds_read_b64_tr_b16 a[58:59], v13 offset:58368
 ds_read_b64_tr_b16 a[60:61], v13 offset:61440
 ds_read_b64_tr_b16 a[62:63], v13 offset:62464
 s_waitcnt lgkmcnt(0)
 s_barrier
 s_add_u32 m0, s45, 32768
 s_add_u32 s43, s44, 3145728
 buffer_load_dwordx4 v12, s[8:11], s43 offen  lds
 s_add_u32 m0, s45, 33792
 s_add_u32 s43, s44, 3178496
 buffer_load_dwordx4 v12, s[8:11], s43 offen  lds
 s_add_u32 m0, s45, 34816
 s_add_u32 s43, s44, 3211264
 buffer_load_dwordx4 v12, s[8:11], s43 offen  lds
 s_add_u32 m0, s45, 35840
 s_add_u32 s43, s44, 3244032
 buffer_load_dwordx4 v12, s[8:11], s43 offen  lds
 s_add_u32 m0, s45, 36864
 s_add_u32 s43, s44, 3276800
 buffer_load_dwordx4 v12, s[8:11], s43 offen  lds
 s_add_u32 m0, s45, 37888
 s_add_u32 s43, s44, 3309568
 buffer_load_dwordx4 v12, s[8:11], s43 offen  lds
 s_add_u32 m0, s45, 38912
 s_add_u32 s43, s44, 3342336
 buffer_load_dwordx4 v12, s[8:11], s43 offen  lds
 s_add_u32 m0, s45, 39936
 s_add_u32 s43, s44, 3375104
 buffer_load_dwordx4 v12, s[8:11], s43 offen  lds
 v_mov_b32 v250, s34
 v_mov_b32 v251, s35
 v_bfrev_b32 v252, 1
 v_cmp_eq_u32 vcc, 64, v0
 s_nop 1
 v_cndmask_b32 v252, v252, 0, vcc
 buffer_atomic_add_x2 v[250:251], v252, s[12:15], s30 offen sc1
 s_waitcnt vmcnt(9)
 s_barrier
 ds_read_b64_tr_b16 a[64:65], v13 offset:0
 ds_read_b64_tr_b16 a[66:67], v13 offset:1024
 ds_read_b64_tr_b16 a[68:69], v13 offset:4096
 ds_read_b64_tr_b16 a[70:71], v13 offset:5120
 ds_read_b64_tr_b16 a[72:73], v13 offset:8192
 ds_read_b64_tr_b16 a[74:75], v13 offset:9216
 ds_read_b64_tr_b16 a[76:77], v13 offset:12288
 ds_read_b64_tr_b16 a[78:79], v13 offset:13312
 s_waitcnt lgkmcnt(0)
 ds_read_b64_tr_b16 a[80:81], v13 offset:16384
 ds_read_b64_tr_b16 a[82:83], v13 offset:17408
 ds_read_b64_tr_b16 a[84:85], v13 offset:20480
 ds_read_b64_tr_b16 a[86:87], v13 offset:21504
 ds_read_b64_tr_b16 a[88:89], v13 offset:24576
 ds_read_b64_tr_b16 a[90:91], v13 offset:25600
 ds_read_b64_tr_b16 a[92:93], v13 offset:28672
 ds_read_b64_tr_b16 a[94:95], v13 offset:29696
 s_waitcnt lgkmcnt(0)
 s_barrier
 s_add_u32 m0, s45, 0
 s_add_u32 s43, s44, 4194304
 buffer_load_dwordx4 v12, s[8:11], s43 offen  lds
 s_add_u32 m0, s45, 1024
 s_add_u32 s43, s44, 4227072
 buffer_load_dwordx4 v12, s[8:11], s43 offen  lds
 s_add_u32 m0, s45, 2048
 s_add_u32 s43, s44, 4259840
 buffer_load_dwordx4 v12, s[8:11], s43 offen  lds
 s_add_u32 m0, s45, 3072
 s_add_u32 s43, s44, 4292608
 buffer_load_dwordx4 v12, s[8:11], s43 offen  lds
 s_add_u32 m0, s45, 4096
 s_add_u32 s43, s44, 4325376
 buffer_load_dwordx4 v12, s[8:11], s43 offen  lds
 s_add_u32 m0, s45, 5120
 s_add_u32 s43, s44, 4358144
 buffer_load_dwordx4 v12, s[8:11], s43 offen  lds
 s_add_u32 m0, s45, 6144
 s_add_u32 s43, s44, 4390912
 buffer_load_dwordx4 v12, s[8:11], s43 offen  lds
 s_add_u32 m0, s45, 7168
 s_add_u32 s43, s44, 4423680
 buffer_load_dwordx4 v12, s[8:11], s43 offen  lds
 s_waitcnt vmcnt(9)
 s_barrier
 ds_read_b64_tr_b16 a[96:97], v13 offset:32768
 ds_read_b64_tr_b16 a[98:99], v13 offset:33792
 ds_read_b64_tr_b16 a[100:101], v13 offset:36864
 ds_read_b64_tr_b16 a[102:103], v13 offset:37888
 ds_read_b64_tr_b16 a[104:105], v13 offset:40960
 ds_read_b64_tr_b16 a[106:107], v13 offset:41984
 ds_read_b64_tr_b16 a[108:109], v13 offset:45056
 ds_read_b64_tr_b16 a[110:111], v13 offset:46080
 s_waitcnt lgkmcnt(0)
 ds_read_b64_tr_b16 a[112:113], v13 offset:49152
 ds_read_b64_tr_b16 a[114:115], v13 offset:50176
 ds_read_b64_tr_b16 a[116:117], v13 offset:53248
 ds_read_b64_tr_b16 a[118:119], v13 offset:54272
 ds_read_b64_tr_b16 a[120:121], v13 offset:57344
 ds_read_b64_tr_b16 a[122:123], v13 offset:58368
 ds_read_b64_tr_b16 a[124:125], v13 offset:61440
 ds_read_b64_tr_b16 a[126:127], v13 offset:62464
 s_waitcnt lgkmcnt(0)
 s_barrier
 s_add_u32 m0, s45, 32768
 s_add_u32 s43, s44, 5242880
 buffer_load_dwordx4 v12, s[8:11], s43 offen  lds
 s_add_u32 m0, s45, 33792
 s_add_u32 s43, s44, 5275648
 buffer_load_dwordx4 v12, s[8:11], s43 offen  lds
 s_add_u32 m0, s45, 34816
 s_add_u32 s43, s44, 5308416
 buffer_load_dwordx4 v12, s[8:11], s43 offen  lds
 s_add_u32 m0, s45, 35840
 s_add_u32 s43, s44, 5341184
 buffer_load_dwordx4 v12, s[8:11], s43 offen  lds
 s_add_u32 m0, s45, 36864
 s_add_u32 s43, s44, 5373952
 buffer_load_dwordx4 v12, s[8:11], s43 offen  lds
 s_add_u32 m0, s45, 37888
 s_add_u32 s43, s44, 5406720
 buffer_load_dwordx4 v12, s[8:11], s43 offen  lds
 s_add_u32 m0, s45, 38912
 s_add_u32 s43, s44, 5439488
 buffer_load_dwordx4 v12, s[8:11], s43 offen  lds
 s_add_u32 m0, s45, 39936
 s_add_u32 s43, s44, 5472256
 buffer_load_dwordx4 v12, s[8:11], s43 offen  lds
 s_waitcnt vmcnt(8)
 s_barrier
 ds_read_b64_tr_b16 a[128:129], v13 offset:0
 ds_read_b64_tr_b16 a[130:131], v13 offset:1024
 ds_read_b64_tr_b16 a[132:133], v13 offset:4096
 ds_read_b64_tr_b16 a[134:135], v13 offset:5120
 ds_read_b64_tr_b16 a[136:137], v13 offset:8192
 ds_read_b64_tr_b16 a[138:139], v13 offset:9216
 ds_read_b64_tr_b16 a[140:141], v13 offset:12288
 ds_read_b64_tr_b16 a[142:143], v13 offset:13312
 s_waitcnt lgkmcnt(0)
 ds_read_b64_tr_b16 a[144:145], v13 offset:16384
 ds_read_b64_tr_b16 a[146:147], v13 offset:17408
 ds_read_b64_tr_b16 a[148:149], v13 offset:20480
 ds_read_b64_tr_b16 a[150:151], v13 offset:21504
 ds_read_b64_tr_b16 a[152:153], v13 offset:24576
 ds_read_b64_tr_b16 a[154:155], v13 offset:25600
 ds_read_b64_tr_b16 a[156:157], v13 offset:28672
 ds_read_b64_tr_b16 a[158:159], v13 offset:29696
 s_waitcnt lgkmcnt(0)
 s_barrier
 s_add_u32 m0, s45, 0
 s_add_u32 s43, s44, 6291456
 buffer_load_dwordx4 v12, s[8:11], s43 offen  lds
 s_add_u32 m0, s45, 1024
 s_add_u32 s43, s44, 6324224
 buffer_load_dwordx4 v12, s[8:11], s43 offen  lds
 s_add_u32 m0, s45, 2048
 s_add_u32 s43, s44, 6356992
 buffer_load_dwordx4 v12, s[8:11], s43 offen  lds
 s_add_u32 m0, s45, 3072
 s_add_u32 s43, s44, 6389760
 buffer_load_dwordx4 v12, s[8:11], s43 offen  lds
 s_add_u32 m0, s45, 4096
 s_add_u32 s43, s44, 6422528
 buffer_load_dwordx4 v12, s[8:11], s43 offen  lds
 s_add_u32 m0, s45, 5120
 s_add_u32 s43, s44, 6455296
 buffer_load_dwordx4 v12, s[8:11], s43 offen  lds
 s_add_u32 m0, s45, 6144
 s_add_u32 s43, s44, 6488064
 buffer_load_dwordx4 v12, s[8:11], s43 offen  lds
 s_add_u32 m0, s45, 7168
 s_add_u32 s43, s44, 6520832
 buffer_load_dwordx4 v12, s[8:11], s43 offen  lds
 s_load_dwordx2 s[36:37], s[0:1], 0
 s_mov_b32 s38, 4194304
 s_mov_b32 s39, 0x20000
 s_lshl_b32 s41, s26, 14
 s_mul_i32 s42, s26, 16512
 s_waitcnt lgkmcnt(0)
 s_add_u32 m0, s42, 0
 s_add_u32 s43, s41, 0
 buffer_load_dwordx4 v2, s[36:39], s43 offen offset:0 lds
 buffer_load_dwordx4 v2, s[36:39], s43 offen offset:1024 lds
 s_add_u32 m0, s42, 2064
 s_add_u32 s43, s41, 2048
 buffer_load_dwordx4 v2, s[36:39], s43 offen offset:0 lds
 buffer_load_dwordx4 v2, s[36:39], s43 offen offset:1024 lds
 s_add_u32 m0, s42, 4128
 s_add_u32 s43, s41, 4096
 buffer_load_dwordx4 v2, s[36:39], s43 offen offset:0 lds
 buffer_load_dwordx4 v2, s[36:39], s43 offen offset:1024 lds
 s_add_u32 m0, s42, 6192
 s_add_u32 s43, s41, 6144
 buffer_load_dwordx4 v2, s[36:39], s43 offen offset:0 lds
 buffer_load_dwordx4 v2, s[36:39], s43 offen offset:1024 lds
 s_add_u32 m0, s42, 8256
 s_add_u32 s43, s41, 8192
 buffer_load_dwordx4 v2, s[36:39], s43 offen offset:0 lds
 buffer_load_dwordx4 v2, s[36:39], s43 offen offset:1024 lds
 s_add_u32 m0, s42, 10320
 s_add_u32 s43, s41, 10240
 buffer_load_dwordx4 v2, s[36:39], s43 offen offset:0 lds
 buffer_load_dwordx4 v2, s[36:39], s43 offen offset:1024 lds
 s_add_u32 m0, s42, 12384
 s_add_u32 s43, s41, 12288
 buffer_load_dwordx4 v2, s[36:39], s43 offen offset:0 lds
 buffer_load_dwordx4 v2, s[36:39], s43 offen offset:1024 lds
 s_add_u32 m0, s42, 14448
 s_add_u32 s43, s41, 14336
 buffer_load_dwordx4 v2, s[36:39], s43 offen offset:0 lds
 buffer_load_dwordx4 v2, s[36:39], s43 offen offset:1024 lds
 s_waitcnt vmcnt(24)
 s_barrier
 ds_read_b64_tr_b16 a[160:161], v13 offset:32768
 ds_read_b64_tr_b16 a[162:163], v13 offset:33792
 ds_read_b64_tr_b16 a[164:165], v13 offset:36864
 ds_read_b64_tr_b16 a[166:167], v13 offset:37888
 ds_read_b64_tr_b16 a[168:169], v13 offset:40960
 ds_read_b64_tr_b16 a[170:171], v13 offset:41984
 ds_read_b64_tr_b16 a[172:173], v13 offset:45056
 ds_read_b64_tr_b16 a[174:175], v13 offset:46080
 s_waitcnt lgkmcnt(0)
 ds_read_b64_tr_b16 a[176:177], v13 offset:49152
 ds_read_b64_tr_b16 a[178:179], v13 offset:50176
 ds_read_b64_tr_b16 a[180:181], v13 offset:53248
 ds_read_b64_tr_b16 a[182:183], v13 offset:54272
 ds_read_b64_tr_b16 a[184:185], v13 offset:57344
 ds_read_b64_tr_b16 a[186:187], v13 offset:58368
 ds_read_b64_tr_b16 a[188:189], v13 offset:61440
 ds_read_b64_tr_b16 a[190:191], v13 offset:62464
 s_waitcnt lgkmcnt(0)
 s_barrier
 s_add_u32 m0, s45, 32768
 s_add_u32 s43, s44, 7340032
 buffer_load_dwordx4 v12, s[8:11], s43 offen  lds
 s_add_u32 m0, s45, 33792
 s_add_u32 s43, s44, 7372800
 buffer_load_dwordx4 v12, s[8:11], s43 offen  lds
 s_add_u32 m0, s45, 34816
 s_add_u32 s43, s44, 7405568
 buffer_load_dwordx4 v12, s[8:11], s43 offen  lds
 s_add_u32 m0, s45, 35840
 s_add_u32 s43, s44, 7438336
 buffer_load_dwordx4 v12, s[8:11], s43 offen  lds
 s_add_u32 m0, s45, 36864
 s_add_u32 s43, s44, 7471104
 buffer_load_dwordx4 v12, s[8:11], s43 offen  lds
 s_add_u32 m0, s45, 37888
 s_add_u32 s43, s44, 7503872
 buffer_load_dwordx4 v12, s[8:11], s43 offen  lds
 s_add_u32 m0, s45, 38912
 s_add_u32 s43, s44, 7536640
 buffer_load_dwordx4 v12, s[8:11], s43 offen  lds
 s_add_u32 m0, s45, 39936
 s_add_u32 s43, s44, 7569408
 buffer_load_dwordx4 v12, s[8:11], s43 offen  lds
 s_waitcnt vmcnt(24)
 s_barrier
 ds_read_b64_tr_b16 a[192:193], v13 offset:0
 ds_read_b64_tr_b16 a[194:195], v13 offset:1024
 ds_read_b64_tr_b16 a[196:197], v13 offset:4096
 ds_read_b64_tr_b16 a[198:199], v13 offset:5120
 ds_read_b64_tr_b16 a[200:201], v13 offset:8192
 ds_read_b64_tr_b16 a[202:203], v13 offset:9216
 ds_read_b64_tr_b16 a[204:205], v13 offset:12288
 ds_read_b64_tr_b16 a[206:207], v13 offset:13312
 s_waitcnt lgkmcnt(0)
 ds_read_b64_tr_b16 a[208:209], v13 offset:16384
 ds_read_b64_tr_b16 a[210:211], v13 offset:17408
 ds_read_b64_tr_b16 a[212:213], v13 offset:20480
 ds_read_b64_tr_b16 a[214:215], v13 offset:21504
 ds_read_b64_tr_b16 a[216:217], v13 offset:24576
 ds_read_b64_tr_b16 a[218:219], v13 offset:25600
 ds_read_b64_tr_b16 a[220:221], v13 offset:28672
 ds_read_b64_tr_b16 a[222:223], v13 offset:29696
 s_waitcnt lgkmcnt(0)
 s_waitcnt vmcnt(0)
 s_barrier
 ds_read_b64_tr_b16 a[224:225], v13 offset:32768
 ds_read_b64_tr_b16 a[226:227], v13 offset:33792
 ds_read_b64_tr_b16 a[228:229], v13 offset:36864
 ds_read_b64_tr_b16 a[230:231], v13 offset:37888
 ds_read_b64_tr_b16 a[232:233], v13 offset:40960
 ds_read_b64_tr_b16 a[234:235], v13 offset:41984
 ds_read_b64_tr_b16 a[236:237], v13 offset:45056
 ds_read_b64_tr_b16 a[238:239], v13 offset:46080
 s_waitcnt lgkmcnt(0)
 ds_read_b64_tr_b16 a[240:241], v13 offset:49152
 ds_read_b64_tr_b16 a[242:243], v13 offset:50176
 ds_read_b64_tr_b16 a[244:245], v13 offset:53248
 ds_read_b64_tr_b16 a[246:247], v13 offset:54272
 ds_read_b64_tr_b16 a[248:249], v13 offset:57344
 ds_read_b64_tr_b16 a[250:251], v13 offset:58368
 ds_read_b64_tr_b16 a[252:253], v13 offset:61440
 ds_read_b64_tr_b16 a[254:255], v13 offset:62464
 s_waitcnt lgkmcnt(0)
 s_barrier
 s_mov_b32 s3, 0
L_rdy_4:
 buffer_load_dwordx4 v[84:87], off, s[12:15], s30 sc1
 s_add_u32 s3, s3, 1
 s_cmp_gt_u32 s3, 400000
 s_cbranch_scc1 L_exit
 s_waitcnt vmcnt(0)
 v_readfirstlane_b32 s32, v84
 v_readfirstlane_b32 s33, v85
 v_readfirstlane_b32 vcc_hi, v86
 s_and_b32 vcc_lo, s32, 0xffff
 s_cmp_lt_u32 vcc_lo, 256
 s_cbranch_scc1 L_rdy_4
 s_cmp_lg_u32 vcc_hi, 0
 s_cbranch_scc1 L_general
 s_load_dwordx2 s[36:37], s[0:1], 0
 s_mov_b32 s38, 4194304
 s_mov_b32 s39, 0x20000
 s_lshl_b32 s44, s26, 14
 s_mul_i32 s45, s26, 16512
 s_lshl_b32 s41, s25, 2
 s_add_u32 s41, s41, s26
 s_lshl_b32 s46, s41, 11
 s_add_u32 s46, s46, 33554432
 s_waitcnt lgkmcnt(0)
 v_mov_b32 v15, 0
 v_and_b32 v255, 1, v1
 v_lshlrev_b32 v255, 2, v255
 s_mov_b32 s56, 0
 s_mov_b32 s57, 0
 s_mov_b32 s58, 0
 s_mov_b32 s59, 0
 s_mov_b32 s60, 0
 s_mov_b32 s61, 0
 s_mov_b32 s62, 0
 s_mov_b32 s63, 0
 s_mov_b32 s64, 0
 s_mov_b32 s65, 0
 s_mov_b32 s66, 0
 s_mov_b32 s67, 0
 s_mov_b32 s68, 0
 s_mov_b32 s69, 0
 s_mov_b32 s70, 0
 s_mov_b32 s71, 0
 s_mov_b32 s40, 0
 s_waitcnt vmcnt(0)
 s_barrier
 ds_read_b128 v[16:19], v10 offset:0
 ds_read_b128 v[20:23], v10 offset:32
 ds_read_b128 v[24:27], v10 offset:64
 ds_read_b128 v[28:31], v10 offset:96
 ds_read_b128 v[32:35], v10 offset:128
 ds_read_b128 v[36:39], v10 offset:160
 s_add_u32 s46, s46, 1073479680
 v_and_b32 v3, 31, v1
 v_lshrrev_b32 v4, 5, v1
 v_lshlrev_b32 v12, 4, v3
 v_lshl_add_u32 v12, v4, 7, v12
 v_cmp_gt_u32 vcc, 8, v3
 v_and_b32 v13, 15, v5
 v_lshlrev_b32 v13, 2, v13
 v_lshl_add_u32 v13, v4, 7, v13
 v_lshrrev_b32 v5, 4, v5
 v_lshl_add_u32 v13, v5, 8, v13
 v_cndmask_b32 v12, v7, v12, vcc
 v_lshlrev_b32 v4, 3, v4
 v_sub_u32 v3, v3, v4
 v_mov_b32 v4, 0xf149f2ca
 v_cmp_gt_i32 vcc, 0, v3
 s_nop 1
 v_cndmask_b32 v232, 0, v4, vcc
 v_cmp_gt_i32 vcc, 1, v3
 s_nop 1
 v_cndmask_b32 v233, 0, v4, vcc
 v_cmp_gt_i32 vcc, 2, v3
 s_nop 1
 v_cndmask_b32 v234, 0, v4, vcc
 v_cmp_gt_i32 vcc, 3, v3
 s_nop 1
 v_cndmask_b32 v235, 0, v4, vcc
 v_cmp_gt_i32 vcc, 4, v3
 s_nop 1
 v_cndmask_b32 v236, 0, v4, vcc
 v_cmp_gt_i32 vcc, 5, v3
 s_nop 1
 v_cndmask_b32 v237, 0, v4, vcc
 v_cmp_gt_i32 vcc, 6, v3
 s_nop 1
 v_cndmask_b32 v238, 0, v4, vcc
 v_cmp_gt_i32 vcc, 7, v3
 s_nop 1
 v_cndmask_b32 v239, 0, v4, vcc
 v_cmp_gt_i32 vcc, 16, v3
 s_nop 1
 v_cndmask_b32 v240, 0, v4, vcc
 v_cmp_gt_i32 vcc, 17, v3
 s_nop 1
 v_cndmask_b32 v241, 0, v4, vcc
 v_cmp_gt_i32 vcc, 18, v3
 s_nop 1
 v_cndmask_b32 v242, 0, v4, vcc
 v_cmp_gt_i32 vcc, 19, v3
 s_nop 1
 v_cndmask_b32 v243, 0, v4, vcc
 v_cmp_gt_i32 vcc, 20, v3
 s_nop 1
 v_cndmask_b32 v244, 0, v4, vcc
 v_cmp_gt_i32 vcc, 21, v3
 s_nop 1
 v_cndmask_b32 v245, 0, v4, vcc
 v_cmp_gt_i32 vcc, 22, v3
 s_nop 1
 v_cndmask_b32 v246, 0, v4, vcc
 v_cmp_gt_i32 vcc, 23, v3
 s_nop 1
 v_cndmask_b32 v247, 0, v4, vcc
 v_mov_b32 v248, 0x3e0293ee
 s_lshl_b32 s47, s51, 7
 s_add_u32 s47, s47, 3739648
 s_mov_b32 s53, 0x40000000
 v_cmp_eq_u32 vcc, 0, v1
 v_mov_b32 v252, 0
 s_nop 0
 v_cndmask_b32 v14, v7, 0, vcc
L_rV_loop:
 s_waitcnt lgkmcnt(5)
 v_mfma_f32_32x32x16_bf16 v[48:63], v[16:19], a[0:3], 0
 ds_read_b128 v[40:43], v10 offset:192
 s_add_u32 s44, s44, 65536
 s_add_u32 m0, s45, 66048
 s_add_u32 s43, s44, 0
 buffer_load_dwordx4 v2, s[36:39], s43 offen offset:0 lds
 s_waitcnt lgkmcnt(5)
 v_mfma_f32_32x32x16_bf16 v[48:63], v[20:23], a[4:7], v[48:63]
 ds_read_b128 v[44:47], v10 offset:224
 s_waitcnt lgkmcnt(5)
 v_mfma_f32_32x32x16_bf16 v[48:63], v[24:27], a[8:11], v[48:63]
 ds_read_b128 v[16:19], v10 offset:256
 buffer_load_dwordx4 v2, s[36:39], s43 offen offset:1024 lds
 s_waitcnt lgkmcnt(5)
 v_mfma_f32_32x32x16_bf16 v[48:63], v[28:31], a[12:15], v[48:63]
 ds_read_b128 v[20:23], v10 offset:288
 s_waitcnt lgkmcnt(5)
 v_mfma_f32_32x32x16_bf16 v[48:63], v[32:35], a[16:19], v[48:63]
 ds_read_b128 v[24:27], v10 offset:320
 s_add_u32 m0, s45, 68112
 s_add_u32 s43, s44, 2048
 buffer_load_dwordx4 v2, s[36:39], s43 offen offset:0 lds
 v_cvt_pk_bf16_f32 v80, v64, v65
 v_cvt_pk_bf16_f32 v81, v66, v67
 s_waitcnt lgkmcnt(5)
 v_mfma_f32_32x32x16_bf16 v[48:63], v[36:39], a[20:23], v[48:63]
 ds_read_b128 v[28:31], v10 offset:352
 v_cvt_pk_bf16_f32 v82, v68, v69
 v_cvt_pk_bf16_f32 v83, v70, v71
 s_waitcnt lgkmcnt(5)
 v_mfma_f32_32x32x16_bf16 v[48:63], v[40:43], a[24:27], v[48:63]
 ds_read_b128 v[32:35], v10 offset:384
 buffer_load_dwordx4 v2, s[36:39], s43 offen offset:1024 lds
 v_cvt_pk_bf16_f32 v84, v72, v73
 v_cvt_pk_bf16_f32 v85, v74, v75
 s_waitcnt lgkmcnt(5)
 v_mfma_f32_32x32x16_bf16 v[48:63], v[44:47], a[28:31], v[48:63]
 ds_read_b128 v[36:39], v10 offset:416
 v_cvt_pk_bf16_f32 v86, v76, v77
 v_cvt_pk_bf16_f32 v87, v78, v79
 s_waitcnt lgkmcnt(5)
 v_mfma_f32_32x32x16_bf16 v[48:63], v[16:19], a[32:35], v[48:63]
 ds_read_b128 v[40:43], v10 offset:448
 s_add_u32 m0, s45, 70176
 s_add_u32 s43, s44, 4096
 buffer_load_dwordx4 v2, s[36:39], s43 offen offset:0 lds
 s_waitcnt lgkmcnt(5)
 v_mfma_f32_32x32x16_bf16 v[48:63], v[20:23], a[36:39], v[48:63]
 ds_read_b128 v[44:47], v10 offset:480
 buffer_store_dwordx4 v[80:83], v2, s[4:7], s46 offen sc1
 s_waitcnt lgkmcnt(5)
 v_mfma_f32_32x32x16_bf16 v[48:63], v[24:27], a[40:43], v[48:63]
 ds_read_b128 v[16:19], v10 offset:512
 buffer_load_dwordx4 v2, s[36:39], s43 offen offset:1024 lds
 s_waitcnt lgkmcnt(5)
 v_mfma_f32_32x32x16_bf16 v[48:63], v[28:31], a[44:47], v[48:63]
 ds_read_b128 v[20:23], v10 offset:544
 buffer_store_dwordx4 v[84:87], v2, s[4:7], s46 offen offset:1024 sc1
 s_add_u32 s46, s46, 0x40000
 s_bitset0_b32 s46, 30
 s_waitcnt lgkmcnt(5)
 v_mfma_f32_32x32x16_bf16 v[48:63], v[32:35], a[48:51], v[48:63]
 ds_read_b128 v[24:27], v10 offset:576
 s_add_u32 m0, s45, 72240
 s_add_u32 s43, s44, 6144
 buffer_load_dwordx4 v2, s[36:39], s43 offen offset:0 lds
 s_waitcnt lgkmcnt(5)
 v_mfma_f32_32x32x16_bf16 v[48:63], v[36:39], a[52:55], v[48:63]
 ds_read_b128 v[28:31], v10 offset:608
 s_load_dwordx4 s[60:63], s[4:5], s47 offset:4096 glc
 s_waitcnt lgkmcnt(5)
 v_mfma_f32_32x32x16_bf16 v[48:63], v[40:43], a[56:59], v[48:63]
 ds_read_b128 v[32:35], v10 offset:640
 buffer_load_dwordx4 v2, s[36:39], s43 offen offset:1024 lds
 s_waitcnt lgkmcnt(5)
 v_mfma_f32_32x32x16_bf16 v[48:63], v[44:47], a[60:63], v[48:63]
 ds_read_b128 v[36:39], v10 offset:672
 s_waitcnt lgkmcnt(5)
 v_mfma_f32_32x32x16_bf16 v[48:63], v[16:19], a[64:67], v[48:63]
 ds_read_b128 v[40:43], v10 offset:704
 s_add_u32 m0, s45, 74304
 s_add_u32 s43, s44, 8192
 buffer_load_dwordx4 v2, s[36:39], s43 offen offset:0 lds
 s_waitcnt lgkmcnt(5)
 v_mfma_f32_32x32x16_bf16 v[48:63], v[20:23], a[68:71], v[48:63]
 ds_read_b128 v[44:47], v10 offset:736
 s_waitcnt lgkmcnt(5)
 v_mfma_f32_32x32x16_bf16 v[48:63], v[24:27], a[72:75], v[48:63]
 ds_read_b128 v[16:19], v10 offset:768
 buffer_load_dwordx4 v2, s[36:39], s43 offen offset:1024 lds
 s_waitcnt lgkmcnt(5)
 v_mfma_f32_32x32x16_bf16 v[48:63], v[28:31], a[76:79], v[48:63]
 ds_read_b128 v[20:23], v10 offset:800
 s_waitcnt lgkmcnt(5)
 v_mfma_f32_32x32x16_bf16 v[48:63], v[32:35], a[80:83], v[48:63]
 ds_read_b128 v[24:27], v10 offset:832
 s_add_u32 m0, s45, 76368
 s_add_u32 s43, s44, 10240
 buffer_load_dwordx4 v2, s[36:39], s43 offen offset:0 lds
 s_waitcnt lgkmcnt(5)
 v_mfma_f32_32x32x16_bf16 v[48:63], v[36:39], a[84:87], v[48:63]
 ds_read_b128 v[28:31], v10 offset:864
 s_waitcnt lgkmcnt(5)
 v_mfma_f32_32x32x16_bf16 v[48:63], v[40:43], a[88:91], v[48:63]
 ds_read_b128 v[32:35], v10 offset:896
 buffer_load_dwordx4 v2, s[36:39], s43 offen offset:1024 lds
 s_waitcnt lgkmcnt(5)
 v_mfma_f32_32x32x16_bf16 v[48:63], v[44:47], a[92:95], v[48:63]
 ds_read_b128 v[36:39], v10 offset:928
 s_waitcnt lgkmcnt(5)
 v_mfma_f32_32x32x16_bf16 v[48:63], v[16:19], a[96:99], v[48:63]
 ds_read_b128 v[40:43], v10 offset:960
 s_add_u32 m0, s45, 78432
 s_add_u32 s43, s44, 12288
 buffer_load_dwordx4 v2, s[36:39], s43 offen offset:0 lds
 s_waitcnt lgkmcnt(5)
 v_mfma_f32_32x32x16_bf16 v[48:63], v[20:23], a[100:103], v[48:63]
 ds_read_b128 v[44:47], v10 offset:992
 s_waitcnt vmcnt(15)
 buffer_store_dword v252, v14, s[4:7], s53 offen sc1
 s_mov_b32 s53, 0x40000000
 s_waitcnt lgkmcnt(5)
 v_mfma_f32_32x32x16_bf16 v[48:63], v[24:27], a[104:107], v[48:63]
 ds_read_b128 v[16:19], v10 offset:1024
 buffer_load_dwordx4 v2, s[36:39], s43 offen offset:1024 lds
 s_waitcnt lgkmcnt(5)
 v_mfma_f32_32x32x16_bf16 v[48:63], v[28:31], a[108:111], v[48:63]
 ds_read_b128 v[20:23], v10 offset:1056
 s_waitcnt lgkmcnt(5)
 v_mfma_f32_32x32x16_bf16 v[48:63], v[32:35], a[112:115], v[48:63]
 ds_read_b128 v[24:27], v10 offset:1088
 s_add_u32 m0, s45, 80496
 s_add_u32 s43, s44, 14336
 buffer_load_dwordx4 v2, s[36:39], s43 offen offset:0 lds
 s_waitcnt lgkmcnt(5)
 v_mfma_f32_32x32x16_bf16 v[48:63], v[36:39], a[116:119], v[48:63]
 ds_read_b128 v[28:31], v10 offset:1120
 s_waitcnt lgkmcnt(5)
 v_mfma_f32_32x32x16_bf16 v[48:63], v[40:43], a[120:123], v[48:63]
 ds_read_b128 v[32:35], v10 offset:1152
 buffer_load_dwordx4 v2, s[36:39], s43 offen offset:1024 lds
 s_waitcnt lgkmcnt(5)
 v_mfma_f32_32x32x16_bf16 v[48:63], v[44:47], a[124:127], v[48:63]
 ds_read_b128 v[36:39], v10 offset:1184
 s_waitcnt lgkmcnt(5)
 v_mfma_f32_32x32x16_bf16 v[48:63], v[16:19], a[128:131], v[48:63]
 ds_read_b128 v[40:43], v10 offset:1216
 s_waitcnt lgkmcnt(5)
 v_mfma_f32_32x32x16_bf16 v[48:63], v[20:23], a[132:135], v[48:63]
 ds_read_b128 v[44:47], v10 offset:1248
 s_waitcnt lgkmcnt(5)
 v_mfma_f32_32x32x16_bf16 v[48:63], v[24:27], a[136:139], v[48:63]
 ds_read_b128 v[16:19], v10 offset:1280
 s_waitcnt lgkmcnt(5)
 v_mfma_f32_32x32x16_bf16 v[48:63], v[28:31], a[140:143], v[48:63]
 ds_read_b128 v[20:23], v10 offset:1312
 s_load_dwordx4 s[56:59], s[4:5], s47 glc
 s_waitcnt lgkmcnt(5)
 v_mfma_f32_32x32x16_bf16 v[48:63], v[32:35], a[144:147], v[48:63]
 ds_read_b128 v[24:27], v10 offset:1344
 s_waitcnt lgkmcnt(5)
 v_mfma_f32_32x32x16_bf16 v[48:63], v[36:39], a[148:151], v[48:63]
 ds_read_b128 v[28:31], v10 offset:1376
 v_mov_b32 v9, s40
 s_waitcnt vmcnt(11)
 buffer_store_dword v9, v8, s[4:7], 0 offen sc1
 s_waitcnt lgkmcnt(5)
 v_mfma_f32_32x32x16_bf16 v[48:63], v[40:43], a[152:155], v[48:63]
 ds_read_b128 v[32:35], v10 offset:1408
 s_waitcnt lgkmcnt(5)
 v_mfma_f32_32x32x16_bf16 v[48:63], v[44:47], a[156:159], v[48:63]
 ds_read_b128 v[36:39], v10 offset:1440
 s_waitcnt lgkmcnt(5)
 v_mfma_f32_32x32x16_bf16 v[48:63], v[16:19], a[160:163], v[48:63]
 ds_read_b128 v[40:43], v10 offset:1472
 s_waitcnt lgkmcnt(5)
 v_mfma_f32_32x32x16_bf16 v[48:63], v[20:23], a[164:167], v[48:63]
 ds_read_b128 v[44:47], v10 offset:1504
 s_waitcnt lgkmcnt(5)
 v_mfma_f32_32x32x16_bf16 v[48:63], v[24:27], a[168:171], v[48:63]
 ds_read_b128 v[16:19], v10 offset:1536
 s_waitcnt lgkmcnt(5)
 v_mfma_f32_32x32x16_bf16 v[48:63], v[28:31], a[172:175], v[48:63]
 ds_read_b128 v[20:23], v10 offset:1568
 s_waitcnt lgkmcnt(5)
 v_mfma_f32_32x32x16_bf16 v[48:63], v[32:35], a[176:179], v[48:63]
 ds_read_b128 v[24:27], v10 offset:1600
 s_waitcnt lgkmcnt(5)
 v_mfma_f32_32x32x16_bf16 v[48:63], v[36:39], a[180:183], v[48:63]
 ds_read_b128 v[28:31], v10 offset:1632
 s_waitcnt lgkmcnt(5)
 v_mfma_f32_32x32x16_bf16 v[48:63], v[40:43], a[184:187], v[48:63]
 ds_read_b128 v[32:35], v10 offset:1664
 s_waitcnt lgkmcnt(5)
 v_mfma_f32_32x32x16_bf16 v[48:63], v[44:47], a[188:191], v[48:63]
 ds_read_b128 v[36:39], v10 offset:1696
 s_waitcnt lgkmcnt(5)
 v_mfma_f32_32x32x16_bf16 v[48:63], v[16:19], a[192:195], v[48:63]
 ds_read_b128 v[40:43], v10 offset:1728
 s_waitcnt lgkmcnt(5)
 v_mfma_f32_32x32x16_bf16 v[48:63], v[20:23], a[196:199], v[48:63]
 ds_read_b128 v[44:47], v10 offset:1760
 s_waitcnt lgkmcnt(5)
 v_mfma_f32_32x32x16_bf16 v[48:63], v[24:27], a[200:203], v[48:63]
 ds_read_b128 v[16:19], v10 offset:1792
 s_waitcnt lgkmcnt(5)
 v_mfma_f32_32x32x16_bf16 v[48:63], v[28:31], a[204:207], v[48:63]
 ds_read_b128 v[20:23], v10 offset:1824
 s_waitcnt lgkmcnt(5)
 v_mfma_f32_32x32x16_bf16 v[48:63], v[32:35], a[208:211], v[48:63]
 ds_read_b128 v[24:27], v10 offset:1856
 s_waitcnt lgkmcnt(5)
 v_mfma_f32_32x32x16_bf16 v[48:63], v[36:39], a[212:215], v[48:63]
 ds_read_b128 v[28:31], v10 offset:1888
 s_waitcnt lgkmcnt(5)
 v_mfma_f32_32x32x16_bf16 v[48:63], v[40:43], a[216:219], v[48:63]
 ds_read_b128 v[32:35], v10 offset:1920
 s_waitcnt lgkmcnt(5)
 v_mfma_f32_32x32x16_bf16 v[48:63], v[44:47], a[220:223], v[48:63]
 ds_read_b128 v[36:39], v10 offset:1952
 s_waitcnt lgkmcnt(5)
 v_mfma_f32_32x32x16_bf16 v[48:63], v[16:19], a[224:227], v[48:63]
 ds_read_b128 v[40:43], v10 offset:1984
 s_waitcnt lgkmcnt(5)
 v_mfma_f32_32x32x16_bf16 v[48:63], v[20:23], a[228:231], v[48:63]
 ds_read_b128 v[44:47], v10 offset:2016
 s_add_u32 s40, s40, 1
 s_mov_b32 s54, 0
 s_waitcnt lgkmcnt(5)
 v_mfma_f32_32x32x16_bf16 v[48:63], v[24:27], a[232:235], v[48:63]
 s_waitcnt lgkmcnt(4)
 v_mfma_f32_32x32x16_bf16 v[48:63], v[28:31], a[236:239], v[48:63]
 s_waitcnt lgkmcnt(0)
 s_waitcnt vmcnt(1)
 s_barrier
 ds_read_b128 v[16:19], v11 offset:0
 ds_read_b128 v[20:23], v11 offset:32
 v_mfma_f32_32x32x16_bf16 v[48:63], v[32:35], a[240:243], v[48:63]
 ds_read_b128 v[24:27], v11 offset:64
 ds_read_b128 v[28:31], v11 offset:96
 v_mfma_f32_32x32x16_bf16 v[48:63], v[36:39], a[244:247], v[48:63]
 ds_read_b128 v[32:35], v11 offset:128
 ds_read_b128 v[36:39], v11 offset:160
 v_mfma_f32_32x32x16_bf16 v[48:63], v[40:43], a[248:251], v[48:63]
 s_min_u32 s52, s56, s57
 s_min_u32 s52, s52, s58
 s_min_u32 s52, s52, s59
 s_min_u32 s52, s52, s60
 v_mfma_f32_32x32x16_bf16 v[48:63], v[44:47], a[252:255], v[48:63]
 s_min_u32 s52, s52, s61
 s_min_u32 s52, s52, s62
 s_min_u32 s52, s52, s63
 s_cmp_gt_u32 s52, s50
 s_cbranch_scc1 L_rV_att
L_rV_ret0:
 s_waitcnt lgkmcnt(5)
 v_mfma_f32_32x32x16_bf16 v[64:79], v[16:19], a[0:3], 0
 ds_read_b128 v[40:43], v11 offset:192
 s_add_u32 s44, s44, 65536
 s_add_u32 m0, s45, 0
 s_add_u32 s43, s44, 0
 buffer_load_dwordx4 v2, s[36:39], s43 offen offset:0 lds
 s_waitcnt lgkmcnt(5)
 v_mfma_f32_32x32x16_bf16 v[64:79], v[20:23], a[4:7], v[64:79]
 ds_read_b128 v[44:47], v11 offset:224
 s_waitcnt lgkmcnt(5)
 v_mfma_f32_32x32x16_bf16 v[64:79], v[24:27], a[8:11], v[64:79]
 ds_read_b128 v[16:19], v11 offset:256
 buffer_load_dwordx4 v2, s[36:39], s43 offen offset:1024 lds
 s_waitcnt lgkmcnt(5)
 v_mfma_f32_32x32x16_bf16 v[64:79], v[28:31], a[12:15], v[64:79]
 ds_read_b128 v[20:23], v11 offset:288
 s_waitcnt lgkmcnt(5)
 v_mfma_f32_32x32x16_bf16 v[64:79], v[32:35], a[16:19], v[64:79]
 ds_read_b128 v[24:27], v11 offset:320
 s_add_u32 m0, s45, 2064
 s_add_u32 s43, s44, 2048
 buffer_load_dwordx4 v2, s[36:39], s43 offen offset:0 lds
 v_cvt_pk_bf16_f32 v80, v48, v49
 v_cvt_pk_bf16_f32 v81, v50, v51
 s_waitcnt lgkmcnt(5)
 v_mfma_f32_32x32x16_bf16 v[64:79], v[36:39], a[20:23], v[64:79]
 ds_read_b128 v[28:31], v11 offset:352
 v_cvt_pk_bf16_f32 v82, v52, v53
 v_cvt_pk_bf16_f32 v83, v54, v55
 s_waitcnt lgkmcnt(5)
 v_mfma_f32_32x32x16_bf16 v[64:79], v[40:43], a[24:27], v[64:79]
 ds_read_b128 v[32:35], v11 offset:384
 buffer_load_dwordx4 v2, s[36:39], s43 offen offset:1024 lds
 v_cvt_pk_bf16_f32 v84, v56, v57
 v_cvt_pk_bf16_f32 v85, v58, v59
 s_waitcnt lgkmcnt(5)
 v_mfma_f32_32x32x16_bf16 v[64:79], v[44:47], a[28:31], v[64:79]
 ds_read_b128 v[36:39], v11 offset:416
 v_cvt_pk_bf16_f32 v86, v60, v61
 v_cvt_pk_bf16_f32 v87, v62, v63
 s_waitcnt lgkmcnt(5)
 v_mfma_f32_32x32x16_bf16 v[64:79], v[16:19], a[32:35], v[64:79]
 ds_read_b128 v[40:43], v11 offset:448
 s_add_u32 m0, s45, 4128
 s_add_u32 s43, s44, 4096
 buffer_load_dwordx4 v2, s[36:39], s43 offen offset:0 lds
 s_waitcnt lgkmcnt(5)
 v_mfma_f32_32x32x16_bf16 v[64:79], v[20:23], a[36:39], v[64:79]
 ds_read_b128 v[44:47], v11 offset:480
 buffer_store_dwordx4 v[80:83], v2, s[4:7], s46 offen sc1
 s_waitcnt lgkmcnt(5)
 v_mfma_f32_32x32x16_bf16 v[64:79], v[24:27], a[40:43], v[64:79]
 ds_read_b128 v[16:19], v11 offset:512
 buffer_load_dwordx4 v2, s[36:39], s43 offen offset:1024 lds
 s_waitcnt lgkmcnt(5)
 v_mfma_f32_32x32x16_bf16 v[64:79], v[28:31], a[44:47], v[64:79]
 ds_read_b128 v[20:23], v11 offset:544
 buffer_store_dwordx4 v[84:87], v2, s[4:7], s46 offen offset:1024 sc1
 s_add_u32 s46, s46, 0x40000
 s_bitset0_b32 s46, 30
 s_waitcnt lgkmcnt(5)
 v_mfma_f32_32x32x16_bf16 v[64:79], v[32:35], a[48:51], v[64:79]
 ds_read_b128 v[24:27], v11 offset:576
 s_add_u32 m0, s45, 6192
 s_add_u32 s43, s44, 6144
 buffer_load_dwordx4 v2, s[36:39], s43 offen offset:0 lds
 s_waitcnt lgkmcnt(5)
 v_mfma_f32_32x32x16_bf16 v[64:79], v[36:39], a[52:55], v[64:79]
 ds_read_b128 v[28:31], v11 offset:608
 s_load_dwordx4 s[60:63], s[4:5], s47 offset:4096 glc
 s_waitcnt lgkmcnt(5)
 v_mfma_f32_32x32x16_bf16 v[64:79], v[40:43], a[56:59], v[64:79]
 ds_read_b128 v[32:35], v11 offset:640
 buffer_load_dwordx4 v2, s[36:39], s43 offen offset:1024 lds
 s_waitcnt lgkmcnt(5)
 v_mfma_f32_32x32x16_bf16 v[64:79], v[44:47], a[60:63], v[64:79]
 ds_read_b128 v[36:39], v11 offset:672
 s_waitcnt lgkmcnt(5)
 v_mfma_f32_32x32x16_bf16 v[64:79], v[16:19], a[64:67], v[64:79]
 ds_read_b128 v[40:43], v11 offset:704
 s_add_u32 m0, s45, 8256
 s_add_u32 s43, s44, 8192
 buffer_load_dwordx4 v2, s[36:39], s43 offen offset:0 lds
 s_waitcnt lgkmcnt(5)
 v_mfma_f32_32x32x16_bf16 v[64:79], v[20:23], a[68:71], v[64:79]
 ds_read_b128 v[44:47], v11 offset:736
 s_waitcnt lgkmcnt(5)
 v_mfma_f32_32x32x16_bf16 v[64:79], v[24:27], a[72:75], v[64:79]
 ds_read_b128 v[16:19], v11 offset:768
 buffer_load_dwordx4 v2, s[36:39], s43 offen offset:1024 lds
 s_waitcnt lgkmcnt(5)
 v_mfma_f32_32x32x16_bf16 v[64:79], v[28:31], a[76:79], v[64:79]
 ds_read_b128 v[20:23], v11 offset:800
 s_waitcnt lgkmcnt(5)
 v_mfma_f32_32x32x16_bf16 v[64:79], v[32:35], a[80:83], v[64:79]
 ds_read_b128 v[24:27], v11 offset:832
 s_add_u32 m0, s45, 10320
 s_add_u32 s43, s44, 10240
 buffer_load_dwordx4 v2, s[36:39], s43 offen offset:0 lds
 s_waitcnt lgkmcnt(5)
 v_mfma_f32_32x32x16_bf16 v[64:79], v[36:39], a[84:87], v[64:79]
 ds_read_b128 v[28:31], v11 offset:864
 s_waitcnt lgkmcnt(5)
 v_mfma_f32_32x32x16_bf16 v[64:79], v[40:43], a[88:91], v[64:79]
 ds_read_b128 v[32:35], v11 offset:896
 buffer_load_dwordx4 v2, s[36:39], s43 offen offset:1024 lds
 s_waitcnt lgkmcnt(5)
 v_mfma_f32_32x32x16_bf16 v[64:79], v[44:47], a[92:95], v[64:79]
 ds_read_b128 v[36:39], v11 offset:928
 s_waitcnt lgkmcnt(5)
 v_mfma_f32_32x32x16_bf16 v[64:79], v[16:19], a[96:99], v[64:79]
 ds_read_b128 v[40:43], v11 offset:960
 s_add_u32 m0, s45, 12384
 s_add_u32 s43, s44, 12288
 buffer_load_dwordx4 v2, s[36:39], s43 offen offset:0 lds
 s_waitcnt lgkmcnt(5)
 v_mfma_f32_32x32x16_bf16 v[64:79], v[20:23], a[100:103], v[64:79]
 ds_read_b128 v[44:47], v11 offset:992
 s_waitcnt vmcnt(15)
 buffer_store_dword v252, v14, s[4:7], s53 offen sc1
 s_mov_b32 s53, 0x40000000
 s_waitcnt lgkmcnt(5)
 v_mfma_f32_32x32x16_bf16 v[64:79], v[24:27], a[104:107], v[64:79]
 ds_read_b128 v[16:19], v11 offset:1024
 buffer_load_dwordx4 v2, s[36:39], s43 offen offset:1024 lds
 s_waitcnt lgkmcnt(5)
 v_mfma_f32_32x32x16_bf16 v[64:79], v[28:31], a[108:111], v[64:79]
 ds_read_b128 v[20:23], v11 offset:1056
 s_waitcnt lgkmcnt(5)
 v_mfma_f32_32x32x16_bf16 v[64:79], v[32:35], a[112:115], v[64:79]
 ds_read_b128 v[24:27], v11 offset:1088
 s_add_u32 m0, s45, 14448
 s_add_u32 s43, s44, 14336
 buffer_load_dwordx4 v2, s[36:39], s43 offen offset:0 lds
 s_waitcnt lgkmcnt(5)
 v_mfma_f32_32x32x16_bf16 v[64:79], v[36:39], a[116:119], v[64:79]
 ds_read_b128 v[28:31], v11 offset:1120
 s_waitcnt lgkmcnt(5)
 v_mfma_f32_32x32x16_bf16 v[64:79], v[40:43], a[120:123], v[64:79]
 ds_read_b128 v[32:35], v11 offset:1152
 buffer_load_dwordx4 v2, s[36:39], s43 offen offset:1024 lds
 s_waitcnt lgkmcnt(5)
 v_mfma_f32_32x32x16_bf16 v[64:79], v[44:47], a[124:127], v[64:79]
 ds_read_b128 v[36:39], v11 offset:1184
 s_waitcnt lgkmcnt(5)
 v_mfma_f32_32x32x16_bf16 v[64:79], v[16:19], a[128:131], v[64:79]
 ds_read_b128 v[40:43], v11 offset:1216
 s_waitcnt lgkmcnt(5)
 v_mfma_f32_32x32x16_bf16 v[64:79], v[20:23], a[132:135], v[64:79]
 ds_read_b128 v[44:47], v11 offset:1248
 s_waitcnt lgkmcnt(5)
 v_mfma_f32_32x32x16_bf16 v[64:79], v[24:27], a[136:139], v[64:79]
 ds_read_b128 v[16:19], v11 offset:1280
 s_waitcnt lgkmcnt(5)
 v_mfma_f32_32x32x16_bf16 v[64:79], v[28:31], a[140:143], v[64:79]
 ds_read_b128 v[20:23], v11 offset:1312
 s_load_dwordx4 s[56:59], s[4:5], s47 glc
 s_waitcnt lgkmcnt(5)
 v_mfma_f32_32x32x16_bf16 v[64:79], v[32:35], a[144:147], v[64:79]
 ds_read_b128 v[24:27], v11 offset:1344
 s_waitcnt lgkmcnt(5)
 v_mfma_f32_32x32x16_bf16 v[64:79], v[36:39], a[148:151], v[64:79]
 ds_read_b128 v[28:31], v11 offset:1376
 v_mov_b32 v9, s40
 s_waitcnt vmcnt(11)
 buffer_store_dword v9, v8, s[4:7], 0 offen sc1
 s_waitcnt lgkmcnt(5)
 v_mfma_f32_32x32x16_bf16 v[64:79], v[40:43], a[152:155], v[64:79]
 ds_read_b128 v[32:35], v11 offset:1408
 s_waitcnt lgkmcnt(5)
 v_mfma_f32_32x32x16_bf16 v[64:79], v[44:47], a[156:159], v[64:79]
 ds_read_b128 v[36:39], v11 offset:1440
 s_waitcnt lgkmcnt(5)
 v_mfma_f32_32x32x16_bf16 v[64:79], v[16:19], a[160:163], v[64:79]
 ds_read_b128 v[40:43], v11 offset:1472
 s_waitcnt lgkmcnt(5)
 v_mfma_f32_32x32x16_bf16 v[64:79], v[20:23], a[164:167], v[64:79]
 ds_read_b128 v[44:47], v11 offset:1504
 s_waitcnt lgkmcnt(5)
 v_mfma_f32_32x32x16_bf16 v[64:79], v[24:27], a[168:171], v[64:79]
 ds_read_b128 v[16:19], v11 offset:1536
 s_waitcnt lgkmcnt(5)
 v_mfma_f32_32x32x16_bf16 v[64:79], v[28:31], a[172:175], v[64:79]
 ds_read_b128 v[20:23], v11 offset:1568
 s_waitcnt lgkmcnt(5)
 v_mfma_f32_32x32x16_bf16 v[64:79], v[32:35], a[176:179], v[64:79]
 ds_read_b128 v[24:27], v11 offset:1600
 s_waitcnt lgkmcnt(5)
 v_mfma_f32_32x32x16_bf16 v[64:79], v[36:39], a[180:183], v[64:79]
 ds_read_b128 v[28:31], v11 offset:1632
 s_waitcnt lgkmcnt(5)
 v_mfma_f32_32x32x16_bf16 v[64:79], v[40:43], a[184:187], v[64:79]
 ds_read_b128 v[32:35], v11 offset:1664
 s_waitcnt lgkmcnt(5)
 v_mfma_f32_32x32x16_bf16 v[64:79], v[44:47], a[188:191], v[64:79]
 ds_read_b128 v[36:39], v11 offset:1696
 s_waitcnt lgkmcnt(5)
 v_mfma_f32_32x32x16_bf16 v[64:79], v[16:19], a[192:195], v[64:79]
 ds_read_b128 v[40:43], v11 offset:1728
 s_waitcnt lgkmcnt(5)
 v_mfma_f32_32x32x16_bf16 v[64:79], v[20:23], a[196:199], v[64:79]
 ds_read_b128 v[44:47], v11 offset:1760
 s_waitcnt lgkmcnt(5)
 v_mfma_f32_32x32x16_bf16 v[64:79], v[24:27], a[200:203], v[64:79]
 ds_read_b128 v[16:19], v11 offset:1792
 s_waitcnt lgkmcnt(5)
 v_mfma_f32_32x32x16_bf16 v[64:79], v[28:31], a[204:207], v[64:79]
 ds_read_b128 v[20:23], v11 offset:1824
 s_waitcnt lgkmcnt(5)
 v_mfma_f32_32x32x16_bf16 v[64:79], v[32:35], a[208:211], v[64:79]
 ds_read_b128 v[24:27], v11 offset:1856
 s_waitcnt lgkmcnt(5)
 v_mfma_f32_32x32x16_bf16 v[64:79], v[36:39], a[212:215], v[64:79]
 ds_read_b128 v[28:31], v11 offset:1888
 s_waitcnt lgkmcnt(5)
 v_mfma_f32_32x32x16_bf16 v[64:79], v[40:43], a[216:219], v[64:79]
 ds_read_b128 v[32:35], v11 offset:1920
 s_waitcnt lgkmcnt(5)
 v_mfma_f32_32x32x16_bf16 v[64:79], v[44:47], a[220:223], v[64:79]
 ds_read_b128 v[36:39], v11 offset:1952
 s_waitcnt lgkmcnt(5)
 v_mfma_f32_32x32x16_bf16 v[64:79], v[16:19], a[224:227], v[64:79]
 ds_read_b128 v[40:43], v11 offset:1984
 s_waitcnt lgkmcnt(5)
 v_mfma_f32_32x32x16_bf16 v[64:79], v[20:23], a[228:231], v[64:79]
 ds_read_b128 v[44:47], v11 offset:2016
 s_add_u32 s40, s40, 1
 s_mov_b32 s54, 1
 s_waitcnt lgkmcnt(5)
 v_mfma_f32_32x32x16_bf16 v[64:79], v[24:27], a[232:235], v[64:79]
 s_waitcnt lgkmcnt(4)
 v_mfma_f32_32x32x16_bf16 v[64:79], v[28:31], a[236:239], v[64:79]
 s_waitcnt lgkmcnt(0)
 s_waitcnt vmcnt(1)
 s_barrier
 ds_read_b128 v[16:19], v10 offset:0
 ds_read_b128 v[20:23], v10 offset:32
 v_mfma_f32_32x32x16_bf16 v[64:79], v[32:35], a[240:243], v[64:79]
 ds_read_b128 v[24:27], v10 offset:64
 ds_read_b128 v[28:31], v10 offset:96
 v_mfma_f32_32x32x16_bf16 v[64:79], v[36:39], a[244:247], v[64:79]
 ds_read_b128 v[32:35], v10 offset:128
 ds_read_b128 v[36:39], v10 offset:160
 v_mfma_f32_32x32x16_bf16 v[64:79], v[40:43], a[248:251], v[64:79]
 s_min_u32 s52, s56, s57
 s_min_u32 s52, s52, s58
 s_min_u32 s52, s52, s59
 s_min_u32 s52, s52, s60
 v_mfma_f32_32x32x16_bf16 v[64:79], v[44:47], a[252:255], v[64:79]
 s_min_u32 s52, s52, s61
 s_min_u32 s52, s52, s62
 s_min_u32 s52, s52, s63
 s_cmp_gt_u32 s52, s50
 s_cbranch_scc1 L_rV_att
L_rV_ret1:
 s_cmp_lt_u32 s40, 64
 s_cbranch_scc1 L_rV_loop
 s_nop 11
 v_cvt_pk_bf16_f32 v80, v64, v65
 v_cvt_pk_bf16_f32 v81, v66, v67
 v_cvt_pk_bf16_f32 v82, v68, v69
 v_cvt_pk_bf16_f32 v83, v70, v71
 v_cvt_pk_bf16_f32 v84, v72, v73
 v_cvt_pk_bf16_f32 v85, v74, v75
 v_cvt_pk_bf16_f32 v86, v76, v77
 v_cvt_pk_bf16_f32 v87, v78, v79
 buffer_store_dwordx4 v[80:83], v2, s[4:7], s46 offen sc1
 buffer_store_dwordx4 v[84:87], v2, s[4:7], s46 offen offset:1024 sc1
 s_add_u32 s46, s46, 0x40000
 v_mov_b32 v9, 64
 s_mov_b32 s54, 2
L_rV_ret2:
 s_waitcnt vmcnt(0) lgkmcnt(0)
 buffer_store_dword v9, v8, s[4:7], 0 offen sc1
 buffer_store_dword v252, v14, s[4:7], s53 offen sc1
 s_mov_b32 s53, 0x40000000
 s_cmp_ge_u32 s50, 64
 s_cbranch_scc1 L_rV_end
L_rV_att:
L_rV_wm1:
 s_min_u32 s52, s56, s57
 s_min_u32 s52, s52, s58
 s_min_u32 s52, s52, s59
 s_max_u32 s41, s50, 1
 s_cmp_ge_u32 s52, s41
 s_cbranch_scc1 L_rV_wm1ok
 s_sleep 12
 s_load_dwordx4 s[56:59], s[4:5], s47 glc
 s_add_u32 s48, s48, 1
 s_cmp_gt_u32 s48, 400000
 s_cbranch_scc1 L_done
 s_waitcnt lgkmcnt(0)
 s_branch L_rV_wm1
L_rV_wm1ok:
 s_lshl_b32 s42, s50, 5
 s_add_u32 s42, s42, s51
 s_lshl_b32 s49, s42, 13
 s_add_u32 s43, s49, 16777216
 buffer_load_dwordx4 v[80:83], v6, s[4:7], s43 offen offset:0 sc1
 buffer_load_dwordx4 v[84:87], v6, s[4:7], s43 offen offset:1024 sc1
 buffer_load_dwordx4 v[88:91], v6, s[4:7], s43 offen offset:2048 sc1
 buffer_load_dwordx4 v[92:95], v6, s[4:7], s43 offen offset:3072 sc1
 s_add_u32 s43, s49, 16781312
 buffer_load_dwordx4 v[96:99], v6, s[4:7], s43 offen offset:0 sc1
 buffer_load_dwordx4 v[100:103], v6, s[4:7], s43 offen offset:1024 sc1
 buffer_load_dwordx4 v[104:107], v6, s[4:7], s43 offen offset:2048 sc1
 buffer_load_dwordx4 v[108:111], v6, s[4:7], s43 offen offset:3072 sc1
L_rV_wq:
 s_min_u32 s41, s60, s61
 s_min_u32 s41, s41, s62
 s_min_u32 s41, s41, s63
 s_cmp_gt_u32 s41, s50
 s_cbranch_scc1 L_rV_wqok
 s_load_dwordx4 s[60:63], s[4:5], s47 offset:4096 glc
 s_add_u32 s48, s48, 1
 s_cmp_gt_u32 s48, 400000
 s_cbranch_scc1 L_done
 s_waitcnt lgkmcnt(0)
 s_branch L_rV_wq
L_rV_wqok:
 s_add_u32 s43, s49, 50331648
 buffer_load_dwordx4 v[144:147], v2, s[4:7], s43 offen offset:0 sc1
 buffer_load_dwordx4 v[148:151], v2, s[4:7], s43 offen offset:1024 sc1
 buffer_load_dwordx4 v[152:155], v2, s[4:7], s43 offen offset:2048 sc1
 buffer_load_dwordx4 v[156:159], v2, s[4:7], s43 offen offset:3072 sc1
 s_add_u32 s43, s49, 50335744
 buffer_load_dwordx4 v[160:163], v2, s[4:7], s43 offen offset:0 sc1
 buffer_load_dwordx4 v[164:167], v2, s[4:7], s43 offen offset:1024 sc1
 buffer_load_dwordx4 v[168:171], v2, s[4:7], s43 offen offset:2048 sc1
 buffer_load_dwordx4 v[172:175], v2, s[4:7], s43 offen offset:3072 sc1
 s_add_u32 s43, s49, 33554432
 buffer_load_dwordx4 v[176:179], v6, s[4:7], s43 offen offset:0 sc1
 buffer_load_dwordx4 v[180:183], v6, s[4:7], s43 offen offset:1024 sc1
 buffer_load_dwordx4 v[184:187], v6, s[4:7], s43 offen offset:2048 sc1
 buffer_load_dwordx4 v[188:191], v6, s[4:7], s43 offen offset:3072 sc1
 s_add_u32 s43, s49, 33558528
 buffer_load_dwordx4 v[192:195], v6, s[4:7], s43 offen offset:0 sc1
 buffer_load_dwordx4 v[196:199], v6, s[4:7], s43 offen offset:1024 sc1
 buffer_load_dwordx4 v[200:203], v6, s[4:7], s43 offen offset:2048 sc1
 buffer_load_dwordx4 v[204:207], v6, s[4:7], s43 offen offset:3072 sc1
L_rV_wm2:
 s_min_u32 s41, s56, s57
 s_min_u32 s41, s41, s58
 s_min_u32 s41, s41, s59
 s_cmp_gt_u32 s41, s50
 s_cbranch_scc1 L_rV_wm2ok
 s_load_dwordx4 s[56:59], s[4:5], s47 glc
 s_add_u32 s48, s48, 1
 s_cmp_gt_u32 s48, 400000
 s_cbranch_scc1 L_done
 s_waitcnt lgkmcnt(0)
 s_branch L_rV_wm2
L_rV_wm2ok:
 s_lshr_b32 s42, s49, 2
 s_add_u32 s43, s42, 4194304
 buffer_load_dwordx4 v[112:115], v12, s[4:7], s43 offen offset:0 sc1
 buffer_load_dwordx4 v[116:119], v12, s[4:7], s43 offen offset:256 sc1
 buffer_load_dwordx4 v[120:123], v12, s[4:7], s43 offen offset:512 sc1
 buffer_load_dwordx4 v[124:127], v12, s[4:7], s43 offen offset:768 sc1
 buffer_load_dwordx4 v[128:131], v12, s[4:7], s43 offen offset:1024 sc1
 buffer_load_dwordx4 v[132:135], v12, s[4:7], s43 offen offset:1280 sc1
 buffer_load_dwordx4 v[136:139], v12, s[4:7], s43 offen offset:1536 sc1
 buffer_load_dwordx4 v[140:143], v12, s[4:7], s43 offen offset:1792 sc1
 s_add_u32 s43, s42, 8388608
 buffer_load_dword v208, v13, s[4:7], s43 offen offset:0 sc1
 buffer_load_dword v209, v13, s[4:7], s43 offen offset:64 sc1
 buffer_load_dword v210, v13, s[4:7], s43 offen offset:512 sc1
 buffer_load_dword v211, v13, s[4:7], s43 offen offset:576 sc1
 buffer_load_dword v212, v13, s[4:7], s43 offen offset:1024 sc1
 buffer_load_dword v213, v13, s[4:7], s43 offen offset:1088 sc1
 buffer_load_dword v214, v13, s[4:7], s43 offen offset:1536 sc1
 buffer_load_dword v215, v13, s[4:7], s43 offen offset:1600 sc1
 s_lshl_b32 s53, s50, 11
 s_add_u32 s53, s53, s55
 s_waitcnt vmcnt(24)
 v_mfma_f32_32x32x16_bf16 v[216:231], v[80:83], v[144:147], v[232:247]
 v_mfma_f32_32x32x16_bf16 v[216:231], v[84:87], v[148:151], v[216:231]
 v_mfma_f32_32x32x16_bf16 v[216:231], v[88:91], v[152:155], v[216:231]
 v_mfma_f32_32x32x16_bf16 v[216:231], v[92:95], v[156:159], v[216:231]
 v_mfma_f32_32x32x16_bf16 v[216:231], v[96:99], v[160:163], v[216:231]
 v_mfma_f32_32x32x16_bf16 v[216:231], v[100:103], v[164:167], v[216:231]
 v_mfma_f32_32x32x16_bf16 v[216:231], v[104:107], v[168:171], v[216:231]
 v_mfma_f32_32x32x16_bf16 v[216:231], v[108:111], v[172:175], v[216:231]
 s_waitcnt vmcnt(8)
 v_mfma_f32_32x32x16_bf16 v[80:95], v[112:115], v[144:147], 0
 v_mfma_f32_32x32x16_bf16 v[80:95], v[116:119], v[148:151], v[80:95]
 v_mfma_f32_32x32x16_bf16 v[80:95], v[120:123], v[152:155], v[80:95]
 v_mfma_f32_32x32x16_bf16 v[80:95], v[124:127], v[156:159], v[80:95]
 v_mfma_f32_32x32x16_bf16 v[80:95], v[128:131], v[160:163], v[80:95]
 v_mfma_f32_32x32x16_bf16 v[80:95], v[132:135], v[164:167], v[80:95]
 v_mfma_f32_32x32x16_bf16 v[80:95], v[136:139], v[168:171], v[80:95]
 v_mfma_f32_32x32x16_bf16 v[80:95], v[140:143], v[172:175], v[80:95]
 s_nop 3
 v_max3_f32 v3, v216, v217, v218
 v_max3_f32 v3, v3, v219, v220
 v_max3_f32 v3, v3, v221, v222
 v_max3_f32 v3, v3, v223, v224
 v_max3_f32 v3, v3, v225, v226
 v_max3_f32 v3, v3, v227, v228
 v_max3_f32 v3, v3, v229, v230
 v_max_f32 v3, v3, v231
 v_max3_f32 v3, v3, v80, v81
 v_max3_f32 v3, v3, v82, v83
 v_mov_b32 v4, v3
 s_nop 1
 v_permlane32_swap_b32 v3, v4
 s_nop 0
 v_max_f32 v3, v3, v4
 v_mul_f32 v3, v248, v3
 v_fma_f32 v216, v216, v248, -v3
 v_fma_f32 v217, v217, v248, -v3
 v_fma_f32 v218, v218, v248, -v3
 v_fma_f32 v219, v219, v248, -v3
 v_fma_f32 v220, v220, v248, -v3
 v_fma_f32 v221, v221, v248, -v3
 v_fma_f32 v222, v222, v248, -v3
 v_fma_f32 v223, v223, v248, -v3
 v_fma_f32 v224, v224, v248, -v3
 v_fma_f32 v225, v225, v248, -v3
 v_fma_f32 v226, v226, v248, -v3
 v_fma_f32 v227, v227, v248, -v3
 v_fma_f32 v228, v228, v248, -v3
 v_fma_f32 v229, v229, v248, -v3
 v_fma_f32 v230, v230, v248, -v3
 v_fma_f32 v231, v231, v248, -v3
 v_fma_f32 v80, v80, v248, -v3
 v_fma_f32 v81, v81, v248, -v3
 v_fma_f32 v82, v82, v248, -v3
 v_fma_f32 v83, v83, v248, -v3
 v_exp_f32 v216, v216
 v_exp_f32 v217, v217
 v_exp_f32 v218, v218
 v_exp_f32 v219, v219
 v_exp_f32 v220, v220
 v_exp_f32 v221, v221
 v_exp_f32 v222, v222
 v_exp_f32 v223, v223
 v_exp_f32 v224, v224
 v_exp_f32 v225, v225
 v_exp_f32 v226, v226
 v_exp_f32 v227, v227
 v_exp_f32 v228, v228
 v_exp_f32 v229, v229
 v_exp_f32 v230, v230
 v_exp_f32 v231, v231
 v_exp_f32 v80, v80
 v_exp_f32 v81, v81
 v_exp_f32 v82, v82
 v_exp_f32 v83, v83
 v_pk_add_f32 v[250:251], v[216:217], v[218:219]
 v_pk_add_f32 v[250:251], v[250:251], v[220:221]
 v_pk_add_f32 v[250:251], v[250:251], v[222:223]
 v_pk_add_f32 v[250:251], v[250:251], v[224:225]
 v_pk_add_f32 v[250:251], v[250:251], v[226:227]
 v_pk_add_f32 v[250:251], v[250:251], v[228:229]
 v_pk_add_f32 v[250:251], v[250:251], v[230:231]
 v_pk_add_f32 v[250:251], v[250:251], v[80:81]
 v_pk_add_f32 v[250:251], v[250:251], v[82:83]
 v_add_f32 v3, v250, v251
 v_add_f32 v4, v250, v251
 s_nop 1
 v_permlane32_swap_b32 v3, v4
 s_nop 0
 v_add_f32 v3, v3, v4
 v_rcp_f32 v250, v3
 s_nop 0
 v_pk_mul_f32 v[216:217], v[216:217], v[250:251] op_sel_hi:[1,0]
 v_pk_mul_f32 v[218:219], v[218:219], v[250:251] op_sel_hi:[1,0]
 v_pk_mul_f32 v[220:221], v[220:221], v[250:251] op_sel_hi:[1,0]
 v_pk_mul_f32 v[222:223], v[222:223], v[250:251] op_sel_hi:[1,0]
 v_pk_mul_f32 v[224:225], v[224:225], v[250:251] op_sel_hi:[1,0]
 v_pk_mul_f32 v[226:227], v[226:227], v[250:251] op_sel_hi:[1,0]
 v_pk_mul_f32 v[228:229], v[228:229], v[250:251] op_sel_hi:[1,0]
 v_pk_mul_f32 v[230:231], v[230:231], v[250:251] op_sel_hi:[1,0]
 v_pk_mul_f32 v[80:81], v[80:81], v[250:251] op_sel_hi:[1,0]
 v_pk_mul_f32 v[82:83], v[82:83], v[250:251] op_sel_hi:[1,0]
 v_cvt_pk_bf16_f32 v144, v216, v217
 v_cvt_pk_bf16_f32 v145, v218, v219
 v_cvt_pk_bf16_f32 v146, v220, v221
 v_cvt_pk_bf16_f32 v147, v222, v223
 v_cvt_pk_bf16_f32 v148, v224, v225
 v_cvt_pk_bf16_f32 v149, v226, v227
 v_cvt_pk_bf16_f32 v150, v228, v229
 v_cvt_pk_bf16_f32 v151, v230, v231
 v_cvt_pk_bf16_f32 v152, v80, v81
 v_cvt_pk_bf16_f32 v153, v82, v83
 s_waitcnt vmcnt(0)
 s_add_u32 s43, s49, 67108864
 s_add_u32 s42, s43, 4096
 v_mfma_f32_32x32x16_bf16 v[80:95], v[176:179], v[144:147], 0
 v_mfma_f32_32x32x16_bf16 v[80:95], v[180:183], v[148:151], v[80:95]
 v_mfma_f32_32x32x8_bf16 v[80:95], v[208:209], v[152:153], v[80:95]
 v_mfma_f32_32x32x16_bf16 v[96:111], v[184:187], v[144:147], 0
 v_mfma_f32_32x32x16_bf16 v[96:111], v[188:191], v[148:151], v[96:111]
 v_mfma_f32_32x32x8_bf16 v[96:111], v[210:211], v[152:153], v[96:111]
 v_mfma_f32_32x32x16_bf16 v[112:127], v[192:195], v[144:147], 0
 v_mfma_f32_32x32x16_bf16 v[112:127], v[196:199], v[148:151], v[112:127]
 v_mfma_f32_32x32x8_bf16 v[112:127], v[212:213], v[152:153], v[112:127]
 v_mfma_f32_32x32x16_bf16 v[128:143], v[200:203], v[144:147], 0
 v_mfma_f32_32x32x16_bf16 v[128:143], v[204:207], v[148:151], v[128:143]
 v_mfma_f32_32x32x8_bf16 v[128:143], v[214:215], v[152:153], v[128:143]
 s_nop 2
 v_cvt_pk_bf16_f32 v176, v80, v81
 v_cvt_pk_bf16_f32 v177, v82, v83
 v_cvt_pk_bf16_f32 v178, v84, v85
 v_cvt_pk_bf16_f32 v179, v86, v87
 v_cvt_pk_bf16_f32 v180, v88, v89
 v_cvt_pk_bf16_f32 v181, v90, v91
 v_cvt_pk_bf16_f32 v182, v92, v93
 v_cvt_pk_bf16_f32 v183, v94, v95
 buffer_store_dwordx4 v[176:179], v2, s[4:7], s43 offen offset:0 sc1
 buffer_store_dwordx4 v[180:183], v2, s[4:7], s43 offen offset:1024 sc1
 v_cvt_pk_bf16_f32 v184, v96, v97
 v_cvt_pk_bf16_f32 v185, v98, v99
 v_cvt_pk_bf16_f32 v186, v100, v101
 v_cvt_pk_bf16_f32 v187, v102, v103
 v_cvt_pk_bf16_f32 v188, v104, v105
 v_cvt_pk_bf16_f32 v189, v106, v107
 v_cvt_pk_bf16_f32 v190, v108, v109
 v_cvt_pk_bf16_f32 v191, v110, v111
 buffer_store_dwordx4 v[184:187], v2, s[4:7], s43 offen offset:2048 sc1
 buffer_store_dwordx4 v[188:191], v2, s[4:7], s43 offen offset:3072 sc1
 v_cvt_pk_bf16_f32 v192, v112, v113
 v_cvt_pk_bf16_f32 v193, v114, v115
 v_cvt_pk_bf16_f32 v194, v116, v117
 v_cvt_pk_bf16_f32 v195, v118, v119
 v_cvt_pk_bf16_f32 v196, v120, v121
 v_cvt_pk_bf16_f32 v197, v122, v123
 v_cvt_pk_bf16_f32 v198, v124, v125
 v_cvt_pk_bf16_f32 v199, v126, v127
 buffer_store_dwordx4 v[192:195], v2, s[4:7], s42 offen offset:0 sc1
 buffer_store_dwordx4 v[196:199], v2, s[4:7], s42 offen offset:1024 sc1
 v_cvt_pk_bf16_f32 v200, v128, v129
 v_cvt_pk_bf16_f32 v201, v130, v131
 v_cvt_pk_bf16_f32 v202, v132, v133
 v_cvt_pk_bf16_f32 v203, v134, v135
 v_cvt_pk_bf16_f32 v204, v136, v137
 v_cvt_pk_bf16_f32 v205, v138, v139
 v_cvt_pk_bf16_f32 v206, v140, v141
 v_cvt_pk_bf16_f32 v207, v142, v143
 buffer_store_dwordx4 v[200:203], v2, s[4:7], s42 offen offset:2048 sc1
 buffer_store_dwordx4 v[204:207], v2, s[4:7], s42 offen offset:3072 sc1
 s_add_u32 s41, s50, 1
 v_mov_b32 v252, s41
 s_add_u32 s50, s50, 8
 s_cmp_lt_u32 s50, 48
 s_cselect_b32 s50, s50, 64
L_rV_back:
 s_cmp_eq_u32 s54, 0
 s_cbranch_scc1 L_rV_ret0
 s_cmp_eq_u32 s54, 1
 s_cbranch_scc1 L_rV_ret1
 s_branch L_rV_ret2
L_rV_end:
 s_waitcnt vmcnt(0) lgkmcnt(0)
 s_barrier
 s_branch L_conv_full
L_role_Q:
 s_mov_b64 s[8:9], s[16:17]
 s_mov_b32 s10, 8388608
 s_mov_b32 s11, 0x20000
 v_and_b32 v1, 63, v0
 v_lshrrev_b32 v12, 4, v1
 v_lshlrev_b32 v12, 13, v12
 v_and_b32 v3, 15, v1
 v_lshl_add_u32 v12, v3, 4, v12
 s_lshl_b32 s44, s25, 8
 s_lshl_b32 s42, s26, 18
 s_add_u32 s44, s44, s42
 s_lshl_b32 s45, s26, 13
 s_add_u32 s45, s45, 0
 s_add_u32 m0, s45, 0
 s_add_u32 s43, s44, 0
 buffer_load_dwordx4 v12, s[8:11], s43 offen  lds
 s_add_u32 m0, s45, 1024
 s_add_u32 s43, s44, 32768
 buffer_load_dwordx4 v12, s[8:11], s43 offen  lds
 s_add_u32 m0, s45, 2048
 s_add_u32 s43, s44, 65536
 buffer_load_dwordx4 v12, s[8:11], s43 offen  lds
 s_add_u32 m0, s45, 3072
 s_add_u32 s43, s44, 98304
 buffer_load_dwordx4 v12, s[8:11], s43 offen  lds
 s_add_u32 m0, s45, 4096
 s_add_u32 s43, s44, 131072
 buffer_load_dwordx4 v12, s[8:11], s43 offen  lds
 s_add_u32 m0, s45, 5120
 s_add_u32 s43, s44, 163840
 buffer_load_dwordx4 v12, s[8:11], s43 offen  lds
 s_add_u32 m0, s45, 6144
 s_add_u32 s43, s44, 196608
 buffer_load_dwordx4 v12, s[8:11], s43 offen  lds
 s_add_u32 m0, s45, 7168
 s_add_u32 s43, s44, 229376
 buffer_load_dwordx4 v12, s[8:11], s43 offen  lds
 v_and_b32 v1, 63, v0
 v_lshlrev_b32 v2, 4, v1
 v_bfrev_b32 v7, 1
 s_mov_b32 s48, 0
 v_and_b32 v5, 0x13, v1
 v_bfe_u32 v3, v1, 2, 1
 v_lshl_add_u32 v5, v3, 3, v5
 v_bfe_u32 v3, v1, 3, 1
 v_lshl_add_u32 v5, v3, 2, v5
 v_lshrrev_b32 v4, 5, v1
 v_lshlrev_b32 v3, 9, v4
 v_lshl_add_u32 v6, v5, 4, v3
 v_and_b32 v3, 31, v1
 v_mul_u32_u24 v3, 2064, v3
 v_lshl_add_u32 v10, v4, 4, v3
 v_add_u32 v11, 66048, v10
 s_lshr_b32 s50, s25, 3
 s_add_u32 s50, s50, 48
 s_and_b32 s51, s25, 7
 s_lshl_b32 s51, s51, 2
 s_add_u32 s51, s51, s26
 v_lshl_add_u32 v3, v1, 2, s50
 v_cmp_gt_u32 vcc, 64, v3
 s_lshr_b32 s41, s51, 1
 s_lshl_b32 s41, s41, 5
 s_and_b32 s42, s51, 1
 s_add_u32 s41, s41, s42
 s_lshl_b32 s41, s41, 2
 s_add_u32 s55, s41, 3932160
 v_lshl_add_u32 v3, v3, 11, s55
 v_cndmask_b32 v14, v7, v3, vcc
 s_lshl_b32 s41, s25, 7
 s_add_u32 s41, s41, 3743744
 s_lshl_b32 s42, s26, 2
 s_add_u32 s41, s41, s42
 v_mov_b32 v3, s41
 v_cmp_eq_u32 vcc, 0, v1
 v_mov_b32 v9, 0
 s_nop 0
 v_cndmask_b32 v8, v7, v3, vcc
 v_bfe_u32 v13, v1, 2, 2
 v_lshrrev_b32 v3, 5, v1
 v_lshl_add_u32 v13, v3, 3, v13
 v_lshlrev_b32 v13, 8, v13
 v_bfe_u32 v3, v1, 4, 1
 v_lshl_add_u32 v13, v3, 5, v13
 v_and_b32 v3, 1, v1
 v_lshl_add_u32 v13, v3, 4, v13
 v_bfe_u32 v3, v1, 1, 1
 v_lshl_add_u32 v13, v3, 3, v13
 s_lshl_b32 s43, s26, 6
 s_add_u32 s43, s43, 0
 v_add_u32 v13, s43, v13
 buffer_store_dword v9, v8, s[4:7], 0 offen sc1
 buffer_store_dword v9, v14, s[4:7], 0 offen sc1
 s_add_u32 m0, s45, 32768
 s_add_u32 s43, s44, 1048576
 buffer_load_dwordx4 v12, s[8:11], s43 offen  lds
 s_add_u32 m0, s45, 33792
 s_add_u32 s43, s44, 1081344
 buffer_load_dwordx4 v12, s[8:11], s43 offen  lds
 s_add_u32 m0, s45, 34816
 s_add_u32 s43, s44, 1114112
 buffer_load_dwordx4 v12, s[8:11], s43 offen  lds
 s_add_u32 m0, s45, 35840
 s_add_u32 s43, s44, 1146880
 buffer_load_dwordx4 v12, s[8:11], s43 offen  lds
 s_add_u32 m0, s45, 36864
 s_add_u32 s43, s44, 1179648
 buffer_load_dwordx4 v12, s[8:11], s43 offen  lds
 s_add_u32 m0, s45, 37888
 s_add_u32 s43, s44, 1212416
 buffer_load_dwordx4 v12, s[8:11], s43 offen  lds
 s_add_u32 m0, s45, 38912
 s_add_u32 s43, s44, 1245184
 buffer_load_dwordx4 v12, s[8:11], s43 offen  lds
 s_add_u32 m0, s45, 39936
 s_add_u32 s43, s44, 1277952
 buffer_load_dwordx4 v12, s[8:11], s43 offen  lds
 s_cmp_lg_u32 s26, 1
 s_cbranch_scc1 L_voted_5
 s_bfe_u32 s64, s2, 0x30003
 s_lshl_b32 s56, s64, 21
 s_lshr_b32 s57, s2, 6
 s_lshl_b32 s57, s57, 3
 s_and_b32 s58, s2, 7
 s_add_u32 s57, s57, s58
 s_lshl_b32 s57, s57, 8
 s_add_u32 s56, s56, s57
 s_add_u32 s56, s56, 135790592
 s_mov_b64 s[62:63], -1
 s_mov_b32 s65, 0
 s_waitcnt lgkmcnt(0)
L_voted_5_l:
 s_memtime s[58:59]
 s_load_dword s57, s[4:5], s56 glc
 s_waitcnt lgkmcnt(0)
 s_memtime s[60:61]
 s_xor_b32 s56, s56, 8192
 s_waitcnt lgkmcnt(0)
 s_sub_u32 s58, s60, s58
 s_min_u32 s58, s58, s62
 s_mov_b32 s62, s63
 s_mov_b32 s63, s58
 s_add_u32 s65, s65, 1
 s_cmp_lt_u32 s65, 8
 s_cbranch_scc1 L_voted_5_l
 s_cmp_lt_u32 s62, s63
 s_cselect_b32 s58, 1, 0
 s_xor_b32 s58, s58, s64
 s_bitcmp1_b32 s58, 0
 s_cselect_b32 s35, 0x10000, 1
L_voted_5:
 s_waitcnt vmcnt(10)
 s_barrier
 ds_read_b64_tr_b16 a[0:1], v13 offset:0
 ds_read_b64_tr_b16 a[2:3], v13 offset:1024
 ds_read_b64_tr_b16 a[4:5], v13 offset:4096
 ds_read_b64_tr_b16 a[6:7], v13 offset:5120
 ds_read_b64_tr_b16 a[8:9], v13 offset:8192
 ds_read_b64_tr_b16 a[10:11], v13 offset:9216
 ds_read_b64_tr_b16 a[12:13], v13 offset:12288
 ds_read_b64_tr_b16 a[14:15], v13 offset:13312
 s_waitcnt lgkmcnt(0)
 ds_read_b64_tr_b16 a[16:17], v13 offset:16384
 ds_read_b64_tr_b16 a[18:19], v13 offset:17408
 ds_read_b64_tr_b16 a[20:21], v13 offset:20480
 ds_read_b64_tr_b16 a[22:23], v13 offset:21504
 ds_read_b64_tr_b16 a[24:25], v13 offset:24576
 ds_read_b64_tr_b16 a[26:27], v13 offset:25600
 ds_read_b64_tr_b16 a[28:29], v13 offset:28672
 ds_read_b64_tr_b16 a[30:31], v13 offset:29696
 s_waitcnt lgkmcnt(0)
 s_barrier
 s_add_u32 m0, s45, 0
 s_add_u32 s43, s44, 2097152
 buffer_load_dwordx4 v12, s[8:11], s43 offen  lds
 s_add_u32 m0, s45, 1024
 s_add_u32 s43, s44, 2129920
 buffer_load_dwordx4 v12, s[8:11], s43 offen  lds
 s_add_u32 m0, s45, 2048
 s_add_u32 s43, s44, 2162688
 buffer_load_dwordx4 v12, s[8:11], s43 offen  lds
 s_add_u32 m0, s45, 3072
 s_add_u32 s43, s44, 2195456
 buffer_load_dwordx4 v12, s[8:11], s43 offen  lds
 s_add_u32 m0, s45, 4096
 s_add_u32 s43, s44, 2228224
 buffer_load_dwordx4 v12, s[8:11], s43 offen  lds
 s_add_u32 m0, s45, 5120
 s_add_u32 s43, s44, 2260992
 buffer_load_dwordx4 v12, s[8:11], s43 offen  lds
 s_add_u32 m0, s45, 6144
 s_add_u32 s43, s44, 2293760
 buffer_load_dwordx4 v12, s[8:11], s43 offen  lds
 s_add_u32 m0, s45, 7168
 s_add_u32 s43, s44, 2326528
 buffer_load_dwordx4 v12, s[8:11], s43 offen  lds
 s_waitcnt vmcnt(8)
 s_barrier
 ds_read_b64_tr_b16 a[32:33], v13 offset:32768
 ds_read_b64_tr_b16 a[34:35], v13 offset:33792
 ds_read_b64_tr_b16 a[36:37], v13 offset:36864
 ds_read_b64_tr_b16 a[38:39], v13 offset:37888
 ds_read_b64_tr_b16 a[40:41], v13 offset:40960
 ds_read_b64_tr_b16 a[42:43], v13 offset:41984
 ds_read_b64_tr_b16 a[44:45], v13 offset:45056
 ds_read_b64_tr_b16 a[46:47], v13 offset:46080
 s_waitcnt lgkmcnt(0)
 ds_read_b64_tr_b16 a[48:49], v13 offset:49152
 ds_read_b64_tr_b16 a[50:51], v13 offset:50176
 ds_read_b64_tr_b16 a[52:53], v13 offset:53248
 ds_read_b64_tr_b16 a[54:55], v13 offset:54272
 ds_read_b64_tr_b16 a[56:57], v13 offset:57344
 ds_read_b64_tr_b16 a[58:59], v13 offset:58368
 ds_read_b64_tr_b16 a[60:61], v13 offset:61440
 ds_read_b64_tr_b16 a[62:63], v13 offset:62464
 s_waitcnt lgkmcnt(0)
 s_barrier
 s_add_u32 m0, s45, 32768
 s_add_u32 s43, s44, 3145728
 buffer_load_dwordx4 v12, s[8:11], s43 offen  lds
 s_add_u32 m0, s45, 33792
 s_add_u32 s43, s44, 3178496
 buffer_load_dwordx4 v12, s[8:11], s43 offen  lds
 s_add_u32 m0, s45, 34816
 s_add_u32 s43, s44, 3211264
 buffer_load_dwordx4 v12, s[8:11], s43 offen  lds
 s_add_u32 m0, s45, 35840
 s_add_u32 s43, s44, 3244032
 buffer_load_dwordx4 v12, s[8:11], s43 offen  lds
 s_add_u32 m0, s45, 36864
 s_add_u32 s43, s44, 3276800
 buffer_load_dwordx4 v12, s[8:11], s43 offen  lds
 s_add_u32 m0, s45, 37888
 s_add_u32 s43, s44, 3309568
 buffer_load_dwordx4 v12, s[8:11], s43 offen  lds
 s_add_u32 m0, s45, 38912
 s_add_u32 s43, s44, 3342336
 buffer_load_dwordx4 v12, s[8:11], s43 offen  lds
 s_add_u32 m0, s45, 39936
 s_add_u32 s43, s44, 3375104
 buffer_load_dwordx4 v12, s[8:11], s43 offen  lds
 v_mov_b32 v250, s34
 v_mov_b32 v251, s35
 v_bfrev_b32 v252, 1
 v_cmp_eq_u32 vcc, 64, v0
 s_nop 1
 v_cndmask_b32 v252, v252, 0, vcc
 buffer_atomic_add_x2 v[250:251], v252, s[12:15], s30 offen sc1
 s_waitcnt vmcnt(9)
 s_barrier
 ds_read_b64_tr_b16 a[64:65], v13 offset:0
 ds_read_b64_tr_b16 a[66:67], v13 offset:1024
 ds_read_b64_tr_b16 a[68:69], v13 offset:4096
 ds_read_b64_tr_b16 a[70:71], v13 offset:5120
 ds_read_b64_tr_b16 a[72:73], v13 offset:8192
 ds_read_b64_tr_b16 a[74:75], v13 offset:9216
 ds_read_b64_tr_b16 a[76:77], v13 offset:12288
 ds_read_b64_tr_b16 a[78:79], v13 offset:13312
 s_waitcnt lgkmcnt(0)
 ds_read_b64_tr_b16 a[80:81], v13 offset:16384
 ds_read_b64_tr_b16 a[82:83], v13 offset:17408
 ds_read_b64_tr_b16 a[84:85], v13 offset:20480
 ds_read_b64_tr_b16 a[86:87], v13 offset:21504
 ds_read_b64_tr_b16 a[88:89], v13 offset:24576
 ds_read_b64_tr_b16 a[90:91], v13 offset:25600
 ds_read_b64_tr_b16 a[92:93], v13 offset:28672
 ds_read_b64_tr_b16 a[94:95], v13 offset:29696
 s_waitcnt lgkmcnt(0)
 s_barrier
 s_add_u32 m0, s45, 0
 s_add_u32 s43, s44, 4194304
 buffer_load_dwordx4 v12, s[8:11], s43 offen  lds
 s_add_u32 m0, s45, 1024
 s_add_u32 s43, s44, 4227072
 buffer_load_dwordx4 v12, s[8:11], s43 offen  lds
 s_add_u32 m0, s45, 2048
 s_add_u32 s43, s44, 4259840
 buffer_load_dwordx4 v12, s[8:11], s43 offen  lds
 s_add_u32 m0, s45, 3072
 s_add_u32 s43, s44, 4292608
 buffer_load_dwordx4 v12, s[8:11], s43 offen  lds
 s_add_u32 m0, s45, 4096
 s_add_u32 s43, s44, 4325376
 buffer_load_dwordx4 v12, s[8:11], s43 offen  lds
 s_add_u32 m0, s45, 5120
 s_add_u32 s43, s44, 4358144
 buffer_load_dwordx4 v12, s[8:11], s43 offen  lds
 s_add_u32 m0, s45, 6144
 s_add_u32 s43, s44, 4390912
 buffer_load_dwordx4 v12, s[8:11], s43 offen  lds
 s_add_u32 m0, s45, 7168
 s_add_u32 s43, s44, 4423680
 buffer_load_dwordx4 v12, s[8:11], s43 offen  lds
 s_waitcnt vmcnt(9)
 s_barrier
 ds_read_b64_tr_b16 a[96:97], v13 offset:32768
 ds_read_b64_tr_b16 a[98:99], v13 offset:33792
 ds_read_b64_tr_b16 a[100:101], v13 offset:36864
 ds_read_b64_tr_b16 a[102:103], v13 offset:37888
 ds_read_b64_tr_b16 a[104:105], v13 offset:40960
 ds_read_b64_tr_b16 a[106:107], v13 offset:41984
 ds_read_b64_tr_b16 a[108:109], v13 offset:45056
 ds_read_b64_tr_b16 a[110:111], v13 offset:46080
 s_waitcnt lgkmcnt(0)
 ds_read_b64_tr_b16 a[112:113], v13 offset:49152
 ds_read_b64_tr_b16 a[114:115], v13 offset:50176
 ds_read_b64_tr_b16 a[116:117], v13 offset:53248
 ds_read_b64_tr_b16 a[118:119], v13 offset:54272
 ds_read_b64_tr_b16 a[120:121], v13 offset:57344
 ds_read_b64_tr_b16 a[122:123], v13 offset:58368
 ds_read_b64_tr_b16 a[124:125], v13 offset:61440
 ds_read_b64_tr_b16 a[126:127], v13 offset:62464
 s_waitcnt lgkmcnt(0)
 s_barrier
 s_add_u32 m0, s45, 32768
 s_add_u32 s43, s44, 5242880
 buffer_load_dwordx4 v12, s[8:11], s43 offen  lds
 s_add_u32 m0, s45, 33792
 s_add_u32 s43, s44, 5275648
 buffer_load_dwordx4 v12, s[8:11], s43 offen  lds
 s_add_u32 m0, s45, 34816
 s_add_u32 s43, s44, 5308416
 buffer_load_dwordx4 v12, s[8:11], s43 offen  lds
 s_add_u32 m0, s45, 35840
 s_add_u32 s43, s44, 5341184
 buffer_load_dwordx4 v12, s[8:11], s43 offen  lds
 s_add_u32 m0, s45, 36864
 s_add_u32 s43, s44, 5373952
 buffer_load_dwordx4 v12, s[8:11], s43 offen  lds
 s_add_u32 m0, s45, 37888
 s_add_u32 s43, s44, 5406720
 buffer_load_dwordx4 v12, s[8:11], s43 offen  lds
 s_add_u32 m0, s45, 38912
 s_add_u32 s43, s44, 5439488
 buffer_load_dwordx4 v12, s[8:11], s43 offen  lds
 s_add_u32 m0, s45, 39936
 s_add_u32 s43, s44, 5472256
 buffer_load_dwordx4 v12, s[8:11], s43 offen  lds
 s_waitcnt vmcnt(8)
 s_barrier
 ds_read_b64_tr_b16 a[128:129], v13 offset:0
 ds_read_b64_tr_b16 a[130:131], v13 offset:1024
 ds_read_b64_tr_b16 a[132:133], v13 offset:4096
 ds_read_b64_tr_b16 a[134:135], v13 offset:5120
 ds_read_b64_tr_b16 a[136:137], v13 offset:8192
 ds_read_b64_tr_b16 a[138:139], v13 offset:9216
 ds_read_b64_tr_b16 a[140:141], v13 offset:12288
 ds_read_b64_tr_b16 a[142:143], v13 offset:13312
 s_waitcnt lgkmcnt(0)
 ds_read_b64_tr_b16 a[144:145], v13 offset:16384
 ds_read_b64_tr_b16 a[146:147], v13 offset:17408
 ds_read_b64_tr_b16 a[148:149], v13 offset:20480
 ds_read_b64_tr_b16 a[150:151], v13 offset:21504
 ds_read_b64_tr_b16 a[152:153], v13 offset:24576
 ds_read_b64_tr_b16 a[154:155], v13 offset:25600
 ds_read_b64_tr_b16 a[156:157], v13 offset:28672
 ds_read_b64_tr_b16 a[158:159], v13 offset:29696
 s_waitcnt lgkmcnt(0)
 s_barrier
 s_add_u32 m0, s45, 0
 s_add_u32 s43, s44, 6291456
 buffer_load_dwordx4 v12, s[8:11], s43 offen  lds
 s_add_u32 m0, s45, 1024
 s_add_u32 s43, s44, 6324224
 buffer_load_dwordx4 v12, s[8:11], s43 offen  lds
 s_add_u32 m0, s45, 2048
 s_add_u32 s43, s44, 6356992
 buffer_load_dwordx4 v12, s[8:11], s43 offen  lds
 s_add_u32 m0, s45, 3072
 s_add_u32 s43, s44, 6389760
 buffer_load_dwordx4 v12, s[8:11], s43 offen  lds
 s_add_u32 m0, s45, 4096
 s_add_u32 s43, s44, 6422528
 buffer_load_dwordx4 v12, s[8:11], s43 offen  lds
 s_add_u32 m0, s45, 5120
 s_add_u32 s43, s44, 6455296
 buffer_load_dwordx4 v12, s[8:11], s43 offen  lds
 s_add_u32 m0, s45, 6144
 s_add_u32 s43, s44, 6488064
 buffer_load_dwordx4 v12, s[8:11], s43 offen  lds
 s_add_u32 m0, s45, 7168
 s_add_u32 s43, s44, 6520832
 buffer_load_dwordx4 v12, s[8:11], s43 offen  lds
 s_waitcnt vmcnt(8)
 s_barrier
 ds_read_b64_tr_b16 a[160:161], v13 offset:32768
 ds_read_b64_tr_b16 a[162:163], v13 offset:33792
 ds_read_b64_tr_b16 a[164:165], v13 offset:36864
 ds_read_b64_tr_b16 a[166:167], v13 offset:37888
 ds_read_b64_tr_b16 a[168:169], v13 offset:40960
 ds_read_b64_tr_b16 a[170:171], v13 offset:41984
 ds_read_b64_tr_b16 a[172:173], v13 offset:45056
 ds_read_b64_tr_b16 a[174:175], v13 offset:46080
 s_waitcnt lgkmcnt(0)
 ds_read_b64_tr_b16 a[176:177], v13 offset:49152
 ds_read_b64_tr_b16 a[178:179], v13 offset:50176
 ds_read_b64_tr_b16 a[180:181], v13 offset:53248
 ds_read_b64_tr_b16 a[182:183], v13 offset:54272
 ds_read_b64_tr_b16 a[184:185], v13 offset:57344
 ds_read_b64_tr_b16 a[186:187], v13 offset:58368
 ds_read_b64_tr_b16 a[188:189], v13 offset:61440
 ds_read_b64_tr_b16 a[190:191], v13 offset:62464
 s_waitcnt lgkmcnt(0)
 s_barrier
 s_add_u32 m0, s45, 32768
 s_add_u32 s43, s44, 7340032
 buffer_load_dwordx4 v12, s[8:11], s43 offen  lds
 s_add_u32 m0, s45, 33792
 s_add_u32 s43, s44, 7372800
 buffer_load_dwordx4 v12, s[8:11], s43 offen  lds
 s_add_u32 m0, s45, 34816
 s_add_u32 s43, s44, 7405568
 buffer_load_dwordx4 v12, s[8:11], s43 offen  lds
 s_add_u32 m0, s45, 35840
 s_add_u32 s43, s44, 7438336
 buffer_load_dwordx4 v12, s[8:11], s43 offen  lds
 s_add_u32 m0, s45, 36864
 s_add_u32 s43, s44, 7471104
 buffer_load_dwordx4 v12, s[8:11], s43 offen  lds
 s_add_u32 m0, s45, 37888
 s_add_u32 s43, s44, 7503872
 buffer_load_dwordx4 v12, s[8:11], s43 offen  lds
 s_add_u32 m0, s45, 38912
 s_add_u32 s43, s44, 7536640
 buffer_load_dwordx4 v12, s[8:11], s43 offen  lds
 s_add_u32 m0, s45, 39936
 s_add_u32 s43, s44, 7569408
 buffer_load_dwordx4 v12, s[8:11], s43 offen  lds
 s_waitcnt vmcnt(8)
 s_barrier
 ds_read_b64_tr_b16 a[192:193], v13 offset:0
 ds_read_b64_tr_b16 a[194:195], v13 offset:1024
 ds_read_b64_tr_b16 a[196:197], v13 offset:4096
 ds_read_b64_tr_b16 a[198:199], v13 offset:5120
 ds_read_b64_tr_b16 a[200:201], v13 offset:8192
 ds_read_b64_tr_b16 a[202:203], v13 offset:9216
 ds_read_b64_tr_b16 a[204:205], v13 offset:12288
 ds_read_b64_tr_b16 a[206:207], v13 offset:13312
 s_waitcnt lgkmcnt(0)
 ds_read_b64_tr_b16 a[208:209], v13 offset:16384
 ds_read_b64_tr_b16 a[210:211], v13 offset:17408
 ds_read_b64_tr_b16 a[212:213], v13 offset:20480
 ds_read_b64_tr_b16 a[214:215], v13 offset:21504
 ds_read_b64_tr_b16 a[216:217], v13 offset:24576
 ds_read_b64_tr_b16 a[218:219], v13 offset:25600
 ds_read_b64_tr_b16 a[220:221], v13 offset:28672
 ds_read_b64_tr_b16 a[222:223], v13 offset:29696
 s_waitcnt lgkmcnt(0)
 s_waitcnt vmcnt(0)
 s_barrier
 ds_read_b64_tr_b16 a[224:225], v13 offset:32768
 ds_read_b64_tr_b16 a[226:227], v13 offset:33792
 ds_read_b64_tr_b16 a[228:229], v13 offset:36864
 ds_read_b64_tr_b16 a[230:231], v13 offset:37888
 ds_read_b64_tr_b16 a[232:233], v13 offset:40960
 ds_read_b64_tr_b16 a[234:235], v13 offset:41984
 ds_read_b64_tr_b16 a[236:237], v13 offset:45056
 ds_read_b64_tr_b16 a[238:239], v13 offset:46080
 s_waitcnt lgkmcnt(0)
 ds_read_b64_tr_b16 a[240:241], v13 offset:49152
 ds_read_b64_tr_b16 a[242:243], v13 offset:50176
 ds_read_b64_tr_b16 a[244:245], v13 offset:53248
 ds_read_b64_tr_b16 a[246:247], v13 offset:54272
 ds_read_b64_tr_b16 a[248:249], v13 offset:57344
 ds_read_b64_tr_b16 a[250:251], v13 offset:58368
 ds_read_b64_tr_b16 a[252:253], v13 offset:61440
 ds_read_b64_tr_b16 a[254:255], v13 offset:62464
 s_waitcnt lgkmcnt(0)
 s_mov_b32 s31, 1
 s_branch L_conv_front
L_conv_ret_Q:
 s_barrier
 s_mov_b32 s3, 0
L_rdy_6:
 buffer_load_dwordx4 v[84:87], off, s[12:15], s30 sc1
 s_add_u32 s3, s3, 1
 s_cmp_gt_u32 s3, 400000
 s_cbranch_scc1 L_exit
 s_waitcnt vmcnt(0)
 v_readfirstlane_b32 s32, v84
 v_readfirstlane_b32 s33, v85
 v_readfirstlane_b32 vcc_hi, v86
 s_and_b32 vcc_lo, s32, 0xffff
 s_cmp_lt_u32 vcc_lo, 256
 s_cbranch_scc1 L_rdy_6
 s_cmp_lg_u32 vcc_hi, 0
 s_cbranch_scc1 L_general
 s_load_dwordx2 s[36:37], s[0:1], 0
 s_mov_b32 s38, 4194304
 s_mov_b32 s39, 0x20000
 s_lshl_b32 s44, s26, 14
 s_mul_i32 s45, s26, 16512
 s_lshl_b32 s41, s25, 2
 s_add_u32 s41, s41, s26
 s_lshl_b32 s46, s41, 11
 s_add_u32 s46, s46, 50331648
 s_waitcnt lgkmcnt(0)
 v_mov_b32 v15, 0
 v_and_b32 v255, 1, v1
 v_lshlrev_b32 v255, 2, v255
 s_mov_b32 s56, 0
 s_mov_b32 s57, 0
 s_mov_b32 s58, 0
 s_mov_b32 s59, 0
 s_mov_b32 s60, 0
 s_mov_b32 s61, 0
 s_mov_b32 s62, 0
 s_mov_b32 s63, 0
 s_mov_b32 s64, 0
 s_mov_b32 s65, 0
 s_mov_b32 s66, 0
 s_mov_b32 s67, 0
 s_mov_b32 s68, 0
 s_mov_b32 s69, 0
 s_mov_b32 s70, 0
 s_mov_b32 s71, 0
 s_mov_b32 s40, 0
 s_add_u32 m0, s45, 0
 s_add_u32 s43, s44, 0
 buffer_load_dwordx4 v2, s[36:39], s43 offen offset:0 lds
 buffer_load_dwordx4 v2, s[36:39], s43 offen offset:1024 lds
 s_add_u32 m0, s45, 2064
 s_add_u32 s43, s44, 2048
 buffer_load_dwordx4 v2, s[36:39], s43 offen offset:0 lds
 buffer_load_dwordx4 v2, s[36:39], s43 offen offset:1024 lds
 s_add_u32 m0, s45, 4128
 s_add_u32 s43, s44, 4096
 buffer_load_dwordx4 v2, s[36:39], s43 offen offset:0 lds
 buffer_load_dwordx4 v2, s[36:39], s43 offen offset:1024 lds
 s_add_u32 m0, s45, 6192
 s_add_u32 s43, s44, 6144
 buffer_load_dwordx4 v2, s[36:39], s43 offen offset:0 lds
 buffer_load_dwordx4 v2, s[36:39], s43 offen offset:1024 lds
 s_add_u32 m0, s45, 8256
 s_add_u32 s43, s44, 8192
 buffer_load_dwordx4 v2, s[36:39], s43 offen offset:0 lds
 buffer_load_dwordx4 v2, s[36:39], s43 offen offset:1024 lds
 s_add_u32 m0, s45, 10320
 s_add_u32 s43, s44, 10240
 buffer_load_dwordx4 v2, s[36:39], s43 offen offset:0 lds
 buffer_load_dwordx4 v2, s[36:39], s43 offen offset:1024 lds
 s_add_u32 m0, s45, 12384
 s_add_u32 s43, s44, 12288
 buffer_load_dwordx4 v2, s[36:39], s43 offen offset:0 lds
 buffer_load_dwordx4 v2, s[36:39], s43 offen offset:1024 lds
 s_add_u32 m0, s45, 14448
 s_add_u32 s43, s44, 14336
 buffer_load_dwordx4 v2, s[36:39], s43 offen offset:0 lds
 buffer_load_dwordx4 v2, s[36:39], s43 offen offset:1024 lds
 s_waitcnt vmcnt(0)
 s_barrier
 ds_read_b128 v[16:19], v10 offset:0
 ds_read_b128 v[20:23], v10 offset:32
 ds_read_b128 v[24:27], v10 offset:64
 ds_read_b128 v[28:31], v10 offset:96
 ds_read_b128 v[32:35], v10 offset:128
 ds_read_b128 v[36:39], v10 offset:160
 s_add_u32 s46, s46, 1073479680
 v_and_b32 v3, 31, v1
 v_lshrrev_b32 v4, 5, v1
 v_lshlrev_b32 v12, 4, v3
 v_lshl_add_u32 v12, v4, 7, v12
 v_cmp_gt_u32 vcc, 8, v3
 v_and_b32 v13, 15, v5
 v_lshlrev_b32 v13, 2, v13
 v_lshl_add_u32 v13, v4, 7, v13
 v_lshrrev_b32 v5, 4, v5
 v_lshl_add_u32 v13, v5, 8, v13
 v_cndmask_b32 v12, v7, v12, vcc
 v_lshlrev_b32 v4, 3, v4
 v_sub_u32 v3, v3, v4
 v_mov_b32 v4, 0xf149f2ca
 v_cmp_gt_i32 vcc, 0, v3
 s_nop 1
 v_cndmask_b32 v232, 0, v4, vcc
 v_cmp_gt_i32 vcc, 1, v3
 s_nop 1
 v_cndmask_b32 v233, 0, v4, vcc
 v_cmp_gt_i32 vcc, 2, v3
 s_nop 1
 v_cndmask_b32 v234, 0, v4, vcc
 v_cmp_gt_i32 vcc, 3, v3
 s_nop 1
 v_cndmask_b32 v235, 0, v4, vcc
 v_cmp_gt_i32 vcc, 4, v3
 s_nop 1
 v_cndmask_b32 v236, 0, v4, vcc
 v_cmp_gt_i32 vcc, 5, v3
 s_nop 1
 v_cndmask_b32 v237, 0, v4, vcc
 v_cmp_gt_i32 vcc, 6, v3
 s_nop 1
 v_cndmask_b32 v238, 0, v4, vcc
 v_cmp_gt_i32 vcc, 7, v3
 s_nop 1
 v_cndmask_b32 v239, 0, v4, vcc
 v_cmp_gt_i32 vcc, 16, v3
 s_nop 1
 v_cndmask_b32 v240, 0, v4, vcc
 v_cmp_gt_i32 vcc, 17, v3
 s_nop 1
 v_cndmask_b32 v241, 0, v4, vcc
 v_cmp_gt_i32 vcc, 18, v3
 s_nop 1
 v_cndmask_b32 v242, 0, v4, vcc
 v_cmp_gt_i32 vcc, 19, v3
 s_nop 1
 v_cndmask_b32 v243, 0, v4, vcc
 v_cmp_gt_i32 vcc, 20, v3
 s_nop 1
 v_cndmask_b32 v244, 0, v4, vcc
 v_cmp_gt_i32 vcc, 21, v3
 s_nop 1
 v_cndmask_b32 v245, 0, v4, vcc
 v_cmp_gt_i32 vcc, 22, v3
 s_nop 1
 v_cndmask_b32 v246, 0, v4, vcc
 v_cmp_gt_i32 vcc, 23, v3
 s_nop 1
 v_cndmask_b32 v247, 0, v4, vcc
 v_mov_b32 v248, 0x3e0293ee
 s_lshl_b32 s47, s51, 7
 s_add_u32 s47, s47, 3739648
 s_mov_b32 s53, 0x40000000
 v_cmp_eq_u32 vcc, 0, v1
 v_mov_b32 v252, 0
 s_nop 0
 v_cndmask_b32 v14, v7, 0, vcc
L_rQ_loop:
 s_waitcnt lgkmcnt(5)
 v_mfma_f32_32x32x16_bf16 v[48:63], a[0:3], v[16:19], 0
 ds_read_b128 v[40:43], v10 offset:192
 s_add_u32 s44, s44, 65536
 s_add_u32 m0, s45, 66048
 s_add_u32 s43, s44, 0
 buffer_load_dwordx4 v2, s[36:39], s43 offen offset:0 lds
 s_waitcnt lgkmcnt(5)
 v_mfma_f32_32x32x16_bf16 v[48:63], a[4:7], v[20:23], v[48:63]
 ds_read_b128 v[44:47], v10 offset:224
 s_waitcnt lgkmcnt(5)
 v_mfma_f32_32x32x16_bf16 v[48:63], a[8:11], v[24:27], v[48:63]
 ds_read_b128 v[16:19], v10 offset:256
 buffer_load_dwordx4 v2, s[36:39], s43 offen offset:1024 lds
 s_waitcnt lgkmcnt(5)
 v_mfma_f32_32x32x16_bf16 v[48:63], a[12:15], v[28:31], v[48:63]
 ds_read_b128 v[20:23], v10 offset:288
 s_waitcnt lgkmcnt(5)
 v_mfma_f32_32x32x16_bf16 v[48:63], a[16:19], v[32:35], v[48:63]
 ds_read_b128 v[24:27], v10 offset:320
 s_add_u32 m0, s45, 68112
 s_add_u32 s43, s44, 2048
 buffer_load_dwordx4 v2, s[36:39], s43 offen offset:0 lds
 v_cvt_pk_bf16_f32 v80, v64, v65
 v_cvt_pk_bf16_f32 v81, v66, v67
 s_waitcnt lgkmcnt(5)
 v_mfma_f32_32x32x16_bf16 v[48:63], a[20:23], v[36:39], v[48:63]
 ds_read_b128 v[28:31], v10 offset:352
 v_cvt_pk_bf16_f32 v82, v68, v69
 v_cvt_pk_bf16_f32 v83, v70, v71
 s_waitcnt lgkmcnt(5)
 v_mfma_f32_32x32x16_bf16 v[48:63], a[24:27], v[40:43], v[48:63]
 ds_read_b128 v[32:35], v10 offset:384
 buffer_load_dwordx4 v2, s[36:39], s43 offen offset:1024 lds
 v_cvt_pk_bf16_f32 v84, v72, v73
 v_cvt_pk_bf16_f32 v85, v74, v75
 s_waitcnt lgkmcnt(5)
 v_mfma_f32_32x32x16_bf16 v[48:63], a[28:31], v[44:47], v[48:63]
 ds_read_b128 v[36:39], v10 offset:416
 v_cvt_pk_bf16_f32 v86, v76, v77
 v_cvt_pk_bf16_f32 v87, v78, v79
 s_waitcnt lgkmcnt(5)
 v_mfma_f32_32x32x16_bf16 v[48:63], a[32:35], v[16:19], v[48:63]
 ds_read_b128 v[40:43], v10 offset:448
 s_add_u32 m0, s45, 70176
 s_add_u32 s43, s44, 4096
 buffer_load_dwordx4 v2, s[36:39], s43 offen offset:0 lds
 s_waitcnt lgkmcnt(5)
 v_mfma_f32_32x32x16_bf16 v[48:63], a[36:39], v[20:23], v[48:63]
 ds_read_b128 v[44:47], v10 offset:480
 buffer_store_dwordx4 v[80:83], v2, s[4:7], s46 offen sc1
 s_waitcnt lgkmcnt(5)
 v_mfma_f32_32x32x16_bf16 v[48:63], a[40:43], v[24:27], v[48:63]
 ds_read_b128 v[16:19], v10 offset:512
 buffer_load_dwordx4 v2, s[36:39], s43 offen offset:1024 lds
 s_waitcnt lgkmcnt(5)
 v_mfma_f32_32x32x16_bf16 v[48:63], a[44:47], v[28:31], v[48:63]
 ds_read_b128 v[20:23], v10 offset:544
 buffer_store_dwordx4 v[84:87], v2, s[4:7], s46 offen offset:1024 sc1
 s_add_u32 s46, s46, 0x40000
 s_bitset0_b32 s46, 30
 s_waitcnt lgkmcnt(5)
 v_mfma_f32_32x32x16_bf16 v[48:63], a[48:51], v[32:35], v[48:63]
 ds_read_b128 v[24:27], v10 offset:576
 s_add_u32 m0, s45, 72240
 s_add_u32 s43, s44, 6144
 buffer_load_dwordx4 v2, s[36:39], s43 offen offset:0 lds
 s_waitcnt lgkmcnt(5)
 v_mfma_f32_32x32x16_bf16 v[48:63], a[52:55], v[36:39], v[48:63]
 ds_read_b128 v[28:31], v10 offset:608
 s_load_dwordx4 s[60:63], s[4:5], s47 offset:4096 glc
 s_waitcnt lgkmcnt(5)
 v_mfma_f32_32x32x16_bf16 v[48:63], a[56:59], v[40:43], v[48:63]
 ds_read_b128 v[32:35], v10 offset:640
 buffer_load_dwordx4 v2, s[36:39], s43 offen offset:1024 lds
 s_waitcnt lgkmcnt(5)
 v_mfma_f32_32x32x16_bf16 v[48:63], a[60:63], v[44:47], v[48:63]
 ds_read_b128 v[36:39], v10 offset:672
 s_waitcnt lgkmcnt(5)
 v_mfma_f32_32x32x16_bf16 v[48:63], a[64:67], v[16:19], v[48:63]
 ds_read_b128 v[40:43], v10 offset:704
 s_add_u32 m0, s45, 74304
 s_add_u32 s43, s44, 8192
 buffer_load_dwordx4 v2, s[36:39], s43 offen offset:0 lds
 s_waitcnt lgkmcnt(5)
 v_mfma_f32_32x32x16_bf16 v[48:63], a[68:71], v[20:23], v[48:63]
 ds_read_b128 v[44:47], v10 offset:736
 s_waitcnt lgkmcnt(5)
 v_mfma_f32_32x32x16_bf16 v[48:63], a[72:75], v[24:27], v[48:63]
 ds_read_b128 v[16:19], v10 offset:768
 buffer_load_dwordx4 v2, s[36:39], s43 offen offset:1024 lds
 s_waitcnt lgkmcnt(5)
 v_mfma_f32_32x32x16_bf16 v[48:63], a[76:79], v[28:31], v[48:63]
 ds_read_b128 v[20:23], v10 offset:800
 s_waitcnt lgkmcnt(5)
 v_mfma_f32_32x32x16_bf16 v[48:63], a[80:83], v[32:35], v[48:63]
 ds_read_b128 v[24:27], v10 offset:832
 s_add_u32 m0, s45, 76368
 s_add_u32 s43, s44, 10240
 buffer_load_dwordx4 v2, s[36:39], s43 offen offset:0 lds
 s_waitcnt lgkmcnt(5)
 v_mfma_f32_32x32x16_bf16 v[48:63], a[84:87], v[36:39], v[48:63]
 ds_read_b128 v[28:31], v10 offset:864
 s_waitcnt lgkmcnt(5)
 v_mfma_f32_32x32x16_bf16 v[48:63], a[88:91], v[40:43], v[48:63]
 ds_read_b128 v[32:35], v10 offset:896
 buffer_load_dwordx4 v2, s[36:39], s43 offen offset:1024 lds
 s_waitcnt lgkmcnt(5)
 v_mfma_f32_32x32x16_bf16 v[48:63], a[92:95], v[44:47], v[48:63]
 ds_read_b128 v[36:39], v10 offset:928
 s_waitcnt lgkmcnt(5)
 v_mfma_f32_32x32x16_bf16 v[48:63], a[96:99], v[16:19], v[48:63]
 ds_read_b128 v[40:43], v10 offset:960
 s_add_u32 m0, s45, 78432
 s_add_u32 s43, s44, 12288
 buffer_load_dwordx4 v2, s[36:39], s43 offen offset:0 lds
 s_waitcnt lgkmcnt(5)
 v_mfma_f32_32x32x16_bf16 v[48:63], a[100:103], v[20:23], v[48:63]
 ds_read_b128 v[44:47], v10 offset:992
 s_waitcnt vmcnt(15)
 buffer_store_dword v252, v14, s[4:7], s53 offen sc1
 s_mov_b32 s53, 0x40000000
 s_waitcnt lgkmcnt(5)
 v_mfma_f32_32x32x16_bf16 v[48:63], a[104:107], v[24:27], v[48:63]
 ds_read_b128 v[16:19], v10 offset:1024
 buffer_load_dwordx4 v2, s[36:39], s43 offen offset:1024 lds
 s_waitcnt lgkmcnt(5)
 v_mfma_f32_32x32x16_bf16 v[48:63], a[108:111], v[28:31], v[48:63]
 ds_read_b128 v[20:23], v10 offset:1056
 s_waitcnt lgkmcnt(5)
 v_mfma_f32_32x32x16_bf16 v[48:63], a[112:115], v[32:35], v[48:63]
 ds_read_b128 v[24:27], v10 offset:1088
 s_add_u32 m0, s45, 80496
 s_add_u32 s43, s44, 14336
 buffer_load_dwordx4 v2, s[36:39], s43 offen offset:0 lds
 s_waitcnt lgkmcnt(5)
 v_mfma_f32_32x32x16_bf16 v[48:63], a[116:119], v[36:39], v[48:63]
 ds_read_b128 v[28:31], v10 offset:1120
 s_waitcnt lgkmcnt(5)
 v_mfma_f32_32x32x16_bf16 v[48:63], a[120:123], v[40:43], v[48:63]
 ds_read_b128 v[32:35], v10 offset:1152
 buffer_load_dwordx4 v2, s[36:39], s43 offen offset:1024 lds
 s_waitcnt lgkmcnt(5)
 v_mfma_f32_32x32x16_bf16 v[48:63], a[124:127], v[44:47], v[48:63]
 ds_read_b128 v[36:39], v10 offset:1184
 s_waitcnt lgkmcnt(5)
 v_mfma_f32_32x32x16_bf16 v[48:63], a[128:131], v[16:19], v[48:63]
 ds_read_b128 v[40:43], v10 offset:1216
 s_waitcnt lgkmcnt(5)
 v_mfma_f32_32x32x16_bf16 v[48:63], a[132:135], v[20:23], v[48:63]
 ds_read_b128 v[44:47], v10 offset:1248
 s_waitcnt lgkmcnt(5)
 v_mfma_f32_32x32x16_bf16 v[48:63], a[136:139], v[24:27], v[48:63]
 ds_read_b128 v[16:19], v10 offset:1280
 s_waitcnt lgkmcnt(5)
 v_mfma_f32_32x32x16_bf16 v[48:63], a[140:143], v[28:31], v[48:63]
 ds_read_b128 v[20:23], v10 offset:1312
 s_load_dwordx4 s[56:59], s[4:5], s47 glc
 s_waitcnt lgkmcnt(5)
 v_mfma_f32_32x32x16_bf16 v[48:63], a[144:147], v[32:35], v[48:63]
 ds_read_b128 v[24:27], v10 offset:1344
 s_waitcnt lgkmcnt(5)
 v_mfma_f32_32x32x16_bf16 v[48:63], a[148:151], v[36:39], v[48:63]
 ds_read_b128 v[28:31], v10 offset:1376
 v_mov_b32 v9, s40
 s_waitcnt vmcnt(11)
 buffer_store_dword v9, v8, s[4:7], 0 offen sc1
 s_waitcnt lgkmcnt(5)
 v_mfma_f32_32x32x16_bf16 v[48:63], a[152:155], v[40:43], v[48:63]
 ds_read_b128 v[32:35], v10 offset:1408
 s_waitcnt lgkmcnt(5)
 v_mfma_f32_32x32x16_bf16 v[48:63], a[156:159], v[44:47], v[48:63]
 ds_read_b128 v[36:39], v10 offset:1440
 s_waitcnt lgkmcnt(5)
 v_mfma_f32_32x32x16_bf16 v[48:63], a[160:163], v[16:19], v[48:63]
 ds_read_b128 v[40:43], v10 offset:1472
 s_waitcnt lgkmcnt(5)
 v_mfma_f32_32x32x16_bf16 v[48:63], a[164:167], v[20:23], v[48:63]
 ds_read_b128 v[44:47], v10 offset:1504
 s_waitcnt lgkmcnt(5)
 v_mfma_f32_32x32x16_bf16 v[48:63], a[168:171], v[24:27], v[48:63]
 ds_read_b128 v[16:19], v10 offset:1536
 s_waitcnt lgkmcnt(5)
 v_mfma_f32_32x32x16_bf16 v[48:63], a[172:175], v[28:31], v[48:63]
 ds_read_b128 v[20:23], v10 offset:1568
 s_waitcnt lgkmcnt(5)
 v_mfma_f32_32x32x16_bf16 v[48:63], a[176:179], v[32:35], v[48:63]
 ds_read_b128 v[24:27], v10 offset:1600
 s_waitcnt lgkmcnt(5)
 v_mfma_f32_32x32x16_bf16 v[48:63], a[180:183], v[36:39], v[48:63]
 ds_read_b128 v[28:31], v10 offset:1632
 s_waitcnt lgkmcnt(5)
 v_mfma_f32_32x32x16_bf16 v[48:63], a[184:187], v[40:43], v[48:63]
 ds_read_b128 v[32:35], v10 offset:1664
 s_waitcnt lgkmcnt(5)
 v_mfma_f32_32x32x16_bf16 v[48:63], a[188:191], v[44:47], v[48:63]
 ds_read_b128 v[36:39], v10 offset:1696
 s_waitcnt lgkmcnt(5)
 v_mfma_f32_32x32x16_bf16 v[48:63], a[192:195], v[16:19], v[48:63]
 ds_read_b128 v[40:43], v10 offset:1728
 s_waitcnt lgkmcnt(5)
 v_mfma_f32_32x32x16_bf16 v[48:63], a[196:199], v[20:23], v[48:63]
 ds_read_b128 v[44:47], v10 offset:1760
 s_waitcnt lgkmcnt(5)
 v_mfma_f32_32x32x16_bf16 v[48:63], a[200:203], v[24:27], v[48:63]
 ds_read_b128 v[16:19], v10 offset:1792
 s_waitcnt lgkmcnt(5)
 v_mfma_f32_32x32x16_bf16 v[48:63], a[204:207], v[28:31], v[48:63]
 ds_read_b128 v[20:23], v10 offset:1824
 s_waitcnt lgkmcnt(5)
 v_mfma_f32_32x32x16_bf16 v[48:63], a[208:211], v[32:35], v[48:63]
 ds_read_b128 v[24:27], v10 offset:1856
 s_waitcnt lgkmcnt(5)
 v_mfma_f32_32x32x16_bf16 v[48:63], a[212:215], v[36:39], v[48:63]
 ds_read_b128 v[28:31], v10 offset:1888
 s_waitcnt lgkmcnt(5)
 v_mfma_f32_32x32x16_bf16 v[48:63], a[216:219], v[40:43], v[48:63]
 ds_read_b128 v[32:35], v10 offset:1920
 s_waitcnt lgkmcnt(5)
 v_mfma_f32_32x32x16_bf16 v[48:63], a[220:223], v[44:47], v[48:63]
 ds_read_b128 v[36:39], v10 offset:1952
 s_waitcnt lgkmcnt(5)
 v_mfma_f32_32x32x16_bf16 v[48:63], a[224:227], v[16:19], v[48:63]
 ds_read_b128 v[40:43], v10 offset:1984
 s_waitcnt lgkmcnt(5)
 v_mfma_f32_32x32x16_bf16 v[48:63], a[228:231], v[20:23], v[48:63]
 ds_read_b128 v[44:47], v10 offset:2016
 s_add_u32 s40, s40, 1
 s_mov_b32 s54, 0
 s_waitcnt lgkmcnt(5)
 v_mfma_f32_32x32x16_bf16 v[48:63], a[232:235], v[24:27], v[48:63]
 s_waitcnt lgkmcnt(4)
 v_mfma_f32_32x32x16_bf16 v[48:63], a[236:239], v[28:31], v[48:63]
 s_waitcnt lgkmcnt(0)
 s_waitcnt vmcnt(1)
 s_barrier
 ds_read_b128 v[16:19], v11 offset:0
 ds_read_b128 v[20:23], v11 offset:32
 v_mfma_f32_32x32x16_bf16 v[48:63], a[240:243], v[32:35], v[48:63]
 ds_read_b128 v[24:27], v11 offset:64
 ds_read_b128 v[28:31], v11 offset:96
 v_mfma_f32_32x32x16_bf16 v[48:63], a[244:247], v[36:39], v[48:63]
 ds_read_b128 v[32:35], v11 offset:128
 ds_read_b128 v[36:39], v11 offset:160
 v_mfma_f32_32x32x16_bf16 v[48:63], a[248:251], v[40:43], v[48:63]
 s_min_u32 s52, s56, s57
 s_min_u32 s52, s52, s58
 s_min_u32 s52, s52, s59
 s_min_u32 s52, s52, s60
 v_mfma_f32_32x32x16_bf16 v[48:63], a[252:255], v[44:47], v[48:63]
 s_min_u32 s52, s52, s61
 s_min_u32 s52, s52, s62
 s_min_u32 s52, s52, s63
 s_cmp_gt_u32 s52, s50
 s_cbranch_scc1 L_rQ_att
L_rQ_ret0:
 s_waitcnt lgkmcnt(5)
 v_mfma_f32_32x32x16_bf16 v[64:79], a[0:3], v[16:19], 0
 ds_read_b128 v[40:43], v11 offset:192
 s_add_u32 s44, s44, 65536
 s_add_u32 m0, s45, 0
 s_add_u32 s43, s44, 0
 buffer_load_dwordx4 v2, s[36:39], s43 offen offset:0 lds
 s_waitcnt lgkmcnt(5)
 v_mfma_f32_32x32x16_bf16 v[64:79], a[4:7], v[20:23], v[64:79]
 ds_read_b128 v[44:47], v11 offset:224
 s_waitcnt lgkmcnt(5)
 v_mfma_f32_32x32x16_bf16 v[64:79], a[8:11], v[24:27], v[64:79]
 ds_read_b128 v[16:19], v11 offset:256
 buffer_load_dwordx4 v2, s[36:39], s43 offen offset:1024 lds
 s_waitcnt lgkmcnt(5)
 v_mfma_f32_32x32x16_bf16 v[64:79], a[12:15], v[28:31], v[64:79]
 ds_read_b128 v[20:23], v11 offset:288
 s_waitcnt lgkmcnt(5)
 v_mfma_f32_32x32x16_bf16 v[64:79], a[16:19], v[32:35], v[64:79]
 ds_read_b128 v[24:27], v11 offset:320
 s_add_u32 m0, s45, 2064
 s_add_u32 s43, s44, 2048
 buffer_load_dwordx4 v2, s[36:39], s43 offen offset:0 lds
 v_cvt_pk_bf16_f32 v80, v48, v49
 v_cvt_pk_bf16_f32 v81, v50, v51
 s_waitcnt lgkmcnt(5)
 v_mfma_f32_32x32x16_bf16 v[64:79], a[20:23], v[36:39], v[64:79]
 ds_read_b128 v[28:31], v11 offset:352
 v_cvt_pk_bf16_f32 v82, v52, v53
 v_cvt_pk_bf16_f32 v83, v54, v55
 s_waitcnt lgkmcnt(5)
 v_mfma_f32_32x32x16_bf16 v[64:79], a[24:27], v[40:43], v[64:79]
 ds_read_b128 v[32:35], v11 offset:384
 buffer_load_dwordx4 v2, s[36:39], s43 offen offset:1024 lds
 v_cvt_pk_bf16_f32 v84, v56, v57
 v_cvt_pk_bf16_f32 v85, v58, v59
 s_waitcnt lgkmcnt(5)
 v_mfma_f32_32x32x16_bf16 v[64:79], a[28:31], v[44:47], v[64:79]
 ds_read_b128 v[36:39], v11 offset:416
 v_cvt_pk_bf16_f32 v86, v60, v61
 v_cvt_pk_bf16_f32 v87, v62, v63
 s_waitcnt lgkmcnt(5)
 v_mfma_f32_32x32x16_bf16 v[64:79], a[32:35], v[16:19], v[64:79]
 ds_read_b128 v[40:43], v11 offset:448
 s_add_u32 m0, s45, 4128
 s_add_u32 s43, s44, 4096
 buffer_load_dwordx4 v2, s[36:39], s43 offen offset:0 lds
 s_waitcnt lgkmcnt(5)
 v_mfma_f32_32x32x16_bf16 v[64:79], a[36:39], v[20:23], v[64:79]
 ds_read_b128 v[44:47], v11 offset:480
 buffer_store_dwordx4 v[80:83], v2, s[4:7], s46 offen sc1
 s_waitcnt lgkmcnt(5)
 v_mfma_f32_32x32x16_bf16 v[64:79], a[40:43], v[24:27], v[64:79]
 ds_read_b128 v[16:19], v11 offset:512
 buffer_load_dwordx4 v2, s[36:39], s43 offen offset:1024 lds
 s_waitcnt lgkmcnt(5)
 v_mfma_f32_32x32x16_bf16 v[64:79], a[44:47], v[28:31], v[64:79]
 ds_read_b128 v[20:23], v11 offset:544
 buffer_store_dwordx4 v[84:87], v2, s[4:7], s46 offen offset:1024 sc1
 s_add_u32 s46, s46, 0x40000
 s_bitset0_b32 s46, 30
 s_waitcnt lgkmcnt(5)
 v_mfma_f32_32x32x16_bf16 v[64:79], a[48:51], v[32:35], v[64:79]
 ds_read_b128 v[24:27], v11 offset:576
 s_add_u32 m0, s45, 6192
 s_add_u32 s43, s44, 6144
 buffer_load_dwordx4 v2, s[36:39], s43 offen offset:0 lds
 s_waitcnt lgkmcnt(5)
 v_mfma_f32_32x32x16_bf16 v[64:79], a[52:55], v[36:39], v[64:79]
 ds_read_b128 v[28:31], v11 offset:608
 s_load_dwordx4 s[60:63], s[4:5], s47 offset:4096 glc
 s_waitcnt lgkmcnt(5)
 v_mfma_f32_32x32x16_bf16 v[64:79], a[56:59], v[40:43], v[64:79]
 ds_read_b128 v[32:35], v11 offset:640
 buffer_load_dwordx4 v2, s[36:39], s43 offen offset:1024 lds
 s_waitcnt lgkmcnt(5)
 v_mfma_f32_32x32x16_bf16 v[64:79], a[60:63], v[44:47], v[64:79]
 ds_read_b128 v[36:39], v11 offset:672
 s_waitcnt lgkmcnt(5)
 v_mfma_f32_32x32x16_bf16 v[64:79], a[64:67], v[16:19], v[64:79]
 ds_read_b128 v[40:43], v11 offset:704
 s_add_u32 m0, s45, 8256
 s_add_u32 s43, s44, 8192
 buffer_load_dwordx4 v2, s[36:39], s43 offen offset:0 lds
 s_waitcnt lgkmcnt(5)
 v_mfma_f32_32x32x16_bf16 v[64:79], a[68:71], v[20:23], v[64:79]
 ds_read_b128 v[44:47], v11 offset:736
 s_waitcnt lgkmcnt(5)
 v_mfma_f32_32x32x16_bf16 v[64:79], a[72:75], v[24:27], v[64:79]
 ds_read_b128 v[16:19], v11 offset:768
 buffer_load_dwordx4 v2, s[36:39], s43 offen offset:1024 lds
 s_waitcnt lgkmcnt(5)
 v_mfma_f32_32x32x16_bf16 v[64:79], a[76:79], v[28:31], v[64:79]
 ds_read_b128 v[20:23], v11 offset:800
 s_waitcnt lgkmcnt(5)
 v_mfma_f32_32x32x16_bf16 v[64:79], a[80:83], v[32:35], v[64:79]
 ds_read_b128 v[24:27], v11 offset:832
 s_add_u32 m0, s45, 10320
 s_add_u32 s43, s44, 10240
 buffer_load_dwordx4 v2, s[36:39], s43 offen offset:0 lds
 s_waitcnt lgkmcnt(5)
 v_mfma_f32_32x32x16_bf16 v[64:79], a[84:87], v[36:39], v[64:79]
 ds_read_b128 v[28:31], v11 offset:864
 s_waitcnt lgkmcnt(5)
 v_mfma_f32_32x32x16_bf16 v[64:79], a[88:91], v[40:43], v[64:79]
 ds_read_b128 v[32:35], v11 offset:896
 buffer_load_dwordx4 v2, s[36:39], s43 offen offset:1024 lds
 s_waitcnt lgkmcnt(5)
 v_mfma_f32_32x32x16_bf16 v[64:79], a[92:95], v[44:47], v[64:79]
 ds_read_b128 v[36:39], v11 offset:928
 s_waitcnt lgkmcnt(5)
 v_mfma_f32_32x32x16_bf16 v[64:79], a[96:99], v[16:19], v[64:79]
 ds_read_b128 v[40:43], v11 offset:960
 s_add_u32 m0, s45, 12384
 s_add_u32 s43, s44, 12288
 buffer_load_dwordx4 v2, s[36:39], s43 offen offset:0 lds
 s_waitcnt lgkmcnt(5)
 v_mfma_f32_32x32x16_bf16 v[64:79], a[100:103], v[20:23], v[64:79]
 ds_read_b128 v[44:47], v11 offset:992
 s_waitcnt vmcnt(15)
 buffer_store_dword v252, v14, s[4:7], s53 offen sc1
 s_mov_b32 s53, 0x40000000
 s_waitcnt lgkmcnt(5)
 v_mfma_f32_32x32x16_bf16 v[64:79], a[104:107], v[24:27], v[64:79]
 ds_read_b128 v[16:19], v11 offset:1024
 buffer_load_dwordx4 v2, s[36:39], s43 offen offset:1024 lds
 s_waitcnt lgkmcnt(5)
 v_mfma_f32_32x32x16_bf16 v[64:79], a[108:111], v[28:31], v[64:79]
 ds_read_b128 v[20:23], v11 offset:1056
 s_waitcnt lgkmcnt(5)
 v_mfma_f32_32x32x16_bf16 v[64:79], a[112:115], v[32:35], v[64:79]
 ds_read_b128 v[24:27], v11 offset:1088
 s_add_u32 m0, s45, 14448
 s_add_u32 s43, s44, 14336
 buffer_load_dwordx4 v2, s[36:39], s43 offen offset:0 lds
 s_waitcnt lgkmcnt(5)
 v_mfma_f32_32x32x16_bf16 v[64:79], a[116:119], v[36:39], v[64:79]
 ds_read_b128 v[28:31], v11 offset:1120
 s_waitcnt lgkmcnt(5)
 v_mfma_f32_32x32x16_bf16 v[64:79], a[120:123], v[40:43], v[64:79]
 ds_read_b128 v[32:35], v11 offset:1152
 buffer_load_dwordx4 v2, s[36:39], s43 offen offset:1024 lds
 s_waitcnt lgkmcnt(5)
 v_mfma_f32_32x32x16_bf16 v[64:79], a[124:127], v[44:47], v[64:79]
 ds_read_b128 v[36:39], v11 offset:1184
 s_waitcnt lgkmcnt(5)
 v_mfma_f32_32x32x16_bf16 v[64:79], a[128:131], v[16:19], v[64:79]
 ds_read_b128 v[40:43], v11 offset:1216
 s_waitcnt lgkmcnt(5)
 v_mfma_f32_32x32x16_bf16 v[64:79], a[132:135], v[20:23], v[64:79]
 ds_read_b128 v[44:47], v11 offset:1248
 s_waitcnt lgkmcnt(5)
 v_mfma_f32_32x32x16_bf16 v[64:79], a[136:139], v[24:27], v[64:79]
 ds_read_b128 v[16:19], v11 offset:1280
 s_waitcnt lgkmcnt(5)
 v_mfma_f32_32x32x16_bf16 v[64:79], a[140:143], v[28:31], v[64:79]
 ds_read_b128 v[20:23], v11 offset:1312
 s_load_dwordx4 s[56:59], s[4:5], s47 glc
 s_waitcnt lgkmcnt(5)
 v_mfma_f32_32x32x16_bf16 v[64:79], a[144:147], v[32:35], v[64:79]
 ds_read_b128 v[24:27], v11 offset:1344
 s_waitcnt lgkmcnt(5)
 v_mfma_f32_32x32x16_bf16 v[64:79], a[148:151], v[36:39], v[64:79]
 ds_read_b128 v[28:31], v11 offset:1376
 v_mov_b32 v9, s40
 s_waitcnt vmcnt(11)
 buffer_store_dword v9, v8, s[4:7], 0 offen sc1
 s_waitcnt lgkmcnt(5)
 v_mfma_f32_32x32x16_bf16 v[64:79], a[152:155], v[40:43], v[64:79]
 ds_read_b128 v[32:35], v11 offset:1408
 s_waitcnt lgkmcnt(5)
 v_mfma_f32_32x32x16_bf16 v[64:79], a[156:159], v[44:47], v[64:79]
 ds_read_b128 v[36:39], v11 offset:1440
 s_waitcnt lgkmcnt(5)
 v_mfma_f32_32x32x16_bf16 v[64:79], a[160:163], v[16:19], v[64:79]
 ds_read_b128 v[40:43], v11 offset:1472
 s_waitcnt lgkmcnt(5)
 v_mfma_f32_32x32x16_bf16 v[64:79], a[164:167], v[20:23], v[64:79]
 ds_read_b128 v[44:47], v11 offset:1504
 s_waitcnt lgkmcnt(5)
 v_mfma_f32_32x32x16_bf16 v[64:79], a[168:171], v[24:27], v[64:79]
 ds_read_b128 v[16:19], v11 offset:1536
 s_waitcnt lgkmcnt(5)
 v_mfma_f32_32x32x16_bf16 v[64:79], a[172:175], v[28:31], v[64:79]
 ds_read_b128 v[20:23], v11 offset:1568
 s_waitcnt lgkmcnt(5)
 v_mfma_f32_32x32x16_bf16 v[64:79], a[176:179], v[32:35], v[64:79]
 ds_read_b128 v[24:27], v11 offset:1600
 s_waitcnt lgkmcnt(5)
 v_mfma_f32_32x32x16_bf16 v[64:79], a[180:183], v[36:39], v[64:79]
 ds_read_b128 v[28:31], v11 offset:1632
 s_waitcnt lgkmcnt(5)
 v_mfma_f32_32x32x16_bf16 v[64:79], a[184:187], v[40:43], v[64:79]
 ds_read_b128 v[32:35], v11 offset:1664
 s_waitcnt lgkmcnt(5)
 v_mfma_f32_32x32x16_bf16 v[64:79], a[188:191], v[44:47], v[64:79]
 ds_read_b128 v[36:39], v11 offset:1696
 s_waitcnt lgkmcnt(5)
 v_mfma_f32_32x32x16_bf16 v[64:79], a[192:195], v[16:19], v[64:79]
 ds_read_b128 v[40:43], v11 offset:1728
 s_waitcnt lgkmcnt(5)
 v_mfma_f32_32x32x16_bf16 v[64:79], a[196:199], v[20:23], v[64:79]
 ds_read_b128 v[44:47], v11 offset:1760
 s_waitcnt lgkmcnt(5)
 v_mfma_f32_32x32x16_bf16 v[64:79], a[200:203], v[24:27], v[64:79]
 ds_read_b128 v[16:19], v11 offset:1792
 s_waitcnt lgkmcnt(5)
 v_mfma_f32_32x32x16_bf16 v[64:79], a[204:207], v[28:31], v[64:79]
 ds_read_b128 v[20:23], v11 offset:1824
 s_waitcnt lgkmcnt(5)
 v_mfma_f32_32x32x16_bf16 v[64:79], a[208:211], v[32:35], v[64:79]
 ds_read_b128 v[24:27], v11 offset:1856
 s_waitcnt lgkmcnt(5)
 v_mfma_f32_32x32x16_bf16 v[64:79], a[212:215], v[36:39], v[64:79]
 ds_read_b128 v[28:31], v11 offset:1888
 s_waitcnt lgkmcnt(5)
 v_mfma_f32_32x32x16_bf16 v[64:79], a[216:219], v[40:43], v[64:79]
 ds_read_b128 v[32:35], v11 offset:1920
 s_waitcnt lgkmcnt(5)
 v_mfma_f32_32x32x16_bf16 v[64:79], a[220:223], v[44:47], v[64:79]
 ds_read_b128 v[36:39], v11 offset:1952
 s_waitcnt lgkmcnt(5)
 v_mfma_f32_32x32x16_bf16 v[64:79], a[224:227], v[16:19], v[64:79]
 ds_read_b128 v[40:43], v11 offset:1984
 s_waitcnt lgkmcnt(5)
 v_mfma_f32_32x32x16_bf16 v[64:79], a[228:231], v[20:23], v[64:79]
 ds_read_b128 v[44:47], v11 offset:2016
 s_add_u32 s40, s40, 1
 s_mov_b32 s54, 1
 s_waitcnt lgkmcnt(5)
 v_mfma_f32_32x32x16_bf16 v[64:79], a[232:235], v[24:27], v[64:79]
 s_waitcnt lgkmcnt(4)
 v_mfma_f32_32x32x16_bf16 v[64:79], a[236:239], v[28:31], v[64:79]
 s_waitcnt lgkmcnt(0)
 s_waitcnt vmcnt(1)
 s_barrier
 ds_read_b128 v[16:19], v10 offset:0
 ds_read_b128 v[20:23], v10 offset:32
 v_mfma_f32_32x32x16_bf16 v[64:79], a[240:243], v[32:35], v[64:79]
 ds_read_b128 v[24:27], v10 offset:64
 ds_read_b128 v[28:31], v10 offset:96
 v_mfma_f32_32x32x16_bf16 v[64:79], a[244:247], v[36:39], v[64:79]
 ds_read_b128 v[32:35], v10 offset:128
 ds_read_b128 v[36:39], v10 offset:160
 v_mfma_f32_32x32x16_bf16 v[64:79], a[248:251], v[40:43], v[64:79]
 s_min_u32 s52, s56, s57
 s_min_u32 s52, s52, s58
 s_min_u32 s52, s52, s59
 s_min_u32 s52, s52, s60
 v_mfma_f32_32x32x16_bf16 v[64:79], a[252:255], v[44:47], v[64:79]
 s_min_u32 s52, s52, s61
 s_min_u32 s52, s52, s62
 s_min_u32 s52, s52, s63
 s_cmp_gt_u32 s52, s50
 s_cbranch_scc1 L_rQ_att
L_rQ_ret1:
 s_cmp_lt_u32 s40, 64
 s_cbranch_scc1 L_rQ_loop
 s_nop 11
 v_cvt_pk_bf16_f32 v80, v64, v65
 v_cvt_pk_bf16_f32 v81, v66, v67
 v_cvt_pk_bf16_f32 v82, v68, v69
 v_cvt_pk_bf16_f32 v83, v70, v71
 v_cvt_pk_bf16_f32 v84, v72, v73
 v_cvt_pk_bf16_f32 v85, v74, v75
 v_cvt_pk_bf16_f32 v86, v76, v77
 v_cvt_pk_bf16_f32 v87, v78, v79
 buffer_store_dwordx4 v[80:83], v2, s[4:7], s46 offen sc1
 buffer_store_dwordx4 v[84:87], v2, s[4:7], s46 offen offset:1024 sc1
 s_add_u32 s46, s46, 0x40000
 v_mov_b32 v9, 64
 s_mov_b32 s54, 2
L_rQ_ret2:
 s_waitcnt vmcnt(0) lgkmcnt(0)
 buffer_store_dword v9, v8, s[4:7], 0 offen sc1
 buffer_store_dword v252, v14, s[4:7], s53 offen sc1
 s_mov_b32 s53, 0x40000000
 s_cmp_ge_u32 s50, 64
 s_cbranch_scc1 L_rQ_end
L_rQ_att:
L_rQ_wm1:
 s_min_u32 s52, s56, s57
 s_min_u32 s52, s52, s58
 s_min_u32 s52, s52, s59
 s_max_u32 s41, s50, 1
 s_cmp_ge_u32 s52, s41
 s_cbranch_scc1 L_rQ_wm1ok
 s_sleep 12
 s_load_dwordx4 s[56:59], s[4:5], s47 glc
 s_add_u32 s48, s48, 1
 s_cmp_gt_u32 s48, 400000
 s_cbranch_scc1 L_done
 s_waitcnt lgkmcnt(0)
 s_branch L_rQ_wm1
L_rQ_wm1ok:
 s_lshl_b32 s42, s50, 5
 s_add_u32 s42, s42, s51
 s_lshl_b32 s49, s42, 13
 s_add_u32 s43, s49, 16777216
 buffer_load_dwordx4 v[80:83], v6, s[4:7], s43 offen offset:0 sc1
 buffer_load_dwordx4 v[84:87], v6, s[4:7], s43 offen offset:1024 sc1
 buffer_load_dwordx4 v[88:91], v6, s[4:7], s43 offen offset:2048 sc1
 buffer_load_dwordx4 v[92:95], v6, s[4:7], s43 offen offset:3072 sc1
 s_add_u32 s43, s49, 16781312
 buffer_load_dwordx4 v[96:99], v6, s[4:7], s43 offen offset:0 sc1
 buffer_load_dwordx4 v[100:103], v6, s[4:7], s43 offen offset:1024 sc1
 buffer_load_dwordx4 v[104:107], v6, s[4:7], s43 offen offset:2048 sc1
 buffer_load_dwordx4 v[108:111], v6, s[4:7], s43 offen offset:3072 sc1
L_rQ_wq:
 s_min_u32 s41, s60, s61
 s_min_u32 s41, s41, s62
 s_min_u32 s41, s41, s63
 s_cmp_gt_u32 s41, s50
 s_cbranch_scc1 L_rQ_wqok
 s_load_dwordx4 s[60:63], s[4:5], s47 offset:4096 glc
 s_add_u32 s48, s48, 1
 s_cmp_gt_u32 s48, 400000
 s_cbranch_scc1 L_done
 s_waitcnt lgkmcnt(0)
 s_branch L_rQ_wq
L_rQ_wqok:
 s_add_u32 s43, s49, 50331648
 buffer_load_dwordx4 v[144:147], v2, s[4:7], s43 offen offset:0 sc1
 buffer_load_dwordx4 v[148:151], v2, s[4:7], s43 offen offset:1024 sc1
 buffer_load_dwordx4 v[152:155], v2, s[4:7], s43 offen offset:2048 sc1
 buffer_load_dwordx4 v[156:159], v2, s[4:7], s43 offen offset:3072 sc1
 s_add_u32 s43, s49, 50335744
 buffer_load_dwordx4 v[160:163], v2, s[4:7], s43 offen offset:0 sc1
 buffer_load_dwordx4 v[164:167], v2, s[4:7], s43 offen offset:1024 sc1
 buffer_load_dwordx4 v[168:171], v2, s[4:7], s43 offen offset:2048 sc1
 buffer_load_dwordx4 v[172:175], v2, s[4:7], s43 offen offset:3072 sc1
 s_add_u32 s43, s49, 33554432
 buffer_load_dwordx4 v[176:179], v6, s[4:7], s43 offen offset:0 sc1
 buffer_load_dwordx4 v[180:183], v6, s[4:7], s43 offen offset:1024 sc1
 buffer_load_dwordx4 v[184:187], v6, s[4:7], s43 offen offset:2048 sc1
 buffer_load_dwordx4 v[188:191], v6, s[4:7], s43 offen offset:3072 sc1
 s_add_u32 s43, s49, 33558528
 buffer_load_dwordx4 v[192:195], v6, s[4:7], s43 offen offset:0 sc1
 buffer_load_dwordx4 v[196:199], v6, s[4:7], s43 offen offset:1024 sc1
 buffer_load_dwordx4 v[200:203], v6, s[4:7], s43 offen offset:2048 sc1
 buffer_load_dwordx4 v[204:207], v6, s[4:7], s43 offen offset:3072 sc1
L_rQ_wm2:
 s_min_u32 s41, s56, s57
 s_min_u32 s41, s41, s58
 s_min_u32 s41, s41, s59
 s_cmp_gt_u32 s41, s50
 s_cbranch_scc1 L_rQ_wm2ok
 s_load_dwordx4 s[56:59], s[4:5], s47 glc
 s_add_u32 s48, s48, 1
 s_cmp_gt_u32 s48, 400000
 s_cbranch_scc1 L_done
 s_waitcnt lgkmcnt(0)
 s_branch L_rQ_wm2
L_rQ_wm2ok:
 s_lshr_b32 s42, s49, 2
 s_add_u32 s43, s42, 4194304
 buffer_load_dwordx4 v[112:115], v12, s[4:7], s43 offen offset:0 sc1
 buffer_load_dwordx4 v[116:119], v12, s[4:7], s43 offen offset:256 sc1
 buffer_load_dwordx4 v[120:123], v12, s[4:7], s43 offen offset:512 sc1
 buffer_load_dwordx4 v[124:127], v12, s[4:7], s43 offen offset:768 sc1
 buffer_load_dwordx4 v[128:131], v12, s[4:7], s43 offen offset:1024 sc1
 buffer_load_dwordx4 v[132:135], v12, s[4:7], s43 offen offset:1280 sc1
 buffer_load_dwordx4 v[136:139], v12, s[4:7], s43 offen offset:1536 sc1
 buffer_load_dwordx4 v[140:143], v12, s[4:7], s43 offen offset:1792 sc1
 s_add_u32 s43, s42, 8388608
 buffer_load_dword v208, v13, s[4:7], s43 offen offset:0 sc1
 buffer_load_dword v209, v13, s[4:7], s43 offen offset:64 sc1
 buffer_load_dword v210, v13, s[4:7], s43 offen offset:512 sc1
 buffer_load_dword v211, v13, s[4:7], s43 offen offset:576 sc1
 buffer_load_dword v212, v13, s[4:7], s43 offen offset:1024 sc1
 buffer_load_dword v213, v13, s[4:7], s43 offen offset:1088 sc1
 buffer_load_dword v214, v13, s[4:7], s43 offen offset:1536 sc1
 buffer_load_dword v215, v13, s[4:7], s43 offen offset:1600 sc1
 s_lshl_b32 s53, s50, 11
 s_add_u32 s53, s53, s55
 s_waitcnt vmcnt(24)
 v_mfma_f32_32x32x16_bf16 v[216:231], v[80:83], v[144:147], v[232:247]
 v_mfma_f32_32x32x16_bf16 v[216:231], v[84:87], v[148:151], v[216:231]
 v_mfma_f32_32x32x16_bf16 v[216:231], v[88:91], v[152:155], v[216:231]
 v_mfma_f32_32x32x16_bf16 v[216:231], v[92:95], v[156:159], v[216:231]
 v_mfma_f32_32x32x16_bf16 v[216:231], v[96:99], v[160:163], v[216:231]
 v_mfma_f32_32x32x16_bf16 v[216:231], v[100:103], v[164:167], v[216:231]
 v_mfma_f32_32x32x16_bf16 v[216:231], v[104:107], v[168:171], v[216:231]
 v_mfma_f32_32x32x16_bf16 v[216:231], v[108:111], v[172:175], v[216:231]
 s_waitcnt vmcnt(8)
 v_mfma_f32_32x32x16_bf16 v[80:95], v[112:115], v[144:147], 0
 v_mfma_f32_32x32x16_bf16 v[80:95], v[116:119], v[148:151], v[80:95]
 v_mfma_f32_32x32x16_bf16 v[80:95], v[120:123], v[152:155], v[80:95]
 v_mfma_f32_32x32x16_bf16 v[80:95], v[124:127], v[156:159], v[80:95]
 v_mfma_f32_32x32x16_bf16 v[80:95], v[128:131], v[160:163], v[80:95]
 v_mfma_f32_32x32x16_bf16 v[80:95], v[132:135], v[164:167], v[80:95]
 v_mfma_f32_32x32x16_bf16 v[80:95], v[136:139], v[168:171], v[80:95]
 v_mfma_f32_32x32x16_bf16 v[80:95], v[140:143], v[172:175], v[80:95]
 s_nop 3
 v_max3_f32 v3, v216, v217, v218
 v_max3_f32 v3, v3, v219, v220
 v_max3_f32 v3, v3, v221, v222
 v_max3_f32 v3, v3, v223, v224
 v_max3_f32 v3, v3, v225, v226
 v_max3_f32 v3, v3, v227, v228
 v_max3_f32 v3, v3, v229, v230
 v_max_f32 v3, v3, v231
 v_max3_f32 v3, v3, v80, v81
 v_max3_f32 v3, v3, v82, v83
 v_mov_b32 v4, v3
 s_nop 1
 v_permlane32_swap_b32 v3, v4
 s_nop 0
 v_max_f32 v3, v3, v4
 v_mul_f32 v3, v248, v3
 v_fma_f32 v216, v216, v248, -v3
 v_fma_f32 v217, v217, v248, -v3
 v_fma_f32 v218, v218, v248, -v3
 v_fma_f32 v219, v219, v248, -v3
 v_fma_f32 v220, v220, v248, -v3
 v_fma_f32 v221, v221, v248, -v3
 v_fma_f32 v222, v222, v248, -v3
 v_fma_f32 v223, v223, v248, -v3
 v_fma_f32 v224, v224, v248, -v3
 v_fma_f32 v225, v225, v248, -v3
 v_fma_f32 v226, v226, v248, -v3
 v_fma_f32 v227, v227, v248, -v3
 v_fma_f32 v228, v228, v248, -v3
 v_fma_f32 v229, v229, v248, -v3
 v_fma_f32 v230, v230, v248, -v3
 v_fma_f32 v231, v231, v248, -v3
 v_fma_f32 v80, v80, v248, -v3
 v_fma_f32 v81, v81, v248, -v3
 v_fma_f32 v82, v82, v248, -v3
 v_fma_f32 v83, v83, v248, -v3
 v_exp_f32 v216, v216
 v_exp_f32 v217, v217
 v_exp_f32 v218, v218
 v_exp_f32 v219, v219
 v_exp_f32 v220, v220
 v_exp_f32 v221, v221
 v_exp_f32 v222, v222
 v_exp_f32 v223, v223
 v_exp_f32 v224, v224
 v_exp_f32 v225, v225
 v_exp_f32 v226, v226
 v_exp_f32 v227, v227
 v_exp_f32 v228, v228
 v_exp_f32 v229, v229
 v_exp_f32 v230, v230
 v_exp_f32 v231, v231
 v_exp_f32 v80, v80
 v_exp_f32 v81, v81
 v_exp_f32 v82, v82
 v_exp_f32 v83, v83
 v_pk_add_f32 v[250:251], v[216:217], v[218:219]
 v_pk_add_f32 v[250:251], v[250:251], v[220:221]
 v_pk_add_f32 v[250:251], v[250:251], v[222:223]
 v_pk_add_f32 v[250:251], v[250:251], v[224:225]
 v_pk_add_f32 v[250:251], v[250:251], v[226:227]
 v_pk_add_f32 v[250:251], v[250:251], v[228:229]
 v_pk_add_f32 v[250:251], v[250:251], v[230:231]
 v_pk_add_f32 v[250:251], v[250:251], v[80:81]
 v_pk_add_f32 v[250:251], v[250:251], v[82:83]
 v_add_f32 v3, v250, v251
 v_add_f32 v4, v250, v251
 s_nop 1
 v_permlane32_swap_b32 v3, v4
 s_nop 0
 v_add_f32 v3, v3, v4
 v_rcp_f32 v250, v3
 s_nop 0
 v_pk_mul_f32 v[216:217], v[216:217], v[250:251] op_sel_hi:[1,0]
 v_pk_mul_f32 v[218:219], v[218:219], v[250:251] op_sel_hi:[1,0]
 v_pk_mul_f32 v[220:221], v[220:221], v[250:251] op_sel_hi:[1,0]
 v_pk_mul_f32 v[222:223], v[222:223], v[250:251] op_sel_hi:[1,0]
 v_pk_mul_f32 v[224:225], v[224:225], v[250:251] op_sel_hi:[1,0]
 v_pk_mul_f32 v[226:227], v[226:227], v[250:251] op_sel_hi:[1,0]
 v_pk_mul_f32 v[228:229], v[228:229], v[250:251] op_sel_hi:[1,0]
 v_pk_mul_f32 v[230:231], v[230:231], v[250:251] op_sel_hi:[1,0]
 v_pk_mul_f32 v[80:81], v[80:81], v[250:251] op_sel_hi:[1,0]
 v_pk_mul_f32 v[82:83], v[82:83], v[250:251] op_sel_hi:[1,0]
 v_cvt_pk_bf16_f32 v144, v216, v217
 v_cvt_pk_bf16_f32 v145, v218, v219
 v_cvt_pk_bf16_f32 v146, v220, v221
 v_cvt_pk_bf16_f32 v147, v222, v223
 v_cvt_pk_bf16_f32 v148, v224, v225
 v_cvt_pk_bf16_f32 v149, v226, v227
 v_cvt_pk_bf16_f32 v150, v228, v229
 v_cvt_pk_bf16_f32 v151, v230, v231
 v_cvt_pk_bf16_f32 v152, v80, v81
 v_cvt_pk_bf16_f32 v153, v82, v83
 s_waitcnt vmcnt(0)
 s_add_u32 s43, s49, 67108864
 s_add_u32 s42, s43, 4096
 v_mfma_f32_32x32x16_bf16 v[80:95], v[176:179], v[144:147], 0
 v_mfma_f32_32x32x16_bf16 v[80:95], v[180:183], v[148:151], v[80:95]
 v_mfma_f32_32x32x8_bf16 v[80:95], v[208:209], v[152:153], v[80:95]
 v_mfma_f32_32x32x16_bf16 v[96:111], v[184:187], v[144:147], 0
 v_mfma_f32_32x32x16_bf16 v[96:111], v[188:191], v[148:151], v[96:111]
 v_mfma_f32_32x32x8_bf16 v[96:111], v[210:211], v[152:153], v[96:111]
 v_mfma_f32_32x32x16_bf16 v[112:127], v[192:195], v[144:147], 0
 v_mfma_f32_32x32x16_bf16 v[112:127], v[196:199], v[148:151], v[112:127]
 v_mfma_f32_32x32x8_bf16 v[112:127], v[212:213], v[152:153], v[112:127]
 v_mfma_f32_32x32x16_bf16 v[128:143], v[200:203], v[144:147], 0
 v_mfma_f32_32x32x16_bf16 v[128:143], v[204:207], v[148:151], v[128:143]
 v_mfma_f32_32x32x8_bf16 v[128:143], v[214:215], v[152:153], v[128:143]
 s_nop 2
 v_cvt_pk_bf16_f32 v176, v80, v81
 v_cvt_pk_bf16_f32 v177, v82, v83
 v_cvt_pk_bf16_f32 v178, v84, v85
 v_cvt_pk_bf16_f32 v179, v86, v87
 v_cvt_pk_bf16_f32 v180, v88, v89
 v_cvt_pk_bf16_f32 v181, v90, v91
 v_cvt_pk_bf16_f32 v182, v92, v93
 v_cvt_pk_bf16_f32 v183, v94, v95
 buffer_store_dwordx4 v[176:179], v2, s[4:7], s43 offen offset:0 sc1
 buffer_store_dwordx4 v[180:183], v2, s[4:7], s43 offen offset:1024 sc1
 v_cvt_pk_bf16_f32 v184, v96, v97
 v_cvt_pk_bf16_f32 v185, v98, v99
 v_cvt_pk_bf16_f32 v186, v100, v101
 v_cvt_pk_bf16_f32 v187, v102, v103
 v_cvt_pk_bf16_f32 v188, v104, v105
 v_cvt_pk_bf16_f32 v189, v106, v107
 v_cvt_pk_bf16_f32 v190, v108, v109
 v_cvt_pk_bf16_f32 v191, v110, v111
 buffer_store_dwordx4 v[184:187], v2, s[4:7], s43 offen offset:2048 sc1
 buffer_store_dwordx4 v[188:191], v2, s[4:7], s43 offen offset:3072 sc1
 v_cvt_pk_bf16_f32 v192, v112, v113
 v_cvt_pk_bf16_f32 v193, v114, v115
 v_cvt_pk_bf16_f32 v194, v116, v117
 v_cvt_pk_bf16_f32 v195, v118, v119
 v_cvt_pk_bf16_f32 v196, v120, v121
 v_cvt_pk_bf16_f32 v197, v122, v123
 v_cvt_pk_bf16_f32 v198, v124, v125
 v_cvt_pk_bf16_f32 v199, v126, v127
 buffer_store_dwordx4 v[192:195], v2, s[4:7], s42 offen offset:0 sc1
 buffer_store_dwordx4 v[196:199], v2, s[4:7], s42 offen offset:1024 sc1
 v_cvt_pk_bf16_f32 v200, v128, v129
 v_cvt_pk_bf16_f32 v201, v130, v131
 v_cvt_pk_bf16_f32 v202, v132, v133
 v_cvt_pk_bf16_f32 v203, v134, v135
 v_cvt_pk_bf16_f32 v204, v136, v137
 v_cvt_pk_bf16_f32 v205, v138, v139
 v_cvt_pk_bf16_f32 v206, v140, v141
 v_cvt_pk_bf16_f32 v207, v142, v143
 buffer_store_dwordx4 v[200:203], v2, s[4:7], s42 offen offset:2048 sc1
 buffer_store_dwordx4 v[204:207], v2, s[4:7], s42 offen offset:3072 sc1
 s_add_u32 s41, s50, 1
 v_mov_b32 v252, s41
 s_add_u32 s50, s50, 4
L_rQ_back:
 s_cmp_eq_u32 s54, 0
 s_cbranch_scc1 L_rQ_ret0
 s_cmp_eq_u32 s54, 1
 s_cbranch_scc1 L_rQ_ret1
 s_branch L_rQ_ret2
L_rQ_end:
 s_waitcnt vmcnt(0) lgkmcnt(0)
 s_barrier
 s_branch L_done
L_role_O:
 s_mov_b64 s[8:9], s[22:23]
 s_mov_b32 s10, 8388608
 s_mov_b32 s11, 0x20000
 v_and_b32 v1, 63, v0
 v_lshrrev_b32 v12, 4, v1
 v_lshlrev_b32 v12, 11, v12
 v_and_b32 v3, 15, v1
 v_lshl_add_u32 v12, v3, 4, v12
 s_lshr_b32 s44, s25, 3
 s_lshl_b32 s44, s44, 21
 s_and_b32 s42, s25, 7
 s_lshl_b32 s42, s42, 8
 s_add_u32 s44, s44, s42
 s_lshl_b32 s42, s26, 16
 s_add_u32 s44, s44, s42
 s_lshl_b32 s45, s26, 13
 s_add_u32 s45, s45, 0
 s_add_u32 m0, s45, 0
 s_add_u32 s43, s44, 0
 buffer_load_dwordx4 v12, s[8:11], s43 offen  lds
 s_add_u32 m0, s45, 1024
 s_add_u32 s43, s44, 8192
 buffer_load_dwordx4 v12, s[8:11], s43 offen  lds
 s_add_u32 m0, s45, 2048
 s_add_u32 s43, s44, 16384
 buffer_load_dwordx4 v12, s[8:11], s43 offen  lds
 s_add_u32 m0, s45, 3072
 s_add_u32 s43, s44, 24576
 buffer_load_dwordx4 v12, s[8:11], s43 offen  lds
 s_add_u32 m0, s45, 4096
 s_add_u32 s43, s44, 32768
 buffer_load_dwordx4 v12, s[8:11], s43 offen  lds
 s_add_u32 m0, s45, 5120
 s_add_u32 s43, s44, 40960
 buffer_load_dwordx4 v12, s[8:11], s43 offen  lds
 s_add_u32 m0, s45, 6144
 s_add_u32 s43, s44, 49152
 buffer_load_dwordx4 v12, s[8:11], s43 offen  lds
 s_add_u32 m0, s45, 7168
 s_add_u32 s43, s44, 57344
 buffer_load_dwordx4 v12, s[8:11], s43 offen  lds
 v_and_b32 v1, 63, v0
 v_lshlrev_b32 v2, 4, v1
 v_bfrev_b32 v7, 1
 s_mov_b32 s48, 0
 v_and_b32 v5, 0x13, v1
 v_bfe_u32 v3, v1, 2, 1
 v_lshl_add_u32 v5, v3, 3, v5
 v_bfe_u32 v3, v1, 3, 1
 v_lshl_add_u32 v5, v3, 2, v5
 v_lshrrev_b32 v4, 5, v1
 v_lshlrev_b32 v3, 9, v4
 v_lshl_add_u32 v6, v5, 4, v3
 v_mov_b32 v10, v2
 v_add_u32 v11, 65536, v10
 s_and_b32 s41, s25, 7
 s_lshl_b32 s41, s41, 2
 s_add_u32 s41, s41, s26
 s_lshl_b32 s41, s41, 7
 s_add_u32 s41, s41, 3751936
 s_mov_b32 s49, s41
 s_lshr_b32 s42, s25, 3
 s_lshl_b32 s42, s42, 2
 s_add_u32 s41, s41, s42
 v_mov_b32 v3, s41
 v_cmp_eq_u32 vcc, 0, v1
 v_mov_b32 v9, 0
 s_nop 0
 v_cndmask_b32 v8, v7, v3, vcc
 v_bfe_u32 v13, v1, 2, 2
 v_lshrrev_b32 v3, 5, v1
 v_lshl_add_u32 v13, v3, 3, v13
 v_lshlrev_b32 v13, 8, v13
 v_bfe_u32 v3, v1, 4, 1
 v_lshl_add_u32 v13, v3, 5, v13
 v_and_b32 v3, 1, v1
 v_lshl_add_u32 v13, v3, 3, v13
 v_bfe_u32 v3, v1, 1, 1
 v_lshl_add_u32 v13, v3, 4, v13
 s_lshr_b32 s43, s25, 3
 s_lshl_b32 s43, s43, 4
 v_xor_b32 v13, s43, v13
 s_lshl_b32 s43, s26, 6
 s_add_u32 s43, s43, 0
 v_add_u32 v13, s43, v13
 buffer_store_dword v9, v8, s[4:7], 0 offen sc1
 s_add_u32 m0, s45, 32768
 s_add_u32 s43, s44, 262144
 buffer_load_dwordx4 v12, s[8:11], s43 offen  lds
 s_add_u32 m0, s45, 33792
 s_add_u32 s43, s44, 270336
 buffer_load_dwordx4 v12, s[8:11], s43 offen  lds
 s_add_u32 m0, s45, 34816
 s_add_u32 s43, s44, 278528
 buffer_load_dwordx4 v12, s[8:11], s43 offen  lds
 s_add_u32 m0, s45, 35840
 s_add_u32 s43, s44, 286720
 buffer_load_dwordx4 v12, s[8:11], s43 offen  lds
 s_add_u32 m0, s45, 36864
 s_add_u32 s43, s44, 294912
 buffer_load_dwordx4 v12, s[8:11], s43 offen  lds
 s_add_u32 m0, s45, 37888
 s_add_u32 s43, s44, 303104
 buffer_load_dwordx4 v12, s[8:11], s43 offen  lds
 s_add_u32 m0, s45, 38912
 s_add_u32 s43, s44, 311296
 buffer_load_dwordx4 v12, s[8:11], s43 offen  lds
 s_add_u32 m0, s45, 39936
 s_add_u32 s43, s44, 319488
 buffer_load_dwordx4 v12, s[8:11], s43 offen  lds
 s_cmp_lg_u32 s26, 1
 s_cbranch_scc1 L_voted_7
 s_bfe_u32 s64, s2, 0x30003
 s_lshl_b32 s56, s64, 21
 s_lshr_b32 s57, s2, 6
 s_lshl_b32 s57, s57, 3
 s_and_b32 s58, s2, 7
 s_add_u32 s57, s57, s58
 s_lshl_b32 s57, s57, 8
 s_add_u32 s56, s56, s57
 s_add_u32 s56, s56, 135790592
 s_mov_b64 s[62:63], -1
 s_mov_b32 s65, 0
 s_waitcnt lgkmcnt(0)
L_voted_7_l:
 s_memtime s[58:59]
 s_load_dword s57, s[4:5], s56 glc
 s_waitcnt lgkmcnt(0)
 s_memtime s[60:61]
 s_xor_b32 s56, s56, 8192
 s_waitcnt lgkmcnt(0)
 s_sub_u32 s58, s60, s58
 s_min_u32 s58, s58, s62
 s_mov_b32 s62, s63
 s_mov_b32 s63, s58
 s_add_u32 s65, s65, 1
 s_cmp_lt_u32 s65, 8
 s_cbranch_scc1 L_voted_7_l
 s_cmp_lt_u32 s62, s63
 s_cselect_b32 s58, 1, 0
 s_xor_b32 s58, s58, s64
 s_bitcmp1_b32 s58, 0
 s_cselect_b32 s35, 0x10000, 1
L_voted_7:
 s_load_dwordx2 s[36:37], s[0:1], 0
 s_mov_b32 s38, 4194304
 s_mov_b32 s39, 0x20000
 v_lshlrev_b32 v4, 7, v0
 s_lshl_b32 s46, s25, 15
 s_waitcnt lgkmcnt(0)
 s_waitcnt vmcnt(9)
 s_barrier
 ds_read_b64_tr_b16 a[0:1], v13 offset:0
 ds_read_b64_tr_b16 a[2:3], v13 offset:1024
 ds_read_b64_tr_b16 a[4:5], v13 offset:4096
 ds_read_b64_tr_b16 a[6:7], v13 offset:5120
 ds_read_b64_tr_b16 a[8:9], v13 offset:8192
 ds_read_b64_tr_b16 a[10:11], v13 offset:9216
 ds_read_b64_tr_b16 a[12:13], v13 offset:12288
 ds_read_b64_tr_b16 a[14:15], v13 offset:13312
 s_waitcnt lgkmcnt(0)
 ds_read_b64_tr_b16 a[16:17], v13 offset:16384
 ds_read_b64_tr_b16 a[18:19], v13 offset:17408
 ds_read_b64_tr_b16 a[20:21], v13 offset:20480
 ds_read_b64_tr_b16 a[22:23], v13 offset:21504
 ds_read_b64_tr_b16 a[24:25], v13 offset:24576
 ds_read_b64_tr_b16 a[26:27], v13 offset:25600
 ds_read_b64_tr_b16 a[28:29], v13 offset:28672
 ds_read_b64_tr_b16 a[30:31], v13 offset:29696
 s_waitcnt lgkmcnt(0)
 s_barrier
 s_add_u32 m0, s45, 0
 s_add_u32 s43, s44, 524288
 buffer_load_dwordx4 v12, s[8:11], s43 offen  lds
 s_add_u32 m0, s45, 1024
 s_add_u32 s43, s44, 532480
 buffer_load_dwordx4 v12, s[8:11], s43 offen  lds
 s_add_u32 m0, s45, 2048
 s_add_u32 s43, s44, 540672
 buffer_load_dwordx4 v12, s[8:11], s43 offen  lds
 s_add_u32 m0, s45, 3072
 s_add_u32 s43, s44, 548864
 buffer_load_dwordx4 v12, s[8:11], s43 offen  lds
 s_add_u32 m0, s45, 4096
 s_add_u32 s43, s44, 557056
 buffer_load_dwordx4 v12, s[8:11], s43 offen  lds
 s_add_u32 m0, s45, 5120
 s_add_u32 s43, s44, 565248
 buffer_load_dwordx4 v12, s[8:11], s43 offen  lds
 s_add_u32 m0, s45, 6144
 s_add_u32 s43, s44, 573440
 buffer_load_dwordx4 v12, s[8:11], s43 offen  lds
 s_add_u32 m0, s45, 7168
 s_add_u32 s43, s44, 581632
 buffer_load_dwordx4 v12, s[8:11], s43 offen  lds
 buffer_load_dword v14, v4, s[36:39], s46 offen sc1
 s_add_u32 s46, s46, 1048576
 s_waitcnt vmcnt(9)
 s_barrier
 ds_read_b64_tr_b16 a[32:33], v13 offset:32768
 ds_read_b64_tr_b16 a[34:35], v13 offset:33792
 ds_read_b64_tr_b16 a[36:37], v13 offset:36864
 ds_read_b64_tr_b16 a[38:39], v13 offset:37888
 ds_read_b64_tr_b16 a[40:41], v13 offset:40960
 ds_read_b64_tr_b16 a[42:43], v13 offset:41984
 ds_read_b64_tr_b16 a[44:45], v13 offset:45056
 ds_read_b64_tr_b16 a[46:47], v13 offset:46080
 s_waitcnt lgkmcnt(0)
 ds_read_b64_tr_b16 a[48:49], v13 offset:49152
 ds_read_b64_tr_b16 a[50:51], v13 offset:50176
 ds_read_b64_tr_b16 a[52:53], v13 offset:53248
 ds_read_b64_tr_b16 a[54:55], v13 offset:54272
 ds_read_b64_tr_b16 a[56:57], v13 offset:57344
 ds_read_b64_tr_b16 a[58:59], v13 offset:58368
 ds_read_b64_tr_b16 a[60:61], v13 offset:61440
 ds_read_b64_tr_b16 a[62:63], v13 offset:62464
 s_waitcnt lgkmcnt(0)
 s_barrier
 s_add_u32 m0, s45, 32768
 s_add_u32 s43, s44, 786432
 buffer_load_dwordx4 v12, s[8:11], s43 offen  lds
 s_add_u32 m0, s45, 33792
 s_add_u32 s43, s44, 794624
 buffer_load_dwordx4 v12, s[8:11], s43 offen  lds
 s_add_u32 m0, s45, 34816
 s_add_u32 s43, s44, 802816
 buffer_load_dwordx4 v12, s[8:11], s43 offen  lds
 s_add_u32 m0, s45, 35840
 s_add_u32 s43, s44, 811008
 buffer_load_dwordx4 v12, s[8:11], s43 offen  lds
 s_add_u32 m0, s45, 36864
 s_add_u32 s43, s44, 819200
 buffer_load_dwordx4 v12, s[8:11], s43 offen  lds
 s_add_u32 m0, s45, 37888
 s_add_u32 s43, s44, 827392
 buffer_load_dwordx4 v12, s[8:11], s43 offen  lds
 s_add_u32 m0, s45, 38912
 s_add_u32 s43, s44, 835584
 buffer_load_dwordx4 v12, s[8:11], s43 offen  lds
 s_add_u32 m0, s45, 39936
 s_add_u32 s43, s44, 843776
 buffer_load_dwordx4 v12, s[8:11], s43 offen  lds
 v_mov_b32 v250, s34
 v_mov_b32 v251, s35
 v_bfrev_b32 v252, 1
 v_cmp_eq_u32 vcc, 64, v0
 s_nop 1
 v_cndmask_b32 v252, v252, 0, vcc
 buffer_atomic_add_x2 v[250:251], v252, s[12:15], s30 offen sc1
 s_waitcnt vmcnt(10)
 s_barrier
 ds_read_b64_tr_b16 a[64:65], v13 offset:0
 ds_read_b64_tr_b16 a[66:67], v13 offset:1024
 ds_read_b64_tr_b16 a[68:69], v13 offset:4096
 ds_read_b64_tr_b16 a[70:71], v13 offset:5120
 ds_read_b64_tr_b16 a[72:73], v13 offset:8192
 ds_read_b64_tr_b16 a[74:75], v13 offset:9216
 ds_read_b64_tr_b16 a[76:77], v13 offset:12288
 ds_read_b64_tr_b16 a[78:79], v13 offset:13312
 s_waitcnt lgkmcnt(0)
 ds_read_b64_tr_b16 a[80:81], v13 offset:16384
 ds_read_b64_tr_b16 a[82:83], v13 offset:17408
 ds_read_b64_tr_b16 a[84:85], v13 offset:20480
 ds_read_b64_tr_b16 a[86:87], v13 offset:21504
 ds_read_b64_tr_b16 a[88:89], v13 offset:24576
 ds_read_b64_tr_b16 a[90:91], v13 offset:25600
 ds_read_b64_tr_b16 a[92:93], v13 offset:28672
 ds_read_b64_tr_b16 a[94:95], v13 offset:29696
 s_waitcnt lgkmcnt(0)
 s_barrier
 s_add_u32 m0, s45, 0
 s_add_u32 s43, s44, 1048576
 buffer_load_dwordx4 v12, s[8:11], s43 offen  lds
 s_add_u32 m0, s45, 1024
 s_add_u32 s43, s44, 1056768
 buffer_load_dwordx4 v12, s[8:11], s43 offen  lds
 s_add_u32 m0, s45, 2048
 s_add_u32 s43, s44, 1064960
 buffer_load_dwordx4 v12, s[8:11], s43 offen  lds
 s_add_u32 m0, s45, 3072
 s_add_u32 s43, s44, 1073152
 buffer_load_dwordx4 v12, s[8:11], s43 offen  lds
 s_add_u32 m0, s45, 4096
 s_add_u32 s43, s44, 1081344
 buffer_load_dwordx4 v12, s[8:11], s43 offen  lds
 s_add_u32 m0, s45, 5120
 s_add_u32 s43, s44, 1089536
 buffer_load_dwordx4 v12, s[8:11], s43 offen  lds
 s_add_u32 m0, s45, 6144
 s_add_u32 s43, s44, 1097728
 buffer_load_dwordx4 v12, s[8:11], s43 offen  lds
 s_add_u32 m0, s45, 7168
 s_add_u32 s43, s44, 1105920
 buffer_load_dwordx4 v12, s[8:11], s43 offen  lds
 buffer_load_dword v14, v4, s[36:39], s46 offen sc1
 s_add_u32 s46, s46, 1048576
 s_waitcnt vmcnt(10)
 s_barrier
 ds_read_b64_tr_b16 a[96:97], v13 offset:32768
 ds_read_b64_tr_b16 a[98:99], v13 offset:33792
 ds_read_b64_tr_b16 a[100:101], v13 offset:36864
 ds_read_b64_tr_b16 a[102:103], v13 offset:37888
 ds_read_b64_tr_b16 a[104:105], v13 offset:40960
 ds_read_b64_tr_b16 a[106:107], v13 offset:41984
 ds_read_b64_tr_b16 a[108:109], v13 offset:45056
 ds_read_b64_tr_b16 a[110:111], v13 offset:46080
 s_waitcnt lgkmcnt(0)
 ds_read_b64_tr_b16 a[112:113], v13 offset:49152
 ds_read_b64_tr_b16 a[114:115], v13 offset:50176
 ds_read_b64_tr_b16 a[116:117], v13 offset:53248
 ds_read_b64_tr_b16 a[118:119], v13 offset:54272
 ds_read_b64_tr_b16 a[120:121], v13 offset:57344
 ds_read_b64_tr_b16 a[122:123], v13 offset:58368
 ds_read_b64_tr_b16 a[124:125], v13 offset:61440
 ds_read_b64_tr_b16 a[126:127], v13 offset:62464
 s_waitcnt lgkmcnt(0)
 s_barrier
 s_add_u32 m0, s45, 32768
 s_add_u32 s43, s44, 1310720
 buffer_load_dwordx4 v12, s[8:11], s43 offen  lds
 s_add_u32 m0, s45, 33792
 s_add_u32 s43, s44, 1318912
 buffer_load_dwordx4 v12, s[8:11], s43 offen  lds
 s_add_u32 m0, s45, 34816
 s_add_u32 s43, s44, 1327104
 buffer_load_dwordx4 v12, s[8:11], s43 offen  lds
 s_add_u32 m0, s45, 35840
 s_add_u32 s43, s44, 1335296
 buffer_load_dwordx4 v12, s[8:11], s43 offen  lds
 s_add_u32 m0, s45, 36864
 s_add_u32 s43, s44, 1343488
 buffer_load_dwordx4 v12, s[8:11], s43 offen  lds
 s_add_u32 m0, s45, 37888
 s_add_u32 s43, s44, 1351680
 buffer_load_dwordx4 v12, s[8:11], s43 offen  lds
 s_add_u32 m0, s45, 38912
 s_add_u32 s43, s44, 1359872
 buffer_load_dwordx4 v12, s[8:11], s43 offen  lds
 s_add_u32 m0, s45, 39936
 s_add_u32 s43, s44, 1368064
 buffer_load_dwordx4 v12, s[8:11], s43 offen  lds
 s_waitcnt vmcnt(9)
 s_barrier
 ds_read_b64_tr_b16 a[128:129], v13 offset:0
 ds_read_b64_tr_b16 a[130:131], v13 offset:1024
 ds_read_b64_tr_b16 a[132:133], v13 offset:4096
 ds_read_b64_tr_b16 a[134:135], v13 offset:5120
 ds_read_b64_tr_b16 a[136:137], v13 offset:8192
 ds_read_b64_tr_b16 a[138:139], v13 offset:9216
 ds_read_b64_tr_b16 a[140:141], v13 offset:12288
 ds_read_b64_tr_b16 a[142:143], v13 offset:13312
 s_waitcnt lgkmcnt(0)
 ds_read_b64_tr_b16 a[144:145], v13 offset:16384
 ds_read_b64_tr_b16 a[146:147], v13 offset:17408
 ds_read_b64_tr_b16 a[148:149], v13 offset:20480
 ds_read_b64_tr_b16 a[150:151], v13 offset:21504
 ds_read_b64_tr_b16 a[152:153], v13 offset:24576
 ds_read_b64_tr_b16 a[154:155], v13 offset:25600
 ds_read_b64_tr_b16 a[156:157], v13 offset:28672
 ds_read_b64_tr_b16 a[158:159], v13 offset:29696
 s_waitcnt lgkmcnt(0)
 s_barrier
 s_add_u32 m0, s45, 0
 s_add_u32 s43, s44, 1572864
 buffer_load_dwordx4 v12, s[8:11], s43 offen  lds
 s_add_u32 m0, s45, 1024
 s_add_u32 s43, s44, 1581056
 buffer_load_dwordx4 v12, s[8:11], s43 offen  lds
 s_add_u32 m0, s45, 2048
 s_add_u32 s43, s44, 1589248
 buffer_load_dwordx4 v12, s[8:11], s43 offen  lds
 s_add_u32 m0, s45, 3072
 s_add_u32 s43, s44, 1597440
 buffer_load_dwordx4 v12, s[8:11], s43 offen  lds
 s_add_u32 m0, s45, 4096
 s_add_u32 s43, s44, 1605632
 buffer_load_dwordx4 v12, s[8:11], s43 offen  lds
 s_add_u32 m0, s45, 5120
 s_add_u32 s43, s44, 1613824
 buffer_load_dwordx4 v12, s[8:11], s43 offen  lds
 s_add_u32 m0, s45, 6144
 s_add_u32 s43, s44, 1622016
 buffer_load_dwordx4 v12, s[8:11], s43 offen  lds
 s_add_u32 m0, s45, 7168
 s_add_u32 s43, s44, 1630208
 buffer_load_dwordx4 v12, s[8:11], s43 offen  lds
 buffer_load_dword v14, v4, s[36:39], s46 offen sc1
 s_add_u32 s46, s46, 1048576
 s_waitcnt vmcnt(9)
 s_barrier
 ds_read_b64_tr_b16 a[160:161], v13 offset:32768
 ds_read_b64_tr_b16 a[162:163], v13 offset:33792
 ds_read_b64_tr_b16 a[164:165], v13 offset:36864
 ds_read_b64_tr_b16 a[166:167], v13 offset:37888
 ds_read_b64_tr_b16 a[168:169], v13 offset:40960
 ds_read_b64_tr_b16 a[170:171], v13 offset:41984
 ds_read_b64_tr_b16 a[172:173], v13 offset:45056
 ds_read_b64_tr_b16 a[174:175], v13 offset:46080
 s_waitcnt lgkmcnt(0)
 ds_read_b64_tr_b16 a[176:177], v13 offset:49152
 ds_read_b64_tr_b16 a[178:179], v13 offset:50176
 ds_read_b64_tr_b16 a[180:181], v13 offset:53248
 ds_read_b64_tr_b16 a[182:183], v13 offset:54272
 ds_read_b64_tr_b16 a[184:185], v13 offset:57344
 ds_read_b64_tr_b16 a[186:187], v13 offset:58368
 ds_read_b64_tr_b16 a[188:189], v13 offset:61440
 ds_read_b64_tr_b16 a[190:191], v13 offset:62464
 s_waitcnt lgkmcnt(0)
 s_barrier
 s_add_u32 m0, s45, 32768
 s_add_u32 s43, s44, 1835008
 buffer_load_dwordx4 v12, s[8:11], s43 offen  lds
 s_add_u32 m0, s45, 33792
 s_add_u32 s43, s44, 1843200
 buffer_load_dwordx4 v12, s[8:11], s43 offen  lds
 s_add_u32 m0, s45, 34816
 s_add_u32 s43, s44, 1851392
 buffer_load_dwordx4 v12, s[8:11], s43 offen  lds
 s_add_u32 m0, s45, 35840
 s_add_u32 s43, s44, 1859584
 buffer_load_dwordx4 v12, s[8:11], s43 offen  lds
 s_add_u32 m0, s45, 36864
 s_add_u32 s43, s44, 1867776
 buffer_load_dwordx4 v12, s[8:11], s43 offen  lds
 s_add_u32 m0, s45, 37888
 s_add_u32 s43, s44, 1875968
 buffer_load_dwordx4 v12, s[8:11], s43 offen  lds
 s_add_u32 m0, s45, 38912
 s_add_u32 s43, s44, 1884160
 buffer_load_dwordx4 v12, s[8:11], s43 offen  lds
 s_add_u32 m0, s45, 39936
 s_add_u32 s43, s44, 1892352
 buffer_load_dwordx4 v12, s[8:11], s43 offen  lds
 s_waitcnt vmcnt(9)
 s_barrier
 ds_read_b64_tr_b16 a[192:193], v13 offset:0
 ds_read_b64_tr_b16 a[194:195], v13 offset:1024
 ds_read_b64_tr_b16 a[196:197], v13 offset:4096
 ds_read_b64_tr_b16 a[198:199], v13 offset:5120
 ds_read_b64_tr_b16 a[200:201], v13 offset:8192
 ds_read_b64_tr_b16 a[202:203], v13 offset:9216
 ds_read_b64_tr_b16 a[204:205], v13 offset:12288
 ds_read_b64_tr_b16 a[206:207], v13 offset:13312
 s_waitcnt lgkmcnt(0)
 ds_read_b64_tr_b16 a[208:209], v13 offset:16384
 ds_read_b64_tr_b16 a[210:211], v13 offset:17408
 ds_read_b64_tr_b16 a[212:213], v13 offset:20480
 ds_read_b64_tr_b16 a[214:215], v13 offset:21504
 ds_read_b64_tr_b16 a[216:217], v13 offset:24576
 ds_read_b64_tr_b16 a[218:219], v13 offset:25600
 ds_read_b64_tr_b16 a[220:221], v13 offset:28672
 ds_read_b64_tr_b16 a[222:223], v13 offset:29696
 s_waitcnt lgkmcnt(0)
 buffer_load_dword v14, v4, s[36:39], s46 offen sc1
 s_add_u32 s46, s46, 1048576
 s_waitcnt vmcnt(1)
 s_barrier
 ds_read_b64_tr_b16 a[224:225], v13 offset:32768
 ds_read_b64_tr_b16 a[226:227], v13 offset:33792
 ds_read_b64_tr_b16 a[228:229], v13 offset:36864
 ds_read_b64_tr_b16 a[230:231], v13 offset:37888
 ds_read_b64_tr_b16 a[232:233], v13 offset:40960
 ds_read_b64_tr_b16 a[234:235], v13 offset:41984
 ds_read_b64_tr_b16 a[236:237], v13 offset:45056
 ds_read_b64_tr_b16 a[238:239], v13 offset:46080
 s_waitcnt lgkmcnt(0)
 ds_read_b64_tr_b16 a[240:241], v13 offset:49152
 ds_read_b64_tr_b16 a[242:243], v13 offset:50176
 ds_read_b64_tr_b16 a[244:245], v13 offset:53248
 ds_read_b64_tr_b16 a[246:247], v13 offset:54272
 ds_read_b64_tr_b16 a[248:249], v13 offset:57344
 ds_read_b64_tr_b16 a[250:251], v13 offset:58368
 ds_read_b64_tr_b16 a[252:253], v13 offset:61440
 ds_read_b64_tr_b16 a[254:255], v13 offset:62464
 s_waitcnt lgkmcnt(0)
 s_mov_b32 s31, 2
 s_branch L_conv_front
L_conv_ret_O:
 s_barrier
 s_mov_b32 s3, 0
L_rdy_8:
 buffer_load_dwordx4 v[84:87], off, s[12:15], s30 sc1
 s_add_u32 s3, s3, 1
 s_cmp_gt_u32 s3, 400000
 s_cbranch_scc1 L_exit
 s_waitcnt vmcnt(0)
 v_readfirstlane_b32 s32, v84
 v_readfirstlane_b32 s33, v85
 v_readfirstlane_b32 vcc_hi, v86
 s_and_b32 vcc_lo, s32, 0xffff
 s_cmp_lt_u32 vcc_lo, 256
 s_cbranch_scc1 L_rdy_8
 s_cmp_lg_u32 vcc_hi, 0
 s_cbranch_scc1 L_general
 s_load_dwordx2 s[8:9], s[0:1], 128
 s_mov_b32 s10, 8388608
 s_mov_b32 s11, 0x20000
 s_mov_b32 s36, s4
 s_mov_b32 s37, s5
 s_mov_b32 s38, s6
 s_mov_b32 s39, s7
 s_lshr_b32 s41, s25, 3
 s_lshl_b32 s41, s41, 2
 s_add_u32 s41, s41, s26
 s_lshl_b32 s44, s41, 14
 s_add_u32 s44, s44, 67108864
 s_lshl_b32 s47, s41, 7
 s_add_u32 s47, s47, 3932160
 s_lshl_b32 s45, s26, 14
 s_waitcnt lgkmcnt(0)
 v_mov_b32 v15, 0
 v_and_b32 v255, 1, v1
 v_lshlrev_b32 v255, 2, v255
 s_mov_b32 s56, 0
 s_mov_b32 s57, 0
 s_mov_b32 s58, 0
 s_mov_b32 s59, 0
 s_mov_b32 s60, 0
 s_mov_b32 s61, 0
 s_mov_b32 s62, 0
 s_mov_b32 s63, 0
 s_mov_b32 s64, 0
 s_mov_b32 s65, 0
 s_mov_b32 s66, 0
 s_mov_b32 s67, 0
 s_mov_b32 s68, 0
 s_mov_b32 s69, 0
 s_mov_b32 s70, 0
 s_mov_b32 s71, 0
 s_mov_b32 s40, 0
 s_and_b32 s41, s25, 7
 s_lshl_b32 s41, s41, 2
 s_add_u32 s41, s41, s26
 s_lshl_b32 s46, s41, 14
 s_lshl_b32 s54, s41, 6
 s_lshr_b32 s41, s25, 3
 s_xor_b32 s42, s41, 1
 s_lshl_b32 s42, s42, 12
 s_add_u32 s42, s42, s46
 s_add_u32 s64, s42, 1163396096
 s_xor_b32 s42, s41, 2
 s_lshl_b32 s42, s42, 12
 s_add_u32 s42, s42, s46
 s_add_u32 s65, s42, 1163397120
 s_xor_b32 s42, s41, 3
 s_lshl_b32 s42, s42, 12
 s_add_u32 s42, s42, s46
 s_add_u32 s66, s42, 1163398144
 s_lshl_b32 s42, s41, 12
 s_add_u32 s42, s42, s46
 s_add_u32 s53, s42, 1162870784
 s_lshl_b32 s42, s41, 4
 s_add_u32 s54, s54, s42
 s_add_u32 s54, s54, 1073348608
 v_and_b32 v3, 31, v1
 v_lshrrev_b32 v4, 5, v1
 v_lshlrev_b32 v14, 12, v3
 v_lshl_add_u32 v14, v4, 3, v14
L_rO_first:
 v_cmp_ge_u32 vcc, 0, v15
 s_and_b32 vcc_lo, vcc_lo, 0x3
 s_cbranch_scc0 L_rO_firstok
 buffer_load_dword v15, v255, s[4:7], s47 offen sc1
 s_add_u32 s48, s48, 1
 s_cmp_gt_u32 s48, 400000
 s_cbranch_scc1 L_done
 s_waitcnt vmcnt(0)
 s_branch L_rO_first
L_rO_firstok:
 s_add_u32 s47, s47, 2048
 buffer_load_dword v15, v255, s[4:7], s47 offen sc1
 s_add_u32 m0, s45, 0
 s_add_u32 s43, s44, 0
 buffer_load_dwordx4 v2, s[36:39], s43 offen offset:0 sc1 lds
 buffer_load_dwordx4 v2, s[36:39], s43 offen offset:1024 sc1 lds
 buffer_load_dwordx4 v2, s[36:39], s43 offen offset:2048 sc1 lds
 buffer_load_dwordx4 v2, s[36:39], s43 offen offset:3072 sc1 lds
 s_add_u32 m0, s45, 4096
 s_add_u32 s43, s44, 4096
 buffer_load_dwordx4 v2, s[36:39], s43 offen offset:0 sc1 lds
 buffer_load_dwordx4 v2, s[36:39], s43 offen offset:1024 sc1 lds
 buffer_load_dwordx4 v2, s[36:39], s43 offen offset:2048 sc1 lds
 buffer_load_dwordx4 v2, s[36:39], s43 offen offset:3072 sc1 lds
 s_add_u32 m0, s45, 8192
 s_add_u32 s43, s44, 8192
 buffer_load_dwordx4 v2, s[36:39], s43 offen offset:0 sc1 lds
 buffer_load_dwordx4 v2, s[36:39], s43 offen offset:1024 sc1 lds
 buffer_load_dwordx4 v2, s[36:39], s43 offen offset:2048 sc1 lds
 buffer_load_dwordx4 v2, s[36:39], s43 offen offset:3072 sc1 lds
 s_add_u32 m0, s45, 12288
 s_add_u32 s43, s44, 12288
 buffer_load_dwordx4 v2, s[36:39], s43 offen offset:0 sc1 lds
 buffer_load_dwordx4 v2, s[36:39], s43 offen offset:1024 sc1 lds
 buffer_load_dwordx4 v2, s[36:39], s43 offen offset:2048 sc1 lds
 buffer_load_dwordx4 v2, s[36:39], s43 offen offset:3072 sc1 lds
 s_waitcnt vmcnt(0)
 s_barrier
 ds_read_b128 v[16:19], v10 offset:0
 ds_read_b128 v[20:23], v10 offset:1024
 ds_read_b128 v[24:27], v10 offset:2048
 ds_read_b128 v[28:31], v10 offset:3072
 ds_read_b128 v[32:35], v10 offset:4096
 ds_read_b128 v[36:39], v10 offset:5120
L_rO_loop:
 s_waitcnt lgkmcnt(5)
 v_mfma_f32_32x32x16_bf16 v[48:63], a[0:3], v[16:19], 0
 ds_read_b128 v[40:43], v10 offset:6144
 s_add_u32 s44, s44, 0x40000
 s_add_u32 s42, s40, 1
 v_cmp_ge_u32 vcc, s42, v15
 s_waitcnt lgkmcnt(5)
 v_mfma_f32_32x32x16_bf16 v[48:63], a[4:7], v[20:23], v[48:63]
 ds_read_b128 v[44:47], v10 offset:7168
 s_and_b32 vcc_lo, vcc_lo, 0x3
 s_cselect_b32 s50, 0, 1
 s_cselect_b32 s51, 1073741824, s44
 s_waitcnt lgkmcnt(5)
 v_mfma_f32_32x32x16_bf16 v[48:63], a[8:11], v[24:27], v[48:63]
 ds_read_b128 v[16:19], v10 offset:8192
 s_add_u32 m0, s45, 65536
 s_add_u32 s43, s51, 0
 buffer_load_dwordx4 v2, s[36:39], s43 offen offset:0 sc1 lds
 s_waitcnt lgkmcnt(5)
 v_mfma_f32_32x32x16_bf16 v[48:63], a[12:15], v[28:31], v[48:63]
 ds_read_b128 v[20:23], v10 offset:9216
 s_waitcnt lgkmcnt(5)
 v_mfma_f32_32x32x16_bf16 v[48:63], a[16:19], v[32:35], v[48:63]
 ds_read_b128 v[24:27], v10 offset:10240
 buffer_load_dwordx4 v2, s[36:39], s43 offen offset:1024 sc1 lds
 s_waitcnt lgkmcnt(5)
 v_mfma_f32_32x32x16_bf16 v[48:63], a[20:23], v[36:39], v[48:63]
 ds_read_b128 v[28:31], v10 offset:11264
 s_waitcnt lgkmcnt(5)
 v_mfma_f32_32x32x16_bf16 v[48:63], a[24:27], v[40:43], v[48:63]
 ds_read_b128 v[32:35], v10 offset:12288
 s_cmp_eq_u32 s29, 1
 s_cbranch_scc1 L_rO_sf1
 buffer_store_dwordx4 v[68:71], v2, s[4:7], s64 offen
L_rO_sb1:
 s_add_u32 s64, s64, 524288
 s_and_b32 s64, s64, 0x3fdfffff
 s_waitcnt lgkmcnt(5)
 v_mfma_f32_32x32x16_bf16 v[48:63], a[28:31], v[44:47], v[48:63]
 ds_read_b128 v[36:39], v10 offset:13312
 buffer_load_dwordx4 v2, s[36:39], s43 offen offset:2048 sc1 lds
 s_waitcnt lgkmcnt(5)
 v_mfma_f32_32x32x16_bf16 v[48:63], a[32:35], v[16:19], v[48:63]
 ds_read_b128 v[40:43], v10 offset:14336
 s_waitcnt lgkmcnt(5)
 v_mfma_f32_32x32x16_bf16 v[48:63], a[36:39], v[20:23], v[48:63]
 ds_read_b128 v[44:47], v10 offset:15360
 buffer_load_dwordx4 v2, s[36:39], s43 offen offset:3072 sc1 lds
 s_waitcnt lgkmcnt(5)
 v_mfma_f32_32x32x16_bf16 v[48:63], a[40:43], v[24:27], v[48:63]
 ds_read_b128 v[16:19], v10 offset:16384
 s_waitcnt lgkmcnt(5)
 v_mfma_f32_32x32x16_bf16 v[48:63], a[44:47], v[28:31], v[48:63]
 ds_read_b128 v[20:23], v10 offset:17408
 s_cmp_eq_u32 s29, 1
 s_cbranch_scc1 L_rO_sf2
 buffer_store_dwordx4 v[72:75], v2, s[4:7], s65 offen
L_rO_sb2:
 s_add_u32 s65, s65, 524288
 s_and_b32 s65, s65, 0x3fdfffff
 s_waitcnt lgkmcnt(5)
 v_mfma_f32_32x32x16_bf16 v[48:63], a[48:51], v[32:35], v[48:63]
 ds_read_b128 v[24:27], v10 offset:18432
 s_add_u32 m0, s45, 69632
 s_add_u32 s43, s51, 4096
 buffer_load_dwordx4 v2, s[36:39], s43 offen offset:0 sc1 lds
 s_waitcnt lgkmcnt(5)
 v_mfma_f32_32x32x16_bf16 v[48:63], a[52:55], v[36:39], v[48:63]
 ds_read_b128 v[28:31], v10 offset:19456
 s_waitcnt lgkmcnt(5)
 v_mfma_f32_32x32x16_bf16 v[48:63], a[56:59], v[40:43], v[48:63]
 ds_read_b128 v[32:35], v10 offset:20480
 buffer_load_dwordx4 v2, s[36:39], s43 offen offset:1024 sc1 lds
 s_waitcnt lgkmcnt(5)
 v_mfma_f32_32x32x16_bf16 v[48:63], a[60:63], v[44:47], v[48:63]
 ds_read_b128 v[36:39], v10 offset:21504
 s_waitcnt lgkmcnt(5)
 v_mfma_f32_32x32x16_bf16 v[48:63], a[64:67], v[16:19], v[48:63]
 ds_read_b128 v[40:43], v10 offset:22528
 s_cmp_eq_u32 s29, 1
 s_cbranch_scc1 L_rO_sf3
 buffer_store_dwordx4 v[76:79], v2, s[4:7], s66 offen
L_rO_sb3:
 s_add_u32 s66, s66, 524288
 s_and_b32 s66, s66, 0x3fdfffff
 s_waitcnt lgkmcnt(5)
 v_mfma_f32_32x32x16_bf16 v[48:63], a[68:71], v[20:23], v[48:63]
 ds_read_b128 v[44:47], v10 offset:23552
 buffer_load_dwordx4 v2, s[36:39], s43 offen offset:2048 sc1 lds
 s_waitcnt lgkmcnt(5)
 v_mfma_f32_32x32x16_bf16 v[48:63], a[72:75], v[24:27], v[48:63]
 ds_read_b128 v[16:19], v10 offset:24576
 s_waitcnt vmcnt(10)
 v_pk_add_f32 v[92:93], v[92:93], v[96:97]
 v_pk_add_f32 v[94:95], v[94:95], v[98:99]
 v_pk_add_f32 v[92:93], v[92:93], v[100:101]
 s_waitcnt lgkmcnt(5)
 v_mfma_f32_32x32x16_bf16 v[48:63], a[76:79], v[28:31], v[48:63]
 ds_read_b128 v[20:23], v10 offset:25600
 buffer_load_dwordx4 v2, s[36:39], s43 offen offset:3072 sc1 lds
 s_waitcnt lgkmcnt(5)
 v_mfma_f32_32x32x16_bf16 v[48:63], a[80:83], v[32:35], v[48:63]
 ds_read_b128 v[24:27], v10 offset:26624
 v_pk_add_f32 v[94:95], v[94:95], v[102:103]
 v_pk_add_f32 v[92:93], v[92:93], v[104:105]
 v_pk_add_f32 v[94:95], v[94:95], v[106:107]
 s_waitcnt lgkmcnt(5)
 v_mfma_f32_32x32x16_bf16 v[48:63], a[84:87], v[36:39], v[48:63]
 ds_read_b128 v[28:31], v10 offset:27648
 v_cvt_pk_bf16_f32 v80, v92, v93
 v_cvt_pk_bf16_f32 v81, v94, v95
 s_waitcnt lgkmcnt(5)
 v_mfma_f32_32x32x16_bf16 v[48:63], a[88:91], v[40:43], v[48:63]
 ds_read_b128 v[32:35], v10 offset:28672
 s_add_u32 m0, s45, 73728
 s_add_u32 s43, s51, 8192
 buffer_load_dwordx4 v2, s[36:39], s43 offen offset:0 sc1 lds
 s_waitcnt lgkmcnt(5)
 v_mfma_f32_32x32x16_bf16 v[48:63], a[92:95], v[44:47], v[48:63]
 ds_read_b128 v[36:39], v10 offset:29696
 buffer_store_dwordx2 v[80:81], v14, s[8:11], s54 offen
 s_add_u32 s54, s54, 131072
 s_bitset0_b32 s54, 30
 s_waitcnt lgkmcnt(5)
 v_mfma_f32_32x32x16_bf16 v[48:63], a[96:99], v[16:19], v[48:63]
 ds_read_b128 v[40:43], v10 offset:30720
 buffer_load_dwordx4 v2, s[36:39], s43 offen offset:1024 sc1 lds
 s_waitcnt lgkmcnt(5)
 v_mfma_f32_32x32x16_bf16 v[48:63], a[100:103], v[20:23], v[48:63]
 ds_read_b128 v[44:47], v10 offset:31744
 v_mov_b32 v92, v64
 v_mov_b32 v93, v65
 v_mov_b32 v94, v66
 v_mov_b32 v95, v67
 s_waitcnt lgkmcnt(5)
 v_mfma_f32_32x32x16_bf16 v[48:63], a[104:107], v[24:27], v[48:63]
 ds_read_b128 v[16:19], v10 offset:32768
 s_load_dwordx4 s[60:63], s[4:5], s49 glc
 s_waitcnt lgkmcnt(5)
 v_mfma_f32_32x32x16_bf16 v[48:63], a[108:111], v[28:31], v[48:63]
 ds_read_b128 v[20:23], v10 offset:33792
 buffer_load_dwordx4 v2, s[36:39], s43 offen offset:2048 sc1 lds
 s_waitcnt lgkmcnt(5)
 v_mfma_f32_32x32x16_bf16 v[48:63], a[112:115], v[32:35], v[48:63]
 ds_read_b128 v[24:27], v10 offset:34816
 s_waitcnt lgkmcnt(5)
 v_mfma_f32_32x32x16_bf16 v[48:63], a[116:119], v[36:39], v[48:63]
 ds_read_b128 v[28:31], v10 offset:35840
 buffer_load_dwordx4 v2, s[36:39], s43 offen offset:3072 sc1 lds
 s_waitcnt lgkmcnt(5)
 v_mfma_f32_32x32x16_bf16 v[48:63], a[120:123], v[40:43], v[48:63]
 ds_read_b128 v[32:35], v10 offset:36864
 s_waitcnt lgkmcnt(5)
 v_mfma_f32_32x32x16_bf16 v[48:63], a[124:127], v[44:47], v[48:63]
 ds_read_b128 v[36:39], v10 offset:37888
 s_waitcnt lgkmcnt(5)
 v_mfma_f32_32x32x16_bf16 v[48:63], a[128:131], v[16:19], v[48:63]
 ds_read_b128 v[40:43], v10 offset:38912
 s_add_u32 m0, s45, 77824
 s_add_u32 s43, s51, 12288
 buffer_load_dwordx4 v2, s[36:39], s43 offen offset:0 sc1 lds
 s_waitcnt lgkmcnt(5)
 v_mfma_f32_32x32x16_bf16 v[48:63], a[132:135], v[20:23], v[48:63]
 ds_read_b128 v[44:47], v10 offset:39936
 s_waitcnt lgkmcnt(5)
 v_mfma_f32_32x32x16_bf16 v[48:63], a[136:139], v[24:27], v[48:63]
 ds_read_b128 v[16:19], v10 offset:40960
 buffer_load_dwordx4 v2, s[36:39], s43 offen offset:1024 sc1 lds
 s_waitcnt lgkmcnt(5)
 v_mfma_f32_32x32x16_bf16 v[48:63], a[140:143], v[28:31], v[48:63]
 ds_read_b128 v[20:23], v10 offset:41984
 s_waitcnt lgkmcnt(5)
 v_mfma_f32_32x32x16_bf16 v[48:63], a[144:147], v[32:35], v[48:63]
 ds_read_b128 v[24:27], v10 offset:43008
 s_waitcnt lgkmcnt(5)
 v_mfma_f32_32x32x16_bf16 v[48:63], a[148:151], v[36:39], v[48:63]
 ds_read_b128 v[28:31], v10 offset:44032
 buffer_load_dwordx4 v2, s[36:39], s43 offen offset:2048 sc1 lds
 s_waitcnt lgkmcnt(5)
 v_mfma_f32_32x32x16_bf16 v[48:63], a[152:155], v[40:43], v[48:63]
 ds_read_b128 v[32:35], v10 offset:45056
 s_waitcnt lgkmcnt(5)
 v_mfma_f32_32x32x16_bf16 v[48:63], a[156:159], v[44:47], v[48:63]
 ds_read_b128 v[36:39], v10 offset:46080
 buffer_load_dwordx4 v2, s[36:39], s43 offen offset:3072 sc1 lds
 s_waitcnt lgkmcnt(5)
 v_mfma_f32_32x32x16_bf16 v[48:63], a[160:163], v[16:19], v[48:63]
 ds_read_b128 v[40:43], v10 offset:47104
 s_lshl_b32 s41, s50, 11
 s_add_u32 s47, s47, s41
 buffer_load_dword v15, v255, s[4:7], s47 offen sc1
 s_waitcnt lgkmcnt(5)
 v_mfma_f32_32x32x16_bf16 v[48:63], a[164:167], v[20:23], v[48:63]
 ds_read_b128 v[44:47], v10 offset:48128
 s_waitcnt lgkmcnt(5)
 v_mfma_f32_32x32x16_bf16 v[48:63], a[168:171], v[24:27], v[48:63]
 ds_read_b128 v[16:19], v10 offset:49152
 s_add_u32 s41, s40, 2
 v_mov_b32 v9, s41
 s_waitcnt vmcnt(12)
 buffer_store_dword v9, v8, s[4:7], 0 offen sc1
 s_waitcnt lgkmcnt(5)
 v_mfma_f32_32x32x16_bf16 v[48:63], a[172:175], v[28:31], v[48:63]
 ds_read_b128 v[20:23], v10 offset:50176
 s_waitcnt lgkmcnt(5)
 v_mfma_f32_32x32x16_bf16 v[48:63], a[176:179], v[32:35], v[48:63]
 ds_read_b128 v[24:27], v10 offset:51200
 s_waitcnt lgkmcnt(5)
 v_mfma_f32_32x32x16_bf16 v[48:63], a[180:183], v[36:39], v[48:63]
 ds_read_b128 v[28:31], v10 offset:52224
 s_waitcnt lgkmcnt(5)
 v_mfma_f32_32x32x16_bf16 v[48:63], a[184:187], v[40:43], v[48:63]
 ds_read_b128 v[32:35], v10 offset:53248
 s_waitcnt lgkmcnt(5)
 v_mfma_f32_32x32x16_bf16 v[48:63], a[188:191], v[44:47], v[48:63]
 ds_read_b128 v[36:39], v10 offset:54272
 s_waitcnt lgkmcnt(5)
 v_mfma_f32_32x32x16_bf16 v[48:63], a[192:195], v[16:19], v[48:63]
 ds_read_b128 v[40:43], v10 offset:55296
 s_waitcnt lgkmcnt(5)
 v_mfma_f32_32x32x16_bf16 v[48:63], a[196:199], v[20:23], v[48:63]
 ds_read_b128 v[44:47], v10 offset:56320
 s_waitcnt lgkmcnt(5)
 v_mfma_f32_32x32x16_bf16 v[48:63], a[200:203], v[24:27], v[48:63]
 ds_read_b128 v[16:19], v10 offset:57344
 s_sub_u32 s52, s40, 0
L_rO_p0:
 s_min_u32 s41, s60, s61
 s_min_u32 s41, s41, s62
 s_min_u32 s41, s41, s63
 s_cmp_gt_u32 s41, s52
 s_cbranch_scc1 L_rO_p0ok
 s_load_dwordx4 s[60:63], s[4:5], s49 glc
 s_add_u32 s48, s48, 1
 s_cmp_gt_u32 s48, 400000
 s_cbranch_scc1 L_done
 s_waitcnt lgkmcnt(0)
 s_branch L_rO_p0
L_rO_p0ok:
 buffer_load_dwordx4 v[96:99], v2, s[4:7], s53 offen offset:1024 sc1
 buffer_load_dwordx4 v[100:103], v2, s[4:7], s53 offen offset:2048 sc1
 buffer_load_dwordx4 v[104:107], v2, s[4:7], s53 offen offset:3072 sc1
 s_add_u32 s53, s53, 524288
 s_bitcmp1_b32 s53, 21
 s_cselect_b32 s41, 0x3fdfffff, -1
 s_and_b32 s53, s53, s41
 s_waitcnt lgkmcnt(5)
 v_mfma_f32_32x32x16_bf16 v[48:63], a[204:207], v[28:31], v[48:63]
 ds_read_b128 v[20:23], v10 offset:58368
 s_waitcnt lgkmcnt(5)
 v_mfma_f32_32x32x16_bf16 v[48:63], a[208:211], v[32:35], v[48:63]
 ds_read_b128 v[24:27], v10 offset:59392
 s_waitcnt lgkmcnt(5)
 v_mfma_f32_32x32x16_bf16 v[48:63], a[212:215], v[36:39], v[48:63]
 ds_read_b128 v[28:31], v10 offset:60416
 s_waitcnt lgkmcnt(5)
 v_mfma_f32_32x32x16_bf16 v[48:63], a[216:219], v[40:43], v[48:63]
 ds_read_b128 v[32:35], v10 offset:61440
 s_waitcnt lgkmcnt(5)
 v_mfma_f32_32x32x16_bf16 v[48:63], a[220:223], v[44:47], v[48:63]
 ds_read_b128 v[36:39], v10 offset:62464
 s_waitcnt lgkmcnt(5)
 v_mfma_f32_32x32x16_bf16 v[48:63], a[224:227], v[16:19], v[48:63]
 ds_read_b128 v[40:43], v10 offset:63488
 s_waitcnt lgkmcnt(5)
 v_mfma_f32_32x32x16_bf16 v[48:63], a[228:231], v[20:23], v[48:63]
 ds_read_b128 v[44:47], v10 offset:64512
 s_waitcnt lgkmcnt(5)
 v_mfma_f32_32x32x16_bf16 v[48:63], a[232:235], v[24:27], v[48:63]
 s_waitcnt lgkmcnt(4)
 v_mfma_f32_32x32x16_bf16 v[48:63], a[236:239], v[28:31], v[48:63]
 s_waitcnt lgkmcnt(0)
 s_add_u32 s40, s40, 1
 s_cmp_eq_u32 s40, 64
 s_cselect_b32 s50, 1, s50
 s_cmp_eq_u32 s50, 1
 s_cbranch_scc1 L_rO_pre0
L_rO_o0:
 v_cmp_ge_u32 vcc, s40, v15
 s_and_b32 vcc_lo, vcc_lo, 0x3
 s_cbranch_scc0 L_rO_o0ok
 buffer_load_dword v15, v255, s[4:7], s47 offen sc1
 s_add_u32 s48, s48, 1
 s_cmp_gt_u32 s48, 400000
 s_cbranch_scc1 L_done
 s_waitcnt vmcnt(0)
 s_branch L_rO_o0
L_rO_o0ok:
 s_add_u32 m0, s45, 65536
 s_add_u32 s43, s44, 0
 buffer_load_dwordx4 v2, s[36:39], s43 offen offset:0 sc1 lds
 buffer_load_dwordx4 v2, s[36:39], s43 offen offset:1024 sc1 lds
 buffer_load_dwordx4 v2, s[36:39], s43 offen offset:2048 sc1 lds
 buffer_load_dwordx4 v2, s[36:39], s43 offen offset:3072 sc1 lds
 s_add_u32 m0, s45, 69632
 s_add_u32 s43, s44, 4096
 buffer_load_dwordx4 v2, s[36:39], s43 offen offset:0 sc1 lds
 buffer_load_dwordx4 v2, s[36:39], s43 offen offset:1024 sc1 lds
 buffer_load_dwordx4 v2, s[36:39], s43 offen offset:2048 sc1 lds
 buffer_load_dwordx4 v2, s[36:39], s43 offen offset:3072 sc1 lds
 s_add_u32 m0, s45, 73728
 s_add_u32 s43, s44, 8192
 buffer_load_dwordx4 v2, s[36:39], s43 offen offset:0 sc1 lds
 buffer_load_dwordx4 v2, s[36:39], s43 offen offset:1024 sc1 lds
 buffer_load_dwordx4 v2, s[36:39], s43 offen offset:2048 sc1 lds
 buffer_load_dwordx4 v2, s[36:39], s43 offen offset:3072 sc1 lds
 s_add_u32 m0, s45, 77824
 s_add_u32 s43, s44, 12288
 buffer_load_dwordx4 v2, s[36:39], s43 offen offset:0 sc1 lds
 buffer_load_dwordx4 v2, s[36:39], s43 offen offset:1024 sc1 lds
 buffer_load_dwordx4 v2, s[36:39], s43 offen offset:2048 sc1 lds
 buffer_load_dwordx4 v2, s[36:39], s43 offen offset:3072 sc1 lds
 s_add_u32 s47, s47, 2048
 buffer_load_dword v15, v255, s[4:7], s47 offen sc1
 s_waitcnt vmcnt(0)
L_rO_pre0:
 s_waitcnt vmcnt(5)
 s_barrier
 ds_read_b128 v[16:19], v11 offset:0
 ds_read_b128 v[20:23], v11 offset:1024
 v_mfma_f32_32x32x16_bf16 v[48:63], a[240:243], v[32:35], v[48:63]
 ds_read_b128 v[24:27], v11 offset:2048
 ds_read_b128 v[28:31], v11 offset:3072
 v_mfma_f32_32x32x16_bf16 v[48:63], a[244:247], v[36:39], v[48:63]
 ds_read_b128 v[32:35], v11 offset:4096
 ds_read_b128 v[36:39], v11 offset:5120
 v_mfma_f32_32x32x16_bf16 v[48:63], a[248:251], v[40:43], v[48:63]
 v_mfma_f32_32x32x16_bf16 v[48:63], a[252:255], v[44:47], v[48:63]
 s_waitcnt lgkmcnt(5)
 v_mfma_f32_32x32x16_bf16 v[64:79], a[0:3], v[16:19], 0
 ds_read_b128 v[40:43], v11 offset:6144
 s_add_u32 s44, s44, 0x40000
 s_add_u32 s42, s40, 1
 v_cmp_ge_u32 vcc, s42, v15
 s_waitcnt lgkmcnt(5)
 v_mfma_f32_32x32x16_bf16 v[64:79], a[4:7], v[20:23], v[64:79]
 ds_read_b128 v[44:47], v11 offset:7168
 s_and_b32 vcc_lo, vcc_lo, 0x3
 s_cselect_b32 s50, 0, 1
 s_cselect_b32 s51, 1073741824, s44
 s_waitcnt lgkmcnt(5)
 v_mfma_f32_32x32x16_bf16 v[64:79], a[8:11], v[24:27], v[64:79]
 ds_read_b128 v[16:19], v11 offset:8192
 s_add_u32 m0, s45, 0
 s_add_u32 s43, s51, 0
 buffer_load_dwordx4 v2, s[36:39], s43 offen offset:0 sc1 lds
 s_waitcnt lgkmcnt(5)
 v_mfma_f32_32x32x16_bf16 v[64:79], a[12:15], v[28:31], v[64:79]
 ds_read_b128 v[20:23], v11 offset:9216
 s_waitcnt lgkmcnt(5)
 v_mfma_f32_32x32x16_bf16 v[64:79], a[16:19], v[32:35], v[64:79]
 ds_read_b128 v[24:27], v11 offset:10240
 buffer_load_dwordx4 v2, s[36:39], s43 offen offset:1024 sc1 lds
 s_waitcnt lgkmcnt(5)
 v_mfma_f32_32x32x16_bf16 v[64:79], a[20:23], v[36:39], v[64:79]
 ds_read_b128 v[28:31], v11 offset:11264
 s_waitcnt lgkmcnt(5)
 v_mfma_f32_32x32x16_bf16 v[64:79], a[24:27], v[40:43], v[64:79]
 ds_read_b128 v[32:35], v11 offset:12288
 s_cmp_eq_u32 s29, 1
 s_cbranch_scc1 L_rO_sf4
 buffer_store_dwordx4 v[52:55], v2, s[4:7], s64 offen
L_rO_sb4:
 s_add_u32 s64, s64, 524288
 s_and_b32 s64, s64, 0x3fdfffff
 s_waitcnt lgkmcnt(5)
 v_mfma_f32_32x32x16_bf16 v[64:79], a[28:31], v[44:47], v[64:79]
 ds_read_b128 v[36:39], v11 offset:13312
 buffer_load_dwordx4 v2, s[36:39], s43 offen offset:2048 sc1 lds
 s_waitcnt lgkmcnt(5)
 v_mfma_f32_32x32x16_bf16 v[64:79], a[32:35], v[16:19], v[64:79]
 ds_read_b128 v[40:43], v11 offset:14336
 s_waitcnt lgkmcnt(5)
 v_mfma_f32_32x32x16_bf16 v[64:79], a[36:39], v[20:23], v[64:79]
 ds_read_b128 v[44:47], v11 offset:15360
 buffer_load_dwordx4 v2, s[36:39], s43 offen offset:3072 sc1 lds
 s_waitcnt lgkmcnt(5)
 v_mfma_f32_32x32x16_bf16 v[64:79], a[40:43], v[24:27], v[64:79]
 ds_read_b128 v[16:19], v11 offset:16384
 s_waitcnt lgkmcnt(5)
 v_mfma_f32_32x32x16_bf16 v[64:79], a[44:47], v[28:31], v[64:79]
 ds_read_b128 v[20:23], v11 offset:17408
 s_cmp_eq_u32 s29, 1
 s_cbranch_scc1 L_rO_sf5
 buffer_store_dwordx4 v[56:59], v2, s[4:7], s65 offen
L_rO_sb5:
 s_add_u32 s65, s65, 524288
 s_and_b32 s65, s65, 0x3fdfffff
 s_waitcnt lgkmcnt(5)
 v_mfma_f32_32x32x16_bf16 v[64:79], a[48:51], v[32:35], v[64:79]
 ds_read_b128 v[24:27], v11 offset:18432
 s_add_u32 m0, s45, 4096
 s_add_u32 s43, s51, 4096
 buffer_load_dwordx4 v2, s[36:39], s43 offen offset:0 sc1 lds
 s_waitcnt lgkmcnt(5)
 v_mfma_f32_32x32x16_bf16 v[64:79], a[52:55], v[36:39], v[64:79]
 ds_read_b128 v[28:31], v11 offset:19456
 s_waitcnt lgkmcnt(5)
 v_mfma_f32_32x32x16_bf16 v[64:79], a[56:59], v[40:43], v[64:79]
 ds_read_b128 v[32:35], v11 offset:20480
 buffer_load_dwordx4 v2, s[36:39], s43 offen offset:1024 sc1 lds
 s_waitcnt lgkmcnt(5)
 v_mfma_f32_32x32x16_bf16 v[64:79], a[60:63], v[44:47], v[64:79]
 ds_read_b128 v[36:39], v11 offset:21504
 s_waitcnt lgkmcnt(5)
 v_mfma_f32_32x32x16_bf16 v[64:79], a[64:67], v[16:19], v[64:79]
 ds_read_b128 v[40:43], v11 offset:22528
 s_cmp_eq_u32 s29, 1
 s_cbranch_scc1 L_rO_sf6
 buffer_store_dwordx4 v[60:63], v2, s[4:7], s66 offen
L_rO_sb6:
 s_add_u32 s66, s66, 524288
 s_and_b32 s66, s66, 0x3fdfffff
 s_waitcnt lgkmcnt(5)
 v_mfma_f32_32x32x16_bf16 v[64:79], a[68:71], v[20:23], v[64:79]
 ds_read_b128 v[44:47], v11 offset:23552
 buffer_load_dwordx4 v2, s[36:39], s43 offen offset:2048 sc1 lds
 s_waitcnt lgkmcnt(5)
 v_mfma_f32_32x32x16_bf16 v[64:79], a[72:75], v[24:27], v[64:79]
 ds_read_b128 v[16:19], v11 offset:24576
 s_waitcnt vmcnt(10)
 v_pk_add_f32 v[88:89], v[88:89], v[96:97]
 v_pk_add_f32 v[90:91], v[90:91], v[98:99]
 v_pk_add_f32 v[88:89], v[88:89], v[100:101]
 s_waitcnt lgkmcnt(5)
 v_mfma_f32_32x32x16_bf16 v[64:79], a[76:79], v[28:31], v[64:79]
 ds_read_b128 v[20:23], v11 offset:25600
 buffer_load_dwordx4 v2, s[36:39], s43 offen offset:3072 sc1 lds
 s_waitcnt lgkmcnt(5)
 v_mfma_f32_32x32x16_bf16 v[64:79], a[80:83], v[32:35], v[64:79]
 ds_read_b128 v[24:27], v11 offset:26624
 v_pk_add_f32 v[90:91], v[90:91], v[102:103]
 v_pk_add_f32 v[88:89], v[88:89], v[104:105]
 v_pk_add_f32 v[90:91], v[90:91], v[106:107]
 s_waitcnt lgkmcnt(5)
 v_mfma_f32_32x32x16_bf16 v[64:79], a[84:87], v[36:39], v[64:79]
 ds_read_b128 v[28:31], v11 offset:27648
 v_cvt_pk_bf16_f32 v80, v88, v89
 v_cvt_pk_bf16_f32 v81, v90, v91
 s_waitcnt lgkmcnt(5)
 v_mfma_f32_32x32x16_bf16 v[64:79], a[88:91], v[40:43], v[64:79]
 ds_read_b128 v[32:35], v11 offset:28672
 s_add_u32 m0, s45, 8192
 s_add_u32 s43, s51, 8192
 buffer_load_dwordx4 v2, s[36:39], s43 offen offset:0 sc1 lds
 s_waitcnt lgkmcnt(5)
 v_mfma_f32_32x32x16_bf16 v[64:79], a[92:95], v[44:47], v[64:79]
 ds_read_b128 v[36:39], v11 offset:29696
 buffer_store_dwordx2 v[80:81], v14, s[8:11], s54 offen
 s_add_u32 s54, s54, 131072
 s_bitset0_b32 s54, 30
 s_waitcnt lgkmcnt(5)
 v_mfma_f32_32x32x16_bf16 v[64:79], a[96:99], v[16:19], v[64:79]
 ds_read_b128 v[40:43], v11 offset:30720
 buffer_load_dwordx4 v2, s[36:39], s43 offen offset:1024 sc1 lds
 s_waitcnt lgkmcnt(5)
 v_mfma_f32_32x32x16_bf16 v[64:79], a[100:103], v[20:23], v[64:79]
 ds_read_b128 v[44:47], v11 offset:31744
 v_mov_b32 v88, v48
 v_mov_b32 v89, v49
 v_mov_b32 v90, v50
 v_mov_b32 v91, v51
 s_waitcnt lgkmcnt(5)
 v_mfma_f32_32x32x16_bf16 v[64:79], a[104:107], v[24:27], v[64:79]
 ds_read_b128 v[16:19], v11 offset:32768
 s_load_dwordx4 s[60:63], s[4:5], s49 glc
 s_waitcnt lgkmcnt(5)
 v_mfma_f32_32x32x16_bf16 v[64:79], a[108:111], v[28:31], v[64:79]
 ds_read_b128 v[20:23], v11 offset:33792
 buffer_load_dwordx4 v2, s[36:39], s43 offen offset:2048 sc1 lds
 s_waitcnt lgkmcnt(5)
 v_mfma_f32_32x32x16_bf16 v[64:79], a[112:115], v[32:35], v[64:79]
 ds_read_b128 v[24:27], v11 offset:34816
 s_waitcnt lgkmcnt(5)
 v_mfma_f32_32x32x16_bf16 v[64:79], a[116:119], v[36:39], v[64:79]
 ds_read_b128 v[28:31], v11 offset:35840
 buffer_load_dwordx4 v2, s[36:39], s43 offen offset:3072 sc1 lds
 s_waitcnt lgkmcnt(5)
 v_mfma_f32_32x32x16_bf16 v[64:79], a[120:123], v[40:43], v[64:79]
 ds_read_b128 v[32:35], v11 offset:36864
 s_waitcnt lgkmcnt(5)
 v_mfma_f32_32x32x16_bf16 v[64:79], a[124:127], v[44:47], v[64:79]
 ds_read_b128 v[36:39], v11 offset:37888
 s_waitcnt lgkmcnt(5)
 v_mfma_f32_32x32x16_bf16 v[64:79], a[128:131], v[16:19], v[64:79]
 ds_read_b128 v[40:43], v11 offset:38912
 s_add_u32 m0, s45, 12288
 s_add_u32 s43, s51, 12288
 buffer_load_dwordx4 v2, s[36:39], s43 offen offset:0 sc1 lds
 s_waitcnt lgkmcnt(5)
 v_mfma_f32_32x32x16_bf16 v[64:79], a[132:135], v[20:23], v[64:79]
 ds_read_b128 v[44:47], v11 offset:39936
 s_waitcnt lgkmcnt(5)
 v_mfma_f32_32x32x16_bf16 v[64:79], a[136:139], v[24:27], v[64:79]
 ds_read_b128 v[16:19], v11 offset:40960
 buffer_load_dwordx4 v2, s[36:39], s43 offen offset:1024 sc1 lds
 s_waitcnt lgkmcnt(5)
 v_mfma_f32_32x32x16_bf16 v[64:79], a[140:143], v[28:31], v[64:79]
 ds_read_b128 v[20:23], v11 offset:41984
 s_waitcnt lgkmcnt(5)
 v_mfma_f32_32x32x16_bf16 v[64:79], a[144:147], v[32:35], v[64:79]
 ds_read_b128 v[24:27], v11 offset:43008
 s_waitcnt lgkmcnt(5)
 v_mfma_f32_32x32x16_bf16 v[64:79], a[148:151], v[36:39], v[64:79]
 ds_read_b128 v[28:31], v11 offset:44032
 buffer_load_dwordx4 v2, s[36:39], s43 offen offset:2048 sc1 lds
 s_waitcnt lgkmcnt(5)
 v_mfma_f32_32x32x16_bf16 v[64:79], a[152:155], v[40:43], v[64:79]
 ds_read_b128 v[32:35], v11 offset:45056
 s_waitcnt lgkmcnt(5)
 v_mfma_f32_32x32x16_bf16 v[64:79], a[156:159], v[44:47], v[64:79]
 ds_read_b128 v[36:39], v11 offset:46080
 buffer_load_dwordx4 v2, s[36:39], s43 offen offset:3072 sc1 lds
 s_waitcnt lgkmcnt(5)
 v_mfma_f32_32x32x16_bf16 v[64:79], a[160:163], v[16:19], v[64:79]
 ds_read_b128 v[40:43], v11 offset:47104
 s_lshl_b32 s41, s50, 11
 s_add_u32 s47, s47, s41
 buffer_load_dword v15, v255, s[4:7], s47 offen sc1
 s_waitcnt lgkmcnt(5)
 v_mfma_f32_32x32x16_bf16 v[64:79], a[164:167], v[20:23], v[64:79]
 ds_read_b128 v[44:47], v11 offset:48128
 s_waitcnt lgkmcnt(5)
 v_mfma_f32_32x32x16_bf16 v[64:79], a[168:171], v[24:27], v[64:79]
 ds_read_b128 v[16:19], v11 offset:49152
 s_add_u32 s41, s40, 2
 v_mov_b32 v9, s41
 s_waitcnt vmcnt(12)
 buffer_store_dword v9, v8, s[4:7], 0 offen sc1
 s_waitcnt lgkmcnt(5)
 v_mfma_f32_32x32x16_bf16 v[64:79], a[172:175], v[28:31], v[64:79]
 ds_read_b128 v[20:23], v11 offset:50176
 s_waitcnt lgkmcnt(5)
 v_mfma_f32_32x32x16_bf16 v[64:79], a[176:179], v[32:35], v[64:79]
 ds_read_b128 v[24:27], v11 offset:51200
 s_waitcnt lgkmcnt(5)
 v_mfma_f32_32x32x16_bf16 v[64:79], a[180:183], v[36:39], v[64:79]
 ds_read_b128 v[28:31], v11 offset:52224
 s_waitcnt lgkmcnt(5)
 v_mfma_f32_32x32x16_bf16 v[64:79], a[184:187], v[40:43], v[64:79]
 ds_read_b128 v[32:35], v11 offset:53248
 s_waitcnt lgkmcnt(5)
 v_mfma_f32_32x32x16_bf16 v[64:79], a[188:191], v[44:47], v[64:79]
 ds_read_b128 v[36:39], v11 offset:54272
 s_waitcnt lgkmcnt(5)
 v_mfma_f32_32x32x16_bf16 v[64:79], a[192:195], v[16:19], v[64:79]
 ds_read_b128 v[40:43], v11 offset:55296
 s_waitcnt lgkmcnt(5)
 v_mfma_f32_32x32x16_bf16 v[64:79], a[196:199], v[20:23], v[64:79]
 ds_read_b128 v[44:47], v11 offset:56320
 s_waitcnt lgkmcnt(5)
 v_mfma_f32_32x32x16_bf16 v[64:79], a[200:203], v[24:27], v[64:79]
 ds_read_b128 v[16:19], v11 offset:57344
 s_sub_u32 s52, s40, 0
L_rO_p1:
 s_min_u32 s41, s60, s61
 s_min_u32 s41, s41, s62
 s_min_u32 s41, s41, s63
 s_cmp_gt_u32 s41, s52
 s_cbranch_scc1 L_rO_p1ok
 s_load_dwordx4 s[60:63], s[4:5], s49 glc
 s_add_u32 s48, s48, 1
 s_cmp_gt_u32 s48, 400000
 s_cbranch_scc1 L_done
 s_waitcnt lgkmcnt(0)
 s_branch L_rO_p1
L_rO_p1ok:
 buffer_load_dwordx4 v[96:99], v2, s[4:7], s53 offen offset:1024 sc1
 buffer_load_dwordx4 v[100:103], v2, s[4:7], s53 offen offset:2048 sc1
 buffer_load_dwordx4 v[104:107], v2, s[4:7], s53 offen offset:3072 sc1
 s_add_u32 s53, s53, 524288
 s_bitcmp1_b32 s53, 21
 s_cselect_b32 s41, 0x3fdfffff, -1
 s_and_b32 s53, s53, s41
 s_waitcnt lgkmcnt(5)
 v_mfma_f32_32x32x16_bf16 v[64:79], a[204:207], v[28:31], v[64:79]
 ds_read_b128 v[20:23], v11 offset:58368
 s_waitcnt lgkmcnt(5)
 v_mfma_f32_32x32x16_bf16 v[64:79], a[208:211], v[32:35], v[64:79]
 ds_read_b128 v[24:27], v11 offset:59392
 s_waitcnt lgkmcnt(5)
 v_mfma_f32_32x32x16_bf16 v[64:79], a[212:215], v[36:39], v[64:79]
 ds_read_b128 v[28:31], v11 offset:60416
 s_waitcnt lgkmcnt(5)
 v_mfma_f32_32x32x16_bf16 v[64:79], a[216:219], v[40:43], v[64:79]
 ds_read_b128 v[32:35], v11 offset:61440
 s_waitcnt lgkmcnt(5)
 v_mfma_f32_32x32x16_bf16 v[64:79], a[220:223], v[44:47], v[64:79]
 ds_read_b128 v[36:39], v11 offset:62464
 s_waitcnt lgkmcnt(5)
 v_mfma_f32_32x32x16_bf16 v[64:79], a[224:227], v[16:19], v[64:79]
 ds_read_b128 v[40:43], v11 offset:63488
 s_waitcnt lgkmcnt(5)
 v_mfma_f32_32x32x16_bf16 v[64:79], a[228:231], v[20:23], v[64:79]
 ds_read_b128 v[44:47], v11 offset:64512
 s_waitcnt lgkmcnt(5)
 v_mfma_f32_32x32x16_bf16 v[64:79], a[232:235], v[24:27], v[64:79]
 s_waitcnt lgkmcnt(4)
 v_mfma_f32_32x32x16_bf16 v[64:79], a[236:239], v[28:31], v[64:79]
 s_waitcnt lgkmcnt(0)
 s_add_u32 s40, s40, 1
 s_cmp_eq_u32 s40, 64
 s_cselect_b32 s50, 1, s50
 s_cmp_eq_u32 s50, 1
 s_cbranch_scc1 L_rO_pre1
L_rO_o1:
 v_cmp_ge_u32 vcc, s40, v15
 s_and_b32 vcc_lo, vcc_lo, 0x3
 s_cbranch_scc0 L_rO_o1ok
 buffer_load_dword v15, v255, s[4:7], s47 offen sc1
 s_add_u32 s48, s48, 1
 s_cmp_gt_u32 s48, 400000
 s_cbranch_scc1 L_done
 s_waitcnt vmcnt(0)
 s_branch L_rO_o1
L_rO_o1ok:
 s_add_u32 m0, s45, 0
 s_add_u32 s43, s44, 0
 buffer_load_dwordx4 v2, s[36:39], s43 offen offset:0 sc1 lds
 buffer_load_dwordx4 v2, s[36:39], s43 offen offset:1024 sc1 lds
 buffer_load_dwordx4 v2, s[36:39], s43 offen offset:2048 sc1 lds
 buffer_load_dwordx4 v2, s[36:39], s43 offen offset:3072 sc1 lds
 s_add_u32 m0, s45, 4096
 s_add_u32 s43, s44, 4096
 buffer_load_dwordx4 v2, s[36:39], s43 offen offset:0 sc1 lds
 buffer_load_dwordx4 v2, s[36:39], s43 offen offset:1024 sc1 lds
 buffer_load_dwordx4 v2, s[36:39], s43 offen offset:2048 sc1 lds
 buffer_load_dwordx4 v2, s[36:39], s43 offen offset:3072 sc1 lds
 s_add_u32 m0, s45, 8192
 s_add_u32 s43, s44, 8192
 buffer_load_dwordx4 v2, s[36:39], s43 offen offset:0 sc1 lds
 buffer_load_dwordx4 v2, s[36:39], s43 offen offset:1024 sc1 lds
 buffer_load_dwordx4 v2, s[36:39], s43 offen offset:2048 sc1 lds
 buffer_load_dwordx4 v2, s[36:39], s43 offen offset:3072 sc1 lds
 s_add_u32 m0, s45, 12288
 s_add_u32 s43, s44, 12288
 buffer_load_dwordx4 v2, s[36:39], s43 offen offset:0 sc1 lds
 buffer_load_dwordx4 v2, s[36:39], s43 offen offset:1024 sc1 lds
 buffer_load_dwordx4 v2, s[36:39], s43 offen offset:2048 sc1 lds
 buffer_load_dwordx4 v2, s[36:39], s43 offen offset:3072 sc1 lds
 s_add_u32 s47, s47, 2048
 buffer_load_dword v15, v255, s[4:7], s47 offen sc1
 s_waitcnt vmcnt(0)
L_rO_pre1:
 s_waitcnt vmcnt(5)
 s_barrier
 ds_read_b128 v[16:19], v10 offset:0
 ds_read_b128 v[20:23], v10 offset:1024
 v_mfma_f32_32x32x16_bf16 v[64:79], a[240:243], v[32:35], v[64:79]
 ds_read_b128 v[24:27], v10 offset:2048
 ds_read_b128 v[28:31], v10 offset:3072
 v_mfma_f32_32x32x16_bf16 v[64:79], a[244:247], v[36:39], v[64:79]
 ds_read_b128 v[32:35], v10 offset:4096
 ds_read_b128 v[36:39], v10 offset:5120
 v_mfma_f32_32x32x16_bf16 v[64:79], a[248:251], v[40:43], v[64:79]
 v_mfma_f32_32x32x16_bf16 v[64:79], a[252:255], v[44:47], v[64:79]
 s_cmp_lt_u32 s40, 64
 s_cbranch_scc1 L_rO_loop
 s_nop 9
 s_cmp_eq_u32 s29, 1
 s_cbranch_scc1 L_rO_sf7
 buffer_store_dwordx4 v[68:71], v2, s[4:7], s64 offen
L_rO_sb7:
 s_add_u32 s64, s64, 524288
 s_and_b32 s64, s64, 0x3fdfffff
 s_cmp_eq_u32 s29, 1
 s_cbranch_scc1 L_rO_sf8
 buffer_store_dwordx4 v[72:75], v2, s[4:7], s65 offen
L_rO_sb8:
 s_add_u32 s65, s65, 524288
 s_and_b32 s65, s65, 0x3fdfffff
 s_cmp_eq_u32 s29, 1
 s_cbranch_scc1 L_rO_sf9
 buffer_store_dwordx4 v[76:79], v2, s[4:7], s66 offen
L_rO_sb9:
 s_add_u32 s66, s66, 524288
 s_and_b32 s66, s66, 0x3fdfffff
 s_waitcnt vmcnt(3)
 v_pk_add_f32 v[92:93], v[92:93], v[96:97]
 v_pk_add_f32 v[94:95], v[94:95], v[98:99]
 v_pk_add_f32 v[92:93], v[92:93], v[100:101]
 v_pk_add_f32 v[94:95], v[94:95], v[102:103]
 v_pk_add_f32 v[92:93], v[92:93], v[104:105]
 v_pk_add_f32 v[94:95], v[94:95], v[106:107]
 v_cvt_pk_bf16_f32 v80, v92, v93
 v_cvt_pk_bf16_f32 v81, v94, v95
 buffer_store_dwordx2 v[80:81], v14, s[8:11], s54 offen
 s_add_u32 s54, s54, 131072
 s_bitset0_b32 s54, 30
 v_mov_b32 v92, v64
 v_mov_b32 v93, v65
 v_mov_b32 v94, v66
 v_mov_b32 v95, v67
 s_waitcnt lgkmcnt(0)
 s_sub_u32 s52, s40, 0
L_rO_t2:
 s_min_u32 s41, s60, s61
 s_min_u32 s41, s41, s62
 s_min_u32 s41, s41, s63
 s_cmp_gt_u32 s41, s52
 s_cbranch_scc1 L_rO_t2ok
 s_load_dwordx4 s[60:63], s[4:5], s49 glc
 s_add_u32 s48, s48, 1
 s_cmp_gt_u32 s48, 400000
 s_cbranch_scc1 L_done
 s_waitcnt lgkmcnt(0)
 s_branch L_rO_t2
L_rO_t2ok:
 buffer_load_dwordx4 v[96:99], v2, s[4:7], s53 offen offset:1024 sc1
 buffer_load_dwordx4 v[100:103], v2, s[4:7], s53 offen offset:2048 sc1
 buffer_load_dwordx4 v[104:107], v2, s[4:7], s53 offen offset:3072 sc1
 s_add_u32 s53, s53, 524288
 s_bitcmp1_b32 s53, 21
 s_cselect_b32 s41, 0x3fdfffff, -1
 s_and_b32 s53, s53, s41
 v_mov_b32 v9, 66
 s_waitcnt vmcnt(4)
 buffer_store_dword v9, v8, s[4:7], 0 offen sc1
 s_waitcnt vmcnt(1)
 v_pk_add_f32 v[88:89], v[88:89], v[96:97]
 v_pk_add_f32 v[90:91], v[90:91], v[98:99]
 v_pk_add_f32 v[88:89], v[88:89], v[100:101]
 v_pk_add_f32 v[90:91], v[90:91], v[102:103]
 v_pk_add_f32 v[88:89], v[88:89], v[104:105]
 v_pk_add_f32 v[90:91], v[90:91], v[106:107]
 v_cvt_pk_bf16_f32 v80, v88, v89
 v_cvt_pk_bf16_f32 v81, v90, v91
 buffer_store_dwordx2 v[80:81], v14, s[8:11], s54 offen
 s_add_u32 s54, s54, 131072
 s_bitset0_b32 s54, 30
 s_add_u32 s40, s40, 1
 s_sub_u32 s52, s40, 0
L_rO_t1:
 s_min_u32 s41, s60, s61
 s_min_u32 s41, s41, s62
 s_min_u32 s41, s41, s63
 s_cmp_gt_u32 s41, s52
 s_cbranch_scc1 L_rO_t1ok
 s_load_dwordx4 s[60:63], s[4:5], s49 glc
 s_add_u32 s48, s48, 1
 s_cmp_gt_u32 s48, 400000
 s_cbranch_scc1 L_done
 s_waitcnt lgkmcnt(0)
 s_branch L_rO_t1
L_rO_t1ok:
 buffer_load_dwordx4 v[96:99], v2, s[4:7], s53 offen offset:1024 sc1
 buffer_load_dwordx4 v[100:103], v2, s[4:7], s53 offen offset:2048 sc1
 buffer_load_dwordx4 v[104:107], v2, s[4:7], s53 offen offset:3072 sc1
 s_add_u32 s53, s53, 524288
 s_bitcmp1_b32 s53, 21
 s_cselect_b32 s41, 0x3fdfffff, -1
 s_and_b32 s53, s53, s41
 s_waitcnt vmcnt(0)
 v_pk_add_f32 v[92:93], v[92:93], v[96:97]
 v_pk_add_f32 v[94:95], v[94:95], v[98:99]
 v_pk_add_f32 v[92:93], v[92:93], v[100:101]
 v_pk_add_f32 v[94:95], v[94:95], v[102:103]
 v_pk_add_f32 v[92:93], v[92:93], v[104:105]
 v_pk_add_f32 v[94:95], v[94:95], v[106:107]
 v_cvt_pk_bf16_f32 v80, v92, v93
 v_cvt_pk_bf16_f32 v81, v94, v95
 buffer_store_dwordx2 v[80:81], v14, s[8:11], s54 offen
 s_add_u32 s54, s54, 131072
 s_bitset0_b32 s54, 30
 s_waitcnt vmcnt(0) lgkmcnt(0)
 s_barrier
 s_branch L_done
L_rO_sf1:
 buffer_store_dwordx4 v[68:71], v2, s[4:7], s64 offen sc1
 s_branch L_rO_sb1
L_rO_sf2:
 buffer_store_dwordx4 v[72:75], v2, s[4:7], s65 offen sc1
 s_branch L_rO_sb2
L_rO_sf3:
 buffer_store_dwordx4 v[76:79], v2, s[4:7], s66 offen sc1
 s_branch L_rO_sb3
L_rO_sf4:
 buffer_store_dwordx4 v[52:55], v2, s[4:7], s64 offen sc1
 s_branch L_rO_sb4
L_rO_sf5:
 buffer_store_dwordx4 v[56:59], v2, s[4:7], s65 offen sc1
 s_branch L_rO_sb5
L_rO_sf6:
 buffer_store_dwordx4 v[60:63], v2, s[4:7], s66 offen sc1
 s_branch L_rO_sb6
L_rO_sf7:
 buffer_store_dwordx4 v[68:71], v2, s[4:7], s64 offen sc1
 s_branch L_rO_sb7
L_rO_sf8:
 buffer_store_dwordx4 v[72:75], v2, s[4:7], s65 offen sc1
 s_branch L_rO_sb8
L_rO_sf9:
 buffer_store_dwordx4 v[76:79], v2, s[4:7], s66 offen sc1
 s_branch L_rO_sb9
L_role_G:
 s_mov_b32 s10, 8388608
 s_mov_b32 s11, 0x20000
 v_and_b32 v1, 63, v0
 v_lshrrev_b32 v32, 2, v1
 v_and_b32 v33, 3, v1
 v_lshlrev_b32 v33, 4, v33
 v_lshl_add_u32 v39, v32, 13, v33
 v_lshl_add_u32 v40, v32, 11, v33
 s_lshl_b32 s55, s24, 5
 s_add_u32 s55, s55, s25
 s_lshl_b32 s55, s55, 6
 s_lshl_b32 s56, s26, 21
 s_add_u32 s42, s55, s56
 s_lshl_b32 s55, s24, 21
 s_lshl_b32 s56, s25, 6
 s_add_u32 s55, s55, s56
 s_lshl_b32 s56, s26, 19
 s_add_u32 s44, s55, s56
 s_lshl_b32 s46, s26, 13
 s_and_b32 s55, s25, 1
 s_mul_i32 s55, s55, 2
 s_lshl_b32 s56, s55, 17
 s_sub_u32 s43, s42, s56
 s_add_u32 s42, s42, s56
 s_lshl_b32 s56, s55, 15
 s_sub_u32 s45, s44, s56
 s_add_u32 s44, s44, s56
 s_lshl_b32 s56, s55, 10
 s_sub_u32 s47, s46, s56
 s_add_u32 s46, s46, s56
 s_mov_b64 s[8:9], s[16:17]
 s_add_u32 m0, s46, 0
 s_add_u32 s55, s42, 0
 buffer_load_dwordx4 v39, s[8:11], s55 offen  lds
 s_add_u32 m0, s46, 1024
 s_add_u32 s55, s42, 131072
 buffer_load_dwordx4 v39, s[8:11], s55 offen  lds
 s_add_u32 m0, s47, 2048
 s_add_u32 s55, s43, 262144
 buffer_load_dwordx4 v39, s[8:11], s55 offen  lds
 s_add_u32 m0, s47, 3072
 s_add_u32 s55, s43, 393216
 buffer_load_dwordx4 v39, s[8:11], s55 offen  lds
 s_add_u32 m0, s46, 4096
 s_add_u32 s55, s42, 524288
 buffer_load_dwordx4 v39, s[8:11], s55 offen  lds
 s_add_u32 m0, s46, 5120
 s_add_u32 s55, s42, 655360
 buffer_load_dwordx4 v39, s[8:11], s55 offen  lds
 s_add_u32 m0, s47, 6144
 s_add_u32 s55, s43, 786432
 buffer_load_dwordx4 v39, s[8:11], s55 offen  lds
 s_add_u32 m0, s47, 7168
 s_add_u32 s55, s43, 917504
 buffer_load_dwordx4 v39, s[8:11], s55 offen  lds
 v_and_b32 v1, 63, v0
 v_lshlrev_b32 v2, 4, v1
 v_lshlrev_b32 v3, 3, v1
 v_lshlrev_b32 v4, 2, v1
 v_mov_b32 v50, -1
 v_mov_b32 v51, -1
 v_mov_b32 v52, -1
 v_mov_b32 v53, -1
 v_bfrev_b32 v31, 1
 v_mov_b32 v37, 0
 v_mov_b32 v30, 0
 v_bfe_u32 v32, v1, 1, 1
 v_mul_u32_u24 v32, 0xaaaa, v32
 v_add_u32 v5, 0x4444, v32
 s_lshl_b32 s55, s26, 12
 v_add_u32 v6, s55, v2
 v_and_b32 v34, 15, v1
 v_lshrrev_b32 v35, 4, v1
 s_mul_i32 s55, s26, 2304
 s_add_u32 s55, s55, 4096
 v_mul_u32_u24 v32, 288, v35
 v_lshl_add_u32 v32, v34, 2, v32
 v_add_u32 v7, s55, v32
 v_add_u32 v8, 1152, v7
 v_mul_u32_u24 v32, 144, v34
 v_lshl_add_u32 v9, v35, 5, v32
 s_lshl_b32 s55, s26, 10
 v_add_u32 v10, s55, v2
 v_mov_b32 v32, 0x3e0293ee
 v_cmp_gt_u32 vcc, 8, v34
 s_nop 1
 v_cndmask_b32 v54, 1.0, v32, vcc
 s_mul_i32 s55, s25, 1280
 v_add_u32 v22, s55, v2
 v_cmp_gt_u32 vcc, 8, v34
 s_nop 1
 v_cndmask_b32 v11, v31, v22, vcc
 v_cmp_gt_u32 vcc, 16, v1
 s_nop 1
 v_cndmask_b32 v23, v31, v22, vcc
 v_lshlrev_b32 v32, 5, v34
 v_lshl_add_u32 v32, v35, 4, v32
 s_add_u32 s56, s55, 768
 v_add_u32 v32, s56, v32
 v_cmp_le_u32 vcc, 8, v34
 s_nop 1
 v_cndmask_b32 v32, v31, v32, vcc
 v_cmp_gt_u32 vcc, 2, v35
 s_nop 1
 v_cndmask_b32 v12, v31, v32, vcc
 s_xor_b32 s55, s25, 1
 s_mul_i32 s55, s55, 1280
 v_add_u32 v47, s55, v2
 s_xor_b32 s55, s25, 2
 s_mul_i32 s55, s55, 1280
 v_add_u32 v48, s55, v2
 s_xor_b32 s55, s25, 3
 s_mul_i32 s55, s55, 1280
 v_add_u32 v49, s55, v2
 s_and_b32 s55, s25, 28
 s_mul_i32 s55, s55, 1280
 s_add_u32 s55, s55, 1024
 v_add_u32 v13, s55, v4
 s_lshl_b32 s55, s25, 9
 v_lshlrev_b32 v32, 4, v34
 v_lshl_add_u32 v32, v35, 7, v32
 v_add_u32 v32, s55, v32
 v_cmp_gt_u32 vcc, 8, v34
 s_nop 1
 v_cndmask_b32 v14, v31, v32, vcc
 v_lshrrev_b32 v32, 2, v34
 v_and_b32 v36, 1, v34
 v_lshl_add_u32 v32, v32, 1, v36
 v_bfe_u32 v36, v34, 1, 1
 v_lshl_add_u32 v32, v36, 3, v32
 v_lshl_add_u32 v32, v35, 4, v32
 v_lshlrev_b32 v20, 4, v32
 v_add_u32 v32, s55, v2
 v_cmp_gt_u32 vcc, 32, v1
 s_nop 1
 v_cndmask_b32 v21, v31, v32, vcc
 v_lshrrev_b32 v32, 5, v1
 v_lshlrev_b32 v32, 8, v32
 v_bfe_u32 v36, v1, 1, 3
 v_lshl_add_u32 v32, v36, 5, v32
 v_bfe_u32 v36, v1, 4, 1
 v_lshl_add_u32 v32, v36, 4, v32
 v_and_b32 v36, 1, v1
 v_lshl_add_u32 v32, v36, 3, v32
 v_add_u32 v16, s55, v32
 s_lshr_b32 s55, s25, 1
 s_lshl_b32 s55, s55, 14
 s_and_b32 s56, s25, 1
 s_lshl_b32 s56, s56, 12
 s_add_u32 s55, s55, s56
 v_mov_b32 v29, v31
 s_add_u32 s56, s24, 1
 s_and_b32 s56, s56, 3
 s_lshl_b32 s56, s56, 10
 s_add_u32 s56, s56, s55
 v_add_u32 v44, s56, v2
 s_add_u32 s56, s56, 0
 v_writelane_b32 v29, s56, 0
 s_mov_b32 s70, s56
 s_add_u32 s56, s24, 2
 s_and_b32 s56, s56, 3
 s_lshl_b32 s56, s56, 10
 s_add_u32 s56, s56, s55
 v_add_u32 v45, s56, v2
 s_add_u32 s56, s56, 4
 v_writelane_b32 v29, s56, 1
 s_mov_b32 s71, s56
 s_add_u32 s56, s24, 3
 s_and_b32 s56, s56, 3
 s_lshl_b32 s56, s56, 10
 s_add_u32 s56, s56, s55
 v_add_u32 v46, s56, v2
 s_add_u32 s56, s56, 8
 v_writelane_b32 v29, s56, 2
 s_mov_b32 s72, s56
 s_lshl_b32 s56, s24, 10
 s_add_u32 s55, s55, s56
 v_add_u32 v24, s55, v2
 s_mov_b32 s69, s55
 s_and_b32 s56, s26, 1
 s_lshl_b32 s56, s56, 9
 s_add_u32 s55, s55, s56
 v_add_u32 v15, s55, v4
 v_lshrrev_b32 v32, 2, v34
 v_and_b32 v36, 3, v34
 v_lshl_add_u32 v32, v32, 3, v36
 v_lshlrev_b32 v32, 4, v32
 v_lshl_add_u32 v17, v35, 9, v32
 v_lshlrev_b32 v32, 4, v34
 v_lshl_add_u32 v18, v35, 9, v32
 v_lshl_add_u32 v32, v35, 7, v32
 v_subrev_u32 v32, 128, v32
 v_cmp_le_u32 vcc, 8, v34
 s_nop 1
 v_cndmask_b32 v19, v31, v32, vcc
 s_lshl_b32 s55, s24, 3
 s_lshr_b32 s56, s25, 2
 s_add_u32 s55, s55, s56
 s_lshl_b32 s55, s55, 7
 s_and_b32 s56, s25, 3
 s_lshl_b32 s56, s56, 2
 s_add_u32 s55, s55, s56
 s_add_u32 s73, s55, 3735552
 s_add_u32 s74, s55, 3735568
 s_add_u32 s55, s55, 3739648
 v_mov_b32 v32, s55
 v_cmp_eq_u32 vcc, 0, v1
 s_nop 1
 v_cndmask_b32 v42, v31, v32, vcc
 s_lshr_b32 s55, s25, 3
 s_lshl_b32 s56, s25, 2
 v_lshl_add_u32 v32, v1, 8, s56
 v_cmp_gt_u32 vcc, 4, v1
 s_nop 1
 v_cndmask_b32 v25, v31, v32, vcc
 v_cmp_ne_u32 vcc, s55, v1
 s_nop 1
 v_cndmask_b32 v25, v31, v25, vcc
 v_lshrrev_b32 v36, 3, v1
 s_and_b32 s56, s56, 28
 s_sub_u32 s56, s56, 3072
 v_lshl_add_u32 v32, v1, 7, s56
 s_add_u32 s56, s55, 4
 v_cmp_eq_u32 vcc, s56, v36
 s_nop 1
 v_cndmask_b32 v25, v25, v32, vcc
 s_add_u32 s56, s25, 32
 v_cmp_ne_u32 vcc, s56, v1
 s_nop 1
 v_cndmask_b32 v25, v31, v25, vcc
 s_lshl_b32 s56, s55, 8
 v_add_u32 v26, s56, v4
 s_lshl_b32 s56, s25, 7
 s_add_u32 s56, s56, 1024
 v_and_b32 v32, 28, v4
 v_add_u32 v32, s56, v32
 v_cmp_eq_u32 vcc, s55, v36
 s_nop 1
 v_cndmask_b32 v26, v26, v32, vcc
 s_lshl_b32 s67, 1, s25
 s_not_b32 s67, s67
 s_lshr_b32 s55, s25, 2
 s_lshl_b32 s55, s55, 8
 s_add_u32 s55, s55, 6144
 v_add_u32 v28, s55, v4
 s_and_b32 s56, s25, 3
 v_cmp_eq_u32 vcc, s56, v1
 s_nop 1
 v_cndmask_b32 v27, v31, v28, vcc
 s_mov_b32 s62, 0x42200000
 s_lshl_b32 s63, s24, 16
 s_lshl_b32 s64, s24, 18
 s_add_u32 s64, s64, 2621440
 s_add_u32 s63, s63, 2097152
 s_lshl_b32 s65, s24, 14
 s_add_u32 s65, s65, 3670016
 s_add_u32 s66, s65, 8192
 s_lshl_b32 s55, s26, 14
 s_add_u32 s49, s63, s55
 s_add_u32 s50, s49, 262144
 s_lshl_b32 s55, s26, 16
 s_add_u32 s51, s64, s55
 s_lshl_b32 s52, s26, 18
 s_add_u32 s52, s52, 134217728
 s_add_u32 s61, s52, 8192
 s_mov_b32 s68, 150732800
 s_mov_b32 s59, 150740992
 s_load_dwordx2 s[36:37], s[0:1], 8
 v_lshrrev_b32 v36, 2, v34
 v_lshlrev_b32 v36, 1, v36
 v_and_b32 v32, 1, v34
 v_add_u32 v36, v36, v32
 v_lshlrev_b32 v36, 11, v36
 v_lshl_add_u32 v36, v35, 5, v36
 v_bfe_u32 v32, v34, 1, 1
 v_lshl_add_u32 v36, v32, 4, v36
 s_lshl_b32 s55, s25, 6
 s_mov_b32 s38, 16384
 s_mov_b32 s39, 0x20000
 buffer_store_dwordx4 v[50:53], v21, s[4:7], s49 offen sc1
 buffer_store_dwordx4 v[50:53], v21, s[4:7], s50 offen sc1
 buffer_store_dwordx4 v[50:53], v22, s[4:7], s51 offen sc1
 buffer_store_dwordx4 v[50:53], v23, s[4:7], s51 offen offset:1024 sc1
 buffer_store_dwordx4 v[50:53], v24, s[4:7], s52 offen sc1
 buffer_store_dwordx4 v[50:53], v24, s[4:7], s61 offen sc1
 buffer_store_dword v37, v29, s[4:7], s59 offen sc1
 buffer_store_dword v37, v25, s[4:7], s65 offen sc1
 buffer_store_dword v37, v27, s[4:7], s65 offen sc1
 buffer_store_dword v37, v25, s[4:7], s66 offen sc1
 buffer_store_dword v37, v29, s[4:7], s68 offen sc1
 buffer_store_dword v37, v42, s[4:7], 0 offen sc1
 s_waitcnt lgkmcnt(0)
 buffer_load_dwordx4 v[232:235], v36, s[36:39], s55 offen
 v_bfe_u32 v41, v1, 2, 1
 v_bfe_u32 v32, v1, 3, 1
 v_lshl_add_u32 v41, v32, 3, v41
 v_bfe_u32 v32, v1, 4, 1
 v_lshl_add_u32 v41, v32, 2, v41
 v_bfe_u32 v32, v1, 5, 1
 v_lshl_add_u32 v41, v32, 4, v41
 v_lshlrev_b32 v41, 6, v41
 v_and_b32 v32, 3, v1
 v_lshl_add_u32 v41, v32, 3, v41
 v_bfe_u32 v38, v1, 2, 1
 v_bfe_u32 v32, v1, 3, 1
 v_lshl_add_u32 v38, v32, 2, v38
 v_bfe_u32 v32, v1, 4, 1
 v_lshl_add_u32 v38, v32, 4, v38
 v_bfe_u32 v32, v1, 5, 1
 v_lshl_add_u32 v38, v32, 3, v38
 v_lshlrev_b32 v38, 6, v38
 v_and_b32 v32, 3, v1
 v_lshl_add_u32 v38, v32, 3, v38
 s_lshl_b32 s56, s26, 13
 v_add_u32 v41, s56, v41
 s_and_b32 s56, s26, 1
 s_lshl_b32 s56, s56, 5
 v_add_u32 v38, s56, v38
 s_add_u32 m0, s46, 32768
 s_add_u32 s55, s42, 1048576
 buffer_load_dwordx4 v39, s[8:11], s55 offen  lds
 s_add_u32 m0, s46, 33792
 s_add_u32 s55, s42, 1179648
 buffer_load_dwordx4 v39, s[8:11], s55 offen  lds
 s_add_u32 m0, s47, 34816
 s_add_u32 s55, s43, 1310720
 buffer_load_dwordx4 v39, s[8:11], s55 offen  lds
 s_add_u32 m0, s47, 35840
 s_add_u32 s55, s43, 1441792
 buffer_load_dwordx4 v39, s[8:11], s55 offen  lds
 s_add_u32 m0, s46, 36864
 s_add_u32 s55, s42, 1572864
 buffer_load_dwordx4 v39, s[8:11], s55 offen  lds
 s_add_u32 m0, s46, 37888
 s_add_u32 s55, s42, 1703936
 buffer_load_dwordx4 v39, s[8:11], s55 offen  lds
 s_add_u32 m0, s47, 38912
 s_add_u32 s55, s43, 1835008
 buffer_load_dwordx4 v39, s[8:11], s55 offen  lds
 s_add_u32 m0, s47, 39936
 s_add_u32 s55, s43, 1966080
 buffer_load_dwordx4 v39, s[8:11], s55 offen  lds
 v_and_b32 v67, 15, v64
 v_lshrrev_b32 v68, 4, v64
 v_cvt_f32_u32 v200, v67
 v_mul_f32 v206, 0x41800000, v200
 v_lshl_add_u32 v65, v67, 1, 0
 v_add_u32 v65, 256, v65
 v_and_b32 v66, 3, v67
 v_lshlrev_b32 v66, 2, v66
 v_lshrrev_b32 v69, 2, v67
 v_lshl_add_u32 v66, v69, 8, v66
 v_cmp_gt_u32 vcc, 8, v67
 s_nop 1
 v_cndmask_b32 v65, v66, v65, vcc
 v_cvt_f32_u32 v202, v65
 v_and_b32 v65, 1, v67
 v_lshlrev_b32 v65, 3, v65
 v_lshrrev_b32 v66, 1, v67
 v_min_u32 v66, 4, v66
 v_lshl_add_u32 v65, v66, 8, v65
 v_add_u32 v65, 1024, v65
 v_cvt_f32_u32 v204, v65
 s_waitcnt vmcnt(30)
 v_lshlrev_b32 v95, 16, v94
 v_mul_f32 v95, 0x3fb8aa3b, v95
 v_exp_f32 v95, v95
 s_nop 0
 v_cvt_pk_bf16_f32 v95, v95, v95
 v_and_b32 v95, s98, v95
 v_lshl_add_u32 v65, v64, 5, s94
 v_lshlrev_b32 v96, 16, v88
 v_lshlrev_b32 v97, 16, v89
 v_lshlrev_b32 v98, 16, v90
 v_lshlrev_b32 v99, 16, v91
 v_lshlrev_b32 v100, 16, v92
 v_lshlrev_b32 v101, 16, v93
 v_mul_f32 v96, v95, v96
 v_mul_f32 v97, v95, v97
 v_mul_f32 v98, v95, v98
 v_mul_f32 v99, v95, v99
 v_mul_f32 v104, 0x3fb8aa3b, v96
 v_mul_f32 v105, 0x3e22f983, v97
 v_mul_f32 v106, v100, v98
 v_fma_f32 v106, -v101, v99, v106
 v_mul_f32 v107, v100, v99
 v_fma_f32 v107, v101, v98, v107
 ds_write_b128 v65, v[104:107] offset:4160
 v_and_b32 v96, s98, v88
 v_and_b32 v97, s98, v89
 v_and_b32 v98, s98, v90
 v_and_b32 v99, s98, v91
 v_and_b32 v100, s98, v92
 v_and_b32 v101, s98, v93
 v_mul_f32 v96, v95, v96
 v_mul_f32 v97, v95, v97
 v_mul_f32 v98, v95, v98
 v_mul_f32 v99, v95, v99
 v_mul_f32 v108, 0x3fb8aa3b, v96
 v_mul_f32 v109, 0x3e22f983, v97
 v_mul_f32 v110, v100, v98
 v_fma_f32 v110, -v101, v99, v110
 v_mul_f32 v111, v100, v99
 v_fma_f32 v111, v101, v98, v111
 ds_write_b128 v65, v[108:111] offset:4176
 v_mov_b32 v120, 0
 v_mov_b32 v121, 0
 v_mov_b32 v122, 0
 v_mov_b32 v123, 0
 v_mov_b32 v124, 0
 v_mov_b32 v125, 0
 v_mov_b32 v126, 0
 v_mov_b32 v127, 0
 v_mov_b32 v128, 0
 v_mov_b32 v129, 0
 v_mov_b32 v130, 0
 v_mov_b32 v131, 0
 v_lshl_add_u32 v69, v68, 6, s94
 s_mov_b32 s95, 0
 s_waitcnt lgkmcnt(0)
L_cgb_kg0:
 ds_read_b128 v[88:91], v69 offset:4160
 ds_read_b128 v[92:95], v69 offset:4176
 ds_read_b128 v[96:99], v69 offset:4192
 ds_read_b128 v[100:103], v69 offset:4208
 v_add_u32 v69, 256, v69
 s_waitcnt lgkmcnt(3)
 v_pk_mul_f32 v[132:133], v[88:89], v[200:201] op_sel_hi:[1,0]
 v_pk_mul_f32 v[136:137], v[88:89], v[202:203] op_sel_hi:[1,0]
 v_pk_mul_f32 v[140:141], v[88:89], v[204:205] op_sel_hi:[1,0]
 v_pk_mul_f32 v[144:145], v[88:89], v[206:207] op_sel_hi:[1,0]
 v_fract_f32 v133, v133
 v_fract_f32 v137, v137
 v_fract_f32 v141, v141
 v_fract_f32 v145, v145
 v_exp_f32 v132, v132
 v_cos_f32 v134, v133
 v_sin_f32 v135, v133
 v_exp_f32 v136, v136
 v_cos_f32 v138, v137
 v_sin_f32 v139, v137
 v_exp_f32 v140, v140
 v_cos_f32 v142, v141
 v_sin_f32 v143, v141
 v_exp_f32 v144, v144
 v_cos_f32 v146, v145
 v_sin_f32 v147, v145
 v_pk_mul_f32 v[134:135], v[134:135], v[132:133] op_sel_hi:[1,0]
 v_pk_mul_f32 v[138:139], v[138:139], v[136:137] op_sel_hi:[1,0]
 v_pk_mul_f32 v[142:143], v[142:143], v[140:141] op_sel_hi:[1,0]
 v_pk_mul_f32 v[146:147], v[146:147], v[144:145] op_sel_hi:[1,0]
 v_pk_mul_f32 v[144:145], v[146:147], v[90:91] op_sel_hi:[0,1] neg_hi:[0,1]
 v_cvt_pk_bf16_f32 v104, v134, v135
 v_cvt_pk_bf16_f32 v108, v138, v139
 v_cvt_pk_bf16_f32 v112, v142, v143
 v_pk_fma_f32 v[144:145], v[146:147], v[90:91], v[144:145] op_sel:[1,1,0] op_sel_hi:[1,0,1] neg_lo:[0,1,0] neg_hi:[0,1,0]
 v_cvt_pk_bf16_f32 v116, v144, v145
 s_waitcnt lgkmcnt(2)
 v_pk_mul_f32 v[132:133], v[92:93], v[200:201] op_sel_hi:[1,0]
 v_pk_mul_f32 v[136:137], v[92:93], v[202:203] op_sel_hi:[1,0]
 v_pk_mul_f32 v[140:141], v[92:93], v[204:205] op_sel_hi:[1,0]
 v_pk_mul_f32 v[144:145], v[92:93], v[206:207] op_sel_hi:[1,0]
 v_fract_f32 v133, v133
 v_fract_f32 v137, v137
 v_fract_f32 v141, v141
 v_fract_f32 v145, v145
 v_exp_f32 v132, v132
 v_cos_f32 v134, v133
 v_sin_f32 v135, v133
 v_exp_f32 v136, v136
 v_cos_f32 v138, v137
 v_sin_f32 v139, v137
 v_exp_f32 v140, v140
 v_cos_f32 v142, v141
 v_sin_f32 v143, v141
 v_exp_f32 v144, v144
 v_cos_f32 v146, v145
 v_sin_f32 v147, v145
 v_pk_mul_f32 v[134:135], v[134:135], v[132:133] op_sel_hi:[1,0]
 v_pk_mul_f32 v[138:139], v[138:139], v[136:137] op_sel_hi:[1,0]
 v_pk_mul_f32 v[142:143], v[142:143], v[140:141] op_sel_hi:[1,0]
 v_pk_mul_f32 v[146:147], v[146:147], v[144:145] op_sel_hi:[1,0]
 v_pk_mul_f32 v[144:145], v[146:147], v[94:95] op_sel_hi:[0,1] neg_hi:[0,1]
 v_cvt_pk_bf16_f32 v105, v134, v135
 v_cvt_pk_bf16_f32 v109, v138, v139
 v_cvt_pk_bf16_f32 v113, v142, v143
 v_pk_fma_f32 v[144:145], v[146:147], v[94:95], v[144:145] op_sel:[1,1,0] op_sel_hi:[1,0,1] neg_lo:[0,1,0] neg_hi:[0,1,0]
 v_cvt_pk_bf16_f32 v117, v144, v145
 s_waitcnt lgkmcnt(1)
 v_pk_mul_f32 v[132:133], v[96:97], v[200:201] op_sel_hi:[1,0]
 v_pk_mul_f32 v[136:137], v[96:97], v[202:203] op_sel_hi:[1,0]
 v_pk_mul_f32 v[140:141], v[96:97], v[204:205] op_sel_hi:[1,0]
 v_pk_mul_f32 v[144:145], v[96:97], v[206:207] op_sel_hi:[1,0]
 v_fract_f32 v133, v133
 v_fract_f32 v137, v137
 v_fract_f32 v141, v141
 v_fract_f32 v145, v145
 v_exp_f32 v132, v132
 v_cos_f32 v134, v133
 v_sin_f32 v135, v133
 v_exp_f32 v136, v136
 v_cos_f32 v138, v137
 v_sin_f32 v139, v137
 v_exp_f32 v140, v140
 v_cos_f32 v142, v141
 v_sin_f32 v143, v141
 v_exp_f32 v144, v144
 v_cos_f32 v146, v145
 v_sin_f32 v147, v145
 v_pk_mul_f32 v[134:135], v[134:135], v[132:133] op_sel_hi:[1,0]
 v_pk_mul_f32 v[138:139], v[138:139], v[136:137] op_sel_hi:[1,0]
 v_pk_mul_f32 v[142:143], v[142:143], v[140:141] op_sel_hi:[1,0]
 v_pk_mul_f32 v[146:147], v[146:147], v[144:145] op_sel_hi:[1,0]
 v_pk_mul_f32 v[144:145], v[146:147], v[98:99] op_sel_hi:[0,1] neg_hi:[0,1]
 v_cvt_pk_bf16_f32 v106, v134, v135
 v_cvt_pk_bf16_f32 v110, v138, v139
 v_cvt_pk_bf16_f32 v114, v142, v143
 v_pk_fma_f32 v[144:145], v[146:147], v[98:99], v[144:145] op_sel:[1,1,0] op_sel_hi:[1,0,1] neg_lo:[0,1,0] neg_hi:[0,1,0]
 v_cvt_pk_bf16_f32 v118, v144, v145
 s_waitcnt lgkmcnt(0)
 v_pk_mul_f32 v[132:133], v[100:101], v[200:201] op_sel_hi:[1,0]
 v_pk_mul_f32 v[136:137], v[100:101], v[202:203] op_sel_hi:[1,0]
 v_pk_mul_f32 v[140:141], v[100:101], v[204:205] op_sel_hi:[1,0]
 v_pk_mul_f32 v[144:145], v[100:101], v[206:207] op_sel_hi:[1,0]
 v_fract_f32 v133, v133
 v_fract_f32 v137, v137
 v_fract_f32 v141, v141
 v_fract_f32 v145, v145
 v_exp_f32 v132, v132
 v_cos_f32 v134, v133
 v_sin_f32 v135, v133
 v_exp_f32 v136, v136
 v_cos_f32 v138, v137
 v_sin_f32 v139, v137
 v_exp_f32 v140, v140
 v_cos_f32 v142, v141
 v_sin_f32 v143, v141
 v_exp_f32 v144, v144
 v_cos_f32 v146, v145
 v_sin_f32 v147, v145
 v_pk_mul_f32 v[134:135], v[134:135], v[132:133] op_sel_hi:[1,0]
 v_pk_mul_f32 v[138:139], v[138:139], v[136:137] op_sel_hi:[1,0]
 v_pk_mul_f32 v[142:143], v[142:143], v[140:141] op_sel_hi:[1,0]
 v_pk_mul_f32 v[146:147], v[146:147], v[144:145] op_sel_hi:[1,0]
 v_pk_mul_f32 v[144:145], v[146:147], v[102:103] op_sel_hi:[0,1] neg_hi:[0,1]
 v_cvt_pk_bf16_f32 v107, v134, v135
 v_cvt_pk_bf16_f32 v111, v138, v139
 v_cvt_pk_bf16_f32 v115, v142, v143
 v_pk_fma_f32 v[144:145], v[146:147], v[102:103], v[144:145] op_sel:[1,1,0] op_sel_hi:[1,0,1] neg_lo:[0,1,0] neg_hi:[0,1,0]
 v_cvt_pk_bf16_f32 v119, v144, v145
 s_add_u32 s95, s95, 1
 s_cmp_lt_u32 s95, 2
 v_mfma_f32_16x16x32_bf16 v[120:123], v[104:107], v[116:119], v[120:123]
 v_mfma_f32_16x16x32_bf16 v[124:127], v[108:111], v[116:119], v[124:127]
 v_mfma_f32_16x16x32_bf16 v[128:131], v[112:115], v[116:119], v[128:131]
 s_cbranch_scc1 L_cgb_kg0
 s_waitcnt vmcnt(21)
 ds_read_b64_tr_b16 a[0:1], v41 offset:0
 ds_read_b64_tr_b16 a[2:3], v41 offset:128
 ds_read_b64_tr_b16 a[4:5], v41 offset:2048
 ds_read_b64_tr_b16 a[6:7], v41 offset:2176
 ds_read_b64_tr_b16 a[8:9], v41 offset:32
 ds_read_b64_tr_b16 a[10:11], v41 offset:160
 ds_read_b64_tr_b16 a[12:13], v41 offset:2080
 ds_read_b64_tr_b16 a[14:15], v41 offset:2208
 s_waitcnt lgkmcnt(0)
 ds_read_b64_tr_b16 a[48:49], v41 offset:4096
 ds_read_b64_tr_b16 a[50:51], v41 offset:4224
 ds_read_b64_tr_b16 a[52:53], v41 offset:6144
 ds_read_b64_tr_b16 a[54:55], v41 offset:6272
 ds_read_b64_tr_b16 a[56:57], v41 offset:4128
 ds_read_b64_tr_b16 a[58:59], v41 offset:4256
 ds_read_b64_tr_b16 a[60:61], v41 offset:6176
 ds_read_b64_tr_b16 a[62:63], v41 offset:6304
 s_waitcnt lgkmcnt(0)
 s_mov_b64 s[8:9], s[18:19]
 s_add_u32 m0, s46, 0
 s_add_u32 s55, s42, 0
 buffer_load_dwordx4 v39, s[8:11], s55 offen  lds
 s_add_u32 m0, s46, 1024
 s_add_u32 s55, s42, 131072
 buffer_load_dwordx4 v39, s[8:11], s55 offen  lds
 s_add_u32 m0, s47, 2048
 s_add_u32 s55, s43, 262144
 buffer_load_dwordx4 v39, s[8:11], s55 offen  lds
 s_add_u32 m0, s47, 3072
 s_add_u32 s55, s43, 393216
 buffer_load_dwordx4 v39, s[8:11], s55 offen  lds
 s_add_u32 m0, s46, 4096
 s_add_u32 s55, s42, 524288
 buffer_load_dwordx4 v39, s[8:11], s55 offen  lds
 s_add_u32 m0, s46, 5120
 s_add_u32 s55, s42, 655360
 buffer_load_dwordx4 v39, s[8:11], s55 offen  lds
 s_add_u32 m0, s47, 6144
 s_add_u32 s55, s43, 786432
 buffer_load_dwordx4 v39, s[8:11], s55 offen  lds
 s_add_u32 m0, s47, 7168
 s_add_u32 s55, s43, 917504
 buffer_load_dwordx4 v39, s[8:11], s55 offen  lds
 s_waitcnt vmcnt(16)
 s_cmp_eq_u32 s26, 0
 s_cselect_b32 s55, s49, 1073741824
 v_min_u32 v232, -2, v232
 v_min_u32 v233, -2, v233
 v_min_u32 v234, -2, v234
 v_min_u32 v235, -2, v235
 buffer_store_dwordx4 v[232:235], v21, s[4:7], s55 offen sc1
L_cgb_kg1:
 ds_read_b128 v[88:91], v69 offset:4160
 ds_read_b128 v[92:95], v69 offset:4176
 ds_read_b128 v[96:99], v69 offset:4192
 ds_read_b128 v[100:103], v69 offset:4208
 v_add_u32 v69, 256, v69
 s_waitcnt lgkmcnt(3)
 v_pk_mul_f32 v[132:133], v[88:89], v[200:201] op_sel_hi:[1,0]
 v_pk_mul_f32 v[136:137], v[88:89], v[202:203] op_sel_hi:[1,0]
 v_pk_mul_f32 v[140:141], v[88:89], v[204:205] op_sel_hi:[1,0]
 v_pk_mul_f32 v[144:145], v[88:89], v[206:207] op_sel_hi:[1,0]
 v_fract_f32 v133, v133
 v_fract_f32 v137, v137
 v_fract_f32 v141, v141
 v_fract_f32 v145, v145
 v_exp_f32 v132, v132
 v_cos_f32 v134, v133
 v_sin_f32 v135, v133
 v_exp_f32 v136, v136
 v_cos_f32 v138, v137
 v_sin_f32 v139, v137
 v_exp_f32 v140, v140
 v_cos_f32 v142, v141
 v_sin_f32 v143, v141
 v_exp_f32 v144, v144
 v_cos_f32 v146, v145
 v_sin_f32 v147, v145
 v_pk_mul_f32 v[134:135], v[134:135], v[132:133] op_sel_hi:[1,0]
 v_pk_mul_f32 v[138:139], v[138:139], v[136:137] op_sel_hi:[1,0]
 v_pk_mul_f32 v[142:143], v[142:143], v[140:141] op_sel_hi:[1,0]
 v_pk_mul_f32 v[146:147], v[146:147], v[144:145] op_sel_hi:[1,0]
 v_pk_mul_f32 v[144:145], v[146:147], v[90:91] op_sel_hi:[0,1] neg_hi:[0,1]
 v_cvt_pk_bf16_f32 v104, v134, v135
 v_cvt_pk_bf16_f32 v108, v138, v139
 v_cvt_pk_bf16_f32 v112, v142, v143
 v_pk_fma_f32 v[144:145], v[146:147], v[90:91], v[144:145] op_sel:[1,1,0] op_sel_hi:[1,0,1] neg_lo:[0,1,0] neg_hi:[0,1,0]
 v_cvt_pk_bf16_f32 v116, v144, v145
 s_waitcnt lgkmcnt(2)
 v_pk_mul_f32 v[132:133], v[92:93], v[200:201] op_sel_hi:[1,0]
 v_pk_mul_f32 v[136:137], v[92:93], v[202:203] op_sel_hi:[1,0]
 v_pk_mul_f32 v[140:141], v[92:93], v[204:205] op_sel_hi:[1,0]
 v_pk_mul_f32 v[144:145], v[92:93], v[206:207] op_sel_hi:[1,0]
 v_fract_f32 v133, v133
 v_fract_f32 v137, v137
 v_fract_f32 v141, v141
 v_fract_f32 v145, v145
 v_exp_f32 v132, v132
 v_cos_f32 v134, v133
 v_sin_f32 v135, v133
 v_exp_f32 v136, v136
 v_cos_f32 v138, v137
 v_sin_f32 v139, v137
 v_exp_f32 v140, v140
 v_cos_f32 v142, v141
 v_sin_f32 v143, v141
 v_exp_f32 v144, v144
 v_cos_f32 v146, v145
 v_sin_f32 v147, v145
 v_pk_mul_f32 v[134:135], v[134:135], v[132:133] op_sel_hi:[1,0]
 v_pk_mul_f32 v[138:139], v[138:139], v[136:137] op_sel_hi:[1,0]
 v_pk_mul_f32 v[142:143], v[142:143], v[140:141] op_sel_hi:[1,0]
 v_pk_mul_f32 v[146:147], v[146:147], v[144:145] op_sel_hi:[1,0]
 v_pk_mul_f32 v[144:145], v[146:147], v[94:95] op_sel_hi:[0,1] neg_hi:[0,1]
 v_cvt_pk_bf16_f32 v105, v134, v135
 v_cvt_pk_bf16_f32 v109, v138, v139
 v_cvt_pk_bf16_f32 v113, v142, v143
 v_pk_fma_f32 v[144:145], v[146:147], v[94:95], v[144:145] op_sel:[1,1,0] op_sel_hi:[1,0,1] neg_lo:[0,1,0] neg_hi:[0,1,0]
 v_cvt_pk_bf16_f32 v117, v144, v145
 s_waitcnt lgkmcnt(1)
 v_pk_mul_f32 v[132:133], v[96:97], v[200:201] op_sel_hi:[1,0]
 v_pk_mul_f32 v[136:137], v[96:97], v[202:203] op_sel_hi:[1,0]
 v_pk_mul_f32 v[140:141], v[96:97], v[204:205] op_sel_hi:[1,0]
 v_pk_mul_f32 v[144:145], v[96:97], v[206:207] op_sel_hi:[1,0]
 v_fract_f32 v133, v133
 v_fract_f32 v137, v137
 v_fract_f32 v141, v141
 v_fract_f32 v145, v145
 v_exp_f32 v132, v132
 v_cos_f32 v134, v133
 v_sin_f32 v135, v133
 v_exp_f32 v136, v136
 v_cos_f32 v138, v137
 v_sin_f32 v139, v137
 v_exp_f32 v140, v140
 v_cos_f32 v142, v141
 v_sin_f32 v143, v141
 v_exp_f32 v144, v144
 v_cos_f32 v146, v145
 v_sin_f32 v147, v145
 v_pk_mul_f32 v[134:135], v[134:135], v[132:133] op_sel_hi:[1,0]
 v_pk_mul_f32 v[138:139], v[138:139], v[136:137] op_sel_hi:[1,0]
 v_pk_mul_f32 v[142:143], v[142:143], v[140:141] op_sel_hi:[1,0]
 v_pk_mul_f32 v[146:147], v[146:147], v[144:145] op_sel_hi:[1,0]
 v_pk_mul_f32 v[144:145], v[146:147], v[98:99] op_sel_hi:[0,1] neg_hi:[0,1]
 v_cvt_pk_bf16_f32 v106, v134, v135
 v_cvt_pk_bf16_f32 v110, v138, v139
 v_cvt_pk_bf16_f32 v114, v142, v143
 v_pk_fma_f32 v[144:145], v[146:147], v[98:99], v[144:145] op_sel:[1,1,0] op_sel_hi:[1,0,1] neg_lo:[0,1,0] neg_hi:[0,1,0]
 v_cvt_pk_bf16_f32 v118, v144, v145
 s_waitcnt lgkmcnt(0)
 v_pk_mul_f32 v[132:133], v[100:101], v[200:201] op_sel_hi:[1,0]
 v_pk_mul_f32 v[136:137], v[100:101], v[202:203] op_sel_hi:[1,0]
 v_pk_mul_f32 v[140:141], v[100:101], v[204:205] op_sel_hi:[1,0]
 v_pk_mul_f32 v[144:145], v[100:101], v[206:207] op_sel_hi:[1,0]
 v_fract_f32 v133, v133
 v_fract_f32 v137, v137
 v_fract_f32 v141, v141
 v_fract_f32 v145, v145
 v_exp_f32 v132, v132
 v_cos_f32 v134, v133
 v_sin_f32 v135, v133
 v_exp_f32 v136, v136
 v_cos_f32 v138, v137
 v_sin_f32 v139, v137
 v_exp_f32 v140, v140
 v_cos_f32 v142, v141
 v_sin_f32 v143, v141
 v_exp_f32 v144, v144
 v_cos_f32 v146, v145
 v_sin_f32 v147, v145
 v_pk_mul_f32 v[134:135], v[134:135], v[132:133] op_sel_hi:[1,0]
 v_pk_mul_f32 v[138:139], v[138:139], v[136:137] op_sel_hi:[1,0]
 v_pk_mul_f32 v[142:143], v[142:143], v[140:141] op_sel_hi:[1,0]
 v_pk_mul_f32 v[146:147], v[146:147], v[144:145] op_sel_hi:[1,0]
 v_pk_mul_f32 v[144:145], v[146:147], v[102:103] op_sel_hi:[0,1] neg_hi:[0,1]
 v_cvt_pk_bf16_f32 v107, v134, v135
 v_cvt_pk_bf16_f32 v111, v138, v139
 v_cvt_pk_bf16_f32 v115, v142, v143
 v_pk_fma_f32 v[144:145], v[146:147], v[102:103], v[144:145] op_sel:[1,1,0] op_sel_hi:[1,0,1] neg_lo:[0,1,0] neg_hi:[0,1,0]
 v_cvt_pk_bf16_f32 v119, v144, v145
 s_add_u32 s95, s95, 1
 s_cmp_lt_u32 s95, 5
 v_mfma_f32_16x16x32_bf16 v[120:123], v[104:107], v[116:119], v[120:123]
 v_mfma_f32_16x16x32_bf16 v[124:127], v[108:111], v[116:119], v[124:127]
 v_mfma_f32_16x16x32_bf16 v[128:131], v[112:115], v[116:119], v[128:131]
 s_cbranch_scc1 L_cgb_kg1
 s_waitcnt vmcnt(9)
 ds_read_b64_tr_b16 a[96:97], v41 offset:32768
 ds_read_b64_tr_b16 a[98:99], v41 offset:32896
 ds_read_b64_tr_b16 a[100:101], v41 offset:34816
 ds_read_b64_tr_b16 a[102:103], v41 offset:34944
 ds_read_b64_tr_b16 a[104:105], v41 offset:32800
 ds_read_b64_tr_b16 a[106:107], v41 offset:32928
 ds_read_b64_tr_b16 a[108:109], v41 offset:34848
 ds_read_b64_tr_b16 a[110:111], v41 offset:34976
 s_waitcnt lgkmcnt(0)
 ds_read_b64_tr_b16 a[144:145], v41 offset:36864
 ds_read_b64_tr_b16 a[146:147], v41 offset:36992
 ds_read_b64_tr_b16 a[148:149], v41 offset:38912
 ds_read_b64_tr_b16 a[150:151], v41 offset:39040
 ds_read_b64_tr_b16 a[152:153], v41 offset:36896
 ds_read_b64_tr_b16 a[154:155], v41 offset:37024
 ds_read_b64_tr_b16 a[156:157], v41 offset:38944
 ds_read_b64_tr_b16 a[158:159], v41 offset:39072
 s_waitcnt lgkmcnt(0)
 s_add_u32 m0, s46, 32768
 s_add_u32 s55, s42, 1048576
 buffer_load_dwordx4 v39, s[8:11], s55 offen  lds
 s_add_u32 m0, s46, 33792
 s_add_u32 s55, s42, 1179648
 buffer_load_dwordx4 v39, s[8:11], s55 offen  lds
 s_add_u32 m0, s47, 34816
 s_add_u32 s55, s43, 1310720
 buffer_load_dwordx4 v39, s[8:11], s55 offen  lds
 s_add_u32 m0, s47, 35840
 s_add_u32 s55, s43, 1441792
 buffer_load_dwordx4 v39, s[8:11], s55 offen  lds
 s_add_u32 m0, s46, 36864
 s_add_u32 s55, s42, 1572864
 buffer_load_dwordx4 v39, s[8:11], s55 offen  lds
 s_add_u32 m0, s46, 37888
 s_add_u32 s55, s42, 1703936
 buffer_load_dwordx4 v39, s[8:11], s55 offen  lds
 s_add_u32 m0, s47, 38912
 s_add_u32 s55, s43, 1835008
 buffer_load_dwordx4 v39, s[8:11], s55 offen  lds
 s_add_u32 m0, s47, 39936
 s_add_u32 s55, s43, 1966080
 buffer_load_dwordx4 v39, s[8:11], s55 offen  lds
 s_barrier
 v_mov_b32 v216, s34
 v_mov_b32 v217, s35
 v_bfrev_b32 v218, 1
 v_cmp_eq_u32 vcc, 64, v0
 s_nop 1
 v_cndmask_b32 v218, v218, 0, vcc
 buffer_atomic_add_x2 v[216:217], v218, s[12:15], s30 offen sc1
L_cgb_kg2:
 ds_read_b128 v[88:91], v69 offset:4160
 ds_read_b128 v[92:95], v69 offset:4176
 ds_read_b128 v[96:99], v69 offset:4192
 ds_read_b128 v[100:103], v69 offset:4208
 v_add_u32 v69, 256, v69
 s_waitcnt lgkmcnt(3)
 v_pk_mul_f32 v[132:133], v[88:89], v[200:201] op_sel_hi:[1,0]
 v_pk_mul_f32 v[136:137], v[88:89], v[202:203] op_sel_hi:[1,0]
 v_pk_mul_f32 v[140:141], v[88:89], v[204:205] op_sel_hi:[1,0]
 v_pk_mul_f32 v[144:145], v[88:89], v[206:207] op_sel_hi:[1,0]
 v_fract_f32 v133, v133
 v_fract_f32 v137, v137
 v_fract_f32 v141, v141
 v_fract_f32 v145, v145
 v_exp_f32 v132, v132
 v_cos_f32 v134, v133
 v_sin_f32 v135, v133
 v_exp_f32 v136, v136
 v_cos_f32 v138, v137
 v_sin_f32 v139, v137
 v_exp_f32 v140, v140
 v_cos_f32 v142, v141
 v_sin_f32 v143, v141
 v_exp_f32 v144, v144
 v_cos_f32 v146, v145
 v_sin_f32 v147, v145
 v_pk_mul_f32 v[134:135], v[134:135], v[132:133] op_sel_hi:[1,0]
 v_pk_mul_f32 v[138:139], v[138:139], v[136:137] op_sel_hi:[1,0]
 v_pk_mul_f32 v[142:143], v[142:143], v[140:141] op_sel_hi:[1,0]
 v_pk_mul_f32 v[146:147], v[146:147], v[144:145] op_sel_hi:[1,0]
 v_pk_mul_f32 v[144:145], v[146:147], v[90:91] op_sel_hi:[0,1] neg_hi:[0,1]
 v_cvt_pk_bf16_f32 v104, v134, v135
 v_cvt_pk_bf16_f32 v108, v138, v139
 v_cvt_pk_bf16_f32 v112, v142, v143
 v_pk_fma_f32 v[144:145], v[146:147], v[90:91], v[144:145] op_sel:[1,1,0] op_sel_hi:[1,0,1] neg_lo:[0,1,0] neg_hi:[0,1,0]
 v_cvt_pk_bf16_f32 v116, v144, v145
 s_waitcnt lgkmcnt(2)
 v_pk_mul_f32 v[132:133], v[92:93], v[200:201] op_sel_hi:[1,0]
 v_pk_mul_f32 v[136:137], v[92:93], v[202:203] op_sel_hi:[1,0]
 v_pk_mul_f32 v[140:141], v[92:93], v[204:205] op_sel_hi:[1,0]
 v_pk_mul_f32 v[144:145], v[92:93], v[206:207] op_sel_hi:[1,0]
 v_fract_f32 v133, v133
 v_fract_f32 v137, v137
 v_fract_f32 v141, v141
 v_fract_f32 v145, v145
 v_exp_f32 v132, v132
 v_cos_f32 v134, v133
 v_sin_f32 v135, v133
 v_exp_f32 v136, v136
 v_cos_f32 v138, v137
 v_sin_f32 v139, v137
 v_exp_f32 v140, v140
 v_cos_f32 v142, v141
 v_sin_f32 v143, v141
 v_exp_f32 v144, v144
 v_cos_f32 v146, v145
 v_sin_f32 v147, v145
 v_pk_mul_f32 v[134:135], v[134:135], v[132:133] op_sel_hi:[1,0]
 v_pk_mul_f32 v[138:139], v[138:139], v[136:137] op_sel_hi:[1,0]
 v_pk_mul_f32 v[142:143], v[142:143], v[140:141] op_sel_hi:[1,0]
 v_pk_mul_f32 v[146:147], v[146:147], v[144:145] op_sel_hi:[1,0]
 v_pk_mul_f32 v[144:145], v[146:147], v[94:95] op_sel_hi:[0,1] neg_hi:[0,1]
 v_cvt_pk_bf16_f32 v105, v134, v135
 v_cvt_pk_bf16_f32 v109, v138, v139
 v_cvt_pk_bf16_f32 v113, v142, v143
 v_pk_fma_f32 v[144:145], v[146:147], v[94:95], v[144:145] op_sel:[1,1,0] op_sel_hi:[1,0,1] neg_lo:[0,1,0] neg_hi:[0,1,0]
 v_cvt_pk_bf16_f32 v117, v144, v145
 s_waitcnt lgkmcnt(1)
 v_pk_mul_f32 v[132:133], v[96:97], v[200:201] op_sel_hi:[1,0]
 v_pk_mul_f32 v[136:137], v[96:97], v[202:203] op_sel_hi:[1,0]
 v_pk_mul_f32 v[140:141], v[96:97], v[204:205] op_sel_hi:[1,0]
 v_pk_mul_f32 v[144:145], v[96:97], v[206:207] op_sel_hi:[1,0]
 v_fract_f32 v133, v133
 v_fract_f32 v137, v137
 v_fract_f32 v141, v141
 v_fract_f32 v145, v145
 v_exp_f32 v132, v132
 v_cos_f32 v134, v133
 v_sin_f32 v135, v133
 v_exp_f32 v136, v136
 v_cos_f32 v138, v137
 v_sin_f32 v139, v137
 v_exp_f32 v140, v140
 v_cos_f32 v142, v141
 v_sin_f32 v143, v141
 v_exp_f32 v144, v144
 v_cos_f32 v146, v145
 v_sin_f32 v147, v145
 v_pk_mul_f32 v[134:135], v[134:135], v[132:133] op_sel_hi:[1,0]
 v_pk_mul_f32 v[138:139], v[138:139], v[136:137] op_sel_hi:[1,0]
 v_pk_mul_f32 v[142:143], v[142:143], v[140:141] op_sel_hi:[1,0]
 v_pk_mul_f32 v[146:147], v[146:147], v[144:145] op_sel_hi:[1,0]
 v_pk_mul_f32 v[144:145], v[146:147], v[98:99] op_sel_hi:[0,1] neg_hi:[0,1]
 v_cvt_pk_bf16_f32 v106, v134, v135
 v_cvt_pk_bf16_f32 v110, v138, v139
 v_cvt_pk_bf16_f32 v114, v142, v143
 v_pk_fma_f32 v[144:145], v[146:147], v[98:99], v[144:145] op_sel:[1,1,0] op_sel_hi:[1,0,1] neg_lo:[0,1,0] neg_hi:[0,1,0]
 v_cvt_pk_bf16_f32 v118, v144, v145
 s_waitcnt lgkmcnt(0)
 v_pk_mul_f32 v[132:133], v[100:101], v[200:201] op_sel_hi:[1,0]
 v_pk_mul_f32 v[136:137], v[100:101], v[202:203] op_sel_hi:[1,0]
 v_pk_mul_f32 v[140:141], v[100:101], v[204:205] op_sel_hi:[1,0]
 v_pk_mul_f32 v[144:145], v[100:101], v[206:207] op_sel_hi:[1,0]
 v_fract_f32 v133, v133
 v_fract_f32 v137, v137
 v_fract_f32 v141, v141
 v_fract_f32 v145, v145
 v_exp_f32 v132, v132
 v_cos_f32 v134, v133
 v_sin_f32 v135, v133
 v_exp_f32 v136, v136
 v_cos_f32 v138, v137
 v_sin_f32 v139, v137
 v_exp_f32 v140, v140
 v_cos_f32 v142, v141
 v_sin_f32 v143, v141
 v_exp_f32 v144, v144
 v_cos_f32 v146, v145
 v_sin_f32 v147, v145
 v_pk_mul_f32 v[134:135], v[134:135], v[132:133] op_sel_hi:[1,0]
 v_pk_mul_f32 v[138:139], v[138:139], v[136:137] op_sel_hi:[1,0]
 v_pk_mul_f32 v[142:143], v[142:143], v[140:141] op_sel_hi:[1,0]
 v_pk_mul_f32 v[146:147], v[146:147], v[144:145] op_sel_hi:[1,0]
 v_pk_mul_f32 v[144:145], v[146:147], v[102:103] op_sel_hi:[0,1] neg_hi:[0,1]
 v_cvt_pk_bf16_f32 v107, v134, v135
 v_cvt_pk_bf16_f32 v111, v138, v139
 v_cvt_pk_bf16_f32 v115, v142, v143
 v_pk_fma_f32 v[144:145], v[146:147], v[102:103], v[144:145] op_sel:[1,1,0] op_sel_hi:[1,0,1] neg_lo:[0,1,0] neg_hi:[0,1,0]
 v_cvt_pk_bf16_f32 v119, v144, v145
 s_add_u32 s95, s95, 1
 s_cmp_lt_u32 s95, 8
 v_mfma_f32_16x16x32_bf16 v[120:123], v[104:107], v[116:119], v[120:123]
 v_mfma_f32_16x16x32_bf16 v[124:127], v[108:111], v[116:119], v[124:127]
 v_mfma_f32_16x16x32_bf16 v[128:131], v[112:115], v[116:119], v[128:131]
 s_cbranch_scc1 L_cgb_kg2
 s_waitcnt vmcnt(10)
 ds_read_b64_tr_b16 a[16:17], v41 offset:0
 ds_read_b64_tr_b16 a[18:19], v41 offset:128
 ds_read_b64_tr_b16 a[20:21], v41 offset:2048
 ds_read_b64_tr_b16 a[22:23], v41 offset:2176
 ds_read_b64_tr_b16 a[24:25], v41 offset:32
 ds_read_b64_tr_b16 a[26:27], v41 offset:160
 ds_read_b64_tr_b16 a[28:29], v41 offset:2080
 ds_read_b64_tr_b16 a[30:31], v41 offset:2208
 s_waitcnt lgkmcnt(0)
 ds_read_b64_tr_b16 a[64:65], v41 offset:4096
 ds_read_b64_tr_b16 a[66:67], v41 offset:4224
 ds_read_b64_tr_b16 a[68:69], v41 offset:6144
 ds_read_b64_tr_b16 a[70:71], v41 offset:6272
 ds_read_b64_tr_b16 a[72:73], v41 offset:4128
 ds_read_b64_tr_b16 a[74:75], v41 offset:4256
 ds_read_b64_tr_b16 a[76:77], v41 offset:6176
 ds_read_b64_tr_b16 a[78:79], v41 offset:6304
 s_waitcnt lgkmcnt(0)
 s_mov_b64 s[8:9], s[20:21]
 s_add_u32 m0, s46, 0
 s_add_u32 s55, s42, 0
 buffer_load_dwordx4 v39, s[8:11], s55 offen  lds
 s_add_u32 m0, s46, 1024
 s_add_u32 s55, s42, 131072
 buffer_load_dwordx4 v39, s[8:11], s55 offen  lds
 s_add_u32 m0, s47, 2048
 s_add_u32 s55, s43, 262144
 buffer_load_dwordx4 v39, s[8:11], s55 offen  lds
 s_add_u32 m0, s47, 3072
 s_add_u32 s55, s43, 393216
 buffer_load_dwordx4 v39, s[8:11], s55 offen  lds
 s_add_u32 m0, s46, 4096
 s_add_u32 s55, s42, 524288
 buffer_load_dwordx4 v39, s[8:11], s55 offen  lds
 s_add_u32 m0, s46, 5120
 s_add_u32 s55, s42, 655360
 buffer_load_dwordx4 v39, s[8:11], s55 offen  lds
 s_add_u32 m0, s47, 6144
 s_add_u32 s55, s43, 786432
 buffer_load_dwordx4 v39, s[8:11], s55 offen  lds
 s_add_u32 m0, s47, 7168
 s_add_u32 s55, s43, 917504
 buffer_load_dwordx4 v39, s[8:11], s55 offen  lds
 v_lshlrev_b32 v65, 5, v67
 v_lshl_add_u32 v65, v68, 3, v65
 v_add_u32 v65, s94, v65
 v_lshlrev_b32 v66, 4, v67
 v_lshl_add_u32 v66, v68, 3, v66
 v_lshlrev_b32 v69, 3, v67
 v_lshl_add_u32 v69, v68, 7, v69
 v_cmp_gt_u32 vcc, 2, v68
 s_nop 1
 v_cndmask_b32 v66, v69, v66, vcc
 v_add_u32 v66, s94, v66
 v_lshlrev_b32 v69, 2, v67
 v_lshl_add_u32 v69, v68, 7, v69
 v_add_u32 v69, s94, v69
 v_cvt_pk_bf16_f32 v132, v120, v121
 v_cvt_pk_bf16_f32 v133, v122, v123
 v_cvt_pk_bf16_f32 v134, v124, v125
 v_cvt_pk_bf16_f32 v135, v126, v127
 v_cvt_pk_bf16_f32 v136, v128, v129
 v_cvt_pk_bf16_f32 v137, v130, v131
 ds_write_b64 v65, v[132:133]
 ds_write_b64 v66, v[134:135] offset:512
 ds_write_b32 v69, v136 offset:1024
 ds_write_b32 v69, v137 offset:1088
 s_waitcnt vmcnt(9)
 ds_read_b64_tr_b16 a[112:113], v41 offset:32768
 ds_read_b64_tr_b16 a[114:115], v41 offset:32896
 ds_read_b64_tr_b16 a[116:117], v41 offset:34816
 ds_read_b64_tr_b16 a[118:119], v41 offset:34944
 ds_read_b64_tr_b16 a[120:121], v41 offset:32800
 ds_read_b64_tr_b16 a[122:123], v41 offset:32928
 ds_read_b64_tr_b16 a[124:125], v41 offset:34848
 ds_read_b64_tr_b16 a[126:127], v41 offset:34976
 s_waitcnt lgkmcnt(0)
 ds_read_b64_tr_b16 a[160:161], v41 offset:36864
 ds_read_b64_tr_b16 a[162:163], v41 offset:36992
 ds_read_b64_tr_b16 a[164:165], v41 offset:38912
 ds_read_b64_tr_b16 a[166:167], v41 offset:39040
 ds_read_b64_tr_b16 a[168:169], v41 offset:36896
 ds_read_b64_tr_b16 a[170:171], v41 offset:37024
 ds_read_b64_tr_b16 a[172:173], v41 offset:38944
 ds_read_b64_tr_b16 a[174:175], v41 offset:39072
 s_waitcnt lgkmcnt(0)
 s_add_u32 m0, s46, 32768
 s_add_u32 s55, s42, 1048576
 buffer_load_dwordx4 v39, s[8:11], s55 offen  lds
 s_add_u32 m0, s46, 33792
 s_add_u32 s55, s42, 1179648
 buffer_load_dwordx4 v39, s[8:11], s55 offen  lds
 s_add_u32 m0, s47, 34816
 s_add_u32 s55, s43, 1310720
 buffer_load_dwordx4 v39, s[8:11], s55 offen  lds
 s_add_u32 m0, s47, 35840
 s_add_u32 s55, s43, 1441792
 buffer_load_dwordx4 v39, s[8:11], s55 offen  lds
 s_add_u32 m0, s46, 36864
 s_add_u32 s55, s42, 1572864
 buffer_load_dwordx4 v39, s[8:11], s55 offen  lds
 s_add_u32 m0, s46, 37888
 s_add_u32 s55, s42, 1703936
 buffer_load_dwordx4 v39, s[8:11], s55 offen  lds
 s_add_u32 m0, s47, 38912
 s_add_u32 s55, s43, 1835008
 buffer_load_dwordx4 v39, s[8:11], s55 offen  lds
 s_add_u32 m0, s47, 39936
 s_add_u32 s55, s43, 1966080
 buffer_load_dwordx4 v39, s[8:11], s55 offen  lds
 s_waitcnt vmcnt(8)
 ds_read_b64_tr_b16 a[32:33], v41 offset:0
 ds_read_b64_tr_b16 a[34:35], v41 offset:128
 ds_read_b64_tr_b16 a[36:37], v41 offset:2048
 ds_read_b64_tr_b16 a[38:39], v41 offset:2176
 ds_read_b64_tr_b16 a[40:41], v41 offset:32
 ds_read_b64_tr_b16 a[42:43], v41 offset:160
 ds_read_b64_tr_b16 a[44:45], v41 offset:2080
 ds_read_b64_tr_b16 a[46:47], v41 offset:2208
 s_waitcnt lgkmcnt(0)
 ds_read_b64_tr_b16 a[80:81], v41 offset:4096
 ds_read_b64_tr_b16 a[82:83], v41 offset:4224
 ds_read_b64_tr_b16 a[84:85], v41 offset:6144
 ds_read_b64_tr_b16 a[86:87], v41 offset:6272
 ds_read_b64_tr_b16 a[88:89], v41 offset:4128
 ds_read_b64_tr_b16 a[90:91], v41 offset:4256
 ds_read_b64_tr_b16 a[92:93], v41 offset:6176
 ds_read_b64_tr_b16 a[94:95], v41 offset:6304
 s_waitcnt lgkmcnt(0)
 s_mov_b64 s[8:9], s[22:23]
 s_add_u32 m0, s46, 0
 s_add_u32 s55, s44, 0
 buffer_load_dwordx4 v40, s[8:11], s55 offen  lds
 s_add_u32 m0, s46, 1024
 s_add_u32 s55, s44, 32768
 buffer_load_dwordx4 v40, s[8:11], s55 offen  lds
 s_add_u32 m0, s47, 2048
 s_add_u32 s55, s45, 65536
 buffer_load_dwordx4 v40, s[8:11], s55 offen  lds
 s_add_u32 m0, s47, 3072
 s_add_u32 s55, s45, 98304
 buffer_load_dwordx4 v40, s[8:11], s55 offen  lds
 s_add_u32 m0, s46, 4096
 s_add_u32 s55, s44, 131072
 buffer_load_dwordx4 v40, s[8:11], s55 offen  lds
 s_add_u32 m0, s46, 5120
 s_add_u32 s55, s44, 163840
 buffer_load_dwordx4 v40, s[8:11], s55 offen  lds
 s_add_u32 m0, s47, 6144
 s_add_u32 s55, s45, 196608
 buffer_load_dwordx4 v40, s[8:11], s55 offen  lds
 s_add_u32 m0, s47, 7168
 s_add_u32 s55, s45, 229376
 buffer_load_dwordx4 v40, s[8:11], s55 offen  lds
 s_waitcnt vmcnt(8)
 ds_read_b64_tr_b16 a[128:129], v41 offset:32768
 ds_read_b64_tr_b16 a[130:131], v41 offset:32896
 ds_read_b64_tr_b16 a[132:133], v41 offset:34816
 ds_read_b64_tr_b16 a[134:135], v41 offset:34944
 ds_read_b64_tr_b16 a[136:137], v41 offset:32800
 ds_read_b64_tr_b16 a[138:139], v41 offset:32928
 ds_read_b64_tr_b16 a[140:141], v41 offset:34848
 ds_read_b64_tr_b16 a[142:143], v41 offset:34976
 s_waitcnt lgkmcnt(0)
 ds_read_b64_tr_b16 a[176:177], v41 offset:36864
 ds_read_b64_tr_b16 a[178:179], v41 offset:36992
 ds_read_b64_tr_b16 a[180:181], v41 offset:38912
 ds_read_b64_tr_b16 a[182:183], v41 offset:39040
 ds_read_b64_tr_b16 a[184:185], v41 offset:36896
 ds_read_b64_tr_b16 a[186:187], v41 offset:37024
 ds_read_b64_tr_b16 a[188:189], v41 offset:38944
 ds_read_b64_tr_b16 a[190:191], v41 offset:39072
 s_waitcnt lgkmcnt(0)
 s_add_u32 m0, s46, 32768
 s_add_u32 s55, s44, 262144
 buffer_load_dwordx4 v40, s[8:11], s55 offen  lds
 s_add_u32 m0, s46, 33792
 s_add_u32 s55, s44, 294912
 buffer_load_dwordx4 v40, s[8:11], s55 offen  lds
 s_add_u32 m0, s47, 34816
 s_add_u32 s55, s45, 327680
 buffer_load_dwordx4 v40, s[8:11], s55 offen  lds
 s_add_u32 m0, s47, 35840
 s_add_u32 s55, s45, 360448
 buffer_load_dwordx4 v40, s[8:11], s55 offen  lds
 s_add_u32 m0, s46, 36864
 s_add_u32 s55, s44, 393216
 buffer_load_dwordx4 v40, s[8:11], s55 offen  lds
 s_add_u32 m0, s46, 37888
 s_add_u32 s55, s44, 425984
 buffer_load_dwordx4 v40, s[8:11], s55 offen  lds
 s_add_u32 m0, s47, 38912
 s_add_u32 s55, s45, 458752
 buffer_load_dwordx4 v40, s[8:11], s55 offen  lds
 s_add_u32 m0, s47, 39936
 s_add_u32 s55, s45, 491520
 buffer_load_dwordx4 v40, s[8:11], s55 offen  lds
 buffer_load_dwordx4 v[216:219], v21, s[4:7], s49 offen sc1
 buffer_load_dwordx4 v[220:223], v21, s[4:7], s50 offen sc1
 buffer_load_dwordx4 v[224:227], v22, s[4:7], s51 offen sc1
 buffer_load_dwordx4 v[228:231], v23, s[4:7], s51 offen offset:1024 sc1
 buffer_load_dword v236, v25, s[4:7], s65 offen sc1
 buffer_load_dword v237, v27, s[4:7], s65 offen sc1
 buffer_load_dword v238, v25, s[4:7], s66 offen sc1
 s_waitcnt vmcnt(15)
 s_barrier
 ds_read_b64_tr_b16 a[192:193], v38 offset:0
 ds_read_b64_tr_b16 a[194:195], v38 offset:128
 ds_read_b64_tr_b16 a[196:197], v38 offset:2048
 ds_read_b64_tr_b16 a[198:199], v38 offset:2176
 ds_read_b64_tr_b16 a[200:201], v38 offset:4096
 ds_read_b64_tr_b16 a[202:203], v38 offset:4224
 ds_read_b64_tr_b16 a[204:205], v38 offset:6144
 ds_read_b64_tr_b16 a[206:207], v38 offset:6272
 s_waitcnt lgkmcnt(0)
 ds_read_b64_tr_b16 a[208:209], v38 offset:8192
 ds_read_b64_tr_b16 a[210:211], v38 offset:8320
 ds_read_b64_tr_b16 a[212:213], v38 offset:10240
 ds_read_b64_tr_b16 a[214:215], v38 offset:10368
 ds_read_b64_tr_b16 a[216:217], v38 offset:12288
 ds_read_b64_tr_b16 a[218:219], v38 offset:12416
 ds_read_b64_tr_b16 a[220:221], v38 offset:14336
 ds_read_b64_tr_b16 a[222:223], v38 offset:14464
 s_waitcnt lgkmcnt(0)
 ds_read_b64_tr_b16 a[224:225], v38 offset:16384
 ds_read_b64_tr_b16 a[226:227], v38 offset:16512
 ds_read_b64_tr_b16 a[228:229], v38 offset:18432
 ds_read_b64_tr_b16 a[230:231], v38 offset:18560
 ds_read_b64_tr_b16 a[232:233], v38 offset:20480
 ds_read_b64_tr_b16 a[234:235], v38 offset:20608
 ds_read_b64_tr_b16 a[236:237], v38 offset:22528
 ds_read_b64_tr_b16 a[238:239], v38 offset:22656
 s_waitcnt lgkmcnt(0)
 ds_read_b64_tr_b16 a[240:241], v38 offset:24576
 ds_read_b64_tr_b16 a[242:243], v38 offset:24704
 ds_read_b64_tr_b16 a[244:245], v38 offset:26624
 ds_read_b64_tr_b16 a[246:247], v38 offset:26752
 ds_read_b64_tr_b16 a[248:249], v38 offset:28672
 ds_read_b64_tr_b16 a[250:251], v38 offset:28800
 ds_read_b64_tr_b16 a[252:253], v38 offset:30720
 ds_read_b64_tr_b16 a[254:255], v38 offset:30848
 s_waitcnt lgkmcnt(0)
 s_waitcnt vmcnt(0)
 s_waitcnt vmcnt(7)
 s_barrier
 ds_read_b64_tr_b16 v[172:173], v38 offset:32768
 ds_read_b64_tr_b16 v[174:175], v38 offset:32896
 ds_read_b64_tr_b16 v[176:177], v38 offset:34816
 ds_read_b64_tr_b16 v[178:179], v38 offset:34944
 ds_read_b64_tr_b16 v[180:181], v38 offset:36864
 ds_read_b64_tr_b16 v[182:183], v38 offset:36992
 ds_read_b64_tr_b16 v[184:185], v38 offset:38912
 ds_read_b64_tr_b16 v[186:187], v38 offset:39040
 s_waitcnt lgkmcnt(0)
 ds_read_b64_tr_b16 v[188:189], v38 offset:40960
 ds_read_b64_tr_b16 v[190:191], v38 offset:41088
 ds_read_b64_tr_b16 v[192:193], v38 offset:43008
 ds_read_b64_tr_b16 v[194:195], v38 offset:43136
 ds_read_b64_tr_b16 v[196:197], v38 offset:45056
 ds_read_b64_tr_b16 v[198:199], v38 offset:45184
 ds_read_b64_tr_b16 v[200:201], v38 offset:47104
 ds_read_b64_tr_b16 v[202:203], v38 offset:47232
 s_waitcnt lgkmcnt(0)
 ds_read_b64_tr_b16 v[204:205], v38 offset:49152
 ds_read_b64_tr_b16 v[206:207], v38 offset:49280
 ds_read_b64_tr_b16 v[208:209], v38 offset:51200
 ds_read_b64_tr_b16 v[210:211], v38 offset:51328
 ds_read_b64_tr_b16 v[212:213], v38 offset:53248
 ds_read_b64_tr_b16 v[214:215], v38 offset:53376
 ds_read_b64_tr_b16 v[216:217], v38 offset:55296
 ds_read_b64_tr_b16 v[218:219], v38 offset:55424
 s_waitcnt lgkmcnt(0)
 ds_read_b64_tr_b16 v[220:221], v38 offset:57344
 ds_read_b64_tr_b16 v[222:223], v38 offset:57472
 ds_read_b64_tr_b16 v[224:225], v38 offset:59392
 ds_read_b64_tr_b16 v[226:227], v38 offset:59520
 ds_read_b64_tr_b16 v[228:229], v38 offset:61440
 ds_read_b64_tr_b16 v[230:231], v38 offset:61568
 ds_read_b64_tr_b16 v[232:233], v38 offset:63488
 ds_read_b64_tr_b16 v[234:235], v38 offset:63616
 s_waitcnt lgkmcnt(0)
 s_barrier
 v_mov_b32 v39, 0
 v_mov_b32 v40, 0
 v_mov_b32 v41, 0
 s_mov_b32 s3, 0
L_rdy_9:
 buffer_load_dwordx4 v[88:91], off, s[12:15], s30 sc1
 s_add_u32 s3, s3, 1
 s_cmp_gt_u32 s3, 400000
 s_cbranch_scc1 L_exit
 s_waitcnt vmcnt(0)
 v_readfirstlane_b32 s32, v88
 v_readfirstlane_b32 s33, v89
 v_readfirstlane_b32 vcc_hi, v90
 s_and_b32 vcc_lo, s32, 0xffff
 s_cmp_lt_u32 vcc_lo, 256
 s_cbranch_scc1 L_rdy_9
 s_cmp_lg_u32 vcc_hi, 0
 s_cbranch_scc1 L_general
 s_mov_b32 s55, 63
 s_lshr_b32 s56, s55, 3
 s_lshr_b32 s56, s27, s56
 s_and_b32 s56, s56, 1
 s_lshl_b32 s56, s56, 13
 s_lshl_b32 s68, s55, 18
 s_add_u32 s68, s68, s56
 s_add_u32 s68, s68, 134217728
 s_add_u32 s69, s69, s68
 s_add_u32 s70, s70, s68
 s_add_u32 s71, s71, s68
 s_add_u32 s72, s72, s68
 s_mov_b32 s48, 0
 s_mov_b32 s49, s63
 s_lshl_b32 s55, s24, 5
 s_add_u32 s55, s55, s25
 s_lshl_b32 s53, s55, 11
 s_add_u32 s53, s53, 16777216
 s_lshl_b32 s54, s55, 9
 s_add_u32 s54, s54, 4194304
 s_mov_b32 s58, 0
 s_mov_b32 s36, 0
 s_mov_b32 s37, 0
 s_mov_b32 s38, 0
 s_mov_b32 s39, 0
 s_cmp_eq_u32 s26, 1
 s_cbranch_scc1 L_cg_w1
 s_cmp_eq_u32 s26, 2
 s_cbranch_scc1 L_cg_w2
 s_cmp_eq_u32 s26, 3
 s_cbranch_scc1 L_cg_w3
L_cg_w0:
 v_mov_b32 v205, 0
 v_mov_b32 v207, 0
 v_mov_b32 v209, 0
 v_mov_b32 v56, 0
 v_mov_b32 v57, 0
 v_mov_b32 v58, 0
 v_mov_b32 v59, 0
 v_mov_b32 v60, 0
 v_mov_b32 v61, 0
 v_mov_b32 v62, 0
 v_mov_b32 v63, 0
 v_mov_b32 v64, 0
 v_mov_b32 v65, 0
 v_mov_b32 v66, 0
 v_mov_b32 v67, 0
 v_mov_b32 v68, 0
 v_mov_b32 v69, 0
 v_mov_b32 v70, 0
 v_mov_b32 v71, 0
 v_mov_b32 v72, 0
 v_mov_b32 v73, 0
 v_mov_b32 v74, 0
 v_mov_b32 v75, 0
 v_mov_b32 v76, 0
 v_mov_b32 v77, 0
 v_mov_b32 v78, 0
 v_mov_b32 v79, 0
 s_waitcnt vmcnt(0)
 s_barrier
 buffer_load_dwordx4 v[92:95], v6, s[4:7], s49 offen offset:0 sc1
 s_nop 3
 buffer_load_dwordx4 v[96:99], v6, s[4:7], s49 offen offset:1024 sc1
 s_nop 3
 buffer_load_dwordx4 v[100:103], v6, s[4:7], s49 offen offset:2048 sc1
 s_nop 3
 buffer_load_dwordx4 v[104:107], v6, s[4:7], s49 offen offset:3072 sc1
L_cg_w0_loop:
 s_and_b32 s55, s48, 3
 s_add_u32 s50, s49, 262144
 s_lshl_b32 s56, s55, 16
 s_add_u32 s51, s64, s56
 v_add_u32 v30, 1, v30
 ds_read_b128 v[172:175], v17 offset:36864
 ds_read_b128 v[176:179], v17 offset:36928
 ds_read_b128 v[180:183], v18 offset:38912
 ds_read_b128 v[184:187], v18 offset:39168
L_cg_w0_dtry:
 s_waitcnt vmcnt(3)
 v_smfmac_f32_16x16x64_bf16 v[56:59], v[92:95], a[0:7], v5
 v_smfmac_f32_16x16x64_bf16 v[60:63], v[92:95], a[8:15], v5
 v_smfmac_f32_16x16x64_bf16 v[64:67], v[92:95], a[16:23], v5
 v_smfmac_f32_16x16x64_bf16 v[68:71], v[92:95], a[24:31], v5
 s_waitcnt vmcnt(2)
 v_smfmac_f32_16x16x64_bf16 v[56:59], v[96:99], a[48:55], v5
 v_smfmac_f32_16x16x64_bf16 v[60:63], v[96:99], a[56:63], v5
 v_smfmac_f32_16x16x64_bf16 v[64:67], v[96:99], a[64:71], v5
 v_smfmac_f32_16x16x64_bf16 v[68:71], v[96:99], a[72:79], v5
 s_waitcnt vmcnt(1)
 v_smfmac_f32_16x16x64_bf16 v[56:59], v[100:103], a[96:103], v5
 v_smfmac_f32_16x16x64_bf16 v[60:63], v[100:103], a[104:111], v5
 v_smfmac_f32_16x16x64_bf16 v[64:67], v[100:103], a[112:119], v5
 v_smfmac_f32_16x16x64_bf16 v[68:71], v[100:103], a[120:127], v5
 s_waitcnt vmcnt(0)
 v_smfmac_f32_16x16x64_bf16 v[56:59], v[104:107], a[144:151], v5
 v_smfmac_f32_16x16x64_bf16 v[60:63], v[104:107], a[152:159], v5
 v_smfmac_f32_16x16x64_bf16 v[64:67], v[104:107], a[160:167], v5
 v_smfmac_f32_16x16x64_bf16 v[68:71], v[104:107], a[168:175], v5
 s_nop 4
 v_pk_add_f32 v[84:85], v[56:57], v[58:59]
 ds_write2_b32 v7, v84, v85 offset0:0 offset1:36
 v_cmp_u_f32 vcc, v84, v85
 v_pk_add_f32 v[86:87], v[60:61], v[62:63]
 ds_write2_b32 v7, v86, v87 offset0:16 offset1:52
 v_pk_add_f32 v[88:89], v[64:65], v[66:67]
 ds_write2_b32 v8, v88, v89 offset0:0 offset1:36
 v_pk_add_f32 v[90:91], v[68:69], v[70:71]
 ds_write2_b32 v8, v90, v91 offset0:16 offset1:52
 s_cbranch_vccnz L_cg_w0_dslow
L_cg_w0_dgood:
 v_smfmac_f32_16x16x64_bf16 v[72:75], v[92:95], a[32:39], v5
 v_smfmac_f32_16x16x64_bf16 v[76:79], v[92:95], a[40:47], v5
 v_smfmac_f32_16x16x64_bf16 v[72:75], v[96:99], a[80:87], v5
 v_smfmac_f32_16x16x64_bf16 v[76:79], v[96:99], a[88:95], v5
 s_waitcnt lgkmcnt(0)
 s_barrier
 ds_read_b128 v[108:111], v9 offset:4096
 ds_read_b128 v[112:115], v9 offset:4112
 ds_read_b128 v[116:119], v9 offset:6400
 ds_read_b128 v[120:123], v9 offset:6416
 ds_read_b128 v[124:127], v9 offset:8704
 ds_read_b128 v[128:131], v9 offset:8720
 ds_read_b128 v[132:135], v9 offset:11008
 ds_read_b128 v[136:139], v9 offset:11024
 v_smfmac_f32_16x16x64_bf16 v[72:75], v[100:103], a[128:135], v5
 s_waitcnt lgkmcnt(6)
 v_pk_mul_f32 v[108:109], v[108:109], v[54:55] op_sel_hi:[1,0]
 v_pk_mul_f32 v[110:111], v[110:111], v[54:55] op_sel_hi:[1,0]
 v_pk_mul_f32 v[112:113], v[112:113], v[54:55] op_sel_hi:[1,0]
 v_pk_mul_f32 v[114:115], v[114:115], v[54:55] op_sel_hi:[1,0]
 s_waitcnt lgkmcnt(4)
 v_pk_fma_f32 v[108:109], v[116:117], v[54:55], v[108:109] op_sel_hi:[1,0,1]
 v_pk_fma_f32 v[110:111], v[118:119], v[54:55], v[110:111] op_sel_hi:[1,0,1]
 v_pk_fma_f32 v[112:113], v[120:121], v[54:55], v[112:113] op_sel_hi:[1,0,1]
 v_pk_fma_f32 v[114:115], v[122:123], v[54:55], v[114:115] op_sel_hi:[1,0,1]
 s_waitcnt lgkmcnt(2)
 v_pk_fma_f32 v[108:109], v[124:125], v[54:55], v[108:109] op_sel_hi:[1,0,1]
 v_pk_fma_f32 v[110:111], v[126:127], v[54:55], v[110:111] op_sel_hi:[1,0,1]
 v_pk_fma_f32 v[112:113], v[128:129], v[54:55], v[112:113] op_sel_hi:[1,0,1]
 v_pk_fma_f32 v[114:115], v[130:131], v[54:55], v[114:115] op_sel_hi:[1,0,1]
 s_waitcnt lgkmcnt(0)
 v_pk_fma_f32 v[108:109], v[132:133], v[54:55], v[108:109] op_sel_hi:[1,0,1]
 v_pk_fma_f32 v[110:111], v[134:135], v[54:55], v[110:111] op_sel_hi:[1,0,1]
 v_pk_fma_f32 v[112:113], v[136:137], v[54:55], v[112:113] op_sel_hi:[1,0,1]
 v_pk_fma_f32 v[114:115], v[138:139], v[54:55], v[114:115] op_sel_hi:[1,0,1]
 v_cvt_pk_bf16_f32 v188, v108, v109
 v_cvt_pk_bf16_f32 v189, v110, v111
 v_cvt_pk_bf16_f32 v190, v112, v113
 v_cvt_pk_bf16_f32 v191, v114, v115
 s_nop 1
 v_mfma_f32_16x16x32_bf16 v[192:195], v[172:175], v[188:191], 0
 v_mfma_f32_16x16x32_bf16 v[196:199], v[176:179], v[188:191], 0
 v_mfma_f32_16x16x32_bf16 v[200:203], v[188:191], v[188:191], 0
 s_nop 5
 buffer_store_dwordx4 v[192:195], v11, s[4:7], s51 offen sc1
 buffer_store_dwordx4 v[196:199], v11, s[4:7], s51 offen offset:128 sc1
 buffer_store_dwordx4 v[200:203], v12, s[4:7], s51 offen sc1
 v_smfmac_f32_16x16x64_bf16 v[76:79], v[100:103], a[136:143], v5
 v_smfmac_f32_16x16x64_bf16 v[72:75], v[104:107], a[176:183], v5
 v_smfmac_f32_16x16x64_bf16 v[76:79], v[104:107], a[184:191], v5
 s_barrier
 buffer_load_dwordx4 v[108:111], v47, s[4:7], s51 offen sc1
 buffer_load_dwordx4 v[112:115], v48, s[4:7], s51 offen sc1
 buffer_load_dwordx4 v[116:119], v49, s[4:7], s51 offen sc1
 buffer_load_dword v120, v13, s[4:7], s51 offen offset:0 sc1
 buffer_load_dword v121, v13, s[4:7], s51 offen offset:1280 sc1
 buffer_load_dword v122, v13, s[4:7], s51 offen offset:2560 sc1
 buffer_load_dword v123, v13, s[4:7], s51 offen offset:3840 sc1
 ds_read_b128 v[124:127], v2 offset:15360
 ds_read_b128 v[128:131], v2 offset:16384
 ds_read_b128 v[132:135], v2 offset:17408
 v_pk_add_f32 v[84:85], v[72:73], v[74:75]
 v_pk_add_f32 v[86:87], v[76:77], v[78:79]
 v_mov_b32_dpp v192, v196 row_ror:8 row_mask:0xf bank_mask:0xc
 v_mov_b32_dpp v193, v197 row_ror:8 row_mask:0xf bank_mask:0xc
 v_mov_b32_dpp v194, v198 row_ror:8 row_mask:0xf bank_mask:0xc
 v_mov_b32_dpp v195, v199 row_ror:8 row_mask:0xf bank_mask:0xc
 s_waitcnt lgkmcnt(2)
 v_pk_add_f32 v[84:85], v[84:85], v[124:125]
 v_pk_add_f32 v[86:87], v[86:87], v[126:127]
 s_waitcnt lgkmcnt(1)
 v_pk_add_f32 v[84:85], v[84:85], v[128:129]
 v_pk_add_f32 v[86:87], v[86:87], v[130:131]
 s_waitcnt lgkmcnt(0)
 v_pk_add_f32 v[84:85], v[84:85], v[132:133]
 v_pk_add_f32 v[86:87], v[86:87], v[134:135]
 v_cvt_pk_bf16_f32 v206, v84, v85
 v_cvt_pk_bf16_f32 v208, v86, v87
 s_cmp_eq_u32 s48, 63
 s_cbranch_scc1 L_cg_w0_done
L_cg_w0_atry:
 s_waitcnt vmcnt(6)
 v_pk_add_f32 v[230:231], v[192:193], v[108:109]
 v_pk_add_f32 v[232:233], v[194:195], v[110:111]
 s_waitcnt vmcnt(5)
 v_pk_add_f32 v[230:231], v[230:231], v[112:113]
 v_pk_add_f32 v[232:233], v[232:233], v[114:115]
 s_waitcnt vmcnt(4)
 v_pk_add_f32 v[230:231], v[230:231], v[116:117]
 v_pk_add_f32 v[232:233], v[232:233], v[118:119]
 v_maximum3_f32 v36, |v230|, |v231|, |v232|
 s_waitcnt vmcnt(0)
 v_pk_add_f32 v[234:235], v[120:121], v[122:123]
 v_add_f32 v234, v234, v235
 v_maximum3_f32 v36, v36, |v233|, |v234|
 v_cmp_ngt_f32 vcc, s62, v36
 v_exp_f32 v214, v230
 v_exp_f32 v215, v231
 v_exp_f32 v216, v232
 v_exp_f32 v217, v233
 v_exp_f32 v136, v234
 s_cbranch_vccnz L_cg_w0_abad
L_cg_w0_agood:
 buffer_store_dword v30, v25, s[4:7], s65 offen sc1
 v_cvt_pk_bf16_f32 v210, v214, v215
 v_cvt_pk_bf16_f32 v211, v216, v217
 v_mov_b32_dpp v138, v136 row_ror:8 row_mask:0xf bank_mask:0xf
 v_mov_b32_dpp v212, v210 row_ror:8 row_mask:0xf bank_mask:0xf
 v_mov_b32_dpp v213, v211 row_ror:8 row_mask:0xf bank_mask:0xf
 v_cvt_pk_bf16_f32 v204, v136, v138
 v_pk_add_f32 v[214:215], v[214:215], v[216:217]
 v_mfma_f32_16x16x32_bf16 v[218:221], v[180:183], v[210:213], 0
 v_add_f32 v137, v214, v215
 v_add_f32 v137, v137, v136
 v_mfma_f32_16x16x32_bf16 v[222:225], v[184:187], v[210:213], 0
 s_nop 0
 v_add_f32_dpp v138, v137, v137 row_ror:8 row_mask:0xf bank_mask:0xf
 v_add_f32_dpp v139, v137, v137 row_ror:8 row_mask:0xf bank_mask:0xf
 v_mfma_f32_16x16x16_bf16 v[218:221], v[206:207], v[204:205], v[218:221]
 s_nop 0
 v_permlane16_swap_b32 v138, v139
 v_mfma_f32_16x16x16_bf16 v[222:225], v[208:209], v[204:205], v[222:225]
 v_add_f32 v137, v138, v139
 v_add_f32 v138, v138, v139
 s_nop 1
 v_permlane32_swap_b32 v137, v138
 s_nop 0
 v_add_f32 v137, v137, v138
 v_rcp_f32 v214, v137
 s_mov_b32 m0, 20480
 v_pk_mul_f32 v[218:219], v[218:219], v[214:215] op_sel_hi:[1,0]
 v_pk_mul_f32 v[220:221], v[220:221], v[214:215] op_sel_hi:[1,0]
 v_pk_mul_f32 v[222:223], v[222:223], v[214:215] op_sel_hi:[1,0]
 v_pk_mul_f32 v[224:225], v[224:225], v[214:215] op_sel_hi:[1,0]
 v_cvt_pk_bf16_f32 v226, v218, v219
 v_cvt_pk_bf16_f32 v227, v220, v221
 v_cvt_pk_bf16_f32 v228, v222, v223
 v_cvt_pk_bf16_f32 v229, v224, v225
 buffer_store_dwordx4 v[226:229], v14, s[4:7], s50 offen sc1
 s_barrier
 buffer_load_dwordx4 v6, s[4:7], s50 offen offset:0 sc1 lds
 s_nop 3
 buffer_load_dwordx4 v6, s[4:7], s50 offen offset:1024 sc1 lds
 s_nop 3
 buffer_load_dwordx4 v6, s[4:7], s50 offen offset:2048 sc1 lds
 s_nop 3
 buffer_load_dwordx4 v6, s[4:7], s50 offen offset:3072 sc1 lds
 s_add_u32 s48, s48, 1
 s_and_b32 s57, s48, 3
 s_lshl_b32 s57, s57, 14
 s_add_u32 s49, s63, s57
 v_mov_b32 v56, 0
 v_mov_b32 v57, 0
 v_mov_b32 v58, 0
 v_mov_b32 v59, 0
 v_mov_b32 v60, 0
 v_mov_b32 v61, 0
 v_mov_b32 v62, 0
 v_mov_b32 v63, 0
 v_mov_b32 v64, 0
 v_mov_b32 v65, 0
 v_mov_b32 v66, 0
 v_mov_b32 v67, 0
 v_mov_b32 v68, 0
 v_mov_b32 v69, 0
 v_mov_b32 v70, 0
 v_mov_b32 v71, 0
 v_mov_b32 v72, 0
 v_mov_b32 v73, 0
 v_mov_b32 v74, 0
 v_mov_b32 v75, 0
 v_mov_b32 v76, 0
 v_mov_b32 v77, 0
 v_mov_b32 v78, 0
 v_mov_b32 v79, 0
 s_add_u32 s57, s54, 4194304
 s_waitcnt vmcnt(3)
 s_barrier
 s_waitcnt vmcnt(2)
 s_barrier
 buffer_store_dwordx4 v[188:191], v19, s[4:7], s54 offen sc1
 s_waitcnt vmcnt(2)
 s_barrier
 buffer_store_dword v206, v4, s[4:7], s57 offen sc1
 buffer_store_dword v208, v4, s[4:7], s57 offen offset:256 sc1
 s_load_dwordx4 s[36:39], s[4:5], s69 glc
 s_waitcnt vmcnt(3)
 s_barrier
 s_add_u32 s54, s54, 0x10000
L_cg_w0_cpoll:
 s_load_dwordx4 s[36:39], s[4:5], s69 glc
 s_min_u32 s55, s36, s37
 s_min_u32 s55, s55, s38
 s_cmp_ge_u32 s55, s48
 s_cbranch_scc1 L_cg_w0_cgo
 s_min_u32 s55, s36, s37
 s_min_u32 s55, s55, s38
 s_cmp_ge_u32 s55, s48
 s_cbranch_scc1 L_cg_w0_cgo
 s_min_u32 s55, s36, s37
 s_min_u32 s55, s55, s38
 s_cmp_ge_u32 s55, s48
 s_cbranch_scc1 L_cg_w0_cgo
 s_waitcnt lgkmcnt(8)
 s_add_u32 s58, s58, 1
 s_cmp_lt_u32 s58, 400000
 s_cbranch_scc1 L_cg_w0_cpoll
 s_branch L_done
L_cg_w0_cgo:
L_cg_w0_bjoin:
 s_barrier
 v_mov_b32 v32, 1
 ds_read_b32 v32, v37 offset:19456
L_cg_w0_fspin:
 v_cmp_eq_u32 vcc, 1, v32
 s_cbranch_vccnz L_cg_w0_fspin
 v_cmp_ne_u32 vcc, 0, v32
 s_cbranch_vccnz L_cg_w0_bretry
 s_add_u32 s56, s73, 4096
 s_waitcnt vmcnt(0)
 s_atomic_umax s48, s[4:5], s56
 s_barrier
 buffer_load_dwordx4 v[92:95], v6, s[4:7], s49 offen offset:0 sc1
 s_nop 3
 buffer_load_dwordx4 v[96:99], v6, s[4:7], s49 offen offset:1024 sc1
 s_nop 3
 buffer_load_dwordx4 v[100:103], v6, s[4:7], s49 offen offset:2048 sc1
 s_nop 3
 buffer_load_dwordx4 v[104:107], v6, s[4:7], s49 offen offset:3072 sc1
 s_branch L_cg_w0_loop
L_cg_w0_dslow:
 v_max_u32 v36, v92, v93
 v_max3_u32 v36, v36, v94, v95
 v_max3_u32 v36, v36, v96, v97
 v_max3_u32 v36, v36, v98, v99
 v_max3_u32 v36, v36, v100, v101
 v_max3_u32 v36, v36, v102, v103
 v_max3_u32 v36, v36, v104, v105
 v_max3_u32 v36, v36, v106, v107
 v_cmp_eq_u32 vcc, -1, v36
 s_cbranch_vccz L_cg_w0_dgood
L_cg_w0_dagain:
 buffer_load_dwordx4 v[92:95], v6, s[4:7], s49 offen offset:0 sc1
 buffer_load_dwordx4 v[96:99], v6, s[4:7], s49 offen offset:1024 sc1
 buffer_load_dwordx4 v[100:103], v6, s[4:7], s49 offen offset:2048 sc1
 buffer_load_dwordx4 v[104:107], v6, s[4:7], s49 offen offset:3072 sc1
 v_mov_b32 v56, 0
 v_mov_b32 v57, 0
 v_mov_b32 v58, 0
 v_mov_b32 v59, 0
 v_mov_b32 v60, 0
 v_mov_b32 v61, 0
 v_mov_b32 v62, 0
 v_mov_b32 v63, 0
 v_mov_b32 v64, 0
 v_mov_b32 v65, 0
 v_mov_b32 v66, 0
 v_mov_b32 v67, 0
 v_mov_b32 v68, 0
 v_mov_b32 v69, 0
 v_mov_b32 v70, 0
 v_mov_b32 v71, 0
 s_add_u32 s58, s58, 1
 s_cmp_gt_u32 s58, 400000
 s_cbranch_scc1 L_done
 s_waitcnt vmcnt(0)
 v_max_u32 v36, v92, v93
 v_max3_u32 v36, v36, v94, v95
 v_max3_u32 v36, v36, v96, v97
 v_max3_u32 v36, v36, v98, v99
 v_max3_u32 v36, v36, v100, v101
 v_max3_u32 v36, v36, v102, v103
 v_max3_u32 v36, v36, v104, v105
 v_max3_u32 v36, v36, v106, v107
 v_cmp_eq_u32 vcc, -1, v36
 s_cbranch_vccnz L_cg_w0_dagain
 s_branch L_cg_w0_dtry
L_cg_w0_bretry:
 s_add_u32 s58, s58, 1
 s_cmp_gt_u32 s58, 400000
 s_cbranch_scc1 L_done
 s_mov_b32 m0, 20480
 s_nop 0
 buffer_load_dwordx4 v6, s[4:7], s50 offen offset:0 sc1 lds
 s_nop 3
 buffer_load_dwordx4 v6, s[4:7], s50 offen offset:1024 sc1 lds
 s_nop 3
 buffer_load_dwordx4 v6, s[4:7], s50 offen offset:2048 sc1 lds
 s_nop 3
 buffer_load_dwordx4 v6, s[4:7], s50 offen offset:3072 sc1 lds
 s_waitcnt vmcnt(3)
 s_barrier
 s_waitcnt vmcnt(2)
 s_barrier
 s_waitcnt vmcnt(1)
 s_barrier
 s_waitcnt vmcnt(0)
 s_barrier
 s_branch L_cg_w0_bjoin
L_cg_w0_abad:
 v_max3_u32 v36, v120, v121, v122
 v_max_u32 v36, v36, v123
 v_max3_u32 v36, v36, v108, v109
 v_max3_u32 v36, v36, v110, v111
 v_max3_u32 v36, v36, v112, v113
 v_max3_u32 v36, v36, v114, v115
 v_max3_u32 v36, v36, v116, v117
 v_max3_u32 v36, v36, v118, v119
 v_cmp_eq_u32 vcc, -1, v36
 buffer_load_dwordx4 v[108:111], v47, s[4:7], s51 offen sc1
 buffer_load_dwordx4 v[112:115], v48, s[4:7], s51 offen sc1
 buffer_load_dwordx4 v[116:119], v49, s[4:7], s51 offen sc1
 buffer_load_dword v120, v13, s[4:7], s51 offen offset:0 sc1
 buffer_load_dword v121, v13, s[4:7], s51 offen offset:1280 sc1
 buffer_load_dword v122, v13, s[4:7], s51 offen offset:2560 sc1
 buffer_load_dword v123, v13, s[4:7], s51 offen offset:3840 sc1
 s_add_u32 s58, s58, 1
 s_cmp_gt_u32 s58, 400000
 s_cbranch_scc1 L_done
 s_cbranch_vccnz L_cg_w0_atry
 v_max3_f32 v36, v230, v231, v232
 v_max3_f32 v36, v36, v233, v234
 s_nop 1
 v_max_f32_dpp v138, v36, v36 row_ror:8 row_mask:0xf bank_mask:0xf
 v_max_f32_dpp v139, v36, v36 row_ror:8 row_mask:0xf bank_mask:0xf
 s_nop 1
 v_permlane16_swap_b32 v138, v139
 s_nop 1
 v_max_f32 v36, v138, v139
 v_max_f32 v138, v138, v139
 s_nop 1
 v_permlane32_swap_b32 v36, v138
 s_nop 1
 v_max_f32 v36, v36, v138
 v_sub_f32 v230, v230, v36
 v_sub_f32 v231, v231, v36
 v_sub_f32 v232, v232, v36
 v_sub_f32 v233, v233, v36
 v_sub_f32 v234, v234, v36
 v_exp_f32 v214, v230
 v_exp_f32 v215, v231
 v_exp_f32 v216, v232
 v_exp_f32 v217, v233
 v_exp_f32 v136, v234
 s_branch L_cg_w0_agood
L_cg_w0_done:
 s_add_u32 s55, s54, 4194304
 buffer_store_dwordx4 v[188:191], v19, s[4:7], s54 offen sc1
 buffer_store_dword v206, v4, s[4:7], s55 offen sc1
 buffer_store_dword v208, v4, s[4:7], s55 offen offset:256 sc1
 s_waitcnt vmcnt(0)
 buffer_store_dword v30, v42, s[4:7], 0 offen sc1
 s_waitcnt vmcnt(0) lgkmcnt(0)
 s_branch L_conv_back
L_cg_w1:
 s_mov_b32 s75, 0
 s_mov_b32 s76, 0
L_cg_w1_kv0:
 s_min_u32 s55, s75, s76
 s_cmp_gt_u32 s55, 0
 s_cbranch_scc1 L_cg_w1_kv0_ok
 s_load_dword s75, s[4:5], s73 glc
 s_load_dword s76, s[4:5], s74 glc
 s_add_u32 s58, s58, 1
 s_cmp_gt_u32 s58, 400000
 s_cbranch_scc1 L_done
 s_waitcnt lgkmcnt(0)
 s_branch L_cg_w1_kv0
L_cg_w1_kv0_ok:
 s_mov_b32 m0, 36864
 s_add_u32 s55, s53, 16775168
 buffer_load_dwordx4 v2, s[4:7], s53 offen sc1 lds
 buffer_load_dwordx4 v2, s[4:7], s53 offen offset:1024 sc1 lds
 buffer_load_dwordx4 v2, s[4:7], s55 offen offset:2048 sc1 lds
 buffer_load_dwordx4 v2, s[4:7], s55 offen offset:3072 sc1 lds
 v_mov_b32 v56, 0
 v_mov_b32 v57, 0
 v_mov_b32 v58, 0
 v_mov_b32 v59, 0
 v_mov_b32 v60, 0
 v_mov_b32 v61, 0
 v_mov_b32 v62, 0
 v_mov_b32 v63, 0
 v_mov_b32 v64, 0
 v_mov_b32 v65, 0
 v_mov_b32 v66, 0
 v_mov_b32 v67, 0
 v_mov_b32 v68, 0
 v_mov_b32 v69, 0
 v_mov_b32 v70, 0
 v_mov_b32 v71, 0
 v_mov_b32 v72, 0
 v_mov_b32 v73, 0
 v_mov_b32 v74, 0
 v_mov_b32 v75, 0
 v_mov_b32 v76, 0
 v_mov_b32 v77, 0
 v_mov_b32 v78, 0
 v_mov_b32 v79, 0
 s_waitcnt vmcnt(0)
 s_barrier
 buffer_load_dwordx4 v[96:99], v6, s[4:7], s49 offen offset:1024 sc1
 s_nop 3
 buffer_load_dwordx4 v[92:95], v6, s[4:7], s49 offen offset:0 sc1
 s_nop 3
 buffer_load_dwordx4 v[104:107], v6, s[4:7], s49 offen offset:3072 sc1
 s_nop 3
 buffer_load_dwordx4 v[100:103], v6, s[4:7], s49 offen offset:2048 sc1
L_cg_w1_loop:
 s_and_b32 s55, s48, 3
 s_add_u32 s50, s49, 262144
 s_lshl_b32 s56, s55, 16
 s_add_u32 s51, s64, s56
 v_add_u32 v30, 1, v30
L_cg_w1_dtry:
 s_waitcnt vmcnt(3)
 v_smfmac_f32_16x16x64_bf16 v[56:59], v[96:99], a[48:55], v5
 v_smfmac_f32_16x16x64_bf16 v[60:63], v[96:99], a[56:63], v5
 v_smfmac_f32_16x16x64_bf16 v[64:67], v[96:99], a[64:71], v5
 v_smfmac_f32_16x16x64_bf16 v[68:71], v[96:99], a[72:79], v5
 s_waitcnt vmcnt(2)
 v_smfmac_f32_16x16x64_bf16 v[56:59], v[92:95], a[0:7], v5
 v_smfmac_f32_16x16x64_bf16 v[60:63], v[92:95], a[8:15], v5
 v_smfmac_f32_16x16x64_bf16 v[64:67], v[92:95], a[16:23], v5
 v_smfmac_f32_16x16x64_bf16 v[68:71], v[92:95], a[24:31], v5
 s_waitcnt vmcnt(1)
 v_smfmac_f32_16x16x64_bf16 v[56:59], v[104:107], a[144:151], v5
 v_smfmac_f32_16x16x64_bf16 v[60:63], v[104:107], a[152:159], v5
 v_smfmac_f32_16x16x64_bf16 v[64:67], v[104:107], a[160:167], v5
 v_smfmac_f32_16x16x64_bf16 v[68:71], v[104:107], a[168:175], v5
 s_waitcnt vmcnt(0)
 v_smfmac_f32_16x16x64_bf16 v[56:59], v[100:103], a[96:103], v5
 v_smfmac_f32_16x16x64_bf16 v[60:63], v[100:103], a[104:111], v5
 v_smfmac_f32_16x16x64_bf16 v[64:67], v[100:103], a[112:119], v5
 v_smfmac_f32_16x16x64_bf16 v[68:71], v[100:103], a[120:127], v5
 s_nop 4
 v_pk_add_f32 v[84:85], v[56:57], v[58:59]
 ds_write2_b32 v7, v84, v85 offset0:0 offset1:36
 v_cmp_u_f32 vcc, v84, v85
 v_pk_add_f32 v[86:87], v[60:61], v[62:63]
 ds_write2_b32 v7, v86, v87 offset0:16 offset1:52
 v_pk_add_f32 v[88:89], v[64:65], v[66:67]
 ds_write2_b32 v8, v88, v89 offset0:0 offset1:36
 v_pk_add_f32 v[90:91], v[68:69], v[70:71]
 ds_write2_b32 v8, v90, v91 offset0:16 offset1:52
 s_cbranch_vccnz L_cg_w1_dslow
L_cg_w1_dgood:
 v_smfmac_f32_16x16x64_bf16 v[72:75], v[92:95], a[32:39], v5
 v_smfmac_f32_16x16x64_bf16 v[76:79], v[92:95], a[40:47], v5
 v_smfmac_f32_16x16x64_bf16 v[72:75], v[96:99], a[80:87], v5
 v_smfmac_f32_16x16x64_bf16 v[76:79], v[96:99], a[88:95], v5
 s_waitcnt lgkmcnt(0)
 s_barrier
 v_smfmac_f32_16x16x64_bf16 v[72:75], v[100:103], a[128:135], v5
 v_smfmac_f32_16x16x64_bf16 v[76:79], v[100:103], a[136:143], v5
 v_smfmac_f32_16x16x64_bf16 v[72:75], v[104:107], a[176:183], v5
 v_smfmac_f32_16x16x64_bf16 v[76:79], v[104:107], a[184:191], v5
 buffer_store_dword v30, v27, s[4:7], s65 offen sc1
 s_nop 7
 v_pk_add_f32 v[84:85], v[72:73], v[74:75]
 v_pk_add_f32 v[86:87], v[76:77], v[78:79]
 ds_write_b128 v10, v[84:87] offset:14336
 s_mov_b32 exec_lo, 15
 s_mov_b32 exec_hi, 0
L_cg_w1_apoll:
 v_cmp_gt_u32 vcc, v30, v39
 buffer_load_dword v39, v28, s[4:7], s65 offen sc1
 s_nop 2
 buffer_load_dword v39, v28, s[4:7], s65 offen sc1
 s_cbranch_vccz L_cg_w1_ago
 v_cmp_gt_u32 vcc, v30, v39
 buffer_load_dword v39, v28, s[4:7], s65 offen sc1
 s_nop 2
 buffer_load_dword v39, v28, s[4:7], s65 offen sc1
 s_cbranch_vccz L_cg_w1_ago
 v_cmp_gt_u32 vcc, v30, v39
 buffer_load_dword v39, v28, s[4:7], s65 offen sc1
 s_nop 2
 buffer_load_dword v39, v28, s[4:7], s65 offen sc1
 s_cbranch_vccz L_cg_w1_ago
 v_cmp_gt_u32 vcc, v30, v39
 buffer_load_dword v39, v28, s[4:7], s65 offen sc1
 s_nop 2
 buffer_load_dword v39, v28, s[4:7], s65 offen sc1
 s_cbranch_vccz L_cg_w1_ago
 v_cmp_gt_u32 vcc, v30, v39
 buffer_load_dword v39, v28, s[4:7], s65 offen sc1
 s_nop 2
 buffer_load_dword v39, v28, s[4:7], s65 offen sc1
 s_cbranch_vccz L_cg_w1_ago
 v_cmp_gt_u32 vcc, v30, v39
 buffer_load_dword v39, v28, s[4:7], s65 offen sc1
 s_nop 2
 buffer_load_dword v39, v28, s[4:7], s65 offen sc1
 s_cbranch_vccz L_cg_w1_ago
 v_cmp_gt_u32 vcc, v30, v39
 buffer_load_dword v39, v28, s[4:7], s65 offen sc1
 s_nop 2
 buffer_load_dword v39, v28, s[4:7], s65 offen sc1
 s_cbranch_vccz L_cg_w1_ago
 v_cmp_gt_u32 vcc, v30, v39
 buffer_load_dword v39, v28, s[4:7], s65 offen sc1
 s_nop 2
 buffer_load_dword v39, v28, s[4:7], s65 offen sc1
 s_cbranch_vccz L_cg_w1_ago
 v_cmp_gt_u32 vcc, v30, v39
 buffer_load_dword v39, v28, s[4:7], s65 offen sc1
 s_nop 2
 buffer_load_dword v39, v28, s[4:7], s65 offen sc1
 s_cbranch_vccz L_cg_w1_ago
 v_cmp_gt_u32 vcc, v30, v39
 buffer_load_dword v39, v28, s[4:7], s65 offen sc1
 s_nop 2
 buffer_load_dword v39, v28, s[4:7], s65 offen sc1
 s_cbranch_vccz L_cg_w1_ago
 s_waitcnt vmcnt(36)
 s_add_u32 s58, s58, 1
 s_cmp_lt_u32 s58, 400000
 s_cbranch_scc1 L_cg_w1_apoll
 s_branch L_done
L_cg_w1_ago:
 s_mov_b64 exec, -1
 s_waitcnt lgkmcnt(0)
 s_barrier
 s_cmp_eq_u32 s48, 63
 s_cbranch_scc1 L_cg_w1_done
 s_lshr_b32 s56, s48, 3
 s_lshr_b32 s56, s27, s56
 s_and_b32 s56, s56, 1
 s_lshl_b32 s56, s56, 13
 s_lshl_b32 s52, s48, 18
 s_add_u32 s52, s52, s56
 s_add_u32 s52, s52, 134217728
 s_mov_b32 m0, 24576
 s_add_u32 s57, s48, 4
 s_lshr_b32 s56, s57, 3
 s_lshr_b32 s56, s27, s56
 s_and_b32 s56, s56, 1
 s_lshl_b32 s56, s56, 13
 s_lshl_b32 s61, s57, 18
 s_add_u32 s61, s61, s56
 s_add_u32 s61, s61, 134217728
 s_cmp_gt_u32 s57, 62
 s_cselect_b32 s61, 1073741824, s61
 s_add_u32 s53, s53, 0x40000
 s_add_u32 s57, s48, 1
L_cg_w1_kv:
 s_min_u32 s55, s75, s76
 s_cmp_gt_u32 s55, s57
 s_cbranch_scc1 L_cg_w1_kv_ok
 s_load_dword s75, s[4:5], s73 glc
 s_load_dword s76, s[4:5], s74 glc
 s_add_u32 s58, s58, 1
 s_cmp_gt_u32 s58, 400000
 s_cbranch_scc1 L_done
 s_waitcnt lgkmcnt(0)
 s_branch L_cg_w1_kv
L_cg_w1_kv_ok:
 s_add_u32 s56, s48, 3
 s_min_u32 s56, s56, 63
 s_cmp_gt_u32 s55, s56
 s_cbranch_scc1 L_cg_w1_kvfresh
 s_load_dword s75, s[4:5], s73 glc
 s_load_dword s76, s[4:5], s74 glc
L_cg_w1_kvfresh:
 s_mov_b32 exec_lo, s67
 s_mov_b32 exec_hi, 0
L_cg_w1_bpoll:
 v_cmp_gt_u32 vcc, v30, v40
 buffer_load_dword v40, v26, s[4:7], s65 offen sc1
 s_nop 2
 buffer_load_dword v40, v26, s[4:7], s65 offen sc1
 s_cbranch_vccz L_cg_w1_bgo
 v_cmp_gt_u32 vcc, v30, v40
 buffer_load_dword v40, v26, s[4:7], s65 offen sc1
 s_nop 2
 buffer_load_dword v40, v26, s[4:7], s65 offen sc1
 s_cbranch_vccz L_cg_w1_bgo
 v_cmp_gt_u32 vcc, v30, v40
 buffer_load_dword v40, v26, s[4:7], s65 offen sc1
 s_nop 2
 buffer_load_dword v40, v26, s[4:7], s65 offen sc1
 s_cbranch_vccz L_cg_w1_bgo
 v_cmp_gt_u32 vcc, v30, v40
 buffer_load_dword v40, v26, s[4:7], s65 offen sc1
 s_nop 2
 buffer_load_dword v40, v26, s[4:7], s65 offen sc1
 s_cbranch_vccz L_cg_w1_bgo
 v_cmp_gt_u32 vcc, v30, v40
 buffer_load_dword v40, v26, s[4:7], s65 offen sc1
 s_nop 2
 buffer_load_dword v40, v26, s[4:7], s65 offen sc1
 s_cbranch_vccz L_cg_w1_bgo
 v_cmp_gt_u32 vcc, v30, v40
 buffer_load_dword v40, v26, s[4:7], s65 offen sc1
 s_nop 2
 buffer_load_dword v40, v26, s[4:7], s65 offen sc1
 s_cbranch_vccz L_cg_w1_bgo
 v_cmp_gt_u32 vcc, v30, v40
 buffer_load_dword v40, v26, s[4:7], s65 offen sc1
 s_nop 2
 buffer_load_dword v40, v26, s[4:7], s65 offen sc1
 s_cbranch_vccz L_cg_w1_bgo
 v_cmp_gt_u32 vcc, v30, v40
 buffer_load_dword v40, v26, s[4:7], s65 offen sc1
 s_nop 2
 buffer_load_dword v40, v26, s[4:7], s65 offen sc1
 s_cbranch_vccz L_cg_w1_bgo
 v_cmp_gt_u32 vcc, v30, v40
 buffer_load_dword v40, v26, s[4:7], s65 offen sc1
 s_nop 2
 buffer_load_dword v40, v26, s[4:7], s65 offen sc1
 s_cbranch_vccz L_cg_w1_bgo
 v_cmp_gt_u32 vcc, v30, v40
 buffer_load_dword v40, v26, s[4:7], s65 offen sc1
 s_nop 2
 buffer_load_dword v40, v26, s[4:7], s65 offen sc1
 s_cbranch_vccz L_cg_w1_bgo
 s_waitcnt vmcnt(36)
 s_add_u32 s58, s58, 1
 s_cmp_lt_u32 s58, 400000
 s_cbranch_scc1 L_cg_w1_bpoll
 s_branch L_done
L_cg_w1_bgo:
 s_mov_b64 exec, -1
 s_barrier
 buffer_load_dwordx4 v6, s[4:7], s50 offen offset:1024 sc1 lds
 s_nop 3
 buffer_load_dwordx4 v6, s[4:7], s50 offen offset:0 sc1 lds
 s_nop 3
 buffer_load_dwordx4 v6, s[4:7], s50 offen offset:3072 sc1 lds
 s_nop 3
 buffer_load_dwordx4 v6, s[4:7], s50 offen offset:2048 sc1 lds
 s_add_u32 s48, s48, 1
 s_and_b32 s57, s48, 3
 s_lshl_b32 s57, s57, 14
 s_add_u32 s49, s63, s57
 v_mov_b32 v56, 0
 v_mov_b32 v57, 0
 v_mov_b32 v58, 0
 v_mov_b32 v59, 0
 v_mov_b32 v60, 0
 v_mov_b32 v61, 0
 v_mov_b32 v62, 0
 v_mov_b32 v63, 0
 v_mov_b32 v64, 0
 v_mov_b32 v65, 0
 v_mov_b32 v66, 0
 v_mov_b32 v67, 0
 v_mov_b32 v68, 0
 v_mov_b32 v69, 0
 v_mov_b32 v70, 0
 v_mov_b32 v71, 0
 v_mov_b32 v72, 0
 v_mov_b32 v73, 0
 v_mov_b32 v74, 0
 v_mov_b32 v75, 0
 v_mov_b32 v76, 0
 v_mov_b32 v77, 0
 v_mov_b32 v78, 0
 v_mov_b32 v79, 0
 s_waitcnt vmcnt(3)
 s_barrier
 s_nop 5
 s_atomic_umax s48, s[4:5], s70
 s_atomic_umax s48, s[4:5], s71
 s_atomic_umax s48, s[4:5], s72
 s_waitcnt vmcnt(2)
 s_barrier
 s_nop 1
 s_mov_b32 m0, 36864
 s_add_u32 s55, s53, 16775168
 buffer_load_dwordx4 v2, s[4:7], s53 offen sc1 lds
 buffer_load_dwordx4 v2, s[4:7], s53 offen offset:1024 sc1 lds
 buffer_load_dwordx4 v2, s[4:7], s55 offen offset:2048 sc1 lds
 buffer_load_dwordx4 v2, s[4:7], s55 offen offset:3072 sc1 lds
 s_waitcnt vmcnt(5)
 s_barrier
 buffer_store_dwordx4 v[50:53], v24, s[4:7], s61 offen sc1
 s_waitcnt vmcnt(5)
 s_barrier
L_cg_w1_bjoin:
 s_barrier
 buffer_load_dwordx4 v[108:111], v44, s[4:7], s52 offen sc1
 buffer_load_dwordx4 v[112:115], v45, s[4:7], s52 offen sc1
 buffer_load_dwordx4 v[116:119], v46, s[4:7], s52 offen sc1
 ds_read_b32 v32, v37 offset:19456
 ds_read_b128 v[120:123], v2 offset:18432
 s_waitcnt lgkmcnt(0)
 v_cmp_ne_u32 vcc, 0, v32
 s_cbranch_vccnz L_cg_w1_bretry
 s_waitcnt vmcnt(2)
 buffer_store_dword v30, v25, s[4:7], s66 offen sc1
 v_pk_add_f32 v[124:125], v[120:121], v[108:109]
 v_pk_add_f32 v[126:127], v[122:123], v[110:111]
 s_waitcnt vmcnt(2)
 v_pk_add_f32 v[124:125], v[124:125], v[112:113]
 v_pk_add_f32 v[126:127], v[126:127], v[114:115]
 s_waitcnt vmcnt(1)
 v_pk_add_f32 v[124:125], v[124:125], v[116:117]
 v_pk_add_f32 v[126:127], v[126:127], v[118:119]
 v_cmpx_o_f32 vcc, v124, v125
 v_cmpx_o_f32 vcc, v126, v127
 v_cvt_pk_bf16_f32 v128, v124, v125
 v_cvt_pk_bf16_f32 v129, v126, v127
 buffer_store_dwordx2 v[128:129], v16, s[4:7], s49 offen sc1
 s_cmp_eq_u64 exec, -1
 s_cbranch_scc0 L_cg_w1_cslow
L_cg_w1_cgood:
 s_barrier
 buffer_load_dwordx4 v[96:99], v6, s[4:7], s49 offen offset:1024 sc1
 s_nop 3
 buffer_load_dwordx4 v[92:95], v6, s[4:7], s49 offen offset:0 sc1
 s_nop 3
 buffer_load_dwordx4 v[104:107], v6, s[4:7], s49 offen offset:3072 sc1
 s_nop 3
 buffer_load_dwordx4 v[100:103], v6, s[4:7], s49 offen offset:2048 sc1
 s_branch L_cg_w1_loop
L_cg_w1_dslow:
 v_max_u32 v36, v92, v93
 v_max3_u32 v36, v36, v94, v95
 v_max3_u32 v36, v36, v96, v97
 v_max3_u32 v36, v36, v98, v99
 v_max3_u32 v36, v36, v100, v101
 v_max3_u32 v36, v36, v102, v103
 v_max3_u32 v36, v36, v104, v105
 v_max3_u32 v36, v36, v106, v107
 v_cmp_eq_u32 vcc, -1, v36
 s_cbranch_vccz L_cg_w1_dgood
L_cg_w1_dagain:
 buffer_load_dwordx4 v[96:99], v6, s[4:7], s49 offen offset:1024 sc1
 buffer_load_dwordx4 v[92:95], v6, s[4:7], s49 offen offset:0 sc1
 buffer_load_dwordx4 v[104:107], v6, s[4:7], s49 offen offset:3072 sc1
 buffer_load_dwordx4 v[100:103], v6, s[4:7], s49 offen offset:2048 sc1
 v_mov_b32 v56, 0
 v_mov_b32 v57, 0
 v_mov_b32 v58, 0
 v_mov_b32 v59, 0
 v_mov_b32 v60, 0
 v_mov_b32 v61, 0
 v_mov_b32 v62, 0
 v_mov_b32 v63, 0
 v_mov_b32 v64, 0
 v_mov_b32 v65, 0
 v_mov_b32 v66, 0
 v_mov_b32 v67, 0
 v_mov_b32 v68, 0
 v_mov_b32 v69, 0
 v_mov_b32 v70, 0
 v_mov_b32 v71, 0
 s_add_u32 s58, s58, 1
 s_cmp_gt_u32 s58, 400000
 s_cbranch_scc1 L_done
 s_waitcnt vmcnt(0)
 v_max_u32 v36, v92, v93
 v_max3_u32 v36, v36, v94, v95
 v_max3_u32 v36, v36, v96, v97
 v_max3_u32 v36, v36, v98, v99
 v_max3_u32 v36, v36, v100, v101
 v_max3_u32 v36, v36, v102, v103
 v_max3_u32 v36, v36, v104, v105
 v_max3_u32 v36, v36, v106, v107
 v_cmp_eq_u32 vcc, -1, v36
 s_cbranch_vccnz L_cg_w1_dagain
 s_branch L_cg_w1_dtry
L_cg_w1_bretry:
 s_add_u32 s58, s58, 1
 s_cmp_gt_u32 s58, 400000
 s_cbranch_scc1 L_done
 s_mov_b32 m0, 24576
 s_nop 0
 buffer_load_dwordx4 v6, s[4:7], s50 offen offset:1024 sc1 lds
 s_nop 3
 buffer_load_dwordx4 v6, s[4:7], s50 offen offset:0 sc1 lds
 s_nop 3
 buffer_load_dwordx4 v6, s[4:7], s50 offen offset:3072 sc1 lds
 s_nop 3
 buffer_load_dwordx4 v6, s[4:7], s50 offen offset:2048 sc1 lds
 s_waitcnt vmcnt(3)
 s_barrier
 s_waitcnt vmcnt(2)
 s_barrier
 s_waitcnt vmcnt(1)
 s_barrier
 s_waitcnt vmcnt(0)
 s_barrier
 s_branch L_cg_w1_bjoin
L_cg_w1_cslow:
 s_mov_b64 exec, -1
 v_max_u32 v36, v108, v109
 v_max3_u32 v36, v36, v110, v111
 v_max3_u32 v36, v36, v112, v113
 v_max3_u32 v36, v36, v114, v115
 v_max3_u32 v36, v36, v116, v117
 v_max3_u32 v36, v36, v118, v119
 v_cmp_eq_u32 vcc, -1, v36
 s_cbranch_vccz L_cg_w1_cfull
 buffer_load_dwordx4 v[108:111], v44, s[4:7], s52 offen sc1
 buffer_load_dwordx4 v[112:115], v45, s[4:7], s52 offen sc1
 buffer_load_dwordx4 v[116:119], v46, s[4:7], s52 offen sc1
 s_add_u32 s58, s58, 1
 s_cmp_gt_u32 s58, 400000
 s_cbranch_scc1 L_done
 s_waitcnt vmcnt(2)
 v_pk_add_f32 v[124:125], v[120:121], v[108:109]
 v_pk_add_f32 v[126:127], v[122:123], v[110:111]
 s_waitcnt vmcnt(1)
 v_pk_add_f32 v[124:125], v[124:125], v[112:113]
 v_pk_add_f32 v[126:127], v[126:127], v[114:115]
 s_waitcnt vmcnt(0)
 v_pk_add_f32 v[124:125], v[124:125], v[116:117]
 v_pk_add_f32 v[126:127], v[126:127], v[118:119]
 s_branch L_cg_w1_cslow
L_cg_w1_cfull:
 v_cvt_pk_bf16_f32 v128, v124, v125
 v_cvt_pk_bf16_f32 v129, v126, v127
 buffer_store_dwordx2 v[128:129], v16, s[4:7], s49 offen sc1
 s_branch L_cg_w1_cgood
L_cg_w1_done:
 s_waitcnt vmcnt(0) lgkmcnt(0)
 s_branch L_conv_back
L_cg_w2:
 v_mov_b32 v56, 0
 v_mov_b32 v57, 0
 v_mov_b32 v58, 0
 v_mov_b32 v59, 0
 v_mov_b32 v60, 0
 v_mov_b32 v61, 0
 v_mov_b32 v62, 0
 v_mov_b32 v63, 0
 v_mov_b32 v64, 0
 v_mov_b32 v65, 0
 v_mov_b32 v66, 0
 v_mov_b32 v67, 0
 v_mov_b32 v68, 0
 v_mov_b32 v69, 0
 v_mov_b32 v70, 0
 v_mov_b32 v71, 0
 v_mov_b32 v72, 0
 v_mov_b32 v73, 0
 v_mov_b32 v74, 0
 v_mov_b32 v75, 0
 v_mov_b32 v76, 0
 v_mov_b32 v77, 0
 v_mov_b32 v78, 0
 v_mov_b32 v79, 0
 s_waitcnt vmcnt(0)
 s_barrier
 buffer_load_dwordx4 v[100:103], v6, s[4:7], s49 offen offset:2048 sc1
 s_nop 3
 buffer_load_dwordx4 v[104:107], v6, s[4:7], s49 offen offset:3072 sc1
 s_nop 3
 buffer_load_dwordx4 v[92:95], v6, s[4:7], s49 offen offset:0 sc1
 s_nop 3
 buffer_load_dwordx4 v[96:99], v6, s[4:7], s49 offen offset:1024 sc1
L_cg_w2_loop:
 s_and_b32 s55, s48, 3
 s_add_u32 s50, s49, 262144
 s_lshl_b32 s56, s55, 16
 s_add_u32 s51, s64, s56
 v_add_u32 v30, 1, v30
L_cg_w2_dtry:
 s_waitcnt vmcnt(3)
 v_smfmac_f32_16x16x64_bf16 v[56:59], v[100:103], a[96:103], v5
 v_smfmac_f32_16x16x64_bf16 v[60:63], v[100:103], a[104:111], v5
 v_smfmac_f32_16x16x64_bf16 v[64:67], v[100:103], a[112:119], v5
 v_smfmac_f32_16x16x64_bf16 v[68:71], v[100:103], a[120:127], v5
 s_waitcnt vmcnt(2)
 v_smfmac_f32_16x16x64_bf16 v[56:59], v[104:107], a[144:151], v5
 v_smfmac_f32_16x16x64_bf16 v[60:63], v[104:107], a[152:159], v5
 v_smfmac_f32_16x16x64_bf16 v[64:67], v[104:107], a[160:167], v5
 v_smfmac_f32_16x16x64_bf16 v[68:71], v[104:107], a[168:175], v5
 s_waitcnt vmcnt(1)
 v_smfmac_f32_16x16x64_bf16 v[56:59], v[92:95], a[0:7], v5
 v_smfmac_f32_16x16x64_bf16 v[60:63], v[92:95], a[8:15], v5
 v_smfmac_f32_16x16x64_bf16 v[64:67], v[92:95], a[16:23], v5
 v_smfmac_f32_16x16x64_bf16 v[68:71], v[92:95], a[24:31], v5
 s_waitcnt vmcnt(0)
 v_smfmac_f32_16x16x64_bf16 v[56:59], v[96:99], a[48:55], v5
 v_smfmac_f32_16x16x64_bf16 v[60:63], v[96:99], a[56:63], v5
 v_smfmac_f32_16x16x64_bf16 v[64:67], v[96:99], a[64:71], v5
 v_smfmac_f32_16x16x64_bf16 v[68:71], v[96:99], a[72:79], v5
 s_nop 4
 v_pk_add_f32 v[84:85], v[56:57], v[58:59]
 ds_write2_b32 v7, v84, v85 offset0:0 offset1:36
 v_cmp_u_f32 vcc, v84, v85
 v_pk_add_f32 v[86:87], v[60:61], v[62:63]
 ds_write2_b32 v7, v86, v87 offset0:16 offset1:52
 v_pk_add_f32 v[88:89], v[64:65], v[66:67]
 ds_write2_b32 v8, v88, v89 offset0:0 offset1:36
 v_pk_add_f32 v[90:91], v[68:69], v[70:71]
 ds_write2_b32 v8, v90, v91 offset0:16 offset1:52
 s_cbranch_vccnz L_cg_w2_dslow
L_cg_w2_dgood:
 v_smfmac_f32_16x16x64_bf16 v[72:75], v[92:95], a[32:39], v5
 v_smfmac_f32_16x16x64_bf16 v[76:79], v[92:95], a[40:47], v5
 v_smfmac_f32_16x16x64_bf16 v[72:75], v[96:99], a[80:87], v5
 v_smfmac_f32_16x16x64_bf16 v[76:79], v[96:99], a[88:95], v5
 s_waitcnt lgkmcnt(0)
 s_barrier
 v_smfmac_f32_16x16x64_bf16 v[72:75], v[100:103], a[128:135], v5
 v_smfmac_f32_16x16x64_bf16 v[76:79], v[100:103], a[136:143], v5
 v_smfmac_f32_16x16x64_bf16 v[72:75], v[104:107], a[176:183], v5
 v_smfmac_f32_16x16x64_bf16 v[76:79], v[104:107], a[184:191], v5
 s_nop 7
 v_pk_add_f32 v[84:85], v[72:73], v[74:75]
 v_pk_add_f32 v[86:87], v[76:77], v[78:79]
 ds_write_b128 v10, v[84:87] offset:14336
 s_waitcnt lgkmcnt(0)
 s_barrier
 s_cmp_eq_u32 s48, 63
 s_cbranch_scc1 L_cg_w2_done
 s_lshr_b32 s56, s48, 3
 s_lshr_b32 s56, s27, s56
 s_and_b32 s56, s56, 1
 s_lshl_b32 s56, s56, 13
 s_lshl_b32 s52, s48, 18
 s_add_u32 s52, s52, s56
 s_add_u32 s52, s52, 134217728
 s_mov_b32 m0, 28672
 v_mov_b32 v80, 0
 v_mov_b32 v81, 0
 v_mov_b32 v82, 0
 v_mov_b32 v83, 0
 s_barrier
 buffer_load_dwordx4 v6, s[4:7], s50 offen offset:2048 sc1 lds
 s_nop 3
 buffer_load_dwordx4 v6, s[4:7], s50 offen offset:3072 sc1 lds
 s_nop 3
 buffer_load_dwordx4 v6, s[4:7], s50 offen offset:0 sc1 lds
 s_nop 3
 buffer_load_dwordx4 v6, s[4:7], s50 offen offset:1024 sc1 lds
 s_add_u32 s48, s48, 1
 s_and_b32 s57, s48, 3
 s_lshl_b32 s57, s57, 14
 s_add_u32 s49, s63, s57
 v_mov_b32 v56, 0
 v_mov_b32 v57, 0
 v_mov_b32 v58, 0
 v_mov_b32 v59, 0
 v_mov_b32 v60, 0
 v_mov_b32 v61, 0
 v_mov_b32 v62, 0
 v_mov_b32 v63, 0
 v_mov_b32 v64, 0
 v_mov_b32 v65, 0
 v_mov_b32 v66, 0
 v_mov_b32 v67, 0
 v_mov_b32 v68, 0
 v_mov_b32 v69, 0
 v_mov_b32 v70, 0
 v_mov_b32 v71, 0
 v_mov_b32 v72, 0
 v_mov_b32 v73, 0
 v_mov_b32 v74, 0
 v_mov_b32 v75, 0
 v_mov_b32 v76, 0
 v_mov_b32 v77, 0
 v_mov_b32 v78, 0
 v_mov_b32 v79, 0
L_cg_w2_bwait:
 s_waitcnt vmcnt(3)
 s_barrier
 ds_read_b128 v[108:111], v20 offset:20480
 ds_read_b128 v[128:131], v20 offset:25600
 ds_read_b128 v[148:151], v20 offset:30720
 ds_read_b128 v[168:171], v20 offset:35840
 s_waitcnt lgkmcnt(3)
 v_smfmac_f32_16x16x64_bf16 v[80:83], v[108:111], a[192:199], v5
 s_waitcnt vmcnt(2)
 s_barrier
 ds_read_b128 v[112:115], v20 offset:21504
 ds_read_b128 v[124:127], v20 offset:24576
 ds_read_b128 v[152:155], v20 offset:31744
 ds_read_b128 v[164:167], v20 offset:34816
 s_waitcnt lgkmcnt(6)
 v_smfmac_f32_16x16x64_bf16 v[80:83], v[128:131], a[216:223], v5
 s_waitcnt lgkmcnt(5)
 v_smfmac_f32_16x16x64_bf16 v[80:83], v[148:151], v[204:211], v5
 s_waitcnt lgkmcnt(4)
 v_smfmac_f32_16x16x64_bf16 v[80:83], v[168:171], v[228:235], v5
 s_waitcnt lgkmcnt(3)
 v_smfmac_f32_16x16x64_bf16 v[80:83], v[112:115], a[200:207], v5
 s_waitcnt vmcnt(1)
 s_barrier
 ds_read_b128 v[116:119], v20 offset:22528
 ds_read_b128 v[136:139], v20 offset:27648
 ds_read_b128 v[140:143], v20 offset:28672
 ds_read_b128 v[160:163], v20 offset:33792
 s_waitcnt lgkmcnt(6)
 v_smfmac_f32_16x16x64_bf16 v[80:83], v[124:127], a[208:215], v5
 s_waitcnt lgkmcnt(5)
 v_smfmac_f32_16x16x64_bf16 v[80:83], v[152:155], v[212:219], v5
 s_waitcnt lgkmcnt(4)
 v_smfmac_f32_16x16x64_bf16 v[80:83], v[164:167], v[220:227], v5
 s_waitcnt lgkmcnt(3)
 v_smfmac_f32_16x16x64_bf16 v[80:83], v[116:119], v[172:179], v5
 s_waitcnt vmcnt(0)
 s_barrier
 ds_read_b128 v[120:123], v20 offset:23552
 ds_read_b128 v[132:135], v20 offset:26624
 ds_read_b128 v[144:147], v20 offset:29696
 ds_read_b128 v[156:159], v20 offset:32768
 s_waitcnt lgkmcnt(6)
 v_smfmac_f32_16x16x64_bf16 v[80:83], v[136:139], v[196:203], v5
 s_waitcnt lgkmcnt(5)
 v_smfmac_f32_16x16x64_bf16 v[80:83], v[140:143], a[224:231], v5
 s_waitcnt lgkmcnt(4)
 v_smfmac_f32_16x16x64_bf16 v[80:83], v[160:163], a[248:255], v5
 s_waitcnt lgkmcnt(3)
 v_smfmac_f32_16x16x64_bf16 v[80:83], v[120:123], v[180:187], v5
 s_waitcnt lgkmcnt(2)
 v_smfmac_f32_16x16x64_bf16 v[80:83], v[132:135], v[188:195], v5
 s_waitcnt lgkmcnt(1)
 v_smfmac_f32_16x16x64_bf16 v[80:83], v[144:147], a[232:239], v5
 s_waitcnt lgkmcnt(0)
 v_smfmac_f32_16x16x64_bf16 v[80:83], v[156:159], a[240:247], v5
 s_nop 7
 v_pk_add_f32 v[84:85], v[80:81], v[82:83]
 v_cmpx_o_f32 vcc, v84, v85
 buffer_store_dword v84, v15, s[4:7], s52 offen sc1
 buffer_store_dword v85, v15, s[4:7], s52 offen offset:256 sc1
 s_cmp_eq_u64 exec, -1
 s_cbranch_scc0 L_cg_w2_bslow
L_cg_w2_bgood:
 ds_write2st64_b32 v4, v84, v85 offset0:72 offset1:73
 ds_write_b32 v37, v37 offset:19456
 s_nop 15
 s_nop 15
 s_nop 15
 s_nop 15
 s_nop 5
 s_waitcnt lgkmcnt(0)
 s_barrier
 s_nop 15
 s_nop 15
 s_nop 15
 s_nop 11
 s_mov_b32 exec_lo, s67
 s_mov_b32 exec_hi, 0
L_cg_w2_spoll:
 v_cmp_gt_u32 vcc, v30, v41
 buffer_load_dword v41, v26, s[4:7], s66 offen sc1
 s_nop 2
 buffer_load_dword v41, v26, s[4:7], s66 offen sc1
 s_cbranch_vccz L_cg_w2_sgo
 v_cmp_gt_u32 vcc, v30, v41
 buffer_load_dword v41, v26, s[4:7], s66 offen sc1
 s_nop 2
 buffer_load_dword v41, v26, s[4:7], s66 offen sc1
 s_cbranch_vccz L_cg_w2_sgo
 v_cmp_gt_u32 vcc, v30, v41
 buffer_load_dword v41, v26, s[4:7], s66 offen sc1
 s_nop 2
 buffer_load_dword v41, v26, s[4:7], s66 offen sc1
 s_cbranch_vccz L_cg_w2_sgo
 v_cmp_gt_u32 vcc, v30, v41
 buffer_load_dword v41, v26, s[4:7], s66 offen sc1
 s_nop 2
 buffer_load_dword v41, v26, s[4:7], s66 offen sc1
 s_cbranch_vccz L_cg_w2_sgo
 v_cmp_gt_u32 vcc, v30, v41
 buffer_load_dword v41, v26, s[4:7], s66 offen sc1
 s_nop 2
 buffer_load_dword v41, v26, s[4:7], s66 offen sc1
 s_cbranch_vccz L_cg_w2_sgo
 v_cmp_gt_u32 vcc, v30, v41
 buffer_load_dword v41, v26, s[4:7], s66 offen sc1
 s_nop 2
 buffer_load_dword v41, v26, s[4:7], s66 offen sc1
 s_cbranch_vccz L_cg_w2_sgo
 v_cmp_gt_u32 vcc, v30, v41
 buffer_load_dword v41, v26, s[4:7], s66 offen sc1
 s_nop 2
 buffer_load_dword v41, v26, s[4:7], s66 offen sc1
 s_cbranch_vccz L_cg_w2_sgo
 v_cmp_gt_u32 vcc, v30, v41
 buffer_load_dword v41, v26, s[4:7], s66 offen sc1
 s_nop 2
 buffer_load_dword v41, v26, s[4:7], s66 offen sc1
 s_cbranch_vccz L_cg_w2_sgo
 v_cmp_gt_u32 vcc, v30, v41
 buffer_load_dword v41, v26, s[4:7], s66 offen sc1
 s_nop 2
 buffer_load_dword v41, v26, s[4:7], s66 offen sc1
 s_cbranch_vccz L_cg_w2_sgo
 v_cmp_gt_u32 vcc, v30, v41
 buffer_load_dword v41, v26, s[4:7], s66 offen sc1
 s_nop 2
 buffer_load_dword v41, v26, s[4:7], s66 offen sc1
 s_cbranch_vccz L_cg_w2_sgo
 s_waitcnt vmcnt(36)
 s_add_u32 s58, s58, 1
 s_cmp_lt_u32 s58, 400000
 s_cbranch_scc1 L_cg_w2_spoll
 s_branch L_done
L_cg_w2_sgo:
 s_mov_b64 exec, -1
 s_barrier
 buffer_load_dwordx4 v[100:103], v6, s[4:7], s49 offen offset:2048 sc1
 s_nop 3
 buffer_load_dwordx4 v[104:107], v6, s[4:7], s49 offen offset:3072 sc1
 s_nop 3
 buffer_load_dwordx4 v[92:95], v6, s[4:7], s49 offen offset:0 sc1
 s_nop 3
 buffer_load_dwordx4 v[96:99], v6, s[4:7], s49 offen offset:1024 sc1
 s_branch L_cg_w2_loop
L_cg_w2_dslow:
 v_max_u32 v36, v92, v93
 v_max3_u32 v36, v36, v94, v95
 v_max3_u32 v36, v36, v96, v97
 v_max3_u32 v36, v36, v98, v99
 v_max3_u32 v36, v36, v100, v101
 v_max3_u32 v36, v36, v102, v103
 v_max3_u32 v36, v36, v104, v105
 v_max3_u32 v36, v36, v106, v107
 v_cmp_eq_u32 vcc, -1, v36
 s_cbranch_vccz L_cg_w2_dgood
L_cg_w2_dagain:
 buffer_load_dwordx4 v[100:103], v6, s[4:7], s49 offen offset:2048 sc1
 buffer_load_dwordx4 v[104:107], v6, s[4:7], s49 offen offset:3072 sc1
 buffer_load_dwordx4 v[92:95], v6, s[4:7], s49 offen offset:0 sc1
 buffer_load_dwordx4 v[96:99], v6, s[4:7], s49 offen offset:1024 sc1
 v_mov_b32 v56, 0
 v_mov_b32 v57, 0
 v_mov_b32 v58, 0
 v_mov_b32 v59, 0
 v_mov_b32 v60, 0
 v_mov_b32 v61, 0
 v_mov_b32 v62, 0
 v_mov_b32 v63, 0
 v_mov_b32 v64, 0
 v_mov_b32 v65, 0
 v_mov_b32 v66, 0
 v_mov_b32 v67, 0
 v_mov_b32 v68, 0
 v_mov_b32 v69, 0
 v_mov_b32 v70, 0
 v_mov_b32 v71, 0
 s_add_u32 s58, s58, 1
 s_cmp_gt_u32 s58, 400000
 s_cbranch_scc1 L_done
 s_waitcnt vmcnt(0)
 v_max_u32 v36, v92, v93
 v_max3_u32 v36, v36, v94, v95
 v_max3_u32 v36, v36, v96, v97
 v_max3_u32 v36, v36, v98, v99
 v_max3_u32 v36, v36, v100, v101
 v_max3_u32 v36, v36, v102, v103
 v_max3_u32 v36, v36, v104, v105
 v_max3_u32 v36, v36, v106, v107
 v_cmp_eq_u32 vcc, -1, v36
 s_cbranch_vccnz L_cg_w2_dagain
 s_branch L_cg_w2_dtry
L_cg_w2_bslow:
 s_mov_b64 exec, -1
 v_max_u32 v36, v108, v109
 v_max3_u32 v36, v36, v110, v111
 v_max3_u32 v36, v36, v112, v113
 v_max3_u32 v36, v36, v114, v115
 v_max3_u32 v36, v36, v116, v117
 v_max3_u32 v36, v36, v118, v119
 v_max3_u32 v36, v36, v120, v121
 v_max3_u32 v36, v36, v122, v123
 v_max3_u32 v36, v36, v124, v125
 v_max3_u32 v36, v36, v126, v127
 v_max3_u32 v36, v36, v128, v129
 v_max3_u32 v36, v36, v130, v131
 v_max3_u32 v36, v36, v132, v133
 v_max3_u32 v36, v36, v134, v135
 v_max3_u32 v36, v36, v136, v137
 v_max3_u32 v36, v36, v138, v139
 v_max3_u32 v36, v36, v140, v141
 v_max3_u32 v36, v36, v142, v143
 v_max3_u32 v36, v36, v144, v145
 v_max3_u32 v36, v36, v146, v147
 v_max3_u32 v36, v36, v148, v149
 v_max3_u32 v36, v36, v150, v151
 v_max3_u32 v36, v36, v152, v153
 v_max3_u32 v36, v36, v154, v155
 v_max3_u32 v36, v36, v156, v157
 v_max3_u32 v36, v36, v158, v159
 v_max3_u32 v36, v36, v160, v161
 v_max3_u32 v36, v36, v162, v163
 v_max3_u32 v36, v36, v164, v165
 v_max3_u32 v36, v36, v166, v167
 v_max3_u32 v36, v36, v168, v169
 v_max3_u32 v36, v36, v170, v171
 v_cmp_eq_u32 vcc, -1, v36
 s_cbranch_vccnz L_cg_w2_bagain
 buffer_store_dword v84, v15, s[4:7], s52 offen sc1
 buffer_store_dword v85, v15, s[4:7], s52 offen offset:256 sc1
 s_branch L_cg_w2_bgood
L_cg_w2_bagain:
 ds_write_b32 v37, v50 offset:19456
 v_mov_b32 v80, 0
 v_mov_b32 v81, 0
 v_mov_b32 v82, 0
 v_mov_b32 v83, 0
 s_add_u32 s58, s58, 1
 s_cmp_gt_u32 s58, 400000
 s_cbranch_scc1 L_done
 s_waitcnt lgkmcnt(0)
 s_barrier
 buffer_load_dwordx4 v6, s[4:7], s50 offen offset:2048 sc1 lds
 s_nop 3
 buffer_load_dwordx4 v6, s[4:7], s50 offen offset:3072 sc1 lds
 s_nop 3
 buffer_load_dwordx4 v6, s[4:7], s50 offen offset:0 sc1 lds
 s_nop 3
 buffer_load_dwordx4 v6, s[4:7], s50 offen offset:1024 sc1 lds
 s_branch L_cg_w2_bwait
L_cg_w2_done:
 s_waitcnt vmcnt(0) lgkmcnt(0)
 s_branch L_conv_back
L_cg_w3:
 v_mov_b32 v56, 0
 v_mov_b32 v57, 0
 v_mov_b32 v58, 0
 v_mov_b32 v59, 0
 v_mov_b32 v60, 0
 v_mov_b32 v61, 0
 v_mov_b32 v62, 0
 v_mov_b32 v63, 0
 v_mov_b32 v64, 0
 v_mov_b32 v65, 0
 v_mov_b32 v66, 0
 v_mov_b32 v67, 0
 v_mov_b32 v68, 0
 v_mov_b32 v69, 0
 v_mov_b32 v70, 0
 v_mov_b32 v71, 0
 v_mov_b32 v72, 0
 v_mov_b32 v73, 0
 v_mov_b32 v74, 0
 v_mov_b32 v75, 0
 v_mov_b32 v76, 0
 v_mov_b32 v77, 0
 v_mov_b32 v78, 0
 v_mov_b32 v79, 0
 s_waitcnt vmcnt(0)
 s_barrier
 buffer_load_dwordx4 v[104:107], v6, s[4:7], s49 offen offset:3072 sc1
 s_nop 3
 buffer_load_dwordx4 v[100:103], v6, s[4:7], s49 offen offset:2048 sc1
 s_nop 3
 buffer_load_dwordx4 v[96:99], v6, s[4:7], s49 offen offset:1024 sc1
 s_nop 3
 buffer_load_dwordx4 v[92:95], v6, s[4:7], s49 offen offset:0 sc1
L_cg_w3_loop:
 s_and_b32 s55, s48, 3
 s_add_u32 s50, s49, 262144
 s_lshl_b32 s56, s55, 16
 s_add_u32 s51, s64, s56
 v_add_u32 v30, 1, v30
L_cg_w3_dtry:
 s_waitcnt vmcnt(3)
 v_smfmac_f32_16x16x64_bf16 v[56:59], v[104:107], a[144:151], v5
 v_smfmac_f32_16x16x64_bf16 v[60:63], v[104:107], a[152:159], v5
 v_smfmac_f32_16x16x64_bf16 v[64:67], v[104:107], a[160:167], v5
 v_smfmac_f32_16x16x64_bf16 v[68:71], v[104:107], a[168:175], v5
 s_waitcnt vmcnt(2)
 v_smfmac_f32_16x16x64_bf16 v[56:59], v[100:103], a[96:103], v5
 v_smfmac_f32_16x16x64_bf16 v[60:63], v[100:103], a[104:111], v5
 v_smfmac_f32_16x16x64_bf16 v[64:67], v[100:103], a[112:119], v5
 v_smfmac_f32_16x16x64_bf16 v[68:71], v[100:103], a[120:127], v5
 s_waitcnt vmcnt(1)
 v_smfmac_f32_16x16x64_bf16 v[56:59], v[96:99], a[48:55], v5
 v_smfmac_f32_16x16x64_bf16 v[60:63], v[96:99], a[56:63], v5
 v_smfmac_f32_16x16x64_bf16 v[64:67], v[96:99], a[64:71], v5
 v_smfmac_f32_16x16x64_bf16 v[68:71], v[96:99], a[72:79], v5
 s_waitcnt vmcnt(0)
 v_smfmac_f32_16x16x64_bf16 v[56:59], v[92:95], a[0:7], v5
 v_smfmac_f32_16x16x64_bf16 v[60:63], v[92:95], a[8:15], v5
 v_smfmac_f32_16x16x64_bf16 v[64:67], v[92:95], a[16:23], v5
 v_smfmac_f32_16x16x64_bf16 v[68:71], v[92:95], a[24:31], v5
 s_nop 4
 v_pk_add_f32 v[84:85], v[56:57], v[58:59]
 ds_write2_b32 v7, v84, v85 offset0:0 offset1:36
 v_cmp_u_f32 vcc, v84, v85
 v_pk_add_f32 v[86:87], v[60:61], v[62:63]
 ds_write2_b32 v7, v86, v87 offset0:16 offset1:52
 v_pk_add_f32 v[88:89], v[64:65], v[66:67]
 ds_write2_b32 v8, v88, v89 offset0:0 offset1:36
 v_pk_add_f32 v[90:91], v[68:69], v[70:71]
 ds_write2_b32 v8, v90, v91 offset0:16 offset1:52
 s_cbranch_vccnz L_cg_w3_dslow
L_cg_w3_dgood:
 v_smfmac_f32_16x16x64_bf16 v[72:75], v[92:95], a[32:39], v5
 v_smfmac_f32_16x16x64_bf16 v[76:79], v[92:95], a[40:47], v5
 v_smfmac_f32_16x16x64_bf16 v[72:75], v[96:99], a[80:87], v5
 v_smfmac_f32_16x16x64_bf16 v[76:79], v[96:99], a[88:95], v5
 s_waitcnt lgkmcnt(0)
 s_barrier
 v_smfmac_f32_16x16x64_bf16 v[72:75], v[100:103], a[128:135], v5
 v_smfmac_f32_16x16x64_bf16 v[76:79], v[100:103], a[136:143], v5
 v_smfmac_f32_16x16x64_bf16 v[72:75], v[104:107], a[176:183], v5
 v_smfmac_f32_16x16x64_bf16 v[76:79], v[104:107], a[184:191], v5
 s_nop 7
 v_pk_add_f32 v[84:85], v[72:73], v[74:75]
 v_pk_add_f32 v[86:87], v[76:77], v[78:79]
 ds_write_b128 v10, v[84:87] offset:14336
 s_waitcnt lgkmcnt(0)
 s_barrier
 s_cmp_eq_u32 s48, 63
 s_cbranch_scc1 L_cg_w3_done
 s_lshr_b32 s56, s48, 3
 s_lshr_b32 s56, s27, s56
 s_and_b32 s56, s56, 1
 s_lshl_b32 s56, s56, 13
 s_lshl_b32 s52, s48, 18
 s_add_u32 s52, s52, s56
 s_add_u32 s52, s52, 134217728
 s_mov_b32 m0, 32768
 v_mov_b32 v80, 0
 v_mov_b32 v81, 0
 v_mov_b32 v82, 0
 v_mov_b32 v83, 0
 s_xor_b32 s59, s49, 0x8000
 s_xor_b32 s60, s51, 0x20000
 s_barrier
 buffer_load_dwordx4 v6, s[4:7], s50 offen offset:3072 sc1 lds
 s_nop 3
 buffer_load_dwordx4 v6, s[4:7], s50 offen offset:2048 sc1 lds
 s_nop 3
 buffer_load_dwordx4 v6, s[4:7], s50 offen offset:1024 sc1 lds
 s_nop 3
 buffer_load_dwordx4 v6, s[4:7], s50 offen offset:0 sc1 lds
 s_add_u32 s48, s48, 1
 s_and_b32 s57, s48, 3
 s_lshl_b32 s57, s57, 14
 s_add_u32 s49, s63, s57
 v_mov_b32 v56, 0
 v_mov_b32 v57, 0
 v_mov_b32 v58, 0
 v_mov_b32 v59, 0
 v_mov_b32 v60, 0
 v_mov_b32 v61, 0
 v_mov_b32 v62, 0
 v_mov_b32 v63, 0
 v_mov_b32 v64, 0
 v_mov_b32 v65, 0
 v_mov_b32 v66, 0
 v_mov_b32 v67, 0
 v_mov_b32 v68, 0
 v_mov_b32 v69, 0
 v_mov_b32 v70, 0
 v_mov_b32 v71, 0
 v_mov_b32 v72, 0
 v_mov_b32 v73, 0
 v_mov_b32 v74, 0
 v_mov_b32 v75, 0
 v_mov_b32 v76, 0
 v_mov_b32 v77, 0
 v_mov_b32 v78, 0
 v_mov_b32 v79, 0
L_cg_w3_bwait:
 s_waitcnt vmcnt(3)
 s_barrier
 ds_read_b128 v[108:111], v20 offset:20480
 ds_read_b128 v[128:131], v20 offset:25600
 ds_read_b128 v[148:151], v20 offset:30720
 ds_read_b128 v[168:171], v20 offset:35840
 s_waitcnt lgkmcnt(3)
 v_smfmac_f32_16x16x64_bf16 v[80:83], v[108:111], a[192:199], v5
 s_waitcnt vmcnt(2)
 s_barrier
 ds_read_b128 v[112:115], v20 offset:21504
 ds_read_b128 v[124:127], v20 offset:24576
 ds_read_b128 v[152:155], v20 offset:31744
 ds_read_b128 v[164:167], v20 offset:34816
 s_waitcnt lgkmcnt(6)
 v_smfmac_f32_16x16x64_bf16 v[80:83], v[128:131], a[216:223], v5
 s_waitcnt lgkmcnt(5)
 v_smfmac_f32_16x16x64_bf16 v[80:83], v[148:151], v[204:211], v5
 s_waitcnt lgkmcnt(4)
 v_smfmac_f32_16x16x64_bf16 v[80:83], v[168:171], v[228:235], v5
 s_waitcnt lgkmcnt(3)
 v_smfmac_f32_16x16x64_bf16 v[80:83], v[112:115], a[200:207], v5
 s_waitcnt vmcnt(1)
 s_barrier
 ds_read_b128 v[116:119], v20 offset:22528
 ds_read_b128 v[136:139], v20 offset:27648
 ds_read_b128 v[140:143], v20 offset:28672
 ds_read_b128 v[160:163], v20 offset:33792
 s_waitcnt lgkmcnt(6)
 v_smfmac_f32_16x16x64_bf16 v[80:83], v[124:127], a[208:215], v5
 s_waitcnt lgkmcnt(5)
 v_smfmac_f32_16x16x64_bf16 v[80:83], v[152:155], v[212:219], v5
 s_waitcnt lgkmcnt(4)
 v_smfmac_f32_16x16x64_bf16 v[80:83], v[164:167], v[220:227], v5
 s_waitcnt lgkmcnt(3)
 v_smfmac_f32_16x16x64_bf16 v[80:83], v[116:119], v[172:179], v5
 s_waitcnt vmcnt(0)
 s_barrier
 ds_read_b128 v[120:123], v20 offset:23552
 ds_read_b128 v[132:135], v20 offset:26624
 ds_read_b128 v[144:147], v20 offset:29696
 ds_read_b128 v[156:159], v20 offset:32768
 s_waitcnt lgkmcnt(6)
 v_smfmac_f32_16x16x64_bf16 v[80:83], v[136:139], v[196:203], v5
 s_waitcnt lgkmcnt(5)
 v_smfmac_f32_16x16x64_bf16 v[80:83], v[140:143], a[224:231], v5
 s_waitcnt lgkmcnt(4)
 v_smfmac_f32_16x16x64_bf16 v[80:83], v[160:163], a[248:255], v5
 s_waitcnt lgkmcnt(3)
 v_smfmac_f32_16x16x64_bf16 v[80:83], v[120:123], v[180:187], v5
 s_waitcnt lgkmcnt(2)
 v_smfmac_f32_16x16x64_bf16 v[80:83], v[132:135], v[188:195], v5
 s_waitcnt lgkmcnt(1)
 v_smfmac_f32_16x16x64_bf16 v[80:83], v[144:147], a[232:239], v5
 s_waitcnt lgkmcnt(0)
 v_smfmac_f32_16x16x64_bf16 v[80:83], v[156:159], a[240:247], v5
 s_nop 7
 v_pk_add_f32 v[84:85], v[80:81], v[82:83]
 v_cmpx_o_f32 vcc, v84, v85
 buffer_store_dword v84, v15, s[4:7], s52 offen sc1
 buffer_store_dword v85, v15, s[4:7], s52 offen offset:256 sc1
 s_cmp_eq_u64 exec, -1
 s_cbranch_scc0 L_cg_w3_bslow
L_cg_w3_bgood:
 ds_write2st64_b32 v4, v84, v85 offset0:74 offset1:75
 s_add_u32 s56, s59, 262144
 buffer_store_dwordx4 v[50:53], v21, s[4:7], s59 offen sc1
 buffer_store_dwordx4 v[50:53], v21, s[4:7], s56 offen sc1
 buffer_store_dwordx4 v[50:53], v22, s[4:7], s60 offen sc1
 buffer_store_dwordx4 v[50:53], v23, s[4:7], s60 offen offset:1024 sc1
 s_waitcnt lgkmcnt(0)
 s_barrier
 s_barrier
 buffer_load_dwordx4 v[104:107], v6, s[4:7], s49 offen offset:3072 sc1
 s_nop 3
 buffer_load_dwordx4 v[100:103], v6, s[4:7], s49 offen offset:2048 sc1
 s_nop 3
 buffer_load_dwordx4 v[96:99], v6, s[4:7], s49 offen offset:1024 sc1
 s_nop 3
 buffer_load_dwordx4 v[92:95], v6, s[4:7], s49 offen offset:0 sc1
 s_branch L_cg_w3_loop
L_cg_w3_dslow:
 v_max_u32 v36, v92, v93
 v_max3_u32 v36, v36, v94, v95
 v_max3_u32 v36, v36, v96, v97
 v_max3_u32 v36, v36, v98, v99
 v_max3_u32 v36, v36, v100, v101
 v_max3_u32 v36, v36, v102, v103
 v_max3_u32 v36, v36, v104, v105
 v_max3_u32 v36, v36, v106, v107
 v_cmp_eq_u32 vcc, -1, v36
 s_cbranch_vccz L_cg_w3_dgood
L_cg_w3_dagain:
 buffer_load_dwordx4 v[104:107], v6, s[4:7], s49 offen offset:3072 sc1
 buffer_load_dwordx4 v[100:103], v6, s[4:7], s49 offen offset:2048 sc1
 buffer_load_dwordx4 v[96:99], v6, s[4:7], s49 offen offset:1024 sc1
 buffer_load_dwordx4 v[92:95], v6, s[4:7], s49 offen offset:0 sc1
 v_mov_b32 v56, 0
 v_mov_b32 v57, 0
 v_mov_b32 v58, 0
 v_mov_b32 v59, 0
 v_mov_b32 v60, 0
 v_mov_b32 v61, 0
 v_mov_b32 v62, 0
 v_mov_b32 v63, 0
 v_mov_b32 v64, 0
 v_mov_b32 v65, 0
 v_mov_b32 v66, 0
 v_mov_b32 v67, 0
 v_mov_b32 v68, 0
 v_mov_b32 v69, 0
 v_mov_b32 v70, 0
 v_mov_b32 v71, 0
 s_add_u32 s58, s58, 1
 s_cmp_gt_u32 s58, 400000
 s_cbranch_scc1 L_done
 s_waitcnt vmcnt(0)
 v_max_u32 v36, v92, v93
 v_max3_u32 v36, v36, v94, v95
 v_max3_u32 v36, v36, v96, v97
 v_max3_u32 v36, v36, v98, v99
 v_max3_u32 v36, v36, v100, v101
 v_max3_u32 v36, v36, v102, v103
 v_max3_u32 v36, v36, v104, v105
 v_max3_u32 v36, v36, v106, v107
 v_cmp_eq_u32 vcc, -1, v36
 s_cbranch_vccnz L_cg_w3_dagain
 s_branch L_cg_w3_dtry
L_cg_w3_bslow:
 s_mov_b64 exec, -1
 v_max_u32 v36, v108, v109
 v_max3_u32 v36, v36, v110, v111
 v_max3_u32 v36, v36, v112, v113
 v_max3_u32 v36, v36, v114, v115
 v_max3_u32 v36, v36, v116, v117
 v_max3_u32 v36, v36, v118, v119
 v_max3_u32 v36, v36, v120, v121
 v_max3_u32 v36, v36, v122, v123
 v_max3_u32 v36, v36, v124, v125
 v_max3_u32 v36, v36, v126, v127
 v_max3_u32 v36, v36, v128, v129
 v_max3_u32 v36, v36, v130, v131
 v_max3_u32 v36, v36, v132, v133
 v_max3_u32 v36, v36, v134, v135
 v_max3_u32 v36, v36, v136, v137
 v_max3_u32 v36, v36, v138, v139
 v_max3_u32 v36, v36, v140, v141
 v_max3_u32 v36, v36, v142, v143
 v_max3_u32 v36, v36, v144, v145
 v_max3_u32 v36, v36, v146, v147
 v_max3_u32 v36, v36, v148, v149
 v_max3_u32 v36, v36, v150, v151
 v_max3_u32 v36, v36, v152, v153
 v_max3_u32 v36, v36, v154, v155
 v_max3_u32 v36, v36, v156, v157
 v_max3_u32 v36, v36, v158, v159
 v_max3_u32 v36, v36, v160, v161
 v_max3_u32 v36, v36, v162, v163
 v_max3_u32 v36, v36, v164, v165
 v_max3_u32 v36, v36, v166, v167
 v_max3_u32 v36, v36, v168, v169
 v_max3_u32 v36, v36, v170, v171
 v_cmp_eq_u32 vcc, -1, v36
 s_cbranch_vccnz L_cg_w3_bagain
 buffer_store_dword v84, v15, s[4:7], s52 offen sc1
 buffer_store_dword v85, v15, s[4:7], s52 offen offset:256 sc1
 s_branch L_cg_w3_bgood
L_cg_w3_bagain:
 v_mov_b32 v80, 0
 v_mov_b32 v81, 0
 v_mov_b32 v82, 0
 v_mov_b32 v83, 0
 s_add_u32 s58, s58, 1
 s_cmp_gt_u32 s58, 400000
 s_cbranch_scc1 L_done
 s_waitcnt lgkmcnt(0)
 s_barrier
 buffer_load_dwordx4 v6, s[4:7], s50 offen offset:3072 sc1 lds
 s_nop 3
 buffer_load_dwordx4 v6, s[4:7], s50 offen offset:2048 sc1 lds
 s_nop 3
 buffer_load_dwordx4 v6, s[4:7], s50 offen offset:1024 sc1 lds
 s_nop 3
 buffer_load_dwordx4 v6, s[4:7], s50 offen offset:0 sc1 lds
 s_branch L_cg_w3_bwait
L_cg_w3_done:
 s_waitcnt vmcnt(0) lgkmcnt(0)
 s_branch L_conv_back
.section .rodata,"a"
.p2align 6
.amdhsa_kernel concat_heads__memory_aug_recurrent_mem_tr__ssm_conv_s4__prompt_kernel
  .amdhsa_next_free_vgpr 512
  .amdhsa_next_free_sgpr 102
  .amdhsa_accum_offset 256
  .amdhsa_group_segment_fixed_size 0
  .amdhsa_kernarg_size 152
  .amdhsa_user_sgpr_count 2
  .amdhsa_user_sgpr_kernarg_segment_ptr 1
  .amdhsa_system_sgpr_workgroup_id_x 1
  .amdhsa_float_denorm_mode_32 3
.end_amdhsa_kernel
```
